```python
import torch

def _softmax(x, axis=-1):
    return torch.softmax(x, dim=axis)
def _gelu(x):
    return torch.nn.functional.gelu(x, approximate="tanh")
def _silu(x):
    return torch.nn.functional.silu(x)
def _sigmoid(x):
    return torch.sigmoid(x)
def _layernorm(x, axis=-1, eps=1e-5):
    m = x.mean(dim=axis, keepdim=True)
    v = x.var(dim=axis, keepdim=True, unbiased=False)
    return (x - m) / torch.sqrt(v + eps)
def _scatter_add(tgt, idx, src, axis=0):
    return tgt.clone().index_add_(axis, idx, src)
def _segment_sum(src, seg, n):
    out = torch.zeros((n,) + src.shape[1:], dtype=src.dtype)
    return out.index_add_(0, seg, src)
def _pad(x, pw):
    flat = tuple(v for pair in reversed(pw) for v in pair)
    return torch.nn.functional.pad(x, flat)

kernel_name = 'standalone__mha_softmax__near_ridge'

def setup_inputs():

    _w = (lambda a: (lambda t: t.to(torch.bfloat16) if t.is_floating_point() else t)(torch.as_tensor(a)))
    B, H, Sq, Sk, D = 16, 32, 384, 512, 128
    return {
        "q": _w((lambda *s: torch.randn(*s, dtype=torch.bfloat16) * 0.8)(B, H, Sq, D)),
        "k": _w((lambda *s: torch.randn(*s, dtype=torch.bfloat16) * 0.8)(B, H, Sk, D)),
        "v": _w((lambda *s: torch.randn(*s, dtype=torch.bfloat16) * 0.05)(B, H, Sk, D)),
    }

def reference(q, k, v):
    scale = q.shape[-1] ** -0.5
    scores = torch.einsum("bhqd,bhkd->bhqk", q, k) * scale
    p = _softmax(scores, axis=-1)
    return torch.einsum("bhqk,bhkd->bhqd", p, v)
```

```asm
; @launch grid=(256,1,1) block=(256,1,1) lds=163392
.amdgcn_target "amdgcn-amd-amdhsa--gfx950"
.text
.globl standalone__mha_softmax__near_ridge_kernel
.p2align 8
.type standalone__mha_softmax__near_ridge_kernel,@function
standalone__mha_softmax__near_ridge_kernel:
 s_load_dwordx8 s[4:11], s[0:1], 0
 s_cmp_ge_u32 s2, 256
 s_cbranch_scc1 L_exit
 v_lshrrev_b32 v10, 6, v0
 v_lshrrev_b32 v11, 3, v0
 v_readfirstlane_b32 s3, v10
 v_and_b32 v0, 63, v0
 v_lshlrev_b32 v1, 4, v0
 s_getpc_b64 s[12:13]
 s_lshr_b32 s38, s2, 3
 s_getreg_b32 s47, hwreg(HW_REG_XCC_ID, 0, 1)
 s_and_b32 s59, s38, 15
 s_lshl_b32 s59, s59, 12
 s_mul_i32 s40, s47, L_main1-L_main0
 s_add_u32 s59, s59, s40
 s_add_u32 s59, s59, L_main0-standalone__mha_softmax__near_ridge_kernel-64
 s_cmp_eq_u32 s38, 31
 s_cselect_b32 s38, 0, s59
 v_lshl_add_u32 v11, v11, 7, s38
 v_min_u32 v11, L_last-standalone__mha_softmax__near_ridge_kernel-64, v11
 global_load_dword a255, v11, s[12:13]
 s_mov_b32 s56, s2
 s_mov_b32 s23, 0x20000
 s_mov_b32 s22, 67108864
 s_mul_i32 s39, s3, 4224
 s_lshl_b32 s33, s56, 17
 s_and_b32 s38, s3, 1
 s_lshl_b32 s38, s38, 12
 s_add_u32 s33, s33, s38
 s_mul_i32 s38, s56, 98304
 s_mul_i32 s59, s3, 24576
 s_add_u32 s38, s38, s59
 s_mov_b32 s18, 24576
 s_mov_b32 s19, 0x20000
 s_mul_i32 s45, s3, 23936
 s_add_u32 s45, s45, 67584
 s_mov_b32 m0, s39
 s_cmp_lt_u32 s3, 2
 s_waitcnt lgkmcnt(0)
 s_cselect_b64 s[20:21], s[6:7], s[8:9]
 buffer_load_dwordx4 v1, s[20:23], s33 offen nt lds
 s_add_u32 m0, s39, 32
 s_mov_b32 s27, 0x20000
 buffer_load_dwordx4 v1, s[20:23], s33 offen offset:1024 nt lds
 s_add_u32 m0, s39, 64
 s_mov_b32 s31, 0x20000
 buffer_load_dwordx4 v1, s[20:23], s33 offen offset:2048 nt lds
 s_add_u32 m0, s39, 96
 s_mov_b32 s52, 0
 buffer_load_dwordx4 v1, s[20:23], s33 offen offset:3072 nt lds
 s_add_u32 s33, s33, 8192
 s_add_u32 s16, s4, s38
 s_addc_u32 s17, s5, 0
 s_mov_b32 s59, 0
 s_add_u32 m0, s45, 0
 s_mov_b64 s[50:51], 0
 buffer_load_dwordx4 v1, s[16:19], s59 offen nt lds
 s_add_u32 m0, s45, 64
 s_mov_b32 s32, 0x3e0293ee
 buffer_load_dwordx4 v1, s[16:19], s59 offen offset:1024 nt lds
 s_add_u32 m0, s45, 128
 s_mov_b32 s60, 1.0
 buffer_load_dwordx4 v1, s[16:19], s59 offen offset:2048 nt lds
 s_add_u32 m0, s45, 192
 s_mov_b32 s61, 0x4e800000
 buffer_load_dwordx4 v1, s[16:19], s59 offen offset:3072 nt lds
 s_add_u32 m0, s39, 16896
 s_add_u32 s57, s56, 256
 buffer_load_dwordx4 v1, s[20:23], s33 offen nt lds
 s_add_u32 m0, s39, 16928
 s_mov_b32 s34, 0xffff0000
 buffer_load_dwordx4 v1, s[20:23], s33 offen offset:1024 nt lds
 v_and_b32 v10, 15, v0
 v_lshrrev_b32 v11, 4, v0
 v_and_b32 v12, 7, v10
 v_mul_u32_u24 v7, 1056, v12
 v_lshrrev_b32 v12, 3, v10
 v_lshl_add_u32 v7, v12, 8, v7
 v_lshl_add_u32 v7, v11, 4, v7
 v_bfe_u32 v12, v0, 2, 3
 v_mul_u32_u24 v8, 1056, v12
 v_lshrrev_b32 v12, 5, v0
 v_lshl_add_u32 v8, v12, 8, v8
 v_and_b32 v12, 3, v0
 v_lshl_add_u32 v8, v12, 3, v8
 v_add_u32 v8, 8448, v8
 v_cmp_gt_u32 vcc, 2, v12
 v_mov_b32 v15, 0x3f803f80
 v_mul_u32_u24 v4, 1088, v12
 v_cndmask_b32 v14, 0, v15, vcc
 v_lshrrev_b32 v13, 2, v10
 v_lshl_add_u32 v4, v13, 8, v4
 v_lshl_add_u32 v4, v11, 4, v4
 v_add_u32 v4, s45, v4
 v_lshl_add_u32 v12, v12, 2, v13
 v_mul_u32_u24 v5, 272, v12
 v_lshl_add_u32 v5, v11, 3, v5
 v_add_u32 v5, s45, v5
 v_mul_u32_u24 v6, 272, v11
 v_lshl_add_u32 v6, v10, 4, v6
 v_add_u32 v6, s45, v6
 v_sub_u32 v15, v15, v14
 v_and_b32 v12, 1, v0
 v_mul_u32_u24 v12, 0xaaaa, v12
 v_add_u32 v2, 0x4444, v12
 v_accvgpr_write_b32 a236, v14
 v_accvgpr_write_b32 a237, v14
 v_accvgpr_write_b32 a238, v14
 v_accvgpr_write_b32 a239, v14
 v_accvgpr_write_b32 a240, v15
 v_accvgpr_write_b32 a241, v15
 v_accvgpr_write_b32 a242, v15
 v_accvgpr_write_b32 a243, v15
 v_accvgpr_write_b32 a224, 0
 v_accvgpr_write_b32 a225, 0
 v_accvgpr_write_b32 a226, 0
 v_accvgpr_write_b32 a227, 0
 v_accvgpr_write_b32 a228, 0
 v_accvgpr_write_b32 a229, 0
 v_accvgpr_write_b32 a230, 0
 v_accvgpr_write_b32 a231, 0
 v_accvgpr_write_b32 a232, 0
 v_accvgpr_write_b32 a233, 0
 v_accvgpr_write_b32 a234, 0
 v_accvgpr_write_b32 a235, 0
 s_mul_i32 s38, s56, 98304
 s_mul_i32 s59, s3, 24576
 s_add_u32 s38, s38, s59
 s_add_u32 s24, s10, s38
 s_addc_u32 s25, s11, 0
 s_mul_i32 s38, s57, 98304
 s_mul_i32 s59, s3, 24576
 s_add_u32 s38, s38, s59
 s_add_u32 s28, s4, s38
 s_addc_u32 s29, s5, 0
 s_lshl_b32 s46, s57, 17
 s_and_b32 s38, s3, 1
 s_lshl_b32 s38, s38, 12
 s_add_u32 s46, s46, s38
 s_add_u32 m0, s39, 16960
 s_mov_b32 s26, 24576
 buffer_load_dwordx4 v1, s[20:23], s33 offen offset:2048 nt lds
 s_add_u32 m0, s39, 16992
 s_mov_b32 s30, 24576
 buffer_load_dwordx4 v1, s[20:23], s33 offen offset:3072 nt lds
 s_add_u32 s33, s33, 8192
 s_mov_b64 exec, 0
 s_cmp_eq_u32 s47, 0
 s_cbranch_scc1 L_visit0
 s_cmp_eq_u32 s3, 0
 s_cbranch_scc1 L_pg1_0
 s_cmp_eq_u32 s3, 1
 s_cbranch_scc1 L_pg1_1
 s_cmp_eq_u32 s3, 2
 s_cbranch_scc1 L_pg1_2
 s_branch L_pg1_3
L_visit0:
 s_cmp_eq_u32 s3, 0
 s_cbranch_scc1 L_pg0_0
 s_cmp_eq_u32 s3, 1
 s_cbranch_scc1 L_pg0_1
 s_cmp_eq_u32 s3, 2
 s_cbranch_scc1 L_pg0_2
 s_branch L_pg0_3
.p2align 12
L_main0:
 s_mov_b64 exec, -1
 s_waitcnt vmcnt(8)
 s_barrier
 ds_read_b128 a[96:99], v7 offset:0
 ds_read_b128 a[100:103], v7 offset:64
 ds_read_b128 a[104:107], v7 offset:128
 ds_read_b128 a[108:111], v7 offset:192
 ds_read_b128 a[124:127], v7 offset:704
 ds_read_b128 a[120:123], v7 offset:640
 ds_read_b128 a[116:119], v7 offset:576
 ds_read_b128 a[112:115], v7 offset:512
 s_waitcnt vmcnt(4)
 ds_read_b128 v[64:67], v4 offset:0
 ds_read_b128 v[68:71], v4 offset:64
 ds_read_b128 v[72:75], v4 offset:128
 ds_read_b128 v[76:79], v4 offset:192
 s_mov_b32 s59, 4096
 s_add_u32 m0, s45, 17408
 s_nop 0
 buffer_load_dwordx4 v1, s[16:19], s59 offen nt lds
 s_add_u32 m0, s45, 17472
 s_nop 0
 buffer_load_dwordx4 v1, s[16:19], s59 offen offset:1024 nt lds
 s_add_u32 m0, s45, 17536
 s_nop 0
 buffer_load_dwordx4 v1, s[16:19], s59 offen offset:2048 nt lds
 s_add_u32 m0, s45, 17600
 s_nop 0
 buffer_load_dwordx4 v1, s[16:19], s59 offen offset:3072 nt lds
 s_waitcnt lgkmcnt(0)
 v_lshlrev_b32 v14, 16, v64
 v_and_b32 v15, s34, v64
 v_lshlrev_b32 v16, 16, v65
 v_and_b32 v17, s34, v65
 v_lshlrev_b32 v18, 16, v66
 v_and_b32 v19, s34, v66
 v_lshlrev_b32 v20, 16, v67
 v_and_b32 v21, s34, v67
 v_pk_mul_f32 v[14:15], v[14:15], s[32:33] op_sel_hi:[1,0]
 v_pk_mul_f32 v[16:17], v[16:17], s[32:33] op_sel_hi:[1,0]
 v_pk_mul_f32 v[18:19], v[18:19], s[32:33] op_sel_hi:[1,0]
 v_pk_mul_f32 v[20:21], v[20:21], s[32:33] op_sel_hi:[1,0]
 v_cvt_pk_bf16_f32 v14, v14, v15
 v_cvt_pk_bf16_f32 v16, v16, v17
 v_cvt_pk_bf16_f32 v18, v18, v19
 v_cvt_pk_bf16_f32 v20, v20, v21
 v_accvgpr_write_b32 a0, v14
 v_accvgpr_write_b32 a1, v16
 v_accvgpr_write_b32 a2, v18
 v_accvgpr_write_b32 a3, v20
 v_lshlrev_b32 v14, 16, v68
 v_and_b32 v15, s34, v68
 v_lshlrev_b32 v16, 16, v69
 v_and_b32 v17, s34, v69
 v_lshlrev_b32 v18, 16, v70
 v_and_b32 v19, s34, v70
 v_lshlrev_b32 v20, 16, v71
 v_and_b32 v21, s34, v71
 v_pk_mul_f32 v[14:15], v[14:15], s[32:33] op_sel_hi:[1,0]
 v_pk_mul_f32 v[16:17], v[16:17], s[32:33] op_sel_hi:[1,0]
 v_pk_mul_f32 v[18:19], v[18:19], s[32:33] op_sel_hi:[1,0]
 v_pk_mul_f32 v[20:21], v[20:21], s[32:33] op_sel_hi:[1,0]
 v_cvt_pk_bf16_f32 v14, v14, v15
 v_cvt_pk_bf16_f32 v16, v16, v17
 v_cvt_pk_bf16_f32 v18, v18, v19
 v_cvt_pk_bf16_f32 v20, v20, v21
 v_accvgpr_write_b32 a4, v14
 v_accvgpr_write_b32 a5, v16
 v_accvgpr_write_b32 a6, v18
 v_accvgpr_write_b32 a7, v20
 v_lshlrev_b32 v14, 16, v72
 v_and_b32 v15, s34, v72
 v_lshlrev_b32 v16, 16, v73
 v_and_b32 v17, s34, v73
 v_lshlrev_b32 v18, 16, v74
 v_and_b32 v19, s34, v74
 v_lshlrev_b32 v20, 16, v75
 v_and_b32 v21, s34, v75
 v_pk_mul_f32 v[14:15], v[14:15], s[32:33] op_sel_hi:[1,0]
 v_pk_mul_f32 v[16:17], v[16:17], s[32:33] op_sel_hi:[1,0]
 v_pk_mul_f32 v[18:19], v[18:19], s[32:33] op_sel_hi:[1,0]
 v_pk_mul_f32 v[20:21], v[20:21], s[32:33] op_sel_hi:[1,0]
 v_cvt_pk_bf16_f32 v14, v14, v15
 v_cvt_pk_bf16_f32 v16, v16, v17
 v_cvt_pk_bf16_f32 v18, v18, v19
 v_cvt_pk_bf16_f32 v20, v20, v21
 v_accvgpr_write_b32 a8, v14
 v_accvgpr_write_b32 a9, v16
 v_accvgpr_write_b32 a10, v18
 v_accvgpr_write_b32 a11, v20
 v_lshlrev_b32 v14, 16, v76
 v_and_b32 v15, s34, v76
 v_lshlrev_b32 v16, 16, v77
 v_and_b32 v17, s34, v77
 v_lshlrev_b32 v18, 16, v78
 v_and_b32 v19, s34, v78
 v_lshlrev_b32 v20, 16, v79
 v_and_b32 v21, s34, v79
 v_pk_mul_f32 v[14:15], v[14:15], s[32:33] op_sel_hi:[1,0]
 v_pk_mul_f32 v[16:17], v[16:17], s[32:33] op_sel_hi:[1,0]
 v_pk_mul_f32 v[18:19], v[18:19], s[32:33] op_sel_hi:[1,0]
 v_pk_mul_f32 v[20:21], v[20:21], s[32:33] op_sel_hi:[1,0]
 v_cvt_pk_bf16_f32 v14, v14, v15
 v_cvt_pk_bf16_f32 v16, v16, v17
 v_cvt_pk_bf16_f32 v18, v18, v19
 v_cvt_pk_bf16_f32 v20, v20, v21
 v_accvgpr_write_b32 a12, v14
 v_accvgpr_write_b32 a13, v16
 v_accvgpr_write_b32 a14, v18
 v_accvgpr_write_b32 a15, v20
 s_nop 1
 v_mfma_f32_16x16x32_bf16 v[24:27], a[96:99], a[0:3], 0
 ds_read_b64_tr_b16 a[160:161], v8 offset:0
 ds_read_b64_tr_b16 a[162:163], v8 offset:512
 v_mfma_f32_16x16x32_bf16 v[24:27], a[100:103], a[4:7], v[24:27]
 ds_read_b64_tr_b16 a[164:165], v8 offset:32
 ds_read_b64_tr_b16 a[166:167], v8 offset:544
 v_mfma_f32_16x16x32_bf16 v[24:27], a[104:107], a[8:11], v[24:27]
 ds_read_b64_tr_b16 a[168:169], v8 offset:64
 ds_read_b64_tr_b16 a[170:171], v8 offset:576
 v_mfma_f32_16x16x32_bf16 v[24:27], a[108:111], a[12:15], v[24:27]
 ds_read_b64_tr_b16 a[172:173], v8 offset:96
 ds_read_b64_tr_b16 a[174:175], v8 offset:608
 v_mfma_f32_16x16x32_bf16 v[28:31], a[124:127], a[12:15], 0
 ds_read_b64_tr_b16 a[176:177], v8 offset:128
 ds_read_b64_tr_b16 a[178:179], v8 offset:640
 v_mfma_f32_16x16x32_bf16 v[28:31], a[120:123], a[8:11], v[28:31]
 ds_read_b64_tr_b16 a[180:181], v8 offset:160
 ds_read_b64_tr_b16 a[182:183], v8 offset:672
 v_mfma_f32_16x16x32_bf16 v[28:31], a[116:119], a[4:7], v[28:31]
 ds_read_b64_tr_b16 a[184:185], v8 offset:192
 ds_read_b64_tr_b16 a[186:187], v8 offset:704
 v_mfma_f32_16x16x32_bf16 v[28:31], a[112:115], a[0:3], v[28:31]
 ds_read_b64_tr_b16 a[188:189], v8 offset:224
 ds_read_b64_tr_b16 a[190:191], v8 offset:736
 s_waitcnt vmcnt(4)
 s_barrier
 ds_read_b128 a[128:131], v7 offset:16896
 ds_read_b128 a[132:135], v7 offset:16960
 ds_read_b128 a[136:139], v7 offset:17024
 ds_read_b128 a[140:143], v7 offset:17088
 ds_read_b128 a[156:159], v7 offset:17600
 ds_read_b128 a[152:155], v7 offset:17536
 ds_read_b128 a[148:151], v7 offset:17472
 ds_read_b128 a[144:147], v7 offset:17408
 ds_read_b64_tr_b16 a[192:193], v8 offset:16896
 ds_read_b64_tr_b16 a[194:195], v8 offset:17408
 ds_read_b64_tr_b16 a[196:197], v8 offset:16928
 ds_read_b64_tr_b16 a[198:199], v8 offset:17440
 ds_read_b64_tr_b16 a[200:201], v8 offset:16960
 ds_read_b64_tr_b16 a[202:203], v8 offset:17472
 ds_read_b64_tr_b16 a[204:205], v8 offset:16992
 ds_read_b64_tr_b16 a[206:207], v8 offset:17504
 s_mov_b32 s59, 8192
 s_add_u32 m0, s45, 4352
 s_nop 0
 buffer_load_dwordx4 v1, s[16:19], s59 offen nt lds
 s_add_u32 m0, s45, 4416
 s_nop 0
 buffer_load_dwordx4 v1, s[16:19], s59 offen offset:1024 nt lds
 s_add_u32 m0, s45, 4480
 s_nop 0
 buffer_load_dwordx4 v1, s[16:19], s59 offen offset:2048 nt lds
 s_add_u32 m0, s45, 4544
 s_nop 0
 buffer_load_dwordx4 v1, s[16:19], s59 offen offset:3072 nt lds
 s_waitcnt lgkmcnt(8)
 v_mfma_f32_16x16x32_bf16 v[32:35], a[128:131], a[0:3], 0
 s_mov_b32 s59, 12288
 s_waitcnt vmcnt(4)
 ds_read_b128 v[96:99], v4 offset:17408
 ds_read_b128 v[100:103], v4 offset:17472
 ds_read_b128 v[104:107], v4 offset:17536
 ds_read_b128 v[108:111], v4 offset:17600
 v_exp_f32 v24, v24
 v_exp_f32 v25, v25
 v_mfma_f32_16x16x32_bf16 v[32:35], a[132:135], a[4:7], v[32:35]
 s_add_u32 m0, s45, 8704
 v_exp_f32 v26, v26
 v_mfma_f32_16x16x32_bf16 v[32:35], a[136:139], a[8:11], v[32:35]
 buffer_load_dwordx4 v1, s[16:19], s59 offen nt lds
 s_add_u32 m0, s45, 8768
 v_exp_f32 v27, v27
 v_exp_f32 v28, v28
 v_cvt_pk_bf16_f32 v40, v24, v25
 v_mfma_f32_16x16x32_bf16 v[32:35], a[140:143], a[12:15], v[32:35]
 buffer_load_dwordx4 v1, s[16:19], s59 offen offset:1024 nt lds
 s_add_u32 m0, s45, 8832
 v_cvt_pk_bf16_f32 v41, v26, v27
 v_exp_f32 v29, v29
 v_exp_f32 v30, v30
 v_mfma_f32_16x16x32_bf16 v[36:39], a[156:159], a[12:15], 0
 buffer_load_dwordx4 v1, s[16:19], s59 offen offset:2048 nt lds
 s_add_u32 m0, s45, 8896
 v_exp_f32 v31, v31
 v_cvt_pk_bf16_f32 v42, v28, v29
 v_cvt_pk_bf16_f32 v43, v30, v31
 v_mfma_f32_16x16x32_bf16 v[36:39], a[152:155], a[8:11], v[36:39]
 s_waitcnt lgkmcnt(3)
 buffer_load_dwordx4 v1, s[16:19], s59 offen offset:3072 nt lds
 v_lshlrev_b32 v14, 16, v96
 v_and_b32 v15, s34, v96
 v_lshlrev_b32 v16, 16, v97
 v_and_b32 v17, s34, v97
 v_lshlrev_b32 v18, 16, v98
 v_and_b32 v19, s34, v98
 v_lshlrev_b32 v20, 16, v99
 v_and_b32 v21, s34, v99
 v_pk_mul_f32 v[14:15], v[14:15], s[32:33] op_sel_hi:[1,0]
 v_pk_mul_f32 v[16:17], v[16:17], s[32:33] op_sel_hi:[1,0]
 v_pk_mul_f32 v[18:19], v[18:19], s[32:33] op_sel_hi:[1,0]
 v_pk_mul_f32 v[20:21], v[20:21], s[32:33] op_sel_hi:[1,0]
 v_cvt_pk_bf16_f32 v14, v14, v15
 v_cvt_pk_bf16_f32 v16, v16, v17
 v_cvt_pk_bf16_f32 v18, v18, v19
 v_cvt_pk_bf16_f32 v20, v20, v21
 v_accvgpr_write_b32 a16, v14
 v_accvgpr_write_b32 a17, v16
 v_accvgpr_write_b32 a18, v18
 v_accvgpr_write_b32 a19, v20
 v_mfma_f32_16x16x32_bf16 v[36:39], a[148:151], a[4:7], v[36:39]
 s_waitcnt lgkmcnt(1)
 v_lshlrev_b32 v14, 16, v100
 v_and_b32 v15, s34, v100
 v_lshlrev_b32 v16, 16, v101
 v_and_b32 v17, s34, v101
 v_lshlrev_b32 v18, 16, v102
 v_and_b32 v19, s34, v102
 v_lshlrev_b32 v20, 16, v103
 v_and_b32 v21, s34, v103
 v_pk_mul_f32 v[14:15], v[14:15], s[32:33] op_sel_hi:[1,0]
 v_pk_mul_f32 v[16:17], v[16:17], s[32:33] op_sel_hi:[1,0]
 v_pk_mul_f32 v[18:19], v[18:19], s[32:33] op_sel_hi:[1,0]
 v_pk_mul_f32 v[20:21], v[20:21], s[32:33] op_sel_hi:[1,0]
 v_cvt_pk_bf16_f32 v14, v14, v15
 v_cvt_pk_bf16_f32 v16, v16, v17
 v_cvt_pk_bf16_f32 v18, v18, v19
 v_cvt_pk_bf16_f32 v20, v20, v21
 v_accvgpr_write_b32 a20, v14
 v_accvgpr_write_b32 a21, v16
 v_accvgpr_write_b32 a22, v18
 v_accvgpr_write_b32 a23, v20
 v_lshlrev_b32 v14, 16, v104
 v_and_b32 v15, s34, v104
 v_lshlrev_b32 v16, 16, v105
 v_and_b32 v17, s34, v105
 v_lshlrev_b32 v18, 16, v106
 v_and_b32 v19, s34, v106
 v_lshlrev_b32 v20, 16, v107
 v_and_b32 v21, s34, v107
 v_pk_mul_f32 v[14:15], v[14:15], s[32:33] op_sel_hi:[1,0]
 v_pk_mul_f32 v[16:17], v[16:17], s[32:33] op_sel_hi:[1,0]
 v_pk_mul_f32 v[18:19], v[18:19], s[32:33] op_sel_hi:[1,0]
 v_pk_mul_f32 v[20:21], v[20:21], s[32:33] op_sel_hi:[1,0]
 v_cvt_pk_bf16_f32 v14, v14, v15
 v_cvt_pk_bf16_f32 v16, v16, v17
 v_cvt_pk_bf16_f32 v18, v18, v19
 v_cvt_pk_bf16_f32 v20, v20, v21
 v_accvgpr_write_b32 a24, v14
 v_accvgpr_write_b32 a25, v16
 v_accvgpr_write_b32 a26, v18
 v_accvgpr_write_b32 a27, v20
 v_mfma_f32_16x16x32_bf16 v[36:39], a[144:147], a[0:3], v[36:39]
 s_waitcnt lgkmcnt(0)
 v_lshlrev_b32 v14, 16, v108
 v_and_b32 v15, s34, v108
 v_lshlrev_b32 v16, 16, v109
 v_and_b32 v17, s34, v109
 v_lshlrev_b32 v18, 16, v110
 v_and_b32 v19, s34, v110
 v_lshlrev_b32 v20, 16, v111
 v_and_b32 v21, s34, v111
 v_pk_mul_f32 v[14:15], v[14:15], s[32:33] op_sel_hi:[1,0]
 v_pk_mul_f32 v[16:17], v[16:17], s[32:33] op_sel_hi:[1,0]
 v_pk_mul_f32 v[18:19], v[18:19], s[32:33] op_sel_hi:[1,0]
 v_pk_mul_f32 v[20:21], v[20:21], s[32:33] op_sel_hi:[1,0]
 v_cvt_pk_bf16_f32 v14, v14, v15
 v_cvt_pk_bf16_f32 v16, v16, v17
 v_cvt_pk_bf16_f32 v18, v18, v19
 v_cvt_pk_bf16_f32 v20, v20, v21
 v_accvgpr_write_b32 a28, v14
 v_accvgpr_write_b32 a29, v16
 v_accvgpr_write_b32 a30, v18
 v_accvgpr_write_b32 a31, v20
 v_mfma_f32_16x16x32_bf16 v[24:27], a[96:99], a[16:19], 0
 v_exp_f32 v32, v32
 v_mfma_f32_16x16x32_bf16 v[24:27], a[100:103], a[20:23], v[24:27]
 ds_read_b64_tr_b16 a[208:209], v8 offset:17024
 ds_read_b64_tr_b16 a[210:211], v8 offset:17536
 v_mfma_f32_16x16x32_bf16 v[24:27], a[104:107], a[24:27], v[24:27]
 v_exp_f32 v33, v33
 v_mfma_f32_16x16x32_bf16 v[24:27], a[108:111], a[28:31], v[24:27]
 ds_read_b64_tr_b16 a[212:213], v8 offset:17056
 ds_read_b64_tr_b16 a[214:215], v8 offset:17568
 v_exp_f32 v34, v34
 v_exp_f32 v35, v35
 v_exp_f32 v36, v36
 v_mfma_f32_16x16x32_bf16 v[28:31], a[124:127], a[28:31], 0
 ds_read_b64_tr_b16 a[216:217], v8 offset:17088
 ds_read_b64_tr_b16 a[218:219], v8 offset:17600
 v_mfma_f32_16x16x32_bf16 v[28:31], a[120:123], a[24:27], v[28:31]
 v_cvt_pk_bf16_f32 v44, v32, v33
 v_cvt_pk_bf16_f32 v45, v34, v35
 v_mfma_f32_16x16x32_bf16 v[28:31], a[116:119], a[20:23], v[28:31]
 ds_read_b64_tr_b16 a[220:221], v8 offset:17120
 ds_read_b64_tr_b16 a[222:223], v8 offset:17632
 v_mfma_f32_16x16x32_bf16 v[28:31], a[112:115], a[16:19], v[28:31]
 v_exp_f32 v37, v37
 v_exp_f32 v38, v38
 v_exp_f32 v39, v39
 v_cvt_pk_bf16_f32 v46, v36, v37
 v_cvt_pk_bf16_f32 v47, v38, v39
 v_mfma_f32_16x16x32_bf16 v[32:35], a[128:131], a[16:19], 0
 v_exp_f32 v24, v24
 v_mfma_f32_16x16x32_bf16 v[32:35], a[132:135], a[20:23], v[32:35]
 s_mov_b32 s59, 16384
 s_waitcnt vmcnt(4)
 v_exp_f32 v25, v25
 v_exp_f32 v26, v26
 v_mfma_f32_16x16x32_bf16 v[32:35], a[136:139], a[24:27], v[32:35]
 s_add_u32 m0, s45, 13056
 ds_read_b128 v[128:131], v4 offset:4352
 ds_read_b128 v[132:135], v4 offset:4416
 v_mfma_f32_16x16x32_bf16 v[32:35], a[140:143], a[28:31], v[32:35]
 buffer_load_dwordx4 v1, s[16:19], s59 offen nt lds
 v_mfma_f32_16x16x32_bf16 v[36:39], a[156:159], a[28:31], 0
 s_add_u32 m0, s45, 13120
 ds_read_b128 v[136:139], v4 offset:4480
 ds_read_b128 v[140:143], v4 offset:4544
 v_mfma_f32_16x16x32_bf16 v[36:39], a[152:155], a[24:27], v[36:39]
 buffer_load_dwordx4 v1, s[16:19], s59 offen offset:1024 nt lds
 v_mfma_f32_16x16x32_bf16 v[36:39], a[148:151], a[20:23], v[36:39]
 s_add_u32 m0, s45, 13184
 v_exp_f32 v27, v27
 v_mfma_f32_16x16x32_bf16 v[36:39], a[144:147], a[16:19], v[36:39]
 s_waitcnt lgkmcnt(15)
 buffer_load_dwordx4 v1, s[16:19], s59 offen offset:2048 nt lds
 v_exp_f32 v28, v28
 v_mfma_f32_16x16x32_bf16 v[64:67], a[160:163], v[40:43], 0
 s_add_u32 m0, s45, 13248
 v_cvt_pk_bf16_f32 v48, v24, v25
 v_cvt_pk_bf16_f32 v49, v26, v27
 v_mfma_f32_16x16x32_bf16 v[64:67], a[192:195], v[44:47], v[64:67]
 buffer_load_dwordx4 v1, s[16:19], s59 offen offset:3072 nt lds
 v_exp_f32 v29, v29
 v_mfma_f32_16x16x32_bf16 v[68:71], a[164:167], v[40:43], 0
 s_waitcnt lgkmcnt(3)
 v_lshlrev_b32 v14, 16, v128
 v_and_b32 v15, s34, v128
 v_lshlrev_b32 v16, 16, v129
 v_and_b32 v17, s34, v129
 v_lshlrev_b32 v18, 16, v130
 v_and_b32 v19, s34, v130
 v_lshlrev_b32 v20, 16, v131
 v_and_b32 v21, s34, v131
 v_pk_mul_f32 v[14:15], v[14:15], s[32:33] op_sel_hi:[1,0]
 v_pk_mul_f32 v[16:17], v[16:17], s[32:33] op_sel_hi:[1,0]
 v_pk_mul_f32 v[18:19], v[18:19], s[32:33] op_sel_hi:[1,0]
 v_pk_mul_f32 v[20:21], v[20:21], s[32:33] op_sel_hi:[1,0]
 v_cvt_pk_bf16_f32 v14, v14, v15
 v_cvt_pk_bf16_f32 v16, v16, v17
 v_cvt_pk_bf16_f32 v18, v18, v19
 v_cvt_pk_bf16_f32 v20, v20, v21
 v_accvgpr_write_b32 a32, v14
 v_accvgpr_write_b32 a33, v16
 v_accvgpr_write_b32 a34, v18
 v_accvgpr_write_b32 a35, v20
 v_mfma_f32_16x16x32_bf16 v[68:71], a[196:199], v[44:47], v[68:71]
 s_waitcnt lgkmcnt(2)
 v_lshlrev_b32 v14, 16, v132
 v_and_b32 v15, s34, v132
 v_lshlrev_b32 v16, 16, v133
 v_and_b32 v17, s34, v133
 v_lshlrev_b32 v18, 16, v134
 v_and_b32 v19, s34, v134
 v_lshlrev_b32 v20, 16, v135
 v_and_b32 v21, s34, v135
 v_pk_mul_f32 v[14:15], v[14:15], s[32:33] op_sel_hi:[1,0]
 v_pk_mul_f32 v[16:17], v[16:17], s[32:33] op_sel_hi:[1,0]
 v_pk_mul_f32 v[18:19], v[18:19], s[32:33] op_sel_hi:[1,0]
 v_pk_mul_f32 v[20:21], v[20:21], s[32:33] op_sel_hi:[1,0]
 v_cvt_pk_bf16_f32 v14, v14, v15
 v_cvt_pk_bf16_f32 v16, v16, v17
 v_cvt_pk_bf16_f32 v18, v18, v19
 v_cvt_pk_bf16_f32 v20, v20, v21
 v_accvgpr_write_b32 a36, v14
 v_accvgpr_write_b32 a37, v16
 v_accvgpr_write_b32 a38, v18
 v_accvgpr_write_b32 a39, v20
 v_mfma_f32_16x16x32_bf16 v[72:75], a[168:171], v[40:43], 0
 s_waitcnt lgkmcnt(1)
 v_lshlrev_b32 v14, 16, v136
 v_and_b32 v15, s34, v136
 v_lshlrev_b32 v16, 16, v137
 v_and_b32 v17, s34, v137
 v_lshlrev_b32 v18, 16, v138
 v_and_b32 v19, s34, v138
 v_lshlrev_b32 v20, 16, v139
 v_and_b32 v21, s34, v139
 v_pk_mul_f32 v[14:15], v[14:15], s[32:33] op_sel_hi:[1,0]
 v_pk_mul_f32 v[16:17], v[16:17], s[32:33] op_sel_hi:[1,0]
 v_pk_mul_f32 v[18:19], v[18:19], s[32:33] op_sel_hi:[1,0]
 v_pk_mul_f32 v[20:21], v[20:21], s[32:33] op_sel_hi:[1,0]
 v_cvt_pk_bf16_f32 v14, v14, v15
 v_cvt_pk_bf16_f32 v16, v16, v17
 v_cvt_pk_bf16_f32 v18, v18, v19
 v_cvt_pk_bf16_f32 v20, v20, v21
 v_accvgpr_write_b32 a40, v14
 v_accvgpr_write_b32 a41, v16
 v_accvgpr_write_b32 a42, v18
 v_accvgpr_write_b32 a43, v20
 v_mfma_f32_16x16x32_bf16 v[72:75], a[200:203], v[44:47], v[72:75]
 s_waitcnt lgkmcnt(0)
 v_lshlrev_b32 v14, 16, v140
 v_and_b32 v15, s34, v140
 v_lshlrev_b32 v16, 16, v141
 v_and_b32 v17, s34, v141
 v_lshlrev_b32 v18, 16, v142
 v_and_b32 v19, s34, v142
 v_lshlrev_b32 v20, 16, v143
 v_and_b32 v21, s34, v143
 v_pk_mul_f32 v[14:15], v[14:15], s[32:33] op_sel_hi:[1,0]
 v_pk_mul_f32 v[16:17], v[16:17], s[32:33] op_sel_hi:[1,0]
 v_pk_mul_f32 v[18:19], v[18:19], s[32:33] op_sel_hi:[1,0]
 v_pk_mul_f32 v[20:21], v[20:21], s[32:33] op_sel_hi:[1,0]
 v_cvt_pk_bf16_f32 v14, v14, v15
 v_cvt_pk_bf16_f32 v16, v16, v17
 v_cvt_pk_bf16_f32 v18, v18, v19
 v_cvt_pk_bf16_f32 v20, v20, v21
 v_accvgpr_write_b32 a44, v14
 v_accvgpr_write_b32 a45, v16
 v_accvgpr_write_b32 a46, v18
 v_accvgpr_write_b32 a47, v20
 v_mfma_f32_16x16x32_bf16 v[76:79], a[172:175], v[40:43], 0
 v_exp_f32 v30, v30
 v_mfma_f32_16x16x32_bf16 v[76:79], a[204:207], v[44:47], v[76:79]
 v_exp_f32 v31, v31
 v_cvt_pk_bf16_f32 v50, v28, v29
 v_cvt_pk_bf16_f32 v51, v30, v31
 v_mfma_f32_16x16x32_bf16 v[24:27], a[96:99], a[32:35], 0
 v_mfma_f32_16x16x32_bf16 v[24:27], a[100:103], a[36:39], v[24:27]
 v_mfma_f32_16x16x32_bf16 v[24:27], a[104:107], a[40:43], v[24:27]
 v_mfma_f32_16x16x32_bf16 v[24:27], a[108:111], a[44:47], v[24:27]
 v_smfmac_f32_16x16x64_bf16 a[224:227], a[236:239], v[40:47], v2
 v_mfma_f32_16x16x32_bf16 v[28:31], a[124:127], a[44:47], 0
 v_mfma_f32_16x16x32_bf16 v[28:31], a[120:123], a[40:43], v[28:31]
 v_mfma_f32_16x16x32_bf16 v[28:31], a[116:119], a[36:39], v[28:31]
 v_exp_f32 v32, v32
 v_mfma_f32_16x16x32_bf16 v[28:31], a[112:115], a[32:35], v[28:31]
 s_waitcnt lgkmcnt(4)
 v_exp_f32 v33, v33
 v_mfma_f32_16x16x32_bf16 v[80:83], a[176:179], v[40:43], 0
 v_exp_f32 v34, v34
 v_mfma_f32_16x16x32_bf16 v[80:83], a[208:211], v[44:47], v[80:83]
 v_exp_f32 v35, v35
 v_mfma_f32_16x16x32_bf16 v[84:87], a[180:183], v[40:43], 0
 v_exp_f32 v36, v36
 v_mfma_f32_16x16x32_bf16 v[84:87], a[212:215], v[44:47], v[84:87]
 v_cvt_pk_bf16_f32 v52, v32, v33
 v_cvt_pk_bf16_f32 v53, v34, v35
 v_mfma_f32_16x16x32_bf16 v[88:91], a[184:187], v[40:43], 0
 v_exp_f32 v37, v37
 v_mfma_f32_16x16x32_bf16 v[88:91], a[216:219], v[44:47], v[88:91]
 v_exp_f32 v38, v38
 v_mfma_f32_16x16x32_bf16 v[92:95], a[188:191], v[40:43], 0
 v_exp_f32 v39, v39
 v_mfma_f32_16x16x32_bf16 v[92:95], a[220:223], v[44:47], v[92:95]
 v_cvt_pk_bf16_f32 v54, v36, v37
 v_cvt_pk_bf16_f32 v55, v38, v39
 v_mfma_f32_16x16x32_bf16 v[32:35], a[128:131], a[32:35], 0
 v_exp_f32 v24, v24
 v_mfma_f32_16x16x32_bf16 v[32:35], a[132:135], a[36:39], v[32:35]
 s_waitcnt vmcnt(4)
 v_exp_f32 v25, v25
 v_mfma_f32_16x16x32_bf16 v[32:35], a[136:139], a[40:43], v[32:35]
 s_add_u32 m0, s39, 33792
 ds_read_b128 v[160:163], v4 offset:8704
 ds_read_b128 v[164:167], v4 offset:8768
 v_mfma_f32_16x16x32_bf16 v[32:35], a[140:143], a[44:47], v[32:35]
 buffer_load_dwordx4 v1, s[20:23], s33 offen nt lds
 v_mfma_f32_16x16x32_bf16 v[36:39], a[156:159], a[44:47], 0
 s_add_u32 m0, s39, 33824
 ds_read_b128 v[168:171], v4 offset:8832
 ds_read_b128 v[172:175], v4 offset:8896
 v_mfma_f32_16x16x32_bf16 v[36:39], a[152:155], a[40:43], v[36:39]
 buffer_load_dwordx4 v1, s[20:23], s33 offen offset:1024 nt lds
 v_exp_f32 v26, v26
 v_mfma_f32_16x16x32_bf16 v[36:39], a[148:151], a[36:39], v[36:39]
 s_add_u32 m0, s39, 33856
 v_exp_f32 v27, v27
 v_mfma_f32_16x16x32_bf16 v[36:39], a[144:147], a[32:35], v[36:39]
 buffer_load_dwordx4 v1, s[20:23], s33 offen offset:2048 nt lds
 v_exp_f32 v28, v28
 v_mfma_f32_16x16x32_bf16 v[96:99], a[160:163], v[48:51], 0
 s_add_u32 m0, s39, 33888
 v_cvt_pk_bf16_f32 v40, v24, v25
 v_cvt_pk_bf16_f32 v41, v26, v27
 v_mfma_f32_16x16x32_bf16 v[96:99], a[192:195], v[52:55], v[96:99]
 buffer_load_dwordx4 v1, s[20:23], s33 offen offset:3072 nt lds
 v_exp_f32 v29, v29
 v_mfma_f32_16x16x32_bf16 v[100:103], a[164:167], v[48:51], 0
 s_add_u32 s33, s33, 8192
 s_waitcnt lgkmcnt(3)
 v_lshlrev_b32 v14, 16, v160
 v_and_b32 v15, s34, v160
 v_lshlrev_b32 v16, 16, v161
 v_and_b32 v17, s34, v161
 v_lshlrev_b32 v18, 16, v162
 v_and_b32 v19, s34, v162
 v_lshlrev_b32 v20, 16, v163
 v_and_b32 v21, s34, v163
 v_pk_mul_f32 v[14:15], v[14:15], s[32:33] op_sel_hi:[1,0]
 v_pk_mul_f32 v[16:17], v[16:17], s[32:33] op_sel_hi:[1,0]
 v_pk_mul_f32 v[18:19], v[18:19], s[32:33] op_sel_hi:[1,0]
 v_pk_mul_f32 v[20:21], v[20:21], s[32:33] op_sel_hi:[1,0]
 v_cvt_pk_bf16_f32 v14, v14, v15
 v_cvt_pk_bf16_f32 v16, v16, v17
 v_cvt_pk_bf16_f32 v18, v18, v19
 v_cvt_pk_bf16_f32 v20, v20, v21
 v_accvgpr_write_b32 a48, v14
 v_accvgpr_write_b32 a49, v16
 v_accvgpr_write_b32 a50, v18
 v_accvgpr_write_b32 a51, v20
 v_mfma_f32_16x16x32_bf16 v[100:103], a[196:199], v[52:55], v[100:103]
 s_waitcnt lgkmcnt(2)
 v_lshlrev_b32 v14, 16, v164
 v_and_b32 v15, s34, v164
 v_lshlrev_b32 v16, 16, v165
 v_and_b32 v17, s34, v165
 v_lshlrev_b32 v18, 16, v166
 v_and_b32 v19, s34, v166
 v_lshlrev_b32 v20, 16, v167
 v_and_b32 v21, s34, v167
 v_pk_mul_f32 v[14:15], v[14:15], s[32:33] op_sel_hi:[1,0]
 v_pk_mul_f32 v[16:17], v[16:17], s[32:33] op_sel_hi:[1,0]
 v_pk_mul_f32 v[18:19], v[18:19], s[32:33] op_sel_hi:[1,0]
 v_pk_mul_f32 v[20:21], v[20:21], s[32:33] op_sel_hi:[1,0]
 v_cvt_pk_bf16_f32 v14, v14, v15
 v_cvt_pk_bf16_f32 v16, v16, v17
 v_cvt_pk_bf16_f32 v18, v18, v19
 v_cvt_pk_bf16_f32 v20, v20, v21
 v_accvgpr_write_b32 a52, v14
 v_accvgpr_write_b32 a53, v16
 v_accvgpr_write_b32 a54, v18
 v_accvgpr_write_b32 a55, v20
 v_mfma_f32_16x16x32_bf16 v[104:107], a[168:171], v[48:51], 0
 s_waitcnt lgkmcnt(1)
 v_lshlrev_b32 v14, 16, v168
 v_and_b32 v15, s34, v168
 v_lshlrev_b32 v16, 16, v169
 v_and_b32 v17, s34, v169
 v_lshlrev_b32 v18, 16, v170
 v_and_b32 v19, s34, v170
 v_lshlrev_b32 v20, 16, v171
 v_and_b32 v21, s34, v171
 v_pk_mul_f32 v[14:15], v[14:15], s[32:33] op_sel_hi:[1,0]
 v_pk_mul_f32 v[16:17], v[16:17], s[32:33] op_sel_hi:[1,0]
 v_pk_mul_f32 v[18:19], v[18:19], s[32:33] op_sel_hi:[1,0]
 v_pk_mul_f32 v[20:21], v[20:21], s[32:33] op_sel_hi:[1,0]
 v_cvt_pk_bf16_f32 v14, v14, v15
 v_cvt_pk_bf16_f32 v16, v16, v17
 v_cvt_pk_bf16_f32 v18, v18, v19
 v_cvt_pk_bf16_f32 v20, v20, v21
 v_accvgpr_write_b32 a56, v14
 v_accvgpr_write_b32 a57, v16
 v_accvgpr_write_b32 a58, v18
 v_accvgpr_write_b32 a59, v20
 v_mfma_f32_16x16x32_bf16 v[104:107], a[200:203], v[52:55], v[104:107]
 s_waitcnt lgkmcnt(0)
 v_lshlrev_b32 v14, 16, v172
 v_and_b32 v15, s34, v172
 v_lshlrev_b32 v16, 16, v173
 v_and_b32 v17, s34, v173
 v_lshlrev_b32 v18, 16, v174
 v_and_b32 v19, s34, v174
 v_lshlrev_b32 v20, 16, v175
 v_and_b32 v21, s34, v175
 v_pk_mul_f32 v[14:15], v[14:15], s[32:33] op_sel_hi:[1,0]
 v_pk_mul_f32 v[16:17], v[16:17], s[32:33] op_sel_hi:[1,0]
 v_pk_mul_f32 v[18:19], v[18:19], s[32:33] op_sel_hi:[1,0]
 v_pk_mul_f32 v[20:21], v[20:21], s[32:33] op_sel_hi:[1,0]
 v_cvt_pk_bf16_f32 v14, v14, v15
 v_cvt_pk_bf16_f32 v16, v16, v17
 v_cvt_pk_bf16_f32 v18, v18, v19
 v_cvt_pk_bf16_f32 v20, v20, v21
 v_accvgpr_write_b32 a60, v14
 v_accvgpr_write_b32 a61, v16
 v_accvgpr_write_b32 a62, v18
 v_accvgpr_write_b32 a63, v20
 v_mfma_f32_16x16x32_bf16 v[108:111], a[172:175], v[48:51], 0
 v_exp_f32 v30, v30
 v_mfma_f32_16x16x32_bf16 v[108:111], a[204:207], v[52:55], v[108:111]
 v_exp_f32 v31, v31
 v_cvt_pk_bf16_f32 v42, v28, v29
 v_cvt_pk_bf16_f32 v43, v30, v31
 v_mfma_f32_16x16x32_bf16 v[24:27], a[96:99], a[48:51], 0
 v_mfma_f32_16x16x32_bf16 v[24:27], a[100:103], a[52:55], v[24:27]
 v_exp_f32 v32, v32
 v_mfma_f32_16x16x32_bf16 v[24:27], a[104:107], a[56:59], v[24:27]
 v_exp_f32 v33, v33
 v_mfma_f32_16x16x32_bf16 v[24:27], a[108:111], a[60:63], v[24:27]
 v_exp_f32 v34, v34
 v_smfmac_f32_16x16x64_bf16 a[224:227], a[240:243], v[48:55], v2
 v_mfma_f32_16x16x32_bf16 v[28:31], a[124:127], a[60:63], 0
 v_exp_f32 v35, v35
 v_mfma_f32_16x16x32_bf16 v[28:31], a[120:123], a[56:59], v[28:31]
 v_exp_f32 v36, v36
 v_mfma_f32_16x16x32_bf16 v[28:31], a[116:119], a[52:55], v[28:31]
 v_mfma_f32_16x16x32_bf16 v[28:31], a[112:115], a[48:51], v[28:31]
 s_barrier
 v_mfma_f32_16x16x32_bf16 v[112:115], a[176:179], v[48:51], 0
 v_cvt_pk_bf16_f32 v44, v32, v33
 v_cvt_pk_bf16_f32 v45, v34, v35
 v_mfma_f32_16x16x32_bf16 v[112:115], a[208:211], v[52:55], v[112:115]
 v_exp_f32 v37, v37
 v_mfma_f32_16x16x32_bf16 v[116:119], a[180:183], v[48:51], 0
L_pg0_0:
 s_cbranch_execz L_pg0_4
 v_mfma_f32_16x16x32_bf16 v[116:119], a[212:215], v[52:55], v[116:119]
 v_exp_f32 v38, v38
 v_mfma_f32_16x16x32_bf16 v[120:123], a[184:187], v[48:51], 0
 v_exp_f32 v39, v39
 v_mfma_f32_16x16x32_bf16 v[120:123], a[216:219], v[52:55], v[120:123]
 v_mfma_f32_16x16x32_bf16 v[124:127], a[188:191], v[48:51], 0
 v_cvt_pk_bf16_f32 v46, v36, v37
 v_cvt_pk_bf16_f32 v47, v38, v39
 v_mfma_f32_16x16x32_bf16 v[124:127], a[220:223], v[52:55], v[124:127]
 v_mfma_f32_16x16x32_bf16 v[32:35], a[128:131], a[48:51], 0
 v_exp_f32 v24, v24
 v_mfma_f32_16x16x32_bf16 v[32:35], a[132:135], a[52:55], v[32:35]
 s_mov_b32 s59, 20480
 s_waitcnt vmcnt(4)
 v_exp_f32 v25, v25
 v_exp_f32 v26, v26
 v_mfma_f32_16x16x32_bf16 v[32:35], a[136:139], a[56:59], v[32:35]
 s_add_u32 m0, s45, 0
 ds_read_b128 v[192:195], v4 offset:13056
 ds_read_b128 v[196:199], v4 offset:13120
 v_mfma_f32_16x16x32_bf16 v[32:35], a[140:143], a[60:63], v[32:35]
 buffer_load_dwordx4 v1, s[16:19], s59 offen nt lds
 v_mfma_f32_16x16x32_bf16 v[36:39], a[156:159], a[60:63], 0
 s_add_u32 m0, s45, 64
 ds_read_b128 v[200:203], v4 offset:13184
 ds_read_b128 v[204:207], v4 offset:13248
 v_mfma_f32_16x16x32_bf16 v[36:39], a[152:155], a[56:59], v[36:39]
 buffer_load_dwordx4 v1, s[16:19], s59 offen offset:1024 nt lds
 v_exp_f32 v27, v27
 v_mfma_f32_16x16x32_bf16 v[36:39], a[148:151], a[52:55], v[36:39]
 s_add_u32 m0, s45, 128
 v_exp_f32 v28, v28
 v_mfma_f32_16x16x32_bf16 v[36:39], a[144:147], a[48:51], v[36:39]
 buffer_load_dwordx4 v1, s[16:19], s59 offen offset:2048 nt lds
 v_mfma_f32_16x16x32_bf16 v[128:131], a[160:163], v[40:43], 0
 s_add_u32 m0, s45, 192
 v_cvt_pk_bf16_f32 v48, v24, v25
 v_cvt_pk_bf16_f32 v49, v26, v27
 v_mfma_f32_16x16x32_bf16 v[128:131], a[192:195], v[44:47], v[128:131]
 buffer_load_dwordx4 v1, s[16:19], s59 offen offset:3072 nt lds
 v_exp_f32 v29, v29
 v_mfma_f32_16x16x32_bf16 v[132:135], a[164:167], v[40:43], 0
 s_waitcnt lgkmcnt(3)
 v_lshlrev_b32 v14, 16, v192
 v_and_b32 v15, s34, v192
 v_lshlrev_b32 v16, 16, v193
 v_and_b32 v17, s34, v193
 v_lshlrev_b32 v18, 16, v194
 v_and_b32 v19, s34, v194
 v_lshlrev_b32 v20, 16, v195
 v_and_b32 v21, s34, v195
 v_pk_mul_f32 v[14:15], v[14:15], s[32:33] op_sel_hi:[1,0]
 v_pk_mul_f32 v[16:17], v[16:17], s[32:33] op_sel_hi:[1,0]
 v_pk_mul_f32 v[18:19], v[18:19], s[32:33] op_sel_hi:[1,0]
 v_pk_mul_f32 v[20:21], v[20:21], s[32:33] op_sel_hi:[1,0]
 v_cvt_pk_bf16_f32 v14, v14, v15
 v_cvt_pk_bf16_f32 v16, v16, v17
 v_cvt_pk_bf16_f32 v18, v18, v19
 v_cvt_pk_bf16_f32 v20, v20, v21
 v_accvgpr_write_b32 a64, v14
 v_accvgpr_write_b32 a65, v16
 v_accvgpr_write_b32 a66, v18
 v_accvgpr_write_b32 a67, v20
 v_mfma_f32_16x16x32_bf16 v[132:135], a[196:199], v[44:47], v[132:135]
 s_waitcnt lgkmcnt(2)
 v_lshlrev_b32 v14, 16, v196
 v_and_b32 v15, s34, v196
 v_lshlrev_b32 v16, 16, v197
 v_and_b32 v17, s34, v197
 v_lshlrev_b32 v18, 16, v198
 v_and_b32 v19, s34, v198
 v_lshlrev_b32 v20, 16, v199
 v_and_b32 v21, s34, v199
 v_pk_mul_f32 v[14:15], v[14:15], s[32:33] op_sel_hi:[1,0]
 v_pk_mul_f32 v[16:17], v[16:17], s[32:33] op_sel_hi:[1,0]
 v_pk_mul_f32 v[18:19], v[18:19], s[32:33] op_sel_hi:[1,0]
 v_pk_mul_f32 v[20:21], v[20:21], s[32:33] op_sel_hi:[1,0]
 v_cvt_pk_bf16_f32 v14, v14, v15
 v_cvt_pk_bf16_f32 v16, v16, v17
 v_cvt_pk_bf16_f32 v18, v18, v19
 v_cvt_pk_bf16_f32 v20, v20, v21
 v_accvgpr_write_b32 a68, v14
 v_accvgpr_write_b32 a69, v16
 v_accvgpr_write_b32 a70, v18
 v_accvgpr_write_b32 a71, v20
 v_mfma_f32_16x16x32_bf16 v[136:139], a[168:171], v[40:43], 0
 s_waitcnt lgkmcnt(1)
 v_lshlrev_b32 v14, 16, v200
 v_and_b32 v15, s34, v200
 v_lshlrev_b32 v16, 16, v201
 v_and_b32 v17, s34, v201
 v_lshlrev_b32 v18, 16, v202
 v_and_b32 v19, s34, v202
 v_lshlrev_b32 v20, 16, v203
 v_and_b32 v21, s34, v203
 v_pk_mul_f32 v[14:15], v[14:15], s[32:33] op_sel_hi:[1,0]
 v_pk_mul_f32 v[16:17], v[16:17], s[32:33] op_sel_hi:[1,0]
 v_pk_mul_f32 v[18:19], v[18:19], s[32:33] op_sel_hi:[1,0]
 v_pk_mul_f32 v[20:21], v[20:21], s[32:33] op_sel_hi:[1,0]
 v_cvt_pk_bf16_f32 v14, v14, v15
 v_cvt_pk_bf16_f32 v16, v16, v17
 v_cvt_pk_bf16_f32 v18, v18, v19
 v_cvt_pk_bf16_f32 v20, v20, v21
 v_accvgpr_write_b32 a72, v14
 v_accvgpr_write_b32 a73, v16
 v_accvgpr_write_b32 a74, v18
 v_accvgpr_write_b32 a75, v20
 v_mfma_f32_16x16x32_bf16 v[136:139], a[200:203], v[44:47], v[136:139]
 s_waitcnt lgkmcnt(0)
 v_lshlrev_b32 v14, 16, v204
 v_and_b32 v15, s34, v204
 v_lshlrev_b32 v16, 16, v205
 v_and_b32 v17, s34, v205
 v_lshlrev_b32 v18, 16, v206
 v_and_b32 v19, s34, v206
 v_lshlrev_b32 v20, 16, v207
 v_and_b32 v21, s34, v207
 v_pk_mul_f32 v[14:15], v[14:15], s[32:33] op_sel_hi:[1,0]
 v_pk_mul_f32 v[16:17], v[16:17], s[32:33] op_sel_hi:[1,0]
 v_pk_mul_f32 v[18:19], v[18:19], s[32:33] op_sel_hi:[1,0]
 v_pk_mul_f32 v[20:21], v[20:21], s[32:33] op_sel_hi:[1,0]
 v_cvt_pk_bf16_f32 v14, v14, v15
 v_cvt_pk_bf16_f32 v16, v16, v17
 v_cvt_pk_bf16_f32 v18, v18, v19
 v_cvt_pk_bf16_f32 v20, v20, v21
 v_accvgpr_write_b32 a76, v14
 v_accvgpr_write_b32 a77, v16
 v_accvgpr_write_b32 a78, v18
 v_accvgpr_write_b32 a79, v20
 v_mfma_f32_16x16x32_bf16 v[140:143], a[172:175], v[40:43], 0
 v_exp_f32 v30, v30
 v_mfma_f32_16x16x32_bf16 v[140:143], a[204:207], v[44:47], v[140:143]
 v_exp_f32 v31, v31
 v_cvt_pk_bf16_f32 v50, v28, v29
 v_cvt_pk_bf16_f32 v51, v30, v31
 v_mfma_f32_16x16x32_bf16 v[24:27], a[96:99], a[64:67], 0
 v_exp_f32 v32, v32
 v_mfma_f32_16x16x32_bf16 v[24:27], a[100:103], a[68:71], v[24:27]
 v_mfma_f32_16x16x32_bf16 v[24:27], a[104:107], a[72:75], v[24:27]
 v_exp_f32 v33, v33
 v_mfma_f32_16x16x32_bf16 v[24:27], a[108:111], a[76:79], v[24:27]
 v_exp_f32 v34, v34
 v_smfmac_f32_16x16x64_bf16 a[228:231], a[236:239], v[40:47], v2
 v_mfma_f32_16x16x32_bf16 v[28:31], a[124:127], a[76:79], 0
 v_exp_f32 v35, v35
 v_mfma_f32_16x16x32_bf16 v[28:31], a[120:123], a[72:75], v[28:31]
 v_exp_f32 v36, v36
 v_mfma_f32_16x16x32_bf16 v[28:31], a[116:119], a[68:71], v[28:31]
 v_mfma_f32_16x16x32_bf16 v[28:31], a[112:115], a[64:67], v[28:31]
 v_cvt_pk_bf16_f32 v52, v32, v33
 v_cvt_pk_bf16_f32 v53, v34, v35
 v_mfma_f32_16x16x32_bf16 v[144:147], a[176:179], v[40:43], 0
 v_mfma_f32_16x16x32_bf16 v[144:147], a[208:211], v[44:47], v[144:147]
 v_exp_f32 v37, v37
 v_mfma_f32_16x16x32_bf16 v[148:151], a[180:183], v[40:43], 0
 v_exp_f32 v38, v38
 v_mfma_f32_16x16x32_bf16 v[148:151], a[212:215], v[44:47], v[148:151]
 v_mfma_f32_16x16x32_bf16 v[152:155], a[184:187], v[40:43], 0
 v_exp_f32 v39, v39
 v_mfma_f32_16x16x32_bf16 v[152:155], a[216:219], v[44:47], v[152:155]
 v_mfma_f32_16x16x32_bf16 v[156:159], a[188:191], v[40:43], 0
 v_cvt_pk_bf16_f32 v54, v36, v37
 v_cvt_pk_bf16_f32 v55, v38, v39
 v_mfma_f32_16x16x32_bf16 v[156:159], a[220:223], v[44:47], v[156:159]
 v_mfma_f32_16x16x32_bf16 v[32:35], a[128:131], a[64:67], 0
 v_exp_f32 v24, v24
 v_mfma_f32_16x16x32_bf16 v[32:35], a[132:135], a[68:71], v[32:35]
 s_waitcnt vmcnt(0)
 v_exp_f32 v25, v25
 v_mfma_f32_16x16x32_bf16 v[32:35], a[136:139], a[72:75], v[32:35]
 s_add_u32 m0, s39, 50688
 ds_read_b128 v[224:227], v4 offset:0
 ds_read_b128 v[228:231], v4 offset:64
 v_mfma_f32_16x16x32_bf16 v[32:35], a[140:143], a[76:79], v[32:35]
 buffer_load_dwordx4 v1, s[20:23], s33 offen nt lds
 v_exp_f32 v26, v26
 v_mfma_f32_16x16x32_bf16 v[36:39], a[156:159], a[76:79], 0
 s_add_u32 m0, s39, 50720
 ds_read_b128 v[232:235], v4 offset:128
 ds_read_b128 v[236:239], v4 offset:192
 v_mfma_f32_16x16x32_bf16 v[36:39], a[152:155], a[72:75], v[36:39]
 buffer_load_dwordx4 v1, s[20:23], s33 offen offset:1024 nt lds
 v_exp_f32 v27, v27
 v_mfma_f32_16x16x32_bf16 v[36:39], a[148:151], a[68:71], v[36:39]
 s_add_u32 m0, s39, 50752
 v_exp_f32 v28, v28
 v_mfma_f32_16x16x32_bf16 v[36:39], a[144:147], a[64:67], v[36:39]
 buffer_load_dwordx4 v1, s[20:23], s33 offen offset:2048 nt lds
 v_cvt_pk_bf16_f32 v40, v24, v25
 v_cvt_pk_bf16_f32 v41, v26, v27
 v_mfma_f32_16x16x32_bf16 v[160:163], a[160:163], v[48:51], 0
 s_add_u32 m0, s39, 50784
 v_exp_f32 v29, v29
 v_mfma_f32_16x16x32_bf16 v[160:163], a[192:195], v[52:55], v[160:163]
 buffer_load_dwordx4 v1, s[20:23], s33 offen offset:3072 nt lds
 v_mfma_f32_16x16x32_bf16 v[164:167], a[164:167], v[48:51], 0
 s_add_u32 s33, s33, 8192
 s_waitcnt lgkmcnt(3)
 v_lshlrev_b32 v14, 16, v224
 v_and_b32 v15, s34, v224
 v_lshlrev_b32 v16, 16, v225
 v_and_b32 v17, s34, v225
 v_lshlrev_b32 v18, 16, v226
 v_and_b32 v19, s34, v226
 v_lshlrev_b32 v20, 16, v227
 v_and_b32 v21, s34, v227
 v_pk_mul_f32 v[14:15], v[14:15], s[32:33] op_sel_hi:[1,0]
 v_pk_mul_f32 v[16:17], v[16:17], s[32:33] op_sel_hi:[1,0]
 v_pk_mul_f32 v[18:19], v[18:19], s[32:33] op_sel_hi:[1,0]
 v_pk_mul_f32 v[20:21], v[20:21], s[32:33] op_sel_hi:[1,0]
 v_cvt_pk_bf16_f32 v14, v14, v15
 v_cvt_pk_bf16_f32 v16, v16, v17
 v_cvt_pk_bf16_f32 v18, v18, v19
 v_cvt_pk_bf16_f32 v20, v20, v21
 v_accvgpr_write_b32 a80, v14
 v_accvgpr_write_b32 a81, v16
 v_accvgpr_write_b32 a82, v18
 v_accvgpr_write_b32 a83, v20
 v_mfma_f32_16x16x32_bf16 v[164:167], a[196:199], v[52:55], v[164:167]
 s_waitcnt lgkmcnt(2)
 v_lshlrev_b32 v14, 16, v228
 v_and_b32 v15, s34, v228
 v_lshlrev_b32 v16, 16, v229
 v_and_b32 v17, s34, v229
 v_lshlrev_b32 v18, 16, v230
 v_and_b32 v19, s34, v230
 v_lshlrev_b32 v20, 16, v231
 v_and_b32 v21, s34, v231
 v_pk_mul_f32 v[14:15], v[14:15], s[32:33] op_sel_hi:[1,0]
 v_pk_mul_f32 v[16:17], v[16:17], s[32:33] op_sel_hi:[1,0]
 v_pk_mul_f32 v[18:19], v[18:19], s[32:33] op_sel_hi:[1,0]
 v_pk_mul_f32 v[20:21], v[20:21], s[32:33] op_sel_hi:[1,0]
 v_cvt_pk_bf16_f32 v14, v14, v15
 v_cvt_pk_bf16_f32 v16, v16, v17
 v_cvt_pk_bf16_f32 v18, v18, v19
 v_cvt_pk_bf16_f32 v20, v20, v21
 v_accvgpr_write_b32 a84, v14
 v_accvgpr_write_b32 a85, v16
 v_accvgpr_write_b32 a86, v18
 v_accvgpr_write_b32 a87, v20
 v_mfma_f32_16x16x32_bf16 v[168:171], a[168:171], v[48:51], 0
 s_waitcnt lgkmcnt(1)
 v_lshlrev_b32 v14, 16, v232
 v_and_b32 v15, s34, v232
 v_lshlrev_b32 v16, 16, v233
 v_and_b32 v17, s34, v233
 v_lshlrev_b32 v18, 16, v234
 v_and_b32 v19, s34, v234
 v_lshlrev_b32 v20, 16, v235
 v_and_b32 v21, s34, v235
 v_pk_mul_f32 v[14:15], v[14:15], s[32:33] op_sel_hi:[1,0]
 v_pk_mul_f32 v[16:17], v[16:17], s[32:33] op_sel_hi:[1,0]
 v_pk_mul_f32 v[18:19], v[18:19], s[32:33] op_sel_hi:[1,0]
 v_pk_mul_f32 v[20:21], v[20:21], s[32:33] op_sel_hi:[1,0]
 v_cvt_pk_bf16_f32 v14, v14, v15
 v_cvt_pk_bf16_f32 v16, v16, v17
 v_cvt_pk_bf16_f32 v18, v18, v19
 v_cvt_pk_bf16_f32 v20, v20, v21
 v_accvgpr_write_b32 a88, v14
 v_accvgpr_write_b32 a89, v16
 v_accvgpr_write_b32 a90, v18
 v_accvgpr_write_b32 a91, v20
 v_mfma_f32_16x16x32_bf16 v[168:171], a[200:203], v[52:55], v[168:171]
 s_waitcnt lgkmcnt(0)
 v_lshlrev_b32 v14, 16, v236
 v_and_b32 v15, s34, v236
 v_lshlrev_b32 v16, 16, v237
 v_and_b32 v17, s34, v237
 v_lshlrev_b32 v18, 16, v238
 v_and_b32 v19, s34, v238
 v_lshlrev_b32 v20, 16, v239
 v_and_b32 v21, s34, v239
 v_pk_mul_f32 v[14:15], v[14:15], s[32:33] op_sel_hi:[1,0]
 v_pk_mul_f32 v[16:17], v[16:17], s[32:33] op_sel_hi:[1,0]
 v_pk_mul_f32 v[18:19], v[18:19], s[32:33] op_sel_hi:[1,0]
 v_pk_mul_f32 v[20:21], v[20:21], s[32:33] op_sel_hi:[1,0]
 v_cvt_pk_bf16_f32 v14, v14, v15
 v_cvt_pk_bf16_f32 v16, v16, v17
 v_cvt_pk_bf16_f32 v18, v18, v19
 v_cvt_pk_bf16_f32 v20, v20, v21
 v_accvgpr_write_b32 a92, v14
 v_accvgpr_write_b32 a93, v16
 v_accvgpr_write_b32 a94, v18
 v_accvgpr_write_b32 a95, v20
 v_mfma_f32_16x16x32_bf16 v[172:175], a[172:175], v[48:51], 0
 v_exp_f32 v30, v30
 v_mfma_f32_16x16x32_bf16 v[172:175], a[204:207], v[52:55], v[172:175]
 v_exp_f32 v31, v31
 v_cvt_pk_bf16_f32 v42, v28, v29
 v_cvt_pk_bf16_f32 v43, v30, v31
 v_mfma_f32_16x16x32_bf16 v[24:27], a[96:99], a[80:83], 0
 v_exp_f32 v32, v32
 v_mfma_f32_16x16x32_bf16 v[24:27], a[100:103], a[84:87], v[24:27]
 v_exp_f32 v33, v33
 v_mfma_f32_16x16x32_bf16 v[24:27], a[104:107], a[88:91], v[24:27]
 v_mfma_f32_16x16x32_bf16 v[24:27], a[108:111], a[92:95], v[24:27]
 v_exp_f32 v34, v34
 v_smfmac_f32_16x16x64_bf16 a[228:231], a[240:243], v[48:55], v2
 v_mfma_f32_16x16x32_bf16 v[28:31], a[124:127], a[92:95], 0
 v_exp_f32 v35, v35
 v_mfma_f32_16x16x32_bf16 v[28:31], a[120:123], a[88:91], v[28:31]
 v_exp_f32 v36, v36
 v_mfma_f32_16x16x32_bf16 v[28:31], a[116:119], a[84:87], v[28:31]
 v_mfma_f32_16x16x32_bf16 v[28:31], a[112:115], a[80:83], v[28:31]
 v_cvt_pk_bf16_f32 v44, v32, v33
 v_cvt_pk_bf16_f32 v45, v34, v35
 v_mfma_f32_16x16x32_bf16 v[176:179], a[176:179], v[48:51], 0
 v_mfma_f32_16x16x32_bf16 v[176:179], a[208:211], v[52:55], v[176:179]
 v_exp_f32 v37, v37
 v_mfma_f32_16x16x32_bf16 v[180:183], a[180:183], v[48:51], 0
 v_exp_f32 v38, v38
 v_mfma_f32_16x16x32_bf16 v[180:183], a[212:215], v[52:55], v[180:183]
 v_exp_f32 v39, v39
 v_mfma_f32_16x16x32_bf16 v[184:187], a[184:187], v[48:51], 0
 v_mfma_f32_16x16x32_bf16 v[184:187], a[216:219], v[52:55], v[184:187]
 v_cvt_pk_bf16_f32 v46, v36, v37
 v_cvt_pk_bf16_f32 v47, v38, v39
 v_mfma_f32_16x16x32_bf16 v[188:191], a[188:191], v[48:51], 0
 v_mfma_f32_16x16x32_bf16 v[188:191], a[220:223], v[52:55], v[188:191]
 s_waitcnt vmcnt(8)
 s_barrier
 v_mfma_f32_16x16x32_bf16 v[32:35], a[128:131], a[80:83], 0
 v_exp_f32 v24, v24
 v_mfma_f32_16x16x32_bf16 v[32:35], a[132:135], a[84:87], v[32:35]
 ds_read_b128 a[96:99], v7 offset:33792
 ds_read_b128 a[100:103], v7 offset:33856
 v_mfma_f32_16x16x32_bf16 v[32:35], a[136:139], a[88:91], v[32:35]
 v_exp_f32 v25, v25
 v_mfma_f32_16x16x32_bf16 v[32:35], a[140:143], a[92:95], v[32:35]
 ds_read_b128 a[104:107], v7 offset:33920
 ds_read_b128 a[108:111], v7 offset:33984
 v_mfma_f32_16x16x32_bf16 v[36:39], a[156:159], a[92:95], 0
 v_exp_f32 v26, v26
 v_mfma_f32_16x16x32_bf16 v[36:39], a[152:155], a[88:91], v[36:39]
 v_exp_f32 v27, v27
 v_mfma_f32_16x16x32_bf16 v[36:39], a[148:151], a[84:87], v[36:39]
 ds_read_b128 a[124:127], v7 offset:34496
 ds_read_b128 a[120:123], v7 offset:34432
 v_mfma_f32_16x16x32_bf16 v[36:39], a[144:147], a[80:83], v[36:39]
 v_exp_f32 v28, v28
 v_mfma_f32_16x16x32_bf16 v[192:195], a[160:163], v[40:43], 0
 ds_read_b128 a[116:119], v7 offset:34368
 ds_read_b128 a[112:115], v7 offset:34304
 v_mfma_f32_16x16x32_bf16 v[192:195], a[192:195], v[44:47], v[192:195]
 v_cvt_pk_bf16_f32 v48, v24, v25
 v_cvt_pk_bf16_f32 v49, v26, v27
 v_mfma_f32_16x16x32_bf16 v[196:199], a[164:167], v[40:43], 0
 v_exp_f32 v29, v29
 v_mfma_f32_16x16x32_bf16 v[196:199], a[196:199], v[44:47], v[196:199]
 v_exp_f32 v30, v30
 v_mfma_f32_16x16x32_bf16 v[200:203], a[168:171], v[40:43], 0
 v_exp_f32 v31, v31
 v_mfma_f32_16x16x32_bf16 v[200:203], a[200:203], v[44:47], v[200:203]
 v_mfma_f32_16x16x32_bf16 v[204:207], a[172:175], v[40:43], 0
 v_cvt_pk_bf16_f32 v50, v28, v29
 v_cvt_pk_bf16_f32 v51, v30, v31
 v_mfma_f32_16x16x32_bf16 v[204:207], a[204:207], v[44:47], v[204:207]
 s_waitcnt lgkmcnt(4)
 s_waitcnt vmcnt(0)
 s_barrier
 v_mfma_f32_16x16x32_bf16 v[24:27], a[96:99], a[0:3], 0
 v_mfma_f32_16x16x32_bf16 v[24:27], a[100:103], a[4:7], v[24:27]
 ds_read_b128 a[128:131], v7 offset:50688
 ds_read_b128 a[132:135], v7 offset:50752
 v_mfma_f32_16x16x32_bf16 v[24:27], a[104:107], a[8:11], v[24:27]
 v_mfma_f32_16x16x32_bf16 v[24:27], a[108:111], a[12:15], v[24:27]
 s_waitcnt lgkmcnt(2)
 v_exp_f32 v32, v32
 v_exp_f32 v33, v33
 v_exp_f32 v34, v34
 v_smfmac_f32_16x16x64_bf16 a[232:235], a[236:239], v[40:47], v2
 ds_read_b128 a[136:139], v7 offset:50816
 ds_read_b128 a[140:143], v7 offset:50880
 v_exp_f32 v35, v35
 v_exp_f32 v36, v36
 v_mfma_f32_16x16x32_bf16 v[28:31], a[124:127], a[12:15], 0
 v_mfma_f32_16x16x32_bf16 v[28:31], a[120:123], a[8:11], v[28:31]
 ds_read_b128 a[156:159], v7 offset:51392
 ds_read_b128 a[152:155], v7 offset:51328
 v_mfma_f32_16x16x32_bf16 v[28:31], a[116:119], a[4:7], v[28:31]
 s_add_u32 m0, s39, 0
 v_mfma_f32_16x16x32_bf16 v[28:31], a[112:115], a[0:3], v[28:31]
 buffer_load_dwordx4 v1, s[20:23], s33 offen nt lds
 v_cvt_pk_bf16_f32 v52, v32, v33
 v_cvt_pk_bf16_f32 v53, v34, v35
 v_mfma_f32_16x16x32_bf16 v[208:211], a[176:179], v[40:43], 0
 ds_read_b128 a[148:151], v7 offset:51264
 ds_read_b128 a[144:147], v7 offset:51200
 v_mfma_f32_16x16x32_bf16 v[208:211], a[208:211], v[44:47], v[208:211]
 v_mfma_f32_16x16x32_bf16 v[212:215], a[180:183], v[40:43], 0
 v_mfma_f32_16x16x32_bf16 v[212:215], a[212:215], v[44:47], v[212:215]
 v_exp_f32 v37, v37
 v_exp_f32 v38, v38
 v_exp_f32 v39, v39
 v_mfma_f32_16x16x32_bf16 v[216:219], a[184:187], v[40:43], 0
 v_mfma_f32_16x16x32_bf16 v[216:219], a[216:219], v[44:47], v[216:219]
 v_mfma_f32_16x16x32_bf16 v[220:223], a[188:191], v[40:43], 0
 s_add_u32 m0, s39, 32
 v_mfma_f32_16x16x32_bf16 v[220:223], a[220:223], v[44:47], v[220:223]
 s_waitcnt lgkmcnt(4)
 buffer_load_dwordx4 v1, s[20:23], s33 offen offset:1024 nt lds
 v_cvt_pk_bf16_f32 v54, v36, v37
 v_cvt_pk_bf16_f32 v55, v38, v39
 v_mfma_f32_16x16x32_bf16 v[32:35], a[128:131], a[0:3], 0
 v_mfma_f32_16x16x32_bf16 v[32:35], a[132:135], a[4:7], v[32:35]
 v_exp_f32 v24, v24
 v_mfma_f32_16x16x32_bf16 v[32:35], a[136:139], a[8:11], v[32:35]
 v_mfma_f32_16x16x32_bf16 v[32:35], a[140:143], a[12:15], v[32:35]
 s_waitcnt lgkmcnt(0)
 v_mfma_f32_16x16x32_bf16 v[36:39], a[156:159], a[12:15], 0
 v_mfma_f32_16x16x32_bf16 v[36:39], a[152:155], a[8:11], v[36:39]
 v_mfma_f32_16x16x32_bf16 v[36:39], a[148:151], a[4:7], v[36:39]
 s_add_u32 m0, s39, 64
 v_exp_f32 v25, v25
 v_mfma_f32_16x16x32_bf16 v[36:39], a[144:147], a[0:3], v[36:39]
 buffer_load_dwordx4 v1, s[20:23], s33 offen offset:2048 nt lds
 v_exp_f32 v26, v26
 v_exp_f32 v27, v27
 v_mfma_f32_16x16x32_bf16 v[224:227], a[160:163], v[48:51], 0
 v_mfma_f32_16x16x32_bf16 v[224:227], a[192:195], v[52:55], v[224:227]
 v_mfma_f32_16x16x32_bf16 v[228:231], a[164:167], v[48:51], 0
 ds_read_b64_tr_b16 a[160:161], v8 offset:33792
 ds_read_b64_tr_b16 a[162:163], v8 offset:34304
 v_mfma_f32_16x16x32_bf16 v[228:231], a[196:199], v[52:55], v[228:231]
 v_mfma_f32_16x16x32_bf16 v[232:235], a[168:171], v[48:51], 0
 s_add_u32 m0, s39, 96
 ds_read_b64_tr_b16 a[192:193], v8 offset:50688
 ds_read_b64_tr_b16 a[194:195], v8 offset:51200
 v_mfma_f32_16x16x32_bf16 v[232:235], a[200:203], v[52:55], v[232:235]
 buffer_load_dwordx4 v1, s[20:23], s33 offen offset:3072 nt lds
 v_exp_f32 v28, v28
 v_cvt_pk_bf16_f32 v40, v24, v25
 v_cvt_pk_bf16_f32 v41, v26, v27
 v_mfma_f32_16x16x32_bf16 v[236:239], a[172:175], v[48:51], 0
 s_add_u32 s33, s33, 8192
 v_mfma_f32_16x16x32_bf16 v[236:239], a[204:207], v[52:55], v[236:239]
 ds_read_b64_tr_b16 a[164:165], v8 offset:33824
 ds_read_b64_tr_b16 a[166:167], v8 offset:34336
 v_exp_f32 v29, v29
 v_exp_f32 v30, v30
 v_exp_f32 v31, v31
 v_mfma_f32_16x16x32_bf16 v[24:27], a[96:99], a[16:19], 0
 v_cvt_pk_bf16_f32 v42, v28, v29
 v_cvt_pk_bf16_f32 v43, v30, v31
 v_mfma_f32_16x16x32_bf16 v[24:27], a[100:103], a[20:23], v[24:27]
 ds_read_b64_tr_b16 a[196:197], v8 offset:50720
 ds_read_b64_tr_b16 a[198:199], v8 offset:51232
 v_mfma_f32_16x16x32_bf16 v[24:27], a[104:107], a[24:27], v[24:27]
 v_mfma_f32_16x16x32_bf16 v[24:27], a[108:111], a[28:31], v[24:27]
 ds_read_b64_tr_b16 a[168:169], v8 offset:33856
 ds_read_b64_tr_b16 a[170:171], v8 offset:34368
 v_exp_f32 v32, v32
 v_exp_f32 v33, v33
 v_smfmac_f32_16x16x64_bf16 a[232:235], a[240:243], v[48:55], v2
 v_mfma_f32_16x16x32_bf16 v[28:31], a[124:127], a[28:31], 0
 ds_read_b64_tr_b16 a[200:201], v8 offset:50752
 ds_read_b64_tr_b16 a[202:203], v8 offset:51264
 v_mfma_f32_16x16x32_bf16 v[28:31], a[120:123], a[24:27], v[28:31]
 s_add_u32 m0, s39, 16896
 v_mfma_f32_16x16x32_bf16 v[28:31], a[116:119], a[20:23], v[28:31]
 buffer_load_dwordx4 v1, s[20:23], s33 offen nt lds
 v_exp_f32 v34, v34
 v_mfma_f32_16x16x32_bf16 v[28:31], a[112:115], a[16:19], v[28:31]
 ds_read_b64_tr_b16 a[172:173], v8 offset:33888
 ds_read_b64_tr_b16 a[174:175], v8 offset:34400
 v_exp_f32 v35, v35
 v_exp_f32 v36, v36
 v_mfma_f32_16x16x32_bf16 v[240:243], a[176:179], v[48:51], 0
 v_mfma_f32_16x16x32_bf16 v[240:243], a[208:211], v[52:55], v[240:243]
 ds_read_b64_tr_b16 a[204:205], v8 offset:50784
 ds_read_b64_tr_b16 a[206:207], v8 offset:51296
 v_cvt_pk_bf16_f32 v44, v32, v33
 v_cvt_pk_bf16_f32 v45, v34, v35
 v_exp_f32 v37, v37
 v_mfma_f32_16x16x32_bf16 v[244:247], a[180:183], v[48:51], 0
 v_exp_f32 v38, v38
 v_mfma_f32_16x16x32_bf16 v[244:247], a[212:215], v[52:55], v[244:247]
 v_mfma_f32_16x16x32_bf16 v[248:251], a[184:187], v[48:51], 0
 v_mfma_f32_16x16x32_bf16 v[248:251], a[216:219], v[52:55], v[248:251]
 ds_read_b64_tr_b16 a[176:177], v8 offset:33920
 ds_read_b64_tr_b16 a[178:179], v8 offset:34432
 v_exp_f32 v39, v39
 v_cvt_pk_bf16_f32 v46, v36, v37
 v_mfma_f32_16x16x32_bf16 v[252:255], a[188:191], v[48:51], 0
 s_add_u32 m0, s39, 16928
 v_mfma_f32_16x16x32_bf16 v[252:255], a[220:223], v[52:55], v[252:255]
 buffer_load_dwordx4 v1, s[20:23], s33 offen offset:1024 nt lds
 v_cvt_pk_bf16_f32 v47, v38, v39
 v_exp_f32 v24, v24
 v_mfma_f32_16x16x32_bf16 v[32:35], a[128:131], a[16:19], 0
 ds_read_b64_tr_b16 a[208:209], v8 offset:50816
 ds_read_b64_tr_b16 a[210:211], v8 offset:51328
 v_mfma_f32_16x16x32_bf16 v[32:35], a[132:135], a[20:23], v[32:35]
 v_mfma_f32_16x16x32_bf16 v[32:35], a[136:139], a[24:27], v[32:35]
 v_exp_f32 v25, v25
 v_mfma_f32_16x16x32_bf16 v[32:35], a[140:143], a[28:31], v[32:35]
 ds_read_b64_tr_b16 a[180:181], v8 offset:33952
 ds_read_b64_tr_b16 a[182:183], v8 offset:34464
 v_exp_f32 v26, v26
 v_exp_f32 v27, v27
 v_mfma_f32_16x16x32_bf16 v[36:39], a[156:159], a[28:31], 0
 v_mfma_f32_16x16x32_bf16 v[36:39], a[152:155], a[24:27], v[36:39]
 v_mfma_f32_16x16x32_bf16 v[36:39], a[148:151], a[20:23], v[36:39]
 s_add_u32 m0, s39, 16960
 ds_read_b64_tr_b16 a[212:213], v8 offset:50848
 ds_read_b64_tr_b16 a[214:215], v8 offset:51360
 v_mfma_f32_16x16x32_bf16 v[36:39], a[144:147], a[16:19], v[36:39]
 s_waitcnt lgkmcnt(15)
 buffer_load_dwordx4 v1, s[20:23], s33 offen offset:2048 nt lds
 v_exp_f32 v28, v28
 v_mfma_f32_16x16x32_bf16 v[64:67], a[160:163], v[40:43], v[64:67]
 v_mfma_f32_16x16x32_bf16 v[64:67], a[192:195], v[44:47], v[64:67]
 ds_read_b64_tr_b16 a[184:185], v8 offset:33984
 ds_read_b64_tr_b16 a[186:187], v8 offset:34496
 v_cvt_pk_bf16_f32 v48, v24, v25
 v_cvt_pk_bf16_f32 v49, v26, v27
 v_exp_f32 v29, v29
 v_mfma_f32_16x16x32_bf16 v[68:71], a[164:167], v[40:43], v[68:71]
 v_mfma_f32_16x16x32_bf16 v[68:71], a[196:199], v[44:47], v[68:71]
 s_waitcnt lgkmcnt(10)
 v_exp_f32 v30, v30
 v_exp_f32 v31, v31
 v_cvt_pk_bf16_f32 v50, v28, v29
 v_cvt_pk_bf16_f32 v51, v30, v31
 v_mfma_f32_16x16x32_bf16 v[72:75], a[168:171], v[40:43], v[72:75]
 s_add_u32 m0, s39, 16992
 ds_read_b64_tr_b16 a[216:217], v8 offset:50880
 ds_read_b64_tr_b16 a[218:219], v8 offset:51392
 v_mfma_f32_16x16x32_bf16 v[72:75], a[200:203], v[44:47], v[72:75]
 buffer_load_dwordx4 v1, s[20:23], s33 offen offset:3072 nt lds
 v_exp_f32 v32, v32
 v_exp_f32 v33, v33
 v_mfma_f32_16x16x32_bf16 v[76:79], a[172:175], v[40:43], v[76:79]
 s_add_u32 s33, s33, 8192
 v_mfma_f32_16x16x32_bf16 v[76:79], a[204:207], v[44:47], v[76:79]
 ds_read_b64_tr_b16 a[188:189], v8 offset:34016
 ds_read_b64_tr_b16 a[190:191], v8 offset:34528
 v_exp_f32 v34, v34
 v_exp_f32 v35, v35
 v_mfma_f32_16x16x32_bf16 v[24:27], a[96:99], a[32:35], 0
 v_mfma_f32_16x16x32_bf16 v[24:27], a[100:103], a[36:39], v[24:27]
 v_mfma_f32_16x16x32_bf16 v[24:27], a[104:107], a[40:43], v[24:27]
 ds_read_b64_tr_b16 a[220:221], v8 offset:50912
 ds_read_b64_tr_b16 a[222:223], v8 offset:51424
 v_mfma_f32_16x16x32_bf16 v[24:27], a[108:111], a[44:47], v[24:27]
 v_smfmac_f32_16x16x64_bf16 a[224:227], a[236:239], v[40:47], v2
 v_exp_f32 v36, v36
 v_cvt_pk_bf16_f32 v52, v32, v33
 v_cvt_pk_bf16_f32 v53, v34, v35
 v_exp_f32 v37, v37
 v_exp_f32 v38, v38
 v_mfma_f32_16x16x32_bf16 v[28:31], a[124:127], a[44:47], 0
 v_mfma_f32_16x16x32_bf16 v[28:31], a[120:123], a[40:43], v[28:31]
 v_mfma_f32_16x16x32_bf16 v[28:31], a[116:119], a[36:39], v[28:31]
 v_mfma_f32_16x16x32_bf16 v[28:31], a[112:115], a[32:35], v[28:31]
 s_waitcnt lgkmcnt(8)
 v_mfma_f32_16x16x32_bf16 v[80:83], a[176:179], v[40:43], v[80:83]
 v_exp_f32 v39, v39
 v_mfma_f32_16x16x32_bf16 v[80:83], a[208:211], v[44:47], v[80:83]
 v_mfma_f32_16x16x32_bf16 v[84:87], a[180:183], v[40:43], v[84:87]
 v_mfma_f32_16x16x32_bf16 v[84:87], a[212:215], v[44:47], v[84:87]
 s_waitcnt lgkmcnt(0)
 s_barrier
 v_mfma_f32_16x16x32_bf16 v[88:91], a[184:187], v[40:43], v[88:91]
 v_mfma_f32_16x16x32_bf16 v[88:91], a[216:219], v[44:47], v[88:91]
 v_mfma_f32_16x16x32_bf16 v[92:95], a[188:191], v[40:43], v[92:95]
 v_cvt_pk_bf16_f32 v54, v36, v37
 v_cvt_pk_bf16_f32 v55, v38, v39
 v_mfma_f32_16x16x32_bf16 v[92:95], a[220:223], v[44:47], v[92:95]
 v_mfma_f32_16x16x32_bf16 v[32:35], a[128:131], a[32:35], 0
 v_mfma_f32_16x16x32_bf16 v[32:35], a[132:135], a[36:39], v[32:35]
 v_mfma_f32_16x16x32_bf16 v[32:35], a[136:139], a[40:43], v[32:35]
 v_mfma_f32_16x16x32_bf16 v[32:35], a[140:143], a[44:47], v[32:35]
 v_exp_f32 v24, v24
 v_exp_f32 v25, v25
 v_exp_f32 v26, v26
 v_exp_f32 v27, v27
 v_mfma_f32_16x16x32_bf16 v[36:39], a[156:159], a[44:47], 0
 v_mfma_f32_16x16x32_bf16 v[36:39], a[152:155], a[40:43], v[36:39]
 v_mfma_f32_16x16x32_bf16 v[36:39], a[148:151], a[36:39], v[36:39]
 v_mfma_f32_16x16x32_bf16 v[36:39], a[144:147], a[32:35], v[36:39]
 v_mfma_f32_16x16x32_bf16 v[96:99], a[160:163], v[48:51], v[96:99]
 v_exp_f32 v28, v28
 v_mfma_f32_16x16x32_bf16 v[96:99], a[192:195], v[52:55], v[96:99]
 v_mfma_f32_16x16x32_bf16 v[100:103], a[164:167], v[48:51], v[100:103]
 v_mfma_f32_16x16x32_bf16 v[100:103], a[196:199], v[52:55], v[100:103]
 v_mfma_f32_16x16x32_bf16 v[104:107], a[168:171], v[48:51], v[104:107]
 v_mfma_f32_16x16x32_bf16 v[104:107], a[200:203], v[52:55], v[104:107]
 v_cvt_pk_bf16_f32 v40, v24, v25
 v_cvt_pk_bf16_f32 v41, v26, v27
 v_exp_f32 v29, v29
 v_exp_f32 v30, v30
 v_mfma_f32_16x16x32_bf16 v[108:111], a[172:175], v[48:51], v[108:111]
 v_mfma_f32_16x16x32_bf16 v[108:111], a[204:207], v[52:55], v[108:111]
 v_mfma_f32_16x16x32_bf16 v[24:27], a[96:99], a[48:51], 0
 v_exp_f32 v31, v31
 v_mfma_f32_16x16x32_bf16 v[24:27], a[100:103], a[52:55], v[24:27]
 v_cvt_pk_bf16_f32 v42, v28, v29
 v_cvt_pk_bf16_f32 v43, v30, v31
 v_mfma_f32_16x16x32_bf16 v[24:27], a[104:107], a[56:59], v[24:27]
 v_mfma_f32_16x16x32_bf16 v[24:27], a[108:111], a[60:63], v[24:27]
 v_exp_f32 v32, v32
 v_exp_f32 v33, v33
 v_exp_f32 v34, v34
 v_exp_f32 v35, v35
 v_smfmac_f32_16x16x64_bf16 a[224:227], a[240:243], v[48:55], v2
L_pg0_1:
 s_cbranch_execz L_pg0_5
 v_mfma_f32_16x16x32_bf16 v[28:31], a[124:127], a[60:63], 0
 v_mfma_f32_16x16x32_bf16 v[28:31], a[120:123], a[56:59], v[28:31]
 v_mfma_f32_16x16x32_bf16 v[28:31], a[116:119], a[52:55], v[28:31]
 v_exp_f32 v36, v36
 v_mfma_f32_16x16x32_bf16 v[28:31], a[112:115], a[48:51], v[28:31]
 v_mfma_f32_16x16x32_bf16 v[112:115], a[176:179], v[48:51], v[112:115]
 v_mfma_f32_16x16x32_bf16 v[112:115], a[208:211], v[52:55], v[112:115]
 v_mfma_f32_16x16x32_bf16 v[116:119], a[180:183], v[48:51], v[116:119]
 v_cvt_pk_bf16_f32 v44, v32, v33
 v_cvt_pk_bf16_f32 v45, v34, v35
 v_mfma_f32_16x16x32_bf16 v[116:119], a[212:215], v[52:55], v[116:119]
 v_mfma_f32_16x16x32_bf16 v[120:123], a[184:187], v[48:51], v[120:123]
 v_mfma_f32_16x16x32_bf16 v[120:123], a[216:219], v[52:55], v[120:123]
 v_exp_f32 v37, v37
 v_exp_f32 v38, v38
 v_exp_f32 v39, v39
 v_cvt_pk_bf16_f32 v46, v36, v37
 v_cvt_pk_bf16_f32 v47, v38, v39
 v_mfma_f32_16x16x32_bf16 v[124:127], a[188:191], v[48:51], v[124:127]
 v_mfma_f32_16x16x32_bf16 v[124:127], a[220:223], v[52:55], v[124:127]
 v_mfma_f32_16x16x32_bf16 v[32:35], a[128:131], a[48:51], 0
 v_mfma_f32_16x16x32_bf16 v[32:35], a[132:135], a[52:55], v[32:35]
 v_exp_f32 v24, v24
 v_mfma_f32_16x16x32_bf16 v[32:35], a[136:139], a[56:59], v[32:35]
 v_mfma_f32_16x16x32_bf16 v[32:35], a[140:143], a[60:63], v[32:35]
 v_mfma_f32_16x16x32_bf16 v[36:39], a[156:159], a[60:63], 0
 v_mfma_f32_16x16x32_bf16 v[36:39], a[152:155], a[56:59], v[36:39]
 v_exp_f32 v25, v25
 v_mfma_f32_16x16x32_bf16 v[36:39], a[148:151], a[52:55], v[36:39]
 s_add_u32 m0, s39, 33792
 v_mfma_f32_16x16x32_bf16 v[36:39], a[144:147], a[48:51], v[36:39]
 buffer_load_dwordx4 v1, s[20:23], s33 offen nt lds
 v_exp_f32 v26, v26
 v_exp_f32 v27, v27
 v_exp_f32 v28, v28
 v_mfma_f32_16x16x32_bf16 v[128:131], a[160:163], v[40:43], v[128:131]
 v_mfma_f32_16x16x32_bf16 v[128:131], a[192:195], v[44:47], v[128:131]
 v_mfma_f32_16x16x32_bf16 v[132:135], a[164:167], v[40:43], v[132:135]
 v_cvt_pk_bf16_f32 v48, v24, v25
 v_cvt_pk_bf16_f32 v49, v26, v27
 v_mfma_f32_16x16x32_bf16 v[132:135], a[196:199], v[44:47], v[132:135]
 v_mfma_f32_16x16x32_bf16 v[136:139], a[168:171], v[40:43], v[136:139]
 v_mfma_f32_16x16x32_bf16 v[136:139], a[200:203], v[44:47], v[136:139]
 v_exp_f32 v29, v29
 v_exp_f32 v30, v30
 v_exp_f32 v31, v31
 v_cvt_pk_bf16_f32 v50, v28, v29
 v_cvt_pk_bf16_f32 v51, v30, v31
 v_mfma_f32_16x16x32_bf16 v[140:143], a[172:175], v[40:43], v[140:143]
 v_mfma_f32_16x16x32_bf16 v[140:143], a[204:207], v[44:47], v[140:143]
 v_mfma_f32_16x16x32_bf16 v[24:27], a[96:99], a[64:67], 0
 v_mfma_f32_16x16x32_bf16 v[24:27], a[100:103], a[68:71], v[24:27]
 v_exp_f32 v32, v32
 v_mfma_f32_16x16x32_bf16 v[24:27], a[104:107], a[72:75], v[24:27]
 s_add_u32 m0, s39, 33824
 v_mfma_f32_16x16x32_bf16 v[24:27], a[108:111], a[76:79], v[24:27]
 buffer_load_dwordx4 v1, s[20:23], s33 offen offset:1024 nt lds
 v_exp_f32 v33, v33
 v_exp_f32 v34, v34
 v_exp_f32 v35, v35
 v_smfmac_f32_16x16x64_bf16 a[228:231], a[236:239], v[40:47], v2
 v_mfma_f32_16x16x32_bf16 v[28:31], a[124:127], a[76:79], 0
 v_mfma_f32_16x16x32_bf16 v[28:31], a[120:123], a[72:75], v[28:31]
 v_exp_f32 v36, v36
 v_mfma_f32_16x16x32_bf16 v[28:31], a[116:119], a[68:71], v[28:31]
 v_mfma_f32_16x16x32_bf16 v[28:31], a[112:115], a[64:67], v[28:31]
 v_mfma_f32_16x16x32_bf16 v[144:147], a[176:179], v[40:43], v[144:147]
 v_cvt_pk_bf16_f32 v52, v32, v33
 v_cvt_pk_bf16_f32 v53, v34, v35
 v_mfma_f32_16x16x32_bf16 v[144:147], a[208:211], v[44:47], v[144:147]
 v_mfma_f32_16x16x32_bf16 v[148:151], a[180:183], v[40:43], v[148:151]
 v_mfma_f32_16x16x32_bf16 v[148:151], a[212:215], v[44:47], v[148:151]
 v_mfma_f32_16x16x32_bf16 v[152:155], a[184:187], v[40:43], v[152:155]
 s_add_u32 m0, s39, 33856
 v_exp_f32 v37, v37
 v_mfma_f32_16x16x32_bf16 v[152:155], a[216:219], v[44:47], v[152:155]
 buffer_load_dwordx4 v1, s[20:23], s33 offen offset:2048 nt lds
 v_exp_f32 v38, v38
 v_exp_f32 v39, v39
 v_cvt_pk_bf16_f32 v54, v36, v37
 v_cvt_pk_bf16_f32 v55, v38, v39
 v_mfma_f32_16x16x32_bf16 v[156:159], a[188:191], v[40:43], v[156:159]
 v_mfma_f32_16x16x32_bf16 v[156:159], a[220:223], v[44:47], v[156:159]
 v_mfma_f32_16x16x32_bf16 v[32:35], a[128:131], a[64:67], 0
 v_mfma_f32_16x16x32_bf16 v[32:35], a[132:135], a[68:71], v[32:35]
 v_exp_f32 v24, v24
 v_mfma_f32_16x16x32_bf16 v[32:35], a[136:139], a[72:75], v[32:35]
 v_mfma_f32_16x16x32_bf16 v[32:35], a[140:143], a[76:79], v[32:35]
 v_mfma_f32_16x16x32_bf16 v[36:39], a[156:159], a[76:79], 0
 v_exp_f32 v25, v25
 v_mfma_f32_16x16x32_bf16 v[36:39], a[152:155], a[72:75], v[36:39]
 v_mfma_f32_16x16x32_bf16 v[36:39], a[148:151], a[68:71], v[36:39]
 v_mfma_f32_16x16x32_bf16 v[36:39], a[144:147], a[64:67], v[36:39]
 v_mfma_f32_16x16x32_bf16 v[160:163], a[160:163], v[48:51], v[160:163]
 s_add_u32 m0, s39, 33888
 v_exp_f32 v26, v26
 v_mfma_f32_16x16x32_bf16 v[160:163], a[192:195], v[52:55], v[160:163]
 buffer_load_dwordx4 v1, s[20:23], s33 offen offset:3072 nt lds
 v_exp_f32 v27, v27
 v_exp_f32 v28, v28
 v_cvt_pk_bf16_f32 v40, v24, v25
 v_mfma_f32_16x16x32_bf16 v[164:167], a[164:167], v[48:51], v[164:167]
 s_add_u32 s33, s33, 8192
 v_mfma_f32_16x16x32_bf16 v[164:167], a[196:199], v[52:55], v[164:167]
 v_mfma_f32_16x16x32_bf16 v[168:171], a[168:171], v[48:51], v[168:171]
 v_mfma_f32_16x16x32_bf16 v[168:171], a[200:203], v[52:55], v[168:171]
 v_cvt_pk_bf16_f32 v41, v26, v27
 v_exp_f32 v29, v29
 v_exp_f32 v30, v30
 v_exp_f32 v31, v31
 v_cvt_pk_bf16_f32 v42, v28, v29
 v_cvt_pk_bf16_f32 v43, v30, v31
 v_mfma_f32_16x16x32_bf16 v[172:175], a[172:175], v[48:51], v[172:175]
 v_mfma_f32_16x16x32_bf16 v[172:175], a[204:207], v[52:55], v[172:175]
 v_mfma_f32_16x16x32_bf16 v[24:27], a[96:99], a[80:83], 0
 v_exp_f32 v32, v32
 v_mfma_f32_16x16x32_bf16 v[24:27], a[100:103], a[84:87], v[24:27]
 v_mfma_f32_16x16x32_bf16 v[24:27], a[104:107], a[88:91], v[24:27]
 v_mfma_f32_16x16x32_bf16 v[24:27], a[108:111], a[92:95], v[24:27]
 v_smfmac_f32_16x16x64_bf16 a[228:231], a[240:243], v[48:55], v2
 v_exp_f32 v33, v33
 v_exp_f32 v34, v34
 v_exp_f32 v35, v35
 v_mfma_f32_16x16x32_bf16 v[28:31], a[124:127], a[92:95], 0
 v_mfma_f32_16x16x32_bf16 v[28:31], a[120:123], a[88:91], v[28:31]
 v_mfma_f32_16x16x32_bf16 v[28:31], a[116:119], a[84:87], v[28:31]
 s_add_u32 m0, s39, 50688
 v_mfma_f32_16x16x32_bf16 v[28:31], a[112:115], a[80:83], v[28:31]
 buffer_load_dwordx4 v1, s[20:23], s33 offen nt lds
 v_exp_f32 v36, v36
 v_cvt_pk_bf16_f32 v44, v32, v33
 v_cvt_pk_bf16_f32 v45, v34, v35
 v_exp_f32 v37, v37
 v_mfma_f32_16x16x32_bf16 v[176:179], a[176:179], v[48:51], v[176:179]
 v_exp_f32 v38, v38
 v_mfma_f32_16x16x32_bf16 v[176:179], a[208:211], v[52:55], v[176:179]
 v_mfma_f32_16x16x32_bf16 v[180:183], a[180:183], v[48:51], v[180:183]
 v_mfma_f32_16x16x32_bf16 v[180:183], a[212:215], v[52:55], v[180:183]
 v_mfma_f32_16x16x32_bf16 v[184:187], a[184:187], v[48:51], v[184:187]
 v_exp_f32 v39, v39
 v_mfma_f32_16x16x32_bf16 v[184:187], a[216:219], v[52:55], v[184:187]
 v_mfma_f32_16x16x32_bf16 v[188:191], a[188:191], v[48:51], v[188:191]
 v_mfma_f32_16x16x32_bf16 v[188:191], a[220:223], v[52:55], v[188:191]
 s_waitcnt vmcnt(9)
 s_barrier
 v_mfma_f32_16x16x32_bf16 v[32:35], a[128:131], a[80:83], 0
 v_cvt_pk_bf16_f32 v46, v36, v37
 v_cvt_pk_bf16_f32 v47, v38, v39
 v_mfma_f32_16x16x32_bf16 v[32:35], a[132:135], a[84:87], v[32:35]
 ds_read_b128 a[96:99], v7 offset:0
 ds_read_b128 a[100:103], v7 offset:64
 v_mfma_f32_16x16x32_bf16 v[32:35], a[136:139], a[88:91], v[32:35]
 v_mfma_f32_16x16x32_bf16 v[32:35], a[140:143], a[92:95], v[32:35]
 ds_read_b128 a[104:107], v7 offset:128
 ds_read_b128 a[108:111], v7 offset:192
 v_exp_f32 v24, v24
 v_exp_f32 v25, v25
 v_mfma_f32_16x16x32_bf16 v[36:39], a[156:159], a[92:95], 0
 v_mfma_f32_16x16x32_bf16 v[36:39], a[152:155], a[88:91], v[36:39]
 v_mfma_f32_16x16x32_bf16 v[36:39], a[148:151], a[84:87], v[36:39]
 s_add_u32 m0, s39, 50720
 ds_read_b128 a[124:127], v7 offset:704
 ds_read_b128 a[120:123], v7 offset:640
 v_mfma_f32_16x16x32_bf16 v[36:39], a[144:147], a[80:83], v[36:39]
 buffer_load_dwordx4 v1, s[20:23], s33 offen offset:1024 nt lds
 v_exp_f32 v26, v26
 v_mfma_f32_16x16x32_bf16 v[192:195], a[160:163], v[40:43], v[192:195]
 ds_read_b128 a[116:119], v7 offset:576
 ds_read_b128 a[112:115], v7 offset:512
 v_mfma_f32_16x16x32_bf16 v[192:195], a[192:195], v[44:47], v[192:195]
 v_exp_f32 v27, v27
 v_exp_f32 v28, v28
 v_cvt_pk_bf16_f32 v48, v24, v25
 v_cvt_pk_bf16_f32 v49, v26, v27
 v_mfma_f32_16x16x32_bf16 v[196:199], a[164:167], v[40:43], v[196:199]
 v_mfma_f32_16x16x32_bf16 v[196:199], a[196:199], v[44:47], v[196:199]
 v_mfma_f32_16x16x32_bf16 v[200:203], a[168:171], v[40:43], v[200:203]
 v_mfma_f32_16x16x32_bf16 v[200:203], a[200:203], v[44:47], v[200:203]
 v_exp_f32 v29, v29
 v_exp_f32 v30, v30
 v_exp_f32 v31, v31
 v_mfma_f32_16x16x32_bf16 v[204:207], a[172:175], v[40:43], v[204:207]
 v_mfma_f32_16x16x32_bf16 v[204:207], a[204:207], v[44:47], v[204:207]
 s_waitcnt lgkmcnt(4)
 s_waitcnt vmcnt(6)
 s_barrier
 v_mfma_f32_16x16x32_bf16 v[24:27], a[96:99], a[0:3], 0
 v_cvt_pk_bf16_f32 v50, v28, v29
 v_cvt_pk_bf16_f32 v51, v30, v31
 v_mfma_f32_16x16x32_bf16 v[24:27], a[100:103], a[4:7], v[24:27]
 ds_read_b128 a[128:131], v7 offset:16896
 ds_read_b128 a[132:135], v7 offset:16960
 v_mfma_f32_16x16x32_bf16 v[24:27], a[104:107], a[8:11], v[24:27]
 s_add_u32 m0, s39, 50752
 v_mfma_f32_16x16x32_bf16 v[24:27], a[108:111], a[12:15], v[24:27]
 s_waitcnt lgkmcnt(2)
 buffer_load_dwordx4 v1, s[20:23], s33 offen offset:2048 nt lds
 v_exp_f32 v32, v32
 v_smfmac_f32_16x16x64_bf16 a[232:235], a[236:239], v[40:47], v2
 ds_read_b128 a[136:139], v7 offset:17024
 ds_read_b128 a[140:143], v7 offset:17088
 v_exp_f32 v33, v33
 v_exp_f32 v34, v34
 v_mfma_f32_16x16x32_bf16 v[28:31], a[124:127], a[12:15], 0
 v_exp_f32 v35, v35
 v_mfma_f32_16x16x32_bf16 v[28:31], a[120:123], a[8:11], v[28:31]
 ds_read_b128 a[156:159], v7 offset:17600
 ds_read_b128 a[152:155], v7 offset:17536
 v_mfma_f32_16x16x32_bf16 v[28:31], a[116:119], a[4:7], v[28:31]
 v_mfma_f32_16x16x32_bf16 v[28:31], a[112:115], a[0:3], v[28:31]
 v_exp_f32 v36, v36
 v_cvt_pk_bf16_f32 v52, v32, v33
 v_cvt_pk_bf16_f32 v53, v34, v35
 v_exp_f32 v37, v37
 v_mfma_f32_16x16x32_bf16 v[208:211], a[176:179], v[40:43], v[208:211]
 ds_read_b128 a[148:151], v7 offset:17472
 ds_read_b128 a[144:147], v7 offset:17408
 v_mfma_f32_16x16x32_bf16 v[208:211], a[208:211], v[44:47], v[208:211]
 v_mfma_f32_16x16x32_bf16 v[212:215], a[180:183], v[40:43], v[212:215]
 v_exp_f32 v38, v38
 v_mfma_f32_16x16x32_bf16 v[212:215], a[212:215], v[44:47], v[212:215]
 v_mfma_f32_16x16x32_bf16 v[216:219], a[184:187], v[40:43], v[216:219]
 v_exp_f32 v39, v39
 v_mfma_f32_16x16x32_bf16 v[216:219], a[216:219], v[44:47], v[216:219]
 v_mfma_f32_16x16x32_bf16 v[220:223], a[188:191], v[40:43], v[220:223]
 s_add_u32 m0, s39, 50784
 v_mfma_f32_16x16x32_bf16 v[220:223], a[220:223], v[44:47], v[220:223]
 s_waitcnt lgkmcnt(4)
 buffer_load_dwordx4 v1, s[20:23], s33 offen offset:3072 nt lds
 v_cvt_pk_bf16_f32 v54, v36, v37
 v_cvt_pk_bf16_f32 v55, v38, v39
 v_mfma_f32_16x16x32_bf16 v[32:35], a[128:131], a[0:3], 0
 s_add_u32 s33, s33, 8192
 v_exp_f32 v24, v24
 v_mfma_f32_16x16x32_bf16 v[32:35], a[132:135], a[4:7], v[32:35]
 v_mfma_f32_16x16x32_bf16 v[32:35], a[136:139], a[8:11], v[32:35]
 v_exp_f32 v25, v25
 v_mfma_f32_16x16x32_bf16 v[32:35], a[140:143], a[12:15], v[32:35]
 s_waitcnt lgkmcnt(0)
 v_mfma_f32_16x16x32_bf16 v[36:39], a[156:159], a[12:15], 0
 v_exp_f32 v26, v26
 v_mfma_f32_16x16x32_bf16 v[36:39], a[152:155], a[8:11], v[36:39]
 v_mfma_f32_16x16x32_bf16 v[36:39], a[148:151], a[4:7], v[36:39]
 v_exp_f32 v27, v27
 v_mfma_f32_16x16x32_bf16 v[36:39], a[144:147], a[0:3], v[36:39]
 s_mov_b32 s59, 0
 v_mfma_f32_16x16x32_bf16 v[224:227], a[160:163], v[48:51], v[224:227]
 s_add_u32 m0, s45, 0
 v_mfma_f32_16x16x32_bf16 v[224:227], a[192:195], v[52:55], v[224:227]
 buffer_load_dwordx4 v1, s[28:31], s59 offen nt lds
 v_exp_f32 v28, v28
 v_cvt_pk_bf16_f32 v40, v24, v25
 v_mfma_f32_16x16x32_bf16 v[228:231], a[164:167], v[48:51], v[228:231]
 ds_read_b64_tr_b16 a[160:161], v8 offset:0
 ds_read_b64_tr_b16 a[162:163], v8 offset:512
 v_mfma_f32_16x16x32_bf16 v[228:231], a[196:199], v[52:55], v[228:231]
 v_cvt_pk_bf16_f32 v41, v26, v27
 v_exp_f32 v29, v29
 v_exp_f32 v30, v30
 v_mfma_f32_16x16x32_bf16 v[232:235], a[168:171], v[48:51], v[232:235]
 ds_read_b64_tr_b16 a[192:193], v8 offset:16896
 ds_read_b64_tr_b16 a[194:195], v8 offset:17408
 v_mfma_f32_16x16x32_bf16 v[232:235], a[200:203], v[52:55], v[232:235]
 v_mfma_f32_16x16x32_bf16 v[236:239], a[172:175], v[48:51], v[236:239]
 v_exp_f32 v31, v31
 v_mfma_f32_16x16x32_bf16 v[236:239], a[204:207], v[52:55], v[236:239]
 ds_read_b64_tr_b16 a[164:165], v8 offset:32
 ds_read_b64_tr_b16 a[166:167], v8 offset:544
 v_cvt_pk_bf16_f32 v42, v28, v29
 v_cvt_pk_bf16_f32 v43, v30, v31
 v_mfma_f32_16x16x32_bf16 v[24:27], a[96:99], a[16:19], 0
 v_mfma_f32_16x16x32_bf16 v[24:27], a[100:103], a[20:23], v[24:27]
 ds_read_b64_tr_b16 a[196:197], v8 offset:16928
 ds_read_b64_tr_b16 a[198:199], v8 offset:17440
 v_mfma_f32_16x16x32_bf16 v[24:27], a[104:107], a[24:27], v[24:27]
 v_exp_f32 v32, v32
 v_mfma_f32_16x16x32_bf16 v[24:27], a[108:111], a[28:31], v[24:27]
 ds_read_b64_tr_b16 a[168:169], v8 offset:64
 ds_read_b64_tr_b16 a[170:171], v8 offset:576
 v_exp_f32 v33, v33
 v_exp_f32 v34, v34
 v_smfmac_f32_16x16x64_bf16 a[232:235], a[240:243], v[48:55], v2
 v_mfma_f32_16x16x32_bf16 v[28:31], a[124:127], a[28:31], 0
 ds_read_b64_tr_b16 a[200:201], v8 offset:16960
 ds_read_b64_tr_b16 a[202:203], v8 offset:17472
 v_mfma_f32_16x16x32_bf16 v[28:31], a[120:123], a[24:27], v[28:31]
 v_exp_f32 v35, v35
 v_mfma_f32_16x16x32_bf16 v[28:31], a[116:119], a[20:23], v[28:31]
 v_mfma_f32_16x16x32_bf16 v[28:31], a[112:115], a[16:19], v[28:31]
 ds_read_b64_tr_b16 a[172:173], v8 offset:96
 ds_read_b64_tr_b16 a[174:175], v8 offset:608
 v_exp_f32 v36, v36
 v_mfma_f32_16x16x32_bf16 v[240:243], a[176:179], v[48:51], v[240:243]
 v_mfma_f32_16x16x32_bf16 v[240:243], a[208:211], v[52:55], v[240:243]
 ds_read_b64_tr_b16 a[204:205], v8 offset:16992
 ds_read_b64_tr_b16 a[206:207], v8 offset:17504
 v_cvt_pk_bf16_f32 v44, v32, v33
 v_cvt_pk_bf16_f32 v45, v34, v35
 v_mfma_f32_16x16x32_bf16 v[244:247], a[180:183], v[48:51], v[244:247]
 v_exp_f32 v37, v37
 v_mfma_f32_16x16x32_bf16 v[244:247], a[212:215], v[52:55], v[244:247]
 v_mfma_f32_16x16x32_bf16 v[248:251], a[184:187], v[48:51], v[248:251]
 v_exp_f32 v38, v38
 v_mfma_f32_16x16x32_bf16 v[248:251], a[216:219], v[52:55], v[248:251]
 ds_read_b64_tr_b16 a[176:177], v8 offset:128
 ds_read_b64_tr_b16 a[178:179], v8 offset:640
 v_exp_f32 v39, v39
 v_mfma_f32_16x16x32_bf16 v[252:255], a[188:191], v[48:51], v[252:255]
 v_mfma_f32_16x16x32_bf16 v[252:255], a[220:223], v[52:55], v[252:255]
 v_cvt_pk_bf16_f32 v46, v36, v37
 v_cvt_pk_bf16_f32 v47, v38, v39
 v_exp_f32 v24, v24
 v_mfma_f32_16x16x32_bf16 v[32:35], a[128:131], a[16:19], 0
 ds_read_b64_tr_b16 a[208:209], v8 offset:17024
 ds_read_b64_tr_b16 a[210:211], v8 offset:17536
 v_mfma_f32_16x16x32_bf16 v[32:35], a[132:135], a[20:23], v[32:35]
 v_mfma_f32_16x16x32_bf16 v[32:35], a[136:139], a[24:27], v[32:35]
 v_exp_f32 v25, v25
 v_mfma_f32_16x16x32_bf16 v[32:35], a[140:143], a[28:31], v[32:35]
 ds_read_b64_tr_b16 a[180:181], v8 offset:160
 ds_read_b64_tr_b16 a[182:183], v8 offset:672
 v_exp_f32 v26, v26
 v_mfma_f32_16x16x32_bf16 v[36:39], a[156:159], a[28:31], 0
 v_mfma_f32_16x16x32_bf16 v[36:39], a[152:155], a[24:27], v[36:39]
 v_mfma_f32_16x16x32_bf16 v[36:39], a[148:151], a[20:23], v[36:39]
 ds_read_b64_tr_b16 a[212:213], v8 offset:17056
 ds_read_b64_tr_b16 a[214:215], v8 offset:17568
 v_mfma_f32_16x16x32_bf16 v[36:39], a[144:147], a[16:19], v[36:39]
 s_waitcnt lgkmcnt(15)
 v_exp_f32 v27, v27
 v_exp_f32 v28, v28
 v_cvt_pk_bf16_f32 v48, v24, v25
 v_mfma_f32_16x16x32_bf16 v[64:67], a[160:163], v[40:43], v[64:67]
 v_mfma_f32_16x16x32_bf16 v[64:67], a[192:195], v[44:47], v[64:67]
 ds_read_b64_tr_b16 a[184:185], v8 offset:192
 ds_read_b64_tr_b16 a[186:187], v8 offset:704
 v_cvt_pk_bf16_f32 v49, v26, v27
 v_exp_f32 v29, v29
 v_mfma_f32_16x16x32_bf16 v[68:71], a[164:167], v[40:43], v[68:71]
 v_exp_f32 v30, v30
 v_mfma_f32_16x16x32_bf16 v[68:71], a[196:199], v[44:47], v[68:71]
 s_waitcnt lgkmcnt(10)
 v_mfma_f32_16x16x32_bf16 v[72:75], a[168:171], v[40:43], v[72:75]
 ds_read_b64_tr_b16 a[216:217], v8 offset:17088
 ds_read_b64_tr_b16 a[218:219], v8 offset:17600
 v_mfma_f32_16x16x32_bf16 v[72:75], a[200:203], v[44:47], v[72:75]
 v_exp_f32 v31, v31
 v_cvt_pk_bf16_f32 v50, v28, v29
 v_cvt_pk_bf16_f32 v51, v30, v31
 v_mfma_f32_16x16x32_bf16 v[76:79], a[172:175], v[40:43], v[76:79]
 v_mfma_f32_16x16x32_bf16 v[76:79], a[204:207], v[44:47], v[76:79]
 ds_read_b64_tr_b16 a[188:189], v8 offset:224
 ds_read_b64_tr_b16 a[190:191], v8 offset:736
 v_exp_f32 v32, v32
 v_exp_f32 v33, v33
 v_mfma_f32_16x16x32_bf16 v[24:27], a[96:99], a[32:35], 0
 v_exp_f32 v34, v34
 v_mfma_f32_16x16x32_bf16 v[24:27], a[100:103], a[36:39], v[24:27]
 v_mfma_f32_16x16x32_bf16 v[24:27], a[104:107], a[40:43], v[24:27]
 ds_read_b64_tr_b16 a[220:221], v8 offset:17120
 ds_read_b64_tr_b16 a[222:223], v8 offset:17632
 v_mfma_f32_16x16x32_bf16 v[24:27], a[108:111], a[44:47], v[24:27]
 v_smfmac_f32_16x16x64_bf16 a[224:227], a[236:239], v[40:47], v2
 v_exp_f32 v35, v35
 v_exp_f32 v36, v36
 v_mfma_f32_16x16x32_bf16 v[28:31], a[124:127], a[44:47], 0
 v_mfma_f32_16x16x32_bf16 v[28:31], a[120:123], a[40:43], v[28:31]
 s_mov_b32 s59, 1024
 v_cvt_pk_bf16_f32 v52, v32, v33
 v_cvt_pk_bf16_f32 v53, v34, v35
 v_mfma_f32_16x16x32_bf16 v[28:31], a[116:119], a[36:39], v[28:31]
 s_add_u32 m0, s45, 1088
 v_mfma_f32_16x16x32_bf16 v[28:31], a[112:115], a[32:35], v[28:31]
 s_waitcnt lgkmcnt(8)
 buffer_load_dwordx4 v1, s[28:31], s59 offen nt lds
 v_exp_f32 v37, v37
 v_mfma_f32_16x16x32_bf16 v[80:83], a[176:179], v[40:43], v[80:83]
 v_exp_f32 v38, v38
 v_mfma_f32_16x16x32_bf16 v[80:83], a[208:211], v[44:47], v[80:83]
 v_mfma_f32_16x16x32_bf16 v[84:87], a[180:183], v[40:43], v[84:87]
 v_exp_f32 v39, v39
 v_mfma_f32_16x16x32_bf16 v[84:87], a[212:215], v[44:47], v[84:87]
 s_waitcnt lgkmcnt(0)
 s_barrier
 v_mfma_f32_16x16x32_bf16 v[88:91], a[184:187], v[40:43], v[88:91]
 v_mfma_f32_16x16x32_bf16 v[88:91], a[216:219], v[44:47], v[88:91]
 v_mfma_f32_16x16x32_bf16 v[92:95], a[188:191], v[40:43], v[92:95]
 v_cvt_pk_bf16_f32 v54, v36, v37
 v_cvt_pk_bf16_f32 v55, v38, v39
 v_mfma_f32_16x16x32_bf16 v[92:95], a[220:223], v[44:47], v[92:95]
 v_mfma_f32_16x16x32_bf16 v[32:35], a[128:131], a[32:35], 0
 v_exp_f32 v24, v24
 v_mfma_f32_16x16x32_bf16 v[32:35], a[132:135], a[36:39], v[32:35]
 v_mfma_f32_16x16x32_bf16 v[32:35], a[136:139], a[40:43], v[32:35]
 v_exp_f32 v25, v25
 v_mfma_f32_16x16x32_bf16 v[32:35], a[140:143], a[44:47], v[32:35]
 v_mfma_f32_16x16x32_bf16 v[36:39], a[156:159], a[44:47], 0
 v_exp_f32 v26, v26
 v_mfma_f32_16x16x32_bf16 v[36:39], a[152:155], a[40:43], v[36:39]
 v_mfma_f32_16x16x32_bf16 v[36:39], a[148:151], a[36:39], v[36:39]
 s_add_u32 m0, s39, 0
 v_mfma_f32_16x16x32_bf16 v[36:39], a[144:147], a[32:35], v[36:39]
 buffer_load_dwordx4 v1, s[20:23], s33 offen nt lds
 v_exp_f32 v27, v27
 v_mfma_f32_16x16x32_bf16 v[96:99], a[160:163], v[48:51], v[96:99]
 v_exp_f32 v28, v28
 v_mfma_f32_16x16x32_bf16 v[96:99], a[192:195], v[52:55], v[96:99]
 v_mfma_f32_16x16x32_bf16 v[100:103], a[164:167], v[48:51], v[100:103]
 v_cvt_pk_bf16_f32 v40, v24, v25
 v_cvt_pk_bf16_f32 v41, v26, v27
 v_mfma_f32_16x16x32_bf16 v[100:103], a[196:199], v[52:55], v[100:103]
 v_mfma_f32_16x16x32_bf16 v[104:107], a[168:171], v[48:51], v[104:107]
 v_exp_f32 v29, v29
 v_mfma_f32_16x16x32_bf16 v[104:107], a[200:203], v[52:55], v[104:107]
 v_mfma_f32_16x16x32_bf16 v[108:111], a[172:175], v[48:51], v[108:111]
 v_exp_f32 v30, v30
 v_mfma_f32_16x16x32_bf16 v[108:111], a[204:207], v[52:55], v[108:111]
 v_mfma_f32_16x16x32_bf16 v[24:27], a[96:99], a[48:51], 0
 v_exp_f32 v31, v31
 v_mfma_f32_16x16x32_bf16 v[24:27], a[100:103], a[52:55], v[24:27]
 v_cvt_pk_bf16_f32 v42, v28, v29
 v_cvt_pk_bf16_f32 v43, v30, v31
 v_mfma_f32_16x16x32_bf16 v[24:27], a[104:107], a[56:59], v[24:27]
 v_exp_f32 v32, v32
 v_mfma_f32_16x16x32_bf16 v[24:27], a[108:111], a[60:63], v[24:27]
 v_smfmac_f32_16x16x64_bf16 a[224:227], a[240:243], v[48:55], v2
 v_exp_f32 v33, v33
 v_mfma_f32_16x16x32_bf16 v[28:31], a[124:127], a[60:63], 0
 v_mfma_f32_16x16x32_bf16 v[28:31], a[120:123], a[56:59], v[28:31]
 v_exp_f32 v34, v34
 v_mfma_f32_16x16x32_bf16 v[28:31], a[116:119], a[52:55], v[28:31]
 s_add_u32 m0, s39, 32
 v_mfma_f32_16x16x32_bf16 v[28:31], a[112:115], a[48:51], v[28:31]
 buffer_load_dwordx4 v1, s[20:23], s33 offen offset:1024 nt lds
 v_mfma_f32_16x16x32_bf16 v[112:115], a[176:179], v[48:51], v[112:115]
 v_exp_f32 v35, v35
 v_mfma_f32_16x16x32_bf16 v[112:115], a[208:211], v[52:55], v[112:115]
 v_exp_f32 v36, v36
 v_cvt_pk_bf16_f32 v44, v32, v33
 v_mfma_f32_16x16x32_bf16 v[116:119], a[180:183], v[48:51], v[116:119]
 v_mfma_f32_16x16x32_bf16 v[116:119], a[212:215], v[52:55], v[116:119]
 v_cvt_pk_bf16_f32 v45, v34, v35
 v_exp_f32 v37, v37
 v_mfma_f32_16x16x32_bf16 v[120:123], a[184:187], v[48:51], v[120:123]
 v_mfma_f32_16x16x32_bf16 v[120:123], a[216:219], v[52:55], v[120:123]
 v_exp_f32 v38, v38
 v_exp_f32 v39, v39
 v_mfma_f32_16x16x32_bf16 v[124:127], a[188:191], v[48:51], v[124:127]
 v_mfma_f32_16x16x32_bf16 v[124:127], a[220:223], v[52:55], v[124:127]
 v_cvt_pk_bf16_f32 v46, v36, v37
 v_cvt_pk_bf16_f32 v47, v38, v39
 v_mfma_f32_16x16x32_bf16 v[32:35], a[128:131], a[48:51], 0
 v_exp_f32 v24, v24
 v_mfma_f32_16x16x32_bf16 v[32:35], a[132:135], a[52:55], v[32:35]
 v_mfma_f32_16x16x32_bf16 v[32:35], a[136:139], a[56:59], v[32:35]
 v_exp_f32 v25, v25
 v_mfma_f32_16x16x32_bf16 v[32:35], a[140:143], a[60:63], v[32:35]
 v_mfma_f32_16x16x32_bf16 v[36:39], a[156:159], a[60:63], 0
 v_exp_f32 v26, v26
 v_mfma_f32_16x16x32_bf16 v[36:39], a[152:155], a[56:59], v[36:39]
 v_mfma_f32_16x16x32_bf16 v[36:39], a[148:151], a[52:55], v[36:39]
 v_exp_f32 v27, v27
 v_mfma_f32_16x16x32_bf16 v[36:39], a[144:147], a[48:51], v[36:39]
 v_exp_f32 v28, v28
 v_cvt_pk_bf16_f32 v48, v24, v25
 v_cvt_pk_bf16_f32 v49, v26, v27
 v_mfma_f32_16x16x32_bf16 v[128:131], a[160:163], v[40:43], v[128:131]
 s_add_u32 m0, s39, 64
 v_mfma_f32_16x16x32_bf16 v[128:131], a[192:195], v[44:47], v[128:131]
 buffer_load_dwordx4 v1, s[20:23], s33 offen offset:2048 nt lds
 v_mfma_f32_16x16x32_bf16 v[132:135], a[164:167], v[40:43], v[132:135]
 v_exp_f32 v29, v29
 v_mfma_f32_16x16x32_bf16 v[132:135], a[196:199], v[44:47], v[132:135]
 v_mfma_f32_16x16x32_bf16 v[136:139], a[168:171], v[40:43], v[136:139]
 v_exp_f32 v30, v30
 v_mfma_f32_16x16x32_bf16 v[136:139], a[200:203], v[44:47], v[136:139]
 v_mfma_f32_16x16x32_bf16 v[140:143], a[172:175], v[40:43], v[140:143]
 v_exp_f32 v31, v31
 v_mfma_f32_16x16x32_bf16 v[140:143], a[204:207], v[44:47], v[140:143]
 v_cvt_pk_bf16_f32 v50, v28, v29
 v_cvt_pk_bf16_f32 v51, v30, v31
 v_mfma_f32_16x16x32_bf16 v[24:27], a[96:99], a[64:67], 0
 v_mfma_f32_16x16x32_bf16 v[24:27], a[100:103], a[68:71], v[24:27]
 v_exp_f32 v32, v32
 v_mfma_f32_16x16x32_bf16 v[24:27], a[104:107], a[72:75], v[24:27]
 v_mfma_f32_16x16x32_bf16 v[24:27], a[108:111], a[76:79], v[24:27]
 v_exp_f32 v33, v33
 v_smfmac_f32_16x16x64_bf16 a[228:231], a[236:239], v[40:47], v2
 v_mfma_f32_16x16x32_bf16 v[28:31], a[124:127], a[76:79], 0
 v_exp_f32 v34, v34
 v_mfma_f32_16x16x32_bf16 v[28:31], a[120:123], a[72:75], v[28:31]
 v_exp_f32 v35, v35
 v_mfma_f32_16x16x32_bf16 v[28:31], a[116:119], a[68:71], v[28:31]
 v_mfma_f32_16x16x32_bf16 v[28:31], a[112:115], a[64:67], v[28:31]
 v_exp_f32 v36, v36
 v_cvt_pk_bf16_f32 v52, v32, v33
 v_cvt_pk_bf16_f32 v53, v34, v35
 v_mfma_f32_16x16x32_bf16 v[144:147], a[176:179], v[40:43], v[144:147]
 s_add_u32 m0, s39, 96
 v_mfma_f32_16x16x32_bf16 v[144:147], a[208:211], v[44:47], v[144:147]
 buffer_load_dwordx4 v1, s[20:23], s33 offen offset:3072 nt lds
 v_mfma_f32_16x16x32_bf16 v[148:151], a[180:183], v[40:43], v[148:151]
 s_add_u32 s33, s33, 8192
 v_exp_f32 v37, v37
 v_mfma_f32_16x16x32_bf16 v[148:151], a[212:215], v[44:47], v[148:151]
 v_mfma_f32_16x16x32_bf16 v[152:155], a[184:187], v[40:43], v[152:155]
 v_exp_f32 v38, v38
 v_mfma_f32_16x16x32_bf16 v[152:155], a[216:219], v[44:47], v[152:155]
 s_mov_b32 s59, 2048
 v_exp_f32 v39, v39
 v_cvt_pk_bf16_f32 v54, v36, v37
 v_cvt_pk_bf16_f32 v55, v38, v39
 v_mfma_f32_16x16x32_bf16 v[156:159], a[188:191], v[40:43], v[156:159]
 s_add_u32 m0, s45, 2176
 v_mfma_f32_16x16x32_bf16 v[156:159], a[220:223], v[44:47], v[156:159]
 buffer_load_dwordx4 v1, s[28:31], s59 offen nt lds
 v_mfma_f32_16x16x32_bf16 v[32:35], a[128:131], a[64:67], 0
 v_exp_f32 v24, v24
 v_mfma_f32_16x16x32_bf16 v[32:35], a[132:135], a[68:71], v[32:35]
 v_mfma_f32_16x16x32_bf16 v[32:35], a[136:139], a[72:75], v[32:35]
 v_exp_f32 v25, v25
 v_mfma_f32_16x16x32_bf16 v[32:35], a[140:143], a[76:79], v[32:35]
 v_mfma_f32_16x16x32_bf16 v[36:39], a[156:159], a[76:79], 0
 v_exp_f32 v26, v26
 v_mfma_f32_16x16x32_bf16 v[36:39], a[152:155], a[72:75], v[36:39]
 v_exp_f32 v27, v27
 v_mfma_f32_16x16x32_bf16 v[36:39], a[148:151], a[68:71], v[36:39]
 v_mfma_f32_16x16x32_bf16 v[36:39], a[144:147], a[64:67], v[36:39]
 v_exp_f32 v28, v28
 v_cvt_pk_bf16_f32 v40, v24, v25
 v_mfma_f32_16x16x32_bf16 v[160:163], a[160:163], v[48:51], v[160:163]
 v_mfma_f32_16x16x32_bf16 v[160:163], a[192:195], v[52:55], v[160:163]
 v_cvt_pk_bf16_f32 v41, v26, v27
 v_exp_f32 v29, v29
 v_mfma_f32_16x16x32_bf16 v[164:167], a[164:167], v[48:51], v[164:167]
 s_add_u32 m0, s39, 16896
 v_mfma_f32_16x16x32_bf16 v[164:167], a[196:199], v[52:55], v[164:167]
 buffer_load_dwordx4 v1, s[20:23], s33 offen nt lds
 v_mfma_f32_16x16x32_bf16 v[168:171], a[168:171], v[48:51], v[168:171]
 v_exp_f32 v30, v30
 v_mfma_f32_16x16x32_bf16 v[168:171], a[200:203], v[52:55], v[168:171]
 v_exp_f32 v31, v31
 v_cvt_pk_bf16_f32 v42, v28, v29
 v_mfma_f32_16x16x32_bf16 v[172:175], a[172:175], v[48:51], v[172:175]
 v_mfma_f32_16x16x32_bf16 v[172:175], a[204:207], v[52:55], v[172:175]
 v_cvt_pk_bf16_f32 v43, v30, v31
 v_exp_f32 v32, v32
 v_mfma_f32_16x16x32_bf16 v[24:27], a[96:99], a[80:83], 0
 v_mfma_f32_16x16x32_bf16 v[24:27], a[100:103], a[84:87], v[24:27]
 v_exp_f32 v33, v33
 v_mfma_f32_16x16x32_bf16 v[24:27], a[104:107], a[88:91], v[24:27]
 v_mfma_f32_16x16x32_bf16 v[24:27], a[108:111], a[92:95], v[24:27]
 v_exp_f32 v34, v34
 v_smfmac_f32_16x16x64_bf16 a[228:231], a[240:243], v[48:55], v2
 v_exp_f32 v35, v35
 v_mfma_f32_16x16x32_bf16 v[28:31], a[124:127], a[92:95], 0
 v_mfma_f32_16x16x32_bf16 v[28:31], a[120:123], a[88:91], v[28:31]
 v_exp_f32 v36, v36
 v_mfma_f32_16x16x32_bf16 v[28:31], a[116:119], a[84:87], v[28:31]
 v_mfma_f32_16x16x32_bf16 v[28:31], a[112:115], a[80:83], v[28:31]
 v_cvt_pk_bf16_f32 v44, v32, v33
 v_cvt_pk_bf16_f32 v45, v34, v35
 v_mfma_f32_16x16x32_bf16 v[176:179], a[176:179], v[48:51], v[176:179]
 v_mfma_f32_16x16x32_bf16 v[176:179], a[208:211], v[52:55], v[176:179]
 v_exp_f32 v37, v37
 v_exp_f32 v38, v38
 v_mfma_f32_16x16x32_bf16 v[180:183], a[180:183], v[48:51], v[180:183]
 s_add_u32 m0, s39, 16928
 v_exp_f32 v39, v39
 v_mfma_f32_16x16x32_bf16 v[180:183], a[212:215], v[52:55], v[180:183]
 buffer_load_dwordx4 v1, s[20:23], s33 offen offset:1024 nt lds
 v_mfma_f32_16x16x32_bf16 v[184:187], a[184:187], v[48:51], v[184:187]
 v_mfma_f32_16x16x32_bf16 v[184:187], a[216:219], v[52:55], v[184:187]
 v_cvt_pk_bf16_f32 v46, v36, v37
 v_cvt_pk_bf16_f32 v47, v38, v39
 v_exp_f32 v24, v24
 v_mfma_f32_16x16x32_bf16 v[188:191], a[188:191], v[48:51], v[188:191]
 v_mfma_f32_16x16x32_bf16 v[188:191], a[220:223], v[52:55], v[188:191]
 s_waitcnt vmcnt(13)
 s_barrier
 v_mfma_f32_16x16x32_bf16 v[32:35], a[128:131], a[80:83], 0
 v_exp_f32 v25, v25
 v_mfma_f32_16x16x32_bf16 v[32:35], a[132:135], a[84:87], v[32:35]
 ds_read_b128 a[96:99], v7 offset:33792
 ds_read_b128 a[100:103], v7 offset:33856
 v_mfma_f32_16x16x32_bf16 v[32:35], a[136:139], a[88:91], v[32:35]
 v_mfma_f32_16x16x32_bf16 v[32:35], a[140:143], a[92:95], v[32:35]
L_pg0_2:
 s_cbranch_execz L_pg0_6
 ds_read_b128 a[104:107], v7 offset:33920
 ds_read_b128 a[108:111], v7 offset:33984
 v_exp_f32 v26, v26
 v_mfma_f32_16x16x32_bf16 v[36:39], a[156:159], a[92:95], 0
 v_exp_f32 v27, v27
 v_mfma_f32_16x16x32_bf16 v[36:39], a[152:155], a[88:91], v[36:39]
 v_exp_f32 v28, v28
 v_mfma_f32_16x16x32_bf16 v[36:39], a[148:151], a[84:87], v[36:39]
 ds_read_b128 a[124:127], v7 offset:34496
 ds_read_b128 a[120:123], v7 offset:34432
 v_mfma_f32_16x16x32_bf16 v[36:39], a[144:147], a[80:83], v[36:39]
 v_mfma_f32_16x16x32_bf16 v[192:195], a[160:163], v[40:43], v[192:195]
 ds_read_b128 a[116:119], v7 offset:34368
 ds_read_b128 a[112:115], v7 offset:34304
 v_mfma_f32_16x16x32_bf16 v[192:195], a[192:195], v[44:47], v[192:195]
 v_cvt_pk_bf16_f32 v48, v24, v25
 v_cvt_pk_bf16_f32 v49, v26, v27
 v_exp_f32 v29, v29
 v_mfma_f32_16x16x32_bf16 v[196:199], a[164:167], v[40:43], v[196:199]
 s_add_u32 m0, s39, 16960
 v_mfma_f32_16x16x32_bf16 v[196:199], a[196:199], v[44:47], v[196:199]
 buffer_load_dwordx4 v1, s[20:23], s33 offen offset:2048 nt lds
 v_mfma_f32_16x16x32_bf16 v[200:203], a[168:171], v[40:43], v[200:203]
 v_exp_f32 v30, v30
 v_mfma_f32_16x16x32_bf16 v[200:203], a[200:203], v[44:47], v[200:203]
 v_mfma_f32_16x16x32_bf16 v[204:207], a[172:175], v[40:43], v[204:207]
 v_exp_f32 v31, v31
 v_mfma_f32_16x16x32_bf16 v[204:207], a[204:207], v[44:47], v[204:207]
 s_waitcnt lgkmcnt(4)
 s_waitcnt vmcnt(10)
 s_barrier
 v_mfma_f32_16x16x32_bf16 v[24:27], a[96:99], a[0:3], 0
 v_cvt_pk_bf16_f32 v50, v28, v29
 v_cvt_pk_bf16_f32 v51, v30, v31
 v_mfma_f32_16x16x32_bf16 v[24:27], a[100:103], a[4:7], v[24:27]
 ds_read_b128 a[128:131], v7 offset:50688
 ds_read_b128 a[132:135], v7 offset:50752
 v_mfma_f32_16x16x32_bf16 v[24:27], a[104:107], a[8:11], v[24:27]
 v_exp_f32 v32, v32
 v_mfma_f32_16x16x32_bf16 v[24:27], a[108:111], a[12:15], v[24:27]
 s_waitcnt lgkmcnt(2)
 v_smfmac_f32_16x16x64_bf16 a[232:235], a[236:239], v[40:47], v2
 ds_read_b128 a[136:139], v7 offset:50816
 ds_read_b128 a[140:143], v7 offset:50880
 v_exp_f32 v33, v33
 v_mfma_f32_16x16x32_bf16 v[28:31], a[124:127], a[12:15], 0
 v_exp_f32 v34, v34
 v_mfma_f32_16x16x32_bf16 v[28:31], a[120:123], a[8:11], v[28:31]
 ds_read_b128 a[156:159], v7 offset:51392
 ds_read_b128 a[152:155], v7 offset:51328
 v_mfma_f32_16x16x32_bf16 v[28:31], a[116:119], a[4:7], v[28:31]
 v_exp_f32 v35, v35
 v_mfma_f32_16x16x32_bf16 v[28:31], a[112:115], a[0:3], v[28:31]
 v_exp_f32 v36, v36
 v_cvt_pk_bf16_f32 v52, v32, v33
 v_cvt_pk_bf16_f32 v53, v34, v35
 v_mfma_f32_16x16x32_bf16 v[208:211], a[176:179], v[40:43], v[208:211]
 ds_read_b128 a[148:151], v7 offset:51264
 ds_read_b128 a[144:147], v7 offset:51200
 v_mfma_f32_16x16x32_bf16 v[208:211], a[208:211], v[44:47], v[208:211]
 v_mfma_f32_16x16x32_bf16 v[212:215], a[180:183], v[40:43], v[212:215]
 s_add_u32 m0, s39, 16992
 v_exp_f32 v37, v37
 v_mfma_f32_16x16x32_bf16 v[212:215], a[212:215], v[44:47], v[212:215]
 buffer_load_dwordx4 v1, s[20:23], s33 offen offset:3072 nt lds
 v_mfma_f32_16x16x32_bf16 v[216:219], a[184:187], v[40:43], v[216:219]
 s_add_u32 s33, s33, 8192
 v_exp_f32 v38, v38
 v_mfma_f32_16x16x32_bf16 v[216:219], a[216:219], v[44:47], v[216:219]
 s_mov_b32 s59, 3072
 v_exp_f32 v39, v39
 v_cvt_pk_bf16_f32 v54, v36, v37
 v_cvt_pk_bf16_f32 v55, v38, v39
 v_mfma_f32_16x16x32_bf16 v[220:223], a[188:191], v[40:43], v[220:223]
 s_add_u32 m0, s45, 3264
 v_mfma_f32_16x16x32_bf16 v[220:223], a[220:223], v[44:47], v[220:223]
 s_waitcnt lgkmcnt(4)
 buffer_load_dwordx4 v1, s[28:31], s59 offen nt lds
 v_mfma_f32_16x16x32_bf16 v[32:35], a[128:131], a[0:3], 0
 v_exp_f32 v24, v24
 v_mfma_f32_16x16x32_bf16 v[32:35], a[132:135], a[4:7], v[32:35]
 v_exp_f32 v25, v25
 v_mfma_f32_16x16x32_bf16 v[32:35], a[136:139], a[8:11], v[32:35]
 v_mfma_f32_16x16x32_bf16 v[32:35], a[140:143], a[12:15], v[32:35]
 s_waitcnt lgkmcnt(0)
 v_exp_f32 v26, v26
 v_mfma_f32_16x16x32_bf16 v[36:39], a[156:159], a[12:15], 0
 v_exp_f32 v27, v27
 v_mfma_f32_16x16x32_bf16 v[36:39], a[152:155], a[8:11], v[36:39]
 v_exp_f32 v28, v28
 v_mfma_f32_16x16x32_bf16 v[36:39], a[148:151], a[4:7], v[36:39]
 v_mfma_f32_16x16x32_bf16 v[36:39], a[144:147], a[0:3], v[36:39]
 v_cvt_pk_bf16_f32 v40, v24, v25
 v_cvt_pk_bf16_f32 v41, v26, v27
 v_mfma_f32_16x16x32_bf16 v[224:227], a[160:163], v[48:51], v[224:227]
 v_exp_f32 v29, v29
 v_mfma_f32_16x16x32_bf16 v[224:227], a[192:195], v[52:55], v[224:227]
 v_mfma_f32_16x16x32_bf16 v[228:231], a[164:167], v[48:51], v[228:231]
 ds_read_b64_tr_b16 a[160:161], v8 offset:33792
 ds_read_b64_tr_b16 a[162:163], v8 offset:34304
 v_mfma_f32_16x16x32_bf16 v[228:231], a[196:199], v[52:55], v[228:231]
 v_exp_f32 v30, v30
 v_mfma_f32_16x16x32_bf16 v[232:235], a[168:171], v[48:51], v[232:235]
 ds_read_b64_tr_b16 a[192:193], v8 offset:50688
 ds_read_b64_tr_b16 a[194:195], v8 offset:51200
 v_mfma_f32_16x16x32_bf16 v[232:235], a[200:203], v[52:55], v[232:235]
 v_exp_f32 v31, v31
 v_mfma_f32_16x16x32_bf16 v[236:239], a[172:175], v[48:51], v[236:239]
 v_cvt_pk_bf16_f32 v42, v28, v29
 v_cvt_pk_bf16_f32 v43, v30, v31
 v_mfma_f32_16x16x32_bf16 v[236:239], a[204:207], v[52:55], v[236:239]
 ds_read_b64_tr_b16 a[164:165], v8 offset:33824
 ds_read_b64_tr_b16 a[166:167], v8 offset:34336
 v_mfma_f32_16x16x32_bf16 v[24:27], a[96:99], a[16:19], 0
 v_mfma_f32_16x16x32_bf16 v[24:27], a[100:103], a[20:23], v[24:27]
 ds_read_b64_tr_b16 a[196:197], v8 offset:50720
 ds_read_b64_tr_b16 a[198:199], v8 offset:51232
 v_mfma_f32_16x16x32_bf16 v[24:27], a[104:107], a[24:27], v[24:27]
 v_exp_f32 v32, v32
 v_mfma_f32_16x16x32_bf16 v[24:27], a[108:111], a[28:31], v[24:27]
 ds_read_b64_tr_b16 a[168:169], v8 offset:33856
 ds_read_b64_tr_b16 a[170:171], v8 offset:34368
 v_exp_f32 v33, v33
 v_smfmac_f32_16x16x64_bf16 a[232:235], a[240:243], v[48:55], v2
 v_exp_f32 v34, v34
 v_mfma_f32_16x16x32_bf16 v[28:31], a[124:127], a[28:31], 0
 ds_read_b64_tr_b16 a[200:201], v8 offset:50752
 ds_read_b64_tr_b16 a[202:203], v8 offset:51264
 v_mfma_f32_16x16x32_bf16 v[28:31], a[120:123], a[24:27], v[28:31]
 v_exp_f32 v35, v35
 v_mfma_f32_16x16x32_bf16 v[28:31], a[116:119], a[20:23], v[28:31]
 v_mfma_f32_16x16x32_bf16 v[28:31], a[112:115], a[16:19], v[28:31]
 ds_read_b64_tr_b16 a[172:173], v8 offset:33888
 ds_read_b64_tr_b16 a[174:175], v8 offset:34400
 v_exp_f32 v36, v36
 v_mfma_f32_16x16x32_bf16 v[240:243], a[176:179], v[48:51], v[240:243]
 v_cvt_pk_bf16_f32 v44, v32, v33
 v_cvt_pk_bf16_f32 v45, v34, v35
 v_mfma_f32_16x16x32_bf16 v[240:243], a[208:211], v[52:55], v[240:243]
 ds_read_b64_tr_b16 a[204:205], v8 offset:50784
 ds_read_b64_tr_b16 a[206:207], v8 offset:51296
 v_mfma_f32_16x16x32_bf16 v[244:247], a[180:183], v[48:51], v[244:247]
 v_exp_f32 v37, v37
 v_mfma_f32_16x16x32_bf16 v[244:247], a[212:215], v[52:55], v[244:247]
 v_mfma_f32_16x16x32_bf16 v[248:251], a[184:187], v[48:51], v[248:251]
 v_exp_f32 v38, v38
 v_mfma_f32_16x16x32_bf16 v[248:251], a[216:219], v[52:55], v[248:251]
 s_mov_b32 s59, 4096
 ds_read_b64_tr_b16 a[176:177], v8 offset:33920
 ds_read_b64_tr_b16 a[178:179], v8 offset:34432
 v_exp_f32 v39, v39
 v_mfma_f32_16x16x32_bf16 v[252:255], a[188:191], v[48:51], v[252:255]
 s_add_u32 m0, s45, 17408
 v_cvt_pk_bf16_f32 v46, v36, v37
 v_cvt_pk_bf16_f32 v47, v38, v39
 v_mfma_f32_16x16x32_bf16 v[252:255], a[220:223], v[52:55], v[252:255]
 buffer_load_dwordx4 v1, s[28:31], s59 offen nt lds
 v_mfma_f32_16x16x32_bf16 v[32:35], a[128:131], a[16:19], 0
 ds_read_b64_tr_b16 a[208:209], v8 offset:50816
 ds_read_b64_tr_b16 a[210:211], v8 offset:51328
 v_mfma_f32_16x16x32_bf16 v[32:35], a[132:135], a[20:23], v[32:35]
 v_exp_f32 v24, v24
 v_mfma_f32_16x16x32_bf16 v[32:35], a[136:139], a[24:27], v[32:35]
 v_mfma_f32_16x16x32_bf16 v[32:35], a[140:143], a[28:31], v[32:35]
 ds_read_b64_tr_b16 a[180:181], v8 offset:33952
 ds_read_b64_tr_b16 a[182:183], v8 offset:34464
 v_exp_f32 v25, v25
 v_mfma_f32_16x16x32_bf16 v[36:39], a[156:159], a[28:31], 0
 v_exp_f32 v26, v26
 v_mfma_f32_16x16x32_bf16 v[36:39], a[152:155], a[24:27], v[36:39]
 v_exp_f32 v27, v27
 v_mfma_f32_16x16x32_bf16 v[36:39], a[148:151], a[20:23], v[36:39]
 ds_read_b64_tr_b16 a[212:213], v8 offset:50848
 ds_read_b64_tr_b16 a[214:215], v8 offset:51360
 v_mfma_f32_16x16x32_bf16 v[36:39], a[144:147], a[16:19], v[36:39]
 s_waitcnt lgkmcnt(15)
 v_mfma_f32_16x16x32_bf16 v[64:67], a[160:163], v[40:43], v[64:67]
 v_exp_f32 v28, v28
 v_mfma_f32_16x16x32_bf16 v[64:67], a[192:195], v[44:47], v[64:67]
 ds_read_b64_tr_b16 a[184:185], v8 offset:33984
 ds_read_b64_tr_b16 a[186:187], v8 offset:34496
 v_mfma_f32_16x16x32_bf16 v[68:71], a[164:167], v[40:43], v[68:71]
 v_cvt_pk_bf16_f32 v48, v24, v25
 v_cvt_pk_bf16_f32 v49, v26, v27
 v_mfma_f32_16x16x32_bf16 v[68:71], a[196:199], v[44:47], v[68:71]
 s_waitcnt lgkmcnt(10)
 v_exp_f32 v29, v29
 v_mfma_f32_16x16x32_bf16 v[72:75], a[168:171], v[40:43], v[72:75]
 ds_read_b64_tr_b16 a[216:217], v8 offset:50880
 ds_read_b64_tr_b16 a[218:219], v8 offset:51392
 v_mfma_f32_16x16x32_bf16 v[72:75], a[200:203], v[44:47], v[72:75]
 v_mfma_f32_16x16x32_bf16 v[76:79], a[172:175], v[40:43], v[76:79]
 v_exp_f32 v30, v30
 v_mfma_f32_16x16x32_bf16 v[76:79], a[204:207], v[44:47], v[76:79]
 ds_read_b64_tr_b16 a[188:189], v8 offset:34016
 ds_read_b64_tr_b16 a[190:191], v8 offset:34528
 v_mfma_f32_16x16x32_bf16 v[24:27], a[96:99], a[32:35], 0
 v_exp_f32 v31, v31
 v_mfma_f32_16x16x32_bf16 v[24:27], a[100:103], a[36:39], v[24:27]
 v_cvt_pk_bf16_f32 v50, v28, v29
 v_cvt_pk_bf16_f32 v51, v30, v31
 v_mfma_f32_16x16x32_bf16 v[24:27], a[104:107], a[40:43], v[24:27]
 ds_read_b64_tr_b16 a[220:221], v8 offset:50912
 ds_read_b64_tr_b16 a[222:223], v8 offset:51424
 v_mfma_f32_16x16x32_bf16 v[24:27], a[108:111], a[44:47], v[24:27]
 v_smfmac_f32_16x16x64_bf16 a[224:227], a[236:239], v[40:47], v2
 v_exp_f32 v32, v32
 v_mfma_f32_16x16x32_bf16 v[28:31], a[124:127], a[44:47], 0
 v_exp_f32 v33, v33
 v_mfma_f32_16x16x32_bf16 v[28:31], a[120:123], a[40:43], v[28:31]
 v_mfma_f32_16x16x32_bf16 v[28:31], a[116:119], a[36:39], v[28:31]
 v_exp_f32 v34, v34
 v_mfma_f32_16x16x32_bf16 v[28:31], a[112:115], a[32:35], v[28:31]
 s_waitcnt lgkmcnt(8)
 v_exp_f32 v35, v35
 v_mfma_f32_16x16x32_bf16 v[80:83], a[176:179], v[40:43], v[80:83]
 v_exp_f32 v36, v36
 v_mfma_f32_16x16x32_bf16 v[80:83], a[208:211], v[44:47], v[80:83]
 v_mfma_f32_16x16x32_bf16 v[84:87], a[180:183], v[40:43], v[84:87]
 v_cvt_pk_bf16_f32 v52, v32, v33
 v_cvt_pk_bf16_f32 v53, v34, v35
 v_mfma_f32_16x16x32_bf16 v[84:87], a[212:215], v[44:47], v[84:87]
 s_waitcnt lgkmcnt(0)
 s_barrier
 v_mfma_f32_16x16x32_bf16 v[88:91], a[184:187], v[40:43], v[88:91]
 v_exp_f32 v37, v37
 v_mfma_f32_16x16x32_bf16 v[88:91], a[216:219], v[44:47], v[88:91]
 s_mov_b32 s59, 5120
 v_mfma_f32_16x16x32_bf16 v[92:95], a[188:191], v[40:43], v[92:95]
 s_add_u32 m0, s45, 18496
 v_exp_f32 v38, v38
 v_mfma_f32_16x16x32_bf16 v[92:95], a[220:223], v[44:47], v[92:95]
 buffer_load_dwordx4 v1, s[28:31], s59 offen nt lds
 v_mfma_f32_16x16x32_bf16 v[32:35], a[128:131], a[32:35], 0
 v_exp_f32 v39, v39
 v_mfma_f32_16x16x32_bf16 v[32:35], a[132:135], a[36:39], v[32:35]
 v_cvt_pk_bf16_f32 v54, v36, v37
 v_cvt_pk_bf16_f32 v55, v38, v39
 v_mfma_f32_16x16x32_bf16 v[32:35], a[136:139], a[40:43], v[32:35]
 v_mfma_f32_16x16x32_bf16 v[32:35], a[140:143], a[44:47], v[32:35]
 v_exp_f32 v24, v24
 v_mfma_f32_16x16x32_bf16 v[36:39], a[156:159], a[44:47], 0
 v_exp_f32 v25, v25
 v_mfma_f32_16x16x32_bf16 v[36:39], a[152:155], a[40:43], v[36:39]
 v_exp_f32 v26, v26
 v_mfma_f32_16x16x32_bf16 v[36:39], a[148:151], a[36:39], v[36:39]
 s_add_u32 m0, s39, 33792
 v_mfma_f32_16x16x32_bf16 v[36:39], a[144:147], a[32:35], v[36:39]
 buffer_load_dwordx4 v1, s[20:23], s33 offen nt lds
 v_mfma_f32_16x16x32_bf16 v[96:99], a[160:163], v[48:51], v[96:99]
 v_exp_f32 v27, v27
 v_mfma_f32_16x16x32_bf16 v[96:99], a[192:195], v[52:55], v[96:99]
 v_exp_f32 v28, v28
 v_mfma_f32_16x16x32_bf16 v[100:103], a[164:167], v[48:51], v[100:103]
 v_mfma_f32_16x16x32_bf16 v[100:103], a[196:199], v[52:55], v[100:103]
 v_cvt_pk_bf16_f32 v40, v24, v25
 v_cvt_pk_bf16_f32 v41, v26, v27
 v_mfma_f32_16x16x32_bf16 v[104:107], a[168:171], v[48:51], v[104:107]
 v_exp_f32 v29, v29
 v_mfma_f32_16x16x32_bf16 v[104:107], a[200:203], v[52:55], v[104:107]
 v_exp_f32 v30, v30
 v_mfma_f32_16x16x32_bf16 v[108:111], a[172:175], v[48:51], v[108:111]
 v_mfma_f32_16x16x32_bf16 v[108:111], a[204:207], v[52:55], v[108:111]
 v_exp_f32 v31, v31
 v_mfma_f32_16x16x32_bf16 v[24:27], a[96:99], a[48:51], 0
 v_cvt_pk_bf16_f32 v42, v28, v29
 v_cvt_pk_bf16_f32 v43, v30, v31
 v_mfma_f32_16x16x32_bf16 v[24:27], a[100:103], a[52:55], v[24:27]
 v_exp_f32 v32, v32
 v_mfma_f32_16x16x32_bf16 v[24:27], a[104:107], a[56:59], v[24:27]
 v_exp_f32 v33, v33
 v_mfma_f32_16x16x32_bf16 v[24:27], a[108:111], a[60:63], v[24:27]
 v_exp_f32 v34, v34
 v_smfmac_f32_16x16x64_bf16 a[224:227], a[240:243], v[48:55], v2
 v_mfma_f32_16x16x32_bf16 v[28:31], a[124:127], a[60:63], 0
 v_exp_f32 v35, v35
 v_mfma_f32_16x16x32_bf16 v[28:31], a[120:123], a[56:59], v[28:31]
 v_exp_f32 v36, v36
 v_mfma_f32_16x16x32_bf16 v[28:31], a[116:119], a[52:55], v[28:31]
 s_add_u32 m0, s39, 33824
 v_mfma_f32_16x16x32_bf16 v[28:31], a[112:115], a[48:51], v[28:31]
 buffer_load_dwordx4 v1, s[20:23], s33 offen offset:1024 nt lds
 v_mfma_f32_16x16x32_bf16 v[112:115], a[176:179], v[48:51], v[112:115]
 v_cvt_pk_bf16_f32 v44, v32, v33
 v_cvt_pk_bf16_f32 v45, v34, v35
 v_mfma_f32_16x16x32_bf16 v[112:115], a[208:211], v[52:55], v[112:115]
 v_exp_f32 v37, v37
 v_mfma_f32_16x16x32_bf16 v[116:119], a[180:183], v[48:51], v[116:119]
 v_mfma_f32_16x16x32_bf16 v[116:119], a[212:215], v[52:55], v[116:119]
 v_exp_f32 v38, v38
 v_mfma_f32_16x16x32_bf16 v[120:123], a[184:187], v[48:51], v[120:123]
 v_exp_f32 v39, v39
 v_mfma_f32_16x16x32_bf16 v[120:123], a[216:219], v[52:55], v[120:123]
 v_mfma_f32_16x16x32_bf16 v[124:127], a[188:191], v[48:51], v[124:127]
 v_cvt_pk_bf16_f32 v46, v36, v37
 v_cvt_pk_bf16_f32 v47, v38, v39
 v_mfma_f32_16x16x32_bf16 v[124:127], a[220:223], v[52:55], v[124:127]
 v_mfma_f32_16x16x32_bf16 v[32:35], a[128:131], a[48:51], 0
 v_exp_f32 v24, v24
 v_mfma_f32_16x16x32_bf16 v[32:35], a[132:135], a[52:55], v[32:35]
 v_mfma_f32_16x16x32_bf16 v[32:35], a[136:139], a[56:59], v[32:35]
 v_exp_f32 v25, v25
 v_mfma_f32_16x16x32_bf16 v[32:35], a[140:143], a[60:63], v[32:35]
 v_exp_f32 v26, v26
 v_mfma_f32_16x16x32_bf16 v[36:39], a[156:159], a[60:63], 0
 v_mfma_f32_16x16x32_bf16 v[36:39], a[152:155], a[56:59], v[36:39]
 v_exp_f32 v27, v27
 v_mfma_f32_16x16x32_bf16 v[36:39], a[148:151], a[52:55], v[36:39]
 v_exp_f32 v28, v28
 v_mfma_f32_16x16x32_bf16 v[36:39], a[144:147], a[48:51], v[36:39]
 v_mfma_f32_16x16x32_bf16 v[128:131], a[160:163], v[40:43], v[128:131]
 s_add_u32 m0, s39, 33856
 v_cvt_pk_bf16_f32 v48, v24, v25
 v_cvt_pk_bf16_f32 v49, v26, v27
 v_mfma_f32_16x16x32_bf16 v[128:131], a[192:195], v[44:47], v[128:131]
 buffer_load_dwordx4 v1, s[20:23], s33 offen offset:2048 nt lds
 v_mfma_f32_16x16x32_bf16 v[132:135], a[164:167], v[40:43], v[132:135]
 v_exp_f32 v29, v29
 v_mfma_f32_16x16x32_bf16 v[132:135], a[196:199], v[44:47], v[132:135]
 v_exp_f32 v30, v30
 v_mfma_f32_16x16x32_bf16 v[136:139], a[168:171], v[40:43], v[136:139]
 v_mfma_f32_16x16x32_bf16 v[136:139], a[200:203], v[44:47], v[136:139]
 v_exp_f32 v31, v31
 v_mfma_f32_16x16x32_bf16 v[140:143], a[172:175], v[40:43], v[140:143]
 v_mfma_f32_16x16x32_bf16 v[140:143], a[204:207], v[44:47], v[140:143]
 v_cvt_pk_bf16_f32 v50, v28, v29
 v_cvt_pk_bf16_f32 v51, v30, v31
 v_mfma_f32_16x16x32_bf16 v[24:27], a[96:99], a[64:67], 0
 v_mfma_f32_16x16x32_bf16 v[24:27], a[100:103], a[68:71], v[24:27]
 v_exp_f32 v32, v32
 v_mfma_f32_16x16x32_bf16 v[24:27], a[104:107], a[72:75], v[24:27]
 v_exp_f32 v33, v33
 v_mfma_f32_16x16x32_bf16 v[24:27], a[108:111], a[76:79], v[24:27]
 v_exp_f32 v34, v34
 v_smfmac_f32_16x16x64_bf16 a[228:231], a[236:239], v[40:47], v2
 v_mfma_f32_16x16x32_bf16 v[28:31], a[124:127], a[76:79], 0
 v_exp_f32 v35, v35
 v_mfma_f32_16x16x32_bf16 v[28:31], a[120:123], a[72:75], v[28:31]
 v_mfma_f32_16x16x32_bf16 v[28:31], a[116:119], a[68:71], v[28:31]
 v_exp_f32 v36, v36
 v_mfma_f32_16x16x32_bf16 v[28:31], a[112:115], a[64:67], v[28:31]
 v_mfma_f32_16x16x32_bf16 v[144:147], a[176:179], v[40:43], v[144:147]
 s_add_u32 m0, s39, 33888
 v_cvt_pk_bf16_f32 v52, v32, v33
 v_cvt_pk_bf16_f32 v53, v34, v35
 v_mfma_f32_16x16x32_bf16 v[144:147], a[208:211], v[44:47], v[144:147]
 buffer_load_dwordx4 v1, s[20:23], s33 offen offset:3072 nt lds
 v_mfma_f32_16x16x32_bf16 v[148:151], a[180:183], v[40:43], v[148:151]
 s_add_u32 s33, s33, 8192
 v_exp_f32 v37, v37
 v_mfma_f32_16x16x32_bf16 v[148:151], a[212:215], v[44:47], v[148:151]
 v_exp_f32 v38, v38
 v_mfma_f32_16x16x32_bf16 v[152:155], a[184:187], v[40:43], v[152:155]
 v_mfma_f32_16x16x32_bf16 v[152:155], a[216:219], v[44:47], v[152:155]
 s_mov_b32 s59, 6144
 v_exp_f32 v39, v39
 v_mfma_f32_16x16x32_bf16 v[156:159], a[188:191], v[40:43], v[156:159]
 s_add_u32 m0, s45, 19584
 v_cvt_pk_bf16_f32 v54, v36, v37
 v_cvt_pk_bf16_f32 v55, v38, v39
 v_mfma_f32_16x16x32_bf16 v[156:159], a[220:223], v[44:47], v[156:159]
 buffer_load_dwordx4 v1, s[28:31], s59 offen nt lds
 v_mfma_f32_16x16x32_bf16 v[32:35], a[128:131], a[64:67], 0
 v_mfma_f32_16x16x32_bf16 v[32:35], a[132:135], a[68:71], v[32:35]
 v_exp_f32 v24, v24
 v_mfma_f32_16x16x32_bf16 v[32:35], a[136:139], a[72:75], v[32:35]
 v_exp_f32 v25, v25
 v_mfma_f32_16x16x32_bf16 v[32:35], a[140:143], a[76:79], v[32:35]
 v_exp_f32 v26, v26
 v_mfma_f32_16x16x32_bf16 v[36:39], a[156:159], a[76:79], 0
 v_mfma_f32_16x16x32_bf16 v[36:39], a[152:155], a[72:75], v[36:39]
 v_exp_f32 v27, v27
 v_mfma_f32_16x16x32_bf16 v[36:39], a[148:151], a[68:71], v[36:39]
 v_exp_f32 v28, v28
 v_mfma_f32_16x16x32_bf16 v[36:39], a[144:147], a[64:67], v[36:39]
 v_mfma_f32_16x16x32_bf16 v[160:163], a[160:163], v[48:51], v[160:163]
 v_cvt_pk_bf16_f32 v40, v24, v25
 v_cvt_pk_bf16_f32 v41, v26, v27
 v_mfma_f32_16x16x32_bf16 v[160:163], a[192:195], v[52:55], v[160:163]
 v_mfma_f32_16x16x32_bf16 v[164:167], a[164:167], v[48:51], v[164:167]
 s_add_u32 m0, s39, 50688
 v_exp_f32 v29, v29
 v_mfma_f32_16x16x32_bf16 v[164:167], a[196:199], v[52:55], v[164:167]
 buffer_load_dwordx4 v1, s[20:23], s33 offen nt lds
 v_mfma_f32_16x16x32_bf16 v[168:171], a[168:171], v[48:51], v[168:171]
 v_exp_f32 v30, v30
 v_mfma_f32_16x16x32_bf16 v[168:171], a[200:203], v[52:55], v[168:171]
 v_exp_f32 v31, v31
 v_mfma_f32_16x16x32_bf16 v[172:175], a[172:175], v[48:51], v[172:175]
 v_mfma_f32_16x16x32_bf16 v[172:175], a[204:207], v[52:55], v[172:175]
 v_cvt_pk_bf16_f32 v42, v28, v29
 v_cvt_pk_bf16_f32 v43, v30, v31
 v_mfma_f32_16x16x32_bf16 v[24:27], a[96:99], a[80:83], 0
 v_mfma_f32_16x16x32_bf16 v[24:27], a[100:103], a[84:87], v[24:27]
 v_exp_f32 v32, v32
 v_mfma_f32_16x16x32_bf16 v[24:27], a[104:107], a[88:91], v[24:27]
 v_mfma_f32_16x16x32_bf16 v[24:27], a[108:111], a[92:95], v[24:27]
 v_exp_f32 v33, v33
 v_smfmac_f32_16x16x64_bf16 a[228:231], a[240:243], v[48:55], v2
 v_mfma_f32_16x16x32_bf16 v[28:31], a[124:127], a[92:95], 0
 v_exp_f32 v34, v34
 v_mfma_f32_16x16x32_bf16 v[28:31], a[120:123], a[88:91], v[28:31]
 v_exp_f32 v35, v35
 v_mfma_f32_16x16x32_bf16 v[28:31], a[116:119], a[84:87], v[28:31]
 v_exp_f32 v36, v36
 v_mfma_f32_16x16x32_bf16 v[28:31], a[112:115], a[80:83], v[28:31]
 s_waitcnt vmcnt(9)
 s_barrier
 v_mfma_f32_16x16x32_bf16 v[176:179], a[176:179], v[48:51], v[176:179]
 v_cvt_pk_bf16_f32 v44, v32, v33
 v_cvt_pk_bf16_f32 v45, v34, v35
 v_mfma_f32_16x16x32_bf16 v[176:179], a[208:211], v[52:55], v[176:179]
 v_exp_f32 v37, v37
 v_mfma_f32_16x16x32_bf16 v[180:183], a[180:183], v[48:51], v[180:183]
 s_add_u32 m0, s39, 50720
 ds_read_b128 a[96:99], v7 offset:0
 ds_read_b128 a[100:103], v7 offset:64
 v_mfma_f32_16x16x32_bf16 v[180:183], a[212:215], v[52:55], v[180:183]
 buffer_load_dwordx4 v1, s[20:23], s33 offen offset:1024 nt lds
 v_mfma_f32_16x16x32_bf16 v[184:187], a[184:187], v[48:51], v[184:187]
 v_exp_f32 v38, v38
 v_mfma_f32_16x16x32_bf16 v[184:187], a[216:219], v[52:55], v[184:187]
 v_exp_f32 v39, v39
 v_mfma_f32_16x16x32_bf16 v[188:191], a[188:191], v[48:51], v[188:191]
 ds_read_b128 a[104:107], v7 offset:128
 ds_read_b128 a[108:111], v7 offset:192
 v_mfma_f32_16x16x32_bf16 v[188:191], a[220:223], v[52:55], v[188:191]
 v_cvt_pk_bf16_f32 v46, v36, v37
 v_cvt_pk_bf16_f32 v47, v38, v39
 v_mfma_f32_16x16x32_bf16 v[32:35], a[128:131], a[80:83], 0
 v_mfma_f32_16x16x32_bf16 v[32:35], a[132:135], a[84:87], v[32:35]
 v_exp_f32 v24, v24
 v_mfma_f32_16x16x32_bf16 v[32:35], a[136:139], a[88:91], v[32:35]
 ds_read_b128 a[124:127], v7 offset:704
 ds_read_b128 a[120:123], v7 offset:640
 v_mfma_f32_16x16x32_bf16 v[32:35], a[140:143], a[92:95], v[32:35]
 v_exp_f32 v25, v25
 v_mfma_f32_16x16x32_bf16 v[36:39], a[156:159], a[92:95], 0
 v_exp_f32 v26, v26
 v_mfma_f32_16x16x32_bf16 v[36:39], a[152:155], a[88:91], v[36:39]
 v_exp_f32 v27, v27
 v_mfma_f32_16x16x32_bf16 v[36:39], a[148:151], a[84:87], v[36:39]
 ds_read_b128 a[116:119], v7 offset:576
 ds_read_b128 a[112:115], v7 offset:512
 v_mfma_f32_16x16x32_bf16 v[36:39], a[144:147], a[80:83], v[36:39]
 v_exp_f32 v28, v28
 v_mfma_f32_16x16x32_bf16 v[192:195], a[160:163], v[40:43], v[192:195]
 v_mfma_f32_16x16x32_bf16 v[192:195], a[192:195], v[44:47], v[192:195]
 v_cvt_pk_bf16_f32 v48, v24, v25
 v_cvt_pk_bf16_f32 v49, v26, v27
 v_mfma_f32_16x16x32_bf16 v[196:199], a[164:167], v[40:43], v[196:199]
 v_exp_f32 v29, v29
 v_mfma_f32_16x16x32_bf16 v[196:199], a[196:199], v[44:47], v[196:199]
 ds_read_b128 a[128:131], v7 offset:16896
 ds_read_b128 a[132:135], v7 offset:16960
 v_mfma_f32_16x16x32_bf16 v[200:203], a[168:171], v[40:43], v[200:203]
 s_add_u32 m0, s39, 50752
 v_exp_f32 v30, v30
 v_mfma_f32_16x16x32_bf16 v[200:203], a[200:203], v[44:47], v[200:203]
 buffer_load_dwordx4 v1, s[20:23], s33 offen offset:2048 nt lds
 v_mfma_f32_16x16x32_bf16 v[204:207], a[172:175], v[40:43], v[204:207]
 v_exp_f32 v31, v31
 v_mfma_f32_16x16x32_bf16 v[204:207], a[204:207], v[44:47], v[204:207]
 s_waitcnt lgkmcnt(6)
 ds_read_b128 a[136:139], v7 offset:17024
 ds_read_b128 a[140:143], v7 offset:17088
 v_mfma_f32_16x16x32_bf16 v[24:27], a[96:99], a[0:3], 0
 v_cvt_pk_bf16_f32 v50, v28, v29
 v_cvt_pk_bf16_f32 v51, v30, v31
 v_mfma_f32_16x16x32_bf16 v[24:27], a[100:103], a[4:7], v[24:27]
 v_exp_f32 v32, v32
 v_mfma_f32_16x16x32_bf16 v[24:27], a[104:107], a[8:11], v[24:27]
 v_exp_f32 v33, v33
 v_mfma_f32_16x16x32_bf16 v[24:27], a[108:111], a[12:15], v[24:27]
 s_waitcnt lgkmcnt(4)
 ds_read_b128 a[156:159], v7 offset:17600
 ds_read_b128 a[152:155], v7 offset:17536
 v_smfmac_f32_16x16x64_bf16 a[232:235], a[236:239], v[40:47], v2
 v_mfma_f32_16x16x32_bf16 v[28:31], a[124:127], a[12:15], 0
 v_exp_f32 v34, v34
 v_mfma_f32_16x16x32_bf16 v[28:31], a[120:123], a[8:11], v[28:31]
 v_exp_f32 v35, v35
 v_mfma_f32_16x16x32_bf16 v[28:31], a[116:119], a[4:7], v[28:31]
 ds_read_b128 a[148:151], v7 offset:17472
 ds_read_b128 a[144:147], v7 offset:17408
 v_mfma_f32_16x16x32_bf16 v[28:31], a[112:115], a[0:3], v[28:31]
 v_exp_f32 v36, v36
 v_mfma_f32_16x16x32_bf16 v[208:211], a[176:179], v[40:43], v[208:211]
 v_cvt_pk_bf16_f32 v52, v32, v33
 v_cvt_pk_bf16_f32 v53, v34, v35
 v_mfma_f32_16x16x32_bf16 v[208:211], a[208:211], v[44:47], v[208:211]
 v_exp_f32 v37, v37
 v_mfma_f32_16x16x32_bf16 v[212:215], a[180:183], v[40:43], v[212:215]
 s_add_u32 m0, s39, 50784
 v_exp_f32 v38, v38
 v_mfma_f32_16x16x32_bf16 v[212:215], a[212:215], v[44:47], v[212:215]
 buffer_load_dwordx4 v1, s[20:23], s33 offen offset:3072 nt lds
 v_mfma_f32_16x16x32_bf16 v[216:219], a[184:187], v[40:43], v[216:219]
 s_add_u32 s33, s33, 8192
 v_exp_f32 v39, v39
 v_mfma_f32_16x16x32_bf16 v[216:219], a[216:219], v[44:47], v[216:219]
 s_mov_b32 s59, 7168
 v_mfma_f32_16x16x32_bf16 v[220:223], a[188:191], v[40:43], v[220:223]
 s_add_u32 m0, s45, 20672
 v_cvt_pk_bf16_f32 v54, v36, v37
 v_cvt_pk_bf16_f32 v55, v38, v39
 v_mfma_f32_16x16x32_bf16 v[220:223], a[220:223], v[44:47], v[220:223]
 s_waitcnt lgkmcnt(4)
 buffer_load_dwordx4 v1, s[28:31], s59 offen nt lds
 v_mfma_f32_16x16x32_bf16 v[32:35], a[128:131], a[0:3], 0
 v_exp_f32 v24, v24
 v_mfma_f32_16x16x32_bf16 v[32:35], a[132:135], a[4:7], v[32:35]
 v_mfma_f32_16x16x32_bf16 v[32:35], a[136:139], a[8:11], v[32:35]
 v_exp_f32 v25, v25
 v_mfma_f32_16x16x32_bf16 v[32:35], a[140:143], a[12:15], v[32:35]
 s_waitcnt lgkmcnt(0)
 v_exp_f32 v26, v26
 v_mfma_f32_16x16x32_bf16 v[36:39], a[156:159], a[12:15], 0
 v_mfma_f32_16x16x32_bf16 v[36:39], a[152:155], a[8:11], v[36:39]
 v_exp_f32 v27, v27
 v_mfma_f32_16x16x32_bf16 v[36:39], a[148:151], a[4:7], v[36:39]
 v_exp_f32 v28, v28
 v_mfma_f32_16x16x32_bf16 v[36:39], a[144:147], a[0:3], v[36:39]
 v_cvt_pk_bf16_f32 v40, v24, v25
 v_cvt_pk_bf16_f32 v41, v26, v27
 v_mfma_f32_16x16x32_bf16 v[224:227], a[160:163], v[48:51], v[224:227]
 v_exp_f32 v29, v29
 v_mfma_f32_16x16x32_bf16 v[224:227], a[192:195], v[52:55], v[224:227]
 v_exp_f32 v30, v30
 v_mfma_f32_16x16x32_bf16 v[228:231], a[164:167], v[48:51], v[228:231]
 ds_read_b64_tr_b16 a[160:161], v8 offset:0
 ds_read_b64_tr_b16 a[162:163], v8 offset:512
 v_mfma_f32_16x16x32_bf16 v[228:231], a[196:199], v[52:55], v[228:231]
 v_exp_f32 v31, v31
 v_mfma_f32_16x16x32_bf16 v[232:235], a[168:171], v[48:51], v[232:235]
 ds_read_b64_tr_b16 a[192:193], v8 offset:16896
 ds_read_b64_tr_b16 a[194:195], v8 offset:17408
 v_mfma_f32_16x16x32_bf16 v[232:235], a[200:203], v[52:55], v[232:235]
 v_cvt_pk_bf16_f32 v42, v28, v29
 v_cvt_pk_bf16_f32 v43, v30, v31
 v_mfma_f32_16x16x32_bf16 v[236:239], a[172:175], v[48:51], v[236:239]
 v_exp_f32 v32, v32
 v_mfma_f32_16x16x32_bf16 v[236:239], a[204:207], v[52:55], v[236:239]
 ds_read_b64_tr_b16 a[164:165], v8 offset:32
 ds_read_b64_tr_b16 a[166:167], v8 offset:544
 v_mfma_f32_16x16x32_bf16 v[24:27], a[96:99], a[16:19], 0
 v_exp_f32 v33, v33
 v_mfma_f32_16x16x32_bf16 v[24:27], a[100:103], a[20:23], v[24:27]
 ds_read_b64_tr_b16 a[196:197], v8 offset:16928
 ds_read_b64_tr_b16 a[198:199], v8 offset:17440
 v_mfma_f32_16x16x32_bf16 v[24:27], a[104:107], a[24:27], v[24:27]
 v_exp_f32 v34, v34
 v_mfma_f32_16x16x32_bf16 v[24:27], a[108:111], a[28:31], v[24:27]
 ds_read_b64_tr_b16 a[168:169], v8 offset:64
 ds_read_b64_tr_b16 a[170:171], v8 offset:576
 v_smfmac_f32_16x16x64_bf16 a[232:235], a[240:243], v[48:55], v2
 v_mfma_f32_16x16x32_bf16 v[28:31], a[124:127], a[28:31], 0
 ds_read_b64_tr_b16 a[200:201], v8 offset:16960
 ds_read_b64_tr_b16 a[202:203], v8 offset:17472
 v_mfma_f32_16x16x32_bf16 v[28:31], a[120:123], a[24:27], v[28:31]
 v_exp_f32 v35, v35
 v_mfma_f32_16x16x32_bf16 v[28:31], a[116:119], a[20:23], v[28:31]
 v_exp_f32 v36, v36
 v_mfma_f32_16x16x32_bf16 v[28:31], a[112:115], a[16:19], v[28:31]
 ds_read_b64_tr_b16 a[172:173], v8 offset:96
 ds_read_b64_tr_b16 a[174:175], v8 offset:608
 v_mfma_f32_16x16x32_bf16 v[240:243], a[176:179], v[48:51], v[240:243]
 v_cvt_pk_bf16_f32 v44, v32, v33
 v_cvt_pk_bf16_f32 v45, v34, v35
 v_mfma_f32_16x16x32_bf16 v[240:243], a[208:211], v[52:55], v[240:243]
 ds_read_b64_tr_b16 a[204:205], v8 offset:16992
 ds_read_b64_tr_b16 a[206:207], v8 offset:17504
 v_mfma_f32_16x16x32_bf16 v[244:247], a[180:183], v[48:51], v[244:247]
 v_exp_f32 v37, v37
 v_mfma_f32_16x16x32_bf16 v[244:247], a[212:215], v[52:55], v[244:247]
 v_exp_f32 v38, v38
 v_mfma_f32_16x16x32_bf16 v[248:251], a[184:187], v[48:51], v[248:251]
 v_exp_f32 v39, v39
 v_mfma_f32_16x16x32_bf16 v[248:251], a[216:219], v[52:55], v[248:251]
 s_mov_b32 s59, 8192
 ds_read_b64_tr_b16 a[176:177], v8 offset:128
 ds_read_b64_tr_b16 a[178:179], v8 offset:640
 v_mfma_f32_16x16x32_bf16 v[252:255], a[188:191], v[48:51], v[252:255]
 s_add_u32 m0, s45, 4352
 v_cvt_pk_bf16_f32 v46, v36, v37
 v_cvt_pk_bf16_f32 v47, v38, v39
 v_mfma_f32_16x16x32_bf16 v[252:255], a[220:223], v[52:55], v[252:255]
L_pg0_3:
 s_cbranch_execz L_pg0_7
 buffer_load_dwordx4 v1, s[28:31], s59 offen nt lds
 v_mfma_f32_16x16x32_bf16 v[32:35], a[128:131], a[16:19], 0
 ds_read_b64_tr_b16 a[208:209], v8 offset:17024
 ds_read_b64_tr_b16 a[210:211], v8 offset:17536
 v_mfma_f32_16x16x32_bf16 v[32:35], a[132:135], a[20:23], v[32:35]
 v_exp_f32 v24, v24
 v_mfma_f32_16x16x32_bf16 v[32:35], a[136:139], a[24:27], v[32:35]
 v_exp_f32 v25, v25
 v_mfma_f32_16x16x32_bf16 v[32:35], a[140:143], a[28:31], v[32:35]
 ds_read_b64_tr_b16 a[180:181], v8 offset:160
 ds_read_b64_tr_b16 a[182:183], v8 offset:672
 v_mfma_f32_16x16x32_bf16 v[36:39], a[156:159], a[28:31], 0
 v_exp_f32 v26, v26
 v_mfma_f32_16x16x32_bf16 v[36:39], a[152:155], a[24:27], v[36:39]
 v_exp_f32 v27, v27
 v_mfma_f32_16x16x32_bf16 v[36:39], a[148:151], a[20:23], v[36:39]
 ds_read_b64_tr_b16 a[212:213], v8 offset:17056
 ds_read_b64_tr_b16 a[214:215], v8 offset:17568
 v_mfma_f32_16x16x32_bf16 v[36:39], a[144:147], a[16:19], v[36:39]
 s_waitcnt lgkmcnt(15)
 v_exp_f32 v28, v28
 v_mfma_f32_16x16x32_bf16 v[64:67], a[160:163], v[40:43], v[64:67]
 v_cvt_pk_bf16_f32 v48, v24, v25
 v_cvt_pk_bf16_f32 v49, v26, v27
 v_mfma_f32_16x16x32_bf16 v[64:67], a[192:195], v[44:47], v[64:67]
 ds_read_b64_tr_b16 a[184:185], v8 offset:192
 ds_read_b64_tr_b16 a[186:187], v8 offset:704
 v_mfma_f32_16x16x32_bf16 v[68:71], a[164:167], v[40:43], v[68:71]
 v_exp_f32 v29, v29
 v_mfma_f32_16x16x32_bf16 v[68:71], a[196:199], v[44:47], v[68:71]
 s_waitcnt lgkmcnt(10)
 v_exp_f32 v30, v30
 v_mfma_f32_16x16x32_bf16 v[72:75], a[168:171], v[40:43], v[72:75]
 ds_read_b64_tr_b16 a[216:217], v8 offset:17088
 ds_read_b64_tr_b16 a[218:219], v8 offset:17600
 v_mfma_f32_16x16x32_bf16 v[72:75], a[200:203], v[44:47], v[72:75]
 v_exp_f32 v31, v31
 v_mfma_f32_16x16x32_bf16 v[76:79], a[172:175], v[40:43], v[76:79]
 v_mfma_f32_16x16x32_bf16 v[76:79], a[204:207], v[44:47], v[76:79]
 ds_read_b64_tr_b16 a[188:189], v8 offset:224
 ds_read_b64_tr_b16 a[190:191], v8 offset:736
 v_mfma_f32_16x16x32_bf16 v[24:27], a[96:99], a[32:35], 0
 v_cvt_pk_bf16_f32 v50, v28, v29
 v_cvt_pk_bf16_f32 v51, v30, v31
 v_mfma_f32_16x16x32_bf16 v[24:27], a[100:103], a[36:39], v[24:27]
 v_exp_f32 v32, v32
 v_mfma_f32_16x16x32_bf16 v[24:27], a[104:107], a[40:43], v[24:27]
 ds_read_b64_tr_b16 a[220:221], v8 offset:17120
 ds_read_b64_tr_b16 a[222:223], v8 offset:17632
 v_mfma_f32_16x16x32_bf16 v[24:27], a[108:111], a[44:47], v[24:27]
 v_exp_f32 v33, v33
 v_smfmac_f32_16x16x64_bf16 a[224:227], a[236:239], v[40:47], v2
 v_mfma_f32_16x16x32_bf16 v[28:31], a[124:127], a[44:47], 0
 v_exp_f32 v34, v34
 v_mfma_f32_16x16x32_bf16 v[28:31], a[120:123], a[40:43], v[28:31]
 v_exp_f32 v35, v35
 v_mfma_f32_16x16x32_bf16 v[28:31], a[116:119], a[36:39], v[28:31]
 v_exp_f32 v36, v36
 v_mfma_f32_16x16x32_bf16 v[28:31], a[112:115], a[32:35], v[28:31]
 s_waitcnt lgkmcnt(8)
 v_mfma_f32_16x16x32_bf16 v[80:83], a[176:179], v[40:43], v[80:83]
 v_cvt_pk_bf16_f32 v52, v32, v33
 v_cvt_pk_bf16_f32 v53, v34, v35
 v_mfma_f32_16x16x32_bf16 v[80:83], a[208:211], v[44:47], v[80:83]
 v_mfma_f32_16x16x32_bf16 v[84:87], a[180:183], v[40:43], v[84:87]
 v_exp_f32 v37, v37
 v_mfma_f32_16x16x32_bf16 v[84:87], a[212:215], v[44:47], v[84:87]
 s_waitcnt lgkmcnt(0)
 s_barrier
 v_mfma_f32_16x16x32_bf16 v[88:91], a[184:187], v[40:43], v[88:91]
 v_exp_f32 v38, v38
 v_mfma_f32_16x16x32_bf16 v[88:91], a[216:219], v[44:47], v[88:91]
 s_mov_b32 s59, 9216
 v_exp_f32 v39, v39
 v_mfma_f32_16x16x32_bf16 v[92:95], a[188:191], v[40:43], v[92:95]
 s_add_u32 m0, s45, 5440
 v_cvt_pk_bf16_f32 v54, v36, v37
 v_cvt_pk_bf16_f32 v55, v38, v39
 v_mfma_f32_16x16x32_bf16 v[92:95], a[220:223], v[44:47], v[92:95]
 buffer_load_dwordx4 v1, s[28:31], s59 offen nt lds
 v_mfma_f32_16x16x32_bf16 v[32:35], a[128:131], a[32:35], 0
 v_mfma_f32_16x16x32_bf16 v[32:35], a[132:135], a[36:39], v[32:35]
 v_exp_f32 v24, v24
 v_mfma_f32_16x16x32_bf16 v[32:35], a[136:139], a[40:43], v[32:35]
 v_exp_f32 v25, v25
 v_mfma_f32_16x16x32_bf16 v[32:35], a[140:143], a[44:47], v[32:35]
 v_mfma_f32_16x16x32_bf16 v[36:39], a[156:159], a[44:47], 0
 v_exp_f32 v26, v26
 v_mfma_f32_16x16x32_bf16 v[36:39], a[152:155], a[40:43], v[36:39]
 v_exp_f32 v27, v27
 v_mfma_f32_16x16x32_bf16 v[36:39], a[148:151], a[36:39], v[36:39]
 s_add_u32 m0, s39, 0
 v_exp_f32 v28, v28
 v_mfma_f32_16x16x32_bf16 v[36:39], a[144:147], a[32:35], v[36:39]
 buffer_load_dwordx4 v1, s[20:23], s33 offen nt lds
 v_mfma_f32_16x16x32_bf16 v[96:99], a[160:163], v[48:51], v[96:99]
 v_mfma_f32_16x16x32_bf16 v[96:99], a[192:195], v[52:55], v[96:99]
 v_cvt_pk_bf16_f32 v40, v24, v25
 v_cvt_pk_bf16_f32 v41, v26, v27
 v_mfma_f32_16x16x32_bf16 v[100:103], a[164:167], v[48:51], v[100:103]
 v_mfma_f32_16x16x32_bf16 v[100:103], a[196:199], v[52:55], v[100:103]
 v_exp_f32 v29, v29
 v_mfma_f32_16x16x32_bf16 v[104:107], a[168:171], v[48:51], v[104:107]
 v_exp_f32 v30, v30
 v_mfma_f32_16x16x32_bf16 v[104:107], a[200:203], v[52:55], v[104:107]
 v_mfma_f32_16x16x32_bf16 v[108:111], a[172:175], v[48:51], v[108:111]
 v_exp_f32 v31, v31
 v_mfma_f32_16x16x32_bf16 v[108:111], a[204:207], v[52:55], v[108:111]
 v_mfma_f32_16x16x32_bf16 v[24:27], a[96:99], a[48:51], 0
 v_cvt_pk_bf16_f32 v42, v28, v29
 v_cvt_pk_bf16_f32 v43, v30, v31
 v_mfma_f32_16x16x32_bf16 v[24:27], a[100:103], a[52:55], v[24:27]
 v_exp_f32 v32, v32
 v_mfma_f32_16x16x32_bf16 v[24:27], a[104:107], a[56:59], v[24:27]
 v_exp_f32 v33, v33
 v_mfma_f32_16x16x32_bf16 v[24:27], a[108:111], a[60:63], v[24:27]
 v_exp_f32 v34, v34
 v_smfmac_f32_16x16x64_bf16 a[224:227], a[240:243], v[48:55], v2
 v_mfma_f32_16x16x32_bf16 v[28:31], a[124:127], a[60:63], 0
 v_exp_f32 v35, v35
 v_mfma_f32_16x16x32_bf16 v[28:31], a[120:123], a[56:59], v[28:31]
 v_exp_f32 v36, v36
 v_mfma_f32_16x16x32_bf16 v[28:31], a[116:119], a[52:55], v[28:31]
 s_add_u32 m0, s39, 32
 v_mfma_f32_16x16x32_bf16 v[28:31], a[112:115], a[48:51], v[28:31]
 buffer_load_dwordx4 v1, s[20:23], s33 offen offset:1024 nt lds
 v_mfma_f32_16x16x32_bf16 v[112:115], a[176:179], v[48:51], v[112:115]
 v_cvt_pk_bf16_f32 v44, v32, v33
 v_cvt_pk_bf16_f32 v45, v34, v35
 v_mfma_f32_16x16x32_bf16 v[112:115], a[208:211], v[52:55], v[112:115]
 v_exp_f32 v37, v37
 v_mfma_f32_16x16x32_bf16 v[116:119], a[180:183], v[48:51], v[116:119]
 v_mfma_f32_16x16x32_bf16 v[116:119], a[212:215], v[52:55], v[116:119]
 v_exp_f32 v38, v38
 v_mfma_f32_16x16x32_bf16 v[120:123], a[184:187], v[48:51], v[120:123]
 v_exp_f32 v39, v39
 v_mfma_f32_16x16x32_bf16 v[120:123], a[216:219], v[52:55], v[120:123]
 v_mfma_f32_16x16x32_bf16 v[124:127], a[188:191], v[48:51], v[124:127]
 v_cvt_pk_bf16_f32 v46, v36, v37
 v_cvt_pk_bf16_f32 v47, v38, v39
 v_mfma_f32_16x16x32_bf16 v[124:127], a[220:223], v[52:55], v[124:127]
 v_mfma_f32_16x16x32_bf16 v[32:35], a[128:131], a[48:51], 0
 v_exp_f32 v24, v24
 v_mfma_f32_16x16x32_bf16 v[32:35], a[132:135], a[52:55], v[32:35]
 v_mfma_f32_16x16x32_bf16 v[32:35], a[136:139], a[56:59], v[32:35]
 v_exp_f32 v25, v25
 v_mfma_f32_16x16x32_bf16 v[32:35], a[140:143], a[60:63], v[32:35]
 v_exp_f32 v26, v26
 v_mfma_f32_16x16x32_bf16 v[36:39], a[156:159], a[60:63], 0
 v_mfma_f32_16x16x32_bf16 v[36:39], a[152:155], a[56:59], v[36:39]
 v_exp_f32 v27, v27
 v_mfma_f32_16x16x32_bf16 v[36:39], a[148:151], a[52:55], v[36:39]
 v_exp_f32 v28, v28
 v_mfma_f32_16x16x32_bf16 v[36:39], a[144:147], a[48:51], v[36:39]
 v_mfma_f32_16x16x32_bf16 v[128:131], a[160:163], v[40:43], v[128:131]
 s_add_u32 m0, s39, 64
 v_cvt_pk_bf16_f32 v48, v24, v25
 v_cvt_pk_bf16_f32 v49, v26, v27
 v_mfma_f32_16x16x32_bf16 v[128:131], a[192:195], v[44:47], v[128:131]
 buffer_load_dwordx4 v1, s[20:23], s33 offen offset:2048 nt lds
 v_mfma_f32_16x16x32_bf16 v[132:135], a[164:167], v[40:43], v[132:135]
 v_exp_f32 v29, v29
 v_mfma_f32_16x16x32_bf16 v[132:135], a[196:199], v[44:47], v[132:135]
 v_exp_f32 v30, v30
 v_mfma_f32_16x16x32_bf16 v[136:139], a[168:171], v[40:43], v[136:139]
 v_mfma_f32_16x16x32_bf16 v[136:139], a[200:203], v[44:47], v[136:139]
 v_exp_f32 v31, v31
 v_mfma_f32_16x16x32_bf16 v[140:143], a[172:175], v[40:43], v[140:143]
 v_mfma_f32_16x16x32_bf16 v[140:143], a[204:207], v[44:47], v[140:143]
 v_cvt_pk_bf16_f32 v50, v28, v29
 v_cvt_pk_bf16_f32 v51, v30, v31
 v_mfma_f32_16x16x32_bf16 v[24:27], a[96:99], a[64:67], 0
 v_mfma_f32_16x16x32_bf16 v[24:27], a[100:103], a[68:71], v[24:27]
 v_exp_f32 v32, v32
 v_mfma_f32_16x16x32_bf16 v[24:27], a[104:107], a[72:75], v[24:27]
 v_exp_f32 v33, v33
 v_mfma_f32_16x16x32_bf16 v[24:27], a[108:111], a[76:79], v[24:27]
 v_exp_f32 v34, v34
 v_smfmac_f32_16x16x64_bf16 a[228:231], a[236:239], v[40:47], v2
 v_mfma_f32_16x16x32_bf16 v[28:31], a[124:127], a[76:79], 0
 v_exp_f32 v35, v35
 v_mfma_f32_16x16x32_bf16 v[28:31], a[120:123], a[72:75], v[28:31]
 v_mfma_f32_16x16x32_bf16 v[28:31], a[116:119], a[68:71], v[28:31]
 v_exp_f32 v36, v36
 v_mfma_f32_16x16x32_bf16 v[28:31], a[112:115], a[64:67], v[28:31]
 v_mfma_f32_16x16x32_bf16 v[144:147], a[176:179], v[40:43], v[144:147]
 s_add_u32 m0, s39, 96
 v_cvt_pk_bf16_f32 v52, v32, v33
 v_cvt_pk_bf16_f32 v53, v34, v35
 v_mfma_f32_16x16x32_bf16 v[144:147], a[208:211], v[44:47], v[144:147]
 buffer_load_dwordx4 v1, s[20:23], s33 offen offset:3072 nt lds
 v_mfma_f32_16x16x32_bf16 v[148:151], a[180:183], v[40:43], v[148:151]
 s_add_u32 s33, s33, 8192
 v_exp_f32 v37, v37
 v_mfma_f32_16x16x32_bf16 v[148:151], a[212:215], v[44:47], v[148:151]
 v_exp_f32 v38, v38
 v_mfma_f32_16x16x32_bf16 v[152:155], a[184:187], v[40:43], v[152:155]
 v_mfma_f32_16x16x32_bf16 v[152:155], a[216:219], v[44:47], v[152:155]
 s_mov_b32 s59, 10240
 v_exp_f32 v39, v39
 v_mfma_f32_16x16x32_bf16 v[156:159], a[188:191], v[40:43], v[156:159]
 s_add_u32 m0, s45, 6528
 v_cvt_pk_bf16_f32 v54, v36, v37
 v_cvt_pk_bf16_f32 v55, v38, v39
 v_mfma_f32_16x16x32_bf16 v[156:159], a[220:223], v[44:47], v[156:159]
 buffer_load_dwordx4 v1, s[28:31], s59 offen nt lds
 v_mfma_f32_16x16x32_bf16 v[32:35], a[128:131], a[64:67], 0
 v_mfma_f32_16x16x32_bf16 v[32:35], a[132:135], a[68:71], v[32:35]
 v_exp_f32 v24, v24
 v_mfma_f32_16x16x32_bf16 v[32:35], a[136:139], a[72:75], v[32:35]
 v_exp_f32 v25, v25
 v_mfma_f32_16x16x32_bf16 v[32:35], a[140:143], a[76:79], v[32:35]
 v_exp_f32 v26, v26
 v_mfma_f32_16x16x32_bf16 v[36:39], a[156:159], a[76:79], 0
 v_mfma_f32_16x16x32_bf16 v[36:39], a[152:155], a[72:75], v[36:39]
 v_exp_f32 v27, v27
 v_mfma_f32_16x16x32_bf16 v[36:39], a[148:151], a[68:71], v[36:39]
 v_exp_f32 v28, v28
 v_mfma_f32_16x16x32_bf16 v[36:39], a[144:147], a[64:67], v[36:39]
 v_mfma_f32_16x16x32_bf16 v[160:163], a[160:163], v[48:51], v[160:163]
 v_cvt_pk_bf16_f32 v40, v24, v25
 v_cvt_pk_bf16_f32 v41, v26, v27
 v_mfma_f32_16x16x32_bf16 v[160:163], a[192:195], v[52:55], v[160:163]
 v_mfma_f32_16x16x32_bf16 v[164:167], a[164:167], v[48:51], v[164:167]
 s_add_u32 m0, s39, 16896
 v_exp_f32 v29, v29
 v_mfma_f32_16x16x32_bf16 v[164:167], a[196:199], v[52:55], v[164:167]
 buffer_load_dwordx4 v1, s[20:23], s33 offen nt lds
 v_mfma_f32_16x16x32_bf16 v[168:171], a[168:171], v[48:51], v[168:171]
 v_exp_f32 v30, v30
 v_mfma_f32_16x16x32_bf16 v[168:171], a[200:203], v[52:55], v[168:171]
 v_exp_f32 v31, v31
 v_mfma_f32_16x16x32_bf16 v[172:175], a[172:175], v[48:51], v[172:175]
 v_mfma_f32_16x16x32_bf16 v[172:175], a[204:207], v[52:55], v[172:175]
 v_cvt_pk_bf16_f32 v42, v28, v29
 v_cvt_pk_bf16_f32 v43, v30, v31
 v_mfma_f32_16x16x32_bf16 v[24:27], a[96:99], a[80:83], 0
 v_mfma_f32_16x16x32_bf16 v[24:27], a[100:103], a[84:87], v[24:27]
 v_exp_f32 v32, v32
 v_mfma_f32_16x16x32_bf16 v[24:27], a[104:107], a[88:91], v[24:27]
 v_mfma_f32_16x16x32_bf16 v[24:27], a[108:111], a[92:95], v[24:27]
 v_exp_f32 v33, v33
 v_smfmac_f32_16x16x64_bf16 a[228:231], a[240:243], v[48:55], v2
 v_mfma_f32_16x16x32_bf16 v[28:31], a[124:127], a[92:95], 0
 v_exp_f32 v34, v34
 v_mfma_f32_16x16x32_bf16 v[28:31], a[120:123], a[88:91], v[28:31]
 v_exp_f32 v35, v35
 v_mfma_f32_16x16x32_bf16 v[28:31], a[116:119], a[84:87], v[28:31]
 v_exp_f32 v36, v36
 v_mfma_f32_16x16x32_bf16 v[28:31], a[112:115], a[80:83], v[28:31]
 s_waitcnt vmcnt(9)
 s_barrier
 v_mfma_f32_16x16x32_bf16 v[176:179], a[176:179], v[48:51], v[176:179]
 v_cvt_pk_bf16_f32 v44, v32, v33
 v_cvt_pk_bf16_f32 v45, v34, v35
 v_mfma_f32_16x16x32_bf16 v[176:179], a[208:211], v[52:55], v[176:179]
 v_exp_f32 v37, v37
 v_mfma_f32_16x16x32_bf16 v[180:183], a[180:183], v[48:51], v[180:183]
 s_add_u32 m0, s39, 16928
 ds_read_b128 a[96:99], v7 offset:33792
 ds_read_b128 a[100:103], v7 offset:33856
 v_mfma_f32_16x16x32_bf16 v[180:183], a[212:215], v[52:55], v[180:183]
 buffer_load_dwordx4 v1, s[20:23], s33 offen offset:1024 nt lds
 v_mfma_f32_16x16x32_bf16 v[184:187], a[184:187], v[48:51], v[184:187]
 v_exp_f32 v38, v38
 v_mfma_f32_16x16x32_bf16 v[184:187], a[216:219], v[52:55], v[184:187]
 v_exp_f32 v39, v39
 v_mfma_f32_16x16x32_bf16 v[188:191], a[188:191], v[48:51], v[188:191]
 ds_read_b128 a[104:107], v7 offset:33920
 ds_read_b128 a[108:111], v7 offset:33984
 v_mfma_f32_16x16x32_bf16 v[188:191], a[220:223], v[52:55], v[188:191]
 v_cvt_pk_bf16_f32 v46, v36, v37
 v_cvt_pk_bf16_f32 v47, v38, v39
 v_mfma_f32_16x16x32_bf16 v[32:35], a[128:131], a[80:83], 0
 v_mfma_f32_16x16x32_bf16 v[32:35], a[132:135], a[84:87], v[32:35]
 v_exp_f32 v24, v24
 v_mfma_f32_16x16x32_bf16 v[32:35], a[136:139], a[88:91], v[32:35]
 ds_read_b128 a[124:127], v7 offset:34496
 ds_read_b128 a[120:123], v7 offset:34432
 v_mfma_f32_16x16x32_bf16 v[32:35], a[140:143], a[92:95], v[32:35]
 v_exp_f32 v25, v25
 v_mfma_f32_16x16x32_bf16 v[36:39], a[156:159], a[92:95], 0
 v_exp_f32 v26, v26
 v_mfma_f32_16x16x32_bf16 v[36:39], a[152:155], a[88:91], v[36:39]
 v_exp_f32 v27, v27
 v_mfma_f32_16x16x32_bf16 v[36:39], a[148:151], a[84:87], v[36:39]
 ds_read_b128 a[116:119], v7 offset:34368
 ds_read_b128 a[112:115], v7 offset:34304
 v_mfma_f32_16x16x32_bf16 v[36:39], a[144:147], a[80:83], v[36:39]
 v_exp_f32 v28, v28
 v_mfma_f32_16x16x32_bf16 v[192:195], a[160:163], v[40:43], v[192:195]
 v_mfma_f32_16x16x32_bf16 v[192:195], a[192:195], v[44:47], v[192:195]
 v_cvt_pk_bf16_f32 v48, v24, v25
 v_cvt_pk_bf16_f32 v49, v26, v27
 v_mfma_f32_16x16x32_bf16 v[196:199], a[164:167], v[40:43], v[196:199]
 v_exp_f32 v29, v29
 v_mfma_f32_16x16x32_bf16 v[196:199], a[196:199], v[44:47], v[196:199]
 ds_read_b128 a[128:131], v7 offset:50688
 ds_read_b128 a[132:135], v7 offset:50752
 v_mfma_f32_16x16x32_bf16 v[200:203], a[168:171], v[40:43], v[200:203]
 s_add_u32 m0, s39, 16960
 v_exp_f32 v30, v30
 v_mfma_f32_16x16x32_bf16 v[200:203], a[200:203], v[44:47], v[200:203]
 buffer_load_dwordx4 v1, s[20:23], s33 offen offset:2048 nt lds
 v_mfma_f32_16x16x32_bf16 v[204:207], a[172:175], v[40:43], v[204:207]
 v_exp_f32 v31, v31
 v_mfma_f32_16x16x32_bf16 v[204:207], a[204:207], v[44:47], v[204:207]
 s_waitcnt lgkmcnt(6)
 ds_read_b128 a[136:139], v7 offset:50816
 ds_read_b128 a[140:143], v7 offset:50880
 v_mfma_f32_16x16x32_bf16 v[24:27], a[96:99], a[0:3], 0
 v_cvt_pk_bf16_f32 v50, v28, v29
 v_cvt_pk_bf16_f32 v51, v30, v31
 v_mfma_f32_16x16x32_bf16 v[24:27], a[100:103], a[4:7], v[24:27]
 v_exp_f32 v32, v32
 v_mfma_f32_16x16x32_bf16 v[24:27], a[104:107], a[8:11], v[24:27]
 v_exp_f32 v33, v33
 v_mfma_f32_16x16x32_bf16 v[24:27], a[108:111], a[12:15], v[24:27]
 s_waitcnt lgkmcnt(4)
 ds_read_b128 a[156:159], v7 offset:51392
 ds_read_b128 a[152:155], v7 offset:51328
 v_smfmac_f32_16x16x64_bf16 a[232:235], a[236:239], v[40:47], v2
 v_mfma_f32_16x16x32_bf16 v[28:31], a[124:127], a[12:15], 0
 v_exp_f32 v34, v34
 v_mfma_f32_16x16x32_bf16 v[28:31], a[120:123], a[8:11], v[28:31]
 v_exp_f32 v35, v35
 v_mfma_f32_16x16x32_bf16 v[28:31], a[116:119], a[4:7], v[28:31]
 ds_read_b128 a[148:151], v7 offset:51264
 ds_read_b128 a[144:147], v7 offset:51200
 v_mfma_f32_16x16x32_bf16 v[28:31], a[112:115], a[0:3], v[28:31]
 v_exp_f32 v36, v36
 v_mfma_f32_16x16x32_bf16 v[208:211], a[176:179], v[40:43], v[208:211]
 v_cvt_pk_bf16_f32 v52, v32, v33
 v_cvt_pk_bf16_f32 v53, v34, v35
 v_mfma_f32_16x16x32_bf16 v[208:211], a[208:211], v[44:47], v[208:211]
 v_exp_f32 v37, v37
 v_mfma_f32_16x16x32_bf16 v[212:215], a[180:183], v[40:43], v[212:215]
 s_add_u32 m0, s39, 16992
 v_exp_f32 v38, v38
 v_mfma_f32_16x16x32_bf16 v[212:215], a[212:215], v[44:47], v[212:215]
 buffer_load_dwordx4 v1, s[20:23], s33 offen offset:3072 nt lds
 v_mfma_f32_16x16x32_bf16 v[216:219], a[184:187], v[40:43], v[216:219]
 s_add_u32 s33, s33, 8192
 v_exp_f32 v39, v39
 v_mfma_f32_16x16x32_bf16 v[216:219], a[216:219], v[44:47], v[216:219]
 s_mov_b32 s59, 11264
 v_mfma_f32_16x16x32_bf16 v[220:223], a[188:191], v[40:43], v[220:223]
 s_add_u32 m0, s45, 7616
 v_cvt_pk_bf16_f32 v54, v36, v37
 v_cvt_pk_bf16_f32 v55, v38, v39
 v_mfma_f32_16x16x32_bf16 v[220:223], a[220:223], v[44:47], v[220:223]
 s_waitcnt lgkmcnt(4)
 buffer_load_dwordx4 v1, s[28:31], s59 offen nt lds
 v_mfma_f32_16x16x32_bf16 v[32:35], a[128:131], a[0:3], 0
 v_exp_f32 v24, v24
 v_mfma_f32_16x16x32_bf16 v[32:35], a[132:135], a[4:7], v[32:35]
 v_mfma_f32_16x16x32_bf16 v[32:35], a[136:139], a[8:11], v[32:35]
 v_exp_f32 v25, v25
 v_mfma_f32_16x16x32_bf16 v[32:35], a[140:143], a[12:15], v[32:35]
 s_waitcnt lgkmcnt(0)
 v_exp_f32 v26, v26
 v_mfma_f32_16x16x32_bf16 v[36:39], a[156:159], a[12:15], 0
 v_mfma_f32_16x16x32_bf16 v[36:39], a[152:155], a[8:11], v[36:39]
 v_exp_f32 v27, v27
 v_mfma_f32_16x16x32_bf16 v[36:39], a[148:151], a[4:7], v[36:39]
 v_exp_f32 v28, v28
 v_mfma_f32_16x16x32_bf16 v[36:39], a[144:147], a[0:3], v[36:39]
 v_cvt_pk_bf16_f32 v40, v24, v25
 v_cvt_pk_bf16_f32 v41, v26, v27
 v_mfma_f32_16x16x32_bf16 v[224:227], a[160:163], v[48:51], v[224:227]
 v_exp_f32 v29, v29
 v_mfma_f32_16x16x32_bf16 v[224:227], a[192:195], v[52:55], v[224:227]
 v_exp_f32 v30, v30
 v_mfma_f32_16x16x32_bf16 v[228:231], a[164:167], v[48:51], v[228:231]
 ds_read_b64_tr_b16 a[160:161], v8 offset:33792
 ds_read_b64_tr_b16 a[162:163], v8 offset:34304
 v_mfma_f32_16x16x32_bf16 v[228:231], a[196:199], v[52:55], v[228:231]
 v_exp_f32 v31, v31
 v_mfma_f32_16x16x32_bf16 v[232:235], a[168:171], v[48:51], v[232:235]
 ds_read_b64_tr_b16 a[192:193], v8 offset:50688
 ds_read_b64_tr_b16 a[194:195], v8 offset:51200
 v_mfma_f32_16x16x32_bf16 v[232:235], a[200:203], v[52:55], v[232:235]
 v_cvt_pk_bf16_f32 v42, v28, v29
 v_cvt_pk_bf16_f32 v43, v30, v31
 v_mfma_f32_16x16x32_bf16 v[236:239], a[172:175], v[48:51], v[236:239]
 v_exp_f32 v32, v32
 v_mfma_f32_16x16x32_bf16 v[236:239], a[204:207], v[52:55], v[236:239]
 ds_read_b64_tr_b16 a[164:165], v8 offset:33824
 ds_read_b64_tr_b16 a[166:167], v8 offset:34336
 v_mfma_f32_16x16x32_bf16 v[24:27], a[96:99], a[16:19], 0
 v_exp_f32 v33, v33
 v_mfma_f32_16x16x32_bf16 v[24:27], a[100:103], a[20:23], v[24:27]
 ds_read_b64_tr_b16 a[196:197], v8 offset:50720
 ds_read_b64_tr_b16 a[198:199], v8 offset:51232
 v_mfma_f32_16x16x32_bf16 v[24:27], a[104:107], a[24:27], v[24:27]
 v_exp_f32 v34, v34
 v_mfma_f32_16x16x32_bf16 v[24:27], a[108:111], a[28:31], v[24:27]
 ds_read_b64_tr_b16 a[168:169], v8 offset:33856
 ds_read_b64_tr_b16 a[170:171], v8 offset:34368
 v_smfmac_f32_16x16x64_bf16 a[232:235], a[240:243], v[48:55], v2
 v_mfma_f32_16x16x32_bf16 v[28:31], a[124:127], a[28:31], 0
 ds_read_b64_tr_b16 a[200:201], v8 offset:50752
 ds_read_b64_tr_b16 a[202:203], v8 offset:51264
 v_mfma_f32_16x16x32_bf16 v[28:31], a[120:123], a[24:27], v[28:31]
 v_exp_f32 v35, v35
 v_mfma_f32_16x16x32_bf16 v[28:31], a[116:119], a[20:23], v[28:31]
 v_exp_f32 v36, v36
 v_mfma_f32_16x16x32_bf16 v[28:31], a[112:115], a[16:19], v[28:31]
 ds_read_b64_tr_b16 a[172:173], v8 offset:33888
 ds_read_b64_tr_b16 a[174:175], v8 offset:34400
 v_mfma_f32_16x16x32_bf16 v[240:243], a[176:179], v[48:51], v[240:243]
 v_cvt_pk_bf16_f32 v44, v32, v33
 v_cvt_pk_bf16_f32 v45, v34, v35
 v_mfma_f32_16x16x32_bf16 v[240:243], a[208:211], v[52:55], v[240:243]
 ds_read_b64_tr_b16 a[204:205], v8 offset:50784
 ds_read_b64_tr_b16 a[206:207], v8 offset:51296
 v_mfma_f32_16x16x32_bf16 v[244:247], a[180:183], v[48:51], v[244:247]
 v_exp_f32 v37, v37
 v_mfma_f32_16x16x32_bf16 v[244:247], a[212:215], v[52:55], v[244:247]
 v_exp_f32 v38, v38
 v_mfma_f32_16x16x32_bf16 v[248:251], a[184:187], v[48:51], v[248:251]
 v_exp_f32 v39, v39
 v_mfma_f32_16x16x32_bf16 v[248:251], a[216:219], v[52:55], v[248:251]
 s_mov_b32 s59, 12288
 ds_read_b64_tr_b16 a[176:177], v8 offset:33920
 ds_read_b64_tr_b16 a[178:179], v8 offset:34432
 v_mfma_f32_16x16x32_bf16 v[252:255], a[188:191], v[48:51], v[252:255]
 s_add_u32 m0, s45, 8704
 v_cvt_pk_bf16_f32 v46, v36, v37
 v_cvt_pk_bf16_f32 v47, v38, v39
 v_mfma_f32_16x16x32_bf16 v[252:255], a[220:223], v[52:55], v[252:255]
 buffer_load_dwordx4 v1, s[28:31], s59 offen nt lds
 v_mfma_f32_16x16x32_bf16 v[32:35], a[128:131], a[16:19], 0
 ds_read_b64_tr_b16 a[208:209], v8 offset:50816
 ds_read_b64_tr_b16 a[210:211], v8 offset:51328
 v_mfma_f32_16x16x32_bf16 v[32:35], a[132:135], a[20:23], v[32:35]
 v_exp_f32 v24, v24
 v_mfma_f32_16x16x32_bf16 v[32:35], a[136:139], a[24:27], v[32:35]
 v_exp_f32 v25, v25
 v_mfma_f32_16x16x32_bf16 v[32:35], a[140:143], a[28:31], v[32:35]
 ds_read_b64_tr_b16 a[180:181], v8 offset:33952
 ds_read_b64_tr_b16 a[182:183], v8 offset:34464
 v_mfma_f32_16x16x32_bf16 v[36:39], a[156:159], a[28:31], 0
 v_exp_f32 v26, v26
 v_mfma_f32_16x16x32_bf16 v[36:39], a[152:155], a[24:27], v[36:39]
 v_exp_f32 v27, v27
 v_mfma_f32_16x16x32_bf16 v[36:39], a[148:151], a[20:23], v[36:39]
 ds_read_b64_tr_b16 a[212:213], v8 offset:50848
 ds_read_b64_tr_b16 a[214:215], v8 offset:51360
 v_mfma_f32_16x16x32_bf16 v[36:39], a[144:147], a[16:19], v[36:39]
 s_waitcnt lgkmcnt(15)
 v_exp_f32 v28, v28
 v_mfma_f32_16x16x32_bf16 v[64:67], a[160:163], v[40:43], v[64:67]
 v_cvt_pk_bf16_f32 v48, v24, v25
 v_cvt_pk_bf16_f32 v49, v26, v27
 v_mfma_f32_16x16x32_bf16 v[64:67], a[192:195], v[44:47], v[64:67]
 ds_read_b64_tr_b16 a[184:185], v8 offset:33984
 ds_read_b64_tr_b16 a[186:187], v8 offset:34496
 v_mfma_f32_16x16x32_bf16 v[68:71], a[164:167], v[40:43], v[68:71]
 v_exp_f32 v29, v29
 v_mfma_f32_16x16x32_bf16 v[68:71], a[196:199], v[44:47], v[68:71]
 s_waitcnt lgkmcnt(10)
 v_exp_f32 v30, v30
 v_mfma_f32_16x16x32_bf16 v[72:75], a[168:171], v[40:43], v[72:75]
 ds_read_b64_tr_b16 a[216:217], v8 offset:50880
 ds_read_b64_tr_b16 a[218:219], v8 offset:51392
 v_mfma_f32_16x16x32_bf16 v[72:75], a[200:203], v[44:47], v[72:75]
 v_exp_f32 v31, v31
 v_mfma_f32_16x16x32_bf16 v[76:79], a[172:175], v[40:43], v[76:79]
 v_mfma_f32_16x16x32_bf16 v[76:79], a[204:207], v[44:47], v[76:79]
 ds_read_b64_tr_b16 a[188:189], v8 offset:34016
 ds_read_b64_tr_b16 a[190:191], v8 offset:34528
 v_mfma_f32_16x16x32_bf16 v[24:27], a[96:99], a[32:35], 0
 v_cvt_pk_bf16_f32 v50, v28, v29
 v_cvt_pk_bf16_f32 v51, v30, v31
 v_mfma_f32_16x16x32_bf16 v[24:27], a[100:103], a[36:39], v[24:27]
 v_exp_f32 v32, v32
 v_mfma_f32_16x16x32_bf16 v[24:27], a[104:107], a[40:43], v[24:27]
 ds_read_b64_tr_b16 a[220:221], v8 offset:50912
 ds_read_b64_tr_b16 a[222:223], v8 offset:51424
 v_mfma_f32_16x16x32_bf16 v[24:27], a[108:111], a[44:47], v[24:27]
 v_exp_f32 v33, v33
 v_smfmac_f32_16x16x64_bf16 a[224:227], a[236:239], v[40:47], v2
 v_mfma_f32_16x16x32_bf16 v[28:31], a[124:127], a[44:47], 0
 v_exp_f32 v34, v34
 v_mfma_f32_16x16x32_bf16 v[28:31], a[120:123], a[40:43], v[28:31]
 v_exp_f32 v35, v35
 v_mfma_f32_16x16x32_bf16 v[28:31], a[116:119], a[36:39], v[28:31]
 v_exp_f32 v36, v36
 v_mfma_f32_16x16x32_bf16 v[28:31], a[112:115], a[32:35], v[28:31]
 s_waitcnt lgkmcnt(8)
 v_mfma_f32_16x16x32_bf16 v[80:83], a[176:179], v[40:43], v[80:83]
 v_cvt_pk_bf16_f32 v52, v32, v33
 v_cvt_pk_bf16_f32 v53, v34, v35
 v_mfma_f32_16x16x32_bf16 v[80:83], a[208:211], v[44:47], v[80:83]
 v_mfma_f32_16x16x32_bf16 v[84:87], a[180:183], v[40:43], v[84:87]
 v_exp_f32 v37, v37
 v_mfma_f32_16x16x32_bf16 v[84:87], a[212:215], v[44:47], v[84:87]
 s_waitcnt lgkmcnt(0)
 s_barrier
 v_mfma_f32_16x16x32_bf16 v[88:91], a[184:187], v[40:43], v[88:91]
 v_exp_f32 v38, v38
 v_mfma_f32_16x16x32_bf16 v[88:91], a[216:219], v[44:47], v[88:91]
 s_mov_b32 s59, 13312
 v_exp_f32 v39, v39
 v_mfma_f32_16x16x32_bf16 v[92:95], a[188:191], v[40:43], v[92:95]
 s_add_u32 m0, s45, 9792
 v_cvt_pk_bf16_f32 v54, v36, v37
 v_cvt_pk_bf16_f32 v55, v38, v39
 v_mfma_f32_16x16x32_bf16 v[92:95], a[220:223], v[44:47], v[92:95]
 buffer_load_dwordx4 v1, s[28:31], s59 offen nt lds
 v_mfma_f32_16x16x32_bf16 v[32:35], a[128:131], a[32:35], 0
 v_mfma_f32_16x16x32_bf16 v[32:35], a[132:135], a[36:39], v[32:35]
 v_exp_f32 v24, v24
 v_mfma_f32_16x16x32_bf16 v[32:35], a[136:139], a[40:43], v[32:35]
 v_exp_f32 v25, v25
 v_mfma_f32_16x16x32_bf16 v[32:35], a[140:143], a[44:47], v[32:35]
 v_mfma_f32_16x16x32_bf16 v[36:39], a[156:159], a[44:47], 0
 v_exp_f32 v26, v26
 v_mfma_f32_16x16x32_bf16 v[36:39], a[152:155], a[40:43], v[36:39]
 v_exp_f32 v27, v27
 v_mfma_f32_16x16x32_bf16 v[36:39], a[148:151], a[36:39], v[36:39]
 s_add_u32 m0, s39, 33792
 v_exp_f32 v28, v28
 v_mfma_f32_16x16x32_bf16 v[36:39], a[144:147], a[32:35], v[36:39]
 buffer_load_dwordx4 v1, s[20:23], s33 offen nt lds
 v_mfma_f32_16x16x32_bf16 v[96:99], a[160:163], v[48:51], v[96:99]
 v_mfma_f32_16x16x32_bf16 v[96:99], a[192:195], v[52:55], v[96:99]
 v_cvt_pk_bf16_f32 v40, v24, v25
 v_cvt_pk_bf16_f32 v41, v26, v27
 v_mfma_f32_16x16x32_bf16 v[100:103], a[164:167], v[48:51], v[100:103]
 v_mfma_f32_16x16x32_bf16 v[100:103], a[196:199], v[52:55], v[100:103]
 v_exp_f32 v29, v29
 v_mfma_f32_16x16x32_bf16 v[104:107], a[168:171], v[48:51], v[104:107]
 v_exp_f32 v30, v30
 v_mfma_f32_16x16x32_bf16 v[104:107], a[200:203], v[52:55], v[104:107]
 v_mfma_f32_16x16x32_bf16 v[108:111], a[172:175], v[48:51], v[108:111]
 v_exp_f32 v31, v31
 v_mfma_f32_16x16x32_bf16 v[108:111], a[204:207], v[52:55], v[108:111]
 v_mfma_f32_16x16x32_bf16 v[24:27], a[96:99], a[48:51], 0
 v_cvt_pk_bf16_f32 v42, v28, v29
 v_cvt_pk_bf16_f32 v43, v30, v31
 v_mfma_f32_16x16x32_bf16 v[24:27], a[100:103], a[52:55], v[24:27]
 v_exp_f32 v32, v32
 v_mfma_f32_16x16x32_bf16 v[24:27], a[104:107], a[56:59], v[24:27]
 v_exp_f32 v33, v33
 v_mfma_f32_16x16x32_bf16 v[24:27], a[108:111], a[60:63], v[24:27]
 v_exp_f32 v34, v34
 v_smfmac_f32_16x16x64_bf16 a[224:227], a[240:243], v[48:55], v2
 v_mfma_f32_16x16x32_bf16 v[28:31], a[124:127], a[60:63], 0
 v_exp_f32 v35, v35
 v_mfma_f32_16x16x32_bf16 v[28:31], a[120:123], a[56:59], v[28:31]
 v_exp_f32 v36, v36
 v_mfma_f32_16x16x32_bf16 v[28:31], a[116:119], a[52:55], v[28:31]
 s_add_u32 m0, s39, 33824
 v_mfma_f32_16x16x32_bf16 v[28:31], a[112:115], a[48:51], v[28:31]
 buffer_load_dwordx4 v1, s[20:23], s33 offen offset:1024 nt lds
 v_mfma_f32_16x16x32_bf16 v[112:115], a[176:179], v[48:51], v[112:115]
 v_cvt_pk_bf16_f32 v44, v32, v33
 v_cvt_pk_bf16_f32 v45, v34, v35
 v_mfma_f32_16x16x32_bf16 v[112:115], a[208:211], v[52:55], v[112:115]
 v_exp_f32 v37, v37
 v_mfma_f32_16x16x32_bf16 v[116:119], a[180:183], v[48:51], v[116:119]
 v_mfma_f32_16x16x32_bf16 v[116:119], a[212:215], v[52:55], v[116:119]
 v_exp_f32 v38, v38
 v_mfma_f32_16x16x32_bf16 v[120:123], a[184:187], v[48:51], v[120:123]
 v_exp_f32 v39, v39
 v_mfma_f32_16x16x32_bf16 v[120:123], a[216:219], v[52:55], v[120:123]
 v_mfma_f32_16x16x32_bf16 v[124:127], a[188:191], v[48:51], v[124:127]
 v_cvt_pk_bf16_f32 v46, v36, v37
 v_cvt_pk_bf16_f32 v47, v38, v39
 v_mfma_f32_16x16x32_bf16 v[124:127], a[220:223], v[52:55], v[124:127]
 v_mfma_f32_16x16x32_bf16 v[32:35], a[128:131], a[48:51], 0
 v_exp_f32 v24, v24
 v_mfma_f32_16x16x32_bf16 v[32:35], a[132:135], a[52:55], v[32:35]
 v_mfma_f32_16x16x32_bf16 v[32:35], a[136:139], a[56:59], v[32:35]
 v_exp_f32 v25, v25
 v_mfma_f32_16x16x32_bf16 v[32:35], a[140:143], a[60:63], v[32:35]
 v_exp_f32 v26, v26
 v_mfma_f32_16x16x32_bf16 v[36:39], a[156:159], a[60:63], 0
 v_mfma_f32_16x16x32_bf16 v[36:39], a[152:155], a[56:59], v[36:39]
 v_exp_f32 v27, v27
 v_mfma_f32_16x16x32_bf16 v[36:39], a[148:151], a[52:55], v[36:39]
 v_exp_f32 v28, v28
 v_mfma_f32_16x16x32_bf16 v[36:39], a[144:147], a[48:51], v[36:39]
L_pg0_4:
 s_cbranch_execz L_pg0_8
 v_mfma_f32_16x16x32_bf16 v[128:131], a[160:163], v[40:43], v[128:131]
 s_add_u32 m0, s39, 33856
 v_cvt_pk_bf16_f32 v48, v24, v25
 v_cvt_pk_bf16_f32 v49, v26, v27
 v_mfma_f32_16x16x32_bf16 v[128:131], a[192:195], v[44:47], v[128:131]
 buffer_load_dwordx4 v1, s[20:23], s33 offen offset:2048 nt lds
 v_mfma_f32_16x16x32_bf16 v[132:135], a[164:167], v[40:43], v[132:135]
 v_exp_f32 v29, v29
 v_mfma_f32_16x16x32_bf16 v[132:135], a[196:199], v[44:47], v[132:135]
 v_exp_f32 v30, v30
 v_mfma_f32_16x16x32_bf16 v[136:139], a[168:171], v[40:43], v[136:139]
 v_mfma_f32_16x16x32_bf16 v[136:139], a[200:203], v[44:47], v[136:139]
 v_exp_f32 v31, v31
 v_mfma_f32_16x16x32_bf16 v[140:143], a[172:175], v[40:43], v[140:143]
 v_mfma_f32_16x16x32_bf16 v[140:143], a[204:207], v[44:47], v[140:143]
 v_cvt_pk_bf16_f32 v50, v28, v29
 v_cvt_pk_bf16_f32 v51, v30, v31
 v_mfma_f32_16x16x32_bf16 v[24:27], a[96:99], a[64:67], 0
 v_mfma_f32_16x16x32_bf16 v[24:27], a[100:103], a[68:71], v[24:27]
 v_exp_f32 v32, v32
 v_mfma_f32_16x16x32_bf16 v[24:27], a[104:107], a[72:75], v[24:27]
 v_exp_f32 v33, v33
 v_mfma_f32_16x16x32_bf16 v[24:27], a[108:111], a[76:79], v[24:27]
 v_exp_f32 v34, v34
 v_smfmac_f32_16x16x64_bf16 a[228:231], a[236:239], v[40:47], v2
 v_mfma_f32_16x16x32_bf16 v[28:31], a[124:127], a[76:79], 0
 v_exp_f32 v35, v35
 v_mfma_f32_16x16x32_bf16 v[28:31], a[120:123], a[72:75], v[28:31]
 v_mfma_f32_16x16x32_bf16 v[28:31], a[116:119], a[68:71], v[28:31]
 v_exp_f32 v36, v36
 v_mfma_f32_16x16x32_bf16 v[28:31], a[112:115], a[64:67], v[28:31]
 v_mfma_f32_16x16x32_bf16 v[144:147], a[176:179], v[40:43], v[144:147]
 s_add_u32 m0, s39, 33888
 v_cvt_pk_bf16_f32 v52, v32, v33
 v_cvt_pk_bf16_f32 v53, v34, v35
 v_mfma_f32_16x16x32_bf16 v[144:147], a[208:211], v[44:47], v[144:147]
 buffer_load_dwordx4 v1, s[20:23], s33 offen offset:3072 nt lds
 v_mfma_f32_16x16x32_bf16 v[148:151], a[180:183], v[40:43], v[148:151]
 s_add_u32 s33, s33, 8192
 v_exp_f32 v37, v37
 v_mfma_f32_16x16x32_bf16 v[148:151], a[212:215], v[44:47], v[148:151]
 v_exp_f32 v38, v38
 v_mfma_f32_16x16x32_bf16 v[152:155], a[184:187], v[40:43], v[152:155]
 v_mfma_f32_16x16x32_bf16 v[152:155], a[216:219], v[44:47], v[152:155]
 s_mov_b32 s59, 14336
 v_exp_f32 v39, v39
 v_mfma_f32_16x16x32_bf16 v[156:159], a[188:191], v[40:43], v[156:159]
 s_add_u32 m0, s45, 10880
 v_cvt_pk_bf16_f32 v54, v36, v37
 v_cvt_pk_bf16_f32 v55, v38, v39
 v_mfma_f32_16x16x32_bf16 v[156:159], a[220:223], v[44:47], v[156:159]
 buffer_load_dwordx4 v1, s[28:31], s59 offen nt lds
 v_mfma_f32_16x16x32_bf16 v[32:35], a[128:131], a[64:67], 0
 v_mfma_f32_16x16x32_bf16 v[32:35], a[132:135], a[68:71], v[32:35]
 v_exp_f32 v24, v24
 v_mfma_f32_16x16x32_bf16 v[32:35], a[136:139], a[72:75], v[32:35]
 v_exp_f32 v25, v25
 v_mfma_f32_16x16x32_bf16 v[32:35], a[140:143], a[76:79], v[32:35]
 v_exp_f32 v26, v26
 v_mfma_f32_16x16x32_bf16 v[36:39], a[156:159], a[76:79], 0
 v_mfma_f32_16x16x32_bf16 v[36:39], a[152:155], a[72:75], v[36:39]
 v_exp_f32 v27, v27
 v_mfma_f32_16x16x32_bf16 v[36:39], a[148:151], a[68:71], v[36:39]
 v_exp_f32 v28, v28
 v_mfma_f32_16x16x32_bf16 v[36:39], a[144:147], a[64:67], v[36:39]
 v_mfma_f32_16x16x32_bf16 v[160:163], a[160:163], v[48:51], v[160:163]
 v_cvt_pk_bf16_f32 v40, v24, v25
 v_cvt_pk_bf16_f32 v41, v26, v27
 v_mfma_f32_16x16x32_bf16 v[160:163], a[192:195], v[52:55], v[160:163]
 v_mfma_f32_16x16x32_bf16 v[164:167], a[164:167], v[48:51], v[164:167]
 s_add_u32 m0, s39, 50688
 v_exp_f32 v29, v29
 v_mfma_f32_16x16x32_bf16 v[164:167], a[196:199], v[52:55], v[164:167]
 buffer_load_dwordx4 v1, s[20:23], s33 offen nt lds
 v_mfma_f32_16x16x32_bf16 v[168:171], a[168:171], v[48:51], v[168:171]
 v_exp_f32 v30, v30
 v_mfma_f32_16x16x32_bf16 v[168:171], a[200:203], v[52:55], v[168:171]
 v_exp_f32 v31, v31
 v_mfma_f32_16x16x32_bf16 v[172:175], a[172:175], v[48:51], v[172:175]
 v_mfma_f32_16x16x32_bf16 v[172:175], a[204:207], v[52:55], v[172:175]
 v_cvt_pk_bf16_f32 v42, v28, v29
 v_cvt_pk_bf16_f32 v43, v30, v31
 v_mfma_f32_16x16x32_bf16 v[24:27], a[96:99], a[80:83], 0
 v_mfma_f32_16x16x32_bf16 v[24:27], a[100:103], a[84:87], v[24:27]
 v_exp_f32 v32, v32
 v_mfma_f32_16x16x32_bf16 v[24:27], a[104:107], a[88:91], v[24:27]
 v_mfma_f32_16x16x32_bf16 v[24:27], a[108:111], a[92:95], v[24:27]
 v_exp_f32 v33, v33
 v_smfmac_f32_16x16x64_bf16 a[228:231], a[240:243], v[48:55], v2
 v_mfma_f32_16x16x32_bf16 v[28:31], a[124:127], a[92:95], 0
 v_exp_f32 v34, v34
 v_mfma_f32_16x16x32_bf16 v[28:31], a[120:123], a[88:91], v[28:31]
 v_exp_f32 v35, v35
 v_mfma_f32_16x16x32_bf16 v[28:31], a[116:119], a[84:87], v[28:31]
 v_exp_f32 v36, v36
 v_mfma_f32_16x16x32_bf16 v[28:31], a[112:115], a[80:83], v[28:31]
 s_waitcnt vmcnt(9)
 s_barrier
 v_mfma_f32_16x16x32_bf16 v[176:179], a[176:179], v[48:51], v[176:179]
 v_cvt_pk_bf16_f32 v44, v32, v33
 v_cvt_pk_bf16_f32 v45, v34, v35
 v_mfma_f32_16x16x32_bf16 v[176:179], a[208:211], v[52:55], v[176:179]
 v_exp_f32 v37, v37
 v_mfma_f32_16x16x32_bf16 v[180:183], a[180:183], v[48:51], v[180:183]
 s_add_u32 m0, s39, 50720
 ds_read_b128 a[96:99], v7 offset:0
 ds_read_b128 a[100:103], v7 offset:64
 v_mfma_f32_16x16x32_bf16 v[180:183], a[212:215], v[52:55], v[180:183]
 buffer_load_dwordx4 v1, s[20:23], s33 offen offset:1024 nt lds
 v_mfma_f32_16x16x32_bf16 v[184:187], a[184:187], v[48:51], v[184:187]
 v_exp_f32 v38, v38
 v_mfma_f32_16x16x32_bf16 v[184:187], a[216:219], v[52:55], v[184:187]
 v_exp_f32 v39, v39
 v_mfma_f32_16x16x32_bf16 v[188:191], a[188:191], v[48:51], v[188:191]
 ds_read_b128 a[104:107], v7 offset:128
 ds_read_b128 a[108:111], v7 offset:192
 v_mfma_f32_16x16x32_bf16 v[188:191], a[220:223], v[52:55], v[188:191]
 v_cvt_pk_bf16_f32 v46, v36, v37
 v_cvt_pk_bf16_f32 v47, v38, v39
 v_mfma_f32_16x16x32_bf16 v[32:35], a[128:131], a[80:83], 0
 v_mfma_f32_16x16x32_bf16 v[32:35], a[132:135], a[84:87], v[32:35]
 v_exp_f32 v24, v24
 v_mfma_f32_16x16x32_bf16 v[32:35], a[136:139], a[88:91], v[32:35]
 ds_read_b128 a[124:127], v7 offset:704
 ds_read_b128 a[120:123], v7 offset:640
 v_mfma_f32_16x16x32_bf16 v[32:35], a[140:143], a[92:95], v[32:35]
 v_exp_f32 v25, v25
 v_mfma_f32_16x16x32_bf16 v[36:39], a[156:159], a[92:95], 0
 v_exp_f32 v26, v26
 v_mfma_f32_16x16x32_bf16 v[36:39], a[152:155], a[88:91], v[36:39]
 v_exp_f32 v27, v27
 v_mfma_f32_16x16x32_bf16 v[36:39], a[148:151], a[84:87], v[36:39]
 ds_read_b128 a[116:119], v7 offset:576
 ds_read_b128 a[112:115], v7 offset:512
 v_mfma_f32_16x16x32_bf16 v[36:39], a[144:147], a[80:83], v[36:39]
 v_exp_f32 v28, v28
 v_mfma_f32_16x16x32_bf16 v[192:195], a[160:163], v[40:43], v[192:195]
 v_mfma_f32_16x16x32_bf16 v[192:195], a[192:195], v[44:47], v[192:195]
 v_cvt_pk_bf16_f32 v48, v24, v25
 v_cvt_pk_bf16_f32 v49, v26, v27
 v_mfma_f32_16x16x32_bf16 v[196:199], a[164:167], v[40:43], v[196:199]
 v_exp_f32 v29, v29
 v_mfma_f32_16x16x32_bf16 v[196:199], a[196:199], v[44:47], v[196:199]
 ds_read_b128 a[128:131], v7 offset:16896
 ds_read_b128 a[132:135], v7 offset:16960
 v_mfma_f32_16x16x32_bf16 v[200:203], a[168:171], v[40:43], v[200:203]
 s_add_u32 m0, s39, 50752
 v_exp_f32 v30, v30
 v_mfma_f32_16x16x32_bf16 v[200:203], a[200:203], v[44:47], v[200:203]
 buffer_load_dwordx4 v1, s[20:23], s33 offen offset:2048 nt lds
 v_mfma_f32_16x16x32_bf16 v[204:207], a[172:175], v[40:43], v[204:207]
 v_exp_f32 v31, v31
 v_mfma_f32_16x16x32_bf16 v[204:207], a[204:207], v[44:47], v[204:207]
 s_waitcnt lgkmcnt(6)
 ds_read_b128 a[136:139], v7 offset:17024
 ds_read_b128 a[140:143], v7 offset:17088
 v_mfma_f32_16x16x32_bf16 v[24:27], a[96:99], a[0:3], 0
 v_cvt_pk_bf16_f32 v50, v28, v29
 v_cvt_pk_bf16_f32 v51, v30, v31
 v_mfma_f32_16x16x32_bf16 v[24:27], a[100:103], a[4:7], v[24:27]
 v_exp_f32 v32, v32
 v_mfma_f32_16x16x32_bf16 v[24:27], a[104:107], a[8:11], v[24:27]
 v_mfma_f32_16x16x32_bf16 v[24:27], a[108:111], a[12:15], v[24:27]
 s_waitcnt lgkmcnt(4)
 ds_read_b128 a[156:159], v7 offset:17600
 ds_read_b128 a[152:155], v7 offset:17536
 v_exp_f32 v33, v33
 v_smfmac_f32_16x16x64_bf16 a[232:235], a[236:239], v[40:47], v2
 v_exp_f32 v34, v34
 v_mfma_f32_16x16x32_bf16 v[28:31], a[124:127], a[12:15], 0
 v_exp_f32 v35, v35
 v_mfma_f32_16x16x32_bf16 v[28:31], a[120:123], a[8:11], v[28:31]
 v_mfma_f32_16x16x32_bf16 v[28:31], a[116:119], a[4:7], v[28:31]
 ds_read_b128 a[148:151], v7 offset:17472
 ds_read_b128 a[144:147], v7 offset:17408
 v_mfma_f32_16x16x32_bf16 v[28:31], a[112:115], a[0:3], v[28:31]
 v_exp_f32 v36, v36
 v_mfma_f32_16x16x32_bf16 v[208:211], a[176:179], v[40:43], v[208:211]
 v_cvt_pk_bf16_f32 v52, v32, v33
 v_cvt_pk_bf16_f32 v53, v34, v35
 v_mfma_f32_16x16x32_bf16 v[208:211], a[208:211], v[44:47], v[208:211]
 v_mfma_f32_16x16x32_bf16 v[212:215], a[180:183], v[40:43], v[212:215]
 s_add_u32 m0, s39, 50784
 v_exp_f32 v37, v37
 v_mfma_f32_16x16x32_bf16 v[212:215], a[212:215], v[44:47], v[212:215]
 buffer_load_dwordx4 v1, s[20:23], s33 offen offset:3072 nt lds
 v_mfma_f32_16x16x32_bf16 v[216:219], a[184:187], v[40:43], v[216:219]
 s_add_u32 s33, s33, 8192
 v_exp_f32 v38, v38
 v_mfma_f32_16x16x32_bf16 v[216:219], a[216:219], v[44:47], v[216:219]
 s_mov_b32 s59, 15360
 v_mfma_f32_16x16x32_bf16 v[220:223], a[188:191], v[40:43], v[220:223]
 s_add_u32 m0, s45, 11968
 v_exp_f32 v39, v39
 v_mfma_f32_16x16x32_bf16 v[220:223], a[220:223], v[44:47], v[220:223]
 s_waitcnt lgkmcnt(4)
 buffer_load_dwordx4 v1, s[28:31], s59 offen nt lds
 v_mfma_f32_16x16x32_bf16 v[32:35], a[128:131], a[0:3], 0
 v_cvt_pk_bf16_f32 v54, v36, v37
 v_cvt_pk_bf16_f32 v55, v38, v39
 v_mfma_f32_16x16x32_bf16 v[32:35], a[132:135], a[4:7], v[32:35]
 v_mfma_f32_16x16x32_bf16 v[32:35], a[136:139], a[8:11], v[32:35]
 v_exp_f32 v24, v24
 v_mfma_f32_16x16x32_bf16 v[32:35], a[140:143], a[12:15], v[32:35]
 s_waitcnt lgkmcnt(0)
 v_exp_f32 v25, v25
 v_mfma_f32_16x16x32_bf16 v[36:39], a[156:159], a[12:15], 0
 v_mfma_f32_16x16x32_bf16 v[36:39], a[152:155], a[8:11], v[36:39]
 v_exp_f32 v26, v26
 v_mfma_f32_16x16x32_bf16 v[36:39], a[148:151], a[4:7], v[36:39]
 v_exp_f32 v27, v27
 v_mfma_f32_16x16x32_bf16 v[36:39], a[144:147], a[0:3], v[36:39]
 v_exp_f32 v28, v28
 v_cvt_pk_bf16_f32 v40, v24, v25
 v_mfma_f32_16x16x32_bf16 v[224:227], a[160:163], v[48:51], v[224:227]
 v_mfma_f32_16x16x32_bf16 v[224:227], a[192:195], v[52:55], v[224:227]
 v_cvt_pk_bf16_f32 v41, v26, v27
 v_exp_f32 v29, v29
 v_mfma_f32_16x16x32_bf16 v[228:231], a[164:167], v[48:51], v[228:231]
 ds_read_b64_tr_b16 a[160:161], v8 offset:0
 ds_read_b64_tr_b16 a[162:163], v8 offset:512
 v_mfma_f32_16x16x32_bf16 v[228:231], a[196:199], v[52:55], v[228:231]
 v_exp_f32 v30, v30
 v_mfma_f32_16x16x32_bf16 v[232:235], a[168:171], v[48:51], v[232:235]
 ds_read_b64_tr_b16 a[192:193], v8 offset:16896
 ds_read_b64_tr_b16 a[194:195], v8 offset:17408
 v_mfma_f32_16x16x32_bf16 v[232:235], a[200:203], v[52:55], v[232:235]
 v_mfma_f32_16x16x32_bf16 v[236:239], a[172:175], v[48:51], v[236:239]
 v_exp_f32 v31, v31
 v_mfma_f32_16x16x32_bf16 v[236:239], a[204:207], v[52:55], v[236:239]
 ds_read_b64_tr_b16 a[164:165], v8 offset:32
 ds_read_b64_tr_b16 a[166:167], v8 offset:544
 v_cvt_pk_bf16_f32 v42, v28, v29
 v_cvt_pk_bf16_f32 v43, v30, v31
 v_mfma_f32_16x16x32_bf16 v[24:27], a[96:99], a[16:19], 0
 v_exp_f32 v32, v32
 v_mfma_f32_16x16x32_bf16 v[24:27], a[100:103], a[20:23], v[24:27]
 ds_read_b64_tr_b16 a[196:197], v8 offset:16928
 ds_read_b64_tr_b16 a[198:199], v8 offset:17440
 v_mfma_f32_16x16x32_bf16 v[24:27], a[104:107], a[24:27], v[24:27]
 v_mfma_f32_16x16x32_bf16 v[24:27], a[108:111], a[28:31], v[24:27]
 ds_read_b64_tr_b16 a[168:169], v8 offset:64
 ds_read_b64_tr_b16 a[170:171], v8 offset:576
 v_exp_f32 v33, v33
 v_smfmac_f32_16x16x64_bf16 a[232:235], a[240:243], v[48:55], v2
 v_exp_f32 v34, v34
 v_mfma_f32_16x16x32_bf16 v[28:31], a[124:127], a[28:31], 0
 ds_read_b64_tr_b16 a[200:201], v8 offset:16960
 ds_read_b64_tr_b16 a[202:203], v8 offset:17472
 v_mfma_f32_16x16x32_bf16 v[28:31], a[120:123], a[24:27], v[28:31]
 v_exp_f32 v35, v35
 v_mfma_f32_16x16x32_bf16 v[28:31], a[116:119], a[20:23], v[28:31]
 v_mfma_f32_16x16x32_bf16 v[28:31], a[112:115], a[16:19], v[28:31]
 ds_read_b64_tr_b16 a[172:173], v8 offset:96
 ds_read_b64_tr_b16 a[174:175], v8 offset:608
 v_exp_f32 v36, v36
 v_mfma_f32_16x16x32_bf16 v[240:243], a[176:179], v[48:51], v[240:243]
 v_cvt_pk_bf16_f32 v44, v32, v33
 v_cvt_pk_bf16_f32 v45, v34, v35
 v_mfma_f32_16x16x32_bf16 v[240:243], a[208:211], v[52:55], v[240:243]
 ds_read_b64_tr_b16 a[204:205], v8 offset:16992
 ds_read_b64_tr_b16 a[206:207], v8 offset:17504
 v_mfma_f32_16x16x32_bf16 v[244:247], a[180:183], v[48:51], v[244:247]
 v_exp_f32 v37, v37
 v_mfma_f32_16x16x32_bf16 v[244:247], a[212:215], v[52:55], v[244:247]
 v_mfma_f32_16x16x32_bf16 v[248:251], a[184:187], v[48:51], v[248:251]
 v_exp_f32 v38, v38
 v_mfma_f32_16x16x32_bf16 v[248:251], a[216:219], v[52:55], v[248:251]
 s_mov_b32 s59, 16384
 ds_read_b64_tr_b16 a[176:177], v8 offset:128
 ds_read_b64_tr_b16 a[178:179], v8 offset:640
 v_exp_f32 v39, v39
 v_mfma_f32_16x16x32_bf16 v[252:255], a[188:191], v[48:51], v[252:255]
 s_add_u32 m0, s45, 13056
 v_cvt_pk_bf16_f32 v46, v36, v37
 v_cvt_pk_bf16_f32 v47, v38, v39
 v_mfma_f32_16x16x32_bf16 v[252:255], a[220:223], v[52:55], v[252:255]
 buffer_load_dwordx4 v1, s[28:31], s59 offen nt lds
 v_mfma_f32_16x16x32_bf16 v[32:35], a[128:131], a[16:19], 0
 ds_read_b64_tr_b16 a[208:209], v8 offset:17024
 ds_read_b64_tr_b16 a[210:211], v8 offset:17536
 v_mfma_f32_16x16x32_bf16 v[32:35], a[132:135], a[20:23], v[32:35]
 v_mfma_f32_16x16x32_bf16 v[32:35], a[136:139], a[24:27], v[32:35]
 v_exp_f32 v24, v24
 v_mfma_f32_16x16x32_bf16 v[32:35], a[140:143], a[28:31], v[32:35]
 ds_read_b64_tr_b16 a[180:181], v8 offset:160
 ds_read_b64_tr_b16 a[182:183], v8 offset:672
 v_exp_f32 v25, v25
 v_mfma_f32_16x16x32_bf16 v[36:39], a[156:159], a[28:31], 0
 v_exp_f32 v26, v26
 v_mfma_f32_16x16x32_bf16 v[36:39], a[152:155], a[24:27], v[36:39]
 v_mfma_f32_16x16x32_bf16 v[36:39], a[148:151], a[20:23], v[36:39]
 ds_read_b64_tr_b16 a[212:213], v8 offset:17056
 ds_read_b64_tr_b16 a[214:215], v8 offset:17568
 v_mfma_f32_16x16x32_bf16 v[36:39], a[144:147], a[16:19], v[36:39]
 s_waitcnt lgkmcnt(15)
 v_exp_f32 v27, v27
 v_mfma_f32_16x16x32_bf16 v[64:67], a[160:163], v[40:43], v[64:67]
 v_exp_f32 v28, v28
 v_mfma_f32_16x16x32_bf16 v[64:67], a[192:195], v[44:47], v[64:67]
 ds_read_b64_tr_b16 a[184:185], v8 offset:192
 ds_read_b64_tr_b16 a[186:187], v8 offset:704
 v_cvt_pk_bf16_f32 v48, v24, v25
 v_mfma_f32_16x16x32_bf16 v[68:71], a[164:167], v[40:43], v[68:71]
 v_mfma_f32_16x16x32_bf16 v[68:71], a[196:199], v[44:47], v[68:71]
 s_waitcnt lgkmcnt(10)
 v_cvt_pk_bf16_f32 v49, v26, v27
 v_exp_f32 v29, v29
 v_mfma_f32_16x16x32_bf16 v[72:75], a[168:171], v[40:43], v[72:75]
 ds_read_b64_tr_b16 a[216:217], v8 offset:17088
 ds_read_b64_tr_b16 a[218:219], v8 offset:17600
 v_mfma_f32_16x16x32_bf16 v[72:75], a[200:203], v[44:47], v[72:75]
 v_exp_f32 v30, v30
 v_exp_f32 v31, v31
 v_mfma_f32_16x16x32_bf16 v[76:79], a[172:175], v[40:43], v[76:79]
 v_mfma_f32_16x16x32_bf16 v[76:79], a[204:207], v[44:47], v[76:79]
 ds_read_b64_tr_b16 a[188:189], v8 offset:224
 ds_read_b64_tr_b16 a[190:191], v8 offset:736
 v_mfma_f32_16x16x32_bf16 v[24:27], a[96:99], a[32:35], 0
 v_cvt_pk_bf16_f32 v50, v28, v29
 v_cvt_pk_bf16_f32 v51, v30, v31
 v_mfma_f32_16x16x32_bf16 v[24:27], a[100:103], a[36:39], v[24:27]
 v_exp_f32 v32, v32
 v_mfma_f32_16x16x32_bf16 v[24:27], a[104:107], a[40:43], v[24:27]
 ds_read_b64_tr_b16 a[220:221], v8 offset:17120
 ds_read_b64_tr_b16 a[222:223], v8 offset:17632
 v_mfma_f32_16x16x32_bf16 v[24:27], a[108:111], a[44:47], v[24:27]
 v_smfmac_f32_16x16x64_bf16 a[224:227], a[236:239], v[40:47], v2
 v_exp_f32 v33, v33
 v_mfma_f32_16x16x32_bf16 v[28:31], a[124:127], a[44:47], 0
 v_exp_f32 v34, v34
 v_mfma_f32_16x16x32_bf16 v[28:31], a[120:123], a[40:43], v[28:31]
 v_mfma_f32_16x16x32_bf16 v[28:31], a[116:119], a[36:39], v[28:31]
 v_exp_f32 v35, v35
 v_mfma_f32_16x16x32_bf16 v[28:31], a[112:115], a[32:35], v[28:31]
 s_waitcnt lgkmcnt(8)
 v_exp_f32 v36, v36
 v_mfma_f32_16x16x32_bf16 v[80:83], a[176:179], v[40:43], v[80:83]
 v_mfma_f32_16x16x32_bf16 v[80:83], a[208:211], v[44:47], v[80:83]
 v_cvt_pk_bf16_f32 v52, v32, v33
 v_cvt_pk_bf16_f32 v53, v34, v35
 v_mfma_f32_16x16x32_bf16 v[84:87], a[180:183], v[40:43], v[84:87]
 v_exp_f32 v37, v37
 v_mfma_f32_16x16x32_bf16 v[84:87], a[212:215], v[44:47], v[84:87]
 s_waitcnt lgkmcnt(0)
 s_barrier
 v_mfma_f32_16x16x32_bf16 v[88:91], a[184:187], v[40:43], v[88:91]
 v_exp_f32 v38, v38
 v_mfma_f32_16x16x32_bf16 v[88:91], a[216:219], v[44:47], v[88:91]
 s_mov_b32 s59, 17408
 v_mfma_f32_16x16x32_bf16 v[92:95], a[188:191], v[40:43], v[92:95]
 s_add_u32 m0, s45, 14144
 v_exp_f32 v39, v39
 v_mfma_f32_16x16x32_bf16 v[92:95], a[220:223], v[44:47], v[92:95]
 buffer_load_dwordx4 v1, s[28:31], s59 offen nt lds
 v_mfma_f32_16x16x32_bf16 v[32:35], a[128:131], a[32:35], 0
 v_cvt_pk_bf16_f32 v54, v36, v37
 v_cvt_pk_bf16_f32 v55, v38, v39
 v_mfma_f32_16x16x32_bf16 v[32:35], a[132:135], a[36:39], v[32:35]
 v_mfma_f32_16x16x32_bf16 v[32:35], a[136:139], a[40:43], v[32:35]
 v_exp_f32 v24, v24
 v_mfma_f32_16x16x32_bf16 v[32:35], a[140:143], a[44:47], v[32:35]
 v_exp_f32 v25, v25
 v_mfma_f32_16x16x32_bf16 v[36:39], a[156:159], a[44:47], 0
 v_mfma_f32_16x16x32_bf16 v[36:39], a[152:155], a[40:43], v[36:39]
 s_mov_b32 s33, s46
 v_exp_f32 v26, v26
 v_mfma_f32_16x16x32_bf16 v[36:39], a[148:151], a[36:39], v[36:39]
 s_add_u32 m0, s39, 0
 v_exp_f32 v27, v27
 v_mfma_f32_16x16x32_bf16 v[36:39], a[144:147], a[32:35], v[36:39]
 buffer_load_dwordx4 v1, s[20:23], s33 offen nt lds
 v_mfma_f32_16x16x32_bf16 v[96:99], a[160:163], v[48:51], v[96:99]
 v_mfma_f32_16x16x32_bf16 v[96:99], a[192:195], v[52:55], v[96:99]
 v_exp_f32 v28, v28
 v_mfma_f32_16x16x32_bf16 v[100:103], a[164:167], v[48:51], v[100:103]
 v_cvt_pk_bf16_f32 v40, v24, v25
 v_cvt_pk_bf16_f32 v41, v26, v27
 v_mfma_f32_16x16x32_bf16 v[100:103], a[196:199], v[52:55], v[100:103]
 v_mfma_f32_16x16x32_bf16 v[104:107], a[168:171], v[48:51], v[104:107]
 v_exp_f32 v29, v29
 v_mfma_f32_16x16x32_bf16 v[104:107], a[200:203], v[52:55], v[104:107]
 v_exp_f32 v30, v30
 v_mfma_f32_16x16x32_bf16 v[108:111], a[172:175], v[48:51], v[108:111]
 v_mfma_f32_16x16x32_bf16 v[108:111], a[204:207], v[52:55], v[108:111]
 v_exp_f32 v31, v31
 v_mfma_f32_16x16x32_bf16 v[24:27], a[96:99], a[48:51], 0
 v_cvt_pk_bf16_f32 v42, v28, v29
 v_cvt_pk_bf16_f32 v43, v30, v31
 v_mfma_f32_16x16x32_bf16 v[24:27], a[100:103], a[52:55], v[24:27]
 v_exp_f32 v32, v32
 v_mfma_f32_16x16x32_bf16 v[24:27], a[104:107], a[56:59], v[24:27]
 v_mfma_f32_16x16x32_bf16 v[24:27], a[108:111], a[60:63], v[24:27]
 v_exp_f32 v33, v33
 v_exp_f32 v34, v34
 v_smfmac_f32_16x16x64_bf16 a[224:227], a[240:243], v[48:55], v2
 v_mfma_f32_16x16x32_bf16 v[28:31], a[124:127], a[60:63], 0
 v_exp_f32 v35, v35
 v_mfma_f32_16x16x32_bf16 v[28:31], a[120:123], a[56:59], v[28:31]
 v_mfma_f32_16x16x32_bf16 v[28:31], a[116:119], a[52:55], v[28:31]
 s_add_u32 m0, s39, 32
 v_exp_f32 v36, v36
 v_mfma_f32_16x16x32_bf16 v[28:31], a[112:115], a[48:51], v[28:31]
 buffer_load_dwordx4 v1, s[20:23], s33 offen offset:1024 nt lds
 v_mfma_f32_16x16x32_bf16 v[112:115], a[176:179], v[48:51], v[112:115]
 v_mfma_f32_16x16x32_bf16 v[112:115], a[208:211], v[52:55], v[112:115]
 v_cvt_pk_bf16_f32 v44, v32, v33
 v_cvt_pk_bf16_f32 v45, v34, v35
 v_exp_f32 v37, v37
 v_mfma_f32_16x16x32_bf16 v[116:119], a[180:183], v[48:51], v[116:119]
 v_mfma_f32_16x16x32_bf16 v[116:119], a[212:215], v[52:55], v[116:119]
 v_exp_f32 v38, v38
 v_exp_f32 v39, v39
 v_mfma_f32_16x16x32_bf16 v[120:123], a[184:187], v[48:51], v[120:123]
 v_cvt_pk_bf16_f32 v46, v36, v37
 v_cvt_pk_bf16_f32 v47, v38, v39
 v_mfma_f32_16x16x32_bf16 v[120:123], a[216:219], v[52:55], v[120:123]
 v_mfma_f32_16x16x32_bf16 v[124:127], a[188:191], v[48:51], v[124:127]
 v_exp_f32 v24, v24
 v_mfma_f32_16x16x32_bf16 v[124:127], a[220:223], v[52:55], v[124:127]
 v_mfma_f32_16x16x32_bf16 v[32:35], a[128:131], a[48:51], 0
 v_exp_f32 v25, v25
 v_mfma_f32_16x16x32_bf16 v[32:35], a[132:135], a[52:55], v[32:35]
 v_mfma_f32_16x16x32_bf16 v[32:35], a[136:139], a[56:59], v[32:35]
 v_exp_f32 v26, v26
 v_mfma_f32_16x16x32_bf16 v[32:35], a[140:143], a[60:63], v[32:35]
 v_mfma_f32_16x16x32_bf16 v[36:39], a[156:159], a[60:63], 0
 v_exp_f32 v27, v27
 v_mfma_f32_16x16x32_bf16 v[36:39], a[152:155], a[56:59], v[36:39]
 s_mov_b32 s59, 18432
 v_mfma_f32_16x16x32_bf16 v[36:39], a[148:151], a[52:55], v[36:39]
 s_add_u32 m0, s45, 15232
 v_exp_f32 v28, v28
 v_mfma_f32_16x16x32_bf16 v[36:39], a[144:147], a[48:51], v[36:39]
 buffer_load_dwordx4 v1, s[28:31], s59 offen nt lds
 v_mfma_f32_16x16x32_bf16 v[128:131], a[160:163], v[40:43], v[128:131]
 s_add_u32 m0, s39, 64
 v_mfma_f32_16x16x32_bf16 v[128:131], a[192:195], v[44:47], v[128:131]
 buffer_load_dwordx4 v1, s[20:23], s33 offen offset:2048 nt lds
 v_mfma_f32_16x16x32_bf16 v[132:135], a[164:167], v[40:43], v[132:135]
 v_cvt_pk_bf16_f32 v48, v24, v25
 v_cvt_pk_bf16_f32 v49, v26, v27
 v_mfma_f32_16x16x32_bf16 v[132:135], a[196:199], v[44:47], v[132:135]
 v_exp_f32 v29, v29
 v_exp_f32 v30, v30
 v_mfma_f32_16x16x32_bf16 v[136:139], a[168:171], v[40:43], v[136:139]
 v_mfma_f32_16x16x32_bf16 v[136:139], a[200:203], v[44:47], v[136:139]
 v_exp_f32 v31, v31
 v_cvt_pk_bf16_f32 v50, v28, v29
 v_mfma_f32_16x16x32_bf16 v[140:143], a[172:175], v[40:43], v[140:143]
 v_mfma_f32_16x16x32_bf16 v[140:143], a[204:207], v[44:47], v[140:143]
 v_cvt_pk_bf16_f32 v51, v30, v31
 v_exp_f32 v32, v32
 v_mfma_f32_16x16x32_bf16 v[24:27], a[96:99], a[64:67], 0
 v_mfma_f32_16x16x32_bf16 v[24:27], a[100:103], a[68:71], v[24:27]
 v_exp_f32 v33, v33
 v_mfma_f32_16x16x32_bf16 v[24:27], a[104:107], a[72:75], v[24:27]
 v_mfma_f32_16x16x32_bf16 v[24:27], a[108:111], a[76:79], v[24:27]
 v_exp_f32 v34, v34
 v_smfmac_f32_16x16x64_bf16 a[228:231], a[236:239], v[40:47], v2
 v_mfma_f32_16x16x32_bf16 v[28:31], a[124:127], a[76:79], 0
 v_exp_f32 v35, v35
 v_mfma_f32_16x16x32_bf16 v[28:31], a[120:123], a[72:75], v[28:31]
 v_exp_f32 v36, v36
 v_mfma_f32_16x16x32_bf16 v[28:31], a[116:119], a[68:71], v[28:31]
 v_mfma_f32_16x16x32_bf16 v[28:31], a[112:115], a[64:67], v[28:31]
 v_cvt_pk_bf16_f32 v52, v32, v33
 v_cvt_pk_bf16_f32 v53, v34, v35
 v_exp_f32 v37, v37
 v_mfma_f32_16x16x32_bf16 v[144:147], a[176:179], v[40:43], v[144:147]
 s_add_u32 m0, s39, 96
 v_mfma_f32_16x16x32_bf16 v[144:147], a[208:211], v[44:47], v[144:147]
 buffer_load_dwordx4 v1, s[20:23], s33 offen offset:3072 nt lds
 v_mfma_f32_16x16x32_bf16 v[148:151], a[180:183], v[40:43], v[148:151]
 s_add_u32 s33, s33, 8192
 v_exp_f32 v38, v38
 v_mfma_f32_16x16x32_bf16 v[148:151], a[212:215], v[44:47], v[148:151]
 v_mfma_f32_16x16x32_bf16 v[152:155], a[184:187], v[40:43], v[152:155]
 v_exp_f32 v39, v39
 v_mfma_f32_16x16x32_bf16 v[152:155], a[216:219], v[44:47], v[152:155]
 v_mfma_f32_16x16x32_bf16 v[156:159], a[188:191], v[40:43], v[156:159]
 v_cvt_pk_bf16_f32 v54, v36, v37
 v_cvt_pk_bf16_f32 v55, v38, v39
 v_mfma_f32_16x16x32_bf16 v[156:159], a[220:223], v[44:47], v[156:159]
 v_mfma_f32_16x16x32_bf16 v[32:35], a[128:131], a[64:67], 0
 v_exp_f32 v24, v24
 v_mfma_f32_16x16x32_bf16 v[32:35], a[132:135], a[68:71], v[32:35]
 v_mfma_f32_16x16x32_bf16 v[32:35], a[136:139], a[72:75], v[32:35]
 v_exp_f32 v25, v25
 v_mfma_f32_16x16x32_bf16 v[32:35], a[140:143], a[76:79], v[32:35]
 v_exp_f32 v26, v26
 v_mfma_f32_16x16x32_bf16 v[36:39], a[156:159], a[76:79], 0
 v_mfma_f32_16x16x32_bf16 v[36:39], a[152:155], a[72:75], v[36:39]
 v_exp_f32 v27, v27
 v_mfma_f32_16x16x32_bf16 v[36:39], a[148:151], a[68:71], v[36:39]
 v_mfma_f32_16x16x32_bf16 v[36:39], a[144:147], a[64:67], v[36:39]
 v_exp_f32 v28, v28
 v_cvt_pk_bf16_f32 v40, v24, v25
 v_mfma_f32_16x16x32_bf16 v[160:163], a[160:163], v[48:51], v[160:163]
 v_mfma_f32_16x16x32_bf16 v[160:163], a[192:195], v[52:55], v[160:163]
 v_cvt_pk_bf16_f32 v41, v26, v27
 v_exp_f32 v29, v29
 v_mfma_f32_16x16x32_bf16 v[164:167], a[164:167], v[48:51], v[164:167]
 s_add_u32 m0, s39, 16896
 v_mfma_f32_16x16x32_bf16 v[164:167], a[196:199], v[52:55], v[164:167]
 buffer_load_dwordx4 v1, s[20:23], s33 offen nt lds
 v_mfma_f32_16x16x32_bf16 v[168:171], a[168:171], v[48:51], v[168:171]
 v_exp_f32 v30, v30
 v_mfma_f32_16x16x32_bf16 v[168:171], a[200:203], v[52:55], v[168:171]
 v_mfma_f32_16x16x32_bf16 v[172:175], a[172:175], v[48:51], v[172:175]
 v_exp_f32 v31, v31
 v_mfma_f32_16x16x32_bf16 v[172:175], a[204:207], v[52:55], v[172:175]
 v_cvt_pk_bf16_f32 v42, v28, v29
 v_cvt_pk_bf16_f32 v43, v30, v31
 v_exp_f32 v32, v32
 v_mfma_f32_16x16x32_bf16 v[24:27], a[96:99], a[80:83], 0
 v_mfma_f32_16x16x32_bf16 v[24:27], a[100:103], a[84:87], v[24:27]
 v_exp_f32 v33, v33
 v_mfma_f32_16x16x32_bf16 v[24:27], a[104:107], a[88:91], v[24:27]
 v_mfma_f32_16x16x32_bf16 v[24:27], a[108:111], a[92:95], v[24:27]
 v_exp_f32 v34, v34
 v_exp_f32 v35, v35
 v_smfmac_f32_16x16x64_bf16 a[228:231], a[240:243], v[48:55], v2
 v_mfma_f32_16x16x32_bf16 v[28:31], a[124:127], a[92:95], 0
 v_exp_f32 v36, v36
 v_mfma_f32_16x16x32_bf16 v[28:31], a[120:123], a[88:91], v[28:31]
 v_mfma_f32_16x16x32_bf16 v[28:31], a[116:119], a[84:87], v[28:31]
 v_cvt_pk_bf16_f32 v44, v32, v33
 v_cvt_pk_bf16_f32 v45, v34, v35
 v_mfma_f32_16x16x32_bf16 v[28:31], a[112:115], a[80:83], v[28:31]
 s_mov_b32 s59, 19456
 s_waitcnt vmcnt(9)
 s_barrier
 v_mfma_f32_16x16x32_bf16 v[176:179], a[176:179], v[48:51], v[176:179]
 s_add_u32 m0, s45, 16320
 v_mfma_f32_16x16x32_bf16 v[176:179], a[208:211], v[52:55], v[176:179]
 buffer_load_dwordx4 v1, s[28:31], s59 offen nt lds
 v_mfma_f32_16x16x32_bf16 v[180:183], a[180:183], v[48:51], v[180:183]
 s_add_u32 m0, s39, 16928
 ds_read_b128 a[96:99], v7 offset:33792
 ds_read_b128 a[100:103], v7 offset:33856
 v_mfma_f32_16x16x32_bf16 v[180:183], a[212:215], v[52:55], v[180:183]
 buffer_load_dwordx4 v1, s[20:23], s33 offen offset:1024 nt lds
 v_mfma_f32_16x16x32_bf16 v[184:187], a[184:187], v[48:51], v[184:187]
 v_exp_f32 v37, v37
 v_mfma_f32_16x16x32_bf16 v[184:187], a[216:219], v[52:55], v[184:187]
 v_mfma_f32_16x16x32_bf16 v[188:191], a[188:191], v[48:51], v[188:191]
 ds_read_b128 a[104:107], v7 offset:33920
 ds_read_b128 a[108:111], v7 offset:33984
 v_mfma_f32_16x16x32_bf16 v[188:191], a[220:223], v[52:55], v[188:191]
 v_exp_f32 v38, v38
 v_exp_f32 v39, v39
 v_mfma_f32_16x16x32_bf16 v[32:35], a[128:131], a[80:83], 0
 v_cvt_pk_bf16_f32 v46, v36, v37
 v_cvt_pk_bf16_f32 v47, v38, v39
 v_mfma_f32_16x16x32_bf16 v[32:35], a[132:135], a[84:87], v[32:35]
 v_mfma_f32_16x16x32_bf16 v[32:35], a[136:139], a[88:91], v[32:35]
 ds_read_b128 a[124:127], v7 offset:34496
 ds_read_b128 a[120:123], v7 offset:34432
 v_mfma_f32_16x16x32_bf16 v[32:35], a[140:143], a[92:95], v[32:35]
 v_exp_f32 v24, v24
 v_exp_f32 v25, v25
 v_mfma_f32_16x16x32_bf16 v[36:39], a[156:159], a[92:95], 0
 v_mfma_f32_16x16x32_bf16 v[36:39], a[152:155], a[88:91], v[36:39]
 v_exp_f32 v26, v26
 v_mfma_f32_16x16x32_bf16 v[36:39], a[148:151], a[84:87], v[36:39]
 ds_read_b128 a[116:119], v7 offset:34368
 ds_read_b128 a[112:115], v7 offset:34304
 v_mfma_f32_16x16x32_bf16 v[36:39], a[144:147], a[80:83], v[36:39]
 v_mfma_f32_16x16x32_bf16 v[192:195], a[160:163], v[40:43], v[192:195]
 v_exp_f32 v27, v27
 v_mfma_f32_16x16x32_bf16 v[192:195], a[192:195], v[44:47], v[192:195]
 v_mfma_f32_16x16x32_bf16 v[196:199], a[164:167], v[40:43], v[196:199]
 v_exp_f32 v28, v28
 v_mfma_f32_16x16x32_bf16 v[196:199], a[196:199], v[44:47], v[196:199]
 ds_read_b128 a[128:131], v7 offset:50688
 ds_read_b128 a[132:135], v7 offset:50752
 v_cvt_pk_bf16_f32 v48, v24, v25
 v_cvt_pk_bf16_f32 v49, v26, v27
 v_mfma_f32_16x16x32_bf16 v[200:203], a[168:171], v[40:43], v[200:203]
 s_add_u32 m0, s39, 16960
 v_mfma_f32_16x16x32_bf16 v[200:203], a[200:203], v[44:47], v[200:203]
 buffer_load_dwordx4 v1, s[20:23], s33 offen offset:2048 nt lds
 v_mfma_f32_16x16x32_bf16 v[204:207], a[172:175], v[40:43], v[204:207]
L_pg0_5:
 s_cbranch_execz L_pg0_9
 v_exp_f32 v29, v29
 v_mfma_f32_16x16x32_bf16 v[204:207], a[204:207], v[44:47], v[204:207]
 s_waitcnt lgkmcnt(6)
 ds_read_b128 a[136:139], v7 offset:50816
 ds_read_b128 a[140:143], v7 offset:50880
 v_exp_f32 v30, v30
 v_mfma_f32_16x16x32_bf16 v[24:27], a[96:99], a[0:3], 0
 v_exp_f32 v31, v31
 v_mfma_f32_16x16x32_bf16 v[24:27], a[100:103], a[4:7], v[24:27]
 v_cvt_pk_bf16_f32 v50, v28, v29
 v_cvt_pk_bf16_f32 v51, v30, v31
 v_mfma_f32_16x16x32_bf16 v[24:27], a[104:107], a[8:11], v[24:27]
 v_exp_f32 v32, v32
 v_mfma_f32_16x16x32_bf16 v[24:27], a[108:111], a[12:15], v[24:27]
 s_waitcnt lgkmcnt(4)
 ds_read_b128 a[156:159], v7 offset:51392
 ds_read_b128 a[152:155], v7 offset:51328
 v_exp_f32 v33, v33
 v_smfmac_f32_16x16x64_bf16 a[232:235], a[236:239], v[40:47], v2
 v_mfma_f32_16x16x32_bf16 v[28:31], a[124:127], a[12:15], 0
 v_exp_f32 v34, v34
 v_mfma_f32_16x16x32_bf16 v[28:31], a[120:123], a[8:11], v[28:31]
 v_mfma_f32_16x16x32_bf16 v[28:31], a[116:119], a[4:7], v[28:31]
 ds_read_b128 a[148:151], v7 offset:51264
 ds_read_b128 a[144:147], v7 offset:51200
 v_mfma_f32_16x16x32_bf16 v[28:31], a[112:115], a[0:3], v[28:31]
 v_exp_f32 v35, v35
 v_exp_f32 v36, v36
 v_mfma_f32_16x16x32_bf16 v[208:211], a[176:179], v[40:43], v[208:211]
 v_cvt_pk_bf16_f32 v52, v32, v33
 v_cvt_pk_bf16_f32 v53, v34, v35
 v_mfma_f32_16x16x32_bf16 v[208:211], a[208:211], v[44:47], v[208:211]
 v_mfma_f32_16x16x32_bf16 v[212:215], a[180:183], v[40:43], v[212:215]
 s_add_u32 m0, s39, 16992
 v_exp_f32 v37, v37
 v_mfma_f32_16x16x32_bf16 v[212:215], a[212:215], v[44:47], v[212:215]
 buffer_load_dwordx4 v1, s[20:23], s33 offen offset:3072 nt lds
 v_mfma_f32_16x16x32_bf16 v[216:219], a[184:187], v[40:43], v[216:219]
 s_add_u32 s33, s33, 8192
 v_exp_f32 v38, v38
 v_mfma_f32_16x16x32_bf16 v[216:219], a[216:219], v[44:47], v[216:219]
 v_mfma_f32_16x16x32_bf16 v[220:223], a[188:191], v[40:43], v[220:223]
 v_exp_f32 v39, v39
 v_mfma_f32_16x16x32_bf16 v[220:223], a[220:223], v[44:47], v[220:223]
 s_waitcnt lgkmcnt(4)
 v_mfma_f32_16x16x32_bf16 v[32:35], a[128:131], a[0:3], 0
 v_cvt_pk_bf16_f32 v54, v36, v37
 v_cvt_pk_bf16_f32 v55, v38, v39
 v_mfma_f32_16x16x32_bf16 v[32:35], a[132:135], a[4:7], v[32:35]
 v_exp_f32 v24, v24
 v_mfma_f32_16x16x32_bf16 v[32:35], a[136:139], a[8:11], v[32:35]
 v_mfma_f32_16x16x32_bf16 v[32:35], a[140:143], a[12:15], v[32:35]
 s_waitcnt lgkmcnt(0)
 v_exp_f32 v25, v25
 v_mfma_f32_16x16x32_bf16 v[36:39], a[156:159], a[12:15], 0
 v_exp_f32 v26, v26
 v_mfma_f32_16x16x32_bf16 v[36:39], a[152:155], a[8:11], v[36:39]
 v_mfma_f32_16x16x32_bf16 v[36:39], a[148:151], a[4:7], v[36:39]
 v_exp_f32 v27, v27
 v_mfma_f32_16x16x32_bf16 v[36:39], a[144:147], a[0:3], v[36:39]
 v_mfma_f32_16x16x32_bf16 v[224:227], a[160:163], v[48:51], v[224:227]
 v_exp_f32 v28, v28
 v_mfma_f32_16x16x32_bf16 v[224:227], a[192:195], v[52:55], v[224:227]
 v_cvt_pk_bf16_f32 v40, v24, v25
 v_cvt_pk_bf16_f32 v41, v26, v27
 v_exp_f32 v29, v29
 v_mfma_f32_16x16x32_bf16 v[228:231], a[164:167], v[48:51], v[228:231]
 ds_read_b64_tr_b16 a[160:161], v8 offset:33792
 ds_read_b64_tr_b16 a[162:163], v8 offset:34304
 v_mfma_f32_16x16x32_bf16 v[228:231], a[196:199], v[52:55], v[228:231]
 v_mfma_f32_16x16x32_bf16 v[232:235], a[168:171], v[48:51], v[232:235]
 ds_read_b64_tr_b16 a[192:193], v8 offset:50688
 ds_read_b64_tr_b16 a[194:195], v8 offset:51200
 v_mfma_f32_16x16x32_bf16 v[232:235], a[200:203], v[52:55], v[232:235]
 v_exp_f32 v30, v30
 v_exp_f32 v31, v31
 v_mfma_f32_16x16x32_bf16 v[236:239], a[172:175], v[48:51], v[236:239]
 v_cvt_pk_bf16_f32 v42, v28, v29
 v_cvt_pk_bf16_f32 v43, v30, v31
 v_mfma_f32_16x16x32_bf16 v[236:239], a[204:207], v[52:55], v[236:239]
 ds_read_b64_tr_b16 a[164:165], v8 offset:33824
 ds_read_b64_tr_b16 a[166:167], v8 offset:34336
 v_exp_f32 v32, v32
 v_mfma_f32_16x16x32_bf16 v[24:27], a[96:99], a[16:19], 0
 v_mfma_f32_16x16x32_bf16 v[24:27], a[100:103], a[20:23], v[24:27]
 ds_read_b64_tr_b16 a[196:197], v8 offset:50720
 ds_read_b64_tr_b16 a[198:199], v8 offset:51232
 v_mfma_f32_16x16x32_bf16 v[24:27], a[104:107], a[24:27], v[24:27]
 s_waitcnt vmcnt(48)
 ds_read_b128 a[0:3], v4 offset:0
 ds_read_b128 a[4:7], v4 offset:64
 v_mfma_f32_16x16x32_bf16 v[24:27], a[108:111], a[28:31], v[24:27]
 ds_read_b64_tr_b16 a[168:169], v8 offset:33856
 ds_read_b64_tr_b16 a[170:171], v8 offset:34368
 v_exp_f32 v33, v33
 v_smfmac_f32_16x16x64_bf16 a[232:235], a[240:243], v[48:55], v2
 v_exp_f32 v34, v34
 v_mfma_f32_16x16x32_bf16 v[28:31], a[124:127], a[28:31], 0
 ds_read_b64_tr_b16 a[200:201], v8 offset:50752
 ds_read_b64_tr_b16 a[202:203], v8 offset:51264
 v_mfma_f32_16x16x32_bf16 v[28:31], a[120:123], a[24:27], v[28:31]
 ds_read_b128 a[8:11], v4 offset:128
 ds_read_b128 a[12:15], v4 offset:192
 v_mfma_f32_16x16x32_bf16 v[28:31], a[116:119], a[20:23], v[28:31]
 v_mfma_f32_16x16x32_bf16 v[28:31], a[112:115], a[16:19], v[28:31]
 ds_read_b64_tr_b16 a[172:173], v8 offset:33888
 ds_read_b64_tr_b16 a[174:175], v8 offset:34400
 v_exp_f32 v35, v35
 v_mfma_f32_16x16x32_bf16 v[240:243], a[176:179], v[48:51], v[240:243]
 v_exp_f32 v36, v36
 v_mfma_f32_16x16x32_bf16 v[240:243], a[208:211], v[52:55], v[240:243]
 ds_read_b64_tr_b16 a[204:205], v8 offset:50784
 ds_read_b64_tr_b16 a[206:207], v8 offset:51296
 v_cvt_pk_bf16_f32 v44, v32, v33
 v_cvt_pk_bf16_f32 v45, v34, v35
 v_mfma_f32_16x16x32_bf16 v[244:247], a[180:183], v[48:51], v[244:247]
 v_exp_f32 v37, v37
 v_mfma_f32_16x16x32_bf16 v[244:247], a[212:215], v[52:55], v[244:247]
 v_mfma_f32_16x16x32_bf16 v[248:251], a[184:187], v[48:51], v[248:251]
 v_exp_f32 v38, v38
 v_mfma_f32_16x16x32_bf16 v[248:251], a[216:219], v[52:55], v[248:251]
 ds_read_b64_tr_b16 a[176:177], v8 offset:33920
 ds_read_b64_tr_b16 a[178:179], v8 offset:34432
 v_exp_f32 v39, v39
 v_mfma_f32_16x16x32_bf16 v[252:255], a[188:191], v[48:51], v[252:255]
 v_cvt_pk_bf16_f32 v46, v36, v37
 v_cvt_pk_bf16_f32 v47, v38, v39
 v_mfma_f32_16x16x32_bf16 v[252:255], a[220:223], v[52:55], v[252:255]
 v_mfma_f32_16x16x32_bf16 v[32:35], a[128:131], a[16:19], 0
 s_waitcnt lgkmcnt(6)
 ds_read_b64_tr_b16 a[208:209], v8 offset:50816
 ds_read_b64_tr_b16 a[210:211], v8 offset:51328
 v_mfma_f32_16x16x32_bf16 v[32:35], a[132:135], a[20:23], v[32:35]
 v_exp_f32 v24, v24
 v_mfma_f32_16x16x32_bf16 v[32:35], a[136:139], a[24:27], v[32:35]
 v_mfma_f32_16x16x32_bf16 v[32:35], a[140:143], a[28:31], v[32:35]
 ds_read_b64_tr_b16 a[180:181], v8 offset:33952
 ds_read_b64_tr_b16 a[182:183], v8 offset:34464
 v_exp_f32 v25, v25
 v_mfma_f32_16x16x32_bf16 v[36:39], a[156:159], a[28:31], 0
 v_exp_f32 v26, v26
 v_mfma_f32_16x16x32_bf16 v[36:39], a[152:155], a[24:27], v[36:39]
 s_mov_b32 s59, 20480
 v_exp_f32 v27, v27
 v_mfma_f32_16x16x32_bf16 v[36:39], a[148:151], a[20:23], v[36:39]
 s_add_u32 m0, s45, 0
 ds_read_b64_tr_b16 a[212:213], v8 offset:50848
 ds_read_b64_tr_b16 a[214:215], v8 offset:51360
 v_mfma_f32_16x16x32_bf16 v[36:39], a[144:147], a[16:19], v[36:39]
 s_waitcnt lgkmcnt(15)
 buffer_load_dwordx4 v1, s[28:31], s59 offen nt lds
 v_mfma_f32_16x16x32_bf16 v[64:67], a[160:163], v[40:43], v[64:67]
 v_mfma_f32_16x16x32_bf16 v[64:67], a[192:195], v[44:47], v[64:67]
 ds_read_b64_tr_b16 a[184:185], v8 offset:33984
 ds_read_b64_tr_b16 a[186:187], v8 offset:34496
 v_exp_f32 v28, v28
 v_mfma_f32_16x16x32_bf16 v[68:71], a[164:167], v[40:43], v[68:71]
 v_cvt_pk_bf16_f32 v48, v24, v25
 v_cvt_pk_bf16_f32 v49, v26, v27
 v_mfma_f32_16x16x32_bf16 v[68:71], a[196:199], v[44:47], v[68:71]
 s_waitcnt lgkmcnt(10)
 v_exp_f32 v29, v29
 v_exp_f32 v30, v30
 v_mfma_f32_16x16x32_bf16 v[72:75], a[168:171], v[40:43], v[72:75]
 ds_read_b64_tr_b16 a[216:217], v8 offset:50880
 ds_read_b64_tr_b16 a[218:219], v8 offset:51392
 v_mfma_f32_16x16x32_bf16 v[72:75], a[200:203], v[44:47], v[72:75]
 v_mfma_f32_16x16x32_bf16 v[76:79], a[172:175], v[40:43], v[76:79]
 v_exp_f32 v31, v31
 v_mfma_f32_16x16x32_bf16 v[76:79], a[204:207], v[44:47], v[76:79]
 ds_read_b64_tr_b16 a[188:189], v8 offset:34016
 ds_read_b64_tr_b16 a[190:191], v8 offset:34528
 v_cvt_pk_bf16_f32 v50, v28, v29
 v_cvt_pk_bf16_f32 v51, v30, v31
 v_mfma_f32_16x16x32_bf16 v[24:27], a[96:99], a[32:35], 0
 v_mfma_f32_16x16x32_bf16 v[24:27], a[100:103], a[36:39], v[24:27]
 v_exp_f32 v32, v32
 v_mfma_f32_16x16x32_bf16 v[24:27], a[104:107], a[40:43], v[24:27]
 ds_read_b64_tr_b16 a[220:221], v8 offset:50912
 ds_read_b64_tr_b16 a[222:223], v8 offset:51424
 v_mfma_f32_16x16x32_bf16 v[24:27], a[108:111], a[44:47], v[24:27]
 s_waitcnt vmcnt(37)
 v_exp_f32 v33, v33
 v_smfmac_f32_16x16x64_bf16 a[224:227], a[236:239], v[40:47], v2
 v_mfma_f32_16x16x32_bf16 v[28:31], a[124:127], a[44:47], 0
 v_exp_f32 v34, v34
 v_mfma_f32_16x16x32_bf16 v[28:31], a[120:123], a[40:43], v[28:31]
 v_exp_f32 v35, v35
 v_mfma_f32_16x16x32_bf16 v[28:31], a[116:119], a[36:39], v[28:31]
 v_mfma_f32_16x16x32_bf16 v[28:31], a[112:115], a[32:35], v[28:31]
 s_waitcnt lgkmcnt(8)
 v_exp_f32 v36, v36
 v_cvt_pk_bf16_f32 v52, v32, v33
 v_cvt_pk_bf16_f32 v53, v34, v35
 v_mfma_f32_16x16x32_bf16 v[80:83], a[176:179], v[40:43], v[80:83]
 s_add_u32 m0, s45, 64
 v_mfma_f32_16x16x32_bf16 v[80:83], a[208:211], v[44:47], v[80:83]
 buffer_load_dwordx4 v1, s[28:31], s59 offen offset:1024 nt lds
 v_mfma_f32_16x16x32_bf16 v[84:87], a[180:183], v[40:43], v[84:87]
 ds_read_b128 a[16:19], v4 offset:17408
 ds_read_b128 a[20:23], v4 offset:17472
 v_mfma_f32_16x16x32_bf16 v[84:87], a[212:215], v[44:47], v[84:87]
 s_waitcnt lgkmcnt(2)
 s_barrier
 v_mfma_f32_16x16x32_bf16 v[88:91], a[184:187], v[40:43], v[88:91]
 v_exp_f32 v37, v37
 v_mfma_f32_16x16x32_bf16 v[88:91], a[216:219], v[44:47], v[88:91]
 v_exp_f32 v38, v38
 v_mfma_f32_16x16x32_bf16 v[92:95], a[188:191], v[40:43], v[92:95]
 v_mfma_f32_16x16x32_bf16 v[92:95], a[220:223], v[44:47], v[92:95]
 v_exp_f32 v39, v39
 v_mfma_f32_16x16x32_bf16 v[32:35], a[128:131], a[32:35], 0
 v_cvt_pk_bf16_f32 v54, v36, v37
 v_cvt_pk_bf16_f32 v55, v38, v39
 v_mfma_f32_16x16x32_bf16 v[32:35], a[132:135], a[36:39], v[32:35]
 v_mfma_f32_16x16x32_bf16 v[32:35], a[136:139], a[40:43], v[32:35]
 v_exp_f32 v24, v24
 v_mfma_f32_16x16x32_bf16 v[32:35], a[140:143], a[44:47], v[32:35]
 v_mfma_f32_16x16x32_bf16 v[36:39], a[156:159], a[44:47], 0
 ds_read_b128 a[24:27], v4 offset:17536
 ds_read_b128 a[28:31], v4 offset:17600
 v_mfma_f32_16x16x32_bf16 v[36:39], a[152:155], a[40:43], v[36:39]
 v_exp_f32 v25, v25
 v_mfma_f32_16x16x32_bf16 v[36:39], a[148:151], a[36:39], v[36:39]
 s_add_u32 m0, s39, 33792
 v_exp_f32 v26, v26
 v_mfma_f32_16x16x32_bf16 v[36:39], a[144:147], a[32:35], v[36:39]
 buffer_load_dwordx4 v1, s[20:23], s33 offen nt lds
 v_mfma_f32_16x16x32_bf16 v[96:99], a[160:163], v[48:51], v[96:99]
 v_mfma_f32_16x16x32_bf16 v[96:99], a[192:195], v[52:55], v[96:99]
 v_accvgpr_read_b32 v11, a224
 v_accvgpr_read_b32 v10, a225
 v_add_f32 v11, v11, v10
 v_rcp_f32 v10, v11
 v_cmp_nle_f32 vcc, s60, v11
 v_accvgpr_write_b32 a224, 0
 v_accvgpr_write_b32 a225, 0
 v_pk_mul_f32 v[64:65], v[64:65], v[10:11] op_sel_hi:[1,0]
 v_pk_mul_f32 v[66:67], v[66:67], v[10:11] op_sel_hi:[1,0]
 v_pk_mul_f32 v[68:69], v[68:69], v[10:11] op_sel_hi:[1,0]
 v_pk_mul_f32 v[70:71], v[70:71], v[10:11] op_sel_hi:[1,0]
 v_pk_mul_f32 v[72:73], v[72:73], v[10:11] op_sel_hi:[1,0]
 v_pk_mul_f32 v[74:75], v[74:75], v[10:11] op_sel_hi:[1,0]
 v_pk_mul_f32 v[76:77], v[76:77], v[10:11] op_sel_hi:[1,0]
 v_pk_mul_f32 v[78:79], v[78:79], v[10:11] op_sel_hi:[1,0]
 v_pk_mul_f32 v[80:81], v[80:81], v[10:11] op_sel_hi:[1,0]
 v_pk_mul_f32 v[82:83], v[82:83], v[10:11] op_sel_hi:[1,0]
 v_pk_mul_f32 v[84:85], v[84:85], v[10:11] op_sel_hi:[1,0]
 v_pk_mul_f32 v[86:87], v[86:87], v[10:11] op_sel_hi:[1,0]
 v_pk_mul_f32 v[88:89], v[88:89], v[10:11] op_sel_hi:[1,0]
 v_pk_mul_f32 v[90:91], v[90:91], v[10:11] op_sel_hi:[1,0]
 v_pk_mul_f32 v[92:93], v[92:93], v[10:11] op_sel_hi:[1,0]
 v_pk_mul_f32 v[94:95], v[94:95], v[10:11] op_sel_hi:[1,0]
 v_mfma_f32_16x16x32_bf16 v[100:103], a[164:167], v[48:51], v[100:103]
 v_exp_f32 v27, v27
 v_mfma_f32_16x16x32_bf16 v[100:103], a[196:199], v[52:55], v[100:103]
 v_exp_f32 v28, v28
 v_cvt_pk_bf16_f32 v40, v24, v25
 v_mfma_f32_16x16x32_bf16 v[104:107], a[168:171], v[48:51], v[104:107]
 s_or_b64 s[50:51], s[50:51], vcc
 v_cmp_nge_f32 vcc, s61, v11
 v_add_u32 v12, 17408, v5
 v_mfma_f32_16x16x32_bf16 v[104:107], a[200:203], v[52:55], v[104:107]
 v_cvt_pk_bf16_f32 v41, v26, v27
 v_exp_f32 v29, v29
 v_mfma_f32_16x16x32_bf16 v[108:111], a[172:175], v[48:51], v[108:111]
 v_cvt_pk_bf16_f32 v64, v64, v65
 v_cvt_pk_bf16_f32 v65, v66, v67
 v_mfma_f32_16x16x32_bf16 v[108:111], a[204:207], v[52:55], v[108:111]
 v_exp_f32 v30, v30
 v_cvt_pk_bf16_f32 v68, v68, v69
 v_mfma_f32_16x16x32_bf16 v[24:27], a[96:99], a[48:51], 0
 v_exp_f32 v31, v31
 v_mfma_f32_16x16x32_bf16 v[24:27], a[100:103], a[52:55], v[24:27]
 v_cvt_pk_bf16_f32 v42, v28, v29
 v_cvt_pk_bf16_f32 v43, v30, v31
 v_mfma_f32_16x16x32_bf16 v[24:27], a[104:107], a[56:59], v[24:27]
 v_exp_f32 v32, v32
 v_mfma_f32_16x16x32_bf16 v[24:27], a[108:111], a[60:63], v[24:27]
 v_exp_f32 v33, v33
 v_cvt_pk_bf16_f32 v69, v70, v71
 v_smfmac_f32_16x16x64_bf16 a[224:227], a[240:243], v[48:55], v2
 s_or_b64 s[50:51], s[50:51], vcc
 ds_write2_b64 v12, v[64:65], v[68:69] offset0:0 offset1:4
 v_mfma_f32_16x16x32_bf16 v[28:31], a[124:127], a[60:63], 0
 v_exp_f32 v34, v34
 v_mfma_f32_16x16x32_bf16 v[28:31], a[120:123], a[56:59], v[28:31]
 v_exp_f32 v35, v35
 v_mfma_f32_16x16x32_bf16 v[28:31], a[116:119], a[52:55], v[28:31]
 s_add_u32 m0, s39, 33824
 v_exp_f32 v36, v36
 v_mfma_f32_16x16x32_bf16 v[28:31], a[112:115], a[48:51], v[28:31]
 buffer_load_dwordx4 v1, s[20:23], s33 offen offset:1024 nt lds
 v_mfma_f32_16x16x32_bf16 v[112:115], a[176:179], v[48:51], v[112:115]
 s_add_u32 m0, s45, 128
 v_cvt_pk_bf16_f32 v44, v32, v33
 v_cvt_pk_bf16_f32 v45, v34, v35
 v_mfma_f32_16x16x32_bf16 v[112:115], a[208:211], v[52:55], v[112:115]
 buffer_load_dwordx4 v1, s[28:31], s59 offen offset:2048 nt lds
 v_mfma_f32_16x16x32_bf16 v[116:119], a[180:183], v[48:51], v[116:119]
 s_waitcnt vmcnt(29)
 ds_read_b128 a[32:35], v4 offset:4352
 ds_read_b128 a[36:39], v4 offset:4416
 v_mfma_f32_16x16x32_bf16 v[116:119], a[212:215], v[52:55], v[116:119]
 v_exp_f32 v37, v37
 v_cvt_pk_bf16_f32 v72, v72, v73
 v_mfma_f32_16x16x32_bf16 v[120:123], a[184:187], v[48:51], v[120:123]
 v_exp_f32 v38, v38
 v_mfma_f32_16x16x32_bf16 v[120:123], a[216:219], v[52:55], v[120:123]
 v_exp_f32 v39, v39
 v_cvt_pk_bf16_f32 v73, v74, v75
 v_mfma_f32_16x16x32_bf16 v[124:127], a[188:191], v[48:51], v[124:127]
 v_cvt_pk_bf16_f32 v76, v76, v77
 v_cvt_pk_bf16_f32 v77, v78, v79
 v_mfma_f32_16x16x32_bf16 v[124:127], a[220:223], v[52:55], v[124:127]
 ds_write2_b64 v12, v[72:73], v[76:77] offset0:8 offset1:12
 v_cvt_pk_bf16_f32 v46, v36, v37
 v_cvt_pk_bf16_f32 v47, v38, v39
 v_mfma_f32_16x16x32_bf16 v[32:35], a[128:131], a[48:51], 0
 v_cvt_pk_bf16_f32 v80, v80, v81
 v_cvt_pk_bf16_f32 v81, v82, v83
 v_mfma_f32_16x16x32_bf16 v[32:35], a[132:135], a[52:55], v[32:35]
 v_exp_f32 v24, v24
 v_mfma_f32_16x16x32_bf16 v[32:35], a[136:139], a[56:59], v[32:35]
 v_cvt_pk_bf16_f32 v84, v84, v85
 v_cvt_pk_bf16_f32 v85, v86, v87
 v_mfma_f32_16x16x32_bf16 v[32:35], a[140:143], a[60:63], v[32:35]
 ds_write2_b64 v12, v[80:81], v[84:85] offset0:16 offset1:20
 v_exp_f32 v25, v25
 v_mfma_f32_16x16x32_bf16 v[36:39], a[156:159], a[60:63], 0
 v_exp_f32 v26, v26
 v_mfma_f32_16x16x32_bf16 v[36:39], a[152:155], a[56:59], v[36:39]
 v_exp_f32 v27, v27
 v_mfma_f32_16x16x32_bf16 v[36:39], a[148:151], a[52:55], v[36:39]
 v_cvt_pk_bf16_f32 v88, v88, v89
 v_cvt_pk_bf16_f32 v89, v90, v91
 v_mfma_f32_16x16x32_bf16 v[36:39], a[144:147], a[48:51], v[36:39]
 v_exp_f32 v28, v28
 v_mfma_f32_16x16x32_bf16 v[128:131], a[160:163], v[40:43], v[128:131]
 s_add_u32 m0, s39, 33856
 v_cvt_pk_bf16_f32 v48, v24, v25
 v_cvt_pk_bf16_f32 v49, v26, v27
 v_mfma_f32_16x16x32_bf16 v[128:131], a[192:195], v[44:47], v[128:131]
 buffer_load_dwordx4 v1, s[20:23], s33 offen offset:2048 nt lds
 v_mfma_f32_16x16x32_bf16 v[132:135], a[164:167], v[40:43], v[132:135]
 v_cvt_pk_bf16_f32 v92, v92, v93
 v_cvt_pk_bf16_f32 v93, v94, v95
 v_mfma_f32_16x16x32_bf16 v[132:135], a[196:199], v[44:47], v[132:135]
 v_exp_f32 v29, v29
 v_mfma_f32_16x16x32_bf16 v[136:139], a[168:171], v[40:43], v[136:139]
 ds_read_b128 a[40:43], v4 offset:4480
 ds_read_b128 a[44:47], v4 offset:4544
 v_mfma_f32_16x16x32_bf16 v[136:139], a[200:203], v[44:47], v[136:139]
 v_exp_f32 v30, v30
 v_mfma_f32_16x16x32_bf16 v[140:143], a[172:175], v[40:43], v[140:143]
 v_exp_f32 v31, v31
 v_mfma_f32_16x16x32_bf16 v[140:143], a[204:207], v[44:47], v[140:143]
 ds_write2_b64 v12, v[88:89], v[92:93] offset0:24 offset1:28
 v_mfma_f32_16x16x32_bf16 v[24:27], a[96:99], a[64:67], 0
 v_cvt_pk_bf16_f32 v50, v28, v29
 v_cvt_pk_bf16_f32 v51, v30, v31
 v_mfma_f32_16x16x32_bf16 v[24:27], a[100:103], a[68:71], v[24:27]
 v_exp_f32 v32, v32
 v_mfma_f32_16x16x32_bf16 v[24:27], a[104:107], a[72:75], v[24:27]
 v_exp_f32 v33, v33
 v_mfma_f32_16x16x32_bf16 v[24:27], a[108:111], a[76:79], v[24:27]
 s_add_u32 m0, s45, 192
 v_accvgpr_read_b32 v11, a226
 v_accvgpr_read_b32 v10, a227
 v_add_f32 v11, v11, v10
 v_rcp_f32 v10, v11
 v_cmp_nle_f32 vcc, s60, v11
 v_accvgpr_write_b32 a226, 0
 v_accvgpr_write_b32 a227, 0
 v_pk_mul_f32 v[96:97], v[96:97], v[10:11] op_sel_hi:[1,0]
 v_pk_mul_f32 v[98:99], v[98:99], v[10:11] op_sel_hi:[1,0]
 v_pk_mul_f32 v[100:101], v[100:101], v[10:11] op_sel_hi:[1,0]
 v_pk_mul_f32 v[102:103], v[102:103], v[10:11] op_sel_hi:[1,0]
 v_pk_mul_f32 v[104:105], v[104:105], v[10:11] op_sel_hi:[1,0]
 v_pk_mul_f32 v[106:107], v[106:107], v[10:11] op_sel_hi:[1,0]
 v_pk_mul_f32 v[108:109], v[108:109], v[10:11] op_sel_hi:[1,0]
 v_pk_mul_f32 v[110:111], v[110:111], v[10:11] op_sel_hi:[1,0]
 v_pk_mul_f32 v[112:113], v[112:113], v[10:11] op_sel_hi:[1,0]
 v_pk_mul_f32 v[114:115], v[114:115], v[10:11] op_sel_hi:[1,0]
 v_pk_mul_f32 v[116:117], v[116:117], v[10:11] op_sel_hi:[1,0]
 v_pk_mul_f32 v[118:119], v[118:119], v[10:11] op_sel_hi:[1,0]
 v_pk_mul_f32 v[120:121], v[120:121], v[10:11] op_sel_hi:[1,0]
 v_pk_mul_f32 v[122:123], v[122:123], v[10:11] op_sel_hi:[1,0]
 v_pk_mul_f32 v[124:125], v[124:125], v[10:11] op_sel_hi:[1,0]
 v_pk_mul_f32 v[126:127], v[126:127], v[10:11] op_sel_hi:[1,0]
 v_smfmac_f32_16x16x64_bf16 a[228:231], a[236:239], v[40:47], v2
 buffer_load_dwordx4 v1, s[28:31], s59 offen offset:3072 nt lds
 v_mfma_f32_16x16x32_bf16 v[28:31], a[124:127], a[76:79], 0
 v_exp_f32 v34, v34
 v_mfma_f32_16x16x32_bf16 v[28:31], a[120:123], a[72:75], v[28:31]
 v_exp_f32 v35, v35
 v_mfma_f32_16x16x32_bf16 v[28:31], a[116:119], a[68:71], v[28:31]
 v_exp_f32 v36, v36
 v_mfma_f32_16x16x32_bf16 v[28:31], a[112:115], a[64:67], v[28:31]
 s_or_b64 s[50:51], s[50:51], vcc
 v_cmp_nge_f32 vcc, s61, v11
 v_add_u32 v12, 4352, v5
 v_cvt_pk_bf16_f32 v96, v96, v97
 v_cvt_pk_bf16_f32 v97, v98, v99
 v_mfma_f32_16x16x32_bf16 v[144:147], a[176:179], v[40:43], v[144:147]
 s_add_u32 m0, s39, 33888
 v_cvt_pk_bf16_f32 v52, v32, v33
 v_cvt_pk_bf16_f32 v53, v34, v35
 v_mfma_f32_16x16x32_bf16 v[144:147], a[208:211], v[44:47], v[144:147]
 buffer_load_dwordx4 v1, s[20:23], s33 offen offset:3072 nt lds
 v_cvt_pk_bf16_f32 v100, v100, v101
 v_cvt_pk_bf16_f32 v101, v102, v103
 v_mfma_f32_16x16x32_bf16 v[148:151], a[180:183], v[40:43], v[148:151]
 s_add_u32 s33, s33, 8192
 v_exp_f32 v37, v37
 v_mfma_f32_16x16x32_bf16 v[148:151], a[212:215], v[44:47], v[148:151]
 s_or_b64 s[50:51], s[50:51], vcc
 ds_write2_b64 v12, v[96:97], v[100:101] offset0:0 offset1:4
 v_mfma_f32_16x16x32_bf16 v[152:155], a[184:187], v[40:43], v[152:155]
 v_exp_f32 v38, v38
 v_mfma_f32_16x16x32_bf16 v[152:155], a[216:219], v[44:47], v[152:155]
 s_waitcnt vmcnt(20)
 ds_read_b128 a[48:51], v4 offset:8704
 ds_read_b128 a[52:55], v4 offset:8768
 v_mfma_f32_16x16x32_bf16 v[156:159], a[188:191], v[40:43], v[156:159]
 v_exp_f32 v39, v39
 v_mfma_f32_16x16x32_bf16 v[156:159], a[220:223], v[44:47], v[156:159]
 v_cvt_pk_bf16_f32 v54, v36, v37
 v_cvt_pk_bf16_f32 v55, v38, v39
 v_mfma_f32_16x16x32_bf16 v[32:35], a[128:131], a[64:67], 0
 v_cvt_pk_bf16_f32 v104, v104, v105
 v_cvt_pk_bf16_f32 v105, v106, v107
 v_mfma_f32_16x16x32_bf16 v[32:35], a[132:135], a[68:71], v[32:35]
 v_exp_f32 v24, v24
 v_mfma_f32_16x16x32_bf16 v[32:35], a[136:139], a[72:75], v[32:35]
 v_cvt_pk_bf16_f32 v108, v108, v109
 v_cvt_pk_bf16_f32 v109, v110, v111
 v_mfma_f32_16x16x32_bf16 v[32:35], a[140:143], a[76:79], v[32:35]
 ds_write2_b64 v12, v[104:105], v[108:109] offset0:8 offset1:12
 v_exp_f32 v25, v25
 v_mfma_f32_16x16x32_bf16 v[36:39], a[156:159], a[76:79], 0
 v_exp_f32 v26, v26
 v_mfma_f32_16x16x32_bf16 v[36:39], a[152:155], a[72:75], v[36:39]
 v_exp_f32 v27, v27
 v_mfma_f32_16x16x32_bf16 v[36:39], a[148:151], a[68:71], v[36:39]
 v_cvt_pk_bf16_f32 v112, v112, v113
 v_cvt_pk_bf16_f32 v113, v114, v115
 v_mfma_f32_16x16x32_bf16 v[36:39], a[144:147], a[64:67], v[36:39]
 v_exp_f32 v28, v28
 v_mfma_f32_16x16x32_bf16 v[160:163], a[160:163], v[48:51], v[160:163]
 v_cvt_pk_bf16_f32 v116, v116, v117
 v_cvt_pk_bf16_f32 v117, v118, v119
 v_mfma_f32_16x16x32_bf16 v[160:163], a[192:195], v[52:55], v[160:163]
 v_cvt_pk_bf16_f32 v40, v24, v25
 v_cvt_pk_bf16_f32 v41, v26, v27
 v_mfma_f32_16x16x32_bf16 v[164:167], a[164:167], v[48:51], v[164:167]
 s_add_u32 m0, s39, 50688
 v_exp_f32 v29, v29
 v_mfma_f32_16x16x32_bf16 v[164:167], a[196:199], v[52:55], v[164:167]
 buffer_load_dwordx4 v1, s[20:23], s33 offen nt lds
 v_mfma_f32_16x16x32_bf16 v[168:171], a[168:171], v[48:51], v[168:171]
 v_exp_f32 v30, v30
 v_mfma_f32_16x16x32_bf16 v[168:171], a[200:203], v[52:55], v[168:171]
 ds_write2_b64 v12, v[112:113], v[116:117] offset0:16 offset1:20
 v_mfma_f32_16x16x32_bf16 v[172:175], a[172:175], v[48:51], v[172:175]
 v_exp_f32 v31, v31
 v_mfma_f32_16x16x32_bf16 v[172:175], a[204:207], v[52:55], v[172:175]
 v_cvt_pk_bf16_f32 v120, v120, v121
 v_cvt_pk_bf16_f32 v121, v122, v123
 v_cvt_pk_bf16_f32 v124, v124, v125
 v_mfma_f32_16x16x32_bf16 v[24:27], a[96:99], a[80:83], 0
 v_cvt_pk_bf16_f32 v42, v28, v29
 v_cvt_pk_bf16_f32 v43, v30, v31
 v_mfma_f32_16x16x32_bf16 v[24:27], a[100:103], a[84:87], v[24:27]
 v_exp_f32 v32, v32
 v_mfma_f32_16x16x32_bf16 v[24:27], a[104:107], a[88:91], v[24:27]
 v_exp_f32 v33, v33
 v_mfma_f32_16x16x32_bf16 v[24:27], a[108:111], a[92:95], v[24:27]
 v_exp_f32 v34, v34
 v_cvt_pk_bf16_f32 v125, v126, v127
 v_smfmac_f32_16x16x64_bf16 a[228:231], a[240:243], v[48:55], v2
 ds_write2_b64 v12, v[120:121], v[124:125] offset0:24 offset1:28
 v_mfma_f32_16x16x32_bf16 v[28:31], a[124:127], a[92:95], 0
 ds_read_b128 a[56:59], v4 offset:8832
 ds_read_b128 a[60:63], v4 offset:8896
 v_mfma_f32_16x16x32_bf16 v[28:31], a[120:123], a[88:91], v[28:31]
 v_exp_f32 v35, v35
 v_mfma_f32_16x16x32_bf16 v[28:31], a[116:119], a[84:87], v[28:31]
 v_exp_f32 v36, v36
 v_mfma_f32_16x16x32_bf16 v[28:31], a[112:115], a[80:83], v[28:31]
 s_waitcnt vmcnt(9)
 s_barrier
 v_mfma_f32_16x16x32_bf16 v[176:179], a[176:179], v[48:51], v[176:179]
 v_cvt_pk_bf16_f32 v44, v32, v33
 v_cvt_pk_bf16_f32 v45, v34, v35
 v_mfma_f32_16x16x32_bf16 v[176:179], a[208:211], v[52:55], v[176:179]
 v_exp_f32 v37, v37
 v_mfma_f32_16x16x32_bf16 v[180:183], a[180:183], v[48:51], v[180:183]
 s_add_u32 m0, s39, 50720
 ds_read_b128 a[96:99], v7 offset:0
 ds_read_b128 a[100:103], v7 offset:64
 v_mfma_f32_16x16x32_bf16 v[180:183], a[212:215], v[52:55], v[180:183]
 buffer_load_dwordx4 v1, s[20:23], s33 offen offset:1024 nt lds
 v_mfma_f32_16x16x32_bf16 v[184:187], a[184:187], v[48:51], v[184:187]
 v_exp_f32 v38, v38
 v_mfma_f32_16x16x32_bf16 v[184:187], a[216:219], v[52:55], v[184:187]
 v_accvgpr_read_b32 v11, a228
 v_accvgpr_read_b32 v10, a229
 v_add_f32 v11, v11, v10
 v_rcp_f32 v10, v11
 v_cmp_nle_f32 vcc, s60, v11
 v_accvgpr_write_b32 a228, 0
 v_accvgpr_write_b32 a229, 0
 v_pk_mul_f32 v[128:129], v[128:129], v[10:11] op_sel_hi:[1,0]
 v_pk_mul_f32 v[130:131], v[130:131], v[10:11] op_sel_hi:[1,0]
 v_pk_mul_f32 v[132:133], v[132:133], v[10:11] op_sel_hi:[1,0]
 v_pk_mul_f32 v[134:135], v[134:135], v[10:11] op_sel_hi:[1,0]
 v_pk_mul_f32 v[136:137], v[136:137], v[10:11] op_sel_hi:[1,0]
 v_pk_mul_f32 v[138:139], v[138:139], v[10:11] op_sel_hi:[1,0]
 v_pk_mul_f32 v[140:141], v[140:141], v[10:11] op_sel_hi:[1,0]
 v_pk_mul_f32 v[142:143], v[142:143], v[10:11] op_sel_hi:[1,0]
 v_pk_mul_f32 v[144:145], v[144:145], v[10:11] op_sel_hi:[1,0]
 v_pk_mul_f32 v[146:147], v[146:147], v[10:11] op_sel_hi:[1,0]
 v_pk_mul_f32 v[148:149], v[148:149], v[10:11] op_sel_hi:[1,0]
 v_pk_mul_f32 v[150:151], v[150:151], v[10:11] op_sel_hi:[1,0]
 v_pk_mul_f32 v[152:153], v[152:153], v[10:11] op_sel_hi:[1,0]
 v_pk_mul_f32 v[154:155], v[154:155], v[10:11] op_sel_hi:[1,0]
 v_pk_mul_f32 v[156:157], v[156:157], v[10:11] op_sel_hi:[1,0]
 v_pk_mul_f32 v[158:159], v[158:159], v[10:11] op_sel_hi:[1,0]
 v_mfma_f32_16x16x32_bf16 v[188:191], a[188:191], v[48:51], v[188:191]
 ds_read_b128 a[104:107], v7 offset:128
 ds_read_b128 a[108:111], v7 offset:192
 v_mfma_f32_16x16x32_bf16 v[188:191], a[220:223], v[52:55], v[188:191]
 s_or_b64 s[50:51], s[50:51], vcc
 v_exp_f32 v39, v39
 v_cmp_nge_f32 vcc, s61, v11
 v_mfma_f32_16x16x32_bf16 v[32:35], a[128:131], a[80:83], 0
 v_cvt_pk_bf16_f32 v46, v36, v37
 v_cvt_pk_bf16_f32 v47, v38, v39
 v_mfma_f32_16x16x32_bf16 v[32:35], a[132:135], a[84:87], v[32:35]
 v_exp_f32 v24, v24
 v_mfma_f32_16x16x32_bf16 v[32:35], a[136:139], a[88:91], v[32:35]
 ds_read_b128 a[124:127], v7 offset:704
 ds_read_b128 a[120:123], v7 offset:640
 v_mfma_f32_16x16x32_bf16 v[32:35], a[140:143], a[92:95], v[32:35]
 s_waitcnt vmcnt(13)
 ds_read_b128 a[64:67], v4 offset:13056
 ds_read_b128 a[68:71], v4 offset:13120
 v_add_u32 v12, 8704, v5
 v_mfma_f32_16x16x32_bf16 v[36:39], a[156:159], a[92:95], 0
 v_exp_f32 v25, v25
 v_mfma_f32_16x16x32_bf16 v[36:39], a[152:155], a[88:91], v[36:39]
 v_exp_f32 v26, v26
 v_mfma_f32_16x16x32_bf16 v[36:39], a[148:151], a[84:87], v[36:39]
 ds_read_b128 a[116:119], v7 offset:576
 ds_read_b128 a[112:115], v7 offset:512
 v_mfma_f32_16x16x32_bf16 v[36:39], a[144:147], a[80:83], v[36:39]
 v_exp_f32 v27, v27
 v_cvt_pk_bf16_f32 v128, v128, v129
 v_cvt_pk_bf16_f32 v129, v130, v131
 v_mfma_f32_16x16x32_bf16 v[192:195], a[160:163], v[40:43], v[192:195]
 v_exp_f32 v28, v28
 v_mfma_f32_16x16x32_bf16 v[192:195], a[192:195], v[44:47], v[192:195]
 v_cvt_pk_bf16_f32 v48, v24, v25
 v_cvt_pk_bf16_f32 v49, v26, v27
 v_cvt_pk_bf16_f32 v132, v132, v133
 v_cvt_pk_bf16_f32 v133, v134, v135
 v_mfma_f32_16x16x32_bf16 v[196:199], a[164:167], v[40:43], v[196:199]
 s_or_b64 s[50:51], s[50:51], vcc
 v_exp_f32 v29, v29
 v_mfma_f32_16x16x32_bf16 v[196:199], a[196:199], v[44:47], v[196:199]
 ds_read_b128 a[128:131], v7 offset:16896
 ds_read_b128 a[132:135], v7 offset:16960
 ds_write2_b64 v12, v[128:129], v[132:133] offset0:0 offset1:4
 v_mfma_f32_16x16x32_bf16 v[200:203], a[168:171], v[40:43], v[200:203]
 s_add_u32 m0, s39, 50752
 v_exp_f32 v30, v30
 v_mfma_f32_16x16x32_bf16 v[200:203], a[200:203], v[44:47], v[200:203]
L_pg0_6:
 s_cbranch_execz L_pg0_10
 buffer_load_dwordx4 v1, s[20:23], s33 offen offset:2048 nt lds
 v_mfma_f32_16x16x32_bf16 v[204:207], a[172:175], v[40:43], v[204:207]
 v_exp_f32 v31, v31
 v_mfma_f32_16x16x32_bf16 v[204:207], a[204:207], v[44:47], v[204:207]
 s_waitcnt lgkmcnt(9)
 ds_read_b128 a[136:139], v7 offset:17024
 ds_read_b128 a[140:143], v7 offset:17088
 v_cvt_pk_bf16_f32 v136, v136, v137
 v_cvt_pk_bf16_f32 v137, v138, v139
 v_mfma_f32_16x16x32_bf16 v[24:27], a[96:99], a[0:3], 0
 v_cvt_pk_bf16_f32 v50, v28, v29
 v_cvt_pk_bf16_f32 v51, v30, v31
 v_mfma_f32_16x16x32_bf16 v[24:27], a[100:103], a[4:7], v[24:27]
 v_exp_f32 v32, v32
 v_mfma_f32_16x16x32_bf16 v[24:27], a[104:107], a[8:11], v[24:27]
 v_exp_f32 v33, v33
 v_mfma_f32_16x16x32_bf16 v[24:27], a[108:111], a[12:15], v[24:27]
 s_waitcnt lgkmcnt(5)
 ds_read_b128 a[156:159], v7 offset:17600
 ds_read_b128 a[152:155], v7 offset:17536
 v_cvt_pk_bf16_f32 v140, v140, v141
 v_cvt_pk_bf16_f32 v141, v142, v143
 v_smfmac_f32_16x16x64_bf16 a[232:235], a[236:239], v[40:47], v2
 ds_write2_b64 v12, v[136:137], v[140:141] offset0:8 offset1:12
 v_exp_f32 v34, v34
 v_mfma_f32_16x16x32_bf16 v[28:31], a[124:127], a[12:15], 0
 v_exp_f32 v35, v35
 v_mfma_f32_16x16x32_bf16 v[28:31], a[120:123], a[8:11], v[28:31]
 v_exp_f32 v36, v36
 v_mfma_f32_16x16x32_bf16 v[28:31], a[116:119], a[4:7], v[28:31]
 ds_read_b128 a[148:151], v7 offset:17472
 ds_read_b128 a[144:147], v7 offset:17408
 v_mfma_f32_16x16x32_bf16 v[28:31], a[112:115], a[0:3], v[28:31]
 v_cvt_pk_bf16_f32 v52, v32, v33
 v_cvt_pk_bf16_f32 v53, v34, v35
 v_cvt_pk_bf16_f32 v144, v144, v145
 v_mfma_f32_16x16x32_bf16 v[208:211], a[176:179], v[40:43], v[208:211]
 v_exp_f32 v37, v37
 v_mfma_f32_16x16x32_bf16 v[208:211], a[208:211], v[44:47], v[208:211]
 v_exp_f32 v38, v38
 v_cvt_pk_bf16_f32 v145, v146, v147
 v_mfma_f32_16x16x32_bf16 v[212:215], a[180:183], v[40:43], v[212:215]
 s_add_u32 m0, s39, 50784
 v_exp_f32 v39, v39
 v_mfma_f32_16x16x32_bf16 v[212:215], a[212:215], v[44:47], v[212:215]
 buffer_load_dwordx4 v1, s[20:23], s33 offen offset:3072 nt lds
 v_mfma_f32_16x16x32_bf16 v[216:219], a[184:187], v[40:43], v[216:219]
 s_add_u32 s33, s33, 8192
 v_cvt_pk_bf16_f32 v54, v36, v37
 v_cvt_pk_bf16_f32 v55, v38, v39
 v_mfma_f32_16x16x32_bf16 v[216:219], a[216:219], v[44:47], v[216:219]
 v_mul_f32 v24, s32, v24
 v_mul_f32 v25, s32, v25
 v_exp_f32 v24, v24
 v_mfma_f32_16x16x32_bf16 v[220:223], a[188:191], v[40:43], v[220:223]
 v_exp_f32 v25, v25
 v_mfma_f32_16x16x32_bf16 v[220:223], a[220:223], v[44:47], v[220:223]
 s_waitcnt lgkmcnt(5)
 v_mul_f32 v26, s32, v26
 v_mul_f32 v27, s32, v27
 v_cvt_pk_bf16_f32 v148, v148, v149
 v_cvt_pk_bf16_f32 v149, v150, v151
 v_mfma_f32_16x16x32_bf16 v[32:35], a[128:131], a[0:3], 0
 v_exp_f32 v26, v26
 v_mfma_f32_16x16x32_bf16 v[32:35], a[132:135], a[4:7], v[32:35]
 v_exp_f32 v27, v27
 v_mfma_f32_16x16x32_bf16 v[32:35], a[136:139], a[8:11], v[32:35]
 v_mul_f32 v28, s32, v28
 v_mul_f32 v29, s32, v29
 v_mfma_f32_16x16x32_bf16 v[32:35], a[140:143], a[12:15], v[32:35]
 s_waitcnt lgkmcnt(0)
 ds_read_b128 a[72:75], v4 offset:13184
 ds_read_b128 a[76:79], v4 offset:13248
 ds_write2_b64 v12, v[144:145], v[148:149] offset0:16 offset1:20
 v_mfma_f32_16x16x32_bf16 v[36:39], a[156:159], a[12:15], 0
 v_cvt_pk_bf16_f32 v40, v24, v25
 v_cvt_pk_bf16_f32 v41, v26, v27
 v_mfma_f32_16x16x32_bf16 v[36:39], a[152:155], a[8:11], v[36:39]
 v_exp_f32 v28, v28
 v_mfma_f32_16x16x32_bf16 v[36:39], a[148:151], a[4:7], v[36:39]
 v_exp_f32 v29, v29
 v_mfma_f32_16x16x32_bf16 v[36:39], a[144:147], a[0:3], v[36:39]
 v_mul_f32 v30, s32, v30
 v_mul_f32 v31, s32, v31
 v_cvt_pk_bf16_f32 v152, v152, v153
 v_cvt_pk_bf16_f32 v153, v154, v155
 v_mfma_f32_16x16x32_bf16 v[224:227], a[160:163], v[48:51], v[224:227]
 v_exp_f32 v30, v30
 v_mfma_f32_16x16x32_bf16 v[224:227], a[192:195], v[52:55], v[224:227]
 v_exp_f32 v31, v31
 v_cvt_pk_bf16_f32 v156, v156, v157
 v_cvt_pk_bf16_f32 v157, v158, v159
 v_mfma_f32_16x16x32_bf16 v[228:231], a[164:167], v[48:51], v[228:231]
 ds_read_b64_tr_b16 a[160:161], v8 offset:0
 ds_read_b64_tr_b16 a[162:163], v8 offset:512
 v_mfma_f32_16x16x32_bf16 v[228:231], a[196:199], v[52:55], v[228:231]
 ds_write2_b64 v12, v[152:153], v[156:157] offset0:24 offset1:28
 v_cvt_pk_bf16_f32 v42, v28, v29
 v_cvt_pk_bf16_f32 v43, v30, v31
 v_mfma_f32_16x16x32_bf16 v[232:235], a[168:171], v[48:51], v[232:235]
 ds_read_b64_tr_b16 a[192:193], v8 offset:16896
 ds_read_b64_tr_b16 a[194:195], v8 offset:17408
 v_mfma_f32_16x16x32_bf16 v[232:235], a[200:203], v[52:55], v[232:235]
 v_mul_f32 v32, s32, v32
 v_mul_f32 v33, s32, v33
 v_exp_f32 v32, v32
 v_mfma_f32_16x16x32_bf16 v[236:239], a[172:175], v[48:51], v[236:239]
 s_waitcnt lgkmcnt(15)
 v_exp_f32 v33, v33
 v_mfma_f32_16x16x32_bf16 v[236:239], a[204:207], v[52:55], v[236:239]
 ds_read_b64_tr_b16 a[164:165], v8 offset:32
 ds_read_b64_tr_b16 a[166:167], v8 offset:544
 v_mul_f32 v34, s32, v34
 v_mul_f32 v35, s32, v35
 v_mfma_f32_16x16x32_bf16 v[24:27], a[96:99], a[16:19], 0
 v_accvgpr_read_b32 v11, a230
 v_accvgpr_read_b32 v10, a231
 v_add_f32 v11, v11, v10
 v_rcp_f32 v10, v11
 v_cmp_nle_f32 vcc, s60, v11
 v_accvgpr_write_b32 a230, 0
 v_accvgpr_write_b32 a231, 0
 v_pk_mul_f32 v[160:161], v[160:161], v[10:11] op_sel_hi:[1,0]
 v_pk_mul_f32 v[162:163], v[162:163], v[10:11] op_sel_hi:[1,0]
 v_pk_mul_f32 v[164:165], v[164:165], v[10:11] op_sel_hi:[1,0]
 v_pk_mul_f32 v[166:167], v[166:167], v[10:11] op_sel_hi:[1,0]
 v_pk_mul_f32 v[168:169], v[168:169], v[10:11] op_sel_hi:[1,0]
 v_pk_mul_f32 v[170:171], v[170:171], v[10:11] op_sel_hi:[1,0]
 v_pk_mul_f32 v[172:173], v[172:173], v[10:11] op_sel_hi:[1,0]
 v_pk_mul_f32 v[174:175], v[174:175], v[10:11] op_sel_hi:[1,0]
 v_pk_mul_f32 v[176:177], v[176:177], v[10:11] op_sel_hi:[1,0]
 v_pk_mul_f32 v[178:179], v[178:179], v[10:11] op_sel_hi:[1,0]
 v_pk_mul_f32 v[180:181], v[180:181], v[10:11] op_sel_hi:[1,0]
 v_pk_mul_f32 v[182:183], v[182:183], v[10:11] op_sel_hi:[1,0]
 v_pk_mul_f32 v[184:185], v[184:185], v[10:11] op_sel_hi:[1,0]
 v_pk_mul_f32 v[186:187], v[186:187], v[10:11] op_sel_hi:[1,0]
 v_pk_mul_f32 v[188:189], v[188:189], v[10:11] op_sel_hi:[1,0]
 v_pk_mul_f32 v[190:191], v[190:191], v[10:11] op_sel_hi:[1,0]
 v_mfma_f32_16x16x32_bf16 v[24:27], a[100:103], a[20:23], v[24:27]
 ds_read_b64_tr_b16 a[196:197], v8 offset:16928
 ds_read_b64_tr_b16 a[198:199], v8 offset:17440
 v_mfma_f32_16x16x32_bf16 v[24:27], a[104:107], a[24:27], v[24:27]
 s_or_b64 s[50:51], s[50:51], vcc
 v_exp_f32 v34, v34
 v_mfma_f32_16x16x32_bf16 v[24:27], a[108:111], a[28:31], v[24:27]
 ds_read_b64_tr_b16 a[168:169], v8 offset:64
 ds_read_b64_tr_b16 a[170:171], v8 offset:576
 v_exp_f32 v35, v35
 v_cmp_nge_f32 vcc, s61, v11
 v_add_u32 v12, 13056, v5
 v_cvt_pk_bf16_f32 v160, v160, v161
 v_cvt_pk_bf16_f32 v161, v162, v163
 v_cvt_pk_bf16_f32 v164, v164, v165
 v_cvt_pk_bf16_f32 v165, v166, v167
 v_smfmac_f32_16x16x64_bf16 a[232:235], a[240:243], v[48:55], v2
 s_or_b64 s[50:51], s[50:51], vcc
 ds_write2_b64 v12, v[160:161], v[164:165] offset0:0 offset1:4
 v_mul_f32 v36, s32, v36
 v_mul_f32 v37, s32, v37
 v_cvt_pk_bf16_f32 v44, v32, v33
 v_mfma_f32_16x16x32_bf16 v[28:31], a[124:127], a[28:31], 0
 ds_read_b64_tr_b16 a[200:201], v8 offset:16960
 ds_read_b64_tr_b16 a[202:203], v8 offset:17472
 v_mfma_f32_16x16x32_bf16 v[28:31], a[120:123], a[24:27], v[28:31]
 ds_read_b128 v[56:59], v6 offset:19584
 v_cvt_pk_bf16_f32 v45, v34, v35
 v_mfma_f32_16x16x32_bf16 v[28:31], a[116:119], a[20:23], v[28:31]
 v_exp_f32 v36, v36
 v_mfma_f32_16x16x32_bf16 v[28:31], a[112:115], a[16:19], v[28:31]
 ds_read_b64_tr_b16 a[172:173], v8 offset:96
 ds_read_b64_tr_b16 a[174:175], v8 offset:608
 v_exp_f32 v37, v37
 v_mfma_f32_16x16x32_bf16 v[240:243], a[176:179], v[48:51], v[240:243]
 v_mul_f32 v38, s32, v38
 v_mul_f32 v39, s32, v39
 v_mfma_f32_16x16x32_bf16 v[240:243], a[208:211], v[52:55], v[240:243]
 ds_read_b64_tr_b16 a[204:205], v8 offset:16992
 ds_read_b64_tr_b16 a[206:207], v8 offset:17504
 v_mfma_f32_16x16x32_bf16 v[244:247], a[180:183], v[48:51], v[244:247]
 v_exp_f32 v38, v38
 v_mfma_f32_16x16x32_bf16 v[244:247], a[212:215], v[52:55], v[244:247]
 v_exp_f32 v39, v39
 v_mfma_f32_16x16x32_bf16 v[248:251], a[184:187], v[48:51], v[248:251]
 v_cvt_pk_bf16_f32 v46, v36, v37
 v_cvt_pk_bf16_f32 v47, v38, v39
 v_mfma_f32_16x16x32_bf16 v[248:251], a[216:219], v[52:55], v[248:251]
 ds_read_b64_tr_b16 a[176:177], v8 offset:128
 ds_read_b64_tr_b16 a[178:179], v8 offset:640
 v_mfma_f32_16x16x32_bf16 v[252:255], a[188:191], v[48:51], v[252:255]
 s_mov_b32 s38, 2048
 v_mul_f32 v24, s32, v24
 v_mul_f32 v25, s32, v25
 v_mfma_f32_16x16x32_bf16 v[252:255], a[220:223], v[52:55], v[252:255]
 s_waitcnt lgkmcnt(6)
 buffer_store_dwordx4 v[56:59], v1, s[24:27], s38 offen sc1 nt
 v_mfma_f32_16x16x32_bf16 v[32:35], a[128:131], a[16:19], 0
 ds_read_b64_tr_b16 a[208:209], v8 offset:17024
 ds_read_b64_tr_b16 a[210:211], v8 offset:17536
 v_mfma_f32_16x16x32_bf16 v[32:35], a[132:135], a[20:23], v[32:35]
 v_exp_f32 v24, v24
 v_mfma_f32_16x16x32_bf16 v[32:35], a[136:139], a[24:27], v[32:35]
 v_exp_f32 v25, v25
 v_mfma_f32_16x16x32_bf16 v[32:35], a[140:143], a[28:31], v[32:35]
 ds_read_b64_tr_b16 a[180:181], v8 offset:160
 ds_read_b64_tr_b16 a[182:183], v8 offset:672
 v_mfma_f32_16x16x32_bf16 v[36:39], a[156:159], a[28:31], 0
 v_mul_f32 v26, s32, v26
 v_mul_f32 v27, s32, v27
 v_mfma_f32_16x16x32_bf16 v[36:39], a[152:155], a[24:27], v[36:39]
 v_exp_f32 v26, v26
 v_mfma_f32_16x16x32_bf16 v[36:39], a[148:151], a[20:23], v[36:39]
 ds_read_b64_tr_b16 a[212:213], v8 offset:17056
 ds_read_b64_tr_b16 a[214:215], v8 offset:17568
 v_mfma_f32_16x16x32_bf16 v[36:39], a[144:147], a[16:19], v[36:39]
 s_waitcnt lgkmcnt(15)
 v_exp_f32 v27, v27
 v_mul_f32 v28, s32, v28
 v_mfma_f32_16x16x32_bf16 v[64:67], a[160:163], v[40:43], 0
 v_mul_f32 v29, s32, v29
 v_cvt_pk_bf16_f32 v48, v24, v25
 v_mfma_f32_16x16x32_bf16 v[64:67], a[192:195], v[44:47], v[64:67]
 ds_read_b64_tr_b16 a[184:185], v8 offset:192
 ds_read_b64_tr_b16 a[186:187], v8 offset:704
 v_cvt_pk_bf16_f32 v49, v26, v27
 v_mfma_f32_16x16x32_bf16 v[68:71], a[164:167], v[40:43], 0
 v_exp_f32 v28, v28
 v_mfma_f32_16x16x32_bf16 v[68:71], a[196:199], v[44:47], v[68:71]
 s_waitcnt lgkmcnt(10)
 v_exp_f32 v29, v29
 v_cvt_pk_bf16_f32 v168, v168, v169
 v_mfma_f32_16x16x32_bf16 v[72:75], a[168:171], v[40:43], 0
 ds_read_b64_tr_b16 a[216:217], v8 offset:17088
 ds_read_b64_tr_b16 a[218:219], v8 offset:17600
 v_mfma_f32_16x16x32_bf16 v[72:75], a[200:203], v[44:47], v[72:75]
 v_mul_f32 v30, s32, v30
 v_mul_f32 v31, s32, v31
 v_cvt_pk_bf16_f32 v169, v170, v171
 v_mfma_f32_16x16x32_bf16 v[76:79], a[172:175], v[40:43], 0
 s_waitcnt lgkmcnt(15)
 v_exp_f32 v30, v30
 v_mfma_f32_16x16x32_bf16 v[76:79], a[204:207], v[44:47], v[76:79]
 ds_read_b64_tr_b16 a[188:189], v8 offset:224
 ds_read_b64_tr_b16 a[190:191], v8 offset:736
 v_cvt_pk_bf16_f32 v172, v172, v173
 v_mfma_f32_16x16x32_bf16 v[24:27], a[96:99], a[32:35], 0
 v_exp_f32 v31, v31
 v_mfma_f32_16x16x32_bf16 v[24:27], a[100:103], a[36:39], v[24:27]
 v_cvt_pk_bf16_f32 v50, v28, v29
 v_cvt_pk_bf16_f32 v51, v30, v31
 v_mfma_f32_16x16x32_bf16 v[24:27], a[104:107], a[40:43], v[24:27]
 ds_read_b64_tr_b16 a[220:221], v8 offset:17120
 ds_read_b64_tr_b16 a[222:223], v8 offset:17632
 v_mfma_f32_16x16x32_bf16 v[24:27], a[108:111], a[44:47], v[24:27]
 v_mul_f32 v32, s32, v32
 v_mul_f32 v33, s32, v33
 v_cvt_pk_bf16_f32 v173, v174, v175
 v_smfmac_f32_16x16x64_bf16 a[224:227], a[236:239], v[40:47], v2
 ds_write2_b64 v12, v[168:169], v[172:173] offset0:8 offset1:12
 v_mfma_f32_16x16x32_bf16 v[28:31], a[124:127], a[44:47], 0
 v_exp_f32 v32, v32
 v_mfma_f32_16x16x32_bf16 v[28:31], a[120:123], a[40:43], v[28:31]
 v_exp_f32 v33, v33
 v_mfma_f32_16x16x32_bf16 v[28:31], a[116:119], a[36:39], v[28:31]
 v_mul_f32 v34, s32, v34
 v_mul_f32 v35, s32, v35
 v_mfma_f32_16x16x32_bf16 v[28:31], a[112:115], a[32:35], v[28:31]
 s_waitcnt lgkmcnt(9)
 v_exp_f32 v34, v34
 v_cvt_pk_bf16_f32 v176, v176, v177
 v_mfma_f32_16x16x32_bf16 v[80:83], a[176:179], v[40:43], 0
 v_exp_f32 v35, v35
 v_mfma_f32_16x16x32_bf16 v[80:83], a[208:211], v[44:47], v[80:83]
 v_mul_f32 v36, s32, v36
 v_mul_f32 v37, s32, v37
 v_cvt_pk_bf16_f32 v177, v178, v179
 v_mfma_f32_16x16x32_bf16 v[84:87], a[180:183], v[40:43], 0
 v_cvt_pk_bf16_f32 v52, v32, v33
 v_cvt_pk_bf16_f32 v53, v34, v35
 v_mfma_f32_16x16x32_bf16 v[84:87], a[212:215], v[44:47], v[84:87]
 s_waitcnt lgkmcnt(1)
 s_barrier
 v_mfma_f32_16x16x32_bf16 v[88:91], a[184:187], v[40:43], 0
 v_exp_f32 v36, v36
 v_mfma_f32_16x16x32_bf16 v[88:91], a[216:219], v[44:47], v[88:91]
 v_exp_f32 v37, v37
 v_cvt_pk_bf16_f32 v180, v180, v181
 v_mfma_f32_16x16x32_bf16 v[92:95], a[188:191], v[40:43], 0
 v_mul_f32 v38, s32, v38
 v_mul_f32 v39, s32, v39
 v_mfma_f32_16x16x32_bf16 v[92:95], a[220:223], v[44:47], v[92:95]
 v_exp_f32 v38, v38
 v_cvt_pk_bf16_f32 v181, v182, v183
 v_mfma_f32_16x16x32_bf16 v[32:35], a[128:131], a[32:35], 0
 v_exp_f32 v39, v39
 v_mfma_f32_16x16x32_bf16 v[32:35], a[132:135], a[36:39], v[32:35]
 v_cvt_pk_bf16_f32 v54, v36, v37
 v_cvt_pk_bf16_f32 v55, v38, v39
 v_mfma_f32_16x16x32_bf16 v[32:35], a[136:139], a[40:43], v[32:35]
 v_mul_f32 v24, s32, v24
 v_mul_f32 v25, s32, v25
 v_mfma_f32_16x16x32_bf16 v[32:35], a[140:143], a[44:47], v[32:35]
 ds_write2_b64 v12, v[176:177], v[180:181] offset0:16 offset1:20
 v_exp_f32 v24, v24
 v_mfma_f32_16x16x32_bf16 v[36:39], a[156:159], a[44:47], 0
 v_exp_f32 v25, v25
 v_mfma_f32_16x16x32_bf16 v[36:39], a[152:155], a[40:43], v[36:39]
 v_mul_f32 v26, s32, v26
 v_mul_f32 v27, s32, v27
 v_mfma_f32_16x16x32_bf16 v[36:39], a[148:151], a[36:39], v[36:39]
 s_add_u32 m0, s39, 0
 v_exp_f32 v26, v26
 v_mfma_f32_16x16x32_bf16 v[36:39], a[144:147], a[32:35], v[36:39]
 buffer_load_dwordx4 v1, s[20:23], s33 offen nt lds
 v_mfma_f32_16x16x32_bf16 v[96:99], a[160:163], v[48:51], 0
 v_exp_f32 v27, v27
 v_mfma_f32_16x16x32_bf16 v[96:99], a[192:195], v[52:55], v[96:99]
 v_mul_f32 v28, s32, v28
 v_mul_f32 v29, s32, v29
 v_cvt_pk_bf16_f32 v184, v184, v185
 v_mfma_f32_16x16x32_bf16 v[100:103], a[164:167], v[48:51], 0
 v_cvt_pk_bf16_f32 v40, v24, v25
 v_cvt_pk_bf16_f32 v41, v26, v27
 v_mfma_f32_16x16x32_bf16 v[100:103], a[196:199], v[52:55], v[100:103]
 v_exp_f32 v28, v28
 v_cvt_pk_bf16_f32 v185, v186, v187
 v_mfma_f32_16x16x32_bf16 v[104:107], a[168:171], v[48:51], 0
 v_exp_f32 v29, v29
 v_mfma_f32_16x16x32_bf16 v[104:107], a[200:203], v[52:55], v[104:107]
 v_mul_f32 v30, s32, v30
 v_mul_f32 v31, s32, v31
 v_cvt_pk_bf16_f32 v188, v188, v189
 v_cvt_pk_bf16_f32 v189, v190, v191
 v_mfma_f32_16x16x32_bf16 v[108:111], a[172:175], v[48:51], 0
 s_waitcnt lgkmcnt(15)
 v_exp_f32 v30, v30
 v_mfma_f32_16x16x32_bf16 v[108:111], a[204:207], v[52:55], v[108:111]
 ds_write2_b64 v12, v[184:185], v[188:189] offset0:24 offset1:28
 v_exp_f32 v31, v31
 v_mfma_f32_16x16x32_bf16 v[24:27], a[96:99], a[48:51], 0
 v_cvt_pk_bf16_f32 v42, v28, v29
 v_cvt_pk_bf16_f32 v43, v30, v31
 v_mfma_f32_16x16x32_bf16 v[24:27], a[100:103], a[52:55], v[24:27]
 s_waitcnt vmcnt(7)
 v_mul_f32 v32, s32, v32
 v_mul_f32 v33, s32, v33
 v_mfma_f32_16x16x32_bf16 v[24:27], a[104:107], a[56:59], v[24:27]
 v_exp_f32 v32, v32
 v_mfma_f32_16x16x32_bf16 v[24:27], a[108:111], a[60:63], v[24:27]
 v_exp_f32 v33, v33
 v_mul_f32 v34, s32, v34
 v_smfmac_f32_16x16x64_bf16 a[224:227], a[240:243], v[48:55], v2
 ds_read_b128 a[80:83], v4 offset:0
 ds_read_b128 a[84:87], v4 offset:64
 v_mul_f32 v35, s32, v35
 v_mfma_f32_16x16x32_bf16 v[28:31], a[124:127], a[60:63], 0
 v_exp_f32 v34, v34
 v_mfma_f32_16x16x32_bf16 v[28:31], a[120:123], a[56:59], v[28:31]
 v_exp_f32 v35, v35
 v_mfma_f32_16x16x32_bf16 v[28:31], a[116:119], a[52:55], v[28:31]
 s_add_u32 m0, s39, 32
 v_mul_f32 v36, s32, v36
 v_mul_f32 v37, s32, v37
 v_mfma_f32_16x16x32_bf16 v[28:31], a[112:115], a[48:51], v[28:31]
 buffer_load_dwordx4 v1, s[20:23], s33 offen offset:1024 nt lds
 v_mfma_f32_16x16x32_bf16 v[112:115], a[176:179], v[48:51], 0
 ds_read_b128 a[88:91], v4 offset:128
 ds_read_b128 a[92:95], v4 offset:192
 v_mfma_f32_16x16x32_bf16 v[112:115], a[208:211], v[52:55], v[112:115]
 v_accvgpr_read_b32 v11, a232
 v_accvgpr_read_b32 v10, a233
 v_add_f32 v11, v11, v10
 v_rcp_f32 v10, v11
 v_cmp_nle_f32 vcc, s60, v11
 v_accvgpr_write_b32 a232, 0
 v_accvgpr_write_b32 a233, 0
 v_pk_mul_f32 v[192:193], v[192:193], v[10:11] op_sel_hi:[1,0]
 v_pk_mul_f32 v[194:195], v[194:195], v[10:11] op_sel_hi:[1,0]
 v_pk_mul_f32 v[196:197], v[196:197], v[10:11] op_sel_hi:[1,0]
 v_pk_mul_f32 v[198:199], v[198:199], v[10:11] op_sel_hi:[1,0]
 v_pk_mul_f32 v[200:201], v[200:201], v[10:11] op_sel_hi:[1,0]
 v_pk_mul_f32 v[202:203], v[202:203], v[10:11] op_sel_hi:[1,0]
 v_pk_mul_f32 v[204:205], v[204:205], v[10:11] op_sel_hi:[1,0]
 v_pk_mul_f32 v[206:207], v[206:207], v[10:11] op_sel_hi:[1,0]
 v_pk_mul_f32 v[208:209], v[208:209], v[10:11] op_sel_hi:[1,0]
 v_pk_mul_f32 v[210:211], v[210:211], v[10:11] op_sel_hi:[1,0]
 v_pk_mul_f32 v[212:213], v[212:213], v[10:11] op_sel_hi:[1,0]
 v_pk_mul_f32 v[214:215], v[214:215], v[10:11] op_sel_hi:[1,0]
 v_pk_mul_f32 v[216:217], v[216:217], v[10:11] op_sel_hi:[1,0]
 v_pk_mul_f32 v[218:219], v[218:219], v[10:11] op_sel_hi:[1,0]
 v_pk_mul_f32 v[220:221], v[220:221], v[10:11] op_sel_hi:[1,0]
 v_pk_mul_f32 v[222:223], v[222:223], v[10:11] op_sel_hi:[1,0]
 v_mfma_f32_16x16x32_bf16 v[116:119], a[180:183], v[48:51], 0
 v_cvt_pk_bf16_f32 v44, v32, v33
 v_cvt_pk_bf16_f32 v45, v34, v35
 v_mfma_f32_16x16x32_bf16 v[116:119], a[212:215], v[52:55], v[116:119]
 s_or_b64 s[50:51], s[50:51], vcc
 v_exp_f32 v36, v36
 v_cmp_nge_f32 vcc, s61, v11
 v_mfma_f32_16x16x32_bf16 v[120:123], a[184:187], v[48:51], 0
 v_exp_f32 v37, v37
 v_mfma_f32_16x16x32_bf16 v[120:123], a[216:219], v[52:55], v[120:123]
 v_mul_f32 v38, s32, v38
 v_mul_f32 v39, s32, v39
 v_add_u32 v12, 0, v5
 v_mfma_f32_16x16x32_bf16 v[124:127], a[188:191], v[48:51], 0
 v_exp_f32 v38, v38
 v_mfma_f32_16x16x32_bf16 v[124:127], a[220:223], v[52:55], v[124:127]
 v_exp_f32 v39, v39
 v_cvt_pk_bf16_f32 v192, v192, v193
 v_cvt_pk_bf16_f32 v193, v194, v195
 v_mfma_f32_16x16x32_bf16 v[32:35], a[128:131], a[48:51], 0
 v_cvt_pk_bf16_f32 v46, v36, v37
 v_cvt_pk_bf16_f32 v47, v38, v39
 v_mfma_f32_16x16x32_bf16 v[32:35], a[132:135], a[52:55], v[32:35]
 v_mul_f32 v24, s32, v24
 v_mul_f32 v25, s32, v25
 v_mfma_f32_16x16x32_bf16 v[32:35], a[136:139], a[56:59], v[32:35]
 v_exp_f32 v24, v24
 v_mfma_f32_16x16x32_bf16 v[32:35], a[140:143], a[60:63], v[32:35]
 v_exp_f32 v25, v25
 v_cvt_pk_bf16_f32 v196, v196, v197
 v_cvt_pk_bf16_f32 v197, v198, v199
 v_mfma_f32_16x16x32_bf16 v[36:39], a[156:159], a[60:63], 0
 v_mul_f32 v26, s32, v26
 v_mul_f32 v27, s32, v27
 v_mfma_f32_16x16x32_bf16 v[36:39], a[152:155], a[56:59], v[36:39]
 v_exp_f32 v26, v26
 v_mfma_f32_16x16x32_bf16 v[36:39], a[148:151], a[52:55], v[36:39]
 v_exp_f32 v27, v27
 v_mfma_f32_16x16x32_bf16 v[36:39], a[144:147], a[48:51], v[36:39]
 s_or_b64 s[50:51], s[50:51], vcc
 ds_write2_b64 v12, v[192:193], v[196:197] offset0:0 offset1:4
 v_mul_f32 v28, s32, v28
 v_mul_f32 v29, s32, v29
 v_mfma_f32_16x16x32_bf16 v[128:131], a[160:163], v[40:43], 0
 s_add_u32 m0, s39, 64
 v_cvt_pk_bf16_f32 v48, v24, v25
 v_cvt_pk_bf16_f32 v49, v26, v27
 v_mfma_f32_16x16x32_bf16 v[128:131], a[192:195], v[44:47], v[128:131]
 buffer_load_dwordx4 v1, s[20:23], s33 offen offset:2048 nt lds
 v_cvt_pk_bf16_f32 v200, v200, v201
 v_mfma_f32_16x16x32_bf16 v[132:135], a[164:167], v[40:43], 0
 v_exp_f32 v28, v28
 v_mfma_f32_16x16x32_bf16 v[132:135], a[196:199], v[44:47], v[132:135]
 v_exp_f32 v29, v29
 v_cvt_pk_bf16_f32 v201, v202, v203
 v_cvt_pk_bf16_f32 v204, v204, v205
 v_cvt_pk_bf16_f32 v205, v206, v207
 v_mfma_f32_16x16x32_bf16 v[136:139], a[168:171], v[40:43], 0
 v_mul_f32 v30, s32, v30
 v_mul_f32 v31, s32, v31
 v_mfma_f32_16x16x32_bf16 v[136:139], a[200:203], v[44:47], v[136:139]
 ds_write2_b64 v12, v[200:201], v[204:205] offset0:8 offset1:12
 v_exp_f32 v30, v30
 v_mfma_f32_16x16x32_bf16 v[140:143], a[172:175], v[40:43], 0
 s_waitcnt lgkmcnt(15)
 v_exp_f32 v31, v31
 v_mfma_f32_16x16x32_bf16 v[140:143], a[204:207], v[44:47], v[140:143]
 v_cvt_pk_bf16_f32 v50, v28, v29
 v_cvt_pk_bf16_f32 v51, v30, v31
 v_cvt_pk_bf16_f32 v208, v208, v209
 v_cvt_pk_bf16_f32 v209, v210, v211
 v_mfma_f32_16x16x32_bf16 v[24:27], a[96:99], a[64:67], 0
 v_mul_f32 v32, s32, v32
 v_mul_f32 v33, s32, v33
 v_mfma_f32_16x16x32_bf16 v[24:27], a[100:103], a[68:71], v[24:27]
 v_exp_f32 v32, v32
 v_mfma_f32_16x16x32_bf16 v[24:27], a[104:107], a[72:75], v[24:27]
 v_exp_f32 v33, v33
 v_mfma_f32_16x16x32_bf16 v[24:27], a[108:111], a[76:79], v[24:27]
 v_mul_f32 v34, s32, v34
 v_mul_f32 v35, s32, v35
 v_cvt_pk_bf16_f32 v212, v212, v213
 v_cvt_pk_bf16_f32 v213, v214, v215
 v_smfmac_f32_16x16x64_bf16 a[228:231], a[236:239], v[40:47], v2
 ds_write2_b64 v12, v[208:209], v[212:213] offset0:16 offset1:20
 v_exp_f32 v34, v34
 v_mfma_f32_16x16x32_bf16 v[28:31], a[124:127], a[76:79], 0
 v_exp_f32 v35, v35
 v_mfma_f32_16x16x32_bf16 v[28:31], a[120:123], a[72:75], v[28:31]
 v_mul_f32 v36, s32, v36
 v_mul_f32 v37, s32, v37
 v_mfma_f32_16x16x32_bf16 v[28:31], a[116:119], a[68:71], v[28:31]
 v_cvt_pk_bf16_f32 v52, v32, v33
 v_cvt_pk_bf16_f32 v53, v34, v35
 v_mfma_f32_16x16x32_bf16 v[28:31], a[112:115], a[64:67], v[28:31]
 v_exp_f32 v36, v36
 v_cvt_pk_bf16_f32 v216, v216, v217
 v_cvt_pk_bf16_f32 v217, v218, v219
 v_mfma_f32_16x16x32_bf16 v[144:147], a[176:179], v[40:43], 0
 s_add_u32 m0, s39, 96
 v_exp_f32 v37, v37
 v_mfma_f32_16x16x32_bf16 v[144:147], a[208:211], v[44:47], v[144:147]
 buffer_load_dwordx4 v1, s[20:23], s33 offen offset:3072 nt lds
 v_mfma_f32_16x16x32_bf16 v[148:151], a[180:183], v[40:43], 0
 s_add_u32 s33, s33, 8192
 ds_read_b128 v[60:63], v6 offset:20672
 v_mul_f32 v38, s32, v38
 v_mfma_f32_16x16x32_bf16 v[148:151], a[212:215], v[44:47], v[148:151]
 v_mul_f32 v39, s32, v39
 v_exp_f32 v38, v38
 v_mfma_f32_16x16x32_bf16 v[152:155], a[184:187], v[40:43], 0
 v_exp_f32 v39, v39
 v_mfma_f32_16x16x32_bf16 v[152:155], a[216:219], v[44:47], v[152:155]
 v_cvt_pk_bf16_f32 v54, v36, v37
 v_cvt_pk_bf16_f32 v55, v38, v39
 v_cvt_pk_bf16_f32 v220, v220, v221
 v_cvt_pk_bf16_f32 v221, v222, v223
 v_mfma_f32_16x16x32_bf16 v[156:159], a[188:191], v[40:43], 0
 v_mul_f32 v24, s32, v24
 v_mul_f32 v25, s32, v25
 v_mfma_f32_16x16x32_bf16 v[156:159], a[220:223], v[44:47], v[156:159]
 ds_write2_b64 v12, v[216:217], v[220:221] offset0:24 offset1:28
 v_exp_f32 v24, v24
 v_mfma_f32_16x16x32_bf16 v[32:35], a[128:131], a[64:67], 0
 v_exp_f32 v25, v25
 v_mfma_f32_16x16x32_bf16 v[32:35], a[132:135], a[68:71], v[32:35]
 v_mul_f32 v26, s32, v26
 v_mul_f32 v27, s32, v27
 v_mfma_f32_16x16x32_bf16 v[32:35], a[136:139], a[72:75], v[32:35]
 s_mov_b32 s38, 3072
 v_exp_f32 v26, v26
 v_mfma_f32_16x16x32_bf16 v[32:35], a[140:143], a[76:79], v[32:35]
 s_waitcnt lgkmcnt(1)
 buffer_store_dwordx4 v[60:63], v1, s[24:27], s38 offen sc1 nt
 v_mfma_f32_16x16x32_bf16 v[36:39], a[156:159], a[76:79], 0
 v_exp_f32 v27, v27
 v_mfma_f32_16x16x32_bf16 v[36:39], a[152:155], a[72:75], v[36:39]
 v_mul_f32 v28, s32, v28
 v_mul_f32 v29, s32, v29
 v_mfma_f32_16x16x32_bf16 v[36:39], a[148:151], a[68:71], v[36:39]
 v_cvt_pk_bf16_f32 v40, v24, v25
 v_cvt_pk_bf16_f32 v41, v26, v27
 v_mfma_f32_16x16x32_bf16 v[36:39], a[144:147], a[64:67], v[36:39]
 v_accvgpr_read_b32 v11, a234
 v_accvgpr_read_b32 v10, a235
 v_add_f32 v11, v11, v10
 v_rcp_f32 v10, v11
 v_cmp_nle_f32 vcc, s60, v11
 v_accvgpr_write_b32 a234, 0
 v_accvgpr_write_b32 a235, 0
 v_pk_mul_f32 v[224:225], v[224:225], v[10:11] op_sel_hi:[1,0]
 v_pk_mul_f32 v[226:227], v[226:227], v[10:11] op_sel_hi:[1,0]
 v_pk_mul_f32 v[228:229], v[228:229], v[10:11] op_sel_hi:[1,0]
 v_pk_mul_f32 v[230:231], v[230:231], v[10:11] op_sel_hi:[1,0]
 v_pk_mul_f32 v[232:233], v[232:233], v[10:11] op_sel_hi:[1,0]
 v_pk_mul_f32 v[234:235], v[234:235], v[10:11] op_sel_hi:[1,0]
 v_pk_mul_f32 v[236:237], v[236:237], v[10:11] op_sel_hi:[1,0]
 v_pk_mul_f32 v[238:239], v[238:239], v[10:11] op_sel_hi:[1,0]
 v_pk_mul_f32 v[240:241], v[240:241], v[10:11] op_sel_hi:[1,0]
 v_pk_mul_f32 v[242:243], v[242:243], v[10:11] op_sel_hi:[1,0]
 v_pk_mul_f32 v[244:245], v[244:245], v[10:11] op_sel_hi:[1,0]
 v_pk_mul_f32 v[246:247], v[246:247], v[10:11] op_sel_hi:[1,0]
 v_pk_mul_f32 v[248:249], v[248:249], v[10:11] op_sel_hi:[1,0]
 v_pk_mul_f32 v[250:251], v[250:251], v[10:11] op_sel_hi:[1,0]
 v_pk_mul_f32 v[252:253], v[252:253], v[10:11] op_sel_hi:[1,0]
 v_pk_mul_f32 v[254:255], v[254:255], v[10:11] op_sel_hi:[1,0]
 v_mfma_f32_16x16x32_bf16 v[160:163], a[160:163], v[48:51], 0
 v_exp_f32 v28, v28
 v_mfma_f32_16x16x32_bf16 v[160:163], a[192:195], v[52:55], v[160:163]
 s_or_b64 s[50:51], s[50:51], vcc
 v_exp_f32 v29, v29
 v_cmp_nge_f32 vcc, s61, v11
 v_mfma_f32_16x16x32_bf16 v[164:167], a[164:167], v[48:51], 0
 s_add_u32 m0, s39, 16896
 v_mul_f32 v30, s32, v30
 v_mul_f32 v31, s32, v31
 v_mfma_f32_16x16x32_bf16 v[164:167], a[196:199], v[52:55], v[164:167]
 buffer_load_dwordx4 v1, s[20:23], s33 offen nt lds
 v_mfma_f32_16x16x32_bf16 v[168:171], a[168:171], v[48:51], 0
 v_exp_f32 v30, v30
 v_mfma_f32_16x16x32_bf16 v[168:171], a[200:203], v[52:55], v[168:171]
 v_exp_f32 v31, v31
 v_add_u32 v12, 19584, v5
 v_mfma_f32_16x16x32_bf16 v[172:175], a[172:175], v[48:51], 0
 s_waitcnt lgkmcnt(5)
 v_cvt_pk_bf16_f32 v42, v28, v29
 v_cvt_pk_bf16_f32 v43, v30, v31
 v_mfma_f32_16x16x32_bf16 v[172:175], a[204:207], v[52:55], v[172:175]
 v_mul_f32 v32, s32, v32
 v_mul_f32 v33, s32, v33
 v_cvt_pk_bf16_f32 v224, v224, v225
 v_cvt_pk_bf16_f32 v225, v226, v227
 v_mfma_f32_16x16x32_bf16 v[24:27], a[96:99], a[80:83], 0
 v_exp_f32 v32, v32
 v_mfma_f32_16x16x32_bf16 v[24:27], a[100:103], a[84:87], v[24:27]
 v_exp_f32 v33, v33
 v_mfma_f32_16x16x32_bf16 v[24:27], a[104:107], a[88:91], v[24:27]
 v_mul_f32 v34, s32, v34
 v_mul_f32 v35, s32, v35
 v_mfma_f32_16x16x32_bf16 v[24:27], a[108:111], a[92:95], v[24:27]
 v_exp_f32 v34, v34
 v_cvt_pk_bf16_f32 v228, v228, v229
 v_cvt_pk_bf16_f32 v229, v230, v231
 v_smfmac_f32_16x16x64_bf16 a[228:231], a[240:243], v[48:55], v2
 s_or_b64 s[50:51], s[50:51], vcc
 ds_write2_b64 v12, v[224:225], v[228:229] offset0:0 offset1:4
 v_exp_f32 v35, v35
 v_mfma_f32_16x16x32_bf16 v[28:31], a[124:127], a[92:95], 0
 v_mul_f32 v36, s32, v36
 v_mul_f32 v37, s32, v37
 v_mfma_f32_16x16x32_bf16 v[28:31], a[120:123], a[88:91], v[28:31]
 v_cvt_pk_bf16_f32 v44, v32, v33
 v_cvt_pk_bf16_f32 v45, v34, v35
 v_mfma_f32_16x16x32_bf16 v[28:31], a[116:119], a[84:87], v[28:31]
 v_exp_f32 v36, v36
 v_mfma_f32_16x16x32_bf16 v[28:31], a[112:115], a[80:83], v[28:31]
 s_waitcnt vmcnt(7)
 s_barrier
 v_mfma_f32_16x16x32_bf16 v[176:179], a[176:179], v[48:51], 0
 v_exp_f32 v37, v37
 v_mfma_f32_16x16x32_bf16 v[176:179], a[208:211], v[52:55], v[176:179]
 v_mul_f32 v38, s32, v38
 v_mul_f32 v39, s32, v39
 v_cvt_pk_bf16_f32 v232, v232, v233
 v_mfma_f32_16x16x32_bf16 v[180:183], a[180:183], v[48:51], 0
 s_add_u32 m0, s39, 16928
 ds_read_b128 a[96:99], v7 offset:33792
 ds_read_b128 a[100:103], v7 offset:33856
 v_mfma_f32_16x16x32_bf16 v[180:183], a[212:215], v[52:55], v[180:183]
L_pg0_7:
 s_cbranch_execz L_pg0_11
 buffer_load_dwordx4 v1, s[20:23], s33 offen offset:1024 nt lds
 v_mfma_f32_16x16x32_bf16 v[184:187], a[184:187], v[48:51], 0
 v_exp_f32 v38, v38
 v_mfma_f32_16x16x32_bf16 v[184:187], a[216:219], v[52:55], v[184:187]
 v_exp_f32 v39, v39
 v_cvt_pk_bf16_f32 v233, v234, v235
 v_mfma_f32_16x16x32_bf16 v[188:191], a[188:191], v[48:51], 0
 ds_read_b128 a[104:107], v7 offset:33920
 ds_read_b128 a[108:111], v7 offset:33984
 v_mfma_f32_16x16x32_bf16 v[188:191], a[220:223], v[52:55], v[188:191]
 v_cvt_pk_bf16_f32 v46, v36, v37
 v_cvt_pk_bf16_f32 v47, v38, v39
 v_cvt_pk_bf16_f32 v236, v236, v237
 v_cvt_pk_bf16_f32 v237, v238, v239
 v_mfma_f32_16x16x32_bf16 v[32:35], a[128:131], a[80:83], 0
 v_mul_f32 v24, s32, v24
 v_mul_f32 v25, s32, v25
 v_mfma_f32_16x16x32_bf16 v[32:35], a[132:135], a[84:87], v[32:35]
 v_exp_f32 v24, v24
 v_mfma_f32_16x16x32_bf16 v[32:35], a[136:139], a[88:91], v[32:35]
 ds_read_b128 a[124:127], v7 offset:34496
 ds_read_b128 a[120:123], v7 offset:34432
 v_mfma_f32_16x16x32_bf16 v[32:35], a[140:143], a[92:95], v[32:35]
 ds_write2_b64 v12, v[232:233], v[236:237] offset0:8 offset1:12
 v_exp_f32 v25, v25
 v_mfma_f32_16x16x32_bf16 v[36:39], a[156:159], a[92:95], 0
 v_mul_f32 v26, s32, v26
 v_mul_f32 v27, s32, v27
 v_mfma_f32_16x16x32_bf16 v[36:39], a[152:155], a[88:91], v[36:39]
 v_exp_f32 v26, v26
 v_mfma_f32_16x16x32_bf16 v[36:39], a[148:151], a[84:87], v[36:39]
 ds_read_b128 a[116:119], v7 offset:34368
 ds_read_b128 a[112:115], v7 offset:34304
 v_mfma_f32_16x16x32_bf16 v[36:39], a[144:147], a[80:83], v[36:39]
 v_exp_f32 v27, v27
 v_mul_f32 v28, s32, v28
 v_mfma_f32_16x16x32_bf16 v[192:195], a[160:163], v[40:43], 0
 v_mul_f32 v29, s32, v29
 v_cvt_pk_bf16_f32 v48, v24, v25
 v_mfma_f32_16x16x32_bf16 v[192:195], a[192:195], v[44:47], v[192:195]
 v_cvt_pk_bf16_f32 v49, v26, v27
 v_exp_f32 v28, v28
 v_mfma_f32_16x16x32_bf16 v[196:199], a[164:167], v[40:43], 0
 v_exp_f32 v29, v29
 v_mfma_f32_16x16x32_bf16 v[196:199], a[196:199], v[44:47], v[196:199]
 ds_read_b128 a[128:131], v7 offset:50688
 ds_read_b128 a[132:135], v7 offset:50752
 v_cvt_pk_bf16_f32 v240, v240, v241
 v_cvt_pk_bf16_f32 v241, v242, v243
 v_mfma_f32_16x16x32_bf16 v[200:203], a[168:171], v[40:43], 0
 s_add_u32 m0, s39, 16960
 v_mul_f32 v30, s32, v30
 v_mul_f32 v31, s32, v31
 v_mfma_f32_16x16x32_bf16 v[200:203], a[200:203], v[44:47], v[200:203]
 buffer_load_dwordx4 v1, s[20:23], s33 offen offset:2048 nt lds
 v_mfma_f32_16x16x32_bf16 v[204:207], a[172:175], v[40:43], 0
 v_exp_f32 v30, v30
 v_mfma_f32_16x16x32_bf16 v[204:207], a[204:207], v[44:47], v[204:207]
 s_waitcnt lgkmcnt(7)
 ds_read_b128 a[136:139], v7 offset:50816
 ds_read_b128 a[140:143], v7 offset:50880
 v_cvt_pk_bf16_f32 v244, v244, v245
 v_cvt_pk_bf16_f32 v245, v246, v247
 v_mfma_f32_16x16x32_bf16 v[24:27], a[96:99], a[0:3], 0
 v_exp_f32 v31, v31
 v_mfma_f32_16x16x32_bf16 v[24:27], a[100:103], a[4:7], v[24:27]
 v_cvt_pk_bf16_f32 v50, v28, v29
 v_cvt_pk_bf16_f32 v51, v30, v31
 v_mfma_f32_16x16x32_bf16 v[24:27], a[104:107], a[8:11], v[24:27]
 v_mul_f32 v32, s32, v32
 v_mul_f32 v33, s32, v33
 v_mfma_f32_16x16x32_bf16 v[24:27], a[108:111], a[12:15], v[24:27]
 s_waitcnt lgkmcnt(4)
 ds_read_b128 a[156:159], v7 offset:51392
 ds_read_b128 a[152:155], v7 offset:51328
 v_exp_f32 v32, v32
 v_smfmac_f32_16x16x64_bf16 a[232:235], a[236:239], v[40:47], v2
 ds_write2_b64 v12, v[240:241], v[244:245] offset0:16 offset1:20
 v_exp_f32 v33, v33
 v_mfma_f32_16x16x32_bf16 v[28:31], a[124:127], a[12:15], 0
 v_mul_f32 v34, s32, v34
 v_mul_f32 v35, s32, v35
 v_mfma_f32_16x16x32_bf16 v[28:31], a[120:123], a[8:11], v[28:31]
 v_exp_f32 v34, v34
 v_mfma_f32_16x16x32_bf16 v[28:31], a[116:119], a[4:7], v[28:31]
 ds_read_b128 a[148:151], v7 offset:51264
 ds_read_b128 a[144:147], v7 offset:51200
 v_mfma_f32_16x16x32_bf16 v[28:31], a[112:115], a[0:3], v[28:31]
 v_exp_f32 v35, v35
 v_mul_f32 v36, s32, v36
 v_mfma_f32_16x16x32_bf16 v[208:211], a[176:179], v[40:43], 0
 v_mul_f32 v37, s32, v37
 v_cvt_pk_bf16_f32 v52, v32, v33
 v_mfma_f32_16x16x32_bf16 v[208:211], a[208:211], v[44:47], v[208:211]
 v_cvt_pk_bf16_f32 v53, v34, v35
 v_exp_f32 v36, v36
 v_cvt_pk_bf16_f32 v248, v248, v249
 v_mfma_f32_16x16x32_bf16 v[212:215], a[180:183], v[40:43], 0
 s_add_u32 m0, s39, 16992
 v_exp_f32 v37, v37
 v_mfma_f32_16x16x32_bf16 v[212:215], a[212:215], v[44:47], v[212:215]
 buffer_load_dwordx4 v1, s[20:23], s33 offen offset:3072 nt lds
 v_mfma_f32_16x16x32_bf16 v[216:219], a[184:187], v[40:43], 0
 s_add_u32 s33, s33, 8192
 v_mul_f32 v38, s32, v38
 v_mul_f32 v39, s32, v39
 v_mfma_f32_16x16x32_bf16 v[216:219], a[216:219], v[44:47], v[216:219]
 v_exp_f32 v38, v38
 v_cvt_pk_bf16_f32 v249, v250, v251
 v_cvt_pk_bf16_f32 v252, v252, v253
 v_mfma_f32_16x16x32_bf16 v[220:223], a[188:191], v[40:43], 0
 v_exp_f32 v39, v39
 v_mfma_f32_16x16x32_bf16 v[220:223], a[220:223], v[44:47], v[220:223]
 s_waitcnt lgkmcnt(5)
 ds_read_b128 v[56:59], v6 offset:17408
 v_cvt_pk_bf16_f32 v54, v36, v37
 v_cvt_pk_bf16_f32 v55, v38, v39
 v_cvt_pk_bf16_f32 v253, v254, v255
 v_mfma_f32_16x16x32_bf16 v[32:35], a[128:131], a[0:3], 0
 v_mul_f32 v24, s32, v24
 v_mul_f32 v25, s32, v25
 v_mfma_f32_16x16x32_bf16 v[32:35], a[132:135], a[4:7], v[32:35]
 v_exp_f32 v24, v24
 v_mfma_f32_16x16x32_bf16 v[32:35], a[136:139], a[8:11], v[32:35]
 v_exp_f32 v25, v25
 v_mfma_f32_16x16x32_bf16 v[32:35], a[140:143], a[12:15], v[32:35]
 s_waitcnt lgkmcnt(1)
 ds_write2_b64 v12, v[248:249], v[252:253] offset0:24 offset1:28
 v_mul_f32 v26, s32, v26
 v_mul_f32 v27, s32, v27
 v_mfma_f32_16x16x32_bf16 v[36:39], a[156:159], a[12:15], 0
 v_exp_f32 v26, v26
 v_mfma_f32_16x16x32_bf16 v[36:39], a[152:155], a[8:11], v[36:39]
 v_exp_f32 v27, v27
 v_mfma_f32_16x16x32_bf16 v[36:39], a[148:151], a[4:7], v[36:39]
 v_mul_f32 v28, s32, v28
 v_mul_f32 v29, s32, v29
 v_mfma_f32_16x16x32_bf16 v[36:39], a[144:147], a[0:3], v[36:39]
 v_cvt_pk_bf16_f32 v40, v24, v25
 v_cvt_pk_bf16_f32 v41, v26, v27
 v_mfma_f32_16x16x32_bf16 v[224:227], a[160:163], v[48:51], 0
 s_mov_b32 s38, 0
 v_exp_f32 v28, v28
 v_mfma_f32_16x16x32_bf16 v[224:227], a[192:195], v[52:55], v[224:227]
 s_waitcnt lgkmcnt(1)
 buffer_store_dwordx4 v[56:59], v1, s[24:27], s38 offen sc1 nt
 v_mfma_f32_16x16x32_bf16 v[228:231], a[164:167], v[48:51], 0
 ds_read_b64_tr_b16 a[160:161], v8 offset:33792
 ds_read_b64_tr_b16 a[162:163], v8 offset:34304
 v_mfma_f32_16x16x32_bf16 v[228:231], a[196:199], v[52:55], v[228:231]
 v_exp_f32 v29, v29
 v_mul_f32 v30, s32, v30
 v_mfma_f32_16x16x32_bf16 v[232:235], a[168:171], v[48:51], 0
 ds_read_b64_tr_b16 a[192:193], v8 offset:50688
 ds_read_b64_tr_b16 a[194:195], v8 offset:51200
 v_mfma_f32_16x16x32_bf16 v[232:235], a[200:203], v[52:55], v[232:235]
 v_mul_f32 v31, s32, v31
 v_exp_f32 v30, v30
 v_mfma_f32_16x16x32_bf16 v[236:239], a[172:175], v[48:51], 0
 v_exp_f32 v31, v31
 v_mfma_f32_16x16x32_bf16 v[236:239], a[204:207], v[52:55], v[236:239]
 ds_read_b64_tr_b16 a[164:165], v8 offset:33824
 ds_read_b64_tr_b16 a[166:167], v8 offset:34336
 v_cvt_pk_bf16_f32 v42, v28, v29
 v_cvt_pk_bf16_f32 v43, v30, v31
 v_mfma_f32_16x16x32_bf16 v[24:27], a[96:99], a[16:19], 0
 v_mul_f32 v32, s32, v32
 v_mul_f32 v33, s32, v33
 v_mfma_f32_16x16x32_bf16 v[24:27], a[100:103], a[20:23], v[24:27]
 ds_read_b64_tr_b16 a[196:197], v8 offset:50720
 ds_read_b64_tr_b16 a[198:199], v8 offset:51232
 v_mfma_f32_16x16x32_bf16 v[24:27], a[104:107], a[24:27], v[24:27]
 v_exp_f32 v32, v32
 v_mfma_f32_16x16x32_bf16 v[24:27], a[108:111], a[28:31], v[24:27]
 ds_read_b64_tr_b16 a[168:169], v8 offset:33856
 ds_read_b64_tr_b16 a[170:171], v8 offset:34368
 v_exp_f32 v33, v33
 v_smfmac_f32_16x16x64_bf16 a[232:235], a[240:243], v[48:55], v2
 v_mul_f32 v34, s32, v34
 v_mul_f32 v35, s32, v35
 v_mfma_f32_16x16x32_bf16 v[28:31], a[124:127], a[28:31], 0
 ds_read_b64_tr_b16 a[200:201], v8 offset:50752
 ds_read_b64_tr_b16 a[202:203], v8 offset:51264
 v_mfma_f32_16x16x32_bf16 v[28:31], a[120:123], a[24:27], v[28:31]
 v_exp_f32 v34, v34
 v_mfma_f32_16x16x32_bf16 v[28:31], a[116:119], a[20:23], v[28:31]
 v_exp_f32 v35, v35
 v_mfma_f32_16x16x32_bf16 v[28:31], a[112:115], a[16:19], v[28:31]
 ds_read_b64_tr_b16 a[172:173], v8 offset:33888
 ds_read_b64_tr_b16 a[174:175], v8 offset:34400
 v_mul_f32 v36, s32, v36
 v_mfma_f32_16x16x32_bf16 v[240:243], a[176:179], v[48:51], 0
 v_mul_f32 v37, s32, v37
 v_cvt_pk_bf16_f32 v44, v32, v33
 v_mfma_f32_16x16x32_bf16 v[240:243], a[208:211], v[52:55], v[240:243]
 s_cmp_lg_u64 s[50:51], 0
 s_cselect_b32 s59, 1, 0
 s_or_b32 s52, s52, s59
 s_mov_b64 s[50:51], 0
 ds_read_b64_tr_b16 a[204:205], v8 offset:50784
 ds_read_b64_tr_b16 a[206:207], v8 offset:51296
 v_cvt_pk_bf16_f32 v45, v34, v35
 v_mfma_f32_16x16x32_bf16 v[244:247], a[180:183], v[48:51], 0
 v_exp_f32 v36, v36
 v_mfma_f32_16x16x32_bf16 v[244:247], a[212:215], v[52:55], v[244:247]
 v_exp_f32 v37, v37
 v_mfma_f32_16x16x32_bf16 v[248:251], a[184:187], v[48:51], 0
 v_mul_f32 v38, s32, v38
 v_mul_f32 v39, s32, v39
 v_mfma_f32_16x16x32_bf16 v[248:251], a[216:219], v[52:55], v[248:251]
 ds_read_b64_tr_b16 a[176:177], v8 offset:33920
 ds_read_b64_tr_b16 a[178:179], v8 offset:34432
 v_mfma_f32_16x16x32_bf16 v[252:255], a[188:191], v[48:51], 0
 v_exp_f32 v38, v38
 v_mfma_f32_16x16x32_bf16 v[252:255], a[220:223], v[52:55], v[252:255]
 v_exp_f32 v39, v39
 v_cvt_pk_bf16_f32 v46, v36, v37
 v_cvt_pk_bf16_f32 v47, v38, v39
 v_mfma_f32_16x16x32_bf16 v[32:35], a[128:131], a[16:19], 0
 ds_read_b64_tr_b16 a[208:209], v8 offset:50816
 ds_read_b64_tr_b16 a[210:211], v8 offset:51328
 v_mfma_f32_16x16x32_bf16 v[32:35], a[132:135], a[20:23], v[32:35]
 v_mul_f32 v24, s32, v24
 v_mul_f32 v25, s32, v25
 v_mfma_f32_16x16x32_bf16 v[32:35], a[136:139], a[24:27], v[32:35]
 v_exp_f32 v24, v24
 v_mfma_f32_16x16x32_bf16 v[32:35], a[140:143], a[28:31], v[32:35]
 ds_read_b64_tr_b16 a[180:181], v8 offset:33952
 ds_read_b64_tr_b16 a[182:183], v8 offset:34464
 v_exp_f32 v25, v25
 v_mfma_f32_16x16x32_bf16 v[36:39], a[156:159], a[28:31], 0
 v_mul_f32 v26, s32, v26
 v_mul_f32 v27, s32, v27
 v_mfma_f32_16x16x32_bf16 v[36:39], a[152:155], a[24:27], v[36:39]
 v_exp_f32 v26, v26
 v_mfma_f32_16x16x32_bf16 v[36:39], a[148:151], a[20:23], v[36:39]
 ds_read_b64_tr_b16 a[212:213], v8 offset:50848
 ds_read_b64_tr_b16 a[214:215], v8 offset:51360
 v_mfma_f32_16x16x32_bf16 v[36:39], a[144:147], a[16:19], v[36:39]
 s_waitcnt lgkmcnt(15)
 v_exp_f32 v27, v27
 v_mul_f32 v28, s32, v28
 v_mfma_f32_16x16x32_bf16 v[64:67], a[160:163], v[40:43], v[64:67]
 v_mul_f32 v29, s32, v29
 v_cvt_pk_bf16_f32 v48, v24, v25
 v_mfma_f32_16x16x32_bf16 v[64:67], a[192:195], v[44:47], v[64:67]
 ds_read_b64_tr_b16 a[184:185], v8 offset:33984
 ds_read_b64_tr_b16 a[186:187], v8 offset:34496
 v_cvt_pk_bf16_f32 v49, v26, v27
 v_mfma_f32_16x16x32_bf16 v[68:71], a[164:167], v[40:43], v[68:71]
 v_exp_f32 v28, v28
 v_mfma_f32_16x16x32_bf16 v[68:71], a[196:199], v[44:47], v[68:71]
 s_waitcnt lgkmcnt(10)
 v_exp_f32 v29, v29
 v_mfma_f32_16x16x32_bf16 v[72:75], a[168:171], v[40:43], v[72:75]
 ds_read_b64_tr_b16 a[216:217], v8 offset:50880
 ds_read_b64_tr_b16 a[218:219], v8 offset:51392
 v_mfma_f32_16x16x32_bf16 v[72:75], a[200:203], v[44:47], v[72:75]
 v_mul_f32 v30, s32, v30
 v_mul_f32 v31, s32, v31
 v_mfma_f32_16x16x32_bf16 v[76:79], a[172:175], v[40:43], v[76:79]
 v_exp_f32 v30, v30
 v_mfma_f32_16x16x32_bf16 v[76:79], a[204:207], v[44:47], v[76:79]
 ds_read_b64_tr_b16 a[188:189], v8 offset:34016
 ds_read_b64_tr_b16 a[190:191], v8 offset:34528
 v_mfma_f32_16x16x32_bf16 v[24:27], a[96:99], a[32:35], 0
 ds_read_b128 v[60:63], v6 offset:18496
 v_exp_f32 v31, v31
 v_mfma_f32_16x16x32_bf16 v[24:27], a[100:103], a[36:39], v[24:27]
 v_cvt_pk_bf16_f32 v50, v28, v29
 v_cvt_pk_bf16_f32 v51, v30, v31
 v_mfma_f32_16x16x32_bf16 v[24:27], a[104:107], a[40:43], v[24:27]
 ds_read_b64_tr_b16 a[220:221], v8 offset:50912
 ds_read_b64_tr_b16 a[222:223], v8 offset:51424
 v_mfma_f32_16x16x32_bf16 v[24:27], a[108:111], a[44:47], v[24:27]
 v_mul_f32 v32, s32, v32
 v_mul_f32 v33, s32, v33
 v_smfmac_f32_16x16x64_bf16 a[224:227], a[236:239], v[40:47], v2
 v_exp_f32 v32, v32
 v_mfma_f32_16x16x32_bf16 v[28:31], a[124:127], a[44:47], 0
 v_exp_f32 v33, v33
 v_mfma_f32_16x16x32_bf16 v[28:31], a[120:123], a[40:43], v[28:31]
 v_mul_f32 v34, s32, v34
 v_mul_f32 v35, s32, v35
 v_mfma_f32_16x16x32_bf16 v[28:31], a[116:119], a[36:39], v[28:31]
 v_exp_f32 v34, v34
 v_mfma_f32_16x16x32_bf16 v[28:31], a[112:115], a[32:35], v[28:31]
 s_waitcnt lgkmcnt(9)
 v_exp_f32 v35, v35
 v_mfma_f32_16x16x32_bf16 v[80:83], a[176:179], v[40:43], v[80:83]
 s_mov_b32 s38, 1024
 v_mul_f32 v36, s32, v36
 v_mul_f32 v37, s32, v37
 v_mfma_f32_16x16x32_bf16 v[80:83], a[208:211], v[44:47], v[80:83]
 s_waitcnt lgkmcnt(2)
 buffer_store_dwordx4 v[60:63], v1, s[24:27], s38 offen sc1 nt
 v_mfma_f32_16x16x32_bf16 v[84:87], a[180:183], v[40:43], v[84:87]
 v_cvt_pk_bf16_f32 v52, v32, v33
 v_cvt_pk_bf16_f32 v53, v34, v35
 v_mfma_f32_16x16x32_bf16 v[84:87], a[212:215], v[44:47], v[84:87]
 s_waitcnt lgkmcnt(0)
 s_barrier
 v_mfma_f32_16x16x32_bf16 v[88:91], a[184:187], v[40:43], v[88:91]
 v_exp_f32 v36, v36
 v_mfma_f32_16x16x32_bf16 v[88:91], a[216:219], v[44:47], v[88:91]
 v_exp_f32 v37, v37
 v_mfma_f32_16x16x32_bf16 v[92:95], a[188:191], v[40:43], v[92:95]
 v_mul_f32 v38, s32, v38
 v_mul_f32 v39, s32, v39
 v_mfma_f32_16x16x32_bf16 v[92:95], a[220:223], v[44:47], v[92:95]
 v_exp_f32 v38, v38
 v_mfma_f32_16x16x32_bf16 v[32:35], a[128:131], a[32:35], 0
 v_exp_f32 v39, v39
 v_mfma_f32_16x16x32_bf16 v[32:35], a[132:135], a[36:39], v[32:35]
 v_cvt_pk_bf16_f32 v54, v36, v37
 v_cvt_pk_bf16_f32 v55, v38, v39
 v_mfma_f32_16x16x32_bf16 v[32:35], a[136:139], a[40:43], v[32:35]
 v_mul_f32 v24, s32, v24
 v_mul_f32 v25, s32, v25
 v_mfma_f32_16x16x32_bf16 v[32:35], a[140:143], a[44:47], v[32:35]
 v_exp_f32 v24, v24
 v_mfma_f32_16x16x32_bf16 v[36:39], a[156:159], a[44:47], 0
 v_exp_f32 v25, v25
 v_mfma_f32_16x16x32_bf16 v[36:39], a[152:155], a[40:43], v[36:39]
 v_mul_f32 v26, s32, v26
 v_mul_f32 v27, s32, v27
 v_mfma_f32_16x16x32_bf16 v[36:39], a[148:151], a[36:39], v[36:39]
 s_add_u32 m0, s39, 33792
 v_exp_f32 v26, v26
 v_mfma_f32_16x16x32_bf16 v[36:39], a[144:147], a[32:35], v[36:39]
 buffer_load_dwordx4 v1, s[20:23], s33 offen nt lds
 v_mfma_f32_16x16x32_bf16 v[96:99], a[160:163], v[48:51], v[96:99]
 v_exp_f32 v27, v27
 v_mfma_f32_16x16x32_bf16 v[96:99], a[192:195], v[52:55], v[96:99]
 v_mul_f32 v28, s32, v28
 v_mul_f32 v29, s32, v29
 v_mfma_f32_16x16x32_bf16 v[100:103], a[164:167], v[48:51], v[100:103]
 v_cvt_pk_bf16_f32 v40, v24, v25
 v_cvt_pk_bf16_f32 v41, v26, v27
 v_mfma_f32_16x16x32_bf16 v[100:103], a[196:199], v[52:55], v[100:103]
 v_exp_f32 v28, v28
 v_mfma_f32_16x16x32_bf16 v[104:107], a[168:171], v[48:51], v[104:107]
 v_exp_f32 v29, v29
 v_mfma_f32_16x16x32_bf16 v[104:107], a[200:203], v[52:55], v[104:107]
 v_mul_f32 v30, s32, v30
 v_mul_f32 v31, s32, v31
 v_mfma_f32_16x16x32_bf16 v[108:111], a[172:175], v[48:51], v[108:111]
 v_exp_f32 v30, v30
 v_mfma_f32_16x16x32_bf16 v[108:111], a[204:207], v[52:55], v[108:111]
 v_exp_f32 v31, v31
 v_mfma_f32_16x16x32_bf16 v[24:27], a[96:99], a[48:51], 0
 v_cvt_pk_bf16_f32 v42, v28, v29
 v_cvt_pk_bf16_f32 v43, v30, v31
 v_mfma_f32_16x16x32_bf16 v[24:27], a[100:103], a[52:55], v[24:27]
 v_mul_f32 v32, s32, v32
 v_mul_f32 v33, s32, v33
 v_mfma_f32_16x16x32_bf16 v[24:27], a[104:107], a[56:59], v[24:27]
 v_mfma_f32_16x16x32_bf16 v[24:27], a[108:111], a[60:63], v[24:27]
 v_exp_f32 v32, v32
 v_exp_f32 v33, v33
 v_smfmac_f32_16x16x64_bf16 a[224:227], a[240:243], v[48:55], v2
 v_mfma_f32_16x16x32_bf16 v[28:31], a[124:127], a[60:63], 0
 v_mul_f32 v34, s32, v34
 v_mul_f32 v35, s32, v35
 v_mfma_f32_16x16x32_bf16 v[28:31], a[120:123], a[56:59], v[28:31]
 v_exp_f32 v34, v34
 v_mfma_f32_16x16x32_bf16 v[28:31], a[116:119], a[52:55], v[28:31]
 s_add_u32 m0, s39, 33824
 v_mfma_f32_16x16x32_bf16 v[28:31], a[112:115], a[48:51], v[28:31]
 buffer_load_dwordx4 v1, s[20:23], s33 offen offset:1024 nt lds
 v_exp_f32 v35, v35
 v_mfma_f32_16x16x32_bf16 v[112:115], a[176:179], v[48:51], v[112:115]
 v_mul_f32 v36, s32, v36
 v_mul_f32 v37, s32, v37
 v_mfma_f32_16x16x32_bf16 v[112:115], a[208:211], v[52:55], v[112:115]
 v_cvt_pk_bf16_f32 v44, v32, v33
 v_cvt_pk_bf16_f32 v45, v34, v35
 v_exp_f32 v36, v36
 v_mfma_f32_16x16x32_bf16 v[116:119], a[180:183], v[48:51], v[116:119]
 v_mfma_f32_16x16x32_bf16 v[116:119], a[212:215], v[52:55], v[116:119]
 v_exp_f32 v37, v37
 v_mul_f32 v38, s32, v38
 v_mul_f32 v39, s32, v39
 v_mfma_f32_16x16x32_bf16 v[120:123], a[184:187], v[48:51], v[120:123]
 v_mfma_f32_16x16x32_bf16 v[120:123], a[216:219], v[52:55], v[120:123]
 v_exp_f32 v38, v38
 v_exp_f32 v39, v39
 v_mfma_f32_16x16x32_bf16 v[124:127], a[188:191], v[48:51], v[124:127]
 v_cvt_pk_bf16_f32 v46, v36, v37
 v_cvt_pk_bf16_f32 v47, v38, v39
 v_mfma_f32_16x16x32_bf16 v[124:127], a[220:223], v[52:55], v[124:127]
 v_mfma_f32_16x16x32_bf16 v[32:35], a[128:131], a[48:51], 0
 v_mul_f32 v24, s32, v24
 v_mul_f32 v25, s32, v25
 v_mfma_f32_16x16x32_bf16 v[32:35], a[132:135], a[52:55], v[32:35]
 v_exp_f32 v24, v24
 v_mfma_f32_16x16x32_bf16 v[32:35], a[136:139], a[56:59], v[32:35]
 v_mfma_f32_16x16x32_bf16 v[32:35], a[140:143], a[60:63], v[32:35]
 v_exp_f32 v25, v25
 v_mul_f32 v26, s32, v26
 v_mul_f32 v27, s32, v27
 v_mfma_f32_16x16x32_bf16 v[36:39], a[156:159], a[60:63], 0
 v_mfma_f32_16x16x32_bf16 v[36:39], a[152:155], a[56:59], v[36:39]
 v_exp_f32 v26, v26
 v_mfma_f32_16x16x32_bf16 v[36:39], a[148:151], a[52:55], v[36:39]
 v_exp_f32 v27, v27
 v_mfma_f32_16x16x32_bf16 v[36:39], a[144:147], a[48:51], v[36:39]
 v_mfma_f32_16x16x32_bf16 v[128:131], a[160:163], v[40:43], v[128:131]
 s_add_u32 m0, s39, 33856
 v_mul_f32 v28, s32, v28
 v_mul_f32 v29, s32, v29
 v_mfma_f32_16x16x32_bf16 v[128:131], a[192:195], v[44:47], v[128:131]
 buffer_load_dwordx4 v1, s[20:23], s33 offen offset:2048 nt lds
 v_cvt_pk_bf16_f32 v48, v24, v25
 v_cvt_pk_bf16_f32 v49, v26, v27
 v_mfma_f32_16x16x32_bf16 v[132:135], a[164:167], v[40:43], v[132:135]
 v_exp_f32 v28, v28
 v_mfma_f32_16x16x32_bf16 v[132:135], a[196:199], v[44:47], v[132:135]
 v_mfma_f32_16x16x32_bf16 v[136:139], a[168:171], v[40:43], v[136:139]
 v_exp_f32 v29, v29
 v_mfma_f32_16x16x32_bf16 v[136:139], a[200:203], v[44:47], v[136:139]
 v_mfma_f32_16x16x32_bf16 v[140:143], a[172:175], v[40:43], v[140:143]
 v_mul_f32 v30, s32, v30
 v_mul_f32 v31, s32, v31
 v_mfma_f32_16x16x32_bf16 v[140:143], a[204:207], v[44:47], v[140:143]
 v_exp_f32 v30, v30
 v_exp_f32 v31, v31
 v_cvt_pk_bf16_f32 v50, v28, v29
 v_cvt_pk_bf16_f32 v51, v30, v31
 v_mfma_f32_16x16x32_bf16 v[24:27], a[96:99], a[64:67], 0
 v_mfma_f32_16x16x32_bf16 v[24:27], a[100:103], a[68:71], v[24:27]
 v_mul_f32 v32, s32, v32
 v_mul_f32 v33, s32, v33
 v_mfma_f32_16x16x32_bf16 v[24:27], a[104:107], a[72:75], v[24:27]
 v_exp_f32 v32, v32
 v_mfma_f32_16x16x32_bf16 v[24:27], a[108:111], a[76:79], v[24:27]
 v_smfmac_f32_16x16x64_bf16 a[228:231], a[236:239], v[40:47], v2
 v_exp_f32 v33, v33
 v_mul_f32 v34, s32, v34
 v_mul_f32 v35, s32, v35
 v_mfma_f32_16x16x32_bf16 v[28:31], a[124:127], a[76:79], 0
 v_mfma_f32_16x16x32_bf16 v[28:31], a[120:123], a[72:75], v[28:31]
 v_exp_f32 v34, v34
 v_mfma_f32_16x16x32_bf16 v[28:31], a[116:119], a[68:71], v[28:31]
 v_exp_f32 v35, v35
 v_mfma_f32_16x16x32_bf16 v[28:31], a[112:115], a[64:67], v[28:31]
 v_mfma_f32_16x16x32_bf16 v[144:147], a[176:179], v[40:43], v[144:147]
 s_add_u32 m0, s39, 33888
 v_mul_f32 v36, s32, v36
 v_mul_f32 v37, s32, v37
 v_mfma_f32_16x16x32_bf16 v[144:147], a[208:211], v[44:47], v[144:147]
 buffer_load_dwordx4 v1, s[20:23], s33 offen offset:3072 nt lds
 v_cvt_pk_bf16_f32 v52, v32, v33
 v_cvt_pk_bf16_f32 v53, v34, v35
 v_mfma_f32_16x16x32_bf16 v[148:151], a[180:183], v[40:43], v[148:151]
 s_add_u32 s33, s33, 8192
 v_exp_f32 v36, v36
 v_mfma_f32_16x16x32_bf16 v[148:151], a[212:215], v[44:47], v[148:151]
 v_mfma_f32_16x16x32_bf16 v[152:155], a[184:187], v[40:43], v[152:155]
 v_exp_f32 v37, v37
 v_mfma_f32_16x16x32_bf16 v[152:155], a[216:219], v[44:47], v[152:155]
 v_mfma_f32_16x16x32_bf16 v[156:159], a[188:191], v[40:43], v[156:159]
 v_mul_f32 v38, s32, v38
 v_mul_f32 v39, s32, v39
 v_mfma_f32_16x16x32_bf16 v[156:159], a[220:223], v[44:47], v[156:159]
 v_exp_f32 v38, v38
 v_exp_f32 v39, v39
 v_cvt_pk_bf16_f32 v54, v36, v37
 v_cvt_pk_bf16_f32 v55, v38, v39
 v_mfma_f32_16x16x32_bf16 v[32:35], a[128:131], a[64:67], 0
 v_mfma_f32_16x16x32_bf16 v[32:35], a[132:135], a[68:71], v[32:35]
 v_mul_f32 v24, s32, v24
 v_mul_f32 v25, s32, v25
 v_mfma_f32_16x16x32_bf16 v[32:35], a[136:139], a[72:75], v[32:35]
 v_exp_f32 v24, v24
 v_mfma_f32_16x16x32_bf16 v[32:35], a[140:143], a[76:79], v[32:35]
 v_mfma_f32_16x16x32_bf16 v[36:39], a[156:159], a[76:79], 0
 v_exp_f32 v25, v25
 v_mfma_f32_16x16x32_bf16 v[36:39], a[152:155], a[72:75], v[36:39]
 v_mfma_f32_16x16x32_bf16 v[36:39], a[148:151], a[68:71], v[36:39]
 v_mul_f32 v26, s32, v26
 v_mul_f32 v27, s32, v27
 v_mfma_f32_16x16x32_bf16 v[36:39], a[144:147], a[64:67], v[36:39]
 v_exp_f32 v26, v26
 v_exp_f32 v27, v27
 v_mul_f32 v28, s32, v28
 v_mfma_f32_16x16x32_bf16 v[160:163], a[160:163], v[48:51], v[160:163]
 v_mfma_f32_16x16x32_bf16 v[160:163], a[192:195], v[52:55], v[160:163]
 v_mul_f32 v29, s32, v29
 v_cvt_pk_bf16_f32 v40, v24, v25
 v_cvt_pk_bf16_f32 v41, v26, v27
 v_exp_f32 v28, v28
 v_mfma_f32_16x16x32_bf16 v[164:167], a[164:167], v[48:51], v[164:167]
 s_add_u32 m0, s39, 50688
 v_exp_f32 v29, v29
 v_mfma_f32_16x16x32_bf16 v[164:167], a[196:199], v[52:55], v[164:167]
 buffer_load_dwordx4 v1, s[20:23], s33 offen nt lds
 v_mul_f32 v30, s32, v30
 v_mul_f32 v31, s32, v31
 v_mfma_f32_16x16x32_bf16 v[168:171], a[168:171], v[48:51], v[168:171]
 v_mfma_f32_16x16x32_bf16 v[168:171], a[200:203], v[52:55], v[168:171]
 v_exp_f32 v30, v30
 v_exp_f32 v31, v31
 v_cvt_pk_bf16_f32 v42, v28, v29
 v_mfma_f32_16x16x32_bf16 v[172:175], a[172:175], v[48:51], v[172:175]
 v_mfma_f32_16x16x32_bf16 v[172:175], a[204:207], v[52:55], v[172:175]
 v_cvt_pk_bf16_f32 v43, v30, v31
 v_mul_f32 v32, s32, v32
 v_mul_f32 v33, s32, v33
 v_exp_f32 v32, v32
 v_mfma_f32_16x16x32_bf16 v[24:27], a[96:99], a[80:83], 0
 v_exp_f32 v33, v33
 v_mfma_f32_16x16x32_bf16 v[24:27], a[100:103], a[84:87], v[24:27]
 v_mfma_f32_16x16x32_bf16 v[24:27], a[104:107], a[88:91], v[24:27]
 v_mul_f32 v34, s32, v34
 v_mul_f32 v35, s32, v35
 v_mfma_f32_16x16x32_bf16 v[24:27], a[108:111], a[92:95], v[24:27]
 v_exp_f32 v34, v34
 v_exp_f32 v35, v35
 v_smfmac_f32_16x16x64_bf16 a[228:231], a[240:243], v[48:55], v2
 v_mfma_f32_16x16x32_bf16 v[28:31], a[124:127], a[92:95], 0
 v_mul_f32 v36, s32, v36
 v_mul_f32 v37, s32, v37
 v_mfma_f32_16x16x32_bf16 v[28:31], a[120:123], a[88:91], v[28:31]
 v_mfma_f32_16x16x32_bf16 v[28:31], a[116:119], a[84:87], v[28:31]
 v_cvt_pk_bf16_f32 v44, v32, v33
 v_cvt_pk_bf16_f32 v45, v34, v35
 v_mfma_f32_16x16x32_bf16 v[28:31], a[112:115], a[80:83], v[28:31]
 s_waitcnt vmcnt(7)
 s_barrier
 v_mfma_f32_16x16x32_bf16 v[176:179], a[176:179], v[48:51], v[176:179]
 v_exp_f32 v36, v36
 v_mfma_f32_16x16x32_bf16 v[176:179], a[208:211], v[52:55], v[176:179]
 v_mfma_f32_16x16x32_bf16 v[180:183], a[180:183], v[48:51], v[180:183]
 s_add_u32 m0, s39, 50720
 ds_read_b128 a[96:99], v7 offset:0
 ds_read_b128 a[100:103], v7 offset:64
 v_mfma_f32_16x16x32_bf16 v[180:183], a[212:215], v[52:55], v[180:183]
 buffer_load_dwordx4 v1, s[20:23], s33 offen offset:1024 nt lds
 v_exp_f32 v37, v37
 v_mfma_f32_16x16x32_bf16 v[184:187], a[184:187], v[48:51], v[184:187]
 v_mul_f32 v38, s32, v38
 v_mul_f32 v39, s32, v39
 v_mfma_f32_16x16x32_bf16 v[184:187], a[216:219], v[52:55], v[184:187]
 v_exp_f32 v38, v38
 v_exp_f32 v39, v39
 v_cvt_pk_bf16_f32 v46, v36, v37
 v_mfma_f32_16x16x32_bf16 v[188:191], a[188:191], v[48:51], v[188:191]
 ds_read_b128 a[104:107], v7 offset:128
 ds_read_b128 a[108:111], v7 offset:192
 v_mfma_f32_16x16x32_bf16 v[188:191], a[220:223], v[52:55], v[188:191]
 v_mfma_f32_16x16x32_bf16 v[32:35], a[128:131], a[80:83], 0
 v_cvt_pk_bf16_f32 v47, v38, v39
 v_mul_f32 v24, s32, v24
 v_mfma_f32_16x16x32_bf16 v[32:35], a[132:135], a[84:87], v[32:35]
 v_mfma_f32_16x16x32_bf16 v[32:35], a[136:139], a[88:91], v[32:35]
 ds_read_b128 a[124:127], v7 offset:704
 ds_read_b128 a[120:123], v7 offset:640
 v_mfma_f32_16x16x32_bf16 v[32:35], a[140:143], a[92:95], v[32:35]
 v_mul_f32 v25, s32, v25
 v_exp_f32 v24, v24
 v_exp_f32 v25, v25
 v_mfma_f32_16x16x32_bf16 v[36:39], a[156:159], a[92:95], 0
 v_mul_f32 v26, s32, v26
 v_mul_f32 v27, s32, v27
 v_mfma_f32_16x16x32_bf16 v[36:39], a[152:155], a[88:91], v[36:39]
 v_mfma_f32_16x16x32_bf16 v[36:39], a[148:151], a[84:87], v[36:39]
 ds_read_b128 a[116:119], v7 offset:576
 ds_read_b128 a[112:115], v7 offset:512
 v_mfma_f32_16x16x32_bf16 v[36:39], a[144:147], a[80:83], v[36:39]
 v_exp_f32 v26, v26
 v_exp_f32 v27, v27
 v_mfma_f32_16x16x32_bf16 v[192:195], a[160:163], v[40:43], v[192:195]
 v_mul_f32 v28, s32, v28
 v_mul_f32 v29, s32, v29
 v_mfma_f32_16x16x32_bf16 v[192:195], a[192:195], v[44:47], v[192:195]
 v_mfma_f32_16x16x32_bf16 v[196:199], a[164:167], v[40:43], v[196:199]
 v_cvt_pk_bf16_f32 v48, v24, v25
 v_cvt_pk_bf16_f32 v49, v26, v27
 v_mfma_f32_16x16x32_bf16 v[196:199], a[196:199], v[44:47], v[196:199]
 ds_read_b128 a[128:131], v7 offset:16896
 ds_read_b128 a[132:135], v7 offset:16960
 v_exp_f32 v28, v28
 v_mfma_f32_16x16x32_bf16 v[200:203], a[168:171], v[40:43], v[200:203]
 s_add_u32 m0, s39, 50752
 v_mfma_f32_16x16x32_bf16 v[200:203], a[200:203], v[44:47], v[200:203]
 buffer_load_dwordx4 v1, s[20:23], s33 offen offset:2048 nt lds
 v_exp_f32 v29, v29
 v_mfma_f32_16x16x32_bf16 v[204:207], a[172:175], v[40:43], v[204:207]
 v_mul_f32 v30, s32, v30
 v_mul_f32 v31, s32, v31
 v_mfma_f32_16x16x32_bf16 v[204:207], a[204:207], v[44:47], v[204:207]
 s_waitcnt lgkmcnt(6)
 ds_read_b128 a[136:139], v7 offset:17024
 ds_read_b128 a[140:143], v7 offset:17088
 v_exp_f32 v30, v30
 v_mfma_f32_16x16x32_bf16 v[24:27], a[96:99], a[0:3], 0
 v_exp_f32 v31, v31
 v_mfma_f32_16x16x32_bf16 v[24:27], a[100:103], a[4:7], v[24:27]
 v_cvt_pk_bf16_f32 v50, v28, v29
 v_cvt_pk_bf16_f32 v51, v30, v31
 v_mfma_f32_16x16x32_bf16 v[24:27], a[104:107], a[8:11], v[24:27]
 v_mul_f32 v32, s32, v32
 v_mul_f32 v33, s32, v33
 v_mfma_f32_16x16x32_bf16 v[24:27], a[108:111], a[12:15], v[24:27]
 s_waitcnt lgkmcnt(4)
 ds_read_b128 a[156:159], v7 offset:17600
 ds_read_b128 a[152:155], v7 offset:17536
 v_exp_f32 v32, v32
 v_smfmac_f32_16x16x64_bf16 a[232:235], a[236:239], v[40:47], v2
 v_exp_f32 v33, v33
 v_mfma_f32_16x16x32_bf16 v[28:31], a[124:127], a[12:15], 0
 v_mul_f32 v34, s32, v34
 v_mul_f32 v35, s32, v35
 v_mfma_f32_16x16x32_bf16 v[28:31], a[120:123], a[8:11], v[28:31]
 v_exp_f32 v34, v34
 v_mfma_f32_16x16x32_bf16 v[28:31], a[116:119], a[4:7], v[28:31]
 ds_read_b128 a[148:151], v7 offset:17472
 ds_read_b128 a[144:147], v7 offset:17408
 v_mfma_f32_16x16x32_bf16 v[28:31], a[112:115], a[0:3], v[28:31]
 v_exp_f32 v35, v35
 v_mul_f32 v36, s32, v36
 v_mul_f32 v37, s32, v37
 v_mfma_f32_16x16x32_bf16 v[208:211], a[176:179], v[40:43], v[208:211]
 v_cvt_pk_bf16_f32 v52, v32, v33
 v_cvt_pk_bf16_f32 v53, v34, v35
 v_mfma_f32_16x16x32_bf16 v[208:211], a[208:211], v[44:47], v[208:211]
L_pg0_8:
 s_cbranch_execz L_pg0_12
 v_mfma_f32_16x16x32_bf16 v[212:215], a[180:183], v[40:43], v[212:215]
 s_add_u32 m0, s39, 50784
 v_exp_f32 v36, v36
 v_mfma_f32_16x16x32_bf16 v[212:215], a[212:215], v[44:47], v[212:215]
 buffer_load_dwordx4 v1, s[20:23], s33 offen offset:3072 nt lds
 v_mfma_f32_16x16x32_bf16 v[216:219], a[184:187], v[40:43], v[216:219]
 s_add_u32 s33, s33, 8192
 v_exp_f32 v37, v37
 v_mfma_f32_16x16x32_bf16 v[216:219], a[216:219], v[44:47], v[216:219]
 v_mul_f32 v38, s32, v38
 v_mul_f32 v39, s32, v39
 v_mfma_f32_16x16x32_bf16 v[220:223], a[188:191], v[40:43], v[220:223]
 v_exp_f32 v38, v38
 v_mfma_f32_16x16x32_bf16 v[220:223], a[220:223], v[44:47], v[220:223]
 s_waitcnt lgkmcnt(4)
 ds_read_b128 v[56:59], v6 offset:4352
 v_exp_f32 v39, v39
 v_mfma_f32_16x16x32_bf16 v[32:35], a[128:131], a[0:3], 0
 v_cvt_pk_bf16_f32 v54, v36, v37
 v_cvt_pk_bf16_f32 v55, v38, v39
 v_mfma_f32_16x16x32_bf16 v[32:35], a[132:135], a[4:7], v[32:35]
 v_mul_f32 v24, s32, v24
 v_mul_f32 v25, s32, v25
 v_mfma_f32_16x16x32_bf16 v[32:35], a[136:139], a[8:11], v[32:35]
 v_exp_f32 v24, v24
 v_mfma_f32_16x16x32_bf16 v[32:35], a[140:143], a[12:15], v[32:35]
 s_waitcnt lgkmcnt(1)
 v_exp_f32 v25, v25
 v_mfma_f32_16x16x32_bf16 v[36:39], a[156:159], a[12:15], 0
 v_mul_f32 v26, s32, v26
 v_mul_f32 v27, s32, v27
 v_mfma_f32_16x16x32_bf16 v[36:39], a[152:155], a[8:11], v[36:39]
 v_exp_f32 v26, v26
 v_mfma_f32_16x16x32_bf16 v[36:39], a[148:151], a[4:7], v[36:39]
 v_mfma_f32_16x16x32_bf16 v[36:39], a[144:147], a[0:3], v[36:39]
 v_exp_f32 v27, v27
 v_mul_f32 v28, s32, v28
 v_mfma_f32_16x16x32_bf16 v[224:227], a[160:163], v[48:51], v[224:227]
 s_mov_b32 s38, 4096
 v_mul_f32 v29, s32, v29
 v_cvt_pk_bf16_f32 v40, v24, v25
 v_mfma_f32_16x16x32_bf16 v[224:227], a[192:195], v[52:55], v[224:227]
 s_waitcnt lgkmcnt(0)
 buffer_store_dwordx4 v[56:59], v1, s[24:27], s38 offen sc1 nt
 v_mfma_f32_16x16x32_bf16 v[228:231], a[164:167], v[48:51], v[228:231]
 ds_read_b64_tr_b16 a[160:161], v8 offset:0
 ds_read_b64_tr_b16 a[162:163], v8 offset:512
 v_mfma_f32_16x16x32_bf16 v[228:231], a[196:199], v[52:55], v[228:231]
 v_cvt_pk_bf16_f32 v41, v26, v27
 v_exp_f32 v28, v28
 v_mfma_f32_16x16x32_bf16 v[232:235], a[168:171], v[48:51], v[232:235]
 ds_read_b64_tr_b16 a[192:193], v8 offset:16896
 ds_read_b64_tr_b16 a[194:195], v8 offset:17408
 v_mfma_f32_16x16x32_bf16 v[232:235], a[200:203], v[52:55], v[232:235]
 v_exp_f32 v29, v29
 v_mul_f32 v30, s32, v30
 v_mul_f32 v31, s32, v31
 v_mfma_f32_16x16x32_bf16 v[236:239], a[172:175], v[48:51], v[236:239]
 v_exp_f32 v30, v30
 v_mfma_f32_16x16x32_bf16 v[236:239], a[204:207], v[52:55], v[236:239]
 ds_read_b64_tr_b16 a[164:165], v8 offset:32
 ds_read_b64_tr_b16 a[166:167], v8 offset:544
 v_exp_f32 v31, v31
 v_mfma_f32_16x16x32_bf16 v[24:27], a[96:99], a[16:19], 0
 v_cvt_pk_bf16_f32 v42, v28, v29
 v_cvt_pk_bf16_f32 v43, v30, v31
 v_mfma_f32_16x16x32_bf16 v[24:27], a[100:103], a[20:23], v[24:27]
 ds_read_b64_tr_b16 a[196:197], v8 offset:16928
 ds_read_b64_tr_b16 a[198:199], v8 offset:17440
 v_mfma_f32_16x16x32_bf16 v[24:27], a[104:107], a[24:27], v[24:27]
 v_mul_f32 v32, s32, v32
 v_mul_f32 v33, s32, v33
 v_mfma_f32_16x16x32_bf16 v[24:27], a[108:111], a[28:31], v[24:27]
 ds_read_b64_tr_b16 a[168:169], v8 offset:64
 ds_read_b64_tr_b16 a[170:171], v8 offset:576
 v_exp_f32 v32, v32
 v_smfmac_f32_16x16x64_bf16 a[232:235], a[240:243], v[48:55], v2
 v_exp_f32 v33, v33
 v_mfma_f32_16x16x32_bf16 v[28:31], a[124:127], a[28:31], 0
 ds_read_b64_tr_b16 a[200:201], v8 offset:16960
 ds_read_b64_tr_b16 a[202:203], v8 offset:17472
 v_mfma_f32_16x16x32_bf16 v[28:31], a[120:123], a[24:27], v[28:31]
 v_mul_f32 v34, s32, v34
 v_mul_f32 v35, s32, v35
 v_mfma_f32_16x16x32_bf16 v[28:31], a[116:119], a[20:23], v[28:31]
 v_exp_f32 v34, v34
 v_mfma_f32_16x16x32_bf16 v[28:31], a[112:115], a[16:19], v[28:31]
 ds_read_b64_tr_b16 a[172:173], v8 offset:96
 ds_read_b64_tr_b16 a[174:175], v8 offset:608
 v_exp_f32 v35, v35
 v_mfma_f32_16x16x32_bf16 v[240:243], a[176:179], v[48:51], v[240:243]
 v_mul_f32 v36, s32, v36
 v_mul_f32 v37, s32, v37
 v_mfma_f32_16x16x32_bf16 v[240:243], a[208:211], v[52:55], v[240:243]
 ds_read_b64_tr_b16 a[204:205], v8 offset:16992
 ds_read_b64_tr_b16 a[206:207], v8 offset:17504
 v_cvt_pk_bf16_f32 v44, v32, v33
 v_mfma_f32_16x16x32_bf16 v[244:247], a[180:183], v[48:51], v[244:247]
 v_mfma_f32_16x16x32_bf16 v[244:247], a[212:215], v[52:55], v[244:247]
 v_cvt_pk_bf16_f32 v45, v34, v35
 v_exp_f32 v36, v36
 v_mfma_f32_16x16x32_bf16 v[248:251], a[184:187], v[48:51], v[248:251]
 v_exp_f32 v37, v37
 v_mfma_f32_16x16x32_bf16 v[248:251], a[216:219], v[52:55], v[248:251]
 ds_read_b64_tr_b16 a[176:177], v8 offset:128
 ds_read_b64_tr_b16 a[178:179], v8 offset:640
 v_mul_f32 v38, s32, v38
 v_mul_f32 v39, s32, v39
 v_mfma_f32_16x16x32_bf16 v[252:255], a[188:191], v[48:51], v[252:255]
 v_exp_f32 v38, v38
 v_mfma_f32_16x16x32_bf16 v[252:255], a[220:223], v[52:55], v[252:255]
 v_exp_f32 v39, v39
 v_cvt_pk_bf16_f32 v46, v36, v37
 v_cvt_pk_bf16_f32 v47, v38, v39
 v_mfma_f32_16x16x32_bf16 v[32:35], a[128:131], a[16:19], 0
 ds_read_b64_tr_b16 a[208:209], v8 offset:17024
 ds_read_b64_tr_b16 a[210:211], v8 offset:17536
 v_mfma_f32_16x16x32_bf16 v[32:35], a[132:135], a[20:23], v[32:35]
 v_mul_f32 v24, s32, v24
 v_mul_f32 v25, s32, v25
 v_mfma_f32_16x16x32_bf16 v[32:35], a[136:139], a[24:27], v[32:35]
 v_exp_f32 v24, v24
 v_mfma_f32_16x16x32_bf16 v[32:35], a[140:143], a[28:31], v[32:35]
 ds_read_b64_tr_b16 a[180:181], v8 offset:160
 ds_read_b64_tr_b16 a[182:183], v8 offset:672
 v_exp_f32 v25, v25
 v_mfma_f32_16x16x32_bf16 v[36:39], a[156:159], a[28:31], 0
 v_mul_f32 v26, s32, v26
 v_mul_f32 v27, s32, v27
 v_mfma_f32_16x16x32_bf16 v[36:39], a[152:155], a[24:27], v[36:39]
 v_exp_f32 v26, v26
 v_mfma_f32_16x16x32_bf16 v[36:39], a[148:151], a[20:23], v[36:39]
 ds_read_b64_tr_b16 a[212:213], v8 offset:17056
 ds_read_b64_tr_b16 a[214:215], v8 offset:17568
 v_mfma_f32_16x16x32_bf16 v[36:39], a[144:147], a[16:19], v[36:39]
 s_waitcnt lgkmcnt(15)
 v_exp_f32 v27, v27
 v_mul_f32 v28, s32, v28
 v_mfma_f32_16x16x32_bf16 v[64:67], a[160:163], v[40:43], v[64:67]
 v_mul_f32 v29, s32, v29
 v_cvt_pk_bf16_f32 v48, v24, v25
 v_mfma_f32_16x16x32_bf16 v[64:67], a[192:195], v[44:47], v[64:67]
 ds_read_b64_tr_b16 a[184:185], v8 offset:192
 ds_read_b64_tr_b16 a[186:187], v8 offset:704
 v_cvt_pk_bf16_f32 v49, v26, v27
 v_mfma_f32_16x16x32_bf16 v[68:71], a[164:167], v[40:43], v[68:71]
 v_exp_f32 v28, v28
 v_mfma_f32_16x16x32_bf16 v[68:71], a[196:199], v[44:47], v[68:71]
 s_waitcnt lgkmcnt(10)
 v_exp_f32 v29, v29
 v_mul_f32 v30, s32, v30
 v_mul_f32 v31, s32, v31
 v_mfma_f32_16x16x32_bf16 v[72:75], a[168:171], v[40:43], v[72:75]
 ds_read_b64_tr_b16 a[216:217], v8 offset:17088
 ds_read_b64_tr_b16 a[218:219], v8 offset:17600
 v_mfma_f32_16x16x32_bf16 v[72:75], a[200:203], v[44:47], v[72:75]
 v_mfma_f32_16x16x32_bf16 v[76:79], a[172:175], v[40:43], v[76:79]
 v_exp_f32 v30, v30
 v_mfma_f32_16x16x32_bf16 v[76:79], a[204:207], v[44:47], v[76:79]
 ds_read_b64_tr_b16 a[188:189], v8 offset:224
 ds_read_b64_tr_b16 a[190:191], v8 offset:736
 v_exp_f32 v31, v31
 v_mfma_f32_16x16x32_bf16 v[24:27], a[96:99], a[32:35], 0
 ds_read_b128 v[60:63], v6 offset:5440
 v_cvt_pk_bf16_f32 v50, v28, v29
 v_mfma_f32_16x16x32_bf16 v[24:27], a[100:103], a[36:39], v[24:27]
 v_cvt_pk_bf16_f32 v51, v30, v31
 v_mul_f32 v32, s32, v32
 v_mfma_f32_16x16x32_bf16 v[24:27], a[104:107], a[40:43], v[24:27]
 ds_read_b64_tr_b16 a[220:221], v8 offset:17120
 ds_read_b64_tr_b16 a[222:223], v8 offset:17632
 v_mfma_f32_16x16x32_bf16 v[24:27], a[108:111], a[44:47], v[24:27]
 v_mul_f32 v33, s32, v33
 v_exp_f32 v32, v32
 v_smfmac_f32_16x16x64_bf16 a[224:227], a[236:239], v[40:47], v2
 v_exp_f32 v33, v33
 v_mfma_f32_16x16x32_bf16 v[28:31], a[124:127], a[44:47], 0
 v_mul_f32 v34, s32, v34
 v_mul_f32 v35, s32, v35
 v_mfma_f32_16x16x32_bf16 v[28:31], a[120:123], a[40:43], v[28:31]
 v_exp_f32 v34, v34
 v_mfma_f32_16x16x32_bf16 v[28:31], a[116:119], a[36:39], v[28:31]
 v_exp_f32 v35, v35
 v_mfma_f32_16x16x32_bf16 v[28:31], a[112:115], a[32:35], v[28:31]
 s_waitcnt lgkmcnt(9)
 v_mul_f32 v36, s32, v36
 v_mul_f32 v37, s32, v37
 v_mfma_f32_16x16x32_bf16 v[80:83], a[176:179], v[40:43], v[80:83]
 s_mov_b32 s38, 5120
 v_cvt_pk_bf16_f32 v52, v32, v33
 v_cvt_pk_bf16_f32 v53, v34, v35
 v_mfma_f32_16x16x32_bf16 v[80:83], a[208:211], v[44:47], v[80:83]
 s_waitcnt lgkmcnt(2)
 buffer_store_dwordx4 v[60:63], v1, s[24:27], s38 offen sc1 nt
 v_mfma_f32_16x16x32_bf16 v[84:87], a[180:183], v[40:43], v[84:87]
 v_exp_f32 v36, v36
 v_mfma_f32_16x16x32_bf16 v[84:87], a[212:215], v[44:47], v[84:87]
 s_waitcnt lgkmcnt(0)
 s_barrier
 v_mfma_f32_16x16x32_bf16 v[88:91], a[184:187], v[40:43], v[88:91]
 v_mfma_f32_16x16x32_bf16 v[88:91], a[216:219], v[44:47], v[88:91]
 v_exp_f32 v37, v37
 v_mfma_f32_16x16x32_bf16 v[92:95], a[188:191], v[40:43], v[92:95]
 v_mul_f32 v38, s32, v38
 v_mul_f32 v39, s32, v39
 v_mfma_f32_16x16x32_bf16 v[92:95], a[220:223], v[44:47], v[92:95]
 v_exp_f32 v38, v38
 v_mfma_f32_16x16x32_bf16 v[32:35], a[128:131], a[32:35], 0
 v_exp_f32 v39, v39
 v_mfma_f32_16x16x32_bf16 v[32:35], a[132:135], a[36:39], v[32:35]
 v_cvt_pk_bf16_f32 v54, v36, v37
 v_cvt_pk_bf16_f32 v55, v38, v39
 v_mfma_f32_16x16x32_bf16 v[32:35], a[136:139], a[40:43], v[32:35]
 v_mul_f32 v24, s32, v24
 v_mul_f32 v25, s32, v25
 v_mfma_f32_16x16x32_bf16 v[32:35], a[140:143], a[44:47], v[32:35]
 v_exp_f32 v24, v24
 v_mfma_f32_16x16x32_bf16 v[36:39], a[156:159], a[44:47], 0
 v_exp_f32 v25, v25
 v_mfma_f32_16x16x32_bf16 v[36:39], a[152:155], a[40:43], v[36:39]
 v_mul_f32 v26, s32, v26
 v_mul_f32 v27, s32, v27
 v_mfma_f32_16x16x32_bf16 v[36:39], a[148:151], a[36:39], v[36:39]
 s_add_u32 m0, s39, 0
 v_exp_f32 v26, v26
 v_mfma_f32_16x16x32_bf16 v[36:39], a[144:147], a[32:35], v[36:39]
 buffer_load_dwordx4 v1, s[20:23], s33 offen nt lds
 v_mfma_f32_16x16x32_bf16 v[96:99], a[160:163], v[48:51], v[96:99]
 v_exp_f32 v27, v27
 v_mfma_f32_16x16x32_bf16 v[96:99], a[192:195], v[52:55], v[96:99]
 v_mfma_f32_16x16x32_bf16 v[100:103], a[164:167], v[48:51], v[100:103]
 v_mul_f32 v28, s32, v28
 v_mul_f32 v29, s32, v29
 v_mfma_f32_16x16x32_bf16 v[100:103], a[196:199], v[52:55], v[100:103]
 v_cvt_pk_bf16_f32 v40, v24, v25
 v_cvt_pk_bf16_f32 v41, v26, v27
 v_mfma_f32_16x16x32_bf16 v[104:107], a[168:171], v[48:51], v[104:107]
 v_exp_f32 v28, v28
 v_mfma_f32_16x16x32_bf16 v[104:107], a[200:203], v[52:55], v[104:107]
 v_exp_f32 v29, v29
 v_mfma_f32_16x16x32_bf16 v[108:111], a[172:175], v[48:51], v[108:111]
 v_mul_f32 v30, s32, v30
 v_mul_f32 v31, s32, v31
 v_mfma_f32_16x16x32_bf16 v[108:111], a[204:207], v[52:55], v[108:111]
 v_exp_f32 v30, v30
 v_mfma_f32_16x16x32_bf16 v[24:27], a[96:99], a[48:51], 0
 v_exp_f32 v31, v31
 v_mfma_f32_16x16x32_bf16 v[24:27], a[100:103], a[52:55], v[24:27]
 v_cvt_pk_bf16_f32 v42, v28, v29
 v_cvt_pk_bf16_f32 v43, v30, v31
 v_mfma_f32_16x16x32_bf16 v[24:27], a[104:107], a[56:59], v[24:27]
 v_mul_f32 v32, s32, v32
 v_mul_f32 v33, s32, v33
 v_mfma_f32_16x16x32_bf16 v[24:27], a[108:111], a[60:63], v[24:27]
 v_smfmac_f32_16x16x64_bf16 a[224:227], a[240:243], v[48:55], v2
 v_exp_f32 v32, v32
 v_exp_f32 v33, v33
 v_mfma_f32_16x16x32_bf16 v[28:31], a[124:127], a[60:63], 0
 v_mul_f32 v34, s32, v34
 v_mul_f32 v35, s32, v35
 v_mfma_f32_16x16x32_bf16 v[28:31], a[120:123], a[56:59], v[28:31]
 v_exp_f32 v34, v34
 v_mfma_f32_16x16x32_bf16 v[28:31], a[116:119], a[52:55], v[28:31]
 s_add_u32 m0, s39, 32
 v_mfma_f32_16x16x32_bf16 v[28:31], a[112:115], a[48:51], v[28:31]
 buffer_load_dwordx4 v1, s[20:23], s33 offen offset:1024 nt lds
 v_mfma_f32_16x16x32_bf16 v[112:115], a[176:179], v[48:51], v[112:115]
 v_exp_f32 v35, v35
 v_mfma_f32_16x16x32_bf16 v[112:115], a[208:211], v[52:55], v[112:115]
 v_mul_f32 v36, s32, v36
 v_mul_f32 v37, s32, v37
 v_cvt_pk_bf16_f32 v44, v32, v33
 v_cvt_pk_bf16_f32 v45, v34, v35
 v_mfma_f32_16x16x32_bf16 v[116:119], a[180:183], v[48:51], v[116:119]
 v_exp_f32 v36, v36
 v_mfma_f32_16x16x32_bf16 v[116:119], a[212:215], v[52:55], v[116:119]
 v_mfma_f32_16x16x32_bf16 v[120:123], a[184:187], v[48:51], v[120:123]
 v_exp_f32 v37, v37
 v_mfma_f32_16x16x32_bf16 v[120:123], a[216:219], v[52:55], v[120:123]
 v_mul_f32 v38, s32, v38
 v_mul_f32 v39, s32, v39
 v_exp_f32 v38, v38
 v_mfma_f32_16x16x32_bf16 v[124:127], a[188:191], v[48:51], v[124:127]
 v_exp_f32 v39, v39
 v_mfma_f32_16x16x32_bf16 v[124:127], a[220:223], v[52:55], v[124:127]
 v_mfma_f32_16x16x32_bf16 v[32:35], a[128:131], a[48:51], 0
 v_cvt_pk_bf16_f32 v46, v36, v37
 v_cvt_pk_bf16_f32 v47, v38, v39
 v_mfma_f32_16x16x32_bf16 v[32:35], a[132:135], a[52:55], v[32:35]
 v_mul_f32 v24, s32, v24
 v_mul_f32 v25, s32, v25
 v_mfma_f32_16x16x32_bf16 v[32:35], a[136:139], a[56:59], v[32:35]
 v_exp_f32 v24, v24
 v_mfma_f32_16x16x32_bf16 v[32:35], a[140:143], a[60:63], v[32:35]
 v_mfma_f32_16x16x32_bf16 v[36:39], a[156:159], a[60:63], 0
 v_exp_f32 v25, v25
 v_mfma_f32_16x16x32_bf16 v[36:39], a[152:155], a[56:59], v[36:39]
 v_mul_f32 v26, s32, v26
 v_mul_f32 v27, s32, v27
 v_mfma_f32_16x16x32_bf16 v[36:39], a[148:151], a[52:55], v[36:39]
 v_exp_f32 v26, v26
 v_mfma_f32_16x16x32_bf16 v[36:39], a[144:147], a[48:51], v[36:39]
 v_mfma_f32_16x16x32_bf16 v[128:131], a[160:163], v[40:43], v[128:131]
 s_add_u32 m0, s39, 64
 v_exp_f32 v27, v27
 v_mfma_f32_16x16x32_bf16 v[128:131], a[192:195], v[44:47], v[128:131]
 buffer_load_dwordx4 v1, s[20:23], s33 offen offset:2048 nt lds
 v_mul_f32 v28, s32, v28
 v_mul_f32 v29, s32, v29
 v_mfma_f32_16x16x32_bf16 v[132:135], a[164:167], v[40:43], v[132:135]
 v_cvt_pk_bf16_f32 v48, v24, v25
 v_cvt_pk_bf16_f32 v49, v26, v27
 v_mfma_f32_16x16x32_bf16 v[132:135], a[196:199], v[44:47], v[132:135]
 v_mfma_f32_16x16x32_bf16 v[136:139], a[168:171], v[40:43], v[136:139]
 v_exp_f32 v28, v28
 v_mfma_f32_16x16x32_bf16 v[136:139], a[200:203], v[44:47], v[136:139]
 v_exp_f32 v29, v29
 v_mul_f32 v30, s32, v30
 v_mul_f32 v31, s32, v31
 v_mfma_f32_16x16x32_bf16 v[140:143], a[172:175], v[40:43], v[140:143]
 v_exp_f32 v30, v30
 v_mfma_f32_16x16x32_bf16 v[140:143], a[204:207], v[44:47], v[140:143]
 v_mfma_f32_16x16x32_bf16 v[24:27], a[96:99], a[64:67], 0
 v_exp_f32 v31, v31
 v_mfma_f32_16x16x32_bf16 v[24:27], a[100:103], a[68:71], v[24:27]
 v_cvt_pk_bf16_f32 v50, v28, v29
 v_cvt_pk_bf16_f32 v51, v30, v31
 v_mfma_f32_16x16x32_bf16 v[24:27], a[104:107], a[72:75], v[24:27]
 v_mul_f32 v32, s32, v32
 v_mul_f32 v33, s32, v33
 v_mfma_f32_16x16x32_bf16 v[24:27], a[108:111], a[76:79], v[24:27]
 v_smfmac_f32_16x16x64_bf16 a[228:231], a[236:239], v[40:47], v2
 v_exp_f32 v32, v32
 v_mfma_f32_16x16x32_bf16 v[28:31], a[124:127], a[76:79], 0
 v_exp_f32 v33, v33
 v_mfma_f32_16x16x32_bf16 v[28:31], a[120:123], a[72:75], v[28:31]
 v_mul_f32 v34, s32, v34
 v_mul_f32 v35, s32, v35
 v_mfma_f32_16x16x32_bf16 v[28:31], a[116:119], a[68:71], v[28:31]
 v_mfma_f32_16x16x32_bf16 v[28:31], a[112:115], a[64:67], v[28:31]
 v_exp_f32 v34, v34
 v_exp_f32 v35, v35
 v_mfma_f32_16x16x32_bf16 v[144:147], a[176:179], v[40:43], v[144:147]
 s_add_u32 m0, s39, 96
 v_mul_f32 v36, s32, v36
 v_mul_f32 v37, s32, v37
 v_mfma_f32_16x16x32_bf16 v[144:147], a[208:211], v[44:47], v[144:147]
 buffer_load_dwordx4 v1, s[20:23], s33 offen offset:3072 nt lds
 v_mfma_f32_16x16x32_bf16 v[148:151], a[180:183], v[40:43], v[148:151]
 s_add_u32 s33, s33, 8192
 v_cvt_pk_bf16_f32 v52, v32, v33
 v_cvt_pk_bf16_f32 v53, v34, v35
 v_mfma_f32_16x16x32_bf16 v[148:151], a[212:215], v[44:47], v[148:151]
 v_mfma_f32_16x16x32_bf16 v[152:155], a[184:187], v[40:43], v[152:155]
 v_exp_f32 v36, v36
 v_mfma_f32_16x16x32_bf16 v[152:155], a[216:219], v[44:47], v[152:155]
 v_exp_f32 v37, v37
 v_mul_f32 v38, s32, v38
 v_mul_f32 v39, s32, v39
 v_mfma_f32_16x16x32_bf16 v[156:159], a[188:191], v[40:43], v[156:159]
 v_mfma_f32_16x16x32_bf16 v[156:159], a[220:223], v[44:47], v[156:159]
 v_exp_f32 v38, v38
 v_exp_f32 v39, v39
 v_mfma_f32_16x16x32_bf16 v[32:35], a[128:131], a[64:67], 0
 v_cvt_pk_bf16_f32 v54, v36, v37
 v_cvt_pk_bf16_f32 v55, v38, v39
 v_mfma_f32_16x16x32_bf16 v[32:35], a[132:135], a[68:71], v[32:35]
 v_mul_f32 v24, s32, v24
 v_mul_f32 v25, s32, v25
 v_mfma_f32_16x16x32_bf16 v[32:35], a[136:139], a[72:75], v[32:35]
 v_mfma_f32_16x16x32_bf16 v[32:35], a[140:143], a[76:79], v[32:35]
 v_exp_f32 v24, v24
 v_exp_f32 v25, v25
 v_mfma_f32_16x16x32_bf16 v[36:39], a[156:159], a[76:79], 0
 v_mul_f32 v26, s32, v26
 v_mul_f32 v27, s32, v27
 v_mfma_f32_16x16x32_bf16 v[36:39], a[152:155], a[72:75], v[36:39]
 v_exp_f32 v26, v26
 v_mfma_f32_16x16x32_bf16 v[36:39], a[148:151], a[68:71], v[36:39]
 v_mfma_f32_16x16x32_bf16 v[36:39], a[144:147], a[64:67], v[36:39]
 v_exp_f32 v27, v27
 v_mul_f32 v28, s32, v28
 v_mfma_f32_16x16x32_bf16 v[160:163], a[160:163], v[48:51], v[160:163]
 v_mul_f32 v29, s32, v29
 v_cvt_pk_bf16_f32 v40, v24, v25
 v_mfma_f32_16x16x32_bf16 v[160:163], a[192:195], v[52:55], v[160:163]
 v_cvt_pk_bf16_f32 v41, v26, v27
 v_exp_f32 v28, v28
 v_mfma_f32_16x16x32_bf16 v[164:167], a[164:167], v[48:51], v[164:167]
 s_add_u32 m0, s39, 16896
 v_mfma_f32_16x16x32_bf16 v[164:167], a[196:199], v[52:55], v[164:167]
 buffer_load_dwordx4 v1, s[20:23], s33 offen nt lds
 v_mfma_f32_16x16x32_bf16 v[168:171], a[168:171], v[48:51], v[168:171]
 v_exp_f32 v29, v29
 v_mfma_f32_16x16x32_bf16 v[168:171], a[200:203], v[52:55], v[168:171]
 v_mul_f32 v30, s32, v30
 v_mul_f32 v31, s32, v31
 v_exp_f32 v30, v30
 v_mfma_f32_16x16x32_bf16 v[172:175], a[172:175], v[48:51], v[172:175]
 v_exp_f32 v31, v31
 v_mfma_f32_16x16x32_bf16 v[172:175], a[204:207], v[52:55], v[172:175]
 v_mfma_f32_16x16x32_bf16 v[24:27], a[96:99], a[80:83], 0
 v_cvt_pk_bf16_f32 v42, v28, v29
 v_cvt_pk_bf16_f32 v43, v30, v31
 v_mfma_f32_16x16x32_bf16 v[24:27], a[100:103], a[84:87], v[24:27]
 v_mul_f32 v32, s32, v32
 v_mul_f32 v33, s32, v33
 v_mfma_f32_16x16x32_bf16 v[24:27], a[104:107], a[88:91], v[24:27]
 v_exp_f32 v32, v32
 v_mfma_f32_16x16x32_bf16 v[24:27], a[108:111], a[92:95], v[24:27]
 v_smfmac_f32_16x16x64_bf16 a[228:231], a[240:243], v[48:55], v2
 v_exp_f32 v33, v33
 v_mul_f32 v34, s32, v34
 v_mul_f32 v35, s32, v35
 v_mfma_f32_16x16x32_bf16 v[28:31], a[124:127], a[92:95], 0
 v_exp_f32 v34, v34
 v_mfma_f32_16x16x32_bf16 v[28:31], a[120:123], a[88:91], v[28:31]
 v_mfma_f32_16x16x32_bf16 v[28:31], a[116:119], a[84:87], v[28:31]
 v_exp_f32 v35, v35
 v_mfma_f32_16x16x32_bf16 v[28:31], a[112:115], a[80:83], v[28:31]
 s_waitcnt vmcnt(7)
 s_barrier
 v_mfma_f32_16x16x32_bf16 v[176:179], a[176:179], v[48:51], v[176:179]
 v_mul_f32 v36, s32, v36
 v_mul_f32 v37, s32, v37
 v_mfma_f32_16x16x32_bf16 v[176:179], a[208:211], v[52:55], v[176:179]
 v_cvt_pk_bf16_f32 v44, v32, v33
 v_cvt_pk_bf16_f32 v45, v34, v35
 v_exp_f32 v36, v36
 v_mfma_f32_16x16x32_bf16 v[180:183], a[180:183], v[48:51], v[180:183]
 s_add_u32 m0, s39, 16928
 ds_read_b128 a[96:99], v7 offset:33792
 ds_read_b128 a[100:103], v7 offset:33856
 v_mfma_f32_16x16x32_bf16 v[180:183], a[212:215], v[52:55], v[180:183]
 buffer_load_dwordx4 v1, s[20:23], s33 offen offset:1024 nt lds
 v_exp_f32 v37, v37
 v_mfma_f32_16x16x32_bf16 v[184:187], a[184:187], v[48:51], v[184:187]
 v_mfma_f32_16x16x32_bf16 v[184:187], a[216:219], v[52:55], v[184:187]
 v_mul_f32 v38, s32, v38
 v_mul_f32 v39, s32, v39
 v_exp_f32 v38, v38
 v_mfma_f32_16x16x32_bf16 v[188:191], a[188:191], v[48:51], v[188:191]
 ds_read_b128 a[104:107], v7 offset:33920
 ds_read_b128 a[108:111], v7 offset:33984
 v_mfma_f32_16x16x32_bf16 v[188:191], a[220:223], v[52:55], v[188:191]
 v_exp_f32 v39, v39
 v_cvt_pk_bf16_f32 v46, v36, v37
 v_cvt_pk_bf16_f32 v47, v38, v39
 v_mfma_f32_16x16x32_bf16 v[32:35], a[128:131], a[80:83], 0
 v_mul_f32 v24, s32, v24
 v_mul_f32 v25, s32, v25
 v_mfma_f32_16x16x32_bf16 v[32:35], a[132:135], a[84:87], v[32:35]
 v_mfma_f32_16x16x32_bf16 v[32:35], a[136:139], a[88:91], v[32:35]
 ds_read_b128 a[124:127], v7 offset:34496
 ds_read_b128 a[120:123], v7 offset:34432
 v_mfma_f32_16x16x32_bf16 v[32:35], a[140:143], a[92:95], v[32:35]
 v_exp_f32 v24, v24
 v_exp_f32 v25, v25
 v_mfma_f32_16x16x32_bf16 v[36:39], a[156:159], a[92:95], 0
 v_mul_f32 v26, s32, v26
 v_mul_f32 v27, s32, v27
 v_mfma_f32_16x16x32_bf16 v[36:39], a[152:155], a[88:91], v[36:39]
 v_exp_f32 v26, v26
 v_mfma_f32_16x16x32_bf16 v[36:39], a[148:151], a[84:87], v[36:39]
 ds_read_b128 a[116:119], v7 offset:34368
 ds_read_b128 a[112:115], v7 offset:34304
 v_mfma_f32_16x16x32_bf16 v[36:39], a[144:147], a[80:83], v[36:39]
 v_mfma_f32_16x16x32_bf16 v[192:195], a[160:163], v[40:43], v[192:195]
 v_exp_f32 v27, v27
 v_mfma_f32_16x16x32_bf16 v[192:195], a[192:195], v[44:47], v[192:195]
 v_mul_f32 v28, s32, v28
 v_mul_f32 v29, s32, v29
 v_cvt_pk_bf16_f32 v48, v24, v25
 v_cvt_pk_bf16_f32 v49, v26, v27
 v_mfma_f32_16x16x32_bf16 v[196:199], a[164:167], v[40:43], v[196:199]
 v_exp_f32 v28, v28
 v_mfma_f32_16x16x32_bf16 v[196:199], a[196:199], v[44:47], v[196:199]
 ds_read_b128 a[128:131], v7 offset:50688
 ds_read_b128 a[132:135], v7 offset:50752
 v_exp_f32 v29, v29
 v_mfma_f32_16x16x32_bf16 v[200:203], a[168:171], v[40:43], v[200:203]
 s_add_u32 m0, s39, 16960
 v_mfma_f32_16x16x32_bf16 v[200:203], a[200:203], v[44:47], v[200:203]
 buffer_load_dwordx4 v1, s[20:23], s33 offen offset:2048 nt lds
 v_mfma_f32_16x16x32_bf16 v[204:207], a[172:175], v[40:43], v[204:207]
 v_mul_f32 v30, s32, v30
 v_mul_f32 v31, s32, v31
 v_mfma_f32_16x16x32_bf16 v[204:207], a[204:207], v[44:47], v[204:207]
 s_waitcnt lgkmcnt(6)
 ds_read_b128 a[136:139], v7 offset:50816
 ds_read_b128 a[140:143], v7 offset:50880
 v_exp_f32 v30, v30
 v_mfma_f32_16x16x32_bf16 v[24:27], a[96:99], a[0:3], 0
 v_exp_f32 v31, v31
 v_mfma_f32_16x16x32_bf16 v[24:27], a[100:103], a[4:7], v[24:27]
 v_cvt_pk_bf16_f32 v50, v28, v29
 v_cvt_pk_bf16_f32 v51, v30, v31
 v_mfma_f32_16x16x32_bf16 v[24:27], a[104:107], a[8:11], v[24:27]
 v_mul_f32 v32, s32, v32
 v_mul_f32 v33, s32, v33
 v_mfma_f32_16x16x32_bf16 v[24:27], a[108:111], a[12:15], v[24:27]
 s_waitcnt lgkmcnt(4)
 ds_read_b128 a[156:159], v7 offset:51392
 ds_read_b128 a[152:155], v7 offset:51328
 v_exp_f32 v32, v32
 v_smfmac_f32_16x16x64_bf16 a[232:235], a[236:239], v[40:47], v2
 v_exp_f32 v33, v33
 v_mfma_f32_16x16x32_bf16 v[28:31], a[124:127], a[12:15], 0
 v_mul_f32 v34, s32, v34
 v_mul_f32 v35, s32, v35
 v_mfma_f32_16x16x32_bf16 v[28:31], a[120:123], a[8:11], v[28:31]
 v_exp_f32 v34, v34
 v_mfma_f32_16x16x32_bf16 v[28:31], a[116:119], a[4:7], v[28:31]
 ds_read_b128 a[148:151], v7 offset:51264
 ds_read_b128 a[144:147], v7 offset:51200
 v_mfma_f32_16x16x32_bf16 v[28:31], a[112:115], a[0:3], v[28:31]
 v_exp_f32 v35, v35
 v_mul_f32 v36, s32, v36
 v_mul_f32 v37, s32, v37
 v_mfma_f32_16x16x32_bf16 v[208:211], a[176:179], v[40:43], v[208:211]
 v_cvt_pk_bf16_f32 v52, v32, v33
 v_cvt_pk_bf16_f32 v53, v34, v35
 v_mfma_f32_16x16x32_bf16 v[208:211], a[208:211], v[44:47], v[208:211]
 v_mfma_f32_16x16x32_bf16 v[212:215], a[180:183], v[40:43], v[212:215]
 s_add_u32 m0, s39, 16992
 v_exp_f32 v36, v36
 v_mfma_f32_16x16x32_bf16 v[212:215], a[212:215], v[44:47], v[212:215]
 buffer_load_dwordx4 v1, s[20:23], s33 offen offset:3072 nt lds
 v_mfma_f32_16x16x32_bf16 v[216:219], a[184:187], v[40:43], v[216:219]
 s_add_u32 s33, s33, 8192
 v_exp_f32 v37, v37
 v_mfma_f32_16x16x32_bf16 v[216:219], a[216:219], v[44:47], v[216:219]
 v_mul_f32 v38, s32, v38
 v_mul_f32 v39, s32, v39
 v_mfma_f32_16x16x32_bf16 v[220:223], a[188:191], v[40:43], v[220:223]
 v_exp_f32 v38, v38
 v_mfma_f32_16x16x32_bf16 v[220:223], a[220:223], v[44:47], v[220:223]
 s_waitcnt lgkmcnt(4)
 ds_read_b128 v[56:59], v6 offset:6528
 v_exp_f32 v39, v39
 v_mfma_f32_16x16x32_bf16 v[32:35], a[128:131], a[0:3], 0
 v_cvt_pk_bf16_f32 v54, v36, v37
 v_cvt_pk_bf16_f32 v55, v38, v39
 v_mfma_f32_16x16x32_bf16 v[32:35], a[132:135], a[4:7], v[32:35]
 v_mul_f32 v24, s32, v24
 v_mul_f32 v25, s32, v25
 v_mfma_f32_16x16x32_bf16 v[32:35], a[136:139], a[8:11], v[32:35]
 v_exp_f32 v24, v24
 v_mfma_f32_16x16x32_bf16 v[32:35], a[140:143], a[12:15], v[32:35]
 s_waitcnt lgkmcnt(1)
 v_exp_f32 v25, v25
 v_mfma_f32_16x16x32_bf16 v[36:39], a[156:159], a[12:15], 0
 v_mul_f32 v26, s32, v26
 v_mul_f32 v27, s32, v27
 v_mfma_f32_16x16x32_bf16 v[36:39], a[152:155], a[8:11], v[36:39]
 v_exp_f32 v26, v26
 v_mfma_f32_16x16x32_bf16 v[36:39], a[148:151], a[4:7], v[36:39]
 v_mfma_f32_16x16x32_bf16 v[36:39], a[144:147], a[0:3], v[36:39]
 v_exp_f32 v27, v27
 v_mul_f32 v28, s32, v28
 v_mfma_f32_16x16x32_bf16 v[224:227], a[160:163], v[48:51], v[224:227]
 s_mov_b32 s38, 6144
 v_mul_f32 v29, s32, v29
 v_cvt_pk_bf16_f32 v40, v24, v25
 v_mfma_f32_16x16x32_bf16 v[224:227], a[192:195], v[52:55], v[224:227]
 s_waitcnt lgkmcnt(0)
 buffer_store_dwordx4 v[56:59], v1, s[24:27], s38 offen sc1 nt
 v_mfma_f32_16x16x32_bf16 v[228:231], a[164:167], v[48:51], v[228:231]
 ds_read_b64_tr_b16 a[160:161], v8 offset:33792
 ds_read_b64_tr_b16 a[162:163], v8 offset:34304
 v_mfma_f32_16x16x32_bf16 v[228:231], a[196:199], v[52:55], v[228:231]
 v_cvt_pk_bf16_f32 v41, v26, v27
 v_exp_f32 v28, v28
 v_mfma_f32_16x16x32_bf16 v[232:235], a[168:171], v[48:51], v[232:235]
 ds_read_b64_tr_b16 a[192:193], v8 offset:50688
 ds_read_b64_tr_b16 a[194:195], v8 offset:51200
 v_mfma_f32_16x16x32_bf16 v[232:235], a[200:203], v[52:55], v[232:235]
 v_exp_f32 v29, v29
 v_mul_f32 v30, s32, v30
 v_mul_f32 v31, s32, v31
 v_mfma_f32_16x16x32_bf16 v[236:239], a[172:175], v[48:51], v[236:239]
 v_exp_f32 v30, v30
 v_mfma_f32_16x16x32_bf16 v[236:239], a[204:207], v[52:55], v[236:239]
 ds_read_b64_tr_b16 a[164:165], v8 offset:33824
 ds_read_b64_tr_b16 a[166:167], v8 offset:34336
 v_exp_f32 v31, v31
 v_mfma_f32_16x16x32_bf16 v[24:27], a[96:99], a[16:19], 0
 v_cvt_pk_bf16_f32 v42, v28, v29
 v_cvt_pk_bf16_f32 v43, v30, v31
 v_mfma_f32_16x16x32_bf16 v[24:27], a[100:103], a[20:23], v[24:27]
 ds_read_b64_tr_b16 a[196:197], v8 offset:50720
 ds_read_b64_tr_b16 a[198:199], v8 offset:51232
 v_mfma_f32_16x16x32_bf16 v[24:27], a[104:107], a[24:27], v[24:27]
 v_mul_f32 v32, s32, v32
 v_mul_f32 v33, s32, v33
 v_mfma_f32_16x16x32_bf16 v[24:27], a[108:111], a[28:31], v[24:27]
 ds_read_b64_tr_b16 a[168:169], v8 offset:33856
 ds_read_b64_tr_b16 a[170:171], v8 offset:34368
 v_exp_f32 v32, v32
 v_smfmac_f32_16x16x64_bf16 a[232:235], a[240:243], v[48:55], v2
 v_exp_f32 v33, v33
 v_mfma_f32_16x16x32_bf16 v[28:31], a[124:127], a[28:31], 0
 ds_read_b64_tr_b16 a[200:201], v8 offset:50752
 ds_read_b64_tr_b16 a[202:203], v8 offset:51264
 v_mfma_f32_16x16x32_bf16 v[28:31], a[120:123], a[24:27], v[28:31]
 v_mul_f32 v34, s32, v34
 v_mul_f32 v35, s32, v35
 v_mfma_f32_16x16x32_bf16 v[28:31], a[116:119], a[20:23], v[28:31]
 v_exp_f32 v34, v34
 v_mfma_f32_16x16x32_bf16 v[28:31], a[112:115], a[16:19], v[28:31]
 ds_read_b64_tr_b16 a[172:173], v8 offset:33888
 ds_read_b64_tr_b16 a[174:175], v8 offset:34400
 v_exp_f32 v35, v35
 v_mfma_f32_16x16x32_bf16 v[240:243], a[176:179], v[48:51], v[240:243]
 v_mul_f32 v36, s32, v36
 v_mul_f32 v37, s32, v37
 v_mfma_f32_16x16x32_bf16 v[240:243], a[208:211], v[52:55], v[240:243]
 ds_read_b64_tr_b16 a[204:205], v8 offset:50784
 ds_read_b64_tr_b16 a[206:207], v8 offset:51296
 v_cvt_pk_bf16_f32 v44, v32, v33
 v_mfma_f32_16x16x32_bf16 v[244:247], a[180:183], v[48:51], v[244:247]
 v_mfma_f32_16x16x32_bf16 v[244:247], a[212:215], v[52:55], v[244:247]
 v_cvt_pk_bf16_f32 v45, v34, v35
 v_exp_f32 v36, v36
 v_mfma_f32_16x16x32_bf16 v[248:251], a[184:187], v[48:51], v[248:251]
 v_exp_f32 v37, v37
 v_mfma_f32_16x16x32_bf16 v[248:251], a[216:219], v[52:55], v[248:251]
 ds_read_b64_tr_b16 a[176:177], v8 offset:33920
 ds_read_b64_tr_b16 a[178:179], v8 offset:34432
 v_mul_f32 v38, s32, v38
 v_mul_f32 v39, s32, v39
 v_mfma_f32_16x16x32_bf16 v[252:255], a[188:191], v[48:51], v[252:255]
 v_exp_f32 v38, v38
 v_mfma_f32_16x16x32_bf16 v[252:255], a[220:223], v[52:55], v[252:255]
 v_exp_f32 v39, v39
 v_cvt_pk_bf16_f32 v46, v36, v37
 v_cvt_pk_bf16_f32 v47, v38, v39
 v_mfma_f32_16x16x32_bf16 v[32:35], a[128:131], a[16:19], 0
L_pg0_9:
 s_cbranch_execz L_pg0_13
 ds_read_b64_tr_b16 a[208:209], v8 offset:50816
 ds_read_b64_tr_b16 a[210:211], v8 offset:51328
 v_mfma_f32_16x16x32_bf16 v[32:35], a[132:135], a[20:23], v[32:35]
 v_mul_f32 v24, s32, v24
 v_mul_f32 v25, s32, v25
 v_mfma_f32_16x16x32_bf16 v[32:35], a[136:139], a[24:27], v[32:35]
 v_exp_f32 v24, v24
 v_mfma_f32_16x16x32_bf16 v[32:35], a[140:143], a[28:31], v[32:35]
 ds_read_b64_tr_b16 a[180:181], v8 offset:33952
 ds_read_b64_tr_b16 a[182:183], v8 offset:34464
 v_exp_f32 v25, v25
 v_mfma_f32_16x16x32_bf16 v[36:39], a[156:159], a[28:31], 0
 v_mul_f32 v26, s32, v26
 v_mul_f32 v27, s32, v27
 v_mfma_f32_16x16x32_bf16 v[36:39], a[152:155], a[24:27], v[36:39]
 v_exp_f32 v26, v26
 v_mfma_f32_16x16x32_bf16 v[36:39], a[148:151], a[20:23], v[36:39]
 ds_read_b64_tr_b16 a[212:213], v8 offset:50848
 ds_read_b64_tr_b16 a[214:215], v8 offset:51360
 v_mfma_f32_16x16x32_bf16 v[36:39], a[144:147], a[16:19], v[36:39]
 s_waitcnt lgkmcnt(15)
 v_exp_f32 v27, v27
 v_mul_f32 v28, s32, v28
 v_mfma_f32_16x16x32_bf16 v[64:67], a[160:163], v[40:43], v[64:67]
 v_mul_f32 v29, s32, v29
 v_cvt_pk_bf16_f32 v48, v24, v25
 v_mfma_f32_16x16x32_bf16 v[64:67], a[192:195], v[44:47], v[64:67]
 ds_read_b64_tr_b16 a[184:185], v8 offset:33984
 ds_read_b64_tr_b16 a[186:187], v8 offset:34496
 v_cvt_pk_bf16_f32 v49, v26, v27
 v_mfma_f32_16x16x32_bf16 v[68:71], a[164:167], v[40:43], v[68:71]
 v_exp_f32 v28, v28
 v_mfma_f32_16x16x32_bf16 v[68:71], a[196:199], v[44:47], v[68:71]
 s_waitcnt lgkmcnt(10)
 v_exp_f32 v29, v29
 v_mul_f32 v30, s32, v30
 v_mul_f32 v31, s32, v31
 v_mfma_f32_16x16x32_bf16 v[72:75], a[168:171], v[40:43], v[72:75]
 ds_read_b64_tr_b16 a[216:217], v8 offset:50880
 ds_read_b64_tr_b16 a[218:219], v8 offset:51392
 v_mfma_f32_16x16x32_bf16 v[72:75], a[200:203], v[44:47], v[72:75]
 v_mfma_f32_16x16x32_bf16 v[76:79], a[172:175], v[40:43], v[76:79]
 v_exp_f32 v30, v30
 v_mfma_f32_16x16x32_bf16 v[76:79], a[204:207], v[44:47], v[76:79]
 ds_read_b64_tr_b16 a[188:189], v8 offset:34016
 ds_read_b64_tr_b16 a[190:191], v8 offset:34528
 v_exp_f32 v31, v31
 v_mfma_f32_16x16x32_bf16 v[24:27], a[96:99], a[32:35], 0
 ds_read_b128 v[60:63], v6 offset:7616
 v_cvt_pk_bf16_f32 v50, v28, v29
 v_mfma_f32_16x16x32_bf16 v[24:27], a[100:103], a[36:39], v[24:27]
 v_cvt_pk_bf16_f32 v51, v30, v31
 v_mul_f32 v32, s32, v32
 v_mfma_f32_16x16x32_bf16 v[24:27], a[104:107], a[40:43], v[24:27]
 ds_read_b64_tr_b16 a[220:221], v8 offset:50912
 ds_read_b64_tr_b16 a[222:223], v8 offset:51424
 v_mfma_f32_16x16x32_bf16 v[24:27], a[108:111], a[44:47], v[24:27]
 v_mul_f32 v33, s32, v33
 v_exp_f32 v32, v32
 v_smfmac_f32_16x16x64_bf16 a[224:227], a[236:239], v[40:47], v2
 v_exp_f32 v33, v33
 v_mfma_f32_16x16x32_bf16 v[28:31], a[124:127], a[44:47], 0
 v_mul_f32 v34, s32, v34
 v_mul_f32 v35, s32, v35
 v_mfma_f32_16x16x32_bf16 v[28:31], a[120:123], a[40:43], v[28:31]
 v_exp_f32 v34, v34
 v_mfma_f32_16x16x32_bf16 v[28:31], a[116:119], a[36:39], v[28:31]
 v_exp_f32 v35, v35
 v_mfma_f32_16x16x32_bf16 v[28:31], a[112:115], a[32:35], v[28:31]
 s_waitcnt lgkmcnt(9)
 v_mul_f32 v36, s32, v36
 v_mul_f32 v37, s32, v37
 v_mfma_f32_16x16x32_bf16 v[80:83], a[176:179], v[40:43], v[80:83]
 s_mov_b32 s38, 7168
 v_cvt_pk_bf16_f32 v52, v32, v33
 v_cvt_pk_bf16_f32 v53, v34, v35
 v_mfma_f32_16x16x32_bf16 v[80:83], a[208:211], v[44:47], v[80:83]
 s_waitcnt lgkmcnt(2)
 buffer_store_dwordx4 v[60:63], v1, s[24:27], s38 offen sc1 nt
 v_mfma_f32_16x16x32_bf16 v[84:87], a[180:183], v[40:43], v[84:87]
 v_exp_f32 v36, v36
 v_mfma_f32_16x16x32_bf16 v[84:87], a[212:215], v[44:47], v[84:87]
 s_waitcnt lgkmcnt(0)
 s_barrier
 v_mfma_f32_16x16x32_bf16 v[88:91], a[184:187], v[40:43], v[88:91]
 v_mfma_f32_16x16x32_bf16 v[88:91], a[216:219], v[44:47], v[88:91]
 v_exp_f32 v37, v37
 v_mfma_f32_16x16x32_bf16 v[92:95], a[188:191], v[40:43], v[92:95]
 v_mul_f32 v38, s32, v38
 v_mul_f32 v39, s32, v39
 v_mfma_f32_16x16x32_bf16 v[92:95], a[220:223], v[44:47], v[92:95]
 v_exp_f32 v38, v38
 v_mfma_f32_16x16x32_bf16 v[32:35], a[128:131], a[32:35], 0
 v_exp_f32 v39, v39
 v_mfma_f32_16x16x32_bf16 v[32:35], a[132:135], a[36:39], v[32:35]
 v_cvt_pk_bf16_f32 v54, v36, v37
 v_cvt_pk_bf16_f32 v55, v38, v39
 v_mfma_f32_16x16x32_bf16 v[32:35], a[136:139], a[40:43], v[32:35]
 v_mul_f32 v24, s32, v24
 v_mul_f32 v25, s32, v25
 v_mfma_f32_16x16x32_bf16 v[32:35], a[140:143], a[44:47], v[32:35]
 v_exp_f32 v24, v24
 v_mfma_f32_16x16x32_bf16 v[36:39], a[156:159], a[44:47], 0
 v_exp_f32 v25, v25
 v_mfma_f32_16x16x32_bf16 v[36:39], a[152:155], a[40:43], v[36:39]
 v_mul_f32 v26, s32, v26
 v_mul_f32 v27, s32, v27
 v_mfma_f32_16x16x32_bf16 v[36:39], a[148:151], a[36:39], v[36:39]
 s_add_u32 m0, s39, 33792
 v_exp_f32 v26, v26
 v_mfma_f32_16x16x32_bf16 v[36:39], a[144:147], a[32:35], v[36:39]
 buffer_load_dwordx4 v1, s[20:23], s33 offen nt lds
 v_mfma_f32_16x16x32_bf16 v[96:99], a[160:163], v[48:51], v[96:99]
 v_exp_f32 v27, v27
 v_mfma_f32_16x16x32_bf16 v[96:99], a[192:195], v[52:55], v[96:99]
 v_mfma_f32_16x16x32_bf16 v[100:103], a[164:167], v[48:51], v[100:103]
 v_mul_f32 v28, s32, v28
 v_mul_f32 v29, s32, v29
 v_mfma_f32_16x16x32_bf16 v[100:103], a[196:199], v[52:55], v[100:103]
 v_cvt_pk_bf16_f32 v40, v24, v25
 v_cvt_pk_bf16_f32 v41, v26, v27
 v_mfma_f32_16x16x32_bf16 v[104:107], a[168:171], v[48:51], v[104:107]
 v_exp_f32 v28, v28
 v_mfma_f32_16x16x32_bf16 v[104:107], a[200:203], v[52:55], v[104:107]
 v_exp_f32 v29, v29
 v_mfma_f32_16x16x32_bf16 v[108:111], a[172:175], v[48:51], v[108:111]
 v_mul_f32 v30, s32, v30
 v_mul_f32 v31, s32, v31
 v_mfma_f32_16x16x32_bf16 v[108:111], a[204:207], v[52:55], v[108:111]
 v_exp_f32 v30, v30
 v_mfma_f32_16x16x32_bf16 v[24:27], a[96:99], a[48:51], 0
 v_exp_f32 v31, v31
 v_mfma_f32_16x16x32_bf16 v[24:27], a[100:103], a[52:55], v[24:27]
 v_cvt_pk_bf16_f32 v42, v28, v29
 v_cvt_pk_bf16_f32 v43, v30, v31
 v_mfma_f32_16x16x32_bf16 v[24:27], a[104:107], a[56:59], v[24:27]
 v_mul_f32 v32, s32, v32
 v_mul_f32 v33, s32, v33
 v_mfma_f32_16x16x32_bf16 v[24:27], a[108:111], a[60:63], v[24:27]
 v_smfmac_f32_16x16x64_bf16 a[224:227], a[240:243], v[48:55], v2
 v_exp_f32 v32, v32
 v_exp_f32 v33, v33
 v_mfma_f32_16x16x32_bf16 v[28:31], a[124:127], a[60:63], 0
 v_mul_f32 v34, s32, v34
 v_mul_f32 v35, s32, v35
 v_mfma_f32_16x16x32_bf16 v[28:31], a[120:123], a[56:59], v[28:31]
 v_exp_f32 v34, v34
 v_mfma_f32_16x16x32_bf16 v[28:31], a[116:119], a[52:55], v[28:31]
 s_add_u32 m0, s39, 33824
 v_mfma_f32_16x16x32_bf16 v[28:31], a[112:115], a[48:51], v[28:31]
 buffer_load_dwordx4 v1, s[20:23], s33 offen offset:1024 nt lds
 v_mfma_f32_16x16x32_bf16 v[112:115], a[176:179], v[48:51], v[112:115]
 v_exp_f32 v35, v35
 v_mfma_f32_16x16x32_bf16 v[112:115], a[208:211], v[52:55], v[112:115]
 v_mul_f32 v36, s32, v36
 v_mul_f32 v37, s32, v37
 v_cvt_pk_bf16_f32 v44, v32, v33
 v_cvt_pk_bf16_f32 v45, v34, v35
 v_mfma_f32_16x16x32_bf16 v[116:119], a[180:183], v[48:51], v[116:119]
 v_exp_f32 v36, v36
 v_mfma_f32_16x16x32_bf16 v[116:119], a[212:215], v[52:55], v[116:119]
 v_mfma_f32_16x16x32_bf16 v[120:123], a[184:187], v[48:51], v[120:123]
 v_exp_f32 v37, v37
 v_mfma_f32_16x16x32_bf16 v[120:123], a[216:219], v[52:55], v[120:123]
 v_mul_f32 v38, s32, v38
 v_mul_f32 v39, s32, v39
 v_exp_f32 v38, v38
 v_mfma_f32_16x16x32_bf16 v[124:127], a[188:191], v[48:51], v[124:127]
 v_exp_f32 v39, v39
 v_mfma_f32_16x16x32_bf16 v[124:127], a[220:223], v[52:55], v[124:127]
 v_mfma_f32_16x16x32_bf16 v[32:35], a[128:131], a[48:51], 0
 v_cvt_pk_bf16_f32 v46, v36, v37
 v_cvt_pk_bf16_f32 v47, v38, v39
 v_mfma_f32_16x16x32_bf16 v[32:35], a[132:135], a[52:55], v[32:35]
 v_mul_f32 v24, s32, v24
 v_mul_f32 v25, s32, v25
 v_mfma_f32_16x16x32_bf16 v[32:35], a[136:139], a[56:59], v[32:35]
 v_exp_f32 v24, v24
 v_mfma_f32_16x16x32_bf16 v[32:35], a[140:143], a[60:63], v[32:35]
 v_mfma_f32_16x16x32_bf16 v[36:39], a[156:159], a[60:63], 0
 v_exp_f32 v25, v25
 v_mfma_f32_16x16x32_bf16 v[36:39], a[152:155], a[56:59], v[36:39]
 v_mul_f32 v26, s32, v26
 v_mul_f32 v27, s32, v27
 v_mfma_f32_16x16x32_bf16 v[36:39], a[148:151], a[52:55], v[36:39]
 v_exp_f32 v26, v26
 v_mfma_f32_16x16x32_bf16 v[36:39], a[144:147], a[48:51], v[36:39]
 v_mfma_f32_16x16x32_bf16 v[128:131], a[160:163], v[40:43], v[128:131]
 s_add_u32 m0, s39, 33856
 v_exp_f32 v27, v27
 v_mfma_f32_16x16x32_bf16 v[128:131], a[192:195], v[44:47], v[128:131]
 buffer_load_dwordx4 v1, s[20:23], s33 offen offset:2048 nt lds
 v_mul_f32 v28, s32, v28
 v_mul_f32 v29, s32, v29
 v_mfma_f32_16x16x32_bf16 v[132:135], a[164:167], v[40:43], v[132:135]
 v_cvt_pk_bf16_f32 v48, v24, v25
 v_cvt_pk_bf16_f32 v49, v26, v27
 v_mfma_f32_16x16x32_bf16 v[132:135], a[196:199], v[44:47], v[132:135]
 v_mfma_f32_16x16x32_bf16 v[136:139], a[168:171], v[40:43], v[136:139]
 v_exp_f32 v28, v28
 v_mfma_f32_16x16x32_bf16 v[136:139], a[200:203], v[44:47], v[136:139]
 v_exp_f32 v29, v29
 v_mul_f32 v30, s32, v30
 v_mul_f32 v31, s32, v31
 v_mfma_f32_16x16x32_bf16 v[140:143], a[172:175], v[40:43], v[140:143]
 v_exp_f32 v30, v30
 v_mfma_f32_16x16x32_bf16 v[140:143], a[204:207], v[44:47], v[140:143]
 v_mfma_f32_16x16x32_bf16 v[24:27], a[96:99], a[64:67], 0
 v_exp_f32 v31, v31
 v_mfma_f32_16x16x32_bf16 v[24:27], a[100:103], a[68:71], v[24:27]
 v_cvt_pk_bf16_f32 v50, v28, v29
 v_cvt_pk_bf16_f32 v51, v30, v31
 v_mfma_f32_16x16x32_bf16 v[24:27], a[104:107], a[72:75], v[24:27]
 v_mul_f32 v32, s32, v32
 v_mul_f32 v33, s32, v33
 v_mfma_f32_16x16x32_bf16 v[24:27], a[108:111], a[76:79], v[24:27]
 v_smfmac_f32_16x16x64_bf16 a[228:231], a[236:239], v[40:47], v2
 v_exp_f32 v32, v32
 v_mfma_f32_16x16x32_bf16 v[28:31], a[124:127], a[76:79], 0
 v_exp_f32 v33, v33
 v_mfma_f32_16x16x32_bf16 v[28:31], a[120:123], a[72:75], v[28:31]
 v_mul_f32 v34, s32, v34
 v_mul_f32 v35, s32, v35
 v_mfma_f32_16x16x32_bf16 v[28:31], a[116:119], a[68:71], v[28:31]
 v_mfma_f32_16x16x32_bf16 v[28:31], a[112:115], a[64:67], v[28:31]
 v_exp_f32 v34, v34
 v_exp_f32 v35, v35
 v_mfma_f32_16x16x32_bf16 v[144:147], a[176:179], v[40:43], v[144:147]
 s_add_u32 m0, s39, 33888
 v_mul_f32 v36, s32, v36
 v_mul_f32 v37, s32, v37
 v_mfma_f32_16x16x32_bf16 v[144:147], a[208:211], v[44:47], v[144:147]
 buffer_load_dwordx4 v1, s[20:23], s33 offen offset:3072 nt lds
 v_mfma_f32_16x16x32_bf16 v[148:151], a[180:183], v[40:43], v[148:151]
 s_add_u32 s33, s33, 8192
 v_cvt_pk_bf16_f32 v52, v32, v33
 v_cvt_pk_bf16_f32 v53, v34, v35
 v_mfma_f32_16x16x32_bf16 v[148:151], a[212:215], v[44:47], v[148:151]
 v_mfma_f32_16x16x32_bf16 v[152:155], a[184:187], v[40:43], v[152:155]
 v_exp_f32 v36, v36
 v_mfma_f32_16x16x32_bf16 v[152:155], a[216:219], v[44:47], v[152:155]
 v_exp_f32 v37, v37
 v_mul_f32 v38, s32, v38
 v_mul_f32 v39, s32, v39
 v_mfma_f32_16x16x32_bf16 v[156:159], a[188:191], v[40:43], v[156:159]
 v_mfma_f32_16x16x32_bf16 v[156:159], a[220:223], v[44:47], v[156:159]
 v_exp_f32 v38, v38
 v_exp_f32 v39, v39
 v_mfma_f32_16x16x32_bf16 v[32:35], a[128:131], a[64:67], 0
 v_cvt_pk_bf16_f32 v54, v36, v37
 v_cvt_pk_bf16_f32 v55, v38, v39
 v_mfma_f32_16x16x32_bf16 v[32:35], a[132:135], a[68:71], v[32:35]
 v_mul_f32 v24, s32, v24
 v_mul_f32 v25, s32, v25
 v_mfma_f32_16x16x32_bf16 v[32:35], a[136:139], a[72:75], v[32:35]
 v_mfma_f32_16x16x32_bf16 v[32:35], a[140:143], a[76:79], v[32:35]
 v_exp_f32 v24, v24
 v_exp_f32 v25, v25
 v_mfma_f32_16x16x32_bf16 v[36:39], a[156:159], a[76:79], 0
 v_mul_f32 v26, s32, v26
 v_mul_f32 v27, s32, v27
 v_mfma_f32_16x16x32_bf16 v[36:39], a[152:155], a[72:75], v[36:39]
 v_exp_f32 v26, v26
 v_mfma_f32_16x16x32_bf16 v[36:39], a[148:151], a[68:71], v[36:39]
 v_mfma_f32_16x16x32_bf16 v[36:39], a[144:147], a[64:67], v[36:39]
 v_exp_f32 v27, v27
 v_mul_f32 v28, s32, v28
 v_mfma_f32_16x16x32_bf16 v[160:163], a[160:163], v[48:51], v[160:163]
 v_mul_f32 v29, s32, v29
 v_cvt_pk_bf16_f32 v40, v24, v25
 v_mfma_f32_16x16x32_bf16 v[160:163], a[192:195], v[52:55], v[160:163]
 v_cvt_pk_bf16_f32 v41, v26, v27
 v_exp_f32 v28, v28
 v_mfma_f32_16x16x32_bf16 v[164:167], a[164:167], v[48:51], v[164:167]
 s_add_u32 m0, s39, 50688
 v_mfma_f32_16x16x32_bf16 v[164:167], a[196:199], v[52:55], v[164:167]
 buffer_load_dwordx4 v1, s[20:23], s33 offen nt lds
 v_mfma_f32_16x16x32_bf16 v[168:171], a[168:171], v[48:51], v[168:171]
 v_exp_f32 v29, v29
 v_mfma_f32_16x16x32_bf16 v[168:171], a[200:203], v[52:55], v[168:171]
 v_mul_f32 v30, s32, v30
 v_mul_f32 v31, s32, v31
 v_exp_f32 v30, v30
 v_mfma_f32_16x16x32_bf16 v[172:175], a[172:175], v[48:51], v[172:175]
 v_exp_f32 v31, v31
 v_mfma_f32_16x16x32_bf16 v[172:175], a[204:207], v[52:55], v[172:175]
 v_mfma_f32_16x16x32_bf16 v[24:27], a[96:99], a[80:83], 0
 v_cvt_pk_bf16_f32 v42, v28, v29
 v_cvt_pk_bf16_f32 v43, v30, v31
 v_mfma_f32_16x16x32_bf16 v[24:27], a[100:103], a[84:87], v[24:27]
 v_mul_f32 v32, s32, v32
 v_mul_f32 v33, s32, v33
 v_mfma_f32_16x16x32_bf16 v[24:27], a[104:107], a[88:91], v[24:27]
 v_exp_f32 v32, v32
 v_mfma_f32_16x16x32_bf16 v[24:27], a[108:111], a[92:95], v[24:27]
 v_smfmac_f32_16x16x64_bf16 a[228:231], a[240:243], v[48:55], v2
 v_exp_f32 v33, v33
 v_mul_f32 v34, s32, v34
 v_mul_f32 v35, s32, v35
 v_mfma_f32_16x16x32_bf16 v[28:31], a[124:127], a[92:95], 0
 v_exp_f32 v34, v34
 v_mfma_f32_16x16x32_bf16 v[28:31], a[120:123], a[88:91], v[28:31]
 v_mfma_f32_16x16x32_bf16 v[28:31], a[116:119], a[84:87], v[28:31]
 v_exp_f32 v35, v35
 v_mfma_f32_16x16x32_bf16 v[28:31], a[112:115], a[80:83], v[28:31]
 s_waitcnt vmcnt(7)
 s_barrier
 v_mfma_f32_16x16x32_bf16 v[176:179], a[176:179], v[48:51], v[176:179]
 v_mul_f32 v36, s32, v36
 v_mul_f32 v37, s32, v37
 v_mfma_f32_16x16x32_bf16 v[176:179], a[208:211], v[52:55], v[176:179]
 v_cvt_pk_bf16_f32 v44, v32, v33
 v_cvt_pk_bf16_f32 v45, v34, v35
 v_exp_f32 v36, v36
 v_mfma_f32_16x16x32_bf16 v[180:183], a[180:183], v[48:51], v[180:183]
 s_add_u32 m0, s39, 50720
 ds_read_b128 a[96:99], v7 offset:0
 ds_read_b128 a[100:103], v7 offset:64
 v_mfma_f32_16x16x32_bf16 v[180:183], a[212:215], v[52:55], v[180:183]
 buffer_load_dwordx4 v1, s[20:23], s33 offen offset:1024 nt lds
 v_exp_f32 v37, v37
 v_mfma_f32_16x16x32_bf16 v[184:187], a[184:187], v[48:51], v[184:187]
 v_mfma_f32_16x16x32_bf16 v[184:187], a[216:219], v[52:55], v[184:187]
 v_mul_f32 v38, s32, v38
 v_mul_f32 v39, s32, v39
 v_exp_f32 v38, v38
 v_mfma_f32_16x16x32_bf16 v[188:191], a[188:191], v[48:51], v[188:191]
 ds_read_b128 a[104:107], v7 offset:128
 ds_read_b128 a[108:111], v7 offset:192
 v_mfma_f32_16x16x32_bf16 v[188:191], a[220:223], v[52:55], v[188:191]
 v_exp_f32 v39, v39
 v_cvt_pk_bf16_f32 v46, v36, v37
 v_cvt_pk_bf16_f32 v47, v38, v39
 v_mfma_f32_16x16x32_bf16 v[32:35], a[128:131], a[80:83], 0
 v_mul_f32 v24, s32, v24
 v_mul_f32 v25, s32, v25
 v_mfma_f32_16x16x32_bf16 v[32:35], a[132:135], a[84:87], v[32:35]
 v_mfma_f32_16x16x32_bf16 v[32:35], a[136:139], a[88:91], v[32:35]
 ds_read_b128 a[124:127], v7 offset:704
 ds_read_b128 a[120:123], v7 offset:640
 v_mfma_f32_16x16x32_bf16 v[32:35], a[140:143], a[92:95], v[32:35]
 v_exp_f32 v24, v24
 v_exp_f32 v25, v25
 v_mfma_f32_16x16x32_bf16 v[36:39], a[156:159], a[92:95], 0
 v_mul_f32 v26, s32, v26
 v_mul_f32 v27, s32, v27
 v_mfma_f32_16x16x32_bf16 v[36:39], a[152:155], a[88:91], v[36:39]
 v_exp_f32 v26, v26
 v_mfma_f32_16x16x32_bf16 v[36:39], a[148:151], a[84:87], v[36:39]
 ds_read_b128 a[116:119], v7 offset:576
 ds_read_b128 a[112:115], v7 offset:512
 v_mfma_f32_16x16x32_bf16 v[36:39], a[144:147], a[80:83], v[36:39]
 v_mfma_f32_16x16x32_bf16 v[192:195], a[160:163], v[40:43], v[192:195]
 v_exp_f32 v27, v27
 v_mfma_f32_16x16x32_bf16 v[192:195], a[192:195], v[44:47], v[192:195]
 v_mul_f32 v28, s32, v28
 v_mul_f32 v29, s32, v29
 v_cvt_pk_bf16_f32 v48, v24, v25
 v_cvt_pk_bf16_f32 v49, v26, v27
 v_mfma_f32_16x16x32_bf16 v[196:199], a[164:167], v[40:43], v[196:199]
 v_exp_f32 v28, v28
 v_mfma_f32_16x16x32_bf16 v[196:199], a[196:199], v[44:47], v[196:199]
 ds_read_b128 a[128:131], v7 offset:16896
 ds_read_b128 a[132:135], v7 offset:16960
 v_exp_f32 v29, v29
 v_mfma_f32_16x16x32_bf16 v[200:203], a[168:171], v[40:43], v[200:203]
 s_add_u32 m0, s39, 50752
 v_mfma_f32_16x16x32_bf16 v[200:203], a[200:203], v[44:47], v[200:203]
 buffer_load_dwordx4 v1, s[20:23], s33 offen offset:2048 nt lds
 v_mfma_f32_16x16x32_bf16 v[204:207], a[172:175], v[40:43], v[204:207]
 v_mul_f32 v30, s32, v30
 v_mul_f32 v31, s32, v31
 v_mfma_f32_16x16x32_bf16 v[204:207], a[204:207], v[44:47], v[204:207]
 s_waitcnt lgkmcnt(6)
 ds_read_b128 a[136:139], v7 offset:17024
 ds_read_b128 a[140:143], v7 offset:17088
 v_exp_f32 v30, v30
 v_mfma_f32_16x16x32_bf16 v[24:27], a[96:99], a[0:3], 0
 v_exp_f32 v31, v31
 v_mfma_f32_16x16x32_bf16 v[24:27], a[100:103], a[4:7], v[24:27]
 v_cvt_pk_bf16_f32 v50, v28, v29
 v_cvt_pk_bf16_f32 v51, v30, v31
 v_mfma_f32_16x16x32_bf16 v[24:27], a[104:107], a[8:11], v[24:27]
 v_mul_f32 v32, s32, v32
 v_mul_f32 v33, s32, v33
 v_mfma_f32_16x16x32_bf16 v[24:27], a[108:111], a[12:15], v[24:27]
 s_waitcnt lgkmcnt(4)
 ds_read_b128 a[156:159], v7 offset:17600
 ds_read_b128 a[152:155], v7 offset:17536
 v_exp_f32 v32, v32
 v_smfmac_f32_16x16x64_bf16 a[232:235], a[236:239], v[40:47], v2
 v_exp_f32 v33, v33
 v_mfma_f32_16x16x32_bf16 v[28:31], a[124:127], a[12:15], 0
 v_mul_f32 v34, s32, v34
 v_mul_f32 v35, s32, v35
 v_mfma_f32_16x16x32_bf16 v[28:31], a[120:123], a[8:11], v[28:31]
 v_exp_f32 v34, v34
 v_mfma_f32_16x16x32_bf16 v[28:31], a[116:119], a[4:7], v[28:31]
 ds_read_b128 a[148:151], v7 offset:17472
 ds_read_b128 a[144:147], v7 offset:17408
 v_mfma_f32_16x16x32_bf16 v[28:31], a[112:115], a[0:3], v[28:31]
 v_exp_f32 v35, v35
 v_mul_f32 v36, s32, v36
 v_mul_f32 v37, s32, v37
 v_mfma_f32_16x16x32_bf16 v[208:211], a[176:179], v[40:43], v[208:211]
 v_cvt_pk_bf16_f32 v52, v32, v33
 v_cvt_pk_bf16_f32 v53, v34, v35
 v_mfma_f32_16x16x32_bf16 v[208:211], a[208:211], v[44:47], v[208:211]
 v_mfma_f32_16x16x32_bf16 v[212:215], a[180:183], v[40:43], v[212:215]
 s_add_u32 m0, s39, 50784
 v_exp_f32 v36, v36
 v_mfma_f32_16x16x32_bf16 v[212:215], a[212:215], v[44:47], v[212:215]
 buffer_load_dwordx4 v1, s[20:23], s33 offen offset:3072 nt lds
 v_mfma_f32_16x16x32_bf16 v[216:219], a[184:187], v[40:43], v[216:219]
 s_add_u32 s33, s33, 8192
 v_exp_f32 v37, v37
 v_mfma_f32_16x16x32_bf16 v[216:219], a[216:219], v[44:47], v[216:219]
 v_mul_f32 v38, s32, v38
 v_mul_f32 v39, s32, v39
 v_mfma_f32_16x16x32_bf16 v[220:223], a[188:191], v[40:43], v[220:223]
 v_exp_f32 v38, v38
 v_mfma_f32_16x16x32_bf16 v[220:223], a[220:223], v[44:47], v[220:223]
 s_waitcnt lgkmcnt(4)
 ds_read_b128 v[56:59], v6 offset:8704
 v_exp_f32 v39, v39
 v_mfma_f32_16x16x32_bf16 v[32:35], a[128:131], a[0:3], 0
 v_cvt_pk_bf16_f32 v54, v36, v37
 v_cvt_pk_bf16_f32 v55, v38, v39
 v_mfma_f32_16x16x32_bf16 v[32:35], a[132:135], a[4:7], v[32:35]
 v_mul_f32 v24, s32, v24
 v_mul_f32 v25, s32, v25
 v_mfma_f32_16x16x32_bf16 v[32:35], a[136:139], a[8:11], v[32:35]
 v_exp_f32 v24, v24
 v_mfma_f32_16x16x32_bf16 v[32:35], a[140:143], a[12:15], v[32:35]
 s_waitcnt lgkmcnt(1)
 v_exp_f32 v25, v25
 v_mfma_f32_16x16x32_bf16 v[36:39], a[156:159], a[12:15], 0
 v_mul_f32 v26, s32, v26
 v_mul_f32 v27, s32, v27
 v_mfma_f32_16x16x32_bf16 v[36:39], a[152:155], a[8:11], v[36:39]
 v_exp_f32 v26, v26
 v_mfma_f32_16x16x32_bf16 v[36:39], a[148:151], a[4:7], v[36:39]
 v_mfma_f32_16x16x32_bf16 v[36:39], a[144:147], a[0:3], v[36:39]
 v_exp_f32 v27, v27
 v_mul_f32 v28, s32, v28
 v_mfma_f32_16x16x32_bf16 v[224:227], a[160:163], v[48:51], v[224:227]
 s_mov_b32 s38, 8192
 v_mul_f32 v29, s32, v29
 v_cvt_pk_bf16_f32 v40, v24, v25
 v_mfma_f32_16x16x32_bf16 v[224:227], a[192:195], v[52:55], v[224:227]
 s_waitcnt lgkmcnt(0)
 buffer_store_dwordx4 v[56:59], v1, s[24:27], s38 offen sc1 nt
 v_mfma_f32_16x16x32_bf16 v[228:231], a[164:167], v[48:51], v[228:231]
 ds_read_b64_tr_b16 a[160:161], v8 offset:0
 ds_read_b64_tr_b16 a[162:163], v8 offset:512
 v_mfma_f32_16x16x32_bf16 v[228:231], a[196:199], v[52:55], v[228:231]
 v_cvt_pk_bf16_f32 v41, v26, v27
 v_exp_f32 v28, v28
 v_mfma_f32_16x16x32_bf16 v[232:235], a[168:171], v[48:51], v[232:235]
 ds_read_b64_tr_b16 a[192:193], v8 offset:16896
 ds_read_b64_tr_b16 a[194:195], v8 offset:17408
 v_mfma_f32_16x16x32_bf16 v[232:235], a[200:203], v[52:55], v[232:235]
 v_exp_f32 v29, v29
 v_mul_f32 v30, s32, v30
 v_mul_f32 v31, s32, v31
 v_mfma_f32_16x16x32_bf16 v[236:239], a[172:175], v[48:51], v[236:239]
 v_exp_f32 v30, v30
 v_mfma_f32_16x16x32_bf16 v[236:239], a[204:207], v[52:55], v[236:239]
 ds_read_b64_tr_b16 a[164:165], v8 offset:32
 ds_read_b64_tr_b16 a[166:167], v8 offset:544
 v_exp_f32 v31, v31
 v_mfma_f32_16x16x32_bf16 v[24:27], a[96:99], a[16:19], 0
 v_cvt_pk_bf16_f32 v42, v28, v29
 v_cvt_pk_bf16_f32 v43, v30, v31
 v_mfma_f32_16x16x32_bf16 v[24:27], a[100:103], a[20:23], v[24:27]
 ds_read_b64_tr_b16 a[196:197], v8 offset:16928
 ds_read_b64_tr_b16 a[198:199], v8 offset:17440
 v_mfma_f32_16x16x32_bf16 v[24:27], a[104:107], a[24:27], v[24:27]
 v_mul_f32 v32, s32, v32
 v_mul_f32 v33, s32, v33
 v_mfma_f32_16x16x32_bf16 v[24:27], a[108:111], a[28:31], v[24:27]
 ds_read_b64_tr_b16 a[168:169], v8 offset:64
 ds_read_b64_tr_b16 a[170:171], v8 offset:576
 v_exp_f32 v32, v32
 v_smfmac_f32_16x16x64_bf16 a[232:235], a[240:243], v[48:55], v2
 v_exp_f32 v33, v33
 v_mfma_f32_16x16x32_bf16 v[28:31], a[124:127], a[28:31], 0
 ds_read_b64_tr_b16 a[200:201], v8 offset:16960
 ds_read_b64_tr_b16 a[202:203], v8 offset:17472
 v_mfma_f32_16x16x32_bf16 v[28:31], a[120:123], a[24:27], v[28:31]
 v_mul_f32 v34, s32, v34
 v_mul_f32 v35, s32, v35
 v_mfma_f32_16x16x32_bf16 v[28:31], a[116:119], a[20:23], v[28:31]
 v_exp_f32 v34, v34
 v_mfma_f32_16x16x32_bf16 v[28:31], a[112:115], a[16:19], v[28:31]
 ds_read_b64_tr_b16 a[172:173], v8 offset:96
 ds_read_b64_tr_b16 a[174:175], v8 offset:608
 v_exp_f32 v35, v35
 v_mfma_f32_16x16x32_bf16 v[240:243], a[176:179], v[48:51], v[240:243]
 v_mul_f32 v36, s32, v36
 v_mul_f32 v37, s32, v37
 v_mfma_f32_16x16x32_bf16 v[240:243], a[208:211], v[52:55], v[240:243]
 ds_read_b64_tr_b16 a[204:205], v8 offset:16992
 ds_read_b64_tr_b16 a[206:207], v8 offset:17504
 v_cvt_pk_bf16_f32 v44, v32, v33
 v_mfma_f32_16x16x32_bf16 v[244:247], a[180:183], v[48:51], v[244:247]
 v_mfma_f32_16x16x32_bf16 v[244:247], a[212:215], v[52:55], v[244:247]
 v_cvt_pk_bf16_f32 v45, v34, v35
 v_exp_f32 v36, v36
 v_mfma_f32_16x16x32_bf16 v[248:251], a[184:187], v[48:51], v[248:251]
 v_exp_f32 v37, v37
 v_mfma_f32_16x16x32_bf16 v[248:251], a[216:219], v[52:55], v[248:251]
 ds_read_b64_tr_b16 a[176:177], v8 offset:128
 ds_read_b64_tr_b16 a[178:179], v8 offset:640
 v_mul_f32 v38, s32, v38
 v_mul_f32 v39, s32, v39
 v_mfma_f32_16x16x32_bf16 v[252:255], a[188:191], v[48:51], v[252:255]
 v_exp_f32 v38, v38
 v_mfma_f32_16x16x32_bf16 v[252:255], a[220:223], v[52:55], v[252:255]
 v_exp_f32 v39, v39
 v_cvt_pk_bf16_f32 v46, v36, v37
 v_cvt_pk_bf16_f32 v47, v38, v39
 v_mfma_f32_16x16x32_bf16 v[32:35], a[128:131], a[16:19], 0
 ds_read_b64_tr_b16 a[208:209], v8 offset:17024
 ds_read_b64_tr_b16 a[210:211], v8 offset:17536
 v_mfma_f32_16x16x32_bf16 v[32:35], a[132:135], a[20:23], v[32:35]
 v_mul_f32 v24, s32, v24
 v_mul_f32 v25, s32, v25
 v_mfma_f32_16x16x32_bf16 v[32:35], a[136:139], a[24:27], v[32:35]
 v_exp_f32 v24, v24
 v_mfma_f32_16x16x32_bf16 v[32:35], a[140:143], a[28:31], v[32:35]
 ds_read_b64_tr_b16 a[180:181], v8 offset:160
 ds_read_b64_tr_b16 a[182:183], v8 offset:672
 v_exp_f32 v25, v25
 v_mfma_f32_16x16x32_bf16 v[36:39], a[156:159], a[28:31], 0
 v_mul_f32 v26, s32, v26
 v_mul_f32 v27, s32, v27
 v_mfma_f32_16x16x32_bf16 v[36:39], a[152:155], a[24:27], v[36:39]
 v_exp_f32 v26, v26
 v_mfma_f32_16x16x32_bf16 v[36:39], a[148:151], a[20:23], v[36:39]
 ds_read_b64_tr_b16 a[212:213], v8 offset:17056
 ds_read_b64_tr_b16 a[214:215], v8 offset:17568
 v_mfma_f32_16x16x32_bf16 v[36:39], a[144:147], a[16:19], v[36:39]
 s_waitcnt lgkmcnt(15)
 v_exp_f32 v27, v27
 v_mul_f32 v28, s32, v28
 v_mfma_f32_16x16x32_bf16 v[64:67], a[160:163], v[40:43], v[64:67]
 v_mul_f32 v29, s32, v29
 v_cvt_pk_bf16_f32 v48, v24, v25
 v_mfma_f32_16x16x32_bf16 v[64:67], a[192:195], v[44:47], v[64:67]
 ds_read_b64_tr_b16 a[184:185], v8 offset:192
 ds_read_b64_tr_b16 a[186:187], v8 offset:704
 v_cvt_pk_bf16_f32 v49, v26, v27
 v_mfma_f32_16x16x32_bf16 v[68:71], a[164:167], v[40:43], v[68:71]
 v_exp_f32 v28, v28
 v_mfma_f32_16x16x32_bf16 v[68:71], a[196:199], v[44:47], v[68:71]
 s_waitcnt lgkmcnt(10)
 v_exp_f32 v29, v29
 v_mul_f32 v30, s32, v30
 v_mul_f32 v31, s32, v31
 v_mfma_f32_16x16x32_bf16 v[72:75], a[168:171], v[40:43], v[72:75]
 ds_read_b64_tr_b16 a[216:217], v8 offset:17088
 ds_read_b64_tr_b16 a[218:219], v8 offset:17600
 v_mfma_f32_16x16x32_bf16 v[72:75], a[200:203], v[44:47], v[72:75]
 v_mfma_f32_16x16x32_bf16 v[76:79], a[172:175], v[40:43], v[76:79]
 v_exp_f32 v30, v30
 v_mfma_f32_16x16x32_bf16 v[76:79], a[204:207], v[44:47], v[76:79]
 ds_read_b64_tr_b16 a[188:189], v8 offset:224
 ds_read_b64_tr_b16 a[190:191], v8 offset:736
 v_exp_f32 v31, v31
 v_mfma_f32_16x16x32_bf16 v[24:27], a[96:99], a[32:35], 0
 ds_read_b128 v[60:63], v6 offset:9792
 v_cvt_pk_bf16_f32 v50, v28, v29
 v_mfma_f32_16x16x32_bf16 v[24:27], a[100:103], a[36:39], v[24:27]
 v_cvt_pk_bf16_f32 v51, v30, v31
 v_mul_f32 v32, s32, v32
 v_mfma_f32_16x16x32_bf16 v[24:27], a[104:107], a[40:43], v[24:27]
 ds_read_b64_tr_b16 a[220:221], v8 offset:17120
 ds_read_b64_tr_b16 a[222:223], v8 offset:17632
 v_mfma_f32_16x16x32_bf16 v[24:27], a[108:111], a[44:47], v[24:27]
 v_mul_f32 v33, s32, v33
 v_exp_f32 v32, v32
 v_smfmac_f32_16x16x64_bf16 a[224:227], a[236:239], v[40:47], v2
 v_exp_f32 v33, v33
 v_mfma_f32_16x16x32_bf16 v[28:31], a[124:127], a[44:47], 0
 v_mul_f32 v34, s32, v34
 v_mul_f32 v35, s32, v35
 v_mfma_f32_16x16x32_bf16 v[28:31], a[120:123], a[40:43], v[28:31]
 v_exp_f32 v34, v34
 v_mfma_f32_16x16x32_bf16 v[28:31], a[116:119], a[36:39], v[28:31]
 v_exp_f32 v35, v35
 v_mfma_f32_16x16x32_bf16 v[28:31], a[112:115], a[32:35], v[28:31]
 s_waitcnt lgkmcnt(9)
 v_mul_f32 v36, s32, v36
 v_mul_f32 v37, s32, v37
 v_mfma_f32_16x16x32_bf16 v[80:83], a[176:179], v[40:43], v[80:83]
 s_mov_b32 s38, 9216
 v_cvt_pk_bf16_f32 v52, v32, v33
 v_cvt_pk_bf16_f32 v53, v34, v35
 v_mfma_f32_16x16x32_bf16 v[80:83], a[208:211], v[44:47], v[80:83]
 s_waitcnt lgkmcnt(2)
 buffer_store_dwordx4 v[60:63], v1, s[24:27], s38 offen sc1 nt
 v_mfma_f32_16x16x32_bf16 v[84:87], a[180:183], v[40:43], v[84:87]
 v_exp_f32 v36, v36
 v_mfma_f32_16x16x32_bf16 v[84:87], a[212:215], v[44:47], v[84:87]
 s_waitcnt lgkmcnt(0)
 s_barrier
 v_mfma_f32_16x16x32_bf16 v[88:91], a[184:187], v[40:43], v[88:91]
 v_mfma_f32_16x16x32_bf16 v[88:91], a[216:219], v[44:47], v[88:91]
 v_exp_f32 v37, v37
 v_mfma_f32_16x16x32_bf16 v[92:95], a[188:191], v[40:43], v[92:95]
 v_mul_f32 v38, s32, v38
 v_mul_f32 v39, s32, v39
 v_mfma_f32_16x16x32_bf16 v[92:95], a[220:223], v[44:47], v[92:95]
 v_exp_f32 v38, v38
 v_mfma_f32_16x16x32_bf16 v[32:35], a[128:131], a[32:35], 0
 v_exp_f32 v39, v39
 v_mfma_f32_16x16x32_bf16 v[32:35], a[132:135], a[36:39], v[32:35]
 v_cvt_pk_bf16_f32 v54, v36, v37
 v_cvt_pk_bf16_f32 v55, v38, v39
 v_mfma_f32_16x16x32_bf16 v[32:35], a[136:139], a[40:43], v[32:35]
 v_mul_f32 v24, s32, v24
 v_mul_f32 v25, s32, v25
 v_mfma_f32_16x16x32_bf16 v[32:35], a[140:143], a[44:47], v[32:35]
 v_exp_f32 v24, v24
 v_mfma_f32_16x16x32_bf16 v[36:39], a[156:159], a[44:47], 0
 v_exp_f32 v25, v25
 v_mfma_f32_16x16x32_bf16 v[36:39], a[152:155], a[40:43], v[36:39]
 v_mul_f32 v26, s32, v26
 v_mul_f32 v27, s32, v27
 v_mfma_f32_16x16x32_bf16 v[36:39], a[148:151], a[36:39], v[36:39]
 s_add_u32 m0, s39, 0
 v_exp_f32 v26, v26
 v_mfma_f32_16x16x32_bf16 v[36:39], a[144:147], a[32:35], v[36:39]
 buffer_load_dwordx4 v1, s[20:23], s33 offen nt lds
 v_mfma_f32_16x16x32_bf16 v[96:99], a[160:163], v[48:51], v[96:99]
 v_exp_f32 v27, v27
 v_mfma_f32_16x16x32_bf16 v[96:99], a[192:195], v[52:55], v[96:99]
L_pg0_10:
 s_cbranch_execz L_main0
 v_mfma_f32_16x16x32_bf16 v[100:103], a[164:167], v[48:51], v[100:103]
 v_mul_f32 v28, s32, v28
 v_mul_f32 v29, s32, v29
 v_mfma_f32_16x16x32_bf16 v[100:103], a[196:199], v[52:55], v[100:103]
 v_cvt_pk_bf16_f32 v40, v24, v25
 v_cvt_pk_bf16_f32 v41, v26, v27
 v_mfma_f32_16x16x32_bf16 v[104:107], a[168:171], v[48:51], v[104:107]
 v_exp_f32 v28, v28
 v_mfma_f32_16x16x32_bf16 v[104:107], a[200:203], v[52:55], v[104:107]
 v_exp_f32 v29, v29
 v_mfma_f32_16x16x32_bf16 v[108:111], a[172:175], v[48:51], v[108:111]
 v_mul_f32 v30, s32, v30
 v_mul_f32 v31, s32, v31
 v_mfma_f32_16x16x32_bf16 v[108:111], a[204:207], v[52:55], v[108:111]
 v_exp_f32 v30, v30
 v_mfma_f32_16x16x32_bf16 v[24:27], a[96:99], a[48:51], 0
 v_exp_f32 v31, v31
 v_mfma_f32_16x16x32_bf16 v[24:27], a[100:103], a[52:55], v[24:27]
 v_cvt_pk_bf16_f32 v42, v28, v29
 v_cvt_pk_bf16_f32 v43, v30, v31
 v_mfma_f32_16x16x32_bf16 v[24:27], a[104:107], a[56:59], v[24:27]
 v_mul_f32 v32, s32, v32
 v_mul_f32 v33, s32, v33
 v_mfma_f32_16x16x32_bf16 v[24:27], a[108:111], a[60:63], v[24:27]
 v_smfmac_f32_16x16x64_bf16 a[224:227], a[240:243], v[48:55], v2
 v_exp_f32 v32, v32
 v_exp_f32 v33, v33
 v_mfma_f32_16x16x32_bf16 v[28:31], a[124:127], a[60:63], 0
 v_mul_f32 v34, s32, v34
 v_mul_f32 v35, s32, v35
 v_mfma_f32_16x16x32_bf16 v[28:31], a[120:123], a[56:59], v[28:31]
 v_exp_f32 v34, v34
 v_mfma_f32_16x16x32_bf16 v[28:31], a[116:119], a[52:55], v[28:31]
 s_add_u32 m0, s39, 32
 v_mfma_f32_16x16x32_bf16 v[28:31], a[112:115], a[48:51], v[28:31]
 buffer_load_dwordx4 v1, s[20:23], s33 offen offset:1024 nt lds
 v_mfma_f32_16x16x32_bf16 v[112:115], a[176:179], v[48:51], v[112:115]
 v_exp_f32 v35, v35
 v_mfma_f32_16x16x32_bf16 v[112:115], a[208:211], v[52:55], v[112:115]
 v_mul_f32 v36, s32, v36
 v_mul_f32 v37, s32, v37
 v_cvt_pk_bf16_f32 v44, v32, v33
 v_cvt_pk_bf16_f32 v45, v34, v35
 v_mfma_f32_16x16x32_bf16 v[116:119], a[180:183], v[48:51], v[116:119]
 v_exp_f32 v36, v36
 v_mfma_f32_16x16x32_bf16 v[116:119], a[212:215], v[52:55], v[116:119]
 v_mfma_f32_16x16x32_bf16 v[120:123], a[184:187], v[48:51], v[120:123]
 v_exp_f32 v37, v37
 v_mfma_f32_16x16x32_bf16 v[120:123], a[216:219], v[52:55], v[120:123]
 v_mul_f32 v38, s32, v38
 v_mul_f32 v39, s32, v39
 v_exp_f32 v38, v38
 v_mfma_f32_16x16x32_bf16 v[124:127], a[188:191], v[48:51], v[124:127]
 v_exp_f32 v39, v39
 v_mfma_f32_16x16x32_bf16 v[124:127], a[220:223], v[52:55], v[124:127]
 v_mfma_f32_16x16x32_bf16 v[32:35], a[128:131], a[48:51], 0
 v_cvt_pk_bf16_f32 v46, v36, v37
 v_cvt_pk_bf16_f32 v47, v38, v39
 v_mfma_f32_16x16x32_bf16 v[32:35], a[132:135], a[52:55], v[32:35]
 v_mul_f32 v24, s32, v24
 v_mul_f32 v25, s32, v25
 v_mfma_f32_16x16x32_bf16 v[32:35], a[136:139], a[56:59], v[32:35]
 v_exp_f32 v24, v24
 v_mfma_f32_16x16x32_bf16 v[32:35], a[140:143], a[60:63], v[32:35]
 v_mfma_f32_16x16x32_bf16 v[36:39], a[156:159], a[60:63], 0
 v_exp_f32 v25, v25
 v_mfma_f32_16x16x32_bf16 v[36:39], a[152:155], a[56:59], v[36:39]
 v_mul_f32 v26, s32, v26
 v_mul_f32 v27, s32, v27
 v_mfma_f32_16x16x32_bf16 v[36:39], a[148:151], a[52:55], v[36:39]
 v_exp_f32 v26, v26
 v_mfma_f32_16x16x32_bf16 v[36:39], a[144:147], a[48:51], v[36:39]
 v_mfma_f32_16x16x32_bf16 v[128:131], a[160:163], v[40:43], v[128:131]
 s_add_u32 m0, s39, 64
 v_exp_f32 v27, v27
 v_mfma_f32_16x16x32_bf16 v[128:131], a[192:195], v[44:47], v[128:131]
 buffer_load_dwordx4 v1, s[20:23], s33 offen offset:2048 nt lds
 v_mul_f32 v28, s32, v28
 v_mul_f32 v29, s32, v29
 v_mfma_f32_16x16x32_bf16 v[132:135], a[164:167], v[40:43], v[132:135]
 v_cvt_pk_bf16_f32 v48, v24, v25
 v_cvt_pk_bf16_f32 v49, v26, v27
 v_mfma_f32_16x16x32_bf16 v[132:135], a[196:199], v[44:47], v[132:135]
 v_mfma_f32_16x16x32_bf16 v[136:139], a[168:171], v[40:43], v[136:139]
 v_exp_f32 v28, v28
 v_mfma_f32_16x16x32_bf16 v[136:139], a[200:203], v[44:47], v[136:139]
 v_exp_f32 v29, v29
 v_mul_f32 v30, s32, v30
 v_mul_f32 v31, s32, v31
 v_mfma_f32_16x16x32_bf16 v[140:143], a[172:175], v[40:43], v[140:143]
 v_exp_f32 v30, v30
 v_mfma_f32_16x16x32_bf16 v[140:143], a[204:207], v[44:47], v[140:143]
 v_mfma_f32_16x16x32_bf16 v[24:27], a[96:99], a[64:67], 0
 v_exp_f32 v31, v31
 v_mfma_f32_16x16x32_bf16 v[24:27], a[100:103], a[68:71], v[24:27]
 v_cvt_pk_bf16_f32 v50, v28, v29
 v_cvt_pk_bf16_f32 v51, v30, v31
 v_mfma_f32_16x16x32_bf16 v[24:27], a[104:107], a[72:75], v[24:27]
 v_mul_f32 v32, s32, v32
 v_mul_f32 v33, s32, v33
 v_mfma_f32_16x16x32_bf16 v[24:27], a[108:111], a[76:79], v[24:27]
 v_smfmac_f32_16x16x64_bf16 a[228:231], a[236:239], v[40:47], v2
 v_exp_f32 v32, v32
 v_mfma_f32_16x16x32_bf16 v[28:31], a[124:127], a[76:79], 0
 v_exp_f32 v33, v33
 v_mfma_f32_16x16x32_bf16 v[28:31], a[120:123], a[72:75], v[28:31]
 v_mul_f32 v34, s32, v34
 v_mul_f32 v35, s32, v35
 v_mfma_f32_16x16x32_bf16 v[28:31], a[116:119], a[68:71], v[28:31]
 v_mfma_f32_16x16x32_bf16 v[28:31], a[112:115], a[64:67], v[28:31]
 v_exp_f32 v34, v34
 v_exp_f32 v35, v35
 v_mfma_f32_16x16x32_bf16 v[144:147], a[176:179], v[40:43], v[144:147]
 s_add_u32 m0, s39, 96
 v_mul_f32 v36, s32, v36
 v_mul_f32 v37, s32, v37
 v_mfma_f32_16x16x32_bf16 v[144:147], a[208:211], v[44:47], v[144:147]
 buffer_load_dwordx4 v1, s[20:23], s33 offen offset:3072 nt lds
 v_mfma_f32_16x16x32_bf16 v[148:151], a[180:183], v[40:43], v[148:151]
 s_add_u32 s33, s33, 8192
 v_cvt_pk_bf16_f32 v52, v32, v33
 v_cvt_pk_bf16_f32 v53, v34, v35
 v_mfma_f32_16x16x32_bf16 v[148:151], a[212:215], v[44:47], v[148:151]
 v_mfma_f32_16x16x32_bf16 v[152:155], a[184:187], v[40:43], v[152:155]
 v_exp_f32 v36, v36
 v_mfma_f32_16x16x32_bf16 v[152:155], a[216:219], v[44:47], v[152:155]
 v_exp_f32 v37, v37
 v_mul_f32 v38, s32, v38
 v_mul_f32 v39, s32, v39
 v_mfma_f32_16x16x32_bf16 v[156:159], a[188:191], v[40:43], v[156:159]
 v_mfma_f32_16x16x32_bf16 v[156:159], a[220:223], v[44:47], v[156:159]
 v_exp_f32 v38, v38
 v_exp_f32 v39, v39
 v_mfma_f32_16x16x32_bf16 v[32:35], a[128:131], a[64:67], 0
 v_cvt_pk_bf16_f32 v54, v36, v37
 v_cvt_pk_bf16_f32 v55, v38, v39
 v_mfma_f32_16x16x32_bf16 v[32:35], a[132:135], a[68:71], v[32:35]
 v_mul_f32 v24, s32, v24
 v_mul_f32 v25, s32, v25
 v_mfma_f32_16x16x32_bf16 v[32:35], a[136:139], a[72:75], v[32:35]
 v_mfma_f32_16x16x32_bf16 v[32:35], a[140:143], a[76:79], v[32:35]
 v_exp_f32 v24, v24
 v_exp_f32 v25, v25
 v_mfma_f32_16x16x32_bf16 v[36:39], a[156:159], a[76:79], 0
 v_mul_f32 v26, s32, v26
 v_mul_f32 v27, s32, v27
 v_mfma_f32_16x16x32_bf16 v[36:39], a[152:155], a[72:75], v[36:39]
 v_exp_f32 v26, v26
 v_mfma_f32_16x16x32_bf16 v[36:39], a[148:151], a[68:71], v[36:39]
 v_mfma_f32_16x16x32_bf16 v[36:39], a[144:147], a[64:67], v[36:39]
 v_exp_f32 v27, v27
 v_mul_f32 v28, s32, v28
 v_mfma_f32_16x16x32_bf16 v[160:163], a[160:163], v[48:51], v[160:163]
 v_mul_f32 v29, s32, v29
 v_cvt_pk_bf16_f32 v40, v24, v25
 v_mfma_f32_16x16x32_bf16 v[160:163], a[192:195], v[52:55], v[160:163]
 v_cvt_pk_bf16_f32 v41, v26, v27
 v_exp_f32 v28, v28
 v_mfma_f32_16x16x32_bf16 v[164:167], a[164:167], v[48:51], v[164:167]
 s_add_u32 m0, s39, 16896
 v_mfma_f32_16x16x32_bf16 v[164:167], a[196:199], v[52:55], v[164:167]
 buffer_load_dwordx4 v1, s[20:23], s33 offen nt lds
 v_mfma_f32_16x16x32_bf16 v[168:171], a[168:171], v[48:51], v[168:171]
 v_exp_f32 v29, v29
 v_mfma_f32_16x16x32_bf16 v[168:171], a[200:203], v[52:55], v[168:171]
 v_mul_f32 v30, s32, v30
 v_mul_f32 v31, s32, v31
 v_exp_f32 v30, v30
 v_mfma_f32_16x16x32_bf16 v[172:175], a[172:175], v[48:51], v[172:175]
 v_exp_f32 v31, v31
 v_mfma_f32_16x16x32_bf16 v[172:175], a[204:207], v[52:55], v[172:175]
 v_mfma_f32_16x16x32_bf16 v[24:27], a[96:99], a[80:83], 0
 v_cvt_pk_bf16_f32 v42, v28, v29
 v_cvt_pk_bf16_f32 v43, v30, v31
 v_mfma_f32_16x16x32_bf16 v[24:27], a[100:103], a[84:87], v[24:27]
 v_mul_f32 v32, s32, v32
 v_mul_f32 v33, s32, v33
 v_mfma_f32_16x16x32_bf16 v[24:27], a[104:107], a[88:91], v[24:27]
 v_exp_f32 v32, v32
 v_mfma_f32_16x16x32_bf16 v[24:27], a[108:111], a[92:95], v[24:27]
 v_smfmac_f32_16x16x64_bf16 a[228:231], a[240:243], v[48:55], v2
 v_exp_f32 v33, v33
 v_mul_f32 v34, s32, v34
 v_mul_f32 v35, s32, v35
 v_mfma_f32_16x16x32_bf16 v[28:31], a[124:127], a[92:95], 0
 v_exp_f32 v34, v34
 v_mfma_f32_16x16x32_bf16 v[28:31], a[120:123], a[88:91], v[28:31]
 v_mfma_f32_16x16x32_bf16 v[28:31], a[116:119], a[84:87], v[28:31]
 v_exp_f32 v35, v35
 v_mfma_f32_16x16x32_bf16 v[28:31], a[112:115], a[80:83], v[28:31]
 s_waitcnt vmcnt(7)
 s_barrier
 v_mfma_f32_16x16x32_bf16 v[176:179], a[176:179], v[48:51], v[176:179]
 v_mul_f32 v36, s32, v36
 v_mul_f32 v37, s32, v37
 v_mfma_f32_16x16x32_bf16 v[176:179], a[208:211], v[52:55], v[176:179]
 v_cvt_pk_bf16_f32 v44, v32, v33
 v_cvt_pk_bf16_f32 v45, v34, v35
 v_exp_f32 v36, v36
 v_mfma_f32_16x16x32_bf16 v[180:183], a[180:183], v[48:51], v[180:183]
 s_add_u32 m0, s39, 16928
 ds_read_b128 a[96:99], v7 offset:33792
 ds_read_b128 a[100:103], v7 offset:33856
 v_mfma_f32_16x16x32_bf16 v[180:183], a[212:215], v[52:55], v[180:183]
 buffer_load_dwordx4 v1, s[20:23], s33 offen offset:1024 nt lds
 v_exp_f32 v37, v37
 v_mfma_f32_16x16x32_bf16 v[184:187], a[184:187], v[48:51], v[184:187]
 v_mfma_f32_16x16x32_bf16 v[184:187], a[216:219], v[52:55], v[184:187]
 v_mul_f32 v38, s32, v38
 v_mul_f32 v39, s32, v39
 v_exp_f32 v38, v38
 v_mfma_f32_16x16x32_bf16 v[188:191], a[188:191], v[48:51], v[188:191]
 ds_read_b128 a[104:107], v7 offset:33920
 ds_read_b128 a[108:111], v7 offset:33984
 v_mfma_f32_16x16x32_bf16 v[188:191], a[220:223], v[52:55], v[188:191]
 v_exp_f32 v39, v39
 v_cvt_pk_bf16_f32 v46, v36, v37
 v_cvt_pk_bf16_f32 v47, v38, v39
 v_mfma_f32_16x16x32_bf16 v[32:35], a[128:131], a[80:83], 0
 v_mul_f32 v24, s32, v24
 v_mul_f32 v25, s32, v25
 v_mfma_f32_16x16x32_bf16 v[32:35], a[132:135], a[84:87], v[32:35]
 v_mfma_f32_16x16x32_bf16 v[32:35], a[136:139], a[88:91], v[32:35]
 ds_read_b128 a[124:127], v7 offset:34496
 ds_read_b128 a[120:123], v7 offset:34432
 v_mfma_f32_16x16x32_bf16 v[32:35], a[140:143], a[92:95], v[32:35]
 v_exp_f32 v24, v24
 v_exp_f32 v25, v25
 v_mfma_f32_16x16x32_bf16 v[36:39], a[156:159], a[92:95], 0
 v_mul_f32 v26, s32, v26
 v_mul_f32 v27, s32, v27
 v_mfma_f32_16x16x32_bf16 v[36:39], a[152:155], a[88:91], v[36:39]
 v_exp_f32 v26, v26
 v_mfma_f32_16x16x32_bf16 v[36:39], a[148:151], a[84:87], v[36:39]
 ds_read_b128 a[116:119], v7 offset:34368
 ds_read_b128 a[112:115], v7 offset:34304
 v_mfma_f32_16x16x32_bf16 v[36:39], a[144:147], a[80:83], v[36:39]
 v_mfma_f32_16x16x32_bf16 v[192:195], a[160:163], v[40:43], v[192:195]
 v_exp_f32 v27, v27
 v_mfma_f32_16x16x32_bf16 v[192:195], a[192:195], v[44:47], v[192:195]
 v_mul_f32 v28, s32, v28
 v_mul_f32 v29, s32, v29
 v_cvt_pk_bf16_f32 v48, v24, v25
 v_cvt_pk_bf16_f32 v49, v26, v27
 v_mfma_f32_16x16x32_bf16 v[196:199], a[164:167], v[40:43], v[196:199]
 v_exp_f32 v28, v28
 v_mfma_f32_16x16x32_bf16 v[196:199], a[196:199], v[44:47], v[196:199]
 ds_read_b128 a[128:131], v7 offset:50688
 ds_read_b128 a[132:135], v7 offset:50752
 v_exp_f32 v29, v29
 v_mfma_f32_16x16x32_bf16 v[200:203], a[168:171], v[40:43], v[200:203]
 s_add_u32 m0, s39, 16960
 v_mfma_f32_16x16x32_bf16 v[200:203], a[200:203], v[44:47], v[200:203]
 buffer_load_dwordx4 v1, s[20:23], s33 offen offset:2048 nt lds
 v_mfma_f32_16x16x32_bf16 v[204:207], a[172:175], v[40:43], v[204:207]
 v_mul_f32 v30, s32, v30
 v_mul_f32 v31, s32, v31
 v_mfma_f32_16x16x32_bf16 v[204:207], a[204:207], v[44:47], v[204:207]
 s_waitcnt lgkmcnt(6)
 ds_read_b128 a[136:139], v7 offset:50816
 ds_read_b128 a[140:143], v7 offset:50880
 v_exp_f32 v30, v30
 v_mfma_f32_16x16x32_bf16 v[24:27], a[96:99], a[0:3], 0
 v_exp_f32 v31, v31
 v_mfma_f32_16x16x32_bf16 v[24:27], a[100:103], a[4:7], v[24:27]
 v_cvt_pk_bf16_f32 v50, v28, v29
 v_cvt_pk_bf16_f32 v51, v30, v31
 v_mfma_f32_16x16x32_bf16 v[24:27], a[104:107], a[8:11], v[24:27]
 v_mul_f32 v32, s32, v32
 v_mul_f32 v33, s32, v33
 v_mfma_f32_16x16x32_bf16 v[24:27], a[108:111], a[12:15], v[24:27]
 s_waitcnt lgkmcnt(4)
 ds_read_b128 a[156:159], v7 offset:51392
 ds_read_b128 a[152:155], v7 offset:51328
 v_exp_f32 v32, v32
 v_smfmac_f32_16x16x64_bf16 a[232:235], a[236:239], v[40:47], v2
 v_exp_f32 v33, v33
 v_mfma_f32_16x16x32_bf16 v[28:31], a[124:127], a[12:15], 0
 v_mul_f32 v34, s32, v34
 v_mul_f32 v35, s32, v35
 v_mfma_f32_16x16x32_bf16 v[28:31], a[120:123], a[8:11], v[28:31]
 v_exp_f32 v34, v34
 v_mfma_f32_16x16x32_bf16 v[28:31], a[116:119], a[4:7], v[28:31]
 ds_read_b128 a[148:151], v7 offset:51264
 ds_read_b128 a[144:147], v7 offset:51200
 v_mfma_f32_16x16x32_bf16 v[28:31], a[112:115], a[0:3], v[28:31]
 v_exp_f32 v35, v35
 v_mul_f32 v36, s32, v36
 v_mul_f32 v37, s32, v37
 v_mfma_f32_16x16x32_bf16 v[208:211], a[176:179], v[40:43], v[208:211]
 v_cvt_pk_bf16_f32 v52, v32, v33
 v_cvt_pk_bf16_f32 v53, v34, v35
 v_mfma_f32_16x16x32_bf16 v[208:211], a[208:211], v[44:47], v[208:211]
 v_mfma_f32_16x16x32_bf16 v[212:215], a[180:183], v[40:43], v[212:215]
 s_add_u32 m0, s39, 16992
 v_exp_f32 v36, v36
 v_mfma_f32_16x16x32_bf16 v[212:215], a[212:215], v[44:47], v[212:215]
 buffer_load_dwordx4 v1, s[20:23], s33 offen offset:3072 nt lds
 v_mfma_f32_16x16x32_bf16 v[216:219], a[184:187], v[40:43], v[216:219]
 s_add_u32 s33, s33, 8192
 v_exp_f32 v37, v37
 v_mfma_f32_16x16x32_bf16 v[216:219], a[216:219], v[44:47], v[216:219]
 v_mul_f32 v38, s32, v38
 v_mul_f32 v39, s32, v39
 v_mfma_f32_16x16x32_bf16 v[220:223], a[188:191], v[40:43], v[220:223]
 v_exp_f32 v38, v38
 v_mfma_f32_16x16x32_bf16 v[220:223], a[220:223], v[44:47], v[220:223]
 s_waitcnt lgkmcnt(4)
 ds_read_b128 v[56:59], v6 offset:10880
 v_exp_f32 v39, v39
 v_mfma_f32_16x16x32_bf16 v[32:35], a[128:131], a[0:3], 0
 v_cvt_pk_bf16_f32 v54, v36, v37
 v_cvt_pk_bf16_f32 v55, v38, v39
 v_mfma_f32_16x16x32_bf16 v[32:35], a[132:135], a[4:7], v[32:35]
 v_mul_f32 v24, s32, v24
 v_mul_f32 v25, s32, v25
 v_mfma_f32_16x16x32_bf16 v[32:35], a[136:139], a[8:11], v[32:35]
 v_exp_f32 v24, v24
 v_mfma_f32_16x16x32_bf16 v[32:35], a[140:143], a[12:15], v[32:35]
 s_waitcnt lgkmcnt(1)
 v_exp_f32 v25, v25
 v_mfma_f32_16x16x32_bf16 v[36:39], a[156:159], a[12:15], 0
 v_mul_f32 v26, s32, v26
 v_mul_f32 v27, s32, v27
 v_mfma_f32_16x16x32_bf16 v[36:39], a[152:155], a[8:11], v[36:39]
 v_exp_f32 v26, v26
 v_mfma_f32_16x16x32_bf16 v[36:39], a[148:151], a[4:7], v[36:39]
 v_mfma_f32_16x16x32_bf16 v[36:39], a[144:147], a[0:3], v[36:39]
 v_exp_f32 v27, v27
 v_mul_f32 v28, s32, v28
 v_mfma_f32_16x16x32_bf16 v[224:227], a[160:163], v[48:51], v[224:227]
 s_mov_b32 s38, 10240
 v_mul_f32 v29, s32, v29
 v_cvt_pk_bf16_f32 v40, v24, v25
 v_mfma_f32_16x16x32_bf16 v[224:227], a[192:195], v[52:55], v[224:227]
 s_waitcnt lgkmcnt(0)
 buffer_store_dwordx4 v[56:59], v1, s[24:27], s38 offen sc1 nt
 v_mfma_f32_16x16x32_bf16 v[228:231], a[164:167], v[48:51], v[228:231]
 ds_read_b64_tr_b16 a[160:161], v8 offset:33792
 ds_read_b64_tr_b16 a[162:163], v8 offset:34304
 v_mfma_f32_16x16x32_bf16 v[228:231], a[196:199], v[52:55], v[228:231]
 v_cvt_pk_bf16_f32 v41, v26, v27
 v_exp_f32 v28, v28
 v_mfma_f32_16x16x32_bf16 v[232:235], a[168:171], v[48:51], v[232:235]
 ds_read_b64_tr_b16 a[192:193], v8 offset:50688
 ds_read_b64_tr_b16 a[194:195], v8 offset:51200
 v_mfma_f32_16x16x32_bf16 v[232:235], a[200:203], v[52:55], v[232:235]
 v_exp_f32 v29, v29
 v_mul_f32 v30, s32, v30
 v_mul_f32 v31, s32, v31
 v_mfma_f32_16x16x32_bf16 v[236:239], a[172:175], v[48:51], v[236:239]
 v_exp_f32 v30, v30
 v_mfma_f32_16x16x32_bf16 v[236:239], a[204:207], v[52:55], v[236:239]
 ds_read_b64_tr_b16 a[164:165], v8 offset:33824
 ds_read_b64_tr_b16 a[166:167], v8 offset:34336
 v_exp_f32 v31, v31
 v_mfma_f32_16x16x32_bf16 v[24:27], a[96:99], a[16:19], 0
 v_cvt_pk_bf16_f32 v42, v28, v29
 v_cvt_pk_bf16_f32 v43, v30, v31
 v_mfma_f32_16x16x32_bf16 v[24:27], a[100:103], a[20:23], v[24:27]
 ds_read_b64_tr_b16 a[196:197], v8 offset:50720
 ds_read_b64_tr_b16 a[198:199], v8 offset:51232
 v_mfma_f32_16x16x32_bf16 v[24:27], a[104:107], a[24:27], v[24:27]
 v_mul_f32 v32, s32, v32
 v_mul_f32 v33, s32, v33
 v_mfma_f32_16x16x32_bf16 v[24:27], a[108:111], a[28:31], v[24:27]
 ds_read_b64_tr_b16 a[168:169], v8 offset:33856
 ds_read_b64_tr_b16 a[170:171], v8 offset:34368
 v_exp_f32 v32, v32
 v_smfmac_f32_16x16x64_bf16 a[232:235], a[240:243], v[48:55], v2
 v_exp_f32 v33, v33
 v_mfma_f32_16x16x32_bf16 v[28:31], a[124:127], a[28:31], 0
 ds_read_b64_tr_b16 a[200:201], v8 offset:50752
 ds_read_b64_tr_b16 a[202:203], v8 offset:51264
 v_mfma_f32_16x16x32_bf16 v[28:31], a[120:123], a[24:27], v[28:31]
 v_mul_f32 v34, s32, v34
 v_mul_f32 v35, s32, v35
 v_mfma_f32_16x16x32_bf16 v[28:31], a[116:119], a[20:23], v[28:31]
 v_exp_f32 v34, v34
 v_mfma_f32_16x16x32_bf16 v[28:31], a[112:115], a[16:19], v[28:31]
 ds_read_b64_tr_b16 a[172:173], v8 offset:33888
 ds_read_b64_tr_b16 a[174:175], v8 offset:34400
 v_exp_f32 v35, v35
 v_mfma_f32_16x16x32_bf16 v[240:243], a[176:179], v[48:51], v[240:243]
 v_mul_f32 v36, s32, v36
 v_mul_f32 v37, s32, v37
 v_mfma_f32_16x16x32_bf16 v[240:243], a[208:211], v[52:55], v[240:243]
 ds_read_b64_tr_b16 a[204:205], v8 offset:50784
 ds_read_b64_tr_b16 a[206:207], v8 offset:51296
 v_cvt_pk_bf16_f32 v44, v32, v33
 v_mfma_f32_16x16x32_bf16 v[244:247], a[180:183], v[48:51], v[244:247]
 v_mfma_f32_16x16x32_bf16 v[244:247], a[212:215], v[52:55], v[244:247]
 v_cvt_pk_bf16_f32 v45, v34, v35
 v_exp_f32 v36, v36
 v_mfma_f32_16x16x32_bf16 v[248:251], a[184:187], v[48:51], v[248:251]
 v_exp_f32 v37, v37
 v_mfma_f32_16x16x32_bf16 v[248:251], a[216:219], v[52:55], v[248:251]
 ds_read_b64_tr_b16 a[176:177], v8 offset:33920
 ds_read_b64_tr_b16 a[178:179], v8 offset:34432
 v_mul_f32 v38, s32, v38
 v_mul_f32 v39, s32, v39
 v_mfma_f32_16x16x32_bf16 v[252:255], a[188:191], v[48:51], v[252:255]
 v_exp_f32 v38, v38
 v_mfma_f32_16x16x32_bf16 v[252:255], a[220:223], v[52:55], v[252:255]
 v_exp_f32 v39, v39
 v_cvt_pk_bf16_f32 v46, v36, v37
 v_cvt_pk_bf16_f32 v47, v38, v39
 v_mfma_f32_16x16x32_bf16 v[32:35], a[128:131], a[16:19], 0
 ds_read_b64_tr_b16 a[208:209], v8 offset:50816
 ds_read_b64_tr_b16 a[210:211], v8 offset:51328
 v_mfma_f32_16x16x32_bf16 v[32:35], a[132:135], a[20:23], v[32:35]
 v_mul_f32 v24, s32, v24
 v_mul_f32 v25, s32, v25
 v_mfma_f32_16x16x32_bf16 v[32:35], a[136:139], a[24:27], v[32:35]
 v_exp_f32 v24, v24
 v_mfma_f32_16x16x32_bf16 v[32:35], a[140:143], a[28:31], v[32:35]
 ds_read_b64_tr_b16 a[180:181], v8 offset:33952
 ds_read_b64_tr_b16 a[182:183], v8 offset:34464
 v_exp_f32 v25, v25
 v_mfma_f32_16x16x32_bf16 v[36:39], a[156:159], a[28:31], 0
 v_mul_f32 v26, s32, v26
 v_mul_f32 v27, s32, v27
 v_mfma_f32_16x16x32_bf16 v[36:39], a[152:155], a[24:27], v[36:39]
 v_exp_f32 v26, v26
 v_mfma_f32_16x16x32_bf16 v[36:39], a[148:151], a[20:23], v[36:39]
 ds_read_b64_tr_b16 a[212:213], v8 offset:50848
 ds_read_b64_tr_b16 a[214:215], v8 offset:51360
 v_mfma_f32_16x16x32_bf16 v[36:39], a[144:147], a[16:19], v[36:39]
 s_waitcnt lgkmcnt(15)
 v_exp_f32 v27, v27
 v_mul_f32 v28, s32, v28
 v_mfma_f32_16x16x32_bf16 v[64:67], a[160:163], v[40:43], v[64:67]
 v_mul_f32 v29, s32, v29
 v_cvt_pk_bf16_f32 v48, v24, v25
 v_mfma_f32_16x16x32_bf16 v[64:67], a[192:195], v[44:47], v[64:67]
 ds_read_b64_tr_b16 a[184:185], v8 offset:33984
 ds_read_b64_tr_b16 a[186:187], v8 offset:34496
 v_cvt_pk_bf16_f32 v49, v26, v27
 v_mfma_f32_16x16x32_bf16 v[68:71], a[164:167], v[40:43], v[68:71]
 v_exp_f32 v28, v28
 v_mfma_f32_16x16x32_bf16 v[68:71], a[196:199], v[44:47], v[68:71]
 s_waitcnt lgkmcnt(10)
 v_exp_f32 v29, v29
 v_mul_f32 v30, s32, v30
 v_mul_f32 v31, s32, v31
 v_mfma_f32_16x16x32_bf16 v[72:75], a[168:171], v[40:43], v[72:75]
 ds_read_b64_tr_b16 a[216:217], v8 offset:50880
 ds_read_b64_tr_b16 a[218:219], v8 offset:51392
 v_mfma_f32_16x16x32_bf16 v[72:75], a[200:203], v[44:47], v[72:75]
 v_mfma_f32_16x16x32_bf16 v[76:79], a[172:175], v[40:43], v[76:79]
 v_exp_f32 v30, v30
 v_mfma_f32_16x16x32_bf16 v[76:79], a[204:207], v[44:47], v[76:79]
 ds_read_b64_tr_b16 a[188:189], v8 offset:34016
 ds_read_b64_tr_b16 a[190:191], v8 offset:34528
 v_exp_f32 v31, v31
 v_mfma_f32_16x16x32_bf16 v[24:27], a[96:99], a[32:35], 0
 ds_read_b128 v[60:63], v6 offset:11968
 v_cvt_pk_bf16_f32 v50, v28, v29
 v_mfma_f32_16x16x32_bf16 v[24:27], a[100:103], a[36:39], v[24:27]
 v_cvt_pk_bf16_f32 v51, v30, v31
 v_mul_f32 v32, s32, v32
 v_mfma_f32_16x16x32_bf16 v[24:27], a[104:107], a[40:43], v[24:27]
 ds_read_b64_tr_b16 a[220:221], v8 offset:50912
 ds_read_b64_tr_b16 a[222:223], v8 offset:51424
 v_mfma_f32_16x16x32_bf16 v[24:27], a[108:111], a[44:47], v[24:27]
 v_mul_f32 v33, s32, v33
 v_exp_f32 v32, v32
 v_smfmac_f32_16x16x64_bf16 a[224:227], a[236:239], v[40:47], v2
 v_exp_f32 v33, v33
 v_mfma_f32_16x16x32_bf16 v[28:31], a[124:127], a[44:47], 0
 v_mul_f32 v34, s32, v34
 v_mul_f32 v35, s32, v35
 v_mfma_f32_16x16x32_bf16 v[28:31], a[120:123], a[40:43], v[28:31]
 v_exp_f32 v34, v34
 v_mfma_f32_16x16x32_bf16 v[28:31], a[116:119], a[36:39], v[28:31]
 v_exp_f32 v35, v35
 v_mfma_f32_16x16x32_bf16 v[28:31], a[112:115], a[32:35], v[28:31]
 s_waitcnt lgkmcnt(9)
 v_mul_f32 v36, s32, v36
 v_mul_f32 v37, s32, v37
 v_mfma_f32_16x16x32_bf16 v[80:83], a[176:179], v[40:43], v[80:83]
 s_mov_b32 s38, 11264
 v_cvt_pk_bf16_f32 v52, v32, v33
 v_cvt_pk_bf16_f32 v53, v34, v35
 v_mfma_f32_16x16x32_bf16 v[80:83], a[208:211], v[44:47], v[80:83]
 s_waitcnt lgkmcnt(2)
 buffer_store_dwordx4 v[60:63], v1, s[24:27], s38 offen sc1 nt
 v_mfma_f32_16x16x32_bf16 v[84:87], a[180:183], v[40:43], v[84:87]
 v_exp_f32 v36, v36
 v_mfma_f32_16x16x32_bf16 v[84:87], a[212:215], v[44:47], v[84:87]
 s_waitcnt lgkmcnt(0)
 s_barrier
 v_mfma_f32_16x16x32_bf16 v[88:91], a[184:187], v[40:43], v[88:91]
 v_mfma_f32_16x16x32_bf16 v[88:91], a[216:219], v[44:47], v[88:91]
 v_exp_f32 v37, v37
 v_mfma_f32_16x16x32_bf16 v[92:95], a[188:191], v[40:43], v[92:95]
 v_mul_f32 v38, s32, v38
 v_mul_f32 v39, s32, v39
 v_mfma_f32_16x16x32_bf16 v[92:95], a[220:223], v[44:47], v[92:95]
 v_exp_f32 v38, v38
 v_mfma_f32_16x16x32_bf16 v[32:35], a[128:131], a[32:35], 0
 v_exp_f32 v39, v39
 v_mfma_f32_16x16x32_bf16 v[32:35], a[132:135], a[36:39], v[32:35]
 v_cvt_pk_bf16_f32 v54, v36, v37
 v_cvt_pk_bf16_f32 v55, v38, v39
 v_mfma_f32_16x16x32_bf16 v[32:35], a[136:139], a[40:43], v[32:35]
 v_mul_f32 v24, s32, v24
 v_mul_f32 v25, s32, v25
 v_mfma_f32_16x16x32_bf16 v[32:35], a[140:143], a[44:47], v[32:35]
 v_exp_f32 v24, v24
 v_mfma_f32_16x16x32_bf16 v[36:39], a[156:159], a[44:47], 0
 v_exp_f32 v25, v25
 v_mfma_f32_16x16x32_bf16 v[36:39], a[152:155], a[40:43], v[36:39]
 v_mul_f32 v26, s32, v26
 v_mul_f32 v27, s32, v27
 v_mfma_f32_16x16x32_bf16 v[36:39], a[148:151], a[36:39], v[36:39]
 s_add_u32 m0, s39, 33792
 v_exp_f32 v26, v26
 v_mfma_f32_16x16x32_bf16 v[36:39], a[144:147], a[32:35], v[36:39]
 buffer_load_dwordx4 v1, s[20:23], s33 offen nt lds
 v_mfma_f32_16x16x32_bf16 v[96:99], a[160:163], v[48:51], v[96:99]
 v_exp_f32 v27, v27
 v_mfma_f32_16x16x32_bf16 v[96:99], a[192:195], v[52:55], v[96:99]
 v_mfma_f32_16x16x32_bf16 v[100:103], a[164:167], v[48:51], v[100:103]
 v_mul_f32 v28, s32, v28
 v_mul_f32 v29, s32, v29
 v_mfma_f32_16x16x32_bf16 v[100:103], a[196:199], v[52:55], v[100:103]
 v_cvt_pk_bf16_f32 v40, v24, v25
 v_cvt_pk_bf16_f32 v41, v26, v27
 v_mfma_f32_16x16x32_bf16 v[104:107], a[168:171], v[48:51], v[104:107]
 v_exp_f32 v28, v28
 v_mfma_f32_16x16x32_bf16 v[104:107], a[200:203], v[52:55], v[104:107]
 v_exp_f32 v29, v29
 v_mfma_f32_16x16x32_bf16 v[108:111], a[172:175], v[48:51], v[108:111]
 v_mul_f32 v30, s32, v30
 v_mul_f32 v31, s32, v31
 v_mfma_f32_16x16x32_bf16 v[108:111], a[204:207], v[52:55], v[108:111]
 v_exp_f32 v30, v30
 v_mfma_f32_16x16x32_bf16 v[24:27], a[96:99], a[48:51], 0
 v_exp_f32 v31, v31
 v_mfma_f32_16x16x32_bf16 v[24:27], a[100:103], a[52:55], v[24:27]
 v_cvt_pk_bf16_f32 v42, v28, v29
 v_cvt_pk_bf16_f32 v43, v30, v31
 v_mfma_f32_16x16x32_bf16 v[24:27], a[104:107], a[56:59], v[24:27]
 v_mul_f32 v32, s32, v32
 v_mul_f32 v33, s32, v33
 v_mfma_f32_16x16x32_bf16 v[24:27], a[108:111], a[60:63], v[24:27]
 v_exp_f32 v32, v32
 v_exp_f32 v33, v33
 v_smfmac_f32_16x16x64_bf16 a[224:227], a[240:243], v[48:55], v2
 v_mfma_f32_16x16x32_bf16 v[28:31], a[124:127], a[60:63], 0
 v_mul_f32 v34, s32, v34
 v_mul_f32 v35, s32, v35
 v_mfma_f32_16x16x32_bf16 v[28:31], a[120:123], a[56:59], v[28:31]
 v_exp_f32 v34, v34
 v_mfma_f32_16x16x32_bf16 v[28:31], a[116:119], a[52:55], v[28:31]
 s_add_u32 m0, s39, 33824
 v_exp_f32 v35, v35
 v_mfma_f32_16x16x32_bf16 v[28:31], a[112:115], a[48:51], v[28:31]
 buffer_load_dwordx4 v1, s[20:23], s33 offen offset:1024 nt lds
 v_mfma_f32_16x16x32_bf16 v[112:115], a[176:179], v[48:51], v[112:115]
 v_mul_f32 v36, s32, v36
 v_mul_f32 v37, s32, v37
 v_mfma_f32_16x16x32_bf16 v[112:115], a[208:211], v[52:55], v[112:115]
 v_mfma_f32_16x16x32_bf16 v[116:119], a[180:183], v[48:51], v[116:119]
 v_cvt_pk_bf16_f32 v44, v32, v33
 v_cvt_pk_bf16_f32 v45, v34, v35
 v_mfma_f32_16x16x32_bf16 v[116:119], a[212:215], v[52:55], v[116:119]
 v_exp_f32 v36, v36
 v_exp_f32 v37, v37
 v_mfma_f32_16x16x32_bf16 v[120:123], a[184:187], v[48:51], v[120:123]
 v_mul_f32 v38, s32, v38
 v_mul_f32 v39, s32, v39
 v_mfma_f32_16x16x32_bf16 v[120:123], a[216:219], v[52:55], v[120:123]
 v_exp_f32 v38, v38
 v_mfma_f32_16x16x32_bf16 v[124:127], a[188:191], v[48:51], v[124:127]
 v_exp_f32 v39, v39
 v_mfma_f32_16x16x32_bf16 v[124:127], a[220:223], v[52:55], v[124:127]
 v_mfma_f32_16x16x32_bf16 v[32:35], a[128:131], a[48:51], 0
 v_cvt_pk_bf16_f32 v46, v36, v37
 v_cvt_pk_bf16_f32 v47, v38, v39
 v_mfma_f32_16x16x32_bf16 v[32:35], a[132:135], a[52:55], v[32:35]
 v_mul_f32 v24, s32, v24
 v_mul_f32 v25, s32, v25
 v_mfma_f32_16x16x32_bf16 v[32:35], a[136:139], a[56:59], v[32:35]
 v_exp_f32 v24, v24
 v_mfma_f32_16x16x32_bf16 v[32:35], a[140:143], a[60:63], v[32:35]
 v_exp_f32 v25, v25
 v_mfma_f32_16x16x32_bf16 v[36:39], a[156:159], a[60:63], 0
 v_mfma_f32_16x16x32_bf16 v[36:39], a[152:155], a[56:59], v[36:39]
 v_mul_f32 v26, s32, v26
 v_mul_f32 v27, s32, v27
 v_mfma_f32_16x16x32_bf16 v[36:39], a[148:151], a[52:55], v[36:39]
 v_exp_f32 v26, v26
 v_mfma_f32_16x16x32_bf16 v[36:39], a[144:147], a[48:51], v[36:39]
 v_exp_f32 v27, v27
 v_mul_f32 v28, s32, v28
 v_mfma_f32_16x16x32_bf16 v[128:131], a[160:163], v[40:43], v[128:131]
 s_add_u32 m0, s39, 33856
 v_mul_f32 v29, s32, v29
 v_cvt_pk_bf16_f32 v48, v24, v25
 v_mfma_f32_16x16x32_bf16 v[128:131], a[192:195], v[44:47], v[128:131]
 buffer_load_dwordx4 v1, s[20:23], s33 offen offset:2048 nt lds
 v_mfma_f32_16x16x32_bf16 v[132:135], a[164:167], v[40:43], v[132:135]
 v_mfma_f32_16x16x32_bf16 v[132:135], a[196:199], v[44:47], v[132:135]
 v_cvt_pk_bf16_f32 v49, v26, v27
 v_exp_f32 v28, v28
 v_mfma_f32_16x16x32_bf16 v[136:139], a[168:171], v[40:43], v[136:139]
 v_exp_f32 v29, v29
 v_mfma_f32_16x16x32_bf16 v[136:139], a[200:203], v[44:47], v[136:139]
 v_mul_f32 v30, s32, v30
 v_mul_f32 v31, s32, v31
 v_mfma_f32_16x16x32_bf16 v[140:143], a[172:175], v[40:43], v[140:143]
 v_exp_f32 v30, v30
 v_mfma_f32_16x16x32_bf16 v[140:143], a[204:207], v[44:47], v[140:143]
 v_mfma_f32_16x16x32_bf16 v[24:27], a[96:99], a[64:67], 0
 v_exp_f32 v31, v31
 v_mfma_f32_16x16x32_bf16 v[24:27], a[100:103], a[68:71], v[24:27]
 v_cvt_pk_bf16_f32 v50, v28, v29
 v_cvt_pk_bf16_f32 v51, v30, v31
 v_mfma_f32_16x16x32_bf16 v[24:27], a[104:107], a[72:75], v[24:27]
 v_mul_f32 v32, s32, v32
 v_mul_f32 v33, s32, v33
 v_mfma_f32_16x16x32_bf16 v[24:27], a[108:111], a[76:79], v[24:27]
 v_exp_f32 v32, v32
 v_smfmac_f32_16x16x64_bf16 a[228:231], a[236:239], v[40:47], v2
 v_exp_f32 v33, v33
 v_mfma_f32_16x16x32_bf16 v[28:31], a[124:127], a[76:79], 0
 v_mfma_f32_16x16x32_bf16 v[28:31], a[120:123], a[72:75], v[28:31]
 v_mul_f32 v34, s32, v34
 v_mul_f32 v35, s32, v35
 v_mfma_f32_16x16x32_bf16 v[28:31], a[116:119], a[68:71], v[28:31]
 v_exp_f32 v34, v34
 v_mfma_f32_16x16x32_bf16 v[28:31], a[112:115], a[64:67], v[28:31]
 v_exp_f32 v35, v35
 v_mul_f32 v36, s32, v36
 v_mfma_f32_16x16x32_bf16 v[144:147], a[176:179], v[40:43], v[144:147]
 s_add_u32 m0, s39, 33888
 v_mul_f32 v37, s32, v37
 v_cvt_pk_bf16_f32 v52, v32, v33
 v_mfma_f32_16x16x32_bf16 v[144:147], a[208:211], v[44:47], v[144:147]
 buffer_load_dwordx4 v1, s[20:23], s33 offen offset:3072 nt lds
 v_mfma_f32_16x16x32_bf16 v[148:151], a[180:183], v[40:43], v[148:151]
L_pg0_11:
 s_cbranch_execz L_main0
 s_add_u32 s33, s33, 8192
 v_mfma_f32_16x16x32_bf16 v[148:151], a[212:215], v[44:47], v[148:151]
 v_cvt_pk_bf16_f32 v53, v34, v35
 v_exp_f32 v36, v36
 v_mfma_f32_16x16x32_bf16 v[152:155], a[184:187], v[40:43], v[152:155]
 v_exp_f32 v37, v37
 v_mfma_f32_16x16x32_bf16 v[152:155], a[216:219], v[44:47], v[152:155]
 v_mul_f32 v38, s32, v38
 v_mul_f32 v39, s32, v39
 v_exp_f32 v38, v38
 v_mfma_f32_16x16x32_bf16 v[156:159], a[188:191], v[40:43], v[156:159]
 v_exp_f32 v39, v39
 v_mfma_f32_16x16x32_bf16 v[156:159], a[220:223], v[44:47], v[156:159]
 v_mfma_f32_16x16x32_bf16 v[32:35], a[128:131], a[64:67], 0
 v_cvt_pk_bf16_f32 v54, v36, v37
 v_cvt_pk_bf16_f32 v55, v38, v39
 v_mfma_f32_16x16x32_bf16 v[32:35], a[132:135], a[68:71], v[32:35]
 v_mul_f32 v24, s32, v24
 v_mul_f32 v25, s32, v25
 v_mfma_f32_16x16x32_bf16 v[32:35], a[136:139], a[72:75], v[32:35]
 v_exp_f32 v24, v24
 v_mfma_f32_16x16x32_bf16 v[32:35], a[140:143], a[76:79], v[32:35]
 v_exp_f32 v25, v25
 v_mfma_f32_16x16x32_bf16 v[36:39], a[156:159], a[76:79], 0
 v_mfma_f32_16x16x32_bf16 v[36:39], a[152:155], a[72:75], v[36:39]
 v_mul_f32 v26, s32, v26
 v_mul_f32 v27, s32, v27
 v_mfma_f32_16x16x32_bf16 v[36:39], a[148:151], a[68:71], v[36:39]
 v_exp_f32 v26, v26
 v_mfma_f32_16x16x32_bf16 v[36:39], a[144:147], a[64:67], v[36:39]
 v_exp_f32 v27, v27
 v_mul_f32 v28, s32, v28
 v_mfma_f32_16x16x32_bf16 v[160:163], a[160:163], v[48:51], v[160:163]
 v_mul_f32 v29, s32, v29
 v_cvt_pk_bf16_f32 v40, v24, v25
 v_mfma_f32_16x16x32_bf16 v[160:163], a[192:195], v[52:55], v[160:163]
 v_cvt_pk_bf16_f32 v41, v26, v27
 v_exp_f32 v28, v28
 v_mfma_f32_16x16x32_bf16 v[164:167], a[164:167], v[48:51], v[164:167]
 s_add_u32 m0, s39, 50688
 v_mfma_f32_16x16x32_bf16 v[164:167], a[196:199], v[52:55], v[164:167]
 buffer_load_dwordx4 v1, s[20:23], s33 offen nt lds
 v_mfma_f32_16x16x32_bf16 v[168:171], a[168:171], v[48:51], v[168:171]
 v_exp_f32 v29, v29
 v_mfma_f32_16x16x32_bf16 v[168:171], a[200:203], v[52:55], v[168:171]
 v_mul_f32 v30, s32, v30
 v_mul_f32 v31, s32, v31
 v_mfma_f32_16x16x32_bf16 v[172:175], a[172:175], v[48:51], v[172:175]
 v_exp_f32 v30, v30
 v_mfma_f32_16x16x32_bf16 v[172:175], a[204:207], v[52:55], v[172:175]
 v_exp_f32 v31, v31
 v_mfma_f32_16x16x32_bf16 v[24:27], a[96:99], a[80:83], 0
 v_mfma_f32_16x16x32_bf16 v[24:27], a[100:103], a[84:87], v[24:27]
 v_cvt_pk_bf16_f32 v42, v28, v29
 v_cvt_pk_bf16_f32 v43, v30, v31
 v_mfma_f32_16x16x32_bf16 v[24:27], a[104:107], a[88:91], v[24:27]
 v_mul_f32 v32, s32, v32
 v_mul_f32 v33, s32, v33
 v_mfma_f32_16x16x32_bf16 v[24:27], a[108:111], a[92:95], v[24:27]
 v_exp_f32 v32, v32
 v_exp_f32 v33, v33
 v_smfmac_f32_16x16x64_bf16 a[228:231], a[240:243], v[48:55], v2
 v_mul_f32 v34, s32, v34
 v_mul_f32 v35, s32, v35
 v_mfma_f32_16x16x32_bf16 v[28:31], a[124:127], a[92:95], 0
 v_mfma_f32_16x16x32_bf16 v[28:31], a[120:123], a[88:91], v[28:31]
 v_exp_f32 v34, v34
 v_mfma_f32_16x16x32_bf16 v[28:31], a[116:119], a[84:87], v[28:31]
 v_exp_f32 v35, v35
 v_mfma_f32_16x16x32_bf16 v[28:31], a[112:115], a[80:83], v[28:31]
 s_waitcnt vmcnt(7)
 s_barrier
 v_mfma_f32_16x16x32_bf16 v[176:179], a[176:179], v[48:51], v[176:179]
 v_mul_f32 v36, s32, v36
 v_mul_f32 v37, s32, v37
 v_mfma_f32_16x16x32_bf16 v[176:179], a[208:211], v[52:55], v[176:179]
 v_cvt_pk_bf16_f32 v44, v32, v33
 v_cvt_pk_bf16_f32 v45, v34, v35
 v_exp_f32 v36, v36
 v_mfma_f32_16x16x32_bf16 v[180:183], a[180:183], v[48:51], v[180:183]
 s_add_u32 m0, s39, 50720
 ds_read_b128 a[96:99], v7 offset:0
 ds_read_b128 a[100:103], v7 offset:64
 v_mfma_f32_16x16x32_bf16 v[180:183], a[212:215], v[52:55], v[180:183]
 buffer_load_dwordx4 v1, s[20:23], s33 offen offset:1024 nt lds
 v_mfma_f32_16x16x32_bf16 v[184:187], a[184:187], v[48:51], v[184:187]
 v_mfma_f32_16x16x32_bf16 v[184:187], a[216:219], v[52:55], v[184:187]
 v_exp_f32 v37, v37
 v_mul_f32 v38, s32, v38
 v_mfma_f32_16x16x32_bf16 v[188:191], a[188:191], v[48:51], v[188:191]
 ds_read_b128 a[104:107], v7 offset:128
 ds_read_b128 a[108:111], v7 offset:192
 v_mfma_f32_16x16x32_bf16 v[188:191], a[220:223], v[52:55], v[188:191]
 v_mul_f32 v39, s32, v39
 v_exp_f32 v38, v38
 v_mfma_f32_16x16x32_bf16 v[32:35], a[128:131], a[80:83], 0
 v_exp_f32 v39, v39
 v_mfma_f32_16x16x32_bf16 v[32:35], a[132:135], a[84:87], v[32:35]
 v_cvt_pk_bf16_f32 v46, v36, v37
 v_cvt_pk_bf16_f32 v47, v38, v39
 v_mfma_f32_16x16x32_bf16 v[32:35], a[136:139], a[88:91], v[32:35]
 ds_read_b128 a[124:127], v7 offset:704
 ds_read_b128 a[120:123], v7 offset:640
 v_mfma_f32_16x16x32_bf16 v[32:35], a[140:143], a[92:95], v[32:35]
 v_mul_f32 v24, s32, v24
 v_mul_f32 v25, s32, v25
 v_exp_f32 v24, v24
 v_mfma_f32_16x16x32_bf16 v[36:39], a[156:159], a[92:95], 0
 v_mfma_f32_16x16x32_bf16 v[36:39], a[152:155], a[88:91], v[36:39]
 v_exp_f32 v25, v25
 v_mfma_f32_16x16x32_bf16 v[36:39], a[148:151], a[84:87], v[36:39]
 ds_read_b128 a[116:119], v7 offset:576
 ds_read_b128 a[112:115], v7 offset:512
 v_mfma_f32_16x16x32_bf16 v[36:39], a[144:147], a[80:83], v[36:39]
 v_mul_f32 v26, s32, v26
 v_mul_f32 v27, s32, v27
 v_exp_f32 v26, v26
 v_mfma_f32_16x16x32_bf16 v[192:195], a[160:163], v[40:43], v[192:195]
 v_exp_f32 v27, v27
 v_mfma_f32_16x16x32_bf16 v[192:195], a[192:195], v[44:47], v[192:195]
 v_mul_f32 v28, s32, v28
 v_mul_f32 v29, s32, v29
 v_cvt_pk_bf16_f32 v48, v24, v25
 v_cvt_pk_bf16_f32 v49, v26, v27
 v_mfma_f32_16x16x32_bf16 v[196:199], a[164:167], v[40:43], v[196:199]
 v_mfma_f32_16x16x32_bf16 v[196:199], a[196:199], v[44:47], v[196:199]
 ds_read_b128 a[128:131], v7 offset:16896
 ds_read_b128 a[132:135], v7 offset:16960
 v_exp_f32 v28, v28
 v_mfma_f32_16x16x32_bf16 v[200:203], a[168:171], v[40:43], v[200:203]
 s_add_u32 m0, s39, 50752
 v_exp_f32 v29, v29
 v_mfma_f32_16x16x32_bf16 v[200:203], a[200:203], v[44:47], v[200:203]
 buffer_load_dwordx4 v1, s[20:23], s33 offen offset:2048 nt lds
 v_mfma_f32_16x16x32_bf16 v[204:207], a[172:175], v[40:43], v[204:207]
 v_mul_f32 v30, s32, v30
 v_mul_f32 v31, s32, v31
 v_mfma_f32_16x16x32_bf16 v[204:207], a[204:207], v[44:47], v[204:207]
 s_waitcnt lgkmcnt(6)
 ds_read_b128 a[136:139], v7 offset:17024
 ds_read_b128 a[140:143], v7 offset:17088
 v_exp_f32 v30, v30
 v_mfma_f32_16x16x32_bf16 v[24:27], a[96:99], a[0:3], 0
 v_exp_f32 v31, v31
 v_mfma_f32_16x16x32_bf16 v[24:27], a[100:103], a[4:7], v[24:27]
 v_cvt_pk_bf16_f32 v50, v28, v29
 v_cvt_pk_bf16_f32 v51, v30, v31
 v_mfma_f32_16x16x32_bf16 v[24:27], a[104:107], a[8:11], v[24:27]
 v_mul_f32 v32, s32, v32
 v_mul_f32 v33, s32, v33
 v_mfma_f32_16x16x32_bf16 v[24:27], a[108:111], a[12:15], v[24:27]
 s_waitcnt lgkmcnt(4)
 ds_read_b128 a[156:159], v7 offset:17600
 ds_read_b128 a[152:155], v7 offset:17536
 v_exp_f32 v32, v32
 v_smfmac_f32_16x16x64_bf16 a[232:235], a[236:239], v[40:47], v2
 v_exp_f32 v33, v33
 v_mfma_f32_16x16x32_bf16 v[28:31], a[124:127], a[12:15], 0
 v_mul_f32 v34, s32, v34
 v_mul_f32 v35, s32, v35
 v_mfma_f32_16x16x32_bf16 v[28:31], a[120:123], a[8:11], v[28:31]
 v_exp_f32 v34, v34
 v_mfma_f32_16x16x32_bf16 v[28:31], a[116:119], a[4:7], v[28:31]
 ds_read_b128 a[148:151], v7 offset:17472
 ds_read_b128 a[144:147], v7 offset:17408
 v_mfma_f32_16x16x32_bf16 v[28:31], a[112:115], a[0:3], v[28:31]
 v_exp_f32 v35, v35
 v_mul_f32 v36, s32, v36
 v_mfma_f32_16x16x32_bf16 v[208:211], a[176:179], v[40:43], v[208:211]
 v_mul_f32 v37, s32, v37
 v_cvt_pk_bf16_f32 v52, v32, v33
 v_mfma_f32_16x16x32_bf16 v[208:211], a[208:211], v[44:47], v[208:211]
 ds_read_b128 v[56:59], v6 offset:13056
 v_cvt_pk_bf16_f32 v53, v34, v35
 v_mfma_f32_16x16x32_bf16 v[212:215], a[180:183], v[40:43], v[212:215]
 s_add_u32 m0, s39, 50784
 v_exp_f32 v36, v36
 v_mfma_f32_16x16x32_bf16 v[212:215], a[212:215], v[44:47], v[212:215]
 buffer_load_dwordx4 v1, s[20:23], s33 offen offset:3072 nt lds
 v_mfma_f32_16x16x32_bf16 v[216:219], a[184:187], v[40:43], v[216:219]
 s_add_u32 s33, s33, 8192
 v_exp_f32 v37, v37
 v_mfma_f32_16x16x32_bf16 v[216:219], a[216:219], v[44:47], v[216:219]
 v_mul_f32 v38, s32, v38
 v_mul_f32 v39, s32, v39
 v_mfma_f32_16x16x32_bf16 v[220:223], a[188:191], v[40:43], v[220:223]
 v_exp_f32 v38, v38
 v_mfma_f32_16x16x32_bf16 v[220:223], a[220:223], v[44:47], v[220:223]
 s_waitcnt lgkmcnt(5)
 v_exp_f32 v39, v39
 v_mfma_f32_16x16x32_bf16 v[32:35], a[128:131], a[0:3], 0
 v_cvt_pk_bf16_f32 v54, v36, v37
 v_cvt_pk_bf16_f32 v55, v38, v39
 v_mfma_f32_16x16x32_bf16 v[32:35], a[132:135], a[4:7], v[32:35]
 v_mul_f32 v24, s32, v24
 v_mul_f32 v25, s32, v25
 v_mfma_f32_16x16x32_bf16 v[32:35], a[136:139], a[8:11], v[32:35]
 s_mov_b32 s38, 12288
 v_exp_f32 v24, v24
 v_mfma_f32_16x16x32_bf16 v[32:35], a[140:143], a[12:15], v[32:35]
 s_waitcnt lgkmcnt(0)
 s_waitcnt lgkmcnt(1)
 buffer_store_dwordx4 v[56:59], v1, s[24:27], s38 offen sc1 nt
 v_mfma_f32_16x16x32_bf16 v[36:39], a[156:159], a[12:15], 0
 v_exp_f32 v25, v25
 v_mfma_f32_16x16x32_bf16 v[36:39], a[152:155], a[8:11], v[36:39]
 v_mul_f32 v26, s32, v26
 v_mul_f32 v27, s32, v27
 v_mfma_f32_16x16x32_bf16 v[36:39], a[148:151], a[4:7], v[36:39]
 v_exp_f32 v26, v26
 v_mfma_f32_16x16x32_bf16 v[36:39], a[144:147], a[0:3], v[36:39]
 v_exp_f32 v27, v27
 v_mul_f32 v28, s32, v28
 v_mfma_f32_16x16x32_bf16 v[224:227], a[160:163], v[48:51], v[224:227]
 v_mul_f32 v29, s32, v29
 v_cvt_pk_bf16_f32 v40, v24, v25
 v_mfma_f32_16x16x32_bf16 v[224:227], a[192:195], v[52:55], v[224:227]
 v_cvt_pk_bf16_f32 v41, v26, v27
 v_exp_f32 v28, v28
 v_mfma_f32_16x16x32_bf16 v[228:231], a[164:167], v[48:51], v[228:231]
 ds_read_b64_tr_b16 a[160:161], v8 offset:0
 ds_read_b64_tr_b16 a[162:163], v8 offset:512
 v_mfma_f32_16x16x32_bf16 v[228:231], a[196:199], v[52:55], v[228:231]
 v_exp_f32 v29, v29
 v_mul_f32 v30, s32, v30
 v_mfma_f32_16x16x32_bf16 v[232:235], a[168:171], v[48:51], v[232:235]
 ds_read_b64_tr_b16 a[192:193], v8 offset:16896
 ds_read_b64_tr_b16 a[194:195], v8 offset:17408
 v_mfma_f32_16x16x32_bf16 v[232:235], a[200:203], v[52:55], v[232:235]
 v_mul_f32 v31, s32, v31
 v_exp_f32 v30, v30
 v_mfma_f32_16x16x32_bf16 v[236:239], a[172:175], v[48:51], v[236:239]
 v_exp_f32 v31, v31
 v_mfma_f32_16x16x32_bf16 v[236:239], a[204:207], v[52:55], v[236:239]
 ds_read_b64_tr_b16 a[164:165], v8 offset:32
 ds_read_b64_tr_b16 a[166:167], v8 offset:544
 v_mfma_f32_16x16x32_bf16 v[24:27], a[96:99], a[16:19], 0
 v_cvt_pk_bf16_f32 v42, v28, v29
 v_cvt_pk_bf16_f32 v43, v30, v31
 v_mfma_f32_16x16x32_bf16 v[24:27], a[100:103], a[20:23], v[24:27]
 ds_read_b64_tr_b16 a[196:197], v8 offset:16928
 ds_read_b64_tr_b16 a[198:199], v8 offset:17440
 v_mfma_f32_16x16x32_bf16 v[24:27], a[104:107], a[24:27], v[24:27]
 v_mul_f32 v32, s32, v32
 v_mul_f32 v33, s32, v33
 v_mfma_f32_16x16x32_bf16 v[24:27], a[108:111], a[28:31], v[24:27]
 ds_read_b64_tr_b16 a[168:169], v8 offset:64
 ds_read_b64_tr_b16 a[170:171], v8 offset:576
 v_exp_f32 v32, v32
 v_smfmac_f32_16x16x64_bf16 a[232:235], a[240:243], v[48:55], v2
 v_exp_f32 v33, v33
 v_mul_f32 v34, s32, v34
 v_mfma_f32_16x16x32_bf16 v[28:31], a[124:127], a[28:31], 0
 ds_read_b64_tr_b16 a[200:201], v8 offset:16960
 ds_read_b64_tr_b16 a[202:203], v8 offset:17472
 v_mfma_f32_16x16x32_bf16 v[28:31], a[120:123], a[24:27], v[28:31]
 ds_read_b128 v[60:63], v6 offset:14144
 v_mul_f32 v35, s32, v35
 v_mfma_f32_16x16x32_bf16 v[28:31], a[116:119], a[20:23], v[28:31]
 v_exp_f32 v34, v34
 v_mfma_f32_16x16x32_bf16 v[28:31], a[112:115], a[16:19], v[28:31]
 ds_read_b64_tr_b16 a[172:173], v8 offset:96
 ds_read_b64_tr_b16 a[174:175], v8 offset:608
 v_exp_f32 v35, v35
 v_mfma_f32_16x16x32_bf16 v[240:243], a[176:179], v[48:51], v[240:243]
 v_mul_f32 v36, s32, v36
 v_mul_f32 v37, s32, v37
 v_mfma_f32_16x16x32_bf16 v[240:243], a[208:211], v[52:55], v[240:243]
 ds_read_b64_tr_b16 a[204:205], v8 offset:16992
 ds_read_b64_tr_b16 a[206:207], v8 offset:17504
 v_cvt_pk_bf16_f32 v44, v32, v33
 v_cvt_pk_bf16_f32 v45, v34, v35
 v_mfma_f32_16x16x32_bf16 v[244:247], a[180:183], v[48:51], v[244:247]
 v_exp_f32 v36, v36
 v_mfma_f32_16x16x32_bf16 v[244:247], a[212:215], v[52:55], v[244:247]
 v_exp_f32 v37, v37
 v_mfma_f32_16x16x32_bf16 v[248:251], a[184:187], v[48:51], v[248:251]
 v_mul_f32 v38, s32, v38
 v_mul_f32 v39, s32, v39
 v_mfma_f32_16x16x32_bf16 v[248:251], a[216:219], v[52:55], v[248:251]
 ds_read_b64_tr_b16 a[176:177], v8 offset:128
 ds_read_b64_tr_b16 a[178:179], v8 offset:640
 v_exp_f32 v38, v38
 v_mfma_f32_16x16x32_bf16 v[252:255], a[188:191], v[48:51], v[252:255]
 s_mov_b32 s38, 13312
 v_exp_f32 v39, v39
 v_mfma_f32_16x16x32_bf16 v[252:255], a[220:223], v[52:55], v[252:255]
 s_waitcnt lgkmcnt(6)
 buffer_store_dwordx4 v[60:63], v1, s[24:27], s38 offen sc1 nt
 v_mfma_f32_16x16x32_bf16 v[32:35], a[128:131], a[16:19], 0
 ds_read_b64_tr_b16 a[208:209], v8 offset:17024
 ds_read_b64_tr_b16 a[210:211], v8 offset:17536
 v_mfma_f32_16x16x32_bf16 v[32:35], a[132:135], a[20:23], v[32:35]
 v_cvt_pk_bf16_f32 v46, v36, v37
 v_cvt_pk_bf16_f32 v47, v38, v39
 v_mfma_f32_16x16x32_bf16 v[32:35], a[136:139], a[24:27], v[32:35]
 v_mul_f32 v24, s32, v24
 v_mul_f32 v25, s32, v25
 v_mfma_f32_16x16x32_bf16 v[32:35], a[140:143], a[28:31], v[32:35]
 ds_read_b64_tr_b16 a[180:181], v8 offset:160
 ds_read_b64_tr_b16 a[182:183], v8 offset:672
 v_exp_f32 v24, v24
 v_mfma_f32_16x16x32_bf16 v[36:39], a[156:159], a[28:31], 0
 v_exp_f32 v25, v25
 v_mfma_f32_16x16x32_bf16 v[36:39], a[152:155], a[24:27], v[36:39]
 v_mul_f32 v26, s32, v26
 v_mul_f32 v27, s32, v27
 v_mfma_f32_16x16x32_bf16 v[36:39], a[148:151], a[20:23], v[36:39]
 ds_read_b64_tr_b16 a[212:213], v8 offset:17056
 ds_read_b64_tr_b16 a[214:215], v8 offset:17568
 v_mfma_f32_16x16x32_bf16 v[36:39], a[144:147], a[16:19], v[36:39]
 s_waitcnt lgkmcnt(15)
 v_exp_f32 v26, v26
 v_mfma_f32_16x16x32_bf16 v[64:67], a[160:163], v[40:43], v[64:67]
 v_exp_f32 v27, v27
 v_mfma_f32_16x16x32_bf16 v[64:67], a[192:195], v[44:47], v[64:67]
 ds_read_b64_tr_b16 a[184:185], v8 offset:192
 ds_read_b64_tr_b16 a[186:187], v8 offset:704
 v_mul_f32 v28, s32, v28
 v_mfma_f32_16x16x32_bf16 v[68:71], a[164:167], v[40:43], v[68:71]
 v_mul_f32 v29, s32, v29
 v_cvt_pk_bf16_f32 v48, v24, v25
 v_mfma_f32_16x16x32_bf16 v[68:71], a[196:199], v[44:47], v[68:71]
 s_waitcnt lgkmcnt(10)
 v_cvt_pk_bf16_f32 v49, v26, v27
 v_exp_f32 v28, v28
 v_mfma_f32_16x16x32_bf16 v[72:75], a[168:171], v[40:43], v[72:75]
 ds_read_b64_tr_b16 a[216:217], v8 offset:17088
 ds_read_b64_tr_b16 a[218:219], v8 offset:17600
 v_mfma_f32_16x16x32_bf16 v[72:75], a[200:203], v[44:47], v[72:75]
 v_exp_f32 v29, v29
 v_mul_f32 v30, s32, v30
 v_mul_f32 v31, s32, v31
 v_mfma_f32_16x16x32_bf16 v[76:79], a[172:175], v[40:43], v[76:79]
 v_exp_f32 v30, v30
 v_mfma_f32_16x16x32_bf16 v[76:79], a[204:207], v[44:47], v[76:79]
 ds_read_b64_tr_b16 a[188:189], v8 offset:224
 ds_read_b64_tr_b16 a[190:191], v8 offset:736
 v_mfma_f32_16x16x32_bf16 v[24:27], a[96:99], a[32:35], 0
 v_exp_f32 v31, v31
 v_mfma_f32_16x16x32_bf16 v[24:27], a[100:103], a[36:39], v[24:27]
 v_cvt_pk_bf16_f32 v50, v28, v29
 v_cvt_pk_bf16_f32 v51, v30, v31
 v_mfma_f32_16x16x32_bf16 v[24:27], a[104:107], a[40:43], v[24:27]
 ds_read_b64_tr_b16 a[220:221], v8 offset:17120
 ds_read_b64_tr_b16 a[222:223], v8 offset:17632
 v_mfma_f32_16x16x32_bf16 v[24:27], a[108:111], a[44:47], v[24:27]
 v_mul_f32 v32, s32, v32
 v_mul_f32 v33, s32, v33
 v_smfmac_f32_16x16x64_bf16 a[224:227], a[236:239], v[40:47], v2
 v_mfma_f32_16x16x32_bf16 v[28:31], a[124:127], a[44:47], 0
 v_exp_f32 v32, v32
 v_mfma_f32_16x16x32_bf16 v[28:31], a[120:123], a[40:43], v[28:31]
 v_exp_f32 v33, v33
 v_mfma_f32_16x16x32_bf16 v[28:31], a[116:119], a[36:39], v[28:31]
 v_mul_f32 v34, s32, v34
 v_mul_f32 v35, s32, v35
 v_mfma_f32_16x16x32_bf16 v[28:31], a[112:115], a[32:35], v[28:31]
 s_waitcnt lgkmcnt(8)
 v_exp_f32 v34, v34
 v_mfma_f32_16x16x32_bf16 v[80:83], a[176:179], v[40:43], v[80:83]
 v_exp_f32 v35, v35
 v_mfma_f32_16x16x32_bf16 v[80:83], a[208:211], v[44:47], v[80:83]
 ds_read_b128 v[56:59], v6 offset:15232
 v_mfma_f32_16x16x32_bf16 v[84:87], a[180:183], v[40:43], v[84:87]
 v_mul_f32 v36, s32, v36
 v_mul_f32 v37, s32, v37
 v_mfma_f32_16x16x32_bf16 v[84:87], a[212:215], v[44:47], v[84:87]
 s_waitcnt lgkmcnt(1)
 v_cvt_pk_bf16_f32 v52, v32, v33
 v_cvt_pk_bf16_f32 v53, v34, v35
 v_mfma_f32_16x16x32_bf16 v[88:91], a[184:187], v[40:43], v[88:91]
 v_exp_f32 v36, v36
 v_mfma_f32_16x16x32_bf16 v[88:91], a[216:219], v[44:47], v[88:91]
 v_exp_f32 v37, v37
 v_mfma_f32_16x16x32_bf16 v[92:95], a[188:191], v[40:43], v[92:95]
 v_mul_f32 v38, s32, v38
 v_mul_f32 v39, s32, v39
 v_mfma_f32_16x16x32_bf16 v[92:95], a[220:223], v[44:47], v[92:95]
 v_exp_f32 v38, v38
 v_mfma_f32_16x16x32_bf16 v[32:35], a[128:131], a[32:35], 0
 v_exp_f32 v39, v39
 v_mfma_f32_16x16x32_bf16 v[32:35], a[132:135], a[36:39], v[32:35]
 v_cvt_pk_bf16_f32 v54, v36, v37
 v_cvt_pk_bf16_f32 v55, v38, v39
 v_mfma_f32_16x16x32_bf16 v[32:35], a[136:139], a[40:43], v[32:35]
 s_mov_b32 s38, 14336
 v_mul_f32 v24, s32, v24
 v_mul_f32 v25, s32, v25
 v_mfma_f32_16x16x32_bf16 v[32:35], a[140:143], a[44:47], v[32:35]
 s_waitcnt lgkmcnt(0)
 buffer_store_dwordx4 v[56:59], v1, s[24:27], s38 offen sc1 nt
 v_mfma_f32_16x16x32_bf16 v[36:39], a[156:159], a[44:47], 0
 v_exp_f32 v24, v24
 v_mfma_f32_16x16x32_bf16 v[36:39], a[152:155], a[40:43], v[36:39]
 v_exp_f32 v25, v25
 v_mfma_f32_16x16x32_bf16 v[36:39], a[148:151], a[36:39], v[36:39]
 v_mul_f32 v26, s32, v26
 v_mul_f32 v27, s32, v27
 v_mfma_f32_16x16x32_bf16 v[36:39], a[144:147], a[32:35], v[36:39]
 v_exp_f32 v26, v26
 v_mfma_f32_16x16x32_bf16 v[96:99], a[160:163], v[48:51], v[96:99]
 v_exp_f32 v27, v27
 v_mfma_f32_16x16x32_bf16 v[96:99], a[192:195], v[52:55], v[96:99]
 v_mul_f32 v28, s32, v28
 v_mul_f32 v29, s32, v29
 v_mfma_f32_16x16x32_bf16 v[100:103], a[164:167], v[48:51], v[100:103]
 v_cvt_pk_bf16_f32 v40, v24, v25
 v_cvt_pk_bf16_f32 v41, v26, v27
 v_mfma_f32_16x16x32_bf16 v[100:103], a[196:199], v[52:55], v[100:103]
 v_exp_f32 v28, v28
 v_mfma_f32_16x16x32_bf16 v[104:107], a[168:171], v[48:51], v[104:107]
 v_exp_f32 v29, v29
 v_mfma_f32_16x16x32_bf16 v[104:107], a[200:203], v[52:55], v[104:107]
 v_mul_f32 v30, s32, v30
 v_mul_f32 v31, s32, v31
 v_mfma_f32_16x16x32_bf16 v[108:111], a[172:175], v[48:51], v[108:111]
 v_exp_f32 v30, v30
 v_mfma_f32_16x16x32_bf16 v[108:111], a[204:207], v[52:55], v[108:111]
 v_exp_f32 v31, v31
 v_mfma_f32_16x16x32_bf16 v[24:27], a[96:99], a[48:51], 0
 v_cvt_pk_bf16_f32 v42, v28, v29
 v_cvt_pk_bf16_f32 v43, v30, v31
 v_mfma_f32_16x16x32_bf16 v[24:27], a[100:103], a[52:55], v[24:27]
 v_mul_f32 v32, s32, v32
 v_mul_f32 v33, s32, v33
 v_mfma_f32_16x16x32_bf16 v[24:27], a[104:107], a[56:59], v[24:27]
 ds_read_b128 v[60:63], v6 offset:16320
 v_mfma_f32_16x16x32_bf16 v[24:27], a[108:111], a[60:63], v[24:27]
 v_exp_f32 v32, v32
 v_smfmac_f32_16x16x64_bf16 a[224:227], a[240:243], v[48:55], v2
 v_mfma_f32_16x16x32_bf16 v[28:31], a[124:127], a[60:63], 0
 v_exp_f32 v33, v33
 v_mfma_f32_16x16x32_bf16 v[28:31], a[120:123], a[56:59], v[28:31]
 v_mul_f32 v34, s32, v34
 v_mul_f32 v35, s32, v35
 v_mfma_f32_16x16x32_bf16 v[28:31], a[116:119], a[52:55], v[28:31]
 v_exp_f32 v34, v34
 v_mfma_f32_16x16x32_bf16 v[28:31], a[112:115], a[48:51], v[28:31]
 v_exp_f32 v35, v35
 v_mfma_f32_16x16x32_bf16 v[112:115], a[176:179], v[48:51], v[112:115]
 v_mul_f32 v36, s32, v36
 v_mul_f32 v37, s32, v37
 v_mfma_f32_16x16x32_bf16 v[112:115], a[208:211], v[52:55], v[112:115]
 v_cvt_pk_bf16_f32 v44, v32, v33
 v_cvt_pk_bf16_f32 v45, v34, v35
 v_mfma_f32_16x16x32_bf16 v[116:119], a[180:183], v[48:51], v[116:119]
 s_mov_b32 s38, 15360
 v_exp_f32 v36, v36
 v_mfma_f32_16x16x32_bf16 v[116:119], a[212:215], v[52:55], v[116:119]
 s_waitcnt lgkmcnt(0)
 buffer_store_dwordx4 v[60:63], v1, s[24:27], s38 offen sc1 nt
 v_mfma_f32_16x16x32_bf16 v[120:123], a[184:187], v[48:51], v[120:123]
 v_exp_f32 v37, v37
 v_mfma_f32_16x16x32_bf16 v[120:123], a[216:219], v[52:55], v[120:123]
 v_mul_f32 v38, s32, v38
 v_mul_f32 v39, s32, v39
 v_mfma_f32_16x16x32_bf16 v[124:127], a[188:191], v[48:51], v[124:127]
 v_exp_f32 v38, v38
 v_mfma_f32_16x16x32_bf16 v[124:127], a[220:223], v[52:55], v[124:127]
 v_exp_f32 v39, v39
 v_mfma_f32_16x16x32_bf16 v[32:35], a[128:131], a[48:51], 0
 v_cvt_pk_bf16_f32 v46, v36, v37
 v_cvt_pk_bf16_f32 v47, v38, v39
 v_mfma_f32_16x16x32_bf16 v[32:35], a[132:135], a[52:55], v[32:35]
 v_mul_f32 v24, s32, v24
 v_mul_f32 v25, s32, v25
 v_mfma_f32_16x16x32_bf16 v[32:35], a[136:139], a[56:59], v[32:35]
 v_exp_f32 v24, v24
 v_mfma_f32_16x16x32_bf16 v[32:35], a[140:143], a[60:63], v[32:35]
 v_exp_f32 v25, v25
 v_mfma_f32_16x16x32_bf16 v[36:39], a[156:159], a[60:63], 0
 v_mul_f32 v26, s32, v26
 v_mul_f32 v27, s32, v27
 v_mfma_f32_16x16x32_bf16 v[36:39], a[152:155], a[56:59], v[36:39]
 ds_read_b128 v[56:59], v6 offset:0
 v_mfma_f32_16x16x32_bf16 v[36:39], a[148:151], a[52:55], v[36:39]
 v_exp_f32 v26, v26
 v_mfma_f32_16x16x32_bf16 v[36:39], a[144:147], a[48:51], v[36:39]
 v_exp_f32 v27, v27
 v_mfma_f32_16x16x32_bf16 v[128:131], a[160:163], v[40:43], v[128:131]
 v_mul_f32 v28, s32, v28
 v_mul_f32 v29, s32, v29
 v_mfma_f32_16x16x32_bf16 v[128:131], a[192:195], v[44:47], v[128:131]
 v_cvt_pk_bf16_f32 v48, v24, v25
 v_cvt_pk_bf16_f32 v49, v26, v27
 v_mfma_f32_16x16x32_bf16 v[132:135], a[164:167], v[40:43], v[132:135]
 v_exp_f32 v28, v28
 v_mfma_f32_16x16x32_bf16 v[132:135], a[196:199], v[44:47], v[132:135]
 v_exp_f32 v29, v29
 v_mfma_f32_16x16x32_bf16 v[136:139], a[168:171], v[40:43], v[136:139]
 v_mul_f32 v30, s32, v30
 v_mul_f32 v31, s32, v31
 v_mfma_f32_16x16x32_bf16 v[136:139], a[200:203], v[44:47], v[136:139]
 v_exp_f32 v30, v30
 v_mfma_f32_16x16x32_bf16 v[140:143], a[172:175], v[40:43], v[140:143]
 s_mov_b32 s38, 16384
 v_exp_f32 v31, v31
 v_mfma_f32_16x16x32_bf16 v[140:143], a[204:207], v[44:47], v[140:143]
 s_waitcnt lgkmcnt(0)
 buffer_store_dwordx4 v[56:59], v1, s[24:27], s38 offen sc1 nt
 v_mfma_f32_16x16x32_bf16 v[24:27], a[96:99], a[64:67], 0
 v_cvt_pk_bf16_f32 v50, v28, v29
 v_cvt_pk_bf16_f32 v51, v30, v31
 v_mfma_f32_16x16x32_bf16 v[24:27], a[100:103], a[68:71], v[24:27]
 v_mul_f32 v32, s32, v32
 v_mul_f32 v33, s32, v33
 v_mfma_f32_16x16x32_bf16 v[24:27], a[104:107], a[72:75], v[24:27]
 v_exp_f32 v32, v32
 v_mfma_f32_16x16x32_bf16 v[24:27], a[108:111], a[76:79], v[24:27]
 v_exp_f32 v33, v33
 v_smfmac_f32_16x16x64_bf16 a[228:231], a[236:239], v[40:47], v2
 v_mfma_f32_16x16x32_bf16 v[28:31], a[124:127], a[76:79], 0
 v_mul_f32 v34, s32, v34
 v_mul_f32 v35, s32, v35
 v_mfma_f32_16x16x32_bf16 v[28:31], a[120:123], a[72:75], v[28:31]
 v_exp_f32 v34, v34
 v_mfma_f32_16x16x32_bf16 v[28:31], a[116:119], a[68:71], v[28:31]
 v_exp_f32 v35, v35
 v_mfma_f32_16x16x32_bf16 v[28:31], a[112:115], a[64:67], v[28:31]
 v_mul_f32 v36, s32, v36
 v_mul_f32 v37, s32, v37
 v_mfma_f32_16x16x32_bf16 v[144:147], a[176:179], v[40:43], v[144:147]
 v_cvt_pk_bf16_f32 v52, v32, v33
 v_cvt_pk_bf16_f32 v53, v34, v35
 v_mfma_f32_16x16x32_bf16 v[144:147], a[208:211], v[44:47], v[144:147]
 ds_read_b128 v[60:63], v6 offset:1088
 v_exp_f32 v36, v36
 v_mfma_f32_16x16x32_bf16 v[148:151], a[180:183], v[40:43], v[148:151]
 v_exp_f32 v37, v37
 v_mfma_f32_16x16x32_bf16 v[148:151], a[212:215], v[44:47], v[148:151]
 v_mul_f32 v38, s32, v38
 v_mul_f32 v39, s32, v39
 v_mfma_f32_16x16x32_bf16 v[152:155], a[184:187], v[40:43], v[152:155]
 v_exp_f32 v38, v38
 v_mfma_f32_16x16x32_bf16 v[152:155], a[216:219], v[44:47], v[152:155]
 v_exp_f32 v39, v39
 v_mfma_f32_16x16x32_bf16 v[156:159], a[188:191], v[40:43], v[156:159]
 v_cvt_pk_bf16_f32 v54, v36, v37
 v_cvt_pk_bf16_f32 v55, v38, v39
 v_mfma_f32_16x16x32_bf16 v[156:159], a[220:223], v[44:47], v[156:159]
 v_mul_f32 v24, s32, v24
 v_mul_f32 v25, s32, v25
 v_mfma_f32_16x16x32_bf16 v[32:35], a[128:131], a[64:67], 0
 v_exp_f32 v24, v24
 v_mfma_f32_16x16x32_bf16 v[32:35], a[132:135], a[68:71], v[32:35]
 v_exp_f32 v25, v25
 v_mfma_f32_16x16x32_bf16 v[32:35], a[136:139], a[72:75], v[32:35]
 s_mov_b32 s38, 17408
 v_mul_f32 v26, s32, v26
 v_mul_f32 v27, s32, v27
 v_mfma_f32_16x16x32_bf16 v[32:35], a[140:143], a[76:79], v[32:35]
 s_waitcnt lgkmcnt(0)
 buffer_store_dwordx4 v[60:63], v1, s[24:27], s38 offen sc1 nt
 v_mfma_f32_16x16x32_bf16 v[36:39], a[156:159], a[76:79], 0
 v_exp_f32 v26, v26
 v_mfma_f32_16x16x32_bf16 v[36:39], a[152:155], a[72:75], v[36:39]
 v_exp_f32 v27, v27
 v_mfma_f32_16x16x32_bf16 v[36:39], a[148:151], a[68:71], v[36:39]
 v_mul_f32 v28, s32, v28
 v_mul_f32 v29, s32, v29
 v_mfma_f32_16x16x32_bf16 v[36:39], a[144:147], a[64:67], v[36:39]
 v_cvt_pk_bf16_f32 v40, v24, v25
 v_cvt_pk_bf16_f32 v41, v26, v27
 v_mfma_f32_16x16x32_bf16 v[160:163], a[160:163], v[48:51], v[160:163]
 v_exp_f32 v28, v28
 v_mfma_f32_16x16x32_bf16 v[160:163], a[192:195], v[52:55], v[160:163]
 v_exp_f32 v29, v29
 v_mfma_f32_16x16x32_bf16 v[164:167], a[164:167], v[48:51], v[164:167]
 ds_read_b128 v[56:59], v6 offset:2176
 v_mul_f32 v30, s32, v30
 v_mfma_f32_16x16x32_bf16 v[164:167], a[196:199], v[52:55], v[164:167]
 v_mul_f32 v31, s32, v31
 v_exp_f32 v30, v30
 v_mfma_f32_16x16x32_bf16 v[168:171], a[168:171], v[48:51], v[168:171]
 v_exp_f32 v31, v31
 v_mfma_f32_16x16x32_bf16 v[168:171], a[200:203], v[52:55], v[168:171]
 v_cvt_pk_bf16_f32 v42, v28, v29
 v_cvt_pk_bf16_f32 v43, v30, v31
 v_mfma_f32_16x16x32_bf16 v[172:175], a[172:175], v[48:51], v[172:175]
 v_mul_f32 v32, s32, v32
 v_mul_f32 v33, s32, v33
 v_mfma_f32_16x16x32_bf16 v[172:175], a[204:207], v[52:55], v[172:175]
 v_exp_f32 v32, v32
 v_mfma_f32_16x16x32_bf16 v[24:27], a[96:99], a[80:83], 0
 v_exp_f32 v33, v33
 v_mfma_f32_16x16x32_bf16 v[24:27], a[100:103], a[84:87], v[24:27]
 v_mul_f32 v34, s32, v34
 v_mul_f32 v35, s32, v35
 v_mfma_f32_16x16x32_bf16 v[24:27], a[104:107], a[88:91], v[24:27]
 v_exp_f32 v34, v34
 v_mfma_f32_16x16x32_bf16 v[24:27], a[108:111], a[92:95], v[24:27]
 s_mov_b32 s38, 18432
 v_exp_f32 v35, v35
 v_smfmac_f32_16x16x64_bf16 a[228:231], a[240:243], v[48:55], v2
 s_waitcnt lgkmcnt(0)
 buffer_store_dwordx4 v[56:59], v1, s[24:27], s38 offen sc1 nt
 v_mfma_f32_16x16x32_bf16 v[28:31], a[124:127], a[92:95], 0
 v_mul_f32 v36, s32, v36
 v_mul_f32 v37, s32, v37
 v_mfma_f32_16x16x32_bf16 v[28:31], a[120:123], a[88:91], v[28:31]
 v_cvt_pk_bf16_f32 v44, v32, v33
 v_cvt_pk_bf16_f32 v45, v34, v35
 v_mfma_f32_16x16x32_bf16 v[28:31], a[116:119], a[84:87], v[28:31]
 v_exp_f32 v36, v36
 v_mfma_f32_16x16x32_bf16 v[28:31], a[112:115], a[80:83], v[28:31]
 s_waitcnt vmcnt(7)
 s_barrier
 v_mfma_f32_16x16x32_bf16 v[176:179], a[176:179], v[48:51], v[176:179]
 v_exp_f32 v37, v37
 v_mfma_f32_16x16x32_bf16 v[176:179], a[208:211], v[52:55], v[176:179]
 v_mul_f32 v38, s32, v38
 v_mul_f32 v39, s32, v39
 v_mfma_f32_16x16x32_bf16 v[180:183], a[180:183], v[48:51], v[180:183]
 ds_read_b128 a[96:99], v7 offset:33792
 ds_read_b128 a[100:103], v7 offset:33856
 v_mfma_f32_16x16x32_bf16 v[180:183], a[212:215], v[52:55], v[180:183]
 v_exp_f32 v38, v38
 v_mfma_f32_16x16x32_bf16 v[184:187], a[184:187], v[48:51], v[184:187]
 v_exp_f32 v39, v39
 v_mfma_f32_16x16x32_bf16 v[184:187], a[216:219], v[52:55], v[184:187]
 ds_read_b128 v[60:63], v6 offset:3264
 v_cvt_pk_bf16_f32 v46, v36, v37
 v_mfma_f32_16x16x32_bf16 v[188:191], a[188:191], v[48:51], v[188:191]
 ds_read_b128 a[104:107], v7 offset:33920
 ds_read_b128 a[108:111], v7 offset:33984
 v_mfma_f32_16x16x32_bf16 v[188:191], a[220:223], v[52:55], v[188:191]
 v_cvt_pk_bf16_f32 v47, v38, v39
 v_mul_f32 v24, s32, v24
 v_mul_f32 v25, s32, v25
 v_mfma_f32_16x16x32_bf16 v[32:35], a[128:131], a[80:83], 0
L_pg0_12:
 s_cbranch_execz L_main0
 v_exp_f32 v24, v24
 v_mfma_f32_16x16x32_bf16 v[32:35], a[132:135], a[84:87], v[32:35]
 v_exp_f32 v25, v25
 v_mfma_f32_16x16x32_bf16 v[32:35], a[136:139], a[88:91], v[32:35]
 ds_read_b128 a[124:127], v7 offset:34496
 ds_read_b128 a[120:123], v7 offset:34432
 v_mfma_f32_16x16x32_bf16 v[32:35], a[140:143], a[92:95], v[32:35]
 v_mul_f32 v26, s32, v26
 v_mul_f32 v27, s32, v27
 v_mfma_f32_16x16x32_bf16 v[36:39], a[156:159], a[92:95], 0
 v_exp_f32 v26, v26
 v_mfma_f32_16x16x32_bf16 v[36:39], a[152:155], a[88:91], v[36:39]
 v_exp_f32 v27, v27
 v_mfma_f32_16x16x32_bf16 v[36:39], a[148:151], a[84:87], v[36:39]
 s_mov_b32 s38, 19456
 ds_read_b128 a[116:119], v7 offset:34368
 ds_read_b128 a[112:115], v7 offset:34304
 v_mfma_f32_16x16x32_bf16 v[36:39], a[144:147], a[80:83], v[36:39]
 s_waitcnt lgkmcnt(6)
 buffer_store_dwordx4 v[60:63], v1, s[24:27], s38 offen sc1 nt
 v_mfma_f32_16x16x32_bf16 v[192:195], a[160:163], v[40:43], v[192:195]
 v_mul_f32 v28, s32, v28
 v_mul_f32 v29, s32, v29
 v_mfma_f32_16x16x32_bf16 v[192:195], a[192:195], v[44:47], v[192:195]
 v_cvt_pk_bf16_f32 v48, v24, v25
 v_cvt_pk_bf16_f32 v49, v26, v27
 v_mfma_f32_16x16x32_bf16 v[196:199], a[164:167], v[40:43], v[196:199]
 v_exp_f32 v28, v28
 v_mfma_f32_16x16x32_bf16 v[196:199], a[196:199], v[44:47], v[196:199]
 ds_read_b128 a[128:131], v7 offset:50688
 ds_read_b128 a[132:135], v7 offset:50752
 v_mfma_f32_16x16x32_bf16 v[200:203], a[168:171], v[40:43], v[200:203]
 v_exp_f32 v29, v29
 v_mfma_f32_16x16x32_bf16 v[200:203], a[200:203], v[44:47], v[200:203]
 v_mul_f32 v30, s32, v30
 v_mul_f32 v31, s32, v31
 v_mfma_f32_16x16x32_bf16 v[204:207], a[172:175], v[40:43], v[204:207]
 v_exp_f32 v30, v30
 v_mfma_f32_16x16x32_bf16 v[204:207], a[204:207], v[44:47], v[204:207]
 s_waitcnt lgkmcnt(6)
 ds_read_b128 a[136:139], v7 offset:50816
 ds_read_b128 a[140:143], v7 offset:50880
 v_mfma_f32_16x16x32_bf16 v[24:27], a[96:99], a[0:3], 0
 v_exp_f32 v31, v31
 v_mfma_f32_16x16x32_bf16 v[24:27], a[100:103], a[4:7], v[24:27]
 v_cvt_pk_bf16_f32 v50, v28, v29
 v_cvt_pk_bf16_f32 v51, v30, v31
 v_mfma_f32_16x16x32_bf16 v[24:27], a[104:107], a[8:11], v[24:27]
 ds_read_b128 v[56:59], v6 offset:19584
 v_mul_f32 v32, s32, v32
 v_mfma_f32_16x16x32_bf16 v[24:27], a[108:111], a[12:15], v[24:27]
 s_waitcnt lgkmcnt(5)
 ds_read_b128 a[156:159], v7 offset:51392
 ds_read_b128 a[152:155], v7 offset:51328
 v_mul_f32 v33, s32, v33
 v_smfmac_f32_16x16x64_bf16 a[232:235], a[236:239], v[40:47], v2
 v_exp_f32 v32, v32
 v_mfma_f32_16x16x32_bf16 v[28:31], a[124:127], a[12:15], 0
 v_exp_f32 v33, v33
 v_mfma_f32_16x16x32_bf16 v[28:31], a[120:123], a[8:11], v[28:31]
 v_mul_f32 v34, s32, v34
 v_mul_f32 v35, s32, v35
 v_mfma_f32_16x16x32_bf16 v[28:31], a[116:119], a[4:7], v[28:31]
 ds_read_b128 a[148:151], v7 offset:51264
 ds_read_b128 a[144:147], v7 offset:51200
 v_mfma_f32_16x16x32_bf16 v[28:31], a[112:115], a[0:3], v[28:31]
 v_exp_f32 v34, v34
 v_mfma_f32_16x16x32_bf16 v[208:211], a[176:179], v[40:43], v[208:211]
 v_exp_f32 v35, v35
 v_mfma_f32_16x16x32_bf16 v[208:211], a[208:211], v[44:47], v[208:211]
 v_mul_f32 v36, s32, v36
 v_mul_f32 v37, s32, v37
 v_mfma_f32_16x16x32_bf16 v[212:215], a[180:183], v[40:43], v[212:215]
 s_mov_b32 s38, 20480
 v_cvt_pk_bf16_f32 v52, v32, v33
 v_cvt_pk_bf16_f32 v53, v34, v35
 v_mfma_f32_16x16x32_bf16 v[212:215], a[212:215], v[44:47], v[212:215]
 s_waitcnt lgkmcnt(4)
 buffer_store_dwordx4 v[56:59], v1, s[24:27], s38 offen sc1 nt
 v_mfma_f32_16x16x32_bf16 v[216:219], a[184:187], v[40:43], v[216:219]
 v_exp_f32 v36, v36
 v_mfma_f32_16x16x32_bf16 v[216:219], a[216:219], v[44:47], v[216:219]
 v_exp_f32 v37, v37
 v_mfma_f32_16x16x32_bf16 v[220:223], a[188:191], v[40:43], v[220:223]
 v_mul_f32 v38, s32, v38
 v_mul_f32 v39, s32, v39
 v_mfma_f32_16x16x32_bf16 v[220:223], a[220:223], v[44:47], v[220:223]
 s_waitcnt lgkmcnt(5)
 v_exp_f32 v38, v38
 v_mfma_f32_16x16x32_bf16 v[32:35], a[128:131], a[0:3], 0
 v_exp_f32 v39, v39
 v_mfma_f32_16x16x32_bf16 v[32:35], a[132:135], a[4:7], v[32:35]
 v_cvt_pk_bf16_f32 v54, v36, v37
 v_cvt_pk_bf16_f32 v55, v38, v39
 v_mfma_f32_16x16x32_bf16 v[32:35], a[136:139], a[8:11], v[32:35]
 v_mul_f32 v24, s32, v24
 v_mul_f32 v25, s32, v25
 v_mfma_f32_16x16x32_bf16 v[32:35], a[140:143], a[12:15], v[32:35]
 s_waitcnt lgkmcnt(0)
 ds_read_b128 v[60:63], v6 offset:20672
 v_exp_f32 v24, v24
 v_mfma_f32_16x16x32_bf16 v[36:39], a[156:159], a[12:15], 0
 v_exp_f32 v25, v25
 v_mfma_f32_16x16x32_bf16 v[36:39], a[152:155], a[8:11], v[36:39]
 v_mul_f32 v26, s32, v26
 v_mul_f32 v27, s32, v27
 v_mfma_f32_16x16x32_bf16 v[36:39], a[148:151], a[4:7], v[36:39]
 v_exp_f32 v26, v26
 v_mfma_f32_16x16x32_bf16 v[36:39], a[144:147], a[0:3], v[36:39]
 v_exp_f32 v27, v27
 v_mul_f32 v28, s32, v28
 v_mfma_f32_16x16x32_bf16 v[224:227], a[160:163], v[48:51], v[224:227]
 v_mul_f32 v29, s32, v29
 v_cvt_pk_bf16_f32 v40, v24, v25
 v_mfma_f32_16x16x32_bf16 v[224:227], a[192:195], v[52:55], v[224:227]
 v_cvt_pk_bf16_f32 v41, v26, v27
 v_exp_f32 v28, v28
 v_mfma_f32_16x16x32_bf16 v[228:231], a[164:167], v[48:51], v[228:231]
 ds_read_b64_tr_b16 a[160:161], v8 offset:33792
 ds_read_b64_tr_b16 a[162:163], v8 offset:34304
 v_mfma_f32_16x16x32_bf16 v[228:231], a[196:199], v[52:55], v[228:231]
 v_exp_f32 v29, v29
 v_mul_f32 v30, s32, v30
 v_mul_f32 v31, s32, v31
 v_mfma_f32_16x16x32_bf16 v[232:235], a[168:171], v[48:51], v[232:235]
 s_mov_b32 s38, 21504
 ds_read_b64_tr_b16 a[192:193], v8 offset:50688
 ds_read_b64_tr_b16 a[194:195], v8 offset:51200
 v_mfma_f32_16x16x32_bf16 v[232:235], a[200:203], v[52:55], v[232:235]
 s_waitcnt lgkmcnt(4)
 buffer_store_dwordx4 v[60:63], v1, s[24:27], s38 offen sc1 nt
 v_mfma_f32_16x16x32_bf16 v[236:239], a[172:175], v[48:51], v[236:239]
 v_exp_f32 v30, v30
 v_mfma_f32_16x16x32_bf16 v[236:239], a[204:207], v[52:55], v[236:239]
 ds_read_b64_tr_b16 a[164:165], v8 offset:33824
 ds_read_b64_tr_b16 a[166:167], v8 offset:34336
 v_exp_f32 v31, v31
 v_mfma_f32_16x16x32_bf16 v[24:27], a[96:99], a[16:19], 0
 v_cvt_pk_bf16_f32 v42, v28, v29
 v_cvt_pk_bf16_f32 v43, v30, v31
 v_mfma_f32_16x16x32_bf16 v[24:27], a[100:103], a[20:23], v[24:27]
 ds_read_b64_tr_b16 a[196:197], v8 offset:50720
 ds_read_b64_tr_b16 a[198:199], v8 offset:51232
 v_mfma_f32_16x16x32_bf16 v[24:27], a[104:107], a[24:27], v[24:27]
 v_mul_f32 v32, s32, v32
 v_mul_f32 v33, s32, v33
 v_mfma_f32_16x16x32_bf16 v[24:27], a[108:111], a[28:31], v[24:27]
 ds_read_b64_tr_b16 a[168:169], v8 offset:33856
 ds_read_b64_tr_b16 a[170:171], v8 offset:34368
 v_exp_f32 v32, v32
 v_smfmac_f32_16x16x64_bf16 a[232:235], a[240:243], v[48:55], v2
 v_exp_f32 v33, v33
 v_mul_f32 v34, s32, v34
 v_mfma_f32_16x16x32_bf16 v[28:31], a[124:127], a[28:31], 0
 ds_read_b64_tr_b16 a[200:201], v8 offset:50752
 ds_read_b64_tr_b16 a[202:203], v8 offset:51264
 v_mfma_f32_16x16x32_bf16 v[28:31], a[120:123], a[24:27], v[28:31]
 ds_read_b128 v[56:59], v6 offset:21760
 v_mul_f32 v35, s32, v35
 v_mfma_f32_16x16x32_bf16 v[28:31], a[116:119], a[20:23], v[28:31]
 v_exp_f32 v34, v34
 v_mfma_f32_16x16x32_bf16 v[28:31], a[112:115], a[16:19], v[28:31]
 ds_read_b64_tr_b16 a[172:173], v8 offset:33888
 ds_read_b64_tr_b16 a[174:175], v8 offset:34400
 v_exp_f32 v35, v35
 v_mfma_f32_16x16x32_bf16 v[240:243], a[176:179], v[48:51], v[240:243]
 v_mul_f32 v36, s32, v36
 v_mul_f32 v37, s32, v37
 v_mfma_f32_16x16x32_bf16 v[240:243], a[208:211], v[52:55], v[240:243]
 ds_read_b64_tr_b16 a[204:205], v8 offset:50784
 ds_read_b64_tr_b16 a[206:207], v8 offset:51296
 v_cvt_pk_bf16_f32 v44, v32, v33
 v_cvt_pk_bf16_f32 v45, v34, v35
 v_mfma_f32_16x16x32_bf16 v[244:247], a[180:183], v[48:51], v[244:247]
 v_exp_f32 v36, v36
 v_mfma_f32_16x16x32_bf16 v[244:247], a[212:215], v[52:55], v[244:247]
 v_exp_f32 v37, v37
 v_mfma_f32_16x16x32_bf16 v[248:251], a[184:187], v[48:51], v[248:251]
 v_mul_f32 v38, s32, v38
 v_mul_f32 v39, s32, v39
 v_mfma_f32_16x16x32_bf16 v[248:251], a[216:219], v[52:55], v[248:251]
 ds_read_b64_tr_b16 a[176:177], v8 offset:33920
 ds_read_b64_tr_b16 a[178:179], v8 offset:34432
 v_exp_f32 v38, v38
 v_mfma_f32_16x16x32_bf16 v[252:255], a[188:191], v[48:51], v[252:255]
 s_mov_b32 s38, 22528
 v_exp_f32 v39, v39
 v_mfma_f32_16x16x32_bf16 v[252:255], a[220:223], v[52:55], v[252:255]
 s_waitcnt lgkmcnt(6)
 buffer_store_dwordx4 v[56:59], v1, s[24:27], s38 offen sc1 nt
 v_mfma_f32_16x16x32_bf16 v[32:35], a[128:131], a[16:19], 0
 ds_read_b64_tr_b16 a[208:209], v8 offset:50816
 ds_read_b64_tr_b16 a[210:211], v8 offset:51328
 v_mfma_f32_16x16x32_bf16 v[32:35], a[132:135], a[20:23], v[32:35]
 v_cvt_pk_bf16_f32 v46, v36, v37
 v_cvt_pk_bf16_f32 v47, v38, v39
 v_mfma_f32_16x16x32_bf16 v[32:35], a[136:139], a[24:27], v[32:35]
 v_mul_f32 v24, s32, v24
 v_mul_f32 v25, s32, v25
 v_mfma_f32_16x16x32_bf16 v[32:35], a[140:143], a[28:31], v[32:35]
 ds_read_b64_tr_b16 a[180:181], v8 offset:33952
 ds_read_b64_tr_b16 a[182:183], v8 offset:34464
 v_exp_f32 v24, v24
 v_mfma_f32_16x16x32_bf16 v[36:39], a[156:159], a[28:31], 0
 v_exp_f32 v25, v25
 v_mfma_f32_16x16x32_bf16 v[36:39], a[152:155], a[24:27], v[36:39]
 v_mul_f32 v26, s32, v26
 v_mul_f32 v27, s32, v27
 v_mfma_f32_16x16x32_bf16 v[36:39], a[148:151], a[20:23], v[36:39]
 ds_read_b64_tr_b16 a[212:213], v8 offset:50848
 ds_read_b64_tr_b16 a[214:215], v8 offset:51360
 v_mfma_f32_16x16x32_bf16 v[36:39], a[144:147], a[16:19], v[36:39]
 s_waitcnt lgkmcnt(15)
 v_exp_f32 v26, v26
 v_exp_f32 v27, v27
 v_mfma_f32_16x16x32_bf16 v[64:67], a[160:163], v[40:43], v[64:67]
 v_mul_f32 v28, s32, v28
 v_mul_f32 v29, s32, v29
 v_mfma_f32_16x16x32_bf16 v[64:67], a[192:195], v[44:47], v[64:67]
 ds_read_b64_tr_b16 a[184:185], v8 offset:33984
 ds_read_b64_tr_b16 a[186:187], v8 offset:34496
 v_cvt_pk_bf16_f32 v48, v24, v25
 v_mfma_f32_16x16x32_bf16 v[68:71], a[164:167], v[40:43], v[68:71]
 ds_read_b128 v[60:63], v6 offset:22848
 v_cvt_pk_bf16_f32 v49, v26, v27
 v_mfma_f32_16x16x32_bf16 v[68:71], a[196:199], v[44:47], v[68:71]
 s_waitcnt lgkmcnt(11)
 v_exp_f32 v28, v28
 v_exp_f32 v29, v29
 v_mfma_f32_16x16x32_bf16 v[72:75], a[168:171], v[40:43], v[72:75]
 ds_read_b64_tr_b16 a[216:217], v8 offset:50880
 ds_read_b64_tr_b16 a[218:219], v8 offset:51392
 v_mfma_f32_16x16x32_bf16 v[72:75], a[200:203], v[44:47], v[72:75]
 v_mul_f32 v30, s32, v30
 v_mul_f32 v31, s32, v31
 v_mfma_f32_16x16x32_bf16 v[76:79], a[172:175], v[40:43], v[76:79]
 v_exp_f32 v30, v30
 v_mfma_f32_16x16x32_bf16 v[76:79], a[204:207], v[44:47], v[76:79]
 ds_read_b64_tr_b16 a[188:189], v8 offset:34016
 ds_read_b64_tr_b16 a[190:191], v8 offset:34528
 v_mfma_f32_16x16x32_bf16 v[24:27], a[96:99], a[32:35], 0
 v_exp_f32 v31, v31
 v_mfma_f32_16x16x32_bf16 v[24:27], a[100:103], a[36:39], v[24:27]
 v_cvt_pk_bf16_f32 v50, v28, v29
 v_cvt_pk_bf16_f32 v51, v30, v31
 v_mfma_f32_16x16x32_bf16 v[24:27], a[104:107], a[40:43], v[24:27]
 s_mov_b32 s38, 23552
 ds_read_b64_tr_b16 a[220:221], v8 offset:50912
 ds_read_b64_tr_b16 a[222:223], v8 offset:51424
 v_mfma_f32_16x16x32_bf16 v[24:27], a[108:111], a[44:47], v[24:27]
 s_waitcnt lgkmcnt(6)
 buffer_store_dwordx4 v[60:63], v1, s[24:27], s38 offen sc1 nt
 v_smfmac_f32_16x16x64_bf16 a[224:227], a[236:239], v[40:47], v2
 v_mul_f32 v32, s32, v32
 v_mul_f32 v33, s32, v33
 v_mfma_f32_16x16x32_bf16 v[28:31], a[124:127], a[44:47], 0
 v_exp_f32 v32, v32
 v_mfma_f32_16x16x32_bf16 v[28:31], a[120:123], a[40:43], v[28:31]
 v_exp_f32 v33, v33
 v_mfma_f32_16x16x32_bf16 v[28:31], a[116:119], a[36:39], v[28:31]
 v_mul_f32 v34, s32, v34
 v_mul_f32 v35, s32, v35
 v_mfma_f32_16x16x32_bf16 v[28:31], a[112:115], a[32:35], v[28:31]
 s_waitcnt lgkmcnt(9)
 v_exp_f32 v34, v34
 v_mfma_f32_16x16x32_bf16 v[80:83], a[176:179], v[40:43], v[80:83]
 v_exp_f32 v35, v35
 v_mfma_f32_16x16x32_bf16 v[80:83], a[208:211], v[44:47], v[80:83]
 v_mul_f32 v36, s32, v36
 v_mul_f32 v37, s32, v37
 v_mfma_f32_16x16x32_bf16 v[84:87], a[180:183], v[40:43], v[84:87]
 v_cvt_pk_bf16_f32 v52, v32, v33
 v_cvt_pk_bf16_f32 v53, v34, v35
 v_mfma_f32_16x16x32_bf16 v[84:87], a[212:215], v[44:47], v[84:87]
 s_waitcnt lgkmcnt(0)
 v_exp_f32 v36, v36
 v_mfma_f32_16x16x32_bf16 v[88:91], a[184:187], v[40:43], v[88:91]
 v_exp_f32 v37, v37
 v_mfma_f32_16x16x32_bf16 v[88:91], a[216:219], v[44:47], v[88:91]
 v_mul_f32 v38, s32, v38
 v_mul_f32 v39, s32, v39
 v_mfma_f32_16x16x32_bf16 v[92:95], a[188:191], v[40:43], v[92:95]
 s_mul_i32 s38, s57, 98304
 v_exp_f32 v38, v38
 v_mfma_f32_16x16x32_bf16 v[92:95], a[220:223], v[44:47], v[92:95]
 s_mul_i32 s59, s3, 24576
 v_exp_f32 v39, v39
 v_mfma_f32_16x16x32_bf16 v[32:35], a[128:131], a[32:35], 0
 s_add_u32 s38, s38, s59
 v_cvt_pk_bf16_f32 v54, v36, v37
 v_cvt_pk_bf16_f32 v55, v38, v39
 v_mfma_f32_16x16x32_bf16 v[32:35], a[132:135], a[36:39], v[32:35]
 s_add_u32 s24, s10, s38
 s_addc_u32 s25, s11, 0
 v_mfma_f32_16x16x32_bf16 v[32:35], a[136:139], a[40:43], v[32:35]
 v_mul_f32 v24, s32, v24
 v_mul_f32 v25, s32, v25
 v_mfma_f32_16x16x32_bf16 v[32:35], a[140:143], a[44:47], v[32:35]
 v_accvgpr_read_b32 v11, a224
 v_accvgpr_read_b32 v10, a225
 v_add_f32 v11, v11, v10
 v_rcp_f32 v10, v11
 v_cmp_nle_f32 vcc, s60, v11
 v_pk_mul_f32 v[64:65], v[64:65], v[10:11] op_sel_hi:[1,0]
 v_pk_mul_f32 v[66:67], v[66:67], v[10:11] op_sel_hi:[1,0]
 v_pk_mul_f32 v[68:69], v[68:69], v[10:11] op_sel_hi:[1,0]
 v_pk_mul_f32 v[70:71], v[70:71], v[10:11] op_sel_hi:[1,0]
 v_pk_mul_f32 v[72:73], v[72:73], v[10:11] op_sel_hi:[1,0]
 v_pk_mul_f32 v[74:75], v[74:75], v[10:11] op_sel_hi:[1,0]
 v_pk_mul_f32 v[76:77], v[76:77], v[10:11] op_sel_hi:[1,0]
 v_pk_mul_f32 v[78:79], v[78:79], v[10:11] op_sel_hi:[1,0]
 v_pk_mul_f32 v[80:81], v[80:81], v[10:11] op_sel_hi:[1,0]
 v_pk_mul_f32 v[82:83], v[82:83], v[10:11] op_sel_hi:[1,0]
 v_pk_mul_f32 v[84:85], v[84:85], v[10:11] op_sel_hi:[1,0]
 v_pk_mul_f32 v[86:87], v[86:87], v[10:11] op_sel_hi:[1,0]
 v_pk_mul_f32 v[88:89], v[88:89], v[10:11] op_sel_hi:[1,0]
 v_pk_mul_f32 v[90:91], v[90:91], v[10:11] op_sel_hi:[1,0]
 v_pk_mul_f32 v[92:93], v[92:93], v[10:11] op_sel_hi:[1,0]
 v_pk_mul_f32 v[94:95], v[94:95], v[10:11] op_sel_hi:[1,0]
 v_mfma_f32_16x16x32_bf16 v[36:39], a[156:159], a[44:47], 0
 s_or_b64 s[50:51], s[50:51], vcc
 v_exp_f32 v24, v24
 v_mfma_f32_16x16x32_bf16 v[36:39], a[152:155], a[40:43], v[36:39]
 v_exp_f32 v25, v25
 v_mfma_f32_16x16x32_bf16 v[36:39], a[148:151], a[36:39], v[36:39]
 v_mul_f32 v26, s32, v26
 v_mul_f32 v27, s32, v27
 v_mfma_f32_16x16x32_bf16 v[36:39], a[144:147], a[32:35], v[36:39]
 v_exp_f32 v26, v26
 v_cmp_nge_f32 vcc, s61, v11
 v_add_u32 v12, 4352, v5
 v_cvt_pk_bf16_f32 v64, v64, v65
 v_cvt_pk_bf16_f32 v65, v66, v67
 v_cvt_pk_bf16_f32 v68, v68, v69
 v_cvt_pk_bf16_f32 v69, v70, v71
 v_mfma_f32_16x16x32_bf16 v[96:99], a[160:163], v[48:51], v[96:99]
 v_exp_f32 v27, v27
 v_mfma_f32_16x16x32_bf16 v[96:99], a[192:195], v[52:55], v[96:99]
 s_or_b64 s[50:51], s[50:51], vcc
 ds_write2_b64 v12, v[64:65], v[68:69] offset0:0 offset1:4
 v_mul_f32 v28, s32, v28
 v_mul_f32 v29, s32, v29
 v_cvt_pk_bf16_f32 v72, v72, v73
 v_cvt_pk_bf16_f32 v73, v74, v75
 v_cvt_pk_bf16_f32 v76, v76, v77
 v_cvt_pk_bf16_f32 v77, v78, v79
 v_mfma_f32_16x16x32_bf16 v[100:103], a[164:167], v[48:51], v[100:103]
 v_cvt_pk_bf16_f32 v40, v24, v25
 v_cvt_pk_bf16_f32 v41, v26, v27
 v_mfma_f32_16x16x32_bf16 v[100:103], a[196:199], v[52:55], v[100:103]
 ds_write2_b64 v12, v[72:73], v[76:77] offset0:8 offset1:12
 v_exp_f32 v28, v28
 v_cvt_pk_bf16_f32 v80, v80, v81
 v_cvt_pk_bf16_f32 v81, v82, v83
 v_cvt_pk_bf16_f32 v84, v84, v85
 v_cvt_pk_bf16_f32 v85, v86, v87
 v_mfma_f32_16x16x32_bf16 v[104:107], a[168:171], v[48:51], v[104:107]
 v_exp_f32 v29, v29
 v_mfma_f32_16x16x32_bf16 v[104:107], a[200:203], v[52:55], v[104:107]
 ds_write2_b64 v12, v[80:81], v[84:85] offset0:16 offset1:20
 v_mul_f32 v30, s32, v30
 v_mul_f32 v31, s32, v31
 v_cvt_pk_bf16_f32 v88, v88, v89
 v_cvt_pk_bf16_f32 v89, v90, v91
 v_cvt_pk_bf16_f32 v92, v92, v93
 v_cvt_pk_bf16_f32 v93, v94, v95
 v_mfma_f32_16x16x32_bf16 v[108:111], a[172:175], v[48:51], v[108:111]
 v_exp_f32 v30, v30
 v_mfma_f32_16x16x32_bf16 v[108:111], a[204:207], v[52:55], v[108:111]
 ds_write2_b64 v12, v[88:89], v[92:93] offset0:24 offset1:28
 ds_read_b128 v[64:67], v6 offset:4352
 ds_read_b128 v[68:71], v6 offset:5440
 ds_read_b128 v[72:75], v6 offset:6528
 ds_read_b128 v[76:79], v6 offset:7616
 v_exp_f32 v31, v31
 v_mfma_f32_16x16x32_bf16 v[24:27], a[96:99], a[48:51], 0
 v_cvt_pk_bf16_f32 v42, v28, v29
 v_cvt_pk_bf16_f32 v43, v30, v31
 v_mfma_f32_16x16x32_bf16 v[24:27], a[100:103], a[52:55], v[24:27]
 v_mul_f32 v32, s32, v32
 v_mul_f32 v33, s32, v33
 v_mfma_f32_16x16x32_bf16 v[24:27], a[104:107], a[56:59], v[24:27]
 v_exp_f32 v32, v32
 v_mfma_f32_16x16x32_bf16 v[24:27], a[108:111], a[60:63], v[24:27]
 v_exp_f32 v33, v33
 v_smfmac_f32_16x16x64_bf16 a[224:227], a[240:243], v[48:55], v2
 v_mfma_f32_16x16x32_bf16 v[28:31], a[124:127], a[60:63], 0
 v_mul_f32 v34, s32, v34
 v_mul_f32 v35, s32, v35
 v_mfma_f32_16x16x32_bf16 v[28:31], a[120:123], a[56:59], v[28:31]
 v_exp_f32 v34, v34
 v_mfma_f32_16x16x32_bf16 v[28:31], a[116:119], a[52:55], v[28:31]
 s_mov_b32 s59, 0
 v_exp_f32 v35, v35
 v_mfma_f32_16x16x32_bf16 v[28:31], a[112:115], a[48:51], v[28:31]
 s_waitcnt lgkmcnt(3)
 v_mul_f32 v36, s32, v36
 v_mul_f32 v37, s32, v37
 v_mfma_f32_16x16x32_bf16 v[112:115], a[176:179], v[48:51], v[112:115]
 v_cvt_pk_bf16_f32 v44, v32, v33
 v_cvt_pk_bf16_f32 v45, v34, v35
 v_mfma_f32_16x16x32_bf16 v[112:115], a[208:211], v[52:55], v[112:115]
 buffer_store_dwordx4 v[64:67], v1, s[24:27], s59 offen sc1 nt
 v_exp_f32 v36, v36
 v_mfma_f32_16x16x32_bf16 v[116:119], a[180:183], v[48:51], v[116:119]
 v_exp_f32 v37, v37
 v_mfma_f32_16x16x32_bf16 v[116:119], a[212:215], v[52:55], v[116:119]
 s_waitcnt lgkmcnt(2)
 buffer_store_dwordx4 v[68:71], v1, s[24:27], s59 offen offset:1024 sc1 nt
 v_mul_f32 v38, s32, v38
 v_mul_f32 v39, s32, v39
 v_mfma_f32_16x16x32_bf16 v[120:123], a[184:187], v[48:51], v[120:123]
 v_exp_f32 v38, v38
 v_mfma_f32_16x16x32_bf16 v[120:123], a[216:219], v[52:55], v[120:123]
 s_waitcnt lgkmcnt(1)
 v_exp_f32 v39, v39
 v_mfma_f32_16x16x32_bf16 v[124:127], a[188:191], v[48:51], v[124:127]
 buffer_store_dwordx4 v[72:75], v1, s[24:27], s59 offen offset:2048 sc1 nt
 v_mfma_f32_16x16x32_bf16 v[124:127], a[220:223], v[52:55], v[124:127]
 s_waitcnt lgkmcnt(0)
 buffer_store_dwordx4 v[76:79], v1, s[24:27], s59 offen offset:3072 sc1 nt
 v_cvt_pk_bf16_f32 v46, v36, v37
 v_cvt_pk_bf16_f32 v47, v38, v39
 v_mfma_f32_16x16x32_bf16 v[32:35], a[128:131], a[48:51], 0
 v_mul_f32 v24, s32, v24
 v_mul_f32 v25, s32, v25
 v_mfma_f32_16x16x32_bf16 v[32:35], a[132:135], a[52:55], v[32:35]
 v_exp_f32 v24, v24
 v_mfma_f32_16x16x32_bf16 v[32:35], a[136:139], a[56:59], v[32:35]
 v_exp_f32 v25, v25
 v_mfma_f32_16x16x32_bf16 v[32:35], a[140:143], a[60:63], v[32:35]
 v_accvgpr_read_b32 v11, a226
 v_accvgpr_read_b32 v10, a227
 v_add_f32 v11, v11, v10
 v_rcp_f32 v10, v11
 v_cmp_nle_f32 vcc, s60, v11
 v_pk_mul_f32 v[96:97], v[96:97], v[10:11] op_sel_hi:[1,0]
 v_pk_mul_f32 v[98:99], v[98:99], v[10:11] op_sel_hi:[1,0]
 v_pk_mul_f32 v[100:101], v[100:101], v[10:11] op_sel_hi:[1,0]
 v_pk_mul_f32 v[102:103], v[102:103], v[10:11] op_sel_hi:[1,0]
 v_pk_mul_f32 v[104:105], v[104:105], v[10:11] op_sel_hi:[1,0]
 v_pk_mul_f32 v[106:107], v[106:107], v[10:11] op_sel_hi:[1,0]
 v_pk_mul_f32 v[108:109], v[108:109], v[10:11] op_sel_hi:[1,0]
 v_pk_mul_f32 v[110:111], v[110:111], v[10:11] op_sel_hi:[1,0]
 v_pk_mul_f32 v[112:113], v[112:113], v[10:11] op_sel_hi:[1,0]
 v_pk_mul_f32 v[114:115], v[114:115], v[10:11] op_sel_hi:[1,0]
 v_pk_mul_f32 v[116:117], v[116:117], v[10:11] op_sel_hi:[1,0]
 v_pk_mul_f32 v[118:119], v[118:119], v[10:11] op_sel_hi:[1,0]
 v_pk_mul_f32 v[120:121], v[120:121], v[10:11] op_sel_hi:[1,0]
 v_pk_mul_f32 v[122:123], v[122:123], v[10:11] op_sel_hi:[1,0]
 v_pk_mul_f32 v[124:125], v[124:125], v[10:11] op_sel_hi:[1,0]
 v_pk_mul_f32 v[126:127], v[126:127], v[10:11] op_sel_hi:[1,0]
 v_mfma_f32_16x16x32_bf16 v[36:39], a[156:159], a[60:63], 0
 s_or_b64 s[50:51], s[50:51], vcc
 v_mul_f32 v26, s32, v26
 v_mul_f32 v27, s32, v27
 v_mfma_f32_16x16x32_bf16 v[36:39], a[152:155], a[56:59], v[36:39]
 v_exp_f32 v26, v26
 v_mfma_f32_16x16x32_bf16 v[36:39], a[148:151], a[52:55], v[36:39]
 v_exp_f32 v27, v27
 v_mfma_f32_16x16x32_bf16 v[36:39], a[144:147], a[48:51], v[36:39]
 v_mul_f32 v28, s32, v28
 v_mul_f32 v29, s32, v29
 v_cmp_nge_f32 vcc, s61, v11
 v_add_u32 v12, 8704, v5
 v_cvt_pk_bf16_f32 v96, v96, v97
 v_cvt_pk_bf16_f32 v97, v98, v99
 v_cvt_pk_bf16_f32 v100, v100, v101
 v_cvt_pk_bf16_f32 v101, v102, v103
 v_mfma_f32_16x16x32_bf16 v[128:131], a[160:163], v[40:43], v[128:131]
 v_cvt_pk_bf16_f32 v48, v24, v25
 v_cvt_pk_bf16_f32 v49, v26, v27
 v_mfma_f32_16x16x32_bf16 v[128:131], a[192:195], v[44:47], v[128:131]
 s_or_b64 s[50:51], s[50:51], vcc
 ds_write2_b64 v12, v[96:97], v[100:101] offset0:0 offset1:4
 v_exp_f32 v28, v28
 v_cvt_pk_bf16_f32 v104, v104, v105
 v_cvt_pk_bf16_f32 v105, v106, v107
 v_cvt_pk_bf16_f32 v108, v108, v109
 v_cvt_pk_bf16_f32 v109, v110, v111
 v_mfma_f32_16x16x32_bf16 v[132:135], a[164:167], v[40:43], v[132:135]
 v_exp_f32 v29, v29
 v_mfma_f32_16x16x32_bf16 v[132:135], a[196:199], v[44:47], v[132:135]
 ds_write2_b64 v12, v[104:105], v[108:109] offset0:8 offset1:12
 v_cvt_pk_bf16_f32 v112, v112, v113
 v_cvt_pk_bf16_f32 v113, v114, v115
 v_cvt_pk_bf16_f32 v116, v116, v117
 v_cvt_pk_bf16_f32 v117, v118, v119
 v_mfma_f32_16x16x32_bf16 v[136:139], a[168:171], v[40:43], v[136:139]
 v_mul_f32 v30, s32, v30
 v_mul_f32 v31, s32, v31
 v_mfma_f32_16x16x32_bf16 v[136:139], a[200:203], v[44:47], v[136:139]
 ds_write2_b64 v12, v[112:113], v[116:117] offset0:16 offset1:20
 v_exp_f32 v30, v30
 v_cvt_pk_bf16_f32 v120, v120, v121
 v_cvt_pk_bf16_f32 v121, v122, v123
 v_cvt_pk_bf16_f32 v124, v124, v125
 v_cvt_pk_bf16_f32 v125, v126, v127
 v_mfma_f32_16x16x32_bf16 v[140:143], a[172:175], v[40:43], v[140:143]
 v_exp_f32 v31, v31
 v_mfma_f32_16x16x32_bf16 v[140:143], a[204:207], v[44:47], v[140:143]
 ds_write2_b64 v12, v[120:121], v[124:125] offset0:24 offset1:28
 ds_read_b128 v[96:99], v6 offset:8704
 ds_read_b128 v[100:103], v6 offset:9792
 ds_read_b128 v[104:107], v6 offset:10880
 ds_read_b128 v[108:111], v6 offset:11968
 v_cvt_pk_bf16_f32 v50, v28, v29
 v_cvt_pk_bf16_f32 v51, v30, v31
 v_mfma_f32_16x16x32_bf16 v[24:27], a[96:99], a[64:67], 0
 v_mul_f32 v32, s32, v32
 v_mul_f32 v33, s32, v33
 v_mfma_f32_16x16x32_bf16 v[24:27], a[100:103], a[68:71], v[24:27]
 v_exp_f32 v32, v32
 v_mfma_f32_16x16x32_bf16 v[24:27], a[104:107], a[72:75], v[24:27]
 v_exp_f32 v33, v33
 v_mfma_f32_16x16x32_bf16 v[24:27], a[108:111], a[76:79], v[24:27]
 v_mul_f32 v34, s32, v34
 v_mul_f32 v35, s32, v35
 v_smfmac_f32_16x16x64_bf16 a[228:231], a[236:239], v[40:47], v2
 v_mfma_f32_16x16x32_bf16 v[28:31], a[124:127], a[76:79], 0
 v_exp_f32 v34, v34
 v_mfma_f32_16x16x32_bf16 v[28:31], a[120:123], a[72:75], v[28:31]
 v_exp_f32 v35, v35
 v_mfma_f32_16x16x32_bf16 v[28:31], a[116:119], a[68:71], v[28:31]
 s_mov_b32 s59, 4096
 v_mul_f32 v36, s32, v36
 v_mul_f32 v37, s32, v37
 v_mfma_f32_16x16x32_bf16 v[28:31], a[112:115], a[64:67], v[28:31]
 s_waitcnt lgkmcnt(3)
 buffer_store_dwordx4 v[96:99], v1, s[24:27], s59 offen sc1 nt
 v_mfma_f32_16x16x32_bf16 v[144:147], a[176:179], v[40:43], v[144:147]
 v_cvt_pk_bf16_f32 v52, v32, v33
 v_cvt_pk_bf16_f32 v53, v34, v35
 v_mfma_f32_16x16x32_bf16 v[144:147], a[208:211], v[44:47], v[144:147]
 v_exp_f32 v36, v36
 v_mfma_f32_16x16x32_bf16 v[148:151], a[180:183], v[40:43], v[148:151]
 v_exp_f32 v37, v37
 v_mfma_f32_16x16x32_bf16 v[148:151], a[212:215], v[44:47], v[148:151]
 s_waitcnt lgkmcnt(2)
 buffer_store_dwordx4 v[100:103], v1, s[24:27], s59 offen offset:1024 sc1 nt
 v_mul_f32 v38, s32, v38
 v_mul_f32 v39, s32, v39
 v_mfma_f32_16x16x32_bf16 v[152:155], a[184:187], v[40:43], v[152:155]
 v_exp_f32 v38, v38
 v_mfma_f32_16x16x32_bf16 v[152:155], a[216:219], v[44:47], v[152:155]
 s_waitcnt lgkmcnt(1)
 buffer_store_dwordx4 v[104:107], v1, s[24:27], s59 offen offset:2048 sc1 nt
 v_exp_f32 v39, v39
 v_mfma_f32_16x16x32_bf16 v[156:159], a[188:191], v[40:43], v[156:159]
 v_cvt_pk_bf16_f32 v54, v36, v37
 v_cvt_pk_bf16_f32 v55, v38, v39
 v_mfma_f32_16x16x32_bf16 v[156:159], a[220:223], v[44:47], v[156:159]
 s_waitcnt lgkmcnt(0)
 buffer_store_dwordx4 v[108:111], v1, s[24:27], s59 offen offset:3072 sc1 nt
 v_mfma_f32_16x16x32_bf16 v[32:35], a[128:131], a[64:67], 0
 v_mul_f32 v24, s32, v24
 v_mul_f32 v25, s32, v25
 v_mfma_f32_16x16x32_bf16 v[32:35], a[132:135], a[68:71], v[32:35]
 v_exp_f32 v24, v24
 v_mfma_f32_16x16x32_bf16 v[32:35], a[136:139], a[72:75], v[32:35]
 v_exp_f32 v25, v25
 v_mfma_f32_16x16x32_bf16 v[32:35], a[140:143], a[76:79], v[32:35]
 v_accvgpr_read_b32 v11, a228
 v_accvgpr_read_b32 v10, a229
 v_add_f32 v11, v11, v10
 v_rcp_f32 v10, v11
 v_cmp_nle_f32 vcc, s60, v11
 v_pk_mul_f32 v[128:129], v[128:129], v[10:11] op_sel_hi:[1,0]
 v_pk_mul_f32 v[130:131], v[130:131], v[10:11] op_sel_hi:[1,0]
 v_pk_mul_f32 v[132:133], v[132:133], v[10:11] op_sel_hi:[1,0]
 v_pk_mul_f32 v[134:135], v[134:135], v[10:11] op_sel_hi:[1,0]
 v_pk_mul_f32 v[136:137], v[136:137], v[10:11] op_sel_hi:[1,0]
 v_pk_mul_f32 v[138:139], v[138:139], v[10:11] op_sel_hi:[1,0]
 v_pk_mul_f32 v[140:141], v[140:141], v[10:11] op_sel_hi:[1,0]
 v_pk_mul_f32 v[142:143], v[142:143], v[10:11] op_sel_hi:[1,0]
 v_pk_mul_f32 v[144:145], v[144:145], v[10:11] op_sel_hi:[1,0]
 v_pk_mul_f32 v[146:147], v[146:147], v[10:11] op_sel_hi:[1,0]
 v_pk_mul_f32 v[148:149], v[148:149], v[10:11] op_sel_hi:[1,0]
 v_pk_mul_f32 v[150:151], v[150:151], v[10:11] op_sel_hi:[1,0]
 v_pk_mul_f32 v[152:153], v[152:153], v[10:11] op_sel_hi:[1,0]
 v_pk_mul_f32 v[154:155], v[154:155], v[10:11] op_sel_hi:[1,0]
 v_pk_mul_f32 v[156:157], v[156:157], v[10:11] op_sel_hi:[1,0]
 v_pk_mul_f32 v[158:159], v[158:159], v[10:11] op_sel_hi:[1,0]
 v_mfma_f32_16x16x32_bf16 v[36:39], a[156:159], a[76:79], 0
 s_or_b64 s[50:51], s[50:51], vcc
 v_mul_f32 v26, s32, v26
 v_mul_f32 v27, s32, v27
 v_mfma_f32_16x16x32_bf16 v[36:39], a[152:155], a[72:75], v[36:39]
 v_exp_f32 v26, v26
 v_mfma_f32_16x16x32_bf16 v[36:39], a[148:151], a[68:71], v[36:39]
 v_exp_f32 v27, v27
 v_mfma_f32_16x16x32_bf16 v[36:39], a[144:147], a[64:67], v[36:39]
 v_mul_f32 v28, s32, v28
 v_mul_f32 v29, s32, v29
 v_cmp_nge_f32 vcc, s61, v11
 v_add_u32 v12, 13056, v5
 v_cvt_pk_bf16_f32 v128, v128, v129
 v_cvt_pk_bf16_f32 v129, v130, v131
 v_cvt_pk_bf16_f32 v132, v132, v133
 v_cvt_pk_bf16_f32 v133, v134, v135
 v_mfma_f32_16x16x32_bf16 v[160:163], a[160:163], v[48:51], v[160:163]
 v_cvt_pk_bf16_f32 v40, v24, v25
 v_cvt_pk_bf16_f32 v41, v26, v27
 v_mfma_f32_16x16x32_bf16 v[160:163], a[192:195], v[52:55], v[160:163]
 s_or_b64 s[50:51], s[50:51], vcc
 ds_write2_b64 v12, v[128:129], v[132:133] offset0:0 offset1:4
 v_exp_f32 v28, v28
 v_cvt_pk_bf16_f32 v136, v136, v137
 v_cvt_pk_bf16_f32 v137, v138, v139
 v_cvt_pk_bf16_f32 v140, v140, v141
 v_cvt_pk_bf16_f32 v141, v142, v143
 v_mfma_f32_16x16x32_bf16 v[164:167], a[164:167], v[48:51], v[164:167]
 v_exp_f32 v29, v29
 v_mfma_f32_16x16x32_bf16 v[164:167], a[196:199], v[52:55], v[164:167]
 ds_write2_b64 v12, v[136:137], v[140:141] offset0:8 offset1:12
 v_mul_f32 v30, s32, v30
 v_mul_f32 v31, s32, v31
 v_cvt_pk_bf16_f32 v144, v144, v145
 v_cvt_pk_bf16_f32 v145, v146, v147
 v_cvt_pk_bf16_f32 v148, v148, v149
 v_cvt_pk_bf16_f32 v149, v150, v151
 v_mfma_f32_16x16x32_bf16 v[168:171], a[168:171], v[48:51], v[168:171]
L_pg0_13:
 s_cbranch_execz L_main0
 v_exp_f32 v30, v30
 v_mfma_f32_16x16x32_bf16 v[168:171], a[200:203], v[52:55], v[168:171]
 ds_write2_b64 v12, v[144:145], v[148:149] offset0:16 offset1:20
 v_exp_f32 v31, v31
 v_cvt_pk_bf16_f32 v152, v152, v153
 v_cvt_pk_bf16_f32 v153, v154, v155
 v_mfma_f32_16x16x32_bf16 v[172:175], a[172:175], v[48:51], v[172:175]
 v_cvt_pk_bf16_f32 v156, v156, v157
 v_cvt_pk_bf16_f32 v157, v158, v159
 v_mfma_f32_16x16x32_bf16 v[172:175], a[204:207], v[52:55], v[172:175]
 ds_write2_b64 v12, v[152:153], v[156:157] offset0:24 offset1:28
 ds_read_b128 v[128:131], v6 offset:13056
 ds_read_b128 v[132:135], v6 offset:14144
 ds_read_b128 v[136:139], v6 offset:15232
 ds_read_b128 v[140:143], v6 offset:16320
 v_cvt_pk_bf16_f32 v42, v28, v29
 v_cvt_pk_bf16_f32 v43, v30, v31
 v_mfma_f32_16x16x32_bf16 v[24:27], a[96:99], a[80:83], 0
 v_mul_f32 v32, s32, v32
 v_mul_f32 v33, s32, v33
 v_mfma_f32_16x16x32_bf16 v[24:27], a[100:103], a[84:87], v[24:27]
 v_exp_f32 v32, v32
 v_mfma_f32_16x16x32_bf16 v[24:27], a[104:107], a[88:91], v[24:27]
 v_exp_f32 v33, v33
 v_mfma_f32_16x16x32_bf16 v[24:27], a[108:111], a[92:95], v[24:27]
 v_mul_f32 v34, s32, v34
 v_mul_f32 v35, s32, v35
 v_smfmac_f32_16x16x64_bf16 a[228:231], a[240:243], v[48:55], v2
 v_mfma_f32_16x16x32_bf16 v[28:31], a[124:127], a[92:95], 0
 v_exp_f32 v34, v34
 v_mfma_f32_16x16x32_bf16 v[28:31], a[120:123], a[88:91], v[28:31]
 v_exp_f32 v35, v35
 v_mfma_f32_16x16x32_bf16 v[28:31], a[116:119], a[84:87], v[28:31]
 s_mov_b32 s59, 8192
 v_mul_f32 v36, s32, v36
 v_mul_f32 v37, s32, v37
 v_mfma_f32_16x16x32_bf16 v[28:31], a[112:115], a[80:83], v[28:31]
 s_waitcnt lgkmcnt(3)
 v_cvt_pk_bf16_f32 v44, v32, v33
 v_cvt_pk_bf16_f32 v45, v34, v35
 v_mfma_f32_16x16x32_bf16 v[176:179], a[176:179], v[48:51], v[176:179]
 v_exp_f32 v36, v36
 v_mfma_f32_16x16x32_bf16 v[176:179], a[208:211], v[52:55], v[176:179]
 v_exp_f32 v37, v37
 v_mfma_f32_16x16x32_bf16 v[180:183], a[180:183], v[48:51], v[180:183]
 buffer_store_dwordx4 v[128:131], v1, s[24:27], s59 offen sc1 nt
 v_mfma_f32_16x16x32_bf16 v[180:183], a[212:215], v[52:55], v[180:183]
 s_waitcnt lgkmcnt(2)
 buffer_store_dwordx4 v[132:135], v1, s[24:27], s59 offen offset:1024 sc1 nt
 v_mul_f32 v38, s32, v38
 v_mul_f32 v39, s32, v39
 v_mfma_f32_16x16x32_bf16 v[184:187], a[184:187], v[48:51], v[184:187]
 v_exp_f32 v38, v38
 v_mfma_f32_16x16x32_bf16 v[184:187], a[216:219], v[52:55], v[184:187]
 s_waitcnt lgkmcnt(1)
 buffer_store_dwordx4 v[136:139], v1, s[24:27], s59 offen offset:2048 sc1 nt
 v_exp_f32 v39, v39
 v_mfma_f32_16x16x32_bf16 v[188:191], a[188:191], v[48:51], v[188:191]
 v_cvt_pk_bf16_f32 v46, v36, v37
 v_cvt_pk_bf16_f32 v47, v38, v39
 v_mfma_f32_16x16x32_bf16 v[188:191], a[220:223], v[52:55], v[188:191]
 s_waitcnt lgkmcnt(0)
 buffer_store_dwordx4 v[140:143], v1, s[24:27], s59 offen offset:3072 sc1 nt
 v_mul_f32 v24, s32, v24
 v_mul_f32 v25, s32, v25
 v_mfma_f32_16x16x32_bf16 v[32:35], a[128:131], a[80:83], 0
 v_exp_f32 v24, v24
 v_mfma_f32_16x16x32_bf16 v[32:35], a[132:135], a[84:87], v[32:35]
 v_exp_f32 v25, v25
 v_mfma_f32_16x16x32_bf16 v[32:35], a[136:139], a[88:91], v[32:35]
 v_mul_f32 v26, s32, v26
 v_mul_f32 v27, s32, v27
 v_mfma_f32_16x16x32_bf16 v[32:35], a[140:143], a[92:95], v[32:35]
 v_accvgpr_read_b32 v11, a230
 v_accvgpr_read_b32 v10, a231
 v_add_f32 v11, v11, v10
 v_rcp_f32 v10, v11
 v_cmp_nle_f32 vcc, s60, v11
 v_pk_mul_f32 v[160:161], v[160:161], v[10:11] op_sel_hi:[1,0]
 v_pk_mul_f32 v[162:163], v[162:163], v[10:11] op_sel_hi:[1,0]
 v_pk_mul_f32 v[164:165], v[164:165], v[10:11] op_sel_hi:[1,0]
 v_pk_mul_f32 v[166:167], v[166:167], v[10:11] op_sel_hi:[1,0]
 v_pk_mul_f32 v[168:169], v[168:169], v[10:11] op_sel_hi:[1,0]
 v_pk_mul_f32 v[170:171], v[170:171], v[10:11] op_sel_hi:[1,0]
 v_pk_mul_f32 v[172:173], v[172:173], v[10:11] op_sel_hi:[1,0]
 v_pk_mul_f32 v[174:175], v[174:175], v[10:11] op_sel_hi:[1,0]
 v_pk_mul_f32 v[176:177], v[176:177], v[10:11] op_sel_hi:[1,0]
 v_pk_mul_f32 v[178:179], v[178:179], v[10:11] op_sel_hi:[1,0]
 v_pk_mul_f32 v[180:181], v[180:181], v[10:11] op_sel_hi:[1,0]
 v_pk_mul_f32 v[182:183], v[182:183], v[10:11] op_sel_hi:[1,0]
 v_pk_mul_f32 v[184:185], v[184:185], v[10:11] op_sel_hi:[1,0]
 v_pk_mul_f32 v[186:187], v[186:187], v[10:11] op_sel_hi:[1,0]
 v_pk_mul_f32 v[188:189], v[188:189], v[10:11] op_sel_hi:[1,0]
 v_pk_mul_f32 v[190:191], v[190:191], v[10:11] op_sel_hi:[1,0]
 v_mfma_f32_16x16x32_bf16 v[36:39], a[156:159], a[92:95], 0
 s_or_b64 s[50:51], s[50:51], vcc
 v_exp_f32 v26, v26
 v_mfma_f32_16x16x32_bf16 v[36:39], a[152:155], a[88:91], v[36:39]
 v_exp_f32 v27, v27
 v_mfma_f32_16x16x32_bf16 v[36:39], a[148:151], a[84:87], v[36:39]
 v_mul_f32 v28, s32, v28
 v_mul_f32 v29, s32, v29
 v_mfma_f32_16x16x32_bf16 v[36:39], a[144:147], a[80:83], v[36:39]
 v_cmp_nge_f32 vcc, s61, v11
 v_add_u32 v12, 4352, v5
 v_cvt_pk_bf16_f32 v160, v160, v161
 v_cvt_pk_bf16_f32 v161, v162, v163
 v_cvt_pk_bf16_f32 v164, v164, v165
 v_cvt_pk_bf16_f32 v165, v166, v167
 v_mfma_f32_16x16x32_bf16 v[192:195], a[160:163], v[40:43], v[192:195]
 v_cvt_pk_bf16_f32 v48, v24, v25
 v_cvt_pk_bf16_f32 v49, v26, v27
 v_mfma_f32_16x16x32_bf16 v[192:195], a[192:195], v[44:47], v[192:195]
 s_or_b64 s[50:51], s[50:51], vcc
 ds_write2_b64 v12, v[160:161], v[164:165] offset0:0 offset1:4
 v_exp_f32 v28, v28
 v_cvt_pk_bf16_f32 v168, v168, v169
 v_cvt_pk_bf16_f32 v169, v170, v171
 v_cvt_pk_bf16_f32 v172, v172, v173
 v_cvt_pk_bf16_f32 v173, v174, v175
 v_mfma_f32_16x16x32_bf16 v[196:199], a[164:167], v[40:43], v[196:199]
 v_exp_f32 v29, v29
 v_mfma_f32_16x16x32_bf16 v[196:199], a[196:199], v[44:47], v[196:199]
 ds_write2_b64 v12, v[168:169], v[172:173] offset0:8 offset1:12
 v_mul_f32 v30, s32, v30
 v_mul_f32 v31, s32, v31
 v_cvt_pk_bf16_f32 v176, v176, v177
 v_cvt_pk_bf16_f32 v177, v178, v179
 v_cvt_pk_bf16_f32 v180, v180, v181
 v_cvt_pk_bf16_f32 v181, v182, v183
 v_mfma_f32_16x16x32_bf16 v[200:203], a[168:171], v[40:43], v[200:203]
 v_exp_f32 v30, v30
 v_mfma_f32_16x16x32_bf16 v[200:203], a[200:203], v[44:47], v[200:203]
 ds_write2_b64 v12, v[176:177], v[180:181] offset0:16 offset1:20
 v_exp_f32 v31, v31
 v_mfma_f32_16x16x32_bf16 v[204:207], a[172:175], v[40:43], v[204:207]
 v_cvt_pk_bf16_f32 v50, v28, v29
 v_cvt_pk_bf16_f32 v51, v30, v31
 v_mfma_f32_16x16x32_bf16 v[204:207], a[204:207], v[44:47], v[204:207]
 v_mul_f32 v32, s32, v32
 v_mul_f32 v33, s32, v33
 v_cvt_pk_bf16_f32 v184, v184, v185
 v_cvt_pk_bf16_f32 v185, v186, v187
 v_cvt_pk_bf16_f32 v188, v188, v189
 v_cvt_pk_bf16_f32 v189, v190, v191
 v_smfmac_f32_16x16x64_bf16 a[232:235], a[236:239], v[40:47], v2
 ds_write2_b64 v12, v[184:185], v[188:189] offset0:24 offset1:28
 v_exp_f32 v32, v32
 v_mfma_f32_16x16x32_bf16 v[208:211], a[176:179], v[40:43], v[208:211]
 v_exp_f32 v33, v33
 v_mfma_f32_16x16x32_bf16 v[208:211], a[208:211], v[44:47], v[208:211]
 ds_read_b128 v[160:163], v6 offset:4352
 ds_read_b128 v[164:167], v6 offset:5440
 ds_read_b128 v[168:171], v6 offset:6528
 ds_read_b128 v[172:175], v6 offset:7616
 v_mul_f32 v34, s32, v34
 v_mul_f32 v35, s32, v35
 v_mfma_f32_16x16x32_bf16 v[212:215], a[180:183], v[40:43], v[212:215]
 v_exp_f32 v34, v34
 v_mfma_f32_16x16x32_bf16 v[212:215], a[212:215], v[44:47], v[212:215]
 v_exp_f32 v35, v35
 v_mul_f32 v36, s32, v36
 v_mfma_f32_16x16x32_bf16 v[216:219], a[184:187], v[40:43], v[216:219]
 v_mul_f32 v37, s32, v37
 v_cvt_pk_bf16_f32 v52, v32, v33
 v_mfma_f32_16x16x32_bf16 v[216:219], a[216:219], v[44:47], v[216:219]
 s_mov_b32 s59, 12288
 v_cvt_pk_bf16_f32 v53, v34, v35
 v_exp_f32 v36, v36
 v_mfma_f32_16x16x32_bf16 v[220:223], a[188:191], v[40:43], v[220:223]
 s_waitcnt lgkmcnt(3)
 buffer_store_dwordx4 v[160:163], v1, s[24:27], s59 offen sc1 nt
 v_exp_f32 v37, v37
 v_mfma_f32_16x16x32_bf16 v[220:223], a[220:223], v[44:47], v[220:223]
 v_mul_f32 v38, s32, v38
 v_mul_f32 v39, s32, v39
 v_exp_f32 v38, v38
 v_exp_f32 v39, v39
 v_cvt_pk_bf16_f32 v54, v36, v37
 v_cvt_pk_bf16_f32 v55, v38, v39
 s_nop 0
 v_mfma_f32_16x16x32_bf16 v[224:227], a[160:163], v[48:51], v[224:227]
 s_waitcnt lgkmcnt(2)
 buffer_store_dwordx4 v[164:167], v1, s[24:27], s59 offen offset:1024 sc1 nt
 v_mfma_f32_16x16x32_bf16 v[224:227], a[192:195], v[52:55], v[224:227]
 s_waitcnt lgkmcnt(1)
 buffer_store_dwordx4 v[168:171], v1, s[24:27], s59 offen offset:2048 sc1 nt
 v_mfma_f32_16x16x32_bf16 v[228:231], a[164:167], v[48:51], v[228:231]
 s_waitcnt lgkmcnt(0)
 buffer_store_dwordx4 v[172:175], v1, s[24:27], s59 offen offset:3072 sc1 nt
 v_mfma_f32_16x16x32_bf16 v[228:231], a[196:199], v[52:55], v[228:231]
 v_accvgpr_read_b32 v11, a232
 v_accvgpr_read_b32 v10, a233
 v_add_f32 v11, v11, v10
 v_rcp_f32 v10, v11
 v_cmp_nle_f32 vcc, s60, v11
 v_pk_mul_f32 v[192:193], v[192:193], v[10:11] op_sel_hi:[1,0]
 v_pk_mul_f32 v[194:195], v[194:195], v[10:11] op_sel_hi:[1,0]
 v_pk_mul_f32 v[196:197], v[196:197], v[10:11] op_sel_hi:[1,0]
 v_pk_mul_f32 v[198:199], v[198:199], v[10:11] op_sel_hi:[1,0]
 v_pk_mul_f32 v[200:201], v[200:201], v[10:11] op_sel_hi:[1,0]
 v_pk_mul_f32 v[202:203], v[202:203], v[10:11] op_sel_hi:[1,0]
 v_pk_mul_f32 v[204:205], v[204:205], v[10:11] op_sel_hi:[1,0]
 v_pk_mul_f32 v[206:207], v[206:207], v[10:11] op_sel_hi:[1,0]
 v_pk_mul_f32 v[208:209], v[208:209], v[10:11] op_sel_hi:[1,0]
 v_pk_mul_f32 v[210:211], v[210:211], v[10:11] op_sel_hi:[1,0]
 v_pk_mul_f32 v[212:213], v[212:213], v[10:11] op_sel_hi:[1,0]
 v_pk_mul_f32 v[214:215], v[214:215], v[10:11] op_sel_hi:[1,0]
 v_pk_mul_f32 v[216:217], v[216:217], v[10:11] op_sel_hi:[1,0]
 v_pk_mul_f32 v[218:219], v[218:219], v[10:11] op_sel_hi:[1,0]
 v_pk_mul_f32 v[220:221], v[220:221], v[10:11] op_sel_hi:[1,0]
 v_pk_mul_f32 v[222:223], v[222:223], v[10:11] op_sel_hi:[1,0]
 v_mfma_f32_16x16x32_bf16 v[232:235], a[168:171], v[48:51], v[232:235]
 s_or_b64 s[50:51], s[50:51], vcc
 v_cmp_nge_f32 vcc, s61, v11
 v_add_u32 v12, 8704, v5
 v_mfma_f32_16x16x32_bf16 v[232:235], a[200:203], v[52:55], v[232:235]
 v_cvt_pk_bf16_f32 v192, v192, v193
 v_cvt_pk_bf16_f32 v193, v194, v195
 v_mfma_f32_16x16x32_bf16 v[236:239], a[172:175], v[48:51], v[236:239]
 v_cvt_pk_bf16_f32 v196, v196, v197
 v_cvt_pk_bf16_f32 v197, v198, v199
 v_mfma_f32_16x16x32_bf16 v[236:239], a[204:207], v[52:55], v[236:239]
 s_or_b64 s[50:51], s[50:51], vcc
 ds_write2_b64 v12, v[192:193], v[196:197] offset0:0 offset1:4
 v_cvt_pk_bf16_f32 v200, v200, v201
 v_cvt_pk_bf16_f32 v201, v202, v203
 v_cvt_pk_bf16_f32 v204, v204, v205
 v_cvt_pk_bf16_f32 v205, v206, v207
 v_smfmac_f32_16x16x64_bf16 a[232:235], a[240:243], v[48:55], v2
 ds_write2_b64 v12, v[200:201], v[204:205] offset0:8 offset1:12
 v_mfma_f32_16x16x32_bf16 v[240:243], a[176:179], v[48:51], v[240:243]
 v_cvt_pk_bf16_f32 v208, v208, v209
 v_cvt_pk_bf16_f32 v209, v210, v211
 v_mfma_f32_16x16x32_bf16 v[240:243], a[208:211], v[52:55], v[240:243]
 v_cvt_pk_bf16_f32 v212, v212, v213
 v_cvt_pk_bf16_f32 v213, v214, v215
 v_mfma_f32_16x16x32_bf16 v[244:247], a[180:183], v[48:51], v[244:247]
 ds_write2_b64 v12, v[208:209], v[212:213] offset0:16 offset1:20
 v_mfma_f32_16x16x32_bf16 v[244:247], a[212:215], v[52:55], v[244:247]
 v_cvt_pk_bf16_f32 v216, v216, v217
 v_cvt_pk_bf16_f32 v217, v218, v219
 v_mfma_f32_16x16x32_bf16 v[248:251], a[184:187], v[48:51], v[248:251]
 v_cvt_pk_bf16_f32 v220, v220, v221
 v_cvt_pk_bf16_f32 v221, v222, v223
 v_mfma_f32_16x16x32_bf16 v[248:251], a[216:219], v[52:55], v[248:251]
 ds_write2_b64 v12, v[216:217], v[220:221] offset0:24 offset1:28
 v_mfma_f32_16x16x32_bf16 v[252:255], a[188:191], v[48:51], v[252:255]
 ds_read_b128 v[192:195], v6 offset:8704
 ds_read_b128 v[196:199], v6 offset:9792
 v_mfma_f32_16x16x32_bf16 v[252:255], a[220:223], v[52:55], v[252:255]
 ds_read_b128 v[200:203], v6 offset:10880
 ds_read_b128 v[204:207], v6 offset:11968
 s_nop 1
 v_accvgpr_read_b32 v11, a234
 v_accvgpr_read_b32 v10, a235
 v_add_f32 v11, v11, v10
 v_rcp_f32 v10, v11
 v_cmp_nle_f32 vcc, s60, v11
 v_pk_mul_f32 v[224:225], v[224:225], v[10:11] op_sel_hi:[1,0]
 v_pk_mul_f32 v[226:227], v[226:227], v[10:11] op_sel_hi:[1,0]
 v_pk_mul_f32 v[228:229], v[228:229], v[10:11] op_sel_hi:[1,0]
 v_pk_mul_f32 v[230:231], v[230:231], v[10:11] op_sel_hi:[1,0]
 v_pk_mul_f32 v[232:233], v[232:233], v[10:11] op_sel_hi:[1,0]
 v_pk_mul_f32 v[234:235], v[234:235], v[10:11] op_sel_hi:[1,0]
 v_pk_mul_f32 v[236:237], v[236:237], v[10:11] op_sel_hi:[1,0]
 v_pk_mul_f32 v[238:239], v[238:239], v[10:11] op_sel_hi:[1,0]
 v_pk_mul_f32 v[240:241], v[240:241], v[10:11] op_sel_hi:[1,0]
 v_pk_mul_f32 v[242:243], v[242:243], v[10:11] op_sel_hi:[1,0]
 v_pk_mul_f32 v[244:245], v[244:245], v[10:11] op_sel_hi:[1,0]
 v_pk_mul_f32 v[246:247], v[246:247], v[10:11] op_sel_hi:[1,0]
 v_pk_mul_f32 v[248:249], v[248:249], v[10:11] op_sel_hi:[1,0]
 v_pk_mul_f32 v[250:251], v[250:251], v[10:11] op_sel_hi:[1,0]
 v_pk_mul_f32 v[252:253], v[252:253], v[10:11] op_sel_hi:[1,0]
 v_pk_mul_f32 v[254:255], v[254:255], v[10:11] op_sel_hi:[1,0]
 s_mov_b32 s59, 16384
 s_waitcnt lgkmcnt(3)
 buffer_store_dwordx4 v[192:195], v1, s[24:27], s59 offen sc1 nt
 s_or_b64 s[50:51], s[50:51], vcc
 v_cmp_nge_f32 vcc, s61, v11
 v_add_u32 v12, 13056, v5
 v_cvt_pk_bf16_f32 v224, v224, v225
 v_cvt_pk_bf16_f32 v225, v226, v227
 v_cvt_pk_bf16_f32 v228, v228, v229
 v_cvt_pk_bf16_f32 v229, v230, v231
 s_or_b64 s[50:51], s[50:51], vcc
 ds_write2_b64 v12, v[224:225], v[228:229] offset0:0 offset1:4
 s_waitcnt lgkmcnt(3)
 buffer_store_dwordx4 v[196:199], v1, s[24:27], s59 offen offset:1024 sc1 nt
 v_cvt_pk_bf16_f32 v232, v232, v233
 v_cvt_pk_bf16_f32 v233, v234, v235
 v_cvt_pk_bf16_f32 v236, v236, v237
 v_cvt_pk_bf16_f32 v237, v238, v239
 ds_write2_b64 v12, v[232:233], v[236:237] offset0:8 offset1:12
 v_cvt_pk_bf16_f32 v240, v240, v241
 v_cvt_pk_bf16_f32 v241, v242, v243
 v_cvt_pk_bf16_f32 v244, v244, v245
 v_cvt_pk_bf16_f32 v245, v246, v247
 ds_write2_b64 v12, v[240:241], v[244:245] offset0:16 offset1:20
 v_cvt_pk_bf16_f32 v248, v248, v249
 v_cvt_pk_bf16_f32 v249, v250, v251
 v_cvt_pk_bf16_f32 v252, v252, v253
 v_cvt_pk_bf16_f32 v253, v254, v255
 ds_write2_b64 v12, v[248:249], v[252:253] offset0:24 offset1:28
 ds_read_b128 v[224:227], v6 offset:13056
 ds_read_b128 v[228:231], v6 offset:14144
 ds_read_b128 v[232:235], v6 offset:15232
 ds_read_b128 v[236:239], v6 offset:16320
 s_waitcnt lgkmcnt(9)
 buffer_store_dwordx4 v[200:203], v1, s[24:27], s59 offen offset:2048 sc1 nt
 s_waitcnt lgkmcnt(8)
 buffer_store_dwordx4 v[204:207], v1, s[24:27], s59 offen offset:3072 sc1 nt
 s_cmp_lg_u64 s[50:51], 0
 s_cselect_b32 s59, 2, 0
 s_or_b32 s52, s52, s59
 s_mov_b64 s[50:51], 0
 s_mov_b32 s59, 20480
 s_waitcnt lgkmcnt(3)
 buffer_store_dwordx4 v[224:227], v1, s[24:27], s59 offen sc1 nt
 s_waitcnt lgkmcnt(2)
 buffer_store_dwordx4 v[228:231], v1, s[24:27], s59 offen offset:1024 sc1 nt
 s_waitcnt lgkmcnt(1)
 buffer_store_dwordx4 v[232:235], v1, s[24:27], s59 offen offset:2048 sc1 nt
 s_waitcnt lgkmcnt(0)
 buffer_store_dwordx4 v[236:239], v1, s[24:27], s59 offen offset:3072 sc1 nt
 s_lshl_b32 s38, s3, 2
 s_add_u32 s38, s38, 163328
 v_mov_b32 v10, s38
 v_mov_b32 v11, s52
 ds_write_b32 v10, v11
 v_mov_b32 v10, 163328
 s_waitcnt lgkmcnt(0)
 s_barrier
 ds_read_b128 v[12:15], v10
 s_waitcnt lgkmcnt(0)
 v_or_b32 v12, v12, v13
 v_or3_b32 v12, v12, v14, v15
 s_nop 0
 v_readfirstlane_b32 s54, v12
 s_nop 3
 s_cmp_lg_u32 s54, 0
 s_cbranch_scc1 L_pend
 s_endpgm
L_end0:
L_fin:
L_pend:
 s_cmp_eq_u32 s54, 0
 s_cbranch_scc1 L_done
 s_bitcmp1_b32 s54, 0
 s_cselect_b32 s41, s56, s57
 s_cselect_b32 s38, 2, 0
 s_and_b32 s54, s54, s38
 s_waitcnt vmcnt(0) lgkmcnt(0)
 s_barrier
 s_mul_i32 s38, s41, 98304
 s_mul_i32 s59, s3, 24576
 s_add_u32 s38, s38, s59
 s_add_u32 s16, s4, s38
 s_addc_u32 s17, s5, 0
 s_mul_i32 s38, s41, 98304
 s_mul_i32 s59, s3, 24576
 s_add_u32 s38, s38, s59
 s_add_u32 s24, s10, s38
 s_addc_u32 s25, s11, 0
 v_mov_b32 v16, 0xff800000
 v_mov_b32 v17, 0xff800000
 v_mov_b32 v18, 0xff800000
 v_mov_b32 v19, 0xff800000
 v_mov_b32 v20, 0xff800000
 v_mov_b32 v21, 0xff800000
 s_mov_b32 s59, 0
 s_add_u32 m0, s45, 0
 s_nop 0
 buffer_load_dwordx4 v1, s[16:19], s59 offen nt lds
 s_add_u32 m0, s45, 64
 s_nop 0
 buffer_load_dwordx4 v1, s[16:19], s59 offen offset:1024 nt lds
 s_add_u32 m0, s45, 128
 s_nop 0
 buffer_load_dwordx4 v1, s[16:19], s59 offen offset:2048 nt lds
 s_add_u32 m0, s45, 192
 s_nop 0
 buffer_load_dwordx4 v1, s[16:19], s59 offen offset:3072 nt lds
 s_mov_b32 s59, 4096
 s_add_u32 m0, s45, 17408
 s_nop 0
 buffer_load_dwordx4 v1, s[16:19], s59 offen nt lds
 s_add_u32 m0, s45, 17472
 s_nop 0
 buffer_load_dwordx4 v1, s[16:19], s59 offen offset:1024 nt lds
 s_add_u32 m0, s45, 17536
 s_nop 0
 buffer_load_dwordx4 v1, s[16:19], s59 offen offset:2048 nt lds
 s_add_u32 m0, s45, 17600
 s_nop 0
 buffer_load_dwordx4 v1, s[16:19], s59 offen offset:3072 nt lds
 s_mov_b32 s59, 8192
 s_add_u32 m0, s45, 4352
 s_nop 0
 buffer_load_dwordx4 v1, s[16:19], s59 offen nt lds
 s_add_u32 m0, s45, 4416
 s_nop 0
 buffer_load_dwordx4 v1, s[16:19], s59 offen offset:1024 nt lds
 s_add_u32 m0, s45, 4480
 s_nop 0
 buffer_load_dwordx4 v1, s[16:19], s59 offen offset:2048 nt lds
 s_add_u32 m0, s45, 4544
 s_nop 0
 buffer_load_dwordx4 v1, s[16:19], s59 offen offset:3072 nt lds
 s_mov_b32 s59, 12288
 s_add_u32 m0, s45, 8704
 s_nop 0
 buffer_load_dwordx4 v1, s[16:19], s59 offen nt lds
 s_add_u32 m0, s45, 8768
 s_nop 0
 buffer_load_dwordx4 v1, s[16:19], s59 offen offset:1024 nt lds
 s_add_u32 m0, s45, 8832
 s_nop 0
 buffer_load_dwordx4 v1, s[16:19], s59 offen offset:2048 nt lds
 s_add_u32 m0, s45, 8896
 s_nop 0
 buffer_load_dwordx4 v1, s[16:19], s59 offen offset:3072 nt lds
 s_mov_b32 s59, 16384
 s_add_u32 m0, s45, 13056
 s_nop 0
 buffer_load_dwordx4 v1, s[16:19], s59 offen nt lds
 s_add_u32 m0, s45, 13120
 s_nop 0
 buffer_load_dwordx4 v1, s[16:19], s59 offen offset:1024 nt lds
 s_add_u32 m0, s45, 13184
 s_nop 0
 buffer_load_dwordx4 v1, s[16:19], s59 offen offset:2048 nt lds
 s_add_u32 m0, s45, 13248
 s_nop 0
 buffer_load_dwordx4 v1, s[16:19], s59 offen offset:3072 nt lds
 s_waitcnt vmcnt(0)
 ds_read_b128 a[0:3], v4 offset:0
 ds_read_b128 a[4:7], v4 offset:64
 ds_read_b128 a[8:11], v4 offset:128
 ds_read_b128 a[12:15], v4 offset:192
 s_waitcnt lgkmcnt(0)
 ds_read_b128 a[16:19], v4 offset:17408
 ds_read_b128 a[20:23], v4 offset:17472
 ds_read_b128 a[24:27], v4 offset:17536
 ds_read_b128 a[28:31], v4 offset:17600
 s_waitcnt lgkmcnt(0)
 ds_read_b128 a[32:35], v4 offset:4352
 ds_read_b128 a[36:39], v4 offset:4416
 ds_read_b128 a[40:43], v4 offset:4480
 ds_read_b128 a[44:47], v4 offset:4544
 s_waitcnt lgkmcnt(0)
 ds_read_b128 a[48:51], v4 offset:8704
 ds_read_b128 a[52:55], v4 offset:8768
 ds_read_b128 a[56:59], v4 offset:8832
 ds_read_b128 a[60:63], v4 offset:8896
 s_waitcnt lgkmcnt(0)
 ds_read_b128 a[64:67], v4 offset:13056
 ds_read_b128 a[68:71], v4 offset:13120
 ds_read_b128 a[72:75], v4 offset:13184
 ds_read_b128 a[76:79], v4 offset:13248
 s_waitcnt lgkmcnt(0)
 s_mov_b32 s59, 20480
 s_add_u32 m0, s45, 0
 s_nop 0
 buffer_load_dwordx4 v1, s[16:19], s59 offen nt lds
 s_add_u32 m0, s45, 64
 s_nop 0
 buffer_load_dwordx4 v1, s[16:19], s59 offen offset:1024 nt lds
 s_add_u32 m0, s45, 128
 s_nop 0
 buffer_load_dwordx4 v1, s[16:19], s59 offen offset:2048 nt lds
 s_add_u32 m0, s45, 192
 s_nop 0
 buffer_load_dwordx4 v1, s[16:19], s59 offen offset:3072 nt lds
 s_waitcnt vmcnt(0)
 ds_read_b128 a[80:83], v4 offset:0
 ds_read_b128 a[84:87], v4 offset:64
 ds_read_b128 a[88:91], v4 offset:128
 ds_read_b128 a[92:95], v4 offset:192
 s_waitcnt lgkmcnt(0)
 s_lshl_b32 s33, s41, 17
 s_and_b32 s38, s3, 1
 s_lshl_b32 s38, s38, 12
 s_add_u32 s33, s33, s38
 s_mov_b32 s40, 0
L_maxloop:
 s_add_u32 m0, s39, 0
 s_nop 0
 buffer_load_dwordx4 v1, s[20:23], s33 offen nt lds
 s_add_u32 m0, s39, 32
 s_nop 0
 buffer_load_dwordx4 v1, s[20:23], s33 offen offset:1024 nt lds
 s_add_u32 m0, s39, 64
 s_nop 0
 buffer_load_dwordx4 v1, s[20:23], s33 offen offset:2048 nt lds
 s_add_u32 m0, s39, 96
 s_nop 0
 buffer_load_dwordx4 v1, s[20:23], s33 offen offset:3072 nt lds
 s_add_u32 s33, s33, 8192
 s_waitcnt vmcnt(0)
 s_barrier
 ds_read_b128 a[96:99], v7 offset:0
 ds_read_b128 a[100:103], v7 offset:64
 ds_read_b128 a[104:107], v7 offset:128
 ds_read_b128 a[108:111], v7 offset:192
 ds_read_b128 a[124:127], v7 offset:704
 ds_read_b128 a[120:123], v7 offset:640
 ds_read_b128 a[116:119], v7 offset:576
 ds_read_b128 a[112:115], v7 offset:512
 s_waitcnt lgkmcnt(0)
 s_barrier
 v_mfma_f32_16x16x32_bf16 v[24:27], a[96:99], a[0:3], 0
 v_mfma_f32_16x16x32_bf16 v[24:27], a[100:103], a[4:7], v[24:27]
 v_mfma_f32_16x16x32_bf16 v[24:27], a[104:107], a[8:11], v[24:27]
 v_mfma_f32_16x16x32_bf16 v[24:27], a[108:111], a[12:15], v[24:27]
 v_mfma_f32_16x16x32_bf16 v[28:31], a[124:127], a[12:15], 0
 v_mfma_f32_16x16x32_bf16 v[28:31], a[120:123], a[8:11], v[28:31]
 v_mfma_f32_16x16x32_bf16 v[28:31], a[116:119], a[4:7], v[28:31]
 v_mfma_f32_16x16x32_bf16 v[28:31], a[112:115], a[0:3], v[28:31]
 s_nop 7
 v_max3_f32 v16, v16, v24, v25
 v_max3_f32 v16, v16, v26, v27
 v_max3_f32 v16, v16, v28, v29
 v_max3_f32 v16, v16, v30, v31
 v_mfma_f32_16x16x32_bf16 v[24:27], a[96:99], a[16:19], 0
 v_mfma_f32_16x16x32_bf16 v[24:27], a[100:103], a[20:23], v[24:27]
 v_mfma_f32_16x16x32_bf16 v[24:27], a[104:107], a[24:27], v[24:27]
 v_mfma_f32_16x16x32_bf16 v[24:27], a[108:111], a[28:31], v[24:27]
 v_mfma_f32_16x16x32_bf16 v[28:31], a[124:127], a[28:31], 0
 v_mfma_f32_16x16x32_bf16 v[28:31], a[120:123], a[24:27], v[28:31]
 v_mfma_f32_16x16x32_bf16 v[28:31], a[116:119], a[20:23], v[28:31]
 v_mfma_f32_16x16x32_bf16 v[28:31], a[112:115], a[16:19], v[28:31]
 s_nop 7
 v_max3_f32 v17, v17, v24, v25
 v_max3_f32 v17, v17, v26, v27
 v_max3_f32 v17, v17, v28, v29
 v_max3_f32 v17, v17, v30, v31
 v_mfma_f32_16x16x32_bf16 v[24:27], a[96:99], a[32:35], 0
 v_mfma_f32_16x16x32_bf16 v[24:27], a[100:103], a[36:39], v[24:27]
 v_mfma_f32_16x16x32_bf16 v[24:27], a[104:107], a[40:43], v[24:27]
 v_mfma_f32_16x16x32_bf16 v[24:27], a[108:111], a[44:47], v[24:27]
 v_mfma_f32_16x16x32_bf16 v[28:31], a[124:127], a[44:47], 0
 v_mfma_f32_16x16x32_bf16 v[28:31], a[120:123], a[40:43], v[28:31]
 v_mfma_f32_16x16x32_bf16 v[28:31], a[116:119], a[36:39], v[28:31]
 v_mfma_f32_16x16x32_bf16 v[28:31], a[112:115], a[32:35], v[28:31]
 s_nop 7
 v_max3_f32 v18, v18, v24, v25
 v_max3_f32 v18, v18, v26, v27
 v_max3_f32 v18, v18, v28, v29
 v_max3_f32 v18, v18, v30, v31
 v_mfma_f32_16x16x32_bf16 v[24:27], a[96:99], a[48:51], 0
 v_mfma_f32_16x16x32_bf16 v[24:27], a[100:103], a[52:55], v[24:27]
 v_mfma_f32_16x16x32_bf16 v[24:27], a[104:107], a[56:59], v[24:27]
 v_mfma_f32_16x16x32_bf16 v[24:27], a[108:111], a[60:63], v[24:27]
 v_mfma_f32_16x16x32_bf16 v[28:31], a[124:127], a[60:63], 0
 v_mfma_f32_16x16x32_bf16 v[28:31], a[120:123], a[56:59], v[28:31]
 v_mfma_f32_16x16x32_bf16 v[28:31], a[116:119], a[52:55], v[28:31]
 v_mfma_f32_16x16x32_bf16 v[28:31], a[112:115], a[48:51], v[28:31]
 s_nop 7
 v_max3_f32 v19, v19, v24, v25
 v_max3_f32 v19, v19, v26, v27
 v_max3_f32 v19, v19, v28, v29
 v_max3_f32 v19, v19, v30, v31
 v_mfma_f32_16x16x32_bf16 v[24:27], a[96:99], a[64:67], 0
 v_mfma_f32_16x16x32_bf16 v[24:27], a[100:103], a[68:71], v[24:27]
 v_mfma_f32_16x16x32_bf16 v[24:27], a[104:107], a[72:75], v[24:27]
 v_mfma_f32_16x16x32_bf16 v[24:27], a[108:111], a[76:79], v[24:27]
 v_mfma_f32_16x16x32_bf16 v[28:31], a[124:127], a[76:79], 0
 v_mfma_f32_16x16x32_bf16 v[28:31], a[120:123], a[72:75], v[28:31]
 v_mfma_f32_16x16x32_bf16 v[28:31], a[116:119], a[68:71], v[28:31]
 v_mfma_f32_16x16x32_bf16 v[28:31], a[112:115], a[64:67], v[28:31]
 s_nop 7
 v_max3_f32 v20, v20, v24, v25
 v_max3_f32 v20, v20, v26, v27
 v_max3_f32 v20, v20, v28, v29
 v_max3_f32 v20, v20, v30, v31
 v_mfma_f32_16x16x32_bf16 v[24:27], a[96:99], a[80:83], 0
 v_mfma_f32_16x16x32_bf16 v[24:27], a[100:103], a[84:87], v[24:27]
 v_mfma_f32_16x16x32_bf16 v[24:27], a[104:107], a[88:91], v[24:27]
 v_mfma_f32_16x16x32_bf16 v[24:27], a[108:111], a[92:95], v[24:27]
 v_mfma_f32_16x16x32_bf16 v[28:31], a[124:127], a[92:95], 0
 v_mfma_f32_16x16x32_bf16 v[28:31], a[120:123], a[88:91], v[28:31]
 v_mfma_f32_16x16x32_bf16 v[28:31], a[116:119], a[84:87], v[28:31]
 v_mfma_f32_16x16x32_bf16 v[28:31], a[112:115], a[80:83], v[28:31]
 s_nop 7
 v_max3_f32 v21, v21, v24, v25
 v_max3_f32 v21, v21, v26, v27
 v_max3_f32 v21, v21, v28, v29
 v_max3_f32 v21, v21, v30, v31
 s_add_u32 s40, s40, 1
 s_cmp_lt_u32 s40, 16
 s_cbranch_scc1 L_maxloop
 v_mov_b32 v10, v16
 s_nop 1
 v_permlane32_swap_b32 v10, v16
 s_nop 1
 v_max_f32 v16, v16, v10
 v_mov_b32 v10, v16
 s_nop 1
 v_permlane16_swap_b32 v10, v16
 s_nop 1
 v_max_f32 v16, v16, v10
 v_mul_f32 v16, s32, v16
 v_sub_f32 v16, 0, v16
 v_mov_b32 v10, v17
 s_nop 1
 v_permlane32_swap_b32 v10, v17
 s_nop 1
 v_max_f32 v17, v17, v10
 v_mov_b32 v10, v17
 s_nop 1
 v_permlane16_swap_b32 v10, v17
 s_nop 1
 v_max_f32 v17, v17, v10
 v_mul_f32 v17, s32, v17
 v_sub_f32 v17, 0, v17
 v_mov_b32 v10, v18
 s_nop 1
 v_permlane32_swap_b32 v10, v18
 s_nop 1
 v_max_f32 v18, v18, v10
 v_mov_b32 v10, v18
 s_nop 1
 v_permlane16_swap_b32 v10, v18
 s_nop 1
 v_max_f32 v18, v18, v10
 v_mul_f32 v18, s32, v18
 v_sub_f32 v18, 0, v18
 v_mov_b32 v10, v19
 s_nop 1
 v_permlane32_swap_b32 v10, v19
 s_nop 1
 v_max_f32 v19, v19, v10
 v_mov_b32 v10, v19
 s_nop 1
 v_permlane16_swap_b32 v10, v19
 s_nop 1
 v_max_f32 v19, v19, v10
 v_mul_f32 v19, s32, v19
 v_sub_f32 v19, 0, v19
 v_mov_b32 v10, v20
 s_nop 1
 v_permlane32_swap_b32 v10, v20
 s_nop 1
 v_max_f32 v20, v20, v10
 v_mov_b32 v10, v20
 s_nop 1
 v_permlane16_swap_b32 v10, v20
 s_nop 1
 v_max_f32 v20, v20, v10
 v_mul_f32 v20, s32, v20
 v_sub_f32 v20, 0, v20
 v_mov_b32 v10, v21
 s_nop 1
 v_permlane32_swap_b32 v10, v21
 s_nop 1
 v_max_f32 v21, v21, v10
 v_mov_b32 v10, v21
 s_nop 1
 v_permlane16_swap_b32 v10, v21
 s_nop 1
 v_max_f32 v21, v21, v10
 v_mul_f32 v21, s32, v21
 v_sub_f32 v21, 0, v21
 v_mov_b64 v[64:65], 0
 v_mov_b64 v[66:67], 0
 v_mov_b64 v[68:69], 0
 v_mov_b64 v[70:71], 0
 v_mov_b64 v[72:73], 0
 v_mov_b64 v[74:75], 0
 v_mov_b64 v[76:77], 0
 v_mov_b64 v[78:79], 0
 v_mov_b64 v[80:81], 0
 v_mov_b64 v[82:83], 0
 v_mov_b64 v[84:85], 0
 v_mov_b64 v[86:87], 0
 v_mov_b64 v[88:89], 0
 v_mov_b64 v[90:91], 0
 v_mov_b64 v[92:93], 0
 v_mov_b64 v[94:95], 0
 v_mov_b64 v[96:97], 0
 v_mov_b64 v[98:99], 0
 v_mov_b64 v[100:101], 0
 v_mov_b64 v[102:103], 0
 v_mov_b64 v[104:105], 0
 v_mov_b64 v[106:107], 0
 v_mov_b64 v[108:109], 0
 v_mov_b64 v[110:111], 0
 v_mov_b64 v[112:113], 0
 v_mov_b64 v[114:115], 0
 v_mov_b64 v[116:117], 0
 v_mov_b64 v[118:119], 0
 v_mov_b64 v[120:121], 0
 v_mov_b64 v[122:123], 0
 v_mov_b64 v[124:125], 0
 v_mov_b64 v[126:127], 0
 v_mov_b64 v[128:129], 0
 v_mov_b64 v[130:131], 0
 v_mov_b64 v[132:133], 0
 v_mov_b64 v[134:135], 0
 v_mov_b64 v[136:137], 0
 v_mov_b64 v[138:139], 0
 v_mov_b64 v[140:141], 0
 v_mov_b64 v[142:143], 0
 v_mov_b64 v[144:145], 0
 v_mov_b64 v[146:147], 0
 v_mov_b64 v[148:149], 0
 v_mov_b64 v[150:151], 0
 v_mov_b64 v[152:153], 0
 v_mov_b64 v[154:155], 0
 v_mov_b64 v[156:157], 0
 v_mov_b64 v[158:159], 0
 v_mov_b64 v[160:161], 0
 v_mov_b64 v[162:163], 0
 v_mov_b64 v[164:165], 0
 v_mov_b64 v[166:167], 0
 v_mov_b64 v[168:169], 0
 v_mov_b64 v[170:171], 0
 v_mov_b64 v[172:173], 0
 v_mov_b64 v[174:175], 0
 v_mov_b64 v[176:177], 0
 v_mov_b64 v[178:179], 0
 v_mov_b64 v[180:181], 0
 v_mov_b64 v[182:183], 0
 v_mov_b64 v[184:185], 0
 v_mov_b64 v[186:187], 0
 v_mov_b64 v[188:189], 0
 v_mov_b64 v[190:191], 0
 v_mov_b64 v[192:193], 0
 v_mov_b64 v[194:195], 0
 v_mov_b64 v[196:197], 0
 v_mov_b64 v[198:199], 0
 v_mov_b64 v[200:201], 0
 v_mov_b64 v[202:203], 0
 v_mov_b64 v[204:205], 0
 v_mov_b64 v[206:207], 0
 v_mov_b64 v[208:209], 0
 v_mov_b64 v[210:211], 0
 v_mov_b64 v[212:213], 0
 v_mov_b64 v[214:215], 0
 v_mov_b64 v[216:217], 0
 v_mov_b64 v[218:219], 0
 v_mov_b64 v[220:221], 0
 v_mov_b64 v[222:223], 0
 v_mov_b64 v[224:225], 0
 v_mov_b64 v[226:227], 0
 v_mov_b64 v[228:229], 0
 v_mov_b64 v[230:231], 0
 v_mov_b64 v[232:233], 0
 v_mov_b64 v[234:235], 0
 v_mov_b64 v[236:237], 0
 v_mov_b64 v[238:239], 0
 v_mov_b64 v[240:241], 0
 v_mov_b64 v[242:243], 0
 v_mov_b64 v[244:245], 0
 v_mov_b64 v[246:247], 0
 v_mov_b64 v[248:249], 0
 v_mov_b64 v[250:251], 0
 v_mov_b64 v[252:253], 0
 v_mov_b64 v[254:255], 0
 v_accvgpr_write_b32 a224, 0
 v_accvgpr_write_b32 a225, 0
 v_accvgpr_write_b32 a226, 0
 v_accvgpr_write_b32 a227, 0
 v_accvgpr_write_b32 a228, 0
 v_accvgpr_write_b32 a229, 0
 v_accvgpr_write_b32 a230, 0
 v_accvgpr_write_b32 a231, 0
 v_accvgpr_write_b32 a232, 0
 v_accvgpr_write_b32 a233, 0
 v_accvgpr_write_b32 a234, 0
 v_accvgpr_write_b32 a235, 0
 s_lshl_b32 s33, s41, 17
 s_and_b32 s38, s3, 1
 s_lshl_b32 s38, s38, 12
 s_add_u32 s33, s33, s38
 s_mov_b32 s40, 0
L_slowloop:
 s_add_u32 m0, s39, 0
 s_nop 0
 buffer_load_dwordx4 v1, s[20:23], s33 offen nt lds
 s_add_u32 m0, s39, 32
 s_nop 0
 buffer_load_dwordx4 v1, s[20:23], s33 offen offset:1024 nt lds
 s_add_u32 m0, s39, 64
 s_nop 0
 buffer_load_dwordx4 v1, s[20:23], s33 offen offset:2048 nt lds
 s_add_u32 m0, s39, 96
 s_nop 0
 buffer_load_dwordx4 v1, s[20:23], s33 offen offset:3072 nt lds
 s_add_u32 s33, s33, 8192
 s_add_u32 m0, s39, 16896
 s_nop 0
 buffer_load_dwordx4 v1, s[20:23], s33 offen nt lds
 s_add_u32 m0, s39, 16928
 s_nop 0
 buffer_load_dwordx4 v1, s[20:23], s33 offen offset:1024 nt lds
 s_add_u32 m0, s39, 16960
 s_nop 0
 buffer_load_dwordx4 v1, s[20:23], s33 offen offset:2048 nt lds
 s_add_u32 m0, s39, 16992
 s_nop 0
 buffer_load_dwordx4 v1, s[20:23], s33 offen offset:3072 nt lds
 s_add_u32 s33, s33, 8192
 s_waitcnt vmcnt(0)
 s_barrier
 ds_read_b128 a[96:99], v7 offset:0
 ds_read_b128 a[100:103], v7 offset:64
 ds_read_b128 a[104:107], v7 offset:128
 ds_read_b128 a[108:111], v7 offset:192
 ds_read_b128 a[124:127], v7 offset:704
 ds_read_b128 a[120:123], v7 offset:640
 ds_read_b128 a[116:119], v7 offset:576
 ds_read_b128 a[112:115], v7 offset:512
 s_waitcnt lgkmcnt(0)
 ds_read_b64_tr_b16 a[160:161], v8 offset:0
 ds_read_b64_tr_b16 a[162:163], v8 offset:512
 ds_read_b64_tr_b16 a[164:165], v8 offset:32
 ds_read_b64_tr_b16 a[166:167], v8 offset:544
 ds_read_b64_tr_b16 a[168:169], v8 offset:64
 ds_read_b64_tr_b16 a[170:171], v8 offset:576
 ds_read_b64_tr_b16 a[172:173], v8 offset:96
 ds_read_b64_tr_b16 a[174:175], v8 offset:608
 s_waitcnt lgkmcnt(0)
 ds_read_b64_tr_b16 a[176:177], v8 offset:128
 ds_read_b64_tr_b16 a[178:179], v8 offset:640
 ds_read_b64_tr_b16 a[180:181], v8 offset:160
 ds_read_b64_tr_b16 a[182:183], v8 offset:672
 ds_read_b64_tr_b16 a[184:185], v8 offset:192
 ds_read_b64_tr_b16 a[186:187], v8 offset:704
 ds_read_b64_tr_b16 a[188:189], v8 offset:224
 ds_read_b64_tr_b16 a[190:191], v8 offset:736
 s_waitcnt lgkmcnt(0)
 ds_read_b128 a[128:131], v7 offset:16896
 ds_read_b128 a[132:135], v7 offset:16960
 ds_read_b128 a[136:139], v7 offset:17024
 ds_read_b128 a[140:143], v7 offset:17088
 ds_read_b128 a[156:159], v7 offset:17600
 ds_read_b128 a[152:155], v7 offset:17536
 ds_read_b128 a[148:151], v7 offset:17472
 ds_read_b128 a[144:147], v7 offset:17408
 s_waitcnt lgkmcnt(0)
 ds_read_b64_tr_b16 a[192:193], v8 offset:16896
 ds_read_b64_tr_b16 a[194:195], v8 offset:17408
 ds_read_b64_tr_b16 a[196:197], v8 offset:16928
 ds_read_b64_tr_b16 a[198:199], v8 offset:17440
 ds_read_b64_tr_b16 a[200:201], v8 offset:16960
 ds_read_b64_tr_b16 a[202:203], v8 offset:17472
 ds_read_b64_tr_b16 a[204:205], v8 offset:16992
 ds_read_b64_tr_b16 a[206:207], v8 offset:17504
 s_waitcnt lgkmcnt(0)
 ds_read_b64_tr_b16 a[208:209], v8 offset:17024
 ds_read_b64_tr_b16 a[210:211], v8 offset:17536
 ds_read_b64_tr_b16 a[212:213], v8 offset:17056
 ds_read_b64_tr_b16 a[214:215], v8 offset:17568
 ds_read_b64_tr_b16 a[216:217], v8 offset:17088
 ds_read_b64_tr_b16 a[218:219], v8 offset:17600
 ds_read_b64_tr_b16 a[220:221], v8 offset:17120
 ds_read_b64_tr_b16 a[222:223], v8 offset:17632
 s_waitcnt lgkmcnt(0)
 s_barrier
 v_mfma_f32_16x16x32_bf16 v[24:27], a[96:99], a[0:3], 0
 v_mfma_f32_16x16x32_bf16 v[24:27], a[100:103], a[4:7], v[24:27]
 v_mfma_f32_16x16x32_bf16 v[24:27], a[104:107], a[8:11], v[24:27]
 v_mfma_f32_16x16x32_bf16 v[24:27], a[108:111], a[12:15], v[24:27]
 v_mfma_f32_16x16x32_bf16 v[28:31], a[124:127], a[12:15], 0
 v_mfma_f32_16x16x32_bf16 v[28:31], a[120:123], a[8:11], v[28:31]
 v_mfma_f32_16x16x32_bf16 v[28:31], a[116:119], a[4:7], v[28:31]
 v_mfma_f32_16x16x32_bf16 v[28:31], a[112:115], a[0:3], v[28:31]
 v_mfma_f32_16x16x32_bf16 v[32:35], a[128:131], a[0:3], 0
 v_mfma_f32_16x16x32_bf16 v[32:35], a[132:135], a[4:7], v[32:35]
 v_mfma_f32_16x16x32_bf16 v[32:35], a[136:139], a[8:11], v[32:35]
 v_mfma_f32_16x16x32_bf16 v[32:35], a[140:143], a[12:15], v[32:35]
 v_mfma_f32_16x16x32_bf16 v[36:39], a[156:159], a[12:15], 0
 v_mfma_f32_16x16x32_bf16 v[36:39], a[152:155], a[8:11], v[36:39]
 v_mfma_f32_16x16x32_bf16 v[36:39], a[148:151], a[4:7], v[36:39]
 v_mfma_f32_16x16x32_bf16 v[36:39], a[144:147], a[0:3], v[36:39]
 s_nop 7
 v_fma_f32 v24, v24, s32, v16
 v_fma_f32 v25, v25, s32, v16
 v_fma_f32 v26, v26, s32, v16
 v_fma_f32 v27, v27, s32, v16
 v_fma_f32 v28, v28, s32, v16
 v_fma_f32 v29, v29, s32, v16
 v_fma_f32 v30, v30, s32, v16
 v_fma_f32 v31, v31, s32, v16
 v_exp_f32 v24, v24
 v_exp_f32 v25, v25
 v_exp_f32 v26, v26
 v_exp_f32 v27, v27
 v_exp_f32 v28, v28
 v_exp_f32 v29, v29
 v_exp_f32 v30, v30
 v_exp_f32 v31, v31
 s_nop 0
 v_cvt_pk_bf16_f32 v40, v24, v25
 v_cvt_pk_bf16_f32 v41, v26, v27
 v_cvt_pk_bf16_f32 v42, v28, v29
 v_cvt_pk_bf16_f32 v43, v30, v31
 v_fma_f32 v32, v32, s32, v16
 v_fma_f32 v33, v33, s32, v16
 v_fma_f32 v34, v34, s32, v16
 v_fma_f32 v35, v35, s32, v16
 v_fma_f32 v36, v36, s32, v16
 v_fma_f32 v37, v37, s32, v16
 v_fma_f32 v38, v38, s32, v16
 v_fma_f32 v39, v39, s32, v16
 v_exp_f32 v32, v32
 v_exp_f32 v33, v33
 v_exp_f32 v34, v34
 v_exp_f32 v35, v35
 v_exp_f32 v36, v36
 v_exp_f32 v37, v37
 v_exp_f32 v38, v38
 v_exp_f32 v39, v39
 s_nop 0
 v_cvt_pk_bf16_f32 v44, v32, v33
 v_cvt_pk_bf16_f32 v45, v34, v35
 v_cvt_pk_bf16_f32 v46, v36, v37
 v_cvt_pk_bf16_f32 v47, v38, v39
 s_nop 1
 v_smfmac_f32_16x16x64_bf16 a[224:227], a[236:239], v[40:47], v2
 v_mfma_f32_16x16x32_bf16 v[64:67], a[160:163], v[40:43], v[64:67]
 v_mfma_f32_16x16x32_bf16 v[64:67], a[192:195], v[44:47], v[64:67]
 v_mfma_f32_16x16x32_bf16 v[68:71], a[164:167], v[40:43], v[68:71]
 v_mfma_f32_16x16x32_bf16 v[68:71], a[196:199], v[44:47], v[68:71]
 v_mfma_f32_16x16x32_bf16 v[72:75], a[168:171], v[40:43], v[72:75]
 v_mfma_f32_16x16x32_bf16 v[72:75], a[200:203], v[44:47], v[72:75]
 v_mfma_f32_16x16x32_bf16 v[76:79], a[172:175], v[40:43], v[76:79]
 v_mfma_f32_16x16x32_bf16 v[76:79], a[204:207], v[44:47], v[76:79]
 v_mfma_f32_16x16x32_bf16 v[80:83], a[176:179], v[40:43], v[80:83]
 v_mfma_f32_16x16x32_bf16 v[80:83], a[208:211], v[44:47], v[80:83]
 v_mfma_f32_16x16x32_bf16 v[84:87], a[180:183], v[40:43], v[84:87]
 v_mfma_f32_16x16x32_bf16 v[84:87], a[212:215], v[44:47], v[84:87]
 v_mfma_f32_16x16x32_bf16 v[88:91], a[184:187], v[40:43], v[88:91]
 v_mfma_f32_16x16x32_bf16 v[88:91], a[216:219], v[44:47], v[88:91]
 v_mfma_f32_16x16x32_bf16 v[92:95], a[188:191], v[40:43], v[92:95]
 v_mfma_f32_16x16x32_bf16 v[92:95], a[220:223], v[44:47], v[92:95]
 v_mfma_f32_16x16x32_bf16 v[24:27], a[96:99], a[16:19], 0
 v_mfma_f32_16x16x32_bf16 v[24:27], a[100:103], a[20:23], v[24:27]
 v_mfma_f32_16x16x32_bf16 v[24:27], a[104:107], a[24:27], v[24:27]
 v_mfma_f32_16x16x32_bf16 v[24:27], a[108:111], a[28:31], v[24:27]
 v_mfma_f32_16x16x32_bf16 v[28:31], a[124:127], a[28:31], 0
 v_mfma_f32_16x16x32_bf16 v[28:31], a[120:123], a[24:27], v[28:31]
 v_mfma_f32_16x16x32_bf16 v[28:31], a[116:119], a[20:23], v[28:31]
 v_mfma_f32_16x16x32_bf16 v[28:31], a[112:115], a[16:19], v[28:31]
 v_mfma_f32_16x16x32_bf16 v[32:35], a[128:131], a[16:19], 0
 v_mfma_f32_16x16x32_bf16 v[32:35], a[132:135], a[20:23], v[32:35]
 v_mfma_f32_16x16x32_bf16 v[32:35], a[136:139], a[24:27], v[32:35]
 v_mfma_f32_16x16x32_bf16 v[32:35], a[140:143], a[28:31], v[32:35]
 v_mfma_f32_16x16x32_bf16 v[36:39], a[156:159], a[28:31], 0
 v_mfma_f32_16x16x32_bf16 v[36:39], a[152:155], a[24:27], v[36:39]
 v_mfma_f32_16x16x32_bf16 v[36:39], a[148:151], a[20:23], v[36:39]
 v_mfma_f32_16x16x32_bf16 v[36:39], a[144:147], a[16:19], v[36:39]
 s_nop 7
 v_fma_f32 v24, v24, s32, v17
 v_fma_f32 v25, v25, s32, v17
 v_fma_f32 v26, v26, s32, v17
 v_fma_f32 v27, v27, s32, v17
 v_fma_f32 v28, v28, s32, v17
 v_fma_f32 v29, v29, s32, v17
 v_fma_f32 v30, v30, s32, v17
 v_fma_f32 v31, v31, s32, v17
 v_exp_f32 v24, v24
 v_exp_f32 v25, v25
 v_exp_f32 v26, v26
 v_exp_f32 v27, v27
 v_exp_f32 v28, v28
 v_exp_f32 v29, v29
 v_exp_f32 v30, v30
 v_exp_f32 v31, v31
 s_nop 0
 v_cvt_pk_bf16_f32 v48, v24, v25
 v_cvt_pk_bf16_f32 v49, v26, v27
 v_cvt_pk_bf16_f32 v50, v28, v29
 v_cvt_pk_bf16_f32 v51, v30, v31
 v_fma_f32 v32, v32, s32, v17
 v_fma_f32 v33, v33, s32, v17
 v_fma_f32 v34, v34, s32, v17
 v_fma_f32 v35, v35, s32, v17
 v_fma_f32 v36, v36, s32, v17
 v_fma_f32 v37, v37, s32, v17
 v_fma_f32 v38, v38, s32, v17
 v_fma_f32 v39, v39, s32, v17
 v_exp_f32 v32, v32
 v_exp_f32 v33, v33
 v_exp_f32 v34, v34
 v_exp_f32 v35, v35
 v_exp_f32 v36, v36
 v_exp_f32 v37, v37
 v_exp_f32 v38, v38
 v_exp_f32 v39, v39
 s_nop 0
 v_cvt_pk_bf16_f32 v52, v32, v33
 v_cvt_pk_bf16_f32 v53, v34, v35
 v_cvt_pk_bf16_f32 v54, v36, v37
 v_cvt_pk_bf16_f32 v55, v38, v39
 s_nop 1
 v_smfmac_f32_16x16x64_bf16 a[224:227], a[240:243], v[48:55], v2
 v_mfma_f32_16x16x32_bf16 v[96:99], a[160:163], v[48:51], v[96:99]
 v_mfma_f32_16x16x32_bf16 v[96:99], a[192:195], v[52:55], v[96:99]
 v_mfma_f32_16x16x32_bf16 v[100:103], a[164:167], v[48:51], v[100:103]
 v_mfma_f32_16x16x32_bf16 v[100:103], a[196:199], v[52:55], v[100:103]
 v_mfma_f32_16x16x32_bf16 v[104:107], a[168:171], v[48:51], v[104:107]
 v_mfma_f32_16x16x32_bf16 v[104:107], a[200:203], v[52:55], v[104:107]
 v_mfma_f32_16x16x32_bf16 v[108:111], a[172:175], v[48:51], v[108:111]
 v_mfma_f32_16x16x32_bf16 v[108:111], a[204:207], v[52:55], v[108:111]
 v_mfma_f32_16x16x32_bf16 v[112:115], a[176:179], v[48:51], v[112:115]
 v_mfma_f32_16x16x32_bf16 v[112:115], a[208:211], v[52:55], v[112:115]
 v_mfma_f32_16x16x32_bf16 v[116:119], a[180:183], v[48:51], v[116:119]
 v_mfma_f32_16x16x32_bf16 v[116:119], a[212:215], v[52:55], v[116:119]
 v_mfma_f32_16x16x32_bf16 v[120:123], a[184:187], v[48:51], v[120:123]
 v_mfma_f32_16x16x32_bf16 v[120:123], a[216:219], v[52:55], v[120:123]
 v_mfma_f32_16x16x32_bf16 v[124:127], a[188:191], v[48:51], v[124:127]
 v_mfma_f32_16x16x32_bf16 v[124:127], a[220:223], v[52:55], v[124:127]
 v_mfma_f32_16x16x32_bf16 v[24:27], a[96:99], a[32:35], 0
 v_mfma_f32_16x16x32_bf16 v[24:27], a[100:103], a[36:39], v[24:27]
 v_mfma_f32_16x16x32_bf16 v[24:27], a[104:107], a[40:43], v[24:27]
 v_mfma_f32_16x16x32_bf16 v[24:27], a[108:111], a[44:47], v[24:27]
 v_mfma_f32_16x16x32_bf16 v[28:31], a[124:127], a[44:47], 0
 v_mfma_f32_16x16x32_bf16 v[28:31], a[120:123], a[40:43], v[28:31]
 v_mfma_f32_16x16x32_bf16 v[28:31], a[116:119], a[36:39], v[28:31]
 v_mfma_f32_16x16x32_bf16 v[28:31], a[112:115], a[32:35], v[28:31]
 v_mfma_f32_16x16x32_bf16 v[32:35], a[128:131], a[32:35], 0
 v_mfma_f32_16x16x32_bf16 v[32:35], a[132:135], a[36:39], v[32:35]
 v_mfma_f32_16x16x32_bf16 v[32:35], a[136:139], a[40:43], v[32:35]
 v_mfma_f32_16x16x32_bf16 v[32:35], a[140:143], a[44:47], v[32:35]
 v_mfma_f32_16x16x32_bf16 v[36:39], a[156:159], a[44:47], 0
 v_mfma_f32_16x16x32_bf16 v[36:39], a[152:155], a[40:43], v[36:39]
 v_mfma_f32_16x16x32_bf16 v[36:39], a[148:151], a[36:39], v[36:39]
 v_mfma_f32_16x16x32_bf16 v[36:39], a[144:147], a[32:35], v[36:39]
 s_nop 7
 v_fma_f32 v24, v24, s32, v18
 v_fma_f32 v25, v25, s32, v18
 v_fma_f32 v26, v26, s32, v18
 v_fma_f32 v27, v27, s32, v18
 v_fma_f32 v28, v28, s32, v18
 v_fma_f32 v29, v29, s32, v18
 v_fma_f32 v30, v30, s32, v18
 v_fma_f32 v31, v31, s32, v18
 v_exp_f32 v24, v24
 v_exp_f32 v25, v25
 v_exp_f32 v26, v26
 v_exp_f32 v27, v27
 v_exp_f32 v28, v28
 v_exp_f32 v29, v29
 v_exp_f32 v30, v30
 v_exp_f32 v31, v31
 s_nop 0
 v_cvt_pk_bf16_f32 v40, v24, v25
 v_cvt_pk_bf16_f32 v41, v26, v27
 v_cvt_pk_bf16_f32 v42, v28, v29
 v_cvt_pk_bf16_f32 v43, v30, v31
 v_fma_f32 v32, v32, s32, v18
 v_fma_f32 v33, v33, s32, v18
 v_fma_f32 v34, v34, s32, v18
 v_fma_f32 v35, v35, s32, v18
 v_fma_f32 v36, v36, s32, v18
 v_fma_f32 v37, v37, s32, v18
 v_fma_f32 v38, v38, s32, v18
 v_fma_f32 v39, v39, s32, v18
 v_exp_f32 v32, v32
 v_exp_f32 v33, v33
 v_exp_f32 v34, v34
 v_exp_f32 v35, v35
 v_exp_f32 v36, v36
 v_exp_f32 v37, v37
 v_exp_f32 v38, v38
 v_exp_f32 v39, v39
 s_nop 0
 v_cvt_pk_bf16_f32 v44, v32, v33
 v_cvt_pk_bf16_f32 v45, v34, v35
 v_cvt_pk_bf16_f32 v46, v36, v37
 v_cvt_pk_bf16_f32 v47, v38, v39
 s_nop 1
 v_smfmac_f32_16x16x64_bf16 a[228:231], a[236:239], v[40:47], v2
 v_mfma_f32_16x16x32_bf16 v[128:131], a[160:163], v[40:43], v[128:131]
 v_mfma_f32_16x16x32_bf16 v[128:131], a[192:195], v[44:47], v[128:131]
 v_mfma_f32_16x16x32_bf16 v[132:135], a[164:167], v[40:43], v[132:135]
 v_mfma_f32_16x16x32_bf16 v[132:135], a[196:199], v[44:47], v[132:135]
 v_mfma_f32_16x16x32_bf16 v[136:139], a[168:171], v[40:43], v[136:139]
 v_mfma_f32_16x16x32_bf16 v[136:139], a[200:203], v[44:47], v[136:139]
 v_mfma_f32_16x16x32_bf16 v[140:143], a[172:175], v[40:43], v[140:143]
 v_mfma_f32_16x16x32_bf16 v[140:143], a[204:207], v[44:47], v[140:143]
 v_mfma_f32_16x16x32_bf16 v[144:147], a[176:179], v[40:43], v[144:147]
 v_mfma_f32_16x16x32_bf16 v[144:147], a[208:211], v[44:47], v[144:147]
 v_mfma_f32_16x16x32_bf16 v[148:151], a[180:183], v[40:43], v[148:151]
 v_mfma_f32_16x16x32_bf16 v[148:151], a[212:215], v[44:47], v[148:151]
 v_mfma_f32_16x16x32_bf16 v[152:155], a[184:187], v[40:43], v[152:155]
 v_mfma_f32_16x16x32_bf16 v[152:155], a[216:219], v[44:47], v[152:155]
 v_mfma_f32_16x16x32_bf16 v[156:159], a[188:191], v[40:43], v[156:159]
 v_mfma_f32_16x16x32_bf16 v[156:159], a[220:223], v[44:47], v[156:159]
 v_mfma_f32_16x16x32_bf16 v[24:27], a[96:99], a[48:51], 0
 v_mfma_f32_16x16x32_bf16 v[24:27], a[100:103], a[52:55], v[24:27]
 v_mfma_f32_16x16x32_bf16 v[24:27], a[104:107], a[56:59], v[24:27]
 v_mfma_f32_16x16x32_bf16 v[24:27], a[108:111], a[60:63], v[24:27]
 v_mfma_f32_16x16x32_bf16 v[28:31], a[124:127], a[60:63], 0
 v_mfma_f32_16x16x32_bf16 v[28:31], a[120:123], a[56:59], v[28:31]
 v_mfma_f32_16x16x32_bf16 v[28:31], a[116:119], a[52:55], v[28:31]
 v_mfma_f32_16x16x32_bf16 v[28:31], a[112:115], a[48:51], v[28:31]
 v_mfma_f32_16x16x32_bf16 v[32:35], a[128:131], a[48:51], 0
 v_mfma_f32_16x16x32_bf16 v[32:35], a[132:135], a[52:55], v[32:35]
 v_mfma_f32_16x16x32_bf16 v[32:35], a[136:139], a[56:59], v[32:35]
 v_mfma_f32_16x16x32_bf16 v[32:35], a[140:143], a[60:63], v[32:35]
 v_mfma_f32_16x16x32_bf16 v[36:39], a[156:159], a[60:63], 0
 v_mfma_f32_16x16x32_bf16 v[36:39], a[152:155], a[56:59], v[36:39]
 v_mfma_f32_16x16x32_bf16 v[36:39], a[148:151], a[52:55], v[36:39]
 v_mfma_f32_16x16x32_bf16 v[36:39], a[144:147], a[48:51], v[36:39]
 s_nop 7
 v_fma_f32 v24, v24, s32, v19
 v_fma_f32 v25, v25, s32, v19
 v_fma_f32 v26, v26, s32, v19
 v_fma_f32 v27, v27, s32, v19
 v_fma_f32 v28, v28, s32, v19
 v_fma_f32 v29, v29, s32, v19
 v_fma_f32 v30, v30, s32, v19
 v_fma_f32 v31, v31, s32, v19
 v_exp_f32 v24, v24
 v_exp_f32 v25, v25
 v_exp_f32 v26, v26
 v_exp_f32 v27, v27
 v_exp_f32 v28, v28
 v_exp_f32 v29, v29
 v_exp_f32 v30, v30
 v_exp_f32 v31, v31
 s_nop 0
 v_cvt_pk_bf16_f32 v48, v24, v25
 v_cvt_pk_bf16_f32 v49, v26, v27
 v_cvt_pk_bf16_f32 v50, v28, v29
 v_cvt_pk_bf16_f32 v51, v30, v31
 v_fma_f32 v32, v32, s32, v19
 v_fma_f32 v33, v33, s32, v19
 v_fma_f32 v34, v34, s32, v19
 v_fma_f32 v35, v35, s32, v19
 v_fma_f32 v36, v36, s32, v19
 v_fma_f32 v37, v37, s32, v19
 v_fma_f32 v38, v38, s32, v19
 v_fma_f32 v39, v39, s32, v19
 v_exp_f32 v32, v32
 v_exp_f32 v33, v33
 v_exp_f32 v34, v34
 v_exp_f32 v35, v35
 v_exp_f32 v36, v36
 v_exp_f32 v37, v37
 v_exp_f32 v38, v38
 v_exp_f32 v39, v39
 s_nop 0
 v_cvt_pk_bf16_f32 v52, v32, v33
 v_cvt_pk_bf16_f32 v53, v34, v35
 v_cvt_pk_bf16_f32 v54, v36, v37
 v_cvt_pk_bf16_f32 v55, v38, v39
 s_nop 1
 v_smfmac_f32_16x16x64_bf16 a[228:231], a[240:243], v[48:55], v2
 v_mfma_f32_16x16x32_bf16 v[160:163], a[160:163], v[48:51], v[160:163]
 v_mfma_f32_16x16x32_bf16 v[160:163], a[192:195], v[52:55], v[160:163]
 v_mfma_f32_16x16x32_bf16 v[164:167], a[164:167], v[48:51], v[164:167]
 v_mfma_f32_16x16x32_bf16 v[164:167], a[196:199], v[52:55], v[164:167]
 v_mfma_f32_16x16x32_bf16 v[168:171], a[168:171], v[48:51], v[168:171]
 v_mfma_f32_16x16x32_bf16 v[168:171], a[200:203], v[52:55], v[168:171]
 v_mfma_f32_16x16x32_bf16 v[172:175], a[172:175], v[48:51], v[172:175]
 v_mfma_f32_16x16x32_bf16 v[172:175], a[204:207], v[52:55], v[172:175]
 v_mfma_f32_16x16x32_bf16 v[176:179], a[176:179], v[48:51], v[176:179]
 v_mfma_f32_16x16x32_bf16 v[176:179], a[208:211], v[52:55], v[176:179]
 v_mfma_f32_16x16x32_bf16 v[180:183], a[180:183], v[48:51], v[180:183]
 v_mfma_f32_16x16x32_bf16 v[180:183], a[212:215], v[52:55], v[180:183]
 v_mfma_f32_16x16x32_bf16 v[184:187], a[184:187], v[48:51], v[184:187]
 v_mfma_f32_16x16x32_bf16 v[184:187], a[216:219], v[52:55], v[184:187]
 v_mfma_f32_16x16x32_bf16 v[188:191], a[188:191], v[48:51], v[188:191]
 v_mfma_f32_16x16x32_bf16 v[188:191], a[220:223], v[52:55], v[188:191]
 v_mfma_f32_16x16x32_bf16 v[24:27], a[96:99], a[64:67], 0
 v_mfma_f32_16x16x32_bf16 v[24:27], a[100:103], a[68:71], v[24:27]
 v_mfma_f32_16x16x32_bf16 v[24:27], a[104:107], a[72:75], v[24:27]
 v_mfma_f32_16x16x32_bf16 v[24:27], a[108:111], a[76:79], v[24:27]
 v_mfma_f32_16x16x32_bf16 v[28:31], a[124:127], a[76:79], 0
 v_mfma_f32_16x16x32_bf16 v[28:31], a[120:123], a[72:75], v[28:31]
 v_mfma_f32_16x16x32_bf16 v[28:31], a[116:119], a[68:71], v[28:31]
 v_mfma_f32_16x16x32_bf16 v[28:31], a[112:115], a[64:67], v[28:31]
 v_mfma_f32_16x16x32_bf16 v[32:35], a[128:131], a[64:67], 0
 v_mfma_f32_16x16x32_bf16 v[32:35], a[132:135], a[68:71], v[32:35]
 v_mfma_f32_16x16x32_bf16 v[32:35], a[136:139], a[72:75], v[32:35]
 v_mfma_f32_16x16x32_bf16 v[32:35], a[140:143], a[76:79], v[32:35]
 v_mfma_f32_16x16x32_bf16 v[36:39], a[156:159], a[76:79], 0
 v_mfma_f32_16x16x32_bf16 v[36:39], a[152:155], a[72:75], v[36:39]
 v_mfma_f32_16x16x32_bf16 v[36:39], a[148:151], a[68:71], v[36:39]
 v_mfma_f32_16x16x32_bf16 v[36:39], a[144:147], a[64:67], v[36:39]
 s_nop 7
 v_fma_f32 v24, v24, s32, v20
 v_fma_f32 v25, v25, s32, v20
 v_fma_f32 v26, v26, s32, v20
 v_fma_f32 v27, v27, s32, v20
 v_fma_f32 v28, v28, s32, v20
 v_fma_f32 v29, v29, s32, v20
 v_fma_f32 v30, v30, s32, v20
 v_fma_f32 v31, v31, s32, v20
 v_exp_f32 v24, v24
 v_exp_f32 v25, v25
 v_exp_f32 v26, v26
 v_exp_f32 v27, v27
 v_exp_f32 v28, v28
 v_exp_f32 v29, v29
 v_exp_f32 v30, v30
 v_exp_f32 v31, v31
 s_nop 0
 v_cvt_pk_bf16_f32 v40, v24, v25
 v_cvt_pk_bf16_f32 v41, v26, v27
 v_cvt_pk_bf16_f32 v42, v28, v29
 v_cvt_pk_bf16_f32 v43, v30, v31
 v_fma_f32 v32, v32, s32, v20
 v_fma_f32 v33, v33, s32, v20
 v_fma_f32 v34, v34, s32, v20
 v_fma_f32 v35, v35, s32, v20
 v_fma_f32 v36, v36, s32, v20
 v_fma_f32 v37, v37, s32, v20
 v_fma_f32 v38, v38, s32, v20
 v_fma_f32 v39, v39, s32, v20
 v_exp_f32 v32, v32
 v_exp_f32 v33, v33
 v_exp_f32 v34, v34
 v_exp_f32 v35, v35
 v_exp_f32 v36, v36
 v_exp_f32 v37, v37
 v_exp_f32 v38, v38
 v_exp_f32 v39, v39
 s_nop 0
 v_cvt_pk_bf16_f32 v44, v32, v33
 v_cvt_pk_bf16_f32 v45, v34, v35
 v_cvt_pk_bf16_f32 v46, v36, v37
 v_cvt_pk_bf16_f32 v47, v38, v39
 s_nop 1
 v_smfmac_f32_16x16x64_bf16 a[232:235], a[236:239], v[40:47], v2
 v_mfma_f32_16x16x32_bf16 v[192:195], a[160:163], v[40:43], v[192:195]
 v_mfma_f32_16x16x32_bf16 v[192:195], a[192:195], v[44:47], v[192:195]
 v_mfma_f32_16x16x32_bf16 v[196:199], a[164:167], v[40:43], v[196:199]
 v_mfma_f32_16x16x32_bf16 v[196:199], a[196:199], v[44:47], v[196:199]
 v_mfma_f32_16x16x32_bf16 v[200:203], a[168:171], v[40:43], v[200:203]
 v_mfma_f32_16x16x32_bf16 v[200:203], a[200:203], v[44:47], v[200:203]
 v_mfma_f32_16x16x32_bf16 v[204:207], a[172:175], v[40:43], v[204:207]
 v_mfma_f32_16x16x32_bf16 v[204:207], a[204:207], v[44:47], v[204:207]
 v_mfma_f32_16x16x32_bf16 v[208:211], a[176:179], v[40:43], v[208:211]
 v_mfma_f32_16x16x32_bf16 v[208:211], a[208:211], v[44:47], v[208:211]
 v_mfma_f32_16x16x32_bf16 v[212:215], a[180:183], v[40:43], v[212:215]
 v_mfma_f32_16x16x32_bf16 v[212:215], a[212:215], v[44:47], v[212:215]
 v_mfma_f32_16x16x32_bf16 v[216:219], a[184:187], v[40:43], v[216:219]
 v_mfma_f32_16x16x32_bf16 v[216:219], a[216:219], v[44:47], v[216:219]
 v_mfma_f32_16x16x32_bf16 v[220:223], a[188:191], v[40:43], v[220:223]
 v_mfma_f32_16x16x32_bf16 v[220:223], a[220:223], v[44:47], v[220:223]
 v_mfma_f32_16x16x32_bf16 v[24:27], a[96:99], a[80:83], 0
 v_mfma_f32_16x16x32_bf16 v[24:27], a[100:103], a[84:87], v[24:27]
 v_mfma_f32_16x16x32_bf16 v[24:27], a[104:107], a[88:91], v[24:27]
 v_mfma_f32_16x16x32_bf16 v[24:27], a[108:111], a[92:95], v[24:27]
 v_mfma_f32_16x16x32_bf16 v[28:31], a[124:127], a[92:95], 0
 v_mfma_f32_16x16x32_bf16 v[28:31], a[120:123], a[88:91], v[28:31]
 v_mfma_f32_16x16x32_bf16 v[28:31], a[116:119], a[84:87], v[28:31]
 v_mfma_f32_16x16x32_bf16 v[28:31], a[112:115], a[80:83], v[28:31]
 v_mfma_f32_16x16x32_bf16 v[32:35], a[128:131], a[80:83], 0
 v_mfma_f32_16x16x32_bf16 v[32:35], a[132:135], a[84:87], v[32:35]
 v_mfma_f32_16x16x32_bf16 v[32:35], a[136:139], a[88:91], v[32:35]
 v_mfma_f32_16x16x32_bf16 v[32:35], a[140:143], a[92:95], v[32:35]
 v_mfma_f32_16x16x32_bf16 v[36:39], a[156:159], a[92:95], 0
 v_mfma_f32_16x16x32_bf16 v[36:39], a[152:155], a[88:91], v[36:39]
 v_mfma_f32_16x16x32_bf16 v[36:39], a[148:151], a[84:87], v[36:39]
 v_mfma_f32_16x16x32_bf16 v[36:39], a[144:147], a[80:83], v[36:39]
 s_nop 7
 v_fma_f32 v24, v24, s32, v21
 v_fma_f32 v25, v25, s32, v21
 v_fma_f32 v26, v26, s32, v21
 v_fma_f32 v27, v27, s32, v21
 v_fma_f32 v28, v28, s32, v21
 v_fma_f32 v29, v29, s32, v21
 v_fma_f32 v30, v30, s32, v21
 v_fma_f32 v31, v31, s32, v21
 v_exp_f32 v24, v24
 v_exp_f32 v25, v25
 v_exp_f32 v26, v26
 v_exp_f32 v27, v27
 v_exp_f32 v28, v28
 v_exp_f32 v29, v29
 v_exp_f32 v30, v30
 v_exp_f32 v31, v31
 s_nop 0
 v_cvt_pk_bf16_f32 v48, v24, v25
 v_cvt_pk_bf16_f32 v49, v26, v27
 v_cvt_pk_bf16_f32 v50, v28, v29
 v_cvt_pk_bf16_f32 v51, v30, v31
 v_fma_f32 v32, v32, s32, v21
 v_fma_f32 v33, v33, s32, v21
 v_fma_f32 v34, v34, s32, v21
 v_fma_f32 v35, v35, s32, v21
 v_fma_f32 v36, v36, s32, v21
 v_fma_f32 v37, v37, s32, v21
 v_fma_f32 v38, v38, s32, v21
 v_fma_f32 v39, v39, s32, v21
 v_exp_f32 v32, v32
 v_exp_f32 v33, v33
 v_exp_f32 v34, v34
 v_exp_f32 v35, v35
 v_exp_f32 v36, v36
 v_exp_f32 v37, v37
 v_exp_f32 v38, v38
 v_exp_f32 v39, v39
 s_nop 0
 v_cvt_pk_bf16_f32 v52, v32, v33
 v_cvt_pk_bf16_f32 v53, v34, v35
 v_cvt_pk_bf16_f32 v54, v36, v37
 v_cvt_pk_bf16_f32 v55, v38, v39
 s_nop 1
 v_smfmac_f32_16x16x64_bf16 a[232:235], a[240:243], v[48:55], v2
 v_mfma_f32_16x16x32_bf16 v[224:227], a[160:163], v[48:51], v[224:227]
 v_mfma_f32_16x16x32_bf16 v[224:227], a[192:195], v[52:55], v[224:227]
 v_mfma_f32_16x16x32_bf16 v[228:231], a[164:167], v[48:51], v[228:231]
 v_mfma_f32_16x16x32_bf16 v[228:231], a[196:199], v[52:55], v[228:231]
 v_mfma_f32_16x16x32_bf16 v[232:235], a[168:171], v[48:51], v[232:235]
 v_mfma_f32_16x16x32_bf16 v[232:235], a[200:203], v[52:55], v[232:235]
 v_mfma_f32_16x16x32_bf16 v[236:239], a[172:175], v[48:51], v[236:239]
 v_mfma_f32_16x16x32_bf16 v[236:239], a[204:207], v[52:55], v[236:239]
 v_mfma_f32_16x16x32_bf16 v[240:243], a[176:179], v[48:51], v[240:243]
 v_mfma_f32_16x16x32_bf16 v[240:243], a[208:211], v[52:55], v[240:243]
 v_mfma_f32_16x16x32_bf16 v[244:247], a[180:183], v[48:51], v[244:247]
 v_mfma_f32_16x16x32_bf16 v[244:247], a[212:215], v[52:55], v[244:247]
 v_mfma_f32_16x16x32_bf16 v[248:251], a[184:187], v[48:51], v[248:251]
 v_mfma_f32_16x16x32_bf16 v[248:251], a[216:219], v[52:55], v[248:251]
 v_mfma_f32_16x16x32_bf16 v[252:255], a[188:191], v[48:51], v[252:255]
 v_mfma_f32_16x16x32_bf16 v[252:255], a[220:223], v[52:55], v[252:255]
 s_add_u32 s40, s40, 1
 s_cmp_lt_u32 s40, 8
 s_cbranch_scc1 L_slowloop
 s_nop 7
 v_accvgpr_read_b32 v11, a224
 v_accvgpr_read_b32 v10, a225
 v_add_f32 v11, v11, v10
 v_rcp_f32 v10, v11
 v_cmp_nle_f32 vcc, s60, v11
 v_pk_mul_f32 v[64:65], v[64:65], v[10:11] op_sel_hi:[1,0]
 v_pk_mul_f32 v[66:67], v[66:67], v[10:11] op_sel_hi:[1,0]
 v_pk_mul_f32 v[68:69], v[68:69], v[10:11] op_sel_hi:[1,0]
 v_pk_mul_f32 v[70:71], v[70:71], v[10:11] op_sel_hi:[1,0]
 v_pk_mul_f32 v[72:73], v[72:73], v[10:11] op_sel_hi:[1,0]
 v_pk_mul_f32 v[74:75], v[74:75], v[10:11] op_sel_hi:[1,0]
 v_pk_mul_f32 v[76:77], v[76:77], v[10:11] op_sel_hi:[1,0]
 v_pk_mul_f32 v[78:79], v[78:79], v[10:11] op_sel_hi:[1,0]
 v_pk_mul_f32 v[80:81], v[80:81], v[10:11] op_sel_hi:[1,0]
 v_pk_mul_f32 v[82:83], v[82:83], v[10:11] op_sel_hi:[1,0]
 v_pk_mul_f32 v[84:85], v[84:85], v[10:11] op_sel_hi:[1,0]
 v_pk_mul_f32 v[86:87], v[86:87], v[10:11] op_sel_hi:[1,0]
 v_pk_mul_f32 v[88:89], v[88:89], v[10:11] op_sel_hi:[1,0]
 v_pk_mul_f32 v[90:91], v[90:91], v[10:11] op_sel_hi:[1,0]
 v_pk_mul_f32 v[92:93], v[92:93], v[10:11] op_sel_hi:[1,0]
 v_pk_mul_f32 v[94:95], v[94:95], v[10:11] op_sel_hi:[1,0]
 s_or_b64 s[50:51], s[50:51], vcc
 v_cmp_nge_f32 vcc, s61, v11
 v_add_u32 v12, 0, v5
 v_cvt_pk_bf16_f32 v64, v64, v65
 v_cvt_pk_bf16_f32 v65, v66, v67
 v_cvt_pk_bf16_f32 v68, v68, v69
 v_cvt_pk_bf16_f32 v69, v70, v71
 s_or_b64 s[50:51], s[50:51], vcc
 ds_write2_b64 v12, v[64:65], v[68:69] offset0:0 offset1:4
 v_cvt_pk_bf16_f32 v72, v72, v73
 v_cvt_pk_bf16_f32 v73, v74, v75
 v_cvt_pk_bf16_f32 v76, v76, v77
 v_cvt_pk_bf16_f32 v77, v78, v79
 ds_write2_b64 v12, v[72:73], v[76:77] offset0:8 offset1:12
 v_cvt_pk_bf16_f32 v80, v80, v81
 v_cvt_pk_bf16_f32 v81, v82, v83
 v_cvt_pk_bf16_f32 v84, v84, v85
 v_cvt_pk_bf16_f32 v85, v86, v87
 ds_write2_b64 v12, v[80:81], v[84:85] offset0:16 offset1:20
 v_cvt_pk_bf16_f32 v88, v88, v89
 v_cvt_pk_bf16_f32 v89, v90, v91
 v_cvt_pk_bf16_f32 v92, v92, v93
 v_cvt_pk_bf16_f32 v93, v94, v95
 ds_write2_b64 v12, v[88:89], v[92:93] offset0:24 offset1:28
 ds_read_b128 v[64:67], v6 offset:0
 ds_read_b128 v[68:71], v6 offset:1088
 ds_read_b128 v[72:75], v6 offset:2176
 ds_read_b128 v[76:79], v6 offset:3264
 s_mov_b32 s59, 0
 s_waitcnt lgkmcnt(3)
 buffer_store_dwordx4 v[64:67], v1, s[24:27], s59 offen sc1 nt
 s_waitcnt lgkmcnt(2)
 buffer_store_dwordx4 v[68:71], v1, s[24:27], s59 offen offset:1024 sc1 nt
 s_waitcnt lgkmcnt(1)
 buffer_store_dwordx4 v[72:75], v1, s[24:27], s59 offen offset:2048 sc1 nt
 s_waitcnt lgkmcnt(0)
 buffer_store_dwordx4 v[76:79], v1, s[24:27], s59 offen offset:3072 sc1 nt
 v_accvgpr_read_b32 v11, a226
 v_accvgpr_read_b32 v10, a227
 v_add_f32 v11, v11, v10
 v_rcp_f32 v10, v11
 v_cmp_nle_f32 vcc, s60, v11
 v_pk_mul_f32 v[96:97], v[96:97], v[10:11] op_sel_hi:[1,0]
 v_pk_mul_f32 v[98:99], v[98:99], v[10:11] op_sel_hi:[1,0]
 v_pk_mul_f32 v[100:101], v[100:101], v[10:11] op_sel_hi:[1,0]
 v_pk_mul_f32 v[102:103], v[102:103], v[10:11] op_sel_hi:[1,0]
 v_pk_mul_f32 v[104:105], v[104:105], v[10:11] op_sel_hi:[1,0]
 v_pk_mul_f32 v[106:107], v[106:107], v[10:11] op_sel_hi:[1,0]
 v_pk_mul_f32 v[108:109], v[108:109], v[10:11] op_sel_hi:[1,0]
 v_pk_mul_f32 v[110:111], v[110:111], v[10:11] op_sel_hi:[1,0]
 v_pk_mul_f32 v[112:113], v[112:113], v[10:11] op_sel_hi:[1,0]
 v_pk_mul_f32 v[114:115], v[114:115], v[10:11] op_sel_hi:[1,0]
 v_pk_mul_f32 v[116:117], v[116:117], v[10:11] op_sel_hi:[1,0]
 v_pk_mul_f32 v[118:119], v[118:119], v[10:11] op_sel_hi:[1,0]
 v_pk_mul_f32 v[120:121], v[120:121], v[10:11] op_sel_hi:[1,0]
 v_pk_mul_f32 v[122:123], v[122:123], v[10:11] op_sel_hi:[1,0]
 v_pk_mul_f32 v[124:125], v[124:125], v[10:11] op_sel_hi:[1,0]
 v_pk_mul_f32 v[126:127], v[126:127], v[10:11] op_sel_hi:[1,0]
 s_or_b64 s[50:51], s[50:51], vcc
 v_cmp_nge_f32 vcc, s61, v11
 v_add_u32 v12, 17408, v5
 v_cvt_pk_bf16_f32 v96, v96, v97
 v_cvt_pk_bf16_f32 v97, v98, v99
 v_cvt_pk_bf16_f32 v100, v100, v101
 v_cvt_pk_bf16_f32 v101, v102, v103
 s_or_b64 s[50:51], s[50:51], vcc
 ds_write2_b64 v12, v[96:97], v[100:101] offset0:0 offset1:4
 v_cvt_pk_bf16_f32 v104, v104, v105
 v_cvt_pk_bf16_f32 v105, v106, v107
 v_cvt_pk_bf16_f32 v108, v108, v109
 v_cvt_pk_bf16_f32 v109, v110, v111
 ds_write2_b64 v12, v[104:105], v[108:109] offset0:8 offset1:12
 v_cvt_pk_bf16_f32 v112, v112, v113
 v_cvt_pk_bf16_f32 v113, v114, v115
 v_cvt_pk_bf16_f32 v116, v116, v117
 v_cvt_pk_bf16_f32 v117, v118, v119
 ds_write2_b64 v12, v[112:113], v[116:117] offset0:16 offset1:20
 v_cvt_pk_bf16_f32 v120, v120, v121
 v_cvt_pk_bf16_f32 v121, v122, v123
 v_cvt_pk_bf16_f32 v124, v124, v125
 v_cvt_pk_bf16_f32 v125, v126, v127
 ds_write2_b64 v12, v[120:121], v[124:125] offset0:24 offset1:28
 ds_read_b128 v[96:99], v6 offset:17408
 ds_read_b128 v[100:103], v6 offset:18496
 ds_read_b128 v[104:107], v6 offset:19584
 ds_read_b128 v[108:111], v6 offset:20672
 s_mov_b32 s59, 4096
 s_waitcnt lgkmcnt(3)
 buffer_store_dwordx4 v[96:99], v1, s[24:27], s59 offen sc1 nt
 s_waitcnt lgkmcnt(2)
 buffer_store_dwordx4 v[100:103], v1, s[24:27], s59 offen offset:1024 sc1 nt
 s_waitcnt lgkmcnt(1)
 buffer_store_dwordx4 v[104:107], v1, s[24:27], s59 offen offset:2048 sc1 nt
 s_waitcnt lgkmcnt(0)
 buffer_store_dwordx4 v[108:111], v1, s[24:27], s59 offen offset:3072 sc1 nt
 v_accvgpr_read_b32 v11, a228
 v_accvgpr_read_b32 v10, a229
 v_add_f32 v11, v11, v10
 v_rcp_f32 v10, v11
 v_cmp_nle_f32 vcc, s60, v11
 v_pk_mul_f32 v[128:129], v[128:129], v[10:11] op_sel_hi:[1,0]
 v_pk_mul_f32 v[130:131], v[130:131], v[10:11] op_sel_hi:[1,0]
 v_pk_mul_f32 v[132:133], v[132:133], v[10:11] op_sel_hi:[1,0]
 v_pk_mul_f32 v[134:135], v[134:135], v[10:11] op_sel_hi:[1,0]
 v_pk_mul_f32 v[136:137], v[136:137], v[10:11] op_sel_hi:[1,0]
 v_pk_mul_f32 v[138:139], v[138:139], v[10:11] op_sel_hi:[1,0]
 v_pk_mul_f32 v[140:141], v[140:141], v[10:11] op_sel_hi:[1,0]
 v_pk_mul_f32 v[142:143], v[142:143], v[10:11] op_sel_hi:[1,0]
 v_pk_mul_f32 v[144:145], v[144:145], v[10:11] op_sel_hi:[1,0]
 v_pk_mul_f32 v[146:147], v[146:147], v[10:11] op_sel_hi:[1,0]
 v_pk_mul_f32 v[148:149], v[148:149], v[10:11] op_sel_hi:[1,0]
 v_pk_mul_f32 v[150:151], v[150:151], v[10:11] op_sel_hi:[1,0]
 v_pk_mul_f32 v[152:153], v[152:153], v[10:11] op_sel_hi:[1,0]
 v_pk_mul_f32 v[154:155], v[154:155], v[10:11] op_sel_hi:[1,0]
 v_pk_mul_f32 v[156:157], v[156:157], v[10:11] op_sel_hi:[1,0]
 v_pk_mul_f32 v[158:159], v[158:159], v[10:11] op_sel_hi:[1,0]
 s_or_b64 s[50:51], s[50:51], vcc
 v_cmp_nge_f32 vcc, s61, v11
 v_add_u32 v12, 4352, v5
 v_cvt_pk_bf16_f32 v128, v128, v129
 v_cvt_pk_bf16_f32 v129, v130, v131
 v_cvt_pk_bf16_f32 v132, v132, v133
 v_cvt_pk_bf16_f32 v133, v134, v135
 s_or_b64 s[50:51], s[50:51], vcc
 ds_write2_b64 v12, v[128:129], v[132:133] offset0:0 offset1:4
 v_cvt_pk_bf16_f32 v136, v136, v137
 v_cvt_pk_bf16_f32 v137, v138, v139
 v_cvt_pk_bf16_f32 v140, v140, v141
 v_cvt_pk_bf16_f32 v141, v142, v143
 ds_write2_b64 v12, v[136:137], v[140:141] offset0:8 offset1:12
 v_cvt_pk_bf16_f32 v144, v144, v145
 v_cvt_pk_bf16_f32 v145, v146, v147
 v_cvt_pk_bf16_f32 v148, v148, v149
 v_cvt_pk_bf16_f32 v149, v150, v151
 ds_write2_b64 v12, v[144:145], v[148:149] offset0:16 offset1:20
 v_cvt_pk_bf16_f32 v152, v152, v153
 v_cvt_pk_bf16_f32 v153, v154, v155
 v_cvt_pk_bf16_f32 v156, v156, v157
 v_cvt_pk_bf16_f32 v157, v158, v159
 ds_write2_b64 v12, v[152:153], v[156:157] offset0:24 offset1:28
 ds_read_b128 v[128:131], v6 offset:4352
 ds_read_b128 v[132:135], v6 offset:5440
 ds_read_b128 v[136:139], v6 offset:6528
 ds_read_b128 v[140:143], v6 offset:7616
 s_mov_b32 s59, 8192
 s_waitcnt lgkmcnt(3)
 buffer_store_dwordx4 v[128:131], v1, s[24:27], s59 offen sc1 nt
 s_waitcnt lgkmcnt(2)
 buffer_store_dwordx4 v[132:135], v1, s[24:27], s59 offen offset:1024 sc1 nt
 s_waitcnt lgkmcnt(1)
 buffer_store_dwordx4 v[136:139], v1, s[24:27], s59 offen offset:2048 sc1 nt
 s_waitcnt lgkmcnt(0)
 buffer_store_dwordx4 v[140:143], v1, s[24:27], s59 offen offset:3072 sc1 nt
 v_accvgpr_read_b32 v11, a230
 v_accvgpr_read_b32 v10, a231
 v_add_f32 v11, v11, v10
 v_rcp_f32 v10, v11
 v_cmp_nle_f32 vcc, s60, v11
 v_pk_mul_f32 v[160:161], v[160:161], v[10:11] op_sel_hi:[1,0]
 v_pk_mul_f32 v[162:163], v[162:163], v[10:11] op_sel_hi:[1,0]
 v_pk_mul_f32 v[164:165], v[164:165], v[10:11] op_sel_hi:[1,0]
 v_pk_mul_f32 v[166:167], v[166:167], v[10:11] op_sel_hi:[1,0]
 v_pk_mul_f32 v[168:169], v[168:169], v[10:11] op_sel_hi:[1,0]
 v_pk_mul_f32 v[170:171], v[170:171], v[10:11] op_sel_hi:[1,0]
 v_pk_mul_f32 v[172:173], v[172:173], v[10:11] op_sel_hi:[1,0]
 v_pk_mul_f32 v[174:175], v[174:175], v[10:11] op_sel_hi:[1,0]
 v_pk_mul_f32 v[176:177], v[176:177], v[10:11] op_sel_hi:[1,0]
 v_pk_mul_f32 v[178:179], v[178:179], v[10:11] op_sel_hi:[1,0]
 v_pk_mul_f32 v[180:181], v[180:181], v[10:11] op_sel_hi:[1,0]
 v_pk_mul_f32 v[182:183], v[182:183], v[10:11] op_sel_hi:[1,0]
 v_pk_mul_f32 v[184:185], v[184:185], v[10:11] op_sel_hi:[1,0]
 v_pk_mul_f32 v[186:187], v[186:187], v[10:11] op_sel_hi:[1,0]
 v_pk_mul_f32 v[188:189], v[188:189], v[10:11] op_sel_hi:[1,0]
 v_pk_mul_f32 v[190:191], v[190:191], v[10:11] op_sel_hi:[1,0]
 s_or_b64 s[50:51], s[50:51], vcc
 v_cmp_nge_f32 vcc, s61, v11
 v_add_u32 v12, 8704, v5
 v_cvt_pk_bf16_f32 v160, v160, v161
 v_cvt_pk_bf16_f32 v161, v162, v163
 v_cvt_pk_bf16_f32 v164, v164, v165
 v_cvt_pk_bf16_f32 v165, v166, v167
 s_or_b64 s[50:51], s[50:51], vcc
 ds_write2_b64 v12, v[160:161], v[164:165] offset0:0 offset1:4
 v_cvt_pk_bf16_f32 v168, v168, v169
 v_cvt_pk_bf16_f32 v169, v170, v171
 v_cvt_pk_bf16_f32 v172, v172, v173
 v_cvt_pk_bf16_f32 v173, v174, v175
 ds_write2_b64 v12, v[168:169], v[172:173] offset0:8 offset1:12
 v_cvt_pk_bf16_f32 v176, v176, v177
 v_cvt_pk_bf16_f32 v177, v178, v179
 v_cvt_pk_bf16_f32 v180, v180, v181
 v_cvt_pk_bf16_f32 v181, v182, v183
 ds_write2_b64 v12, v[176:177], v[180:181] offset0:16 offset1:20
 v_cvt_pk_bf16_f32 v184, v184, v185
 v_cvt_pk_bf16_f32 v185, v186, v187
 v_cvt_pk_bf16_f32 v188, v188, v189
 v_cvt_pk_bf16_f32 v189, v190, v191
 ds_write2_b64 v12, v[184:185], v[188:189] offset0:24 offset1:28
 ds_read_b128 v[160:163], v6 offset:8704
 ds_read_b128 v[164:167], v6 offset:9792
 ds_read_b128 v[168:171], v6 offset:10880
 ds_read_b128 v[172:175], v6 offset:11968
 s_mov_b32 s59, 12288
 s_waitcnt lgkmcnt(3)
 buffer_store_dwordx4 v[160:163], v1, s[24:27], s59 offen sc1 nt
 s_waitcnt lgkmcnt(2)
 buffer_store_dwordx4 v[164:167], v1, s[24:27], s59 offen offset:1024 sc1 nt
 s_waitcnt lgkmcnt(1)
 buffer_store_dwordx4 v[168:171], v1, s[24:27], s59 offen offset:2048 sc1 nt
 s_waitcnt lgkmcnt(0)
 buffer_store_dwordx4 v[172:175], v1, s[24:27], s59 offen offset:3072 sc1 nt
 v_accvgpr_read_b32 v11, a232
 v_accvgpr_read_b32 v10, a233
 v_add_f32 v11, v11, v10
 v_rcp_f32 v10, v11
 v_cmp_nle_f32 vcc, s60, v11
 v_pk_mul_f32 v[192:193], v[192:193], v[10:11] op_sel_hi:[1,0]
 v_pk_mul_f32 v[194:195], v[194:195], v[10:11] op_sel_hi:[1,0]
 v_pk_mul_f32 v[196:197], v[196:197], v[10:11] op_sel_hi:[1,0]
 v_pk_mul_f32 v[198:199], v[198:199], v[10:11] op_sel_hi:[1,0]
 v_pk_mul_f32 v[200:201], v[200:201], v[10:11] op_sel_hi:[1,0]
 v_pk_mul_f32 v[202:203], v[202:203], v[10:11] op_sel_hi:[1,0]
 v_pk_mul_f32 v[204:205], v[204:205], v[10:11] op_sel_hi:[1,0]
 v_pk_mul_f32 v[206:207], v[206:207], v[10:11] op_sel_hi:[1,0]
 v_pk_mul_f32 v[208:209], v[208:209], v[10:11] op_sel_hi:[1,0]
 v_pk_mul_f32 v[210:211], v[210:211], v[10:11] op_sel_hi:[1,0]
 v_pk_mul_f32 v[212:213], v[212:213], v[10:11] op_sel_hi:[1,0]
 v_pk_mul_f32 v[214:215], v[214:215], v[10:11] op_sel_hi:[1,0]
 v_pk_mul_f32 v[216:217], v[216:217], v[10:11] op_sel_hi:[1,0]
 v_pk_mul_f32 v[218:219], v[218:219], v[10:11] op_sel_hi:[1,0]
 v_pk_mul_f32 v[220:221], v[220:221], v[10:11] op_sel_hi:[1,0]
 v_pk_mul_f32 v[222:223], v[222:223], v[10:11] op_sel_hi:[1,0]
 s_or_b64 s[50:51], s[50:51], vcc
 v_cmp_nge_f32 vcc, s61, v11
 v_add_u32 v12, 13056, v5
 v_cvt_pk_bf16_f32 v192, v192, v193
 v_cvt_pk_bf16_f32 v193, v194, v195
 v_cvt_pk_bf16_f32 v196, v196, v197
 v_cvt_pk_bf16_f32 v197, v198, v199
 s_or_b64 s[50:51], s[50:51], vcc
 ds_write2_b64 v12, v[192:193], v[196:197] offset0:0 offset1:4
 v_cvt_pk_bf16_f32 v200, v200, v201
 v_cvt_pk_bf16_f32 v201, v202, v203
 v_cvt_pk_bf16_f32 v204, v204, v205
 v_cvt_pk_bf16_f32 v205, v206, v207
 ds_write2_b64 v12, v[200:201], v[204:205] offset0:8 offset1:12
 v_cvt_pk_bf16_f32 v208, v208, v209
 v_cvt_pk_bf16_f32 v209, v210, v211
 v_cvt_pk_bf16_f32 v212, v212, v213
 v_cvt_pk_bf16_f32 v213, v214, v215
 ds_write2_b64 v12, v[208:209], v[212:213] offset0:16 offset1:20
 v_cvt_pk_bf16_f32 v216, v216, v217
 v_cvt_pk_bf16_f32 v217, v218, v219
 v_cvt_pk_bf16_f32 v220, v220, v221
 v_cvt_pk_bf16_f32 v221, v222, v223
 ds_write2_b64 v12, v[216:217], v[220:221] offset0:24 offset1:28
 ds_read_b128 v[192:195], v6 offset:13056
 ds_read_b128 v[196:199], v6 offset:14144
 ds_read_b128 v[200:203], v6 offset:15232
 ds_read_b128 v[204:207], v6 offset:16320
 s_mov_b32 s59, 16384
 s_waitcnt lgkmcnt(3)
 buffer_store_dwordx4 v[192:195], v1, s[24:27], s59 offen sc1 nt
 s_waitcnt lgkmcnt(2)
 buffer_store_dwordx4 v[196:199], v1, s[24:27], s59 offen offset:1024 sc1 nt
 s_waitcnt lgkmcnt(1)
 buffer_store_dwordx4 v[200:203], v1, s[24:27], s59 offen offset:2048 sc1 nt
 s_waitcnt lgkmcnt(0)
 buffer_store_dwordx4 v[204:207], v1, s[24:27], s59 offen offset:3072 sc1 nt
 v_accvgpr_read_b32 v11, a234
 v_accvgpr_read_b32 v10, a235
 v_add_f32 v11, v11, v10
 v_rcp_f32 v10, v11
 v_cmp_nle_f32 vcc, s60, v11
 v_pk_mul_f32 v[224:225], v[224:225], v[10:11] op_sel_hi:[1,0]
 v_pk_mul_f32 v[226:227], v[226:227], v[10:11] op_sel_hi:[1,0]
 v_pk_mul_f32 v[228:229], v[228:229], v[10:11] op_sel_hi:[1,0]
 v_pk_mul_f32 v[230:231], v[230:231], v[10:11] op_sel_hi:[1,0]
 v_pk_mul_f32 v[232:233], v[232:233], v[10:11] op_sel_hi:[1,0]
 v_pk_mul_f32 v[234:235], v[234:235], v[10:11] op_sel_hi:[1,0]
 v_pk_mul_f32 v[236:237], v[236:237], v[10:11] op_sel_hi:[1,0]
 v_pk_mul_f32 v[238:239], v[238:239], v[10:11] op_sel_hi:[1,0]
 v_pk_mul_f32 v[240:241], v[240:241], v[10:11] op_sel_hi:[1,0]
 v_pk_mul_f32 v[242:243], v[242:243], v[10:11] op_sel_hi:[1,0]
 v_pk_mul_f32 v[244:245], v[244:245], v[10:11] op_sel_hi:[1,0]
 v_pk_mul_f32 v[246:247], v[246:247], v[10:11] op_sel_hi:[1,0]
 v_pk_mul_f32 v[248:249], v[248:249], v[10:11] op_sel_hi:[1,0]
 v_pk_mul_f32 v[250:251], v[250:251], v[10:11] op_sel_hi:[1,0]
 v_pk_mul_f32 v[252:253], v[252:253], v[10:11] op_sel_hi:[1,0]
 v_pk_mul_f32 v[254:255], v[254:255], v[10:11] op_sel_hi:[1,0]
 s_or_b64 s[50:51], s[50:51], vcc
 v_cmp_nge_f32 vcc, s61, v11
 v_add_u32 v12, 0, v5
 v_cvt_pk_bf16_f32 v224, v224, v225
 v_cvt_pk_bf16_f32 v225, v226, v227
 v_cvt_pk_bf16_f32 v228, v228, v229
 v_cvt_pk_bf16_f32 v229, v230, v231
 s_or_b64 s[50:51], s[50:51], vcc
 ds_write2_b64 v12, v[224:225], v[228:229] offset0:0 offset1:4
 v_cvt_pk_bf16_f32 v232, v232, v233
 v_cvt_pk_bf16_f32 v233, v234, v235
 v_cvt_pk_bf16_f32 v236, v236, v237
 v_cvt_pk_bf16_f32 v237, v238, v239
 ds_write2_b64 v12, v[232:233], v[236:237] offset0:8 offset1:12
 v_cvt_pk_bf16_f32 v240, v240, v241
 v_cvt_pk_bf16_f32 v241, v242, v243
 v_cvt_pk_bf16_f32 v244, v244, v245
 v_cvt_pk_bf16_f32 v245, v246, v247
 ds_write2_b64 v12, v[240:241], v[244:245] offset0:16 offset1:20
 v_cvt_pk_bf16_f32 v248, v248, v249
 v_cvt_pk_bf16_f32 v249, v250, v251
 v_cvt_pk_bf16_f32 v252, v252, v253
 v_cvt_pk_bf16_f32 v253, v254, v255
 ds_write2_b64 v12, v[248:249], v[252:253] offset0:24 offset1:28
 ds_read_b128 v[224:227], v6 offset:0
 ds_read_b128 v[228:231], v6 offset:1088
 ds_read_b128 v[232:235], v6 offset:2176
 ds_read_b128 v[236:239], v6 offset:3264
 s_mov_b32 s59, 20480
 s_waitcnt lgkmcnt(3)
 buffer_store_dwordx4 v[224:227], v1, s[24:27], s59 offen sc1 nt
 s_waitcnt lgkmcnt(2)
 buffer_store_dwordx4 v[228:231], v1, s[24:27], s59 offen offset:1024 sc1 nt
 s_waitcnt lgkmcnt(1)
 buffer_store_dwordx4 v[232:235], v1, s[24:27], s59 offen offset:2048 sc1 nt
 s_waitcnt lgkmcnt(0)
 buffer_store_dwordx4 v[236:239], v1, s[24:27], s59 offen offset:3072 sc1 nt
 s_branch L_pend
L_done:
L_exit:
 s_endpgm
.p2align 12
L_main1:
 s_mov_b64 exec, -1
 s_waitcnt vmcnt(8)
 s_barrier
 ds_read_b128 a[96:99], v7 offset:0
 ds_read_b128 a[100:103], v7 offset:64
 ds_read_b128 a[104:107], v7 offset:128
 ds_read_b128 a[108:111], v7 offset:192
 ds_read_b128 a[124:127], v7 offset:704
 ds_read_b128 a[120:123], v7 offset:640
 ds_read_b128 a[116:119], v7 offset:576
 ds_read_b128 a[112:115], v7 offset:512
 s_mov_b32 s59, 4096
 s_add_u32 m0, s45, 17408
 s_nop 0
 buffer_load_dwordx4 v1, s[16:19], s59 offen nt lds
 s_add_u32 m0, s45, 17472
 s_nop 0
 buffer_load_dwordx4 v1, s[16:19], s59 offen offset:1024 nt lds
 s_add_u32 m0, s45, 17536
 s_nop 0
 buffer_load_dwordx4 v1, s[16:19], s59 offen offset:2048 nt lds
 s_add_u32 m0, s45, 17600
 s_nop 0
 buffer_load_dwordx4 v1, s[16:19], s59 offen offset:3072 nt lds
 s_waitcnt vmcnt(8)
 ds_read_b128 v[64:67], v4 offset:0
 ds_read_b128 v[68:71], v4 offset:64
 ds_read_b128 v[72:75], v4 offset:128
 ds_read_b128 v[76:79], v4 offset:192
 s_mov_b32 s59, 8192
 s_add_u32 m0, s45, 4352
 s_nop 0
 buffer_load_dwordx4 v1, s[16:19], s59 offen nt lds
 s_add_u32 m0, s45, 4416
 s_nop 0
 buffer_load_dwordx4 v1, s[16:19], s59 offen offset:1024 nt lds
 s_add_u32 m0, s45, 4480
 s_nop 0
 buffer_load_dwordx4 v1, s[16:19], s59 offen offset:2048 nt lds
 s_add_u32 m0, s45, 4544
 s_nop 0
 buffer_load_dwordx4 v1, s[16:19], s59 offen offset:3072 nt lds
 s_waitcnt lgkmcnt(0)
 v_lshlrev_b32 v14, 16, v64
 v_and_b32 v15, s34, v64
 v_lshlrev_b32 v16, 16, v65
 v_and_b32 v17, s34, v65
 v_lshlrev_b32 v18, 16, v66
 v_and_b32 v19, s34, v66
 v_lshlrev_b32 v20, 16, v67
 v_and_b32 v21, s34, v67
 v_pk_mul_f32 v[14:15], v[14:15], s[32:33] op_sel_hi:[1,0]
 v_pk_mul_f32 v[16:17], v[16:17], s[32:33] op_sel_hi:[1,0]
 v_pk_mul_f32 v[18:19], v[18:19], s[32:33] op_sel_hi:[1,0]
 v_pk_mul_f32 v[20:21], v[20:21], s[32:33] op_sel_hi:[1,0]
 v_cvt_pk_bf16_f32 v14, v14, v15
 v_cvt_pk_bf16_f32 v16, v16, v17
 v_cvt_pk_bf16_f32 v18, v18, v19
 v_cvt_pk_bf16_f32 v20, v20, v21
 v_accvgpr_write_b32 a0, v14
 v_accvgpr_write_b32 a1, v16
 v_accvgpr_write_b32 a2, v18
 v_accvgpr_write_b32 a3, v20
 v_lshlrev_b32 v14, 16, v68
 v_and_b32 v15, s34, v68
 v_lshlrev_b32 v16, 16, v69
 v_and_b32 v17, s34, v69
 v_lshlrev_b32 v18, 16, v70
 v_and_b32 v19, s34, v70
 v_lshlrev_b32 v20, 16, v71
 v_and_b32 v21, s34, v71
 v_pk_mul_f32 v[14:15], v[14:15], s[32:33] op_sel_hi:[1,0]
 v_pk_mul_f32 v[16:17], v[16:17], s[32:33] op_sel_hi:[1,0]
 v_pk_mul_f32 v[18:19], v[18:19], s[32:33] op_sel_hi:[1,0]
 v_pk_mul_f32 v[20:21], v[20:21], s[32:33] op_sel_hi:[1,0]
 v_cvt_pk_bf16_f32 v14, v14, v15
 v_cvt_pk_bf16_f32 v16, v16, v17
 v_cvt_pk_bf16_f32 v18, v18, v19
 v_cvt_pk_bf16_f32 v20, v20, v21
 v_accvgpr_write_b32 a4, v14
 v_accvgpr_write_b32 a5, v16
 v_accvgpr_write_b32 a6, v18
 v_accvgpr_write_b32 a7, v20
 v_lshlrev_b32 v14, 16, v72
 v_and_b32 v15, s34, v72
 v_lshlrev_b32 v16, 16, v73
 v_and_b32 v17, s34, v73
 v_lshlrev_b32 v18, 16, v74
 v_and_b32 v19, s34, v74
 v_lshlrev_b32 v20, 16, v75
 v_and_b32 v21, s34, v75
 v_pk_mul_f32 v[14:15], v[14:15], s[32:33] op_sel_hi:[1,0]
 v_pk_mul_f32 v[16:17], v[16:17], s[32:33] op_sel_hi:[1,0]
 v_pk_mul_f32 v[18:19], v[18:19], s[32:33] op_sel_hi:[1,0]
 v_pk_mul_f32 v[20:21], v[20:21], s[32:33] op_sel_hi:[1,0]
 v_cvt_pk_bf16_f32 v14, v14, v15
 v_cvt_pk_bf16_f32 v16, v16, v17
 v_cvt_pk_bf16_f32 v18, v18, v19
 v_cvt_pk_bf16_f32 v20, v20, v21
 v_accvgpr_write_b32 a8, v14
 v_accvgpr_write_b32 a9, v16
 v_accvgpr_write_b32 a10, v18
 v_accvgpr_write_b32 a11, v20
 v_lshlrev_b32 v14, 16, v76
 v_and_b32 v15, s34, v76
 v_lshlrev_b32 v16, 16, v77
 v_and_b32 v17, s34, v77
 v_lshlrev_b32 v18, 16, v78
 v_and_b32 v19, s34, v78
 v_lshlrev_b32 v20, 16, v79
 v_and_b32 v21, s34, v79
 v_pk_mul_f32 v[14:15], v[14:15], s[32:33] op_sel_hi:[1,0]
 v_pk_mul_f32 v[16:17], v[16:17], s[32:33] op_sel_hi:[1,0]
 v_pk_mul_f32 v[18:19], v[18:19], s[32:33] op_sel_hi:[1,0]
 v_pk_mul_f32 v[20:21], v[20:21], s[32:33] op_sel_hi:[1,0]
 v_cvt_pk_bf16_f32 v14, v14, v15
 v_cvt_pk_bf16_f32 v16, v16, v17
 v_cvt_pk_bf16_f32 v18, v18, v19
 v_cvt_pk_bf16_f32 v20, v20, v21
 v_accvgpr_write_b32 a12, v14
 v_accvgpr_write_b32 a13, v16
 v_accvgpr_write_b32 a14, v18
 v_accvgpr_write_b32 a15, v20
 s_nop 1
 v_mfma_f32_16x16x32_bf16 v[24:27], a[96:99], a[0:3], 0
 ds_read_b64_tr_b16 a[160:161], v8 offset:0
 ds_read_b64_tr_b16 a[162:163], v8 offset:512
 v_mfma_f32_16x16x32_bf16 v[24:27], a[100:103], a[4:7], v[24:27]
 ds_read_b64_tr_b16 a[164:165], v8 offset:32
 ds_read_b64_tr_b16 a[166:167], v8 offset:544
 v_mfma_f32_16x16x32_bf16 v[24:27], a[104:107], a[8:11], v[24:27]
 ds_read_b64_tr_b16 a[168:169], v8 offset:64
 ds_read_b64_tr_b16 a[170:171], v8 offset:576
 v_mfma_f32_16x16x32_bf16 v[24:27], a[108:111], a[12:15], v[24:27]
 ds_read_b64_tr_b16 a[172:173], v8 offset:96
 ds_read_b64_tr_b16 a[174:175], v8 offset:608
 v_mfma_f32_16x16x32_bf16 v[28:31], a[124:127], a[12:15], 0
 ds_read_b64_tr_b16 a[176:177], v8 offset:128
 ds_read_b64_tr_b16 a[178:179], v8 offset:640
 v_mfma_f32_16x16x32_bf16 v[28:31], a[120:123], a[8:11], v[28:31]
 ds_read_b64_tr_b16 a[180:181], v8 offset:160
 ds_read_b64_tr_b16 a[182:183], v8 offset:672
 v_mfma_f32_16x16x32_bf16 v[28:31], a[116:119], a[4:7], v[28:31]
 ds_read_b64_tr_b16 a[184:185], v8 offset:192
 ds_read_b64_tr_b16 a[186:187], v8 offset:704
 v_mfma_f32_16x16x32_bf16 v[28:31], a[112:115], a[0:3], v[28:31]
 ds_read_b64_tr_b16 a[188:189], v8 offset:224
 ds_read_b64_tr_b16 a[190:191], v8 offset:736
 s_waitcnt vmcnt(8)
 s_barrier
 ds_read_b128 a[128:131], v7 offset:16896
 ds_read_b128 a[132:135], v7 offset:16960
 ds_read_b128 a[136:139], v7 offset:17024
 ds_read_b128 a[140:143], v7 offset:17088
 ds_read_b128 a[156:159], v7 offset:17600
 ds_read_b128 a[152:155], v7 offset:17536
 ds_read_b128 a[148:151], v7 offset:17472
 ds_read_b128 a[144:147], v7 offset:17408
 ds_read_b64_tr_b16 a[192:193], v8 offset:16896
 ds_read_b64_tr_b16 a[194:195], v8 offset:17408
 ds_read_b64_tr_b16 a[196:197], v8 offset:16928
 ds_read_b64_tr_b16 a[198:199], v8 offset:17440
 ds_read_b64_tr_b16 a[200:201], v8 offset:16960
 ds_read_b64_tr_b16 a[202:203], v8 offset:17472
 ds_read_b64_tr_b16 a[204:205], v8 offset:16992
 ds_read_b64_tr_b16 a[206:207], v8 offset:17504
 s_mov_b32 s59, 12288
 s_add_u32 m0, s45, 8704
 s_nop 0
 buffer_load_dwordx4 v1, s[16:19], s59 offen nt lds
 s_add_u32 m0, s45, 8768
 s_nop 0
 buffer_load_dwordx4 v1, s[16:19], s59 offen offset:1024 nt lds
 s_add_u32 m0, s45, 8832
 s_nop 0
 buffer_load_dwordx4 v1, s[16:19], s59 offen offset:2048 nt lds
 s_add_u32 m0, s45, 8896
 s_nop 0
 buffer_load_dwordx4 v1, s[16:19], s59 offen offset:3072 nt lds
 s_waitcnt lgkmcnt(8)
 v_mfma_f32_16x16x32_bf16 v[32:35], a[128:131], a[0:3], 0
 s_mov_b32 s59, 16384
 s_waitcnt vmcnt(8)
 ds_read_b128 v[96:99], v4 offset:17408
 ds_read_b128 v[100:103], v4 offset:17472
 ds_read_b128 v[104:107], v4 offset:17536
 ds_read_b128 v[108:111], v4 offset:17600
 v_exp_f32 v24, v24
 v_exp_f32 v25, v25
 v_mfma_f32_16x16x32_bf16 v[32:35], a[132:135], a[4:7], v[32:35]
 s_add_u32 m0, s45, 13056
 v_exp_f32 v26, v26
 v_mfma_f32_16x16x32_bf16 v[32:35], a[136:139], a[8:11], v[32:35]
 buffer_load_dwordx4 v1, s[16:19], s59 offen nt lds
 s_add_u32 m0, s45, 13120
 v_exp_f32 v27, v27
 v_exp_f32 v28, v28
 v_cvt_pk_bf16_f32 v40, v24, v25
 v_mfma_f32_16x16x32_bf16 v[32:35], a[140:143], a[12:15], v[32:35]
 buffer_load_dwordx4 v1, s[16:19], s59 offen offset:1024 nt lds
 s_add_u32 m0, s45, 13184
 v_cvt_pk_bf16_f32 v41, v26, v27
 v_exp_f32 v29, v29
 v_exp_f32 v30, v30
 v_mfma_f32_16x16x32_bf16 v[36:39], a[156:159], a[12:15], 0
 buffer_load_dwordx4 v1, s[16:19], s59 offen offset:2048 nt lds
 s_add_u32 m0, s45, 13248
 v_exp_f32 v31, v31
 v_cvt_pk_bf16_f32 v42, v28, v29
 v_cvt_pk_bf16_f32 v43, v30, v31
 v_mfma_f32_16x16x32_bf16 v[36:39], a[152:155], a[8:11], v[36:39]
 s_waitcnt lgkmcnt(3)
 buffer_load_dwordx4 v1, s[16:19], s59 offen offset:3072 nt lds
 v_lshlrev_b32 v14, 16, v96
 v_and_b32 v15, s34, v96
 v_lshlrev_b32 v16, 16, v97
 v_and_b32 v17, s34, v97
 v_lshlrev_b32 v18, 16, v98
 v_and_b32 v19, s34, v98
 v_lshlrev_b32 v20, 16, v99
 v_and_b32 v21, s34, v99
 v_pk_mul_f32 v[14:15], v[14:15], s[32:33] op_sel_hi:[1,0]
 v_pk_mul_f32 v[16:17], v[16:17], s[32:33] op_sel_hi:[1,0]
 v_pk_mul_f32 v[18:19], v[18:19], s[32:33] op_sel_hi:[1,0]
 v_pk_mul_f32 v[20:21], v[20:21], s[32:33] op_sel_hi:[1,0]
 v_cvt_pk_bf16_f32 v14, v14, v15
 v_cvt_pk_bf16_f32 v16, v16, v17
 v_cvt_pk_bf16_f32 v18, v18, v19
 v_cvt_pk_bf16_f32 v20, v20, v21
 v_accvgpr_write_b32 a16, v14
 v_accvgpr_write_b32 a17, v16
 v_accvgpr_write_b32 a18, v18
 v_accvgpr_write_b32 a19, v20
 v_mfma_f32_16x16x32_bf16 v[36:39], a[148:151], a[4:7], v[36:39]
 s_waitcnt lgkmcnt(1)
 v_lshlrev_b32 v14, 16, v100
 v_and_b32 v15, s34, v100
 v_lshlrev_b32 v16, 16, v101
 v_and_b32 v17, s34, v101
 v_lshlrev_b32 v18, 16, v102
 v_and_b32 v19, s34, v102
 v_lshlrev_b32 v20, 16, v103
 v_and_b32 v21, s34, v103
 v_pk_mul_f32 v[14:15], v[14:15], s[32:33] op_sel_hi:[1,0]
 v_pk_mul_f32 v[16:17], v[16:17], s[32:33] op_sel_hi:[1,0]
 v_pk_mul_f32 v[18:19], v[18:19], s[32:33] op_sel_hi:[1,0]
 v_pk_mul_f32 v[20:21], v[20:21], s[32:33] op_sel_hi:[1,0]
 v_cvt_pk_bf16_f32 v14, v14, v15
 v_cvt_pk_bf16_f32 v16, v16, v17
 v_cvt_pk_bf16_f32 v18, v18, v19
 v_cvt_pk_bf16_f32 v20, v20, v21
 v_accvgpr_write_b32 a20, v14
 v_accvgpr_write_b32 a21, v16
 v_accvgpr_write_b32 a22, v18
 v_accvgpr_write_b32 a23, v20
 v_lshlrev_b32 v14, 16, v104
 v_and_b32 v15, s34, v104
 v_lshlrev_b32 v16, 16, v105
 v_and_b32 v17, s34, v105
 v_lshlrev_b32 v18, 16, v106
 v_and_b32 v19, s34, v106
 v_lshlrev_b32 v20, 16, v107
 v_and_b32 v21, s34, v107
 v_pk_mul_f32 v[14:15], v[14:15], s[32:33] op_sel_hi:[1,0]
 v_pk_mul_f32 v[16:17], v[16:17], s[32:33] op_sel_hi:[1,0]
 v_pk_mul_f32 v[18:19], v[18:19], s[32:33] op_sel_hi:[1,0]
 v_pk_mul_f32 v[20:21], v[20:21], s[32:33] op_sel_hi:[1,0]
 v_cvt_pk_bf16_f32 v14, v14, v15
 v_cvt_pk_bf16_f32 v16, v16, v17
 v_cvt_pk_bf16_f32 v18, v18, v19
 v_cvt_pk_bf16_f32 v20, v20, v21
 v_accvgpr_write_b32 a24, v14
 v_accvgpr_write_b32 a25, v16
 v_accvgpr_write_b32 a26, v18
 v_accvgpr_write_b32 a27, v20
 v_mfma_f32_16x16x32_bf16 v[36:39], a[144:147], a[0:3], v[36:39]
 s_waitcnt lgkmcnt(0)
 v_lshlrev_b32 v14, 16, v108
 v_and_b32 v15, s34, v108
 v_lshlrev_b32 v16, 16, v109
 v_and_b32 v17, s34, v109
 v_lshlrev_b32 v18, 16, v110
 v_and_b32 v19, s34, v110
 v_lshlrev_b32 v20, 16, v111
 v_and_b32 v21, s34, v111
 v_pk_mul_f32 v[14:15], v[14:15], s[32:33] op_sel_hi:[1,0]
 v_pk_mul_f32 v[16:17], v[16:17], s[32:33] op_sel_hi:[1,0]
 v_pk_mul_f32 v[18:19], v[18:19], s[32:33] op_sel_hi:[1,0]
 v_pk_mul_f32 v[20:21], v[20:21], s[32:33] op_sel_hi:[1,0]
 v_cvt_pk_bf16_f32 v14, v14, v15
 v_cvt_pk_bf16_f32 v16, v16, v17
 v_cvt_pk_bf16_f32 v18, v18, v19
 v_cvt_pk_bf16_f32 v20, v20, v21
 v_accvgpr_write_b32 a28, v14
 v_accvgpr_write_b32 a29, v16
 v_accvgpr_write_b32 a30, v18
 v_accvgpr_write_b32 a31, v20
 v_mfma_f32_16x16x32_bf16 v[24:27], a[96:99], a[16:19], 0
 v_exp_f32 v32, v32
 v_mfma_f32_16x16x32_bf16 v[24:27], a[100:103], a[20:23], v[24:27]
 ds_read_b64_tr_b16 a[208:209], v8 offset:17024
 ds_read_b64_tr_b16 a[210:211], v8 offset:17536
 v_mfma_f32_16x16x32_bf16 v[24:27], a[104:107], a[24:27], v[24:27]
 v_exp_f32 v33, v33
 v_mfma_f32_16x16x32_bf16 v[24:27], a[108:111], a[28:31], v[24:27]
 ds_read_b64_tr_b16 a[212:213], v8 offset:17056
 ds_read_b64_tr_b16 a[214:215], v8 offset:17568
 v_exp_f32 v34, v34
 v_exp_f32 v35, v35
 v_exp_f32 v36, v36
 v_mfma_f32_16x16x32_bf16 v[28:31], a[124:127], a[28:31], 0
 ds_read_b64_tr_b16 a[216:217], v8 offset:17088
 ds_read_b64_tr_b16 a[218:219], v8 offset:17600
 v_mfma_f32_16x16x32_bf16 v[28:31], a[120:123], a[24:27], v[28:31]
 v_cvt_pk_bf16_f32 v44, v32, v33
 v_cvt_pk_bf16_f32 v45, v34, v35
 v_mfma_f32_16x16x32_bf16 v[28:31], a[116:119], a[20:23], v[28:31]
 ds_read_b64_tr_b16 a[220:221], v8 offset:17120
 ds_read_b64_tr_b16 a[222:223], v8 offset:17632
 v_mfma_f32_16x16x32_bf16 v[28:31], a[112:115], a[16:19], v[28:31]
 v_exp_f32 v37, v37
 v_exp_f32 v38, v38
 v_exp_f32 v39, v39
 v_cvt_pk_bf16_f32 v46, v36, v37
 v_cvt_pk_bf16_f32 v47, v38, v39
 v_mfma_f32_16x16x32_bf16 v[32:35], a[128:131], a[16:19], 0
 v_exp_f32 v24, v24
 v_mfma_f32_16x16x32_bf16 v[32:35], a[132:135], a[20:23], v[32:35]
 s_waitcnt vmcnt(8)
 v_exp_f32 v25, v25
 v_mfma_f32_16x16x32_bf16 v[32:35], a[136:139], a[24:27], v[32:35]
 s_add_u32 m0, s39, 33792
 ds_read_b128 v[128:131], v4 offset:4352
 ds_read_b128 v[132:135], v4 offset:4416
 v_mfma_f32_16x16x32_bf16 v[32:35], a[140:143], a[28:31], v[32:35]
 buffer_load_dwordx4 v1, s[20:23], s33 offen nt lds
 v_mfma_f32_16x16x32_bf16 v[36:39], a[156:159], a[28:31], 0
 s_add_u32 m0, s39, 33824
 ds_read_b128 v[136:139], v4 offset:4480
 ds_read_b128 v[140:143], v4 offset:4544
 v_mfma_f32_16x16x32_bf16 v[36:39], a[152:155], a[24:27], v[36:39]
 buffer_load_dwordx4 v1, s[20:23], s33 offen offset:1024 nt lds
 v_exp_f32 v26, v26
 v_mfma_f32_16x16x32_bf16 v[36:39], a[148:151], a[20:23], v[36:39]
 s_add_u32 m0, s39, 33856
 v_exp_f32 v27, v27
 v_mfma_f32_16x16x32_bf16 v[36:39], a[144:147], a[16:19], v[36:39]
 s_waitcnt lgkmcnt(15)
 buffer_load_dwordx4 v1, s[20:23], s33 offen offset:2048 nt lds
 v_exp_f32 v28, v28
 v_mfma_f32_16x16x32_bf16 v[64:67], a[160:163], v[40:43], 0
 s_add_u32 m0, s39, 33888
 v_cvt_pk_bf16_f32 v48, v24, v25
 v_cvt_pk_bf16_f32 v49, v26, v27
 v_mfma_f32_16x16x32_bf16 v[64:67], a[192:195], v[44:47], v[64:67]
 buffer_load_dwordx4 v1, s[20:23], s33 offen offset:3072 nt lds
 v_exp_f32 v29, v29
 v_mfma_f32_16x16x32_bf16 v[68:71], a[164:167], v[40:43], 0
 s_add_u32 s33, s33, 8192
 s_waitcnt lgkmcnt(3)
 v_lshlrev_b32 v14, 16, v128
 v_and_b32 v15, s34, v128
 v_lshlrev_b32 v16, 16, v129
 v_and_b32 v17, s34, v129
 v_lshlrev_b32 v18, 16, v130
 v_and_b32 v19, s34, v130
 v_lshlrev_b32 v20, 16, v131
 v_and_b32 v21, s34, v131
 v_pk_mul_f32 v[14:15], v[14:15], s[32:33] op_sel_hi:[1,0]
 v_pk_mul_f32 v[16:17], v[16:17], s[32:33] op_sel_hi:[1,0]
 v_pk_mul_f32 v[18:19], v[18:19], s[32:33] op_sel_hi:[1,0]
 v_pk_mul_f32 v[20:21], v[20:21], s[32:33] op_sel_hi:[1,0]
 v_cvt_pk_bf16_f32 v14, v14, v15
 v_cvt_pk_bf16_f32 v16, v16, v17
 v_cvt_pk_bf16_f32 v18, v18, v19
 v_cvt_pk_bf16_f32 v20, v20, v21
 v_accvgpr_write_b32 a32, v14
 v_accvgpr_write_b32 a33, v16
 v_accvgpr_write_b32 a34, v18
 v_accvgpr_write_b32 a35, v20
 v_mfma_f32_16x16x32_bf16 v[68:71], a[196:199], v[44:47], v[68:71]
 s_waitcnt lgkmcnt(2)
 v_lshlrev_b32 v14, 16, v132
 v_and_b32 v15, s34, v132
 v_lshlrev_b32 v16, 16, v133
 v_and_b32 v17, s34, v133
 v_lshlrev_b32 v18, 16, v134
 v_and_b32 v19, s34, v134
 v_lshlrev_b32 v20, 16, v135
 v_and_b32 v21, s34, v135
 v_pk_mul_f32 v[14:15], v[14:15], s[32:33] op_sel_hi:[1,0]
 v_pk_mul_f32 v[16:17], v[16:17], s[32:33] op_sel_hi:[1,0]
 v_pk_mul_f32 v[18:19], v[18:19], s[32:33] op_sel_hi:[1,0]
 v_pk_mul_f32 v[20:21], v[20:21], s[32:33] op_sel_hi:[1,0]
 v_cvt_pk_bf16_f32 v14, v14, v15
 v_cvt_pk_bf16_f32 v16, v16, v17
 v_cvt_pk_bf16_f32 v18, v18, v19
 v_cvt_pk_bf16_f32 v20, v20, v21
 v_accvgpr_write_b32 a36, v14
 v_accvgpr_write_b32 a37, v16
 v_accvgpr_write_b32 a38, v18
 v_accvgpr_write_b32 a39, v20
 v_mfma_f32_16x16x32_bf16 v[72:75], a[168:171], v[40:43], 0
 s_waitcnt lgkmcnt(1)
 v_lshlrev_b32 v14, 16, v136
 v_and_b32 v15, s34, v136
 v_lshlrev_b32 v16, 16, v137
 v_and_b32 v17, s34, v137
 v_lshlrev_b32 v18, 16, v138
 v_and_b32 v19, s34, v138
 v_lshlrev_b32 v20, 16, v139
 v_and_b32 v21, s34, v139
 v_pk_mul_f32 v[14:15], v[14:15], s[32:33] op_sel_hi:[1,0]
 v_pk_mul_f32 v[16:17], v[16:17], s[32:33] op_sel_hi:[1,0]
 v_pk_mul_f32 v[18:19], v[18:19], s[32:33] op_sel_hi:[1,0]
 v_pk_mul_f32 v[20:21], v[20:21], s[32:33] op_sel_hi:[1,0]
 v_cvt_pk_bf16_f32 v14, v14, v15
 v_cvt_pk_bf16_f32 v16, v16, v17
 v_cvt_pk_bf16_f32 v18, v18, v19
 v_cvt_pk_bf16_f32 v20, v20, v21
 v_accvgpr_write_b32 a40, v14
 v_accvgpr_write_b32 a41, v16
 v_accvgpr_write_b32 a42, v18
 v_accvgpr_write_b32 a43, v20
 v_mfma_f32_16x16x32_bf16 v[72:75], a[200:203], v[44:47], v[72:75]
 s_waitcnt lgkmcnt(0)
 v_lshlrev_b32 v14, 16, v140
 v_and_b32 v15, s34, v140
 v_lshlrev_b32 v16, 16, v141
 v_and_b32 v17, s34, v141
 v_lshlrev_b32 v18, 16, v142
 v_and_b32 v19, s34, v142
 v_lshlrev_b32 v20, 16, v143
 v_and_b32 v21, s34, v143
 v_pk_mul_f32 v[14:15], v[14:15], s[32:33] op_sel_hi:[1,0]
 v_pk_mul_f32 v[16:17], v[16:17], s[32:33] op_sel_hi:[1,0]
 v_pk_mul_f32 v[18:19], v[18:19], s[32:33] op_sel_hi:[1,0]
 v_pk_mul_f32 v[20:21], v[20:21], s[32:33] op_sel_hi:[1,0]
 v_cvt_pk_bf16_f32 v14, v14, v15
 v_cvt_pk_bf16_f32 v16, v16, v17
 v_cvt_pk_bf16_f32 v18, v18, v19
 v_cvt_pk_bf16_f32 v20, v20, v21
 v_accvgpr_write_b32 a44, v14
 v_accvgpr_write_b32 a45, v16
 v_accvgpr_write_b32 a46, v18
 v_accvgpr_write_b32 a47, v20
 v_mfma_f32_16x16x32_bf16 v[76:79], a[172:175], v[40:43], 0
 v_exp_f32 v30, v30
 v_mfma_f32_16x16x32_bf16 v[76:79], a[204:207], v[44:47], v[76:79]
 v_exp_f32 v31, v31
 v_cvt_pk_bf16_f32 v50, v28, v29
 v_cvt_pk_bf16_f32 v51, v30, v31
 v_mfma_f32_16x16x32_bf16 v[24:27], a[96:99], a[32:35], 0
 v_mfma_f32_16x16x32_bf16 v[24:27], a[100:103], a[36:39], v[24:27]
 v_mfma_f32_16x16x32_bf16 v[24:27], a[104:107], a[40:43], v[24:27]
 v_mfma_f32_16x16x32_bf16 v[24:27], a[108:111], a[44:47], v[24:27]
 v_smfmac_f32_16x16x64_bf16 a[224:227], a[236:239], v[40:47], v2
 v_mfma_f32_16x16x32_bf16 v[28:31], a[124:127], a[44:47], 0
 v_mfma_f32_16x16x32_bf16 v[28:31], a[120:123], a[40:43], v[28:31]
 v_mfma_f32_16x16x32_bf16 v[28:31], a[116:119], a[36:39], v[28:31]
 v_exp_f32 v32, v32
 v_mfma_f32_16x16x32_bf16 v[28:31], a[112:115], a[32:35], v[28:31]
 s_waitcnt lgkmcnt(4)
 v_exp_f32 v33, v33
 v_mfma_f32_16x16x32_bf16 v[80:83], a[176:179], v[40:43], 0
 v_exp_f32 v34, v34
 v_mfma_f32_16x16x32_bf16 v[80:83], a[208:211], v[44:47], v[80:83]
 v_exp_f32 v35, v35
 v_mfma_f32_16x16x32_bf16 v[84:87], a[180:183], v[40:43], 0
 v_exp_f32 v36, v36
 v_mfma_f32_16x16x32_bf16 v[84:87], a[212:215], v[44:47], v[84:87]
 v_cvt_pk_bf16_f32 v52, v32, v33
 v_cvt_pk_bf16_f32 v53, v34, v35
 v_mfma_f32_16x16x32_bf16 v[88:91], a[184:187], v[40:43], 0
 v_exp_f32 v37, v37
 v_mfma_f32_16x16x32_bf16 v[88:91], a[216:219], v[44:47], v[88:91]
 v_exp_f32 v38, v38
 v_mfma_f32_16x16x32_bf16 v[92:95], a[188:191], v[40:43], 0
 v_exp_f32 v39, v39
 v_mfma_f32_16x16x32_bf16 v[92:95], a[220:223], v[44:47], v[92:95]
 v_cvt_pk_bf16_f32 v54, v36, v37
 v_cvt_pk_bf16_f32 v55, v38, v39
 v_mfma_f32_16x16x32_bf16 v[32:35], a[128:131], a[32:35], 0
 v_exp_f32 v24, v24
 v_mfma_f32_16x16x32_bf16 v[32:35], a[132:135], a[36:39], v[32:35]
 s_mov_b32 s59, 20480
 s_waitcnt vmcnt(8)
 v_exp_f32 v25, v25
 v_exp_f32 v26, v26
 v_mfma_f32_16x16x32_bf16 v[32:35], a[136:139], a[40:43], v[32:35]
 s_add_u32 m0, s45, 0
 ds_read_b128 v[160:163], v4 offset:8704
 ds_read_b128 v[164:167], v4 offset:8768
 v_mfma_f32_16x16x32_bf16 v[32:35], a[140:143], a[44:47], v[32:35]
 buffer_load_dwordx4 v1, s[16:19], s59 offen nt lds
 v_mfma_f32_16x16x32_bf16 v[36:39], a[156:159], a[44:47], 0
 s_add_u32 m0, s45, 64
 ds_read_b128 v[168:171], v4 offset:8832
 ds_read_b128 v[172:175], v4 offset:8896
 v_mfma_f32_16x16x32_bf16 v[36:39], a[152:155], a[40:43], v[36:39]
 buffer_load_dwordx4 v1, s[16:19], s59 offen offset:1024 nt lds
 v_mfma_f32_16x16x32_bf16 v[36:39], a[148:151], a[36:39], v[36:39]
 s_add_u32 m0, s45, 128
 v_exp_f32 v27, v27
 v_mfma_f32_16x16x32_bf16 v[36:39], a[144:147], a[32:35], v[36:39]
 buffer_load_dwordx4 v1, s[16:19], s59 offen offset:2048 nt lds
 v_exp_f32 v28, v28
 v_mfma_f32_16x16x32_bf16 v[96:99], a[160:163], v[48:51], 0
 s_add_u32 m0, s45, 192
 v_cvt_pk_bf16_f32 v40, v24, v25
 v_cvt_pk_bf16_f32 v41, v26, v27
 v_mfma_f32_16x16x32_bf16 v[96:99], a[192:195], v[52:55], v[96:99]
 buffer_load_dwordx4 v1, s[16:19], s59 offen offset:3072 nt lds
 v_exp_f32 v29, v29
 v_mfma_f32_16x16x32_bf16 v[100:103], a[164:167], v[48:51], 0
 s_waitcnt lgkmcnt(3)
 v_lshlrev_b32 v14, 16, v160
 v_and_b32 v15, s34, v160
 v_lshlrev_b32 v16, 16, v161
 v_and_b32 v17, s34, v161
 v_lshlrev_b32 v18, 16, v162
 v_and_b32 v19, s34, v162
 v_lshlrev_b32 v20, 16, v163
 v_and_b32 v21, s34, v163
 v_pk_mul_f32 v[14:15], v[14:15], s[32:33] op_sel_hi:[1,0]
 v_pk_mul_f32 v[16:17], v[16:17], s[32:33] op_sel_hi:[1,0]
 v_pk_mul_f32 v[18:19], v[18:19], s[32:33] op_sel_hi:[1,0]
 v_pk_mul_f32 v[20:21], v[20:21], s[32:33] op_sel_hi:[1,0]
 v_cvt_pk_bf16_f32 v14, v14, v15
 v_cvt_pk_bf16_f32 v16, v16, v17
 v_cvt_pk_bf16_f32 v18, v18, v19
 v_cvt_pk_bf16_f32 v20, v20, v21
 v_accvgpr_write_b32 a48, v14
 v_accvgpr_write_b32 a49, v16
 v_accvgpr_write_b32 a50, v18
 v_accvgpr_write_b32 a51, v20
 v_mfma_f32_16x16x32_bf16 v[100:103], a[196:199], v[52:55], v[100:103]
 s_waitcnt lgkmcnt(2)
 v_lshlrev_b32 v14, 16, v164
 v_and_b32 v15, s34, v164
 v_lshlrev_b32 v16, 16, v165
 v_and_b32 v17, s34, v165
 v_lshlrev_b32 v18, 16, v166
 v_and_b32 v19, s34, v166
 v_lshlrev_b32 v20, 16, v167
 v_and_b32 v21, s34, v167
 v_pk_mul_f32 v[14:15], v[14:15], s[32:33] op_sel_hi:[1,0]
 v_pk_mul_f32 v[16:17], v[16:17], s[32:33] op_sel_hi:[1,0]
 v_pk_mul_f32 v[18:19], v[18:19], s[32:33] op_sel_hi:[1,0]
 v_pk_mul_f32 v[20:21], v[20:21], s[32:33] op_sel_hi:[1,0]
 v_cvt_pk_bf16_f32 v14, v14, v15
 v_cvt_pk_bf16_f32 v16, v16, v17
 v_cvt_pk_bf16_f32 v18, v18, v19
 v_cvt_pk_bf16_f32 v20, v20, v21
 v_accvgpr_write_b32 a52, v14
 v_accvgpr_write_b32 a53, v16
 v_accvgpr_write_b32 a54, v18
 v_accvgpr_write_b32 a55, v20
 v_mfma_f32_16x16x32_bf16 v[104:107], a[168:171], v[48:51], 0
 s_waitcnt lgkmcnt(1)
 v_lshlrev_b32 v14, 16, v168
 v_and_b32 v15, s34, v168
 v_lshlrev_b32 v16, 16, v169
 v_and_b32 v17, s34, v169
 v_lshlrev_b32 v18, 16, v170
 v_and_b32 v19, s34, v170
 v_lshlrev_b32 v20, 16, v171
 v_and_b32 v21, s34, v171
 v_pk_mul_f32 v[14:15], v[14:15], s[32:33] op_sel_hi:[1,0]
 v_pk_mul_f32 v[16:17], v[16:17], s[32:33] op_sel_hi:[1,0]
 v_pk_mul_f32 v[18:19], v[18:19], s[32:33] op_sel_hi:[1,0]
 v_pk_mul_f32 v[20:21], v[20:21], s[32:33] op_sel_hi:[1,0]
 v_cvt_pk_bf16_f32 v14, v14, v15
 v_cvt_pk_bf16_f32 v16, v16, v17
 v_cvt_pk_bf16_f32 v18, v18, v19
 v_cvt_pk_bf16_f32 v20, v20, v21
 v_accvgpr_write_b32 a56, v14
 v_accvgpr_write_b32 a57, v16
 v_accvgpr_write_b32 a58, v18
 v_accvgpr_write_b32 a59, v20
 v_mfma_f32_16x16x32_bf16 v[104:107], a[200:203], v[52:55], v[104:107]
 s_waitcnt lgkmcnt(0)
 v_lshlrev_b32 v14, 16, v172
 v_and_b32 v15, s34, v172
 v_lshlrev_b32 v16, 16, v173
 v_and_b32 v17, s34, v173
 v_lshlrev_b32 v18, 16, v174
 v_and_b32 v19, s34, v174
 v_lshlrev_b32 v20, 16, v175
 v_and_b32 v21, s34, v175
 v_pk_mul_f32 v[14:15], v[14:15], s[32:33] op_sel_hi:[1,0]
 v_pk_mul_f32 v[16:17], v[16:17], s[32:33] op_sel_hi:[1,0]
 v_pk_mul_f32 v[18:19], v[18:19], s[32:33] op_sel_hi:[1,0]
 v_pk_mul_f32 v[20:21], v[20:21], s[32:33] op_sel_hi:[1,0]
 v_cvt_pk_bf16_f32 v14, v14, v15
 v_cvt_pk_bf16_f32 v16, v16, v17
 v_cvt_pk_bf16_f32 v18, v18, v19
 v_cvt_pk_bf16_f32 v20, v20, v21
 v_accvgpr_write_b32 a60, v14
 v_accvgpr_write_b32 a61, v16
 v_accvgpr_write_b32 a62, v18
 v_accvgpr_write_b32 a63, v20
 v_mfma_f32_16x16x32_bf16 v[108:111], a[172:175], v[48:51], 0
 v_exp_f32 v30, v30
 v_mfma_f32_16x16x32_bf16 v[108:111], a[204:207], v[52:55], v[108:111]
 v_exp_f32 v31, v31
 v_cvt_pk_bf16_f32 v42, v28, v29
 v_cvt_pk_bf16_f32 v43, v30, v31
 v_mfma_f32_16x16x32_bf16 v[24:27], a[96:99], a[48:51], 0
 v_mfma_f32_16x16x32_bf16 v[24:27], a[100:103], a[52:55], v[24:27]
 v_exp_f32 v32, v32
 v_mfma_f32_16x16x32_bf16 v[24:27], a[104:107], a[56:59], v[24:27]
 v_exp_f32 v33, v33
 v_mfma_f32_16x16x32_bf16 v[24:27], a[108:111], a[60:63], v[24:27]
 v_exp_f32 v34, v34
 v_smfmac_f32_16x16x64_bf16 a[224:227], a[240:243], v[48:55], v2
 v_mfma_f32_16x16x32_bf16 v[28:31], a[124:127], a[60:63], 0
 v_exp_f32 v35, v35
 v_mfma_f32_16x16x32_bf16 v[28:31], a[120:123], a[56:59], v[28:31]
 v_exp_f32 v36, v36
 v_mfma_f32_16x16x32_bf16 v[28:31], a[116:119], a[52:55], v[28:31]
L_pg1_0:
 s_cbranch_execz L_pg1_4
 v_mfma_f32_16x16x32_bf16 v[28:31], a[112:115], a[48:51], v[28:31]
 s_barrier
 v_mfma_f32_16x16x32_bf16 v[112:115], a[176:179], v[48:51], 0
 v_cvt_pk_bf16_f32 v44, v32, v33
 v_cvt_pk_bf16_f32 v45, v34, v35
 v_mfma_f32_16x16x32_bf16 v[112:115], a[208:211], v[52:55], v[112:115]
 v_exp_f32 v37, v37
 v_mfma_f32_16x16x32_bf16 v[116:119], a[180:183], v[48:51], 0
 v_mfma_f32_16x16x32_bf16 v[116:119], a[212:215], v[52:55], v[116:119]
 v_exp_f32 v38, v38
 v_mfma_f32_16x16x32_bf16 v[120:123], a[184:187], v[48:51], 0
 v_exp_f32 v39, v39
 v_mfma_f32_16x16x32_bf16 v[120:123], a[216:219], v[52:55], v[120:123]
 v_mfma_f32_16x16x32_bf16 v[124:127], a[188:191], v[48:51], 0
 v_cvt_pk_bf16_f32 v46, v36, v37
 v_cvt_pk_bf16_f32 v47, v38, v39
 v_mfma_f32_16x16x32_bf16 v[124:127], a[220:223], v[52:55], v[124:127]
 v_mfma_f32_16x16x32_bf16 v[32:35], a[128:131], a[48:51], 0
 v_exp_f32 v24, v24
 v_mfma_f32_16x16x32_bf16 v[32:35], a[132:135], a[52:55], v[32:35]
 s_waitcnt vmcnt(8)
 v_exp_f32 v25, v25
 v_mfma_f32_16x16x32_bf16 v[32:35], a[136:139], a[56:59], v[32:35]
 s_add_u32 m0, s39, 50688
 ds_read_b128 v[192:195], v4 offset:13056
 ds_read_b128 v[196:199], v4 offset:13120
 v_mfma_f32_16x16x32_bf16 v[32:35], a[140:143], a[60:63], v[32:35]
 buffer_load_dwordx4 v1, s[20:23], s33 offen nt lds
 v_exp_f32 v26, v26
 v_mfma_f32_16x16x32_bf16 v[36:39], a[156:159], a[60:63], 0
 s_add_u32 m0, s39, 50720
 ds_read_b128 v[200:203], v4 offset:13184
 ds_read_b128 v[204:207], v4 offset:13248
 v_mfma_f32_16x16x32_bf16 v[36:39], a[152:155], a[56:59], v[36:39]
 buffer_load_dwordx4 v1, s[20:23], s33 offen offset:1024 nt lds
 v_exp_f32 v27, v27
 v_mfma_f32_16x16x32_bf16 v[36:39], a[148:151], a[52:55], v[36:39]
 s_add_u32 m0, s39, 50752
 v_exp_f32 v28, v28
 v_mfma_f32_16x16x32_bf16 v[36:39], a[144:147], a[48:51], v[36:39]
 buffer_load_dwordx4 v1, s[20:23], s33 offen offset:2048 nt lds
 v_mfma_f32_16x16x32_bf16 v[128:131], a[160:163], v[40:43], 0
 s_add_u32 m0, s39, 50784
 v_cvt_pk_bf16_f32 v48, v24, v25
 v_cvt_pk_bf16_f32 v49, v26, v27
 v_mfma_f32_16x16x32_bf16 v[128:131], a[192:195], v[44:47], v[128:131]
 buffer_load_dwordx4 v1, s[20:23], s33 offen offset:3072 nt lds
 v_exp_f32 v29, v29
 v_mfma_f32_16x16x32_bf16 v[132:135], a[164:167], v[40:43], 0
 s_add_u32 s33, s33, 8192
 s_waitcnt lgkmcnt(3)
 v_lshlrev_b32 v14, 16, v192
 v_and_b32 v15, s34, v192
 v_lshlrev_b32 v16, 16, v193
 v_and_b32 v17, s34, v193
 v_lshlrev_b32 v18, 16, v194
 v_and_b32 v19, s34, v194
 v_lshlrev_b32 v20, 16, v195
 v_and_b32 v21, s34, v195
 v_pk_mul_f32 v[14:15], v[14:15], s[32:33] op_sel_hi:[1,0]
 v_pk_mul_f32 v[16:17], v[16:17], s[32:33] op_sel_hi:[1,0]
 v_pk_mul_f32 v[18:19], v[18:19], s[32:33] op_sel_hi:[1,0]
 v_pk_mul_f32 v[20:21], v[20:21], s[32:33] op_sel_hi:[1,0]
 v_cvt_pk_bf16_f32 v14, v14, v15
 v_cvt_pk_bf16_f32 v16, v16, v17
 v_cvt_pk_bf16_f32 v18, v18, v19
 v_cvt_pk_bf16_f32 v20, v20, v21
 v_accvgpr_write_b32 a64, v14
 v_accvgpr_write_b32 a65, v16
 v_accvgpr_write_b32 a66, v18
 v_accvgpr_write_b32 a67, v20
 v_mfma_f32_16x16x32_bf16 v[132:135], a[196:199], v[44:47], v[132:135]
 s_waitcnt lgkmcnt(2)
 v_lshlrev_b32 v14, 16, v196
 v_and_b32 v15, s34, v196
 v_lshlrev_b32 v16, 16, v197
 v_and_b32 v17, s34, v197
 v_lshlrev_b32 v18, 16, v198
 v_and_b32 v19, s34, v198
 v_lshlrev_b32 v20, 16, v199
 v_and_b32 v21, s34, v199
 v_pk_mul_f32 v[14:15], v[14:15], s[32:33] op_sel_hi:[1,0]
 v_pk_mul_f32 v[16:17], v[16:17], s[32:33] op_sel_hi:[1,0]
 v_pk_mul_f32 v[18:19], v[18:19], s[32:33] op_sel_hi:[1,0]
 v_pk_mul_f32 v[20:21], v[20:21], s[32:33] op_sel_hi:[1,0]
 v_cvt_pk_bf16_f32 v14, v14, v15
 v_cvt_pk_bf16_f32 v16, v16, v17
 v_cvt_pk_bf16_f32 v18, v18, v19
 v_cvt_pk_bf16_f32 v20, v20, v21
 v_accvgpr_write_b32 a68, v14
 v_accvgpr_write_b32 a69, v16
 v_accvgpr_write_b32 a70, v18
 v_accvgpr_write_b32 a71, v20
 v_mfma_f32_16x16x32_bf16 v[136:139], a[168:171], v[40:43], 0
 s_waitcnt lgkmcnt(1)
 v_lshlrev_b32 v14, 16, v200
 v_and_b32 v15, s34, v200
 v_lshlrev_b32 v16, 16, v201
 v_and_b32 v17, s34, v201
 v_lshlrev_b32 v18, 16, v202
 v_and_b32 v19, s34, v202
 v_lshlrev_b32 v20, 16, v203
 v_and_b32 v21, s34, v203
 v_pk_mul_f32 v[14:15], v[14:15], s[32:33] op_sel_hi:[1,0]
 v_pk_mul_f32 v[16:17], v[16:17], s[32:33] op_sel_hi:[1,0]
 v_pk_mul_f32 v[18:19], v[18:19], s[32:33] op_sel_hi:[1,0]
 v_pk_mul_f32 v[20:21], v[20:21], s[32:33] op_sel_hi:[1,0]
 v_cvt_pk_bf16_f32 v14, v14, v15
 v_cvt_pk_bf16_f32 v16, v16, v17
 v_cvt_pk_bf16_f32 v18, v18, v19
 v_cvt_pk_bf16_f32 v20, v20, v21
 v_accvgpr_write_b32 a72, v14
 v_accvgpr_write_b32 a73, v16
 v_accvgpr_write_b32 a74, v18
 v_accvgpr_write_b32 a75, v20
 v_mfma_f32_16x16x32_bf16 v[136:139], a[200:203], v[44:47], v[136:139]
 s_waitcnt lgkmcnt(0)
 v_lshlrev_b32 v14, 16, v204
 v_and_b32 v15, s34, v204
 v_lshlrev_b32 v16, 16, v205
 v_and_b32 v17, s34, v205
 v_lshlrev_b32 v18, 16, v206
 v_and_b32 v19, s34, v206
 v_lshlrev_b32 v20, 16, v207
 v_and_b32 v21, s34, v207
 v_pk_mul_f32 v[14:15], v[14:15], s[32:33] op_sel_hi:[1,0]
 v_pk_mul_f32 v[16:17], v[16:17], s[32:33] op_sel_hi:[1,0]
 v_pk_mul_f32 v[18:19], v[18:19], s[32:33] op_sel_hi:[1,0]
 v_pk_mul_f32 v[20:21], v[20:21], s[32:33] op_sel_hi:[1,0]
 v_cvt_pk_bf16_f32 v14, v14, v15
 v_cvt_pk_bf16_f32 v16, v16, v17
 v_cvt_pk_bf16_f32 v18, v18, v19
 v_cvt_pk_bf16_f32 v20, v20, v21
 v_accvgpr_write_b32 a76, v14
 v_accvgpr_write_b32 a77, v16
 v_accvgpr_write_b32 a78, v18
 v_accvgpr_write_b32 a79, v20
 v_mfma_f32_16x16x32_bf16 v[140:143], a[172:175], v[40:43], 0
 v_exp_f32 v30, v30
 v_mfma_f32_16x16x32_bf16 v[140:143], a[204:207], v[44:47], v[140:143]
 v_exp_f32 v31, v31
 v_cvt_pk_bf16_f32 v50, v28, v29
 v_cvt_pk_bf16_f32 v51, v30, v31
 v_mfma_f32_16x16x32_bf16 v[24:27], a[96:99], a[64:67], 0
 v_exp_f32 v32, v32
 v_mfma_f32_16x16x32_bf16 v[24:27], a[100:103], a[68:71], v[24:27]
 v_mfma_f32_16x16x32_bf16 v[24:27], a[104:107], a[72:75], v[24:27]
 v_exp_f32 v33, v33
 v_mfma_f32_16x16x32_bf16 v[24:27], a[108:111], a[76:79], v[24:27]
 v_exp_f32 v34, v34
 v_smfmac_f32_16x16x64_bf16 a[228:231], a[236:239], v[40:47], v2
 v_mfma_f32_16x16x32_bf16 v[28:31], a[124:127], a[76:79], 0
 v_exp_f32 v35, v35
 v_mfma_f32_16x16x32_bf16 v[28:31], a[120:123], a[72:75], v[28:31]
 v_exp_f32 v36, v36
 v_mfma_f32_16x16x32_bf16 v[28:31], a[116:119], a[68:71], v[28:31]
 v_mfma_f32_16x16x32_bf16 v[28:31], a[112:115], a[64:67], v[28:31]
 v_cvt_pk_bf16_f32 v52, v32, v33
 v_cvt_pk_bf16_f32 v53, v34, v35
 v_mfma_f32_16x16x32_bf16 v[144:147], a[176:179], v[40:43], 0
 v_mfma_f32_16x16x32_bf16 v[144:147], a[208:211], v[44:47], v[144:147]
 v_exp_f32 v37, v37
 v_mfma_f32_16x16x32_bf16 v[148:151], a[180:183], v[40:43], 0
 v_exp_f32 v38, v38
 v_mfma_f32_16x16x32_bf16 v[148:151], a[212:215], v[44:47], v[148:151]
 v_mfma_f32_16x16x32_bf16 v[152:155], a[184:187], v[40:43], 0
 v_exp_f32 v39, v39
 v_mfma_f32_16x16x32_bf16 v[152:155], a[216:219], v[44:47], v[152:155]
 v_mfma_f32_16x16x32_bf16 v[156:159], a[188:191], v[40:43], 0
 v_cvt_pk_bf16_f32 v54, v36, v37
 v_cvt_pk_bf16_f32 v55, v38, v39
 v_mfma_f32_16x16x32_bf16 v[156:159], a[220:223], v[44:47], v[156:159]
 v_mfma_f32_16x16x32_bf16 v[32:35], a[128:131], a[64:67], 0
 v_exp_f32 v24, v24
 v_mfma_f32_16x16x32_bf16 v[32:35], a[132:135], a[68:71], v[32:35]
 s_waitcnt vmcnt(4)
 v_exp_f32 v25, v25
 v_mfma_f32_16x16x32_bf16 v[32:35], a[136:139], a[72:75], v[32:35]
 ds_read_b128 v[224:227], v4 offset:0
 ds_read_b128 v[228:231], v4 offset:64
 v_mfma_f32_16x16x32_bf16 v[32:35], a[140:143], a[76:79], v[32:35]
 v_exp_f32 v26, v26
 v_mfma_f32_16x16x32_bf16 v[36:39], a[156:159], a[76:79], 0
 ds_read_b128 v[232:235], v4 offset:128
 ds_read_b128 v[236:239], v4 offset:192
 v_mfma_f32_16x16x32_bf16 v[36:39], a[152:155], a[72:75], v[36:39]
 v_exp_f32 v27, v27
 v_mfma_f32_16x16x32_bf16 v[36:39], a[148:151], a[68:71], v[36:39]
 v_exp_f32 v28, v28
 v_mfma_f32_16x16x32_bf16 v[36:39], a[144:147], a[64:67], v[36:39]
 v_cvt_pk_bf16_f32 v40, v24, v25
 v_cvt_pk_bf16_f32 v41, v26, v27
 v_mfma_f32_16x16x32_bf16 v[160:163], a[160:163], v[48:51], 0
 v_exp_f32 v29, v29
 v_mfma_f32_16x16x32_bf16 v[160:163], a[192:195], v[52:55], v[160:163]
 v_exp_f32 v30, v30
 v_mfma_f32_16x16x32_bf16 v[164:167], a[164:167], v[48:51], 0
 s_waitcnt lgkmcnt(3)
 v_lshlrev_b32 v14, 16, v224
 v_and_b32 v15, s34, v224
 v_lshlrev_b32 v16, 16, v225
 v_and_b32 v17, s34, v225
 v_lshlrev_b32 v18, 16, v226
 v_and_b32 v19, s34, v226
 v_lshlrev_b32 v20, 16, v227
 v_and_b32 v21, s34, v227
 v_pk_mul_f32 v[14:15], v[14:15], s[32:33] op_sel_hi:[1,0]
 v_pk_mul_f32 v[16:17], v[16:17], s[32:33] op_sel_hi:[1,0]
 v_pk_mul_f32 v[18:19], v[18:19], s[32:33] op_sel_hi:[1,0]
 v_pk_mul_f32 v[20:21], v[20:21], s[32:33] op_sel_hi:[1,0]
 v_cvt_pk_bf16_f32 v14, v14, v15
 v_cvt_pk_bf16_f32 v16, v16, v17
 v_cvt_pk_bf16_f32 v18, v18, v19
 v_cvt_pk_bf16_f32 v20, v20, v21
 v_accvgpr_write_b32 a80, v14
 v_accvgpr_write_b32 a81, v16
 v_accvgpr_write_b32 a82, v18
 v_accvgpr_write_b32 a83, v20
 v_mfma_f32_16x16x32_bf16 v[164:167], a[196:199], v[52:55], v[164:167]
 s_waitcnt lgkmcnt(2)
 v_lshlrev_b32 v14, 16, v228
 v_and_b32 v15, s34, v228
 v_lshlrev_b32 v16, 16, v229
 v_and_b32 v17, s34, v229
 v_lshlrev_b32 v18, 16, v230
 v_and_b32 v19, s34, v230
 v_lshlrev_b32 v20, 16, v231
 v_and_b32 v21, s34, v231
 v_pk_mul_f32 v[14:15], v[14:15], s[32:33] op_sel_hi:[1,0]
 v_pk_mul_f32 v[16:17], v[16:17], s[32:33] op_sel_hi:[1,0]
 v_pk_mul_f32 v[18:19], v[18:19], s[32:33] op_sel_hi:[1,0]
 v_pk_mul_f32 v[20:21], v[20:21], s[32:33] op_sel_hi:[1,0]
 v_cvt_pk_bf16_f32 v14, v14, v15
 v_cvt_pk_bf16_f32 v16, v16, v17
 v_cvt_pk_bf16_f32 v18, v18, v19
 v_cvt_pk_bf16_f32 v20, v20, v21
 v_accvgpr_write_b32 a84, v14
 v_accvgpr_write_b32 a85, v16
 v_accvgpr_write_b32 a86, v18
 v_accvgpr_write_b32 a87, v20
 v_mfma_f32_16x16x32_bf16 v[168:171], a[168:171], v[48:51], 0
 s_waitcnt lgkmcnt(1)
 v_lshlrev_b32 v14, 16, v232
 v_and_b32 v15, s34, v232
 v_lshlrev_b32 v16, 16, v233
 v_and_b32 v17, s34, v233
 v_lshlrev_b32 v18, 16, v234
 v_and_b32 v19, s34, v234
 v_lshlrev_b32 v20, 16, v235
 v_and_b32 v21, s34, v235
 v_pk_mul_f32 v[14:15], v[14:15], s[32:33] op_sel_hi:[1,0]
 v_pk_mul_f32 v[16:17], v[16:17], s[32:33] op_sel_hi:[1,0]
 v_pk_mul_f32 v[18:19], v[18:19], s[32:33] op_sel_hi:[1,0]
 v_pk_mul_f32 v[20:21], v[20:21], s[32:33] op_sel_hi:[1,0]
 v_cvt_pk_bf16_f32 v14, v14, v15
 v_cvt_pk_bf16_f32 v16, v16, v17
 v_cvt_pk_bf16_f32 v18, v18, v19
 v_cvt_pk_bf16_f32 v20, v20, v21
 v_accvgpr_write_b32 a88, v14
 v_accvgpr_write_b32 a89, v16
 v_accvgpr_write_b32 a90, v18
 v_accvgpr_write_b32 a91, v20
 v_mfma_f32_16x16x32_bf16 v[168:171], a[200:203], v[52:55], v[168:171]
 s_waitcnt lgkmcnt(0)
 v_lshlrev_b32 v14, 16, v236
 v_and_b32 v15, s34, v236
 v_lshlrev_b32 v16, 16, v237
 v_and_b32 v17, s34, v237
 v_lshlrev_b32 v18, 16, v238
 v_and_b32 v19, s34, v238
 v_lshlrev_b32 v20, 16, v239
 v_and_b32 v21, s34, v239
 v_pk_mul_f32 v[14:15], v[14:15], s[32:33] op_sel_hi:[1,0]
 v_pk_mul_f32 v[16:17], v[16:17], s[32:33] op_sel_hi:[1,0]
 v_pk_mul_f32 v[18:19], v[18:19], s[32:33] op_sel_hi:[1,0]
 v_pk_mul_f32 v[20:21], v[20:21], s[32:33] op_sel_hi:[1,0]
 v_cvt_pk_bf16_f32 v14, v14, v15
 v_cvt_pk_bf16_f32 v16, v16, v17
 v_cvt_pk_bf16_f32 v18, v18, v19
 v_cvt_pk_bf16_f32 v20, v20, v21
 v_accvgpr_write_b32 a92, v14
 v_accvgpr_write_b32 a93, v16
 v_accvgpr_write_b32 a94, v18
 v_accvgpr_write_b32 a95, v20
 v_mfma_f32_16x16x32_bf16 v[172:175], a[172:175], v[48:51], 0
 v_exp_f32 v31, v31
 v_mfma_f32_16x16x32_bf16 v[172:175], a[204:207], v[52:55], v[172:175]
 v_cvt_pk_bf16_f32 v42, v28, v29
 v_cvt_pk_bf16_f32 v43, v30, v31
 v_mfma_f32_16x16x32_bf16 v[24:27], a[96:99], a[80:83], 0
 v_exp_f32 v32, v32
 v_mfma_f32_16x16x32_bf16 v[24:27], a[100:103], a[84:87], v[24:27]
 v_exp_f32 v33, v33
 v_mfma_f32_16x16x32_bf16 v[24:27], a[104:107], a[88:91], v[24:27]
 v_mfma_f32_16x16x32_bf16 v[24:27], a[108:111], a[92:95], v[24:27]
 v_exp_f32 v34, v34
 v_smfmac_f32_16x16x64_bf16 a[228:231], a[240:243], v[48:55], v2
 v_mfma_f32_16x16x32_bf16 v[28:31], a[124:127], a[92:95], 0
 v_exp_f32 v35, v35
 v_mfma_f32_16x16x32_bf16 v[28:31], a[120:123], a[88:91], v[28:31]
 v_exp_f32 v36, v36
 v_mfma_f32_16x16x32_bf16 v[28:31], a[116:119], a[84:87], v[28:31]
 v_mfma_f32_16x16x32_bf16 v[28:31], a[112:115], a[80:83], v[28:31]
 v_cvt_pk_bf16_f32 v44, v32, v33
 v_cvt_pk_bf16_f32 v45, v34, v35
 v_mfma_f32_16x16x32_bf16 v[176:179], a[176:179], v[48:51], 0
 v_mfma_f32_16x16x32_bf16 v[176:179], a[208:211], v[52:55], v[176:179]
 v_exp_f32 v37, v37
 v_mfma_f32_16x16x32_bf16 v[180:183], a[180:183], v[48:51], 0
 v_exp_f32 v38, v38
 v_mfma_f32_16x16x32_bf16 v[180:183], a[212:215], v[52:55], v[180:183]
 v_exp_f32 v39, v39
 v_mfma_f32_16x16x32_bf16 v[184:187], a[184:187], v[48:51], 0
 v_mfma_f32_16x16x32_bf16 v[184:187], a[216:219], v[52:55], v[184:187]
 v_cvt_pk_bf16_f32 v46, v36, v37
 v_cvt_pk_bf16_f32 v47, v38, v39
 v_mfma_f32_16x16x32_bf16 v[188:191], a[188:191], v[48:51], 0
 v_mfma_f32_16x16x32_bf16 v[188:191], a[220:223], v[52:55], v[188:191]
 s_waitcnt vmcnt(8)
 s_barrier
 v_mfma_f32_16x16x32_bf16 v[32:35], a[128:131], a[80:83], 0
 v_exp_f32 v24, v24
 v_mfma_f32_16x16x32_bf16 v[32:35], a[132:135], a[84:87], v[32:35]
 ds_read_b128 a[96:99], v7 offset:33792
 ds_read_b128 a[100:103], v7 offset:33856
 v_mfma_f32_16x16x32_bf16 v[32:35], a[136:139], a[88:91], v[32:35]
 v_exp_f32 v25, v25
 v_mfma_f32_16x16x32_bf16 v[32:35], a[140:143], a[92:95], v[32:35]
 ds_read_b128 a[104:107], v7 offset:33920
 ds_read_b128 a[108:111], v7 offset:33984
 v_mfma_f32_16x16x32_bf16 v[36:39], a[156:159], a[92:95], 0
 v_exp_f32 v26, v26
 v_mfma_f32_16x16x32_bf16 v[36:39], a[152:155], a[88:91], v[36:39]
 v_exp_f32 v27, v27
 v_mfma_f32_16x16x32_bf16 v[36:39], a[148:151], a[84:87], v[36:39]
 ds_read_b128 a[124:127], v7 offset:34496
 ds_read_b128 a[120:123], v7 offset:34432
 v_mfma_f32_16x16x32_bf16 v[36:39], a[144:147], a[80:83], v[36:39]
 v_exp_f32 v28, v28
 v_mfma_f32_16x16x32_bf16 v[192:195], a[160:163], v[40:43], 0
 ds_read_b128 a[116:119], v7 offset:34368
 ds_read_b128 a[112:115], v7 offset:34304
 v_mfma_f32_16x16x32_bf16 v[192:195], a[192:195], v[44:47], v[192:195]
 v_cvt_pk_bf16_f32 v48, v24, v25
 v_cvt_pk_bf16_f32 v49, v26, v27
 v_mfma_f32_16x16x32_bf16 v[196:199], a[164:167], v[40:43], 0
 v_exp_f32 v29, v29
 v_mfma_f32_16x16x32_bf16 v[196:199], a[196:199], v[44:47], v[196:199]
 v_exp_f32 v30, v30
 v_mfma_f32_16x16x32_bf16 v[200:203], a[168:171], v[40:43], 0
 v_exp_f32 v31, v31
 v_mfma_f32_16x16x32_bf16 v[200:203], a[200:203], v[44:47], v[200:203]
 v_mfma_f32_16x16x32_bf16 v[204:207], a[172:175], v[40:43], 0
 v_cvt_pk_bf16_f32 v50, v28, v29
 v_cvt_pk_bf16_f32 v51, v30, v31
 v_mfma_f32_16x16x32_bf16 v[204:207], a[204:207], v[44:47], v[204:207]
 s_waitcnt lgkmcnt(4)
 s_waitcnt vmcnt(0)
 s_barrier
 v_mfma_f32_16x16x32_bf16 v[24:27], a[96:99], a[0:3], 0
 v_mfma_f32_16x16x32_bf16 v[24:27], a[100:103], a[4:7], v[24:27]
 ds_read_b128 a[128:131], v7 offset:50688
 ds_read_b128 a[132:135], v7 offset:50752
 v_mfma_f32_16x16x32_bf16 v[24:27], a[104:107], a[8:11], v[24:27]
 v_exp_f32 v32, v32
 v_mfma_f32_16x16x32_bf16 v[24:27], a[108:111], a[12:15], v[24:27]
 s_waitcnt lgkmcnt(2)
 v_smfmac_f32_16x16x64_bf16 a[232:235], a[236:239], v[40:47], v2
 ds_read_b128 a[136:139], v7 offset:50816
 ds_read_b128 a[140:143], v7 offset:50880
 v_exp_f32 v33, v33
 v_exp_f32 v34, v34
 v_mfma_f32_16x16x32_bf16 v[28:31], a[124:127], a[12:15], 0
 v_mfma_f32_16x16x32_bf16 v[28:31], a[120:123], a[8:11], v[28:31]
 ds_read_b128 a[156:159], v7 offset:51392
 ds_read_b128 a[152:155], v7 offset:51328
 v_mfma_f32_16x16x32_bf16 v[28:31], a[116:119], a[4:7], v[28:31]
 s_add_u32 m0, s39, 0
 v_exp_f32 v35, v35
 v_mfma_f32_16x16x32_bf16 v[28:31], a[112:115], a[0:3], v[28:31]
 buffer_load_dwordx4 v1, s[20:23], s33 offen nt lds
 v_exp_f32 v36, v36
 v_cvt_pk_bf16_f32 v52, v32, v33
 v_mfma_f32_16x16x32_bf16 v[208:211], a[176:179], v[40:43], 0
 ds_read_b128 a[148:151], v7 offset:51264
 ds_read_b128 a[144:147], v7 offset:51200
 v_mfma_f32_16x16x32_bf16 v[208:211], a[208:211], v[44:47], v[208:211]
 v_mfma_f32_16x16x32_bf16 v[212:215], a[180:183], v[40:43], 0
 v_mfma_f32_16x16x32_bf16 v[212:215], a[212:215], v[44:47], v[212:215]
 v_cvt_pk_bf16_f32 v53, v34, v35
 v_exp_f32 v37, v37
 v_exp_f32 v38, v38
 v_mfma_f32_16x16x32_bf16 v[216:219], a[184:187], v[40:43], 0
 v_mfma_f32_16x16x32_bf16 v[216:219], a[216:219], v[44:47], v[216:219]
 v_mfma_f32_16x16x32_bf16 v[220:223], a[188:191], v[40:43], 0
 s_add_u32 m0, s39, 32
 v_exp_f32 v39, v39
 v_mfma_f32_16x16x32_bf16 v[220:223], a[220:223], v[44:47], v[220:223]
 s_waitcnt lgkmcnt(4)
 buffer_load_dwordx4 v1, s[20:23], s33 offen offset:1024 nt lds
 v_cvt_pk_bf16_f32 v54, v36, v37
 v_cvt_pk_bf16_f32 v55, v38, v39
 v_mfma_f32_16x16x32_bf16 v[32:35], a[128:131], a[0:3], 0
 v_mfma_f32_16x16x32_bf16 v[32:35], a[132:135], a[4:7], v[32:35]
 v_mfma_f32_16x16x32_bf16 v[32:35], a[136:139], a[8:11], v[32:35]
 v_exp_f32 v24, v24
 v_mfma_f32_16x16x32_bf16 v[32:35], a[140:143], a[12:15], v[32:35]
 s_waitcnt lgkmcnt(0)
 v_mfma_f32_16x16x32_bf16 v[36:39], a[156:159], a[12:15], 0
 v_mfma_f32_16x16x32_bf16 v[36:39], a[152:155], a[8:11], v[36:39]
 v_exp_f32 v25, v25
 v_mfma_f32_16x16x32_bf16 v[36:39], a[148:151], a[4:7], v[36:39]
 s_add_u32 m0, s39, 64
 v_mfma_f32_16x16x32_bf16 v[36:39], a[144:147], a[0:3], v[36:39]
 buffer_load_dwordx4 v1, s[20:23], s33 offen offset:2048 nt lds
 v_exp_f32 v26, v26
 v_exp_f32 v27, v27
 v_mfma_f32_16x16x32_bf16 v[224:227], a[160:163], v[48:51], 0
 v_exp_f32 v28, v28
 v_mfma_f32_16x16x32_bf16 v[224:227], a[192:195], v[52:55], v[224:227]
 v_mfma_f32_16x16x32_bf16 v[228:231], a[164:167], v[48:51], 0
 ds_read_b64_tr_b16 a[160:161], v8 offset:33792
 ds_read_b64_tr_b16 a[162:163], v8 offset:34304
 v_mfma_f32_16x16x32_bf16 v[228:231], a[196:199], v[52:55], v[228:231]
 v_mfma_f32_16x16x32_bf16 v[232:235], a[168:171], v[48:51], 0
 s_add_u32 m0, s39, 96
 ds_read_b64_tr_b16 a[192:193], v8 offset:50688
 ds_read_b64_tr_b16 a[194:195], v8 offset:51200
 v_mfma_f32_16x16x32_bf16 v[232:235], a[200:203], v[52:55], v[232:235]
 buffer_load_dwordx4 v1, s[20:23], s33 offen offset:3072 nt lds
 v_cvt_pk_bf16_f32 v40, v24, v25
 v_cvt_pk_bf16_f32 v41, v26, v27
 v_exp_f32 v29, v29
 v_mfma_f32_16x16x32_bf16 v[236:239], a[172:175], v[48:51], 0
 s_add_u32 s33, s33, 8192
 v_exp_f32 v30, v30
 v_mfma_f32_16x16x32_bf16 v[236:239], a[204:207], v[52:55], v[236:239]
 ds_read_b64_tr_b16 a[164:165], v8 offset:33824
 ds_read_b64_tr_b16 a[166:167], v8 offset:34336
 v_exp_f32 v31, v31
 v_cvt_pk_bf16_f32 v42, v28, v29
 v_cvt_pk_bf16_f32 v43, v30, v31
 v_mfma_f32_16x16x32_bf16 v[24:27], a[96:99], a[16:19], 0
 v_mfma_f32_16x16x32_bf16 v[24:27], a[100:103], a[20:23], v[24:27]
 ds_read_b64_tr_b16 a[196:197], v8 offset:50720
 ds_read_b64_tr_b16 a[198:199], v8 offset:51232
 v_mfma_f32_16x16x32_bf16 v[24:27], a[104:107], a[24:27], v[24:27]
 v_mfma_f32_16x16x32_bf16 v[24:27], a[108:111], a[28:31], v[24:27]
 ds_read_b64_tr_b16 a[168:169], v8 offset:33856
 ds_read_b64_tr_b16 a[170:171], v8 offset:34368
 v_exp_f32 v32, v32
 v_smfmac_f32_16x16x64_bf16 a[232:235], a[240:243], v[48:55], v2
 v_exp_f32 v33, v33
 v_exp_f32 v34, v34
 v_mfma_f32_16x16x32_bf16 v[28:31], a[124:127], a[28:31], 0
 ds_read_b64_tr_b16 a[200:201], v8 offset:50752
 ds_read_b64_tr_b16 a[202:203], v8 offset:51264
 v_mfma_f32_16x16x32_bf16 v[28:31], a[120:123], a[24:27], v[28:31]
 s_add_u32 m0, s39, 16896
 v_mfma_f32_16x16x32_bf16 v[28:31], a[116:119], a[20:23], v[28:31]
 buffer_load_dwordx4 v1, s[20:23], s33 offen nt lds
 v_exp_f32 v35, v35
 v_mfma_f32_16x16x32_bf16 v[28:31], a[112:115], a[16:19], v[28:31]
 ds_read_b64_tr_b16 a[172:173], v8 offset:33888
 ds_read_b64_tr_b16 a[174:175], v8 offset:34400
 v_exp_f32 v36, v36
 v_cvt_pk_bf16_f32 v44, v32, v33
 v_mfma_f32_16x16x32_bf16 v[240:243], a[176:179], v[48:51], 0
 v_mfma_f32_16x16x32_bf16 v[240:243], a[208:211], v[52:55], v[240:243]
 ds_read_b64_tr_b16 a[204:205], v8 offset:50784
 ds_read_b64_tr_b16 a[206:207], v8 offset:51296
 v_cvt_pk_bf16_f32 v45, v34, v35
 v_exp_f32 v37, v37
 v_mfma_f32_16x16x32_bf16 v[244:247], a[180:183], v[48:51], 0
 v_exp_f32 v38, v38
 v_mfma_f32_16x16x32_bf16 v[244:247], a[212:215], v[52:55], v[244:247]
 v_mfma_f32_16x16x32_bf16 v[248:251], a[184:187], v[48:51], 0
 v_mfma_f32_16x16x32_bf16 v[248:251], a[216:219], v[52:55], v[248:251]
 ds_read_b64_tr_b16 a[176:177], v8 offset:33920
 ds_read_b64_tr_b16 a[178:179], v8 offset:34432
 v_exp_f32 v39, v39
 v_mfma_f32_16x16x32_bf16 v[252:255], a[188:191], v[48:51], 0
 s_add_u32 m0, s39, 16928
 v_cvt_pk_bf16_f32 v46, v36, v37
 v_cvt_pk_bf16_f32 v47, v38, v39
 v_mfma_f32_16x16x32_bf16 v[252:255], a[220:223], v[52:55], v[252:255]
 buffer_load_dwordx4 v1, s[20:23], s33 offen offset:1024 nt lds
 v_exp_f32 v24, v24
 v_mfma_f32_16x16x32_bf16 v[32:35], a[128:131], a[16:19], 0
 ds_read_b64_tr_b16 a[208:209], v8 offset:50816
 ds_read_b64_tr_b16 a[210:211], v8 offset:51328
 v_mfma_f32_16x16x32_bf16 v[32:35], a[132:135], a[20:23], v[32:35]
 v_mfma_f32_16x16x32_bf16 v[32:35], a[136:139], a[24:27], v[32:35]
 v_mfma_f32_16x16x32_bf16 v[32:35], a[140:143], a[28:31], v[32:35]
 ds_read_b64_tr_b16 a[180:181], v8 offset:33952
 ds_read_b64_tr_b16 a[182:183], v8 offset:34464
 v_exp_f32 v25, v25
 v_exp_f32 v26, v26
 v_mfma_f32_16x16x32_bf16 v[36:39], a[156:159], a[28:31], 0
 v_exp_f32 v27, v27
 v_mfma_f32_16x16x32_bf16 v[36:39], a[152:155], a[24:27], v[36:39]
 v_mfma_f32_16x16x32_bf16 v[36:39], a[148:151], a[20:23], v[36:39]
 s_add_u32 m0, s39, 16960
 ds_read_b64_tr_b16 a[212:213], v8 offset:50848
 ds_read_b64_tr_b16 a[214:215], v8 offset:51360
 v_mfma_f32_16x16x32_bf16 v[36:39], a[144:147], a[16:19], v[36:39]
 s_waitcnt lgkmcnt(15)
 buffer_load_dwordx4 v1, s[20:23], s33 offen offset:2048 nt lds
 v_exp_f32 v28, v28
 v_mfma_f32_16x16x32_bf16 v[64:67], a[160:163], v[40:43], v[64:67]
 v_mfma_f32_16x16x32_bf16 v[64:67], a[192:195], v[44:47], v[64:67]
 ds_read_b64_tr_b16 a[184:185], v8 offset:33984
 ds_read_b64_tr_b16 a[186:187], v8 offset:34496
 v_cvt_pk_bf16_f32 v48, v24, v25
 v_cvt_pk_bf16_f32 v49, v26, v27
 v_exp_f32 v29, v29
 v_mfma_f32_16x16x32_bf16 v[68:71], a[164:167], v[40:43], v[68:71]
 v_exp_f32 v30, v30
 v_mfma_f32_16x16x32_bf16 v[68:71], a[196:199], v[44:47], v[68:71]
 s_waitcnt lgkmcnt(10)
 v_mfma_f32_16x16x32_bf16 v[72:75], a[168:171], v[40:43], v[72:75]
 s_add_u32 m0, s39, 16992
 ds_read_b64_tr_b16 a[216:217], v8 offset:50880
 ds_read_b64_tr_b16 a[218:219], v8 offset:51392
 v_mfma_f32_16x16x32_bf16 v[72:75], a[200:203], v[44:47], v[72:75]
 buffer_load_dwordx4 v1, s[20:23], s33 offen offset:3072 nt lds
 v_exp_f32 v31, v31
 v_mfma_f32_16x16x32_bf16 v[76:79], a[172:175], v[40:43], v[76:79]
 s_add_u32 s33, s33, 8192
 v_mfma_f32_16x16x32_bf16 v[76:79], a[204:207], v[44:47], v[76:79]
 ds_read_b64_tr_b16 a[188:189], v8 offset:34016
 ds_read_b64_tr_b16 a[190:191], v8 offset:34528
 v_cvt_pk_bf16_f32 v50, v28, v29
 v_cvt_pk_bf16_f32 v51, v30, v31
 v_exp_f32 v32, v32
 v_mfma_f32_16x16x32_bf16 v[24:27], a[96:99], a[32:35], 0
 v_exp_f32 v33, v33
 v_mfma_f32_16x16x32_bf16 v[24:27], a[100:103], a[36:39], v[24:27]
 v_mfma_f32_16x16x32_bf16 v[24:27], a[104:107], a[40:43], v[24:27]
 ds_read_b64_tr_b16 a[220:221], v8 offset:50912
 ds_read_b64_tr_b16 a[222:223], v8 offset:51424
 v_mfma_f32_16x16x32_bf16 v[24:27], a[108:111], a[44:47], v[24:27]
 v_smfmac_f32_16x16x64_bf16 a[224:227], a[236:239], v[40:47], v2
 v_exp_f32 v34, v34
 v_exp_f32 v35, v35
 v_mfma_f32_16x16x32_bf16 v[28:31], a[124:127], a[44:47], 0
 v_mfma_f32_16x16x32_bf16 v[28:31], a[120:123], a[40:43], v[28:31]
 v_mfma_f32_16x16x32_bf16 v[28:31], a[116:119], a[36:39], v[28:31]
 v_exp_f32 v36, v36
 v_mfma_f32_16x16x32_bf16 v[28:31], a[112:115], a[32:35], v[28:31]
 s_waitcnt lgkmcnt(8)
 v_mfma_f32_16x16x32_bf16 v[80:83], a[176:179], v[40:43], v[80:83]
 v_mfma_f32_16x16x32_bf16 v[80:83], a[208:211], v[44:47], v[80:83]
 v_cvt_pk_bf16_f32 v52, v32, v33
 v_cvt_pk_bf16_f32 v53, v34, v35
 v_exp_f32 v37, v37
 v_mfma_f32_16x16x32_bf16 v[84:87], a[180:183], v[40:43], v[84:87]
 v_mfma_f32_16x16x32_bf16 v[84:87], a[212:215], v[44:47], v[84:87]
 s_waitcnt lgkmcnt(0)
 s_barrier
 v_mfma_f32_16x16x32_bf16 v[88:91], a[184:187], v[40:43], v[88:91]
 v_mfma_f32_16x16x32_bf16 v[88:91], a[216:219], v[44:47], v[88:91]
 v_exp_f32 v38, v38
 v_exp_f32 v39, v39
 v_cvt_pk_bf16_f32 v54, v36, v37
 v_mfma_f32_16x16x32_bf16 v[92:95], a[188:191], v[40:43], v[92:95]
 v_mfma_f32_16x16x32_bf16 v[92:95], a[220:223], v[44:47], v[92:95]
 v_cvt_pk_bf16_f32 v55, v38, v39
 v_exp_f32 v24, v24
 v_exp_f32 v25, v25
 v_mfma_f32_16x16x32_bf16 v[32:35], a[128:131], a[32:35], 0
 v_mfma_f32_16x16x32_bf16 v[32:35], a[132:135], a[36:39], v[32:35]
 v_mfma_f32_16x16x32_bf16 v[32:35], a[136:139], a[40:43], v[32:35]
 v_exp_f32 v26, v26
 v_mfma_f32_16x16x32_bf16 v[32:35], a[140:143], a[44:47], v[32:35]
 v_mfma_f32_16x16x32_bf16 v[36:39], a[156:159], a[44:47], 0
 v_mfma_f32_16x16x32_bf16 v[36:39], a[152:155], a[40:43], v[36:39]
 v_exp_f32 v27, v27
 v_mfma_f32_16x16x32_bf16 v[36:39], a[148:151], a[36:39], v[36:39]
 v_mfma_f32_16x16x32_bf16 v[36:39], a[144:147], a[32:35], v[36:39]
 v_mfma_f32_16x16x32_bf16 v[96:99], a[160:163], v[48:51], v[96:99]
 v_exp_f32 v28, v28
 v_mfma_f32_16x16x32_bf16 v[96:99], a[192:195], v[52:55], v[96:99]
 v_mfma_f32_16x16x32_bf16 v[100:103], a[164:167], v[48:51], v[100:103]
 v_mfma_f32_16x16x32_bf16 v[100:103], a[196:199], v[52:55], v[100:103]
 v_cvt_pk_bf16_f32 v40, v24, v25
 v_cvt_pk_bf16_f32 v41, v26, v27
 v_exp_f32 v29, v29
 v_mfma_f32_16x16x32_bf16 v[104:107], a[168:171], v[48:51], v[104:107]
 v_mfma_f32_16x16x32_bf16 v[104:107], a[200:203], v[52:55], v[104:107]
 v_mfma_f32_16x16x32_bf16 v[108:111], a[172:175], v[48:51], v[108:111]
 v_exp_f32 v30, v30
 v_mfma_f32_16x16x32_bf16 v[108:111], a[204:207], v[52:55], v[108:111]
 v_mfma_f32_16x16x32_bf16 v[24:27], a[96:99], a[48:51], 0
 v_exp_f32 v31, v31
 v_mfma_f32_16x16x32_bf16 v[24:27], a[100:103], a[52:55], v[24:27]
 v_cvt_pk_bf16_f32 v42, v28, v29
 v_cvt_pk_bf16_f32 v43, v30, v31
 v_mfma_f32_16x16x32_bf16 v[24:27], a[104:107], a[56:59], v[24:27]
 v_mfma_f32_16x16x32_bf16 v[24:27], a[108:111], a[60:63], v[24:27]
 v_exp_f32 v32, v32
 v_exp_f32 v33, v33
 v_smfmac_f32_16x16x64_bf16 a[224:227], a[240:243], v[48:55], v2
L_pg1_1:
 s_cbranch_execz L_pg1_5
 v_mfma_f32_16x16x32_bf16 v[28:31], a[124:127], a[60:63], 0
 v_exp_f32 v34, v34
 v_mfma_f32_16x16x32_bf16 v[28:31], a[120:123], a[56:59], v[28:31]
 v_mfma_f32_16x16x32_bf16 v[28:31], a[116:119], a[52:55], v[28:31]
 v_exp_f32 v35, v35
 v_mfma_f32_16x16x32_bf16 v[28:31], a[112:115], a[48:51], v[28:31]
 v_mfma_f32_16x16x32_bf16 v[112:115], a[176:179], v[48:51], v[112:115]
 v_exp_f32 v36, v36
 v_mfma_f32_16x16x32_bf16 v[112:115], a[208:211], v[52:55], v[112:115]
 v_mfma_f32_16x16x32_bf16 v[116:119], a[180:183], v[48:51], v[116:119]
 v_cvt_pk_bf16_f32 v44, v32, v33
 v_cvt_pk_bf16_f32 v45, v34, v35
 v_mfma_f32_16x16x32_bf16 v[116:119], a[212:215], v[52:55], v[116:119]
 v_mfma_f32_16x16x32_bf16 v[120:123], a[184:187], v[48:51], v[120:123]
 v_exp_f32 v37, v37
 v_mfma_f32_16x16x32_bf16 v[120:123], a[216:219], v[52:55], v[120:123]
 v_mfma_f32_16x16x32_bf16 v[124:127], a[188:191], v[48:51], v[124:127]
 v_mfma_f32_16x16x32_bf16 v[124:127], a[220:223], v[52:55], v[124:127]
 v_exp_f32 v38, v38
 v_exp_f32 v39, v39
 v_mfma_f32_16x16x32_bf16 v[32:35], a[128:131], a[48:51], 0
 v_mfma_f32_16x16x32_bf16 v[32:35], a[132:135], a[52:55], v[32:35]
 v_cvt_pk_bf16_f32 v46, v36, v37
 v_cvt_pk_bf16_f32 v47, v38, v39
 v_mfma_f32_16x16x32_bf16 v[32:35], a[136:139], a[56:59], v[32:35]
 v_mfma_f32_16x16x32_bf16 v[32:35], a[140:143], a[60:63], v[32:35]
 v_exp_f32 v24, v24
 v_exp_f32 v25, v25
 v_mfma_f32_16x16x32_bf16 v[36:39], a[156:159], a[60:63], 0
 v_mfma_f32_16x16x32_bf16 v[36:39], a[152:155], a[56:59], v[36:39]
 v_exp_f32 v26, v26
 v_mfma_f32_16x16x32_bf16 v[36:39], a[148:151], a[52:55], v[36:39]
 s_add_u32 m0, s39, 33792
 v_mfma_f32_16x16x32_bf16 v[36:39], a[144:147], a[48:51], v[36:39]
 buffer_load_dwordx4 v1, s[20:23], s33 offen nt lds
 v_exp_f32 v27, v27
 v_mfma_f32_16x16x32_bf16 v[128:131], a[160:163], v[40:43], v[128:131]
 v_exp_f32 v28, v28
 v_mfma_f32_16x16x32_bf16 v[128:131], a[192:195], v[44:47], v[128:131]
 v_mfma_f32_16x16x32_bf16 v[132:135], a[164:167], v[40:43], v[132:135]
 v_mfma_f32_16x16x32_bf16 v[132:135], a[196:199], v[44:47], v[132:135]
 v_cvt_pk_bf16_f32 v48, v24, v25
 v_cvt_pk_bf16_f32 v49, v26, v27
 v_exp_f32 v29, v29
 v_mfma_f32_16x16x32_bf16 v[136:139], a[168:171], v[40:43], v[136:139]
 v_mfma_f32_16x16x32_bf16 v[136:139], a[200:203], v[44:47], v[136:139]
 v_exp_f32 v30, v30
 v_exp_f32 v31, v31
 v_mfma_f32_16x16x32_bf16 v[140:143], a[172:175], v[40:43], v[140:143]
 v_mfma_f32_16x16x32_bf16 v[140:143], a[204:207], v[44:47], v[140:143]
 v_cvt_pk_bf16_f32 v50, v28, v29
 v_cvt_pk_bf16_f32 v51, v30, v31
 v_exp_f32 v32, v32
 v_mfma_f32_16x16x32_bf16 v[24:27], a[96:99], a[64:67], 0
 v_mfma_f32_16x16x32_bf16 v[24:27], a[100:103], a[68:71], v[24:27]
 v_exp_f32 v33, v33
 v_mfma_f32_16x16x32_bf16 v[24:27], a[104:107], a[72:75], v[24:27]
 s_add_u32 m0, s39, 33824
 v_mfma_f32_16x16x32_bf16 v[24:27], a[108:111], a[76:79], v[24:27]
 buffer_load_dwordx4 v1, s[20:23], s33 offen offset:1024 nt lds
 v_smfmac_f32_16x16x64_bf16 a[228:231], a[236:239], v[40:47], v2
 v_exp_f32 v34, v34
 v_exp_f32 v35, v35
 v_mfma_f32_16x16x32_bf16 v[28:31], a[124:127], a[76:79], 0
 v_mfma_f32_16x16x32_bf16 v[28:31], a[120:123], a[72:75], v[28:31]
 v_exp_f32 v36, v36
 v_mfma_f32_16x16x32_bf16 v[28:31], a[116:119], a[68:71], v[28:31]
 v_mfma_f32_16x16x32_bf16 v[28:31], a[112:115], a[64:67], v[28:31]
 v_mfma_f32_16x16x32_bf16 v[144:147], a[176:179], v[40:43], v[144:147]
 v_cvt_pk_bf16_f32 v52, v32, v33
 v_cvt_pk_bf16_f32 v53, v34, v35
 v_mfma_f32_16x16x32_bf16 v[144:147], a[208:211], v[44:47], v[144:147]
 v_mfma_f32_16x16x32_bf16 v[148:151], a[180:183], v[40:43], v[148:151]
 v_exp_f32 v37, v37
 v_mfma_f32_16x16x32_bf16 v[148:151], a[212:215], v[44:47], v[148:151]
 v_mfma_f32_16x16x32_bf16 v[152:155], a[184:187], v[40:43], v[152:155]
 s_add_u32 m0, s39, 33856
 v_exp_f32 v38, v38
 v_mfma_f32_16x16x32_bf16 v[152:155], a[216:219], v[44:47], v[152:155]
 buffer_load_dwordx4 v1, s[20:23], s33 offen offset:2048 nt lds
 v_exp_f32 v39, v39
 v_mfma_f32_16x16x32_bf16 v[156:159], a[188:191], v[40:43], v[156:159]
 v_mfma_f32_16x16x32_bf16 v[156:159], a[220:223], v[44:47], v[156:159]
 v_cvt_pk_bf16_f32 v54, v36, v37
 v_cvt_pk_bf16_f32 v55, v38, v39
 v_exp_f32 v24, v24
 v_mfma_f32_16x16x32_bf16 v[32:35], a[128:131], a[64:67], 0
 v_mfma_f32_16x16x32_bf16 v[32:35], a[132:135], a[68:71], v[32:35]
 v_exp_f32 v25, v25
 v_mfma_f32_16x16x32_bf16 v[32:35], a[136:139], a[72:75], v[32:35]
 v_mfma_f32_16x16x32_bf16 v[32:35], a[140:143], a[76:79], v[32:35]
 v_mfma_f32_16x16x32_bf16 v[36:39], a[156:159], a[76:79], 0
 v_exp_f32 v26, v26
 v_mfma_f32_16x16x32_bf16 v[36:39], a[152:155], a[72:75], v[36:39]
 v_mfma_f32_16x16x32_bf16 v[36:39], a[148:151], a[68:71], v[36:39]
 v_exp_f32 v27, v27
 v_mfma_f32_16x16x32_bf16 v[36:39], a[144:147], a[64:67], v[36:39]
 v_mfma_f32_16x16x32_bf16 v[160:163], a[160:163], v[48:51], v[160:163]
 s_add_u32 m0, s39, 33888
 v_exp_f32 v28, v28
 v_mfma_f32_16x16x32_bf16 v[160:163], a[192:195], v[52:55], v[160:163]
 buffer_load_dwordx4 v1, s[20:23], s33 offen offset:3072 nt lds
 v_mfma_f32_16x16x32_bf16 v[164:167], a[164:167], v[48:51], v[164:167]
 s_add_u32 s33, s33, 8192
 v_mfma_f32_16x16x32_bf16 v[164:167], a[196:199], v[52:55], v[164:167]
 v_cvt_pk_bf16_f32 v40, v24, v25
 v_cvt_pk_bf16_f32 v41, v26, v27
 v_exp_f32 v29, v29
 v_mfma_f32_16x16x32_bf16 v[168:171], a[168:171], v[48:51], v[168:171]
 v_mfma_f32_16x16x32_bf16 v[168:171], a[200:203], v[52:55], v[168:171]
 v_exp_f32 v30, v30
 v_exp_f32 v31, v31
 v_mfma_f32_16x16x32_bf16 v[172:175], a[172:175], v[48:51], v[172:175]
 v_mfma_f32_16x16x32_bf16 v[172:175], a[204:207], v[52:55], v[172:175]
 v_cvt_pk_bf16_f32 v42, v28, v29
 v_cvt_pk_bf16_f32 v43, v30, v31
 v_exp_f32 v32, v32
 v_mfma_f32_16x16x32_bf16 v[24:27], a[96:99], a[80:83], 0
 v_mfma_f32_16x16x32_bf16 v[24:27], a[100:103], a[84:87], v[24:27]
 v_mfma_f32_16x16x32_bf16 v[24:27], a[104:107], a[88:91], v[24:27]
 v_exp_f32 v33, v33
 v_mfma_f32_16x16x32_bf16 v[24:27], a[108:111], a[92:95], v[24:27]
 v_smfmac_f32_16x16x64_bf16 a[228:231], a[240:243], v[48:55], v2
 v_exp_f32 v34, v34
 v_exp_f32 v35, v35
 v_mfma_f32_16x16x32_bf16 v[28:31], a[124:127], a[92:95], 0
 v_mfma_f32_16x16x32_bf16 v[28:31], a[120:123], a[88:91], v[28:31]
 v_exp_f32 v36, v36
 v_mfma_f32_16x16x32_bf16 v[28:31], a[116:119], a[84:87], v[28:31]
 s_add_u32 m0, s39, 50688
 v_mfma_f32_16x16x32_bf16 v[28:31], a[112:115], a[80:83], v[28:31]
 buffer_load_dwordx4 v1, s[20:23], s33 offen nt lds
 v_mfma_f32_16x16x32_bf16 v[176:179], a[176:179], v[48:51], v[176:179]
 v_cvt_pk_bf16_f32 v44, v32, v33
 v_cvt_pk_bf16_f32 v45, v34, v35
 v_mfma_f32_16x16x32_bf16 v[176:179], a[208:211], v[52:55], v[176:179]
 v_mfma_f32_16x16x32_bf16 v[180:183], a[180:183], v[48:51], v[180:183]
 v_exp_f32 v37, v37
 v_mfma_f32_16x16x32_bf16 v[180:183], a[212:215], v[52:55], v[180:183]
 v_mfma_f32_16x16x32_bf16 v[184:187], a[184:187], v[48:51], v[184:187]
 v_mfma_f32_16x16x32_bf16 v[184:187], a[216:219], v[52:55], v[184:187]
 v_exp_f32 v38, v38
 v_exp_f32 v39, v39
 v_mfma_f32_16x16x32_bf16 v[188:191], a[188:191], v[48:51], v[188:191]
 v_mfma_f32_16x16x32_bf16 v[188:191], a[220:223], v[52:55], v[188:191]
 s_waitcnt vmcnt(9)
 s_barrier
 v_mfma_f32_16x16x32_bf16 v[32:35], a[128:131], a[80:83], 0
 v_cvt_pk_bf16_f32 v46, v36, v37
 v_cvt_pk_bf16_f32 v47, v38, v39
 v_mfma_f32_16x16x32_bf16 v[32:35], a[132:135], a[84:87], v[32:35]
 ds_read_b128 a[96:99], v7 offset:0
 ds_read_b128 a[100:103], v7 offset:64
 v_mfma_f32_16x16x32_bf16 v[32:35], a[136:139], a[88:91], v[32:35]
 v_mfma_f32_16x16x32_bf16 v[32:35], a[140:143], a[92:95], v[32:35]
 ds_read_b128 a[104:107], v7 offset:128
 ds_read_b128 a[108:111], v7 offset:192
 v_exp_f32 v24, v24
 v_mfma_f32_16x16x32_bf16 v[36:39], a[156:159], a[92:95], 0
 v_exp_f32 v25, v25
 v_mfma_f32_16x16x32_bf16 v[36:39], a[152:155], a[88:91], v[36:39]
 v_mfma_f32_16x16x32_bf16 v[36:39], a[148:151], a[84:87], v[36:39]
 s_add_u32 m0, s39, 50720
 ds_read_b128 a[124:127], v7 offset:704
 ds_read_b128 a[120:123], v7 offset:640
 v_mfma_f32_16x16x32_bf16 v[36:39], a[144:147], a[80:83], v[36:39]
 buffer_load_dwordx4 v1, s[20:23], s33 offen offset:1024 nt lds
 v_exp_f32 v26, v26
 v_mfma_f32_16x16x32_bf16 v[192:195], a[160:163], v[40:43], v[192:195]
 ds_read_b128 a[116:119], v7 offset:576
 ds_read_b128 a[112:115], v7 offset:512
 v_mfma_f32_16x16x32_bf16 v[192:195], a[192:195], v[44:47], v[192:195]
 v_exp_f32 v27, v27
 v_exp_f32 v28, v28
 v_mfma_f32_16x16x32_bf16 v[196:199], a[164:167], v[40:43], v[196:199]
 v_mfma_f32_16x16x32_bf16 v[196:199], a[196:199], v[44:47], v[196:199]
 v_cvt_pk_bf16_f32 v48, v24, v25
 v_cvt_pk_bf16_f32 v49, v26, v27
 v_exp_f32 v29, v29
 v_mfma_f32_16x16x32_bf16 v[200:203], a[168:171], v[40:43], v[200:203]
 v_mfma_f32_16x16x32_bf16 v[200:203], a[200:203], v[44:47], v[200:203]
 v_exp_f32 v30, v30
 v_exp_f32 v31, v31
 v_mfma_f32_16x16x32_bf16 v[204:207], a[172:175], v[40:43], v[204:207]
 v_mfma_f32_16x16x32_bf16 v[204:207], a[204:207], v[44:47], v[204:207]
 s_waitcnt lgkmcnt(4)
 s_waitcnt vmcnt(6)
 s_barrier
 v_mfma_f32_16x16x32_bf16 v[24:27], a[96:99], a[0:3], 0
 v_cvt_pk_bf16_f32 v50, v28, v29
 v_cvt_pk_bf16_f32 v51, v30, v31
 v_mfma_f32_16x16x32_bf16 v[24:27], a[100:103], a[4:7], v[24:27]
 ds_read_b128 a[128:131], v7 offset:16896
 ds_read_b128 a[132:135], v7 offset:16960
 v_mfma_f32_16x16x32_bf16 v[24:27], a[104:107], a[8:11], v[24:27]
 s_add_u32 m0, s39, 50752
 v_exp_f32 v32, v32
 v_mfma_f32_16x16x32_bf16 v[24:27], a[108:111], a[12:15], v[24:27]
 s_waitcnt lgkmcnt(2)
 buffer_load_dwordx4 v1, s[20:23], s33 offen offset:2048 nt lds
 v_smfmac_f32_16x16x64_bf16 a[232:235], a[236:239], v[40:47], v2
 ds_read_b128 a[136:139], v7 offset:17024
 ds_read_b128 a[140:143], v7 offset:17088
 v_exp_f32 v33, v33
 v_mfma_f32_16x16x32_bf16 v[28:31], a[124:127], a[12:15], 0
 v_mfma_f32_16x16x32_bf16 v[28:31], a[120:123], a[8:11], v[28:31]
 ds_read_b128 a[156:159], v7 offset:17600
 ds_read_b128 a[152:155], v7 offset:17536
 v_mfma_f32_16x16x32_bf16 v[28:31], a[116:119], a[4:7], v[28:31]
 v_exp_f32 v34, v34
 v_mfma_f32_16x16x32_bf16 v[28:31], a[112:115], a[0:3], v[28:31]
 v_exp_f32 v35, v35
 v_exp_f32 v36, v36
 v_mfma_f32_16x16x32_bf16 v[208:211], a[176:179], v[40:43], v[208:211]
 ds_read_b128 a[148:151], v7 offset:17472
 ds_read_b128 a[144:147], v7 offset:17408
 v_mfma_f32_16x16x32_bf16 v[208:211], a[208:211], v[44:47], v[208:211]
 v_mfma_f32_16x16x32_bf16 v[212:215], a[180:183], v[40:43], v[212:215]
 v_cvt_pk_bf16_f32 v52, v32, v33
 v_cvt_pk_bf16_f32 v53, v34, v35
 v_mfma_f32_16x16x32_bf16 v[212:215], a[212:215], v[44:47], v[212:215]
 v_exp_f32 v37, v37
 v_exp_f32 v38, v38
 v_mfma_f32_16x16x32_bf16 v[216:219], a[184:187], v[40:43], v[216:219]
 v_exp_f32 v39, v39
 v_mfma_f32_16x16x32_bf16 v[216:219], a[216:219], v[44:47], v[216:219]
 v_mfma_f32_16x16x32_bf16 v[220:223], a[188:191], v[40:43], v[220:223]
 s_add_u32 m0, s39, 50784
 v_cvt_pk_bf16_f32 v54, v36, v37
 v_cvt_pk_bf16_f32 v55, v38, v39
 v_mfma_f32_16x16x32_bf16 v[220:223], a[220:223], v[44:47], v[220:223]
 s_waitcnt lgkmcnt(4)
 buffer_load_dwordx4 v1, s[20:23], s33 offen offset:3072 nt lds
 v_mfma_f32_16x16x32_bf16 v[32:35], a[128:131], a[0:3], 0
 s_add_u32 s33, s33, 8192
 v_exp_f32 v24, v24
 v_mfma_f32_16x16x32_bf16 v[32:35], a[132:135], a[4:7], v[32:35]
 v_mfma_f32_16x16x32_bf16 v[32:35], a[136:139], a[8:11], v[32:35]
 v_exp_f32 v25, v25
 v_mfma_f32_16x16x32_bf16 v[32:35], a[140:143], a[12:15], v[32:35]
 s_waitcnt lgkmcnt(0)
 v_exp_f32 v26, v26
 v_mfma_f32_16x16x32_bf16 v[36:39], a[156:159], a[12:15], 0
 v_mfma_f32_16x16x32_bf16 v[36:39], a[152:155], a[8:11], v[36:39]
 v_exp_f32 v27, v27
 v_mfma_f32_16x16x32_bf16 v[36:39], a[148:151], a[4:7], v[36:39]
 v_exp_f32 v28, v28
 v_mfma_f32_16x16x32_bf16 v[36:39], a[144:147], a[0:3], v[36:39]
 s_mov_b32 s59, 0
 v_cvt_pk_bf16_f32 v40, v24, v25
 v_cvt_pk_bf16_f32 v41, v26, v27
 v_mfma_f32_16x16x32_bf16 v[224:227], a[160:163], v[48:51], v[224:227]
 s_add_u32 m0, s45, 0
 v_mfma_f32_16x16x32_bf16 v[224:227], a[192:195], v[52:55], v[224:227]
 buffer_load_dwordx4 v1, s[28:31], s59 offen nt lds
 v_mfma_f32_16x16x32_bf16 v[228:231], a[164:167], v[48:51], v[228:231]
 ds_read_b64_tr_b16 a[160:161], v8 offset:0
 ds_read_b64_tr_b16 a[162:163], v8 offset:512
 v_mfma_f32_16x16x32_bf16 v[228:231], a[196:199], v[52:55], v[228:231]
 v_exp_f32 v29, v29
 v_exp_f32 v30, v30
 v_mfma_f32_16x16x32_bf16 v[232:235], a[168:171], v[48:51], v[232:235]
 ds_read_b64_tr_b16 a[192:193], v8 offset:16896
 ds_read_b64_tr_b16 a[194:195], v8 offset:17408
 v_mfma_f32_16x16x32_bf16 v[232:235], a[200:203], v[52:55], v[232:235]
 v_exp_f32 v31, v31
 v_cvt_pk_bf16_f32 v42, v28, v29
 v_mfma_f32_16x16x32_bf16 v[236:239], a[172:175], v[48:51], v[236:239]
 v_mfma_f32_16x16x32_bf16 v[236:239], a[204:207], v[52:55], v[236:239]
 ds_read_b64_tr_b16 a[164:165], v8 offset:32
 ds_read_b64_tr_b16 a[166:167], v8 offset:544
 v_cvt_pk_bf16_f32 v43, v30, v31
 v_mfma_f32_16x16x32_bf16 v[24:27], a[96:99], a[16:19], 0
 v_exp_f32 v32, v32
 v_mfma_f32_16x16x32_bf16 v[24:27], a[100:103], a[20:23], v[24:27]
 ds_read_b64_tr_b16 a[196:197], v8 offset:16928
 ds_read_b64_tr_b16 a[198:199], v8 offset:17440
 v_mfma_f32_16x16x32_bf16 v[24:27], a[104:107], a[24:27], v[24:27]
 v_exp_f32 v33, v33
 v_mfma_f32_16x16x32_bf16 v[24:27], a[108:111], a[28:31], v[24:27]
 ds_read_b64_tr_b16 a[168:169], v8 offset:64
 ds_read_b64_tr_b16 a[170:171], v8 offset:576
 v_exp_f32 v34, v34
 v_smfmac_f32_16x16x64_bf16 a[232:235], a[240:243], v[48:55], v2
 v_mfma_f32_16x16x32_bf16 v[28:31], a[124:127], a[28:31], 0
 ds_read_b64_tr_b16 a[200:201], v8 offset:16960
 ds_read_b64_tr_b16 a[202:203], v8 offset:17472
 v_mfma_f32_16x16x32_bf16 v[28:31], a[120:123], a[24:27], v[28:31]
 v_exp_f32 v35, v35
 v_mfma_f32_16x16x32_bf16 v[28:31], a[116:119], a[20:23], v[28:31]
 v_exp_f32 v36, v36
 v_mfma_f32_16x16x32_bf16 v[28:31], a[112:115], a[16:19], v[28:31]
 ds_read_b64_tr_b16 a[172:173], v8 offset:96
 ds_read_b64_tr_b16 a[174:175], v8 offset:608
 v_cvt_pk_bf16_f32 v44, v32, v33
 v_mfma_f32_16x16x32_bf16 v[240:243], a[176:179], v[48:51], v[240:243]
 v_mfma_f32_16x16x32_bf16 v[240:243], a[208:211], v[52:55], v[240:243]
 ds_read_b64_tr_b16 a[204:205], v8 offset:16992
 ds_read_b64_tr_b16 a[206:207], v8 offset:17504
 v_cvt_pk_bf16_f32 v45, v34, v35
 v_mfma_f32_16x16x32_bf16 v[244:247], a[180:183], v[48:51], v[244:247]
 v_exp_f32 v37, v37
 v_mfma_f32_16x16x32_bf16 v[244:247], a[212:215], v[52:55], v[244:247]
 v_exp_f32 v38, v38
 v_mfma_f32_16x16x32_bf16 v[248:251], a[184:187], v[48:51], v[248:251]
 v_exp_f32 v39, v39
 v_mfma_f32_16x16x32_bf16 v[248:251], a[216:219], v[52:55], v[248:251]
 ds_read_b64_tr_b16 a[176:177], v8 offset:128
 ds_read_b64_tr_b16 a[178:179], v8 offset:640
 v_cvt_pk_bf16_f32 v46, v36, v37
 v_mfma_f32_16x16x32_bf16 v[252:255], a[188:191], v[48:51], v[252:255]
 v_mfma_f32_16x16x32_bf16 v[252:255], a[220:223], v[52:55], v[252:255]
 v_cvt_pk_bf16_f32 v47, v38, v39
 v_exp_f32 v24, v24
 v_mfma_f32_16x16x32_bf16 v[32:35], a[128:131], a[16:19], 0
 ds_read_b64_tr_b16 a[208:209], v8 offset:17024
 ds_read_b64_tr_b16 a[210:211], v8 offset:17536
 v_mfma_f32_16x16x32_bf16 v[32:35], a[132:135], a[20:23], v[32:35]
 v_exp_f32 v25, v25
 v_mfma_f32_16x16x32_bf16 v[32:35], a[136:139], a[24:27], v[32:35]
 v_mfma_f32_16x16x32_bf16 v[32:35], a[140:143], a[28:31], v[32:35]
 ds_read_b64_tr_b16 a[180:181], v8 offset:160
 ds_read_b64_tr_b16 a[182:183], v8 offset:672
 v_exp_f32 v26, v26
 v_mfma_f32_16x16x32_bf16 v[36:39], a[156:159], a[28:31], 0
 v_exp_f32 v27, v27
 v_mfma_f32_16x16x32_bf16 v[36:39], a[152:155], a[24:27], v[36:39]
 v_exp_f32 v28, v28
 v_mfma_f32_16x16x32_bf16 v[36:39], a[148:151], a[20:23], v[36:39]
 ds_read_b64_tr_b16 a[212:213], v8 offset:17056
 ds_read_b64_tr_b16 a[214:215], v8 offset:17568
 v_mfma_f32_16x16x32_bf16 v[36:39], a[144:147], a[16:19], v[36:39]
 s_waitcnt lgkmcnt(15)
 v_mfma_f32_16x16x32_bf16 v[64:67], a[160:163], v[40:43], v[64:67]
 v_cvt_pk_bf16_f32 v48, v24, v25
 v_cvt_pk_bf16_f32 v49, v26, v27
 v_mfma_f32_16x16x32_bf16 v[64:67], a[192:195], v[44:47], v[64:67]
 ds_read_b64_tr_b16 a[184:185], v8 offset:192
 ds_read_b64_tr_b16 a[186:187], v8 offset:704
 v_mfma_f32_16x16x32_bf16 v[68:71], a[164:167], v[40:43], v[68:71]
 v_exp_f32 v29, v29
 v_mfma_f32_16x16x32_bf16 v[68:71], a[196:199], v[44:47], v[68:71]
 s_waitcnt lgkmcnt(10)
 v_mfma_f32_16x16x32_bf16 v[72:75], a[168:171], v[40:43], v[72:75]
 ds_read_b64_tr_b16 a[216:217], v8 offset:17088
 ds_read_b64_tr_b16 a[218:219], v8 offset:17600
 v_mfma_f32_16x16x32_bf16 v[72:75], a[200:203], v[44:47], v[72:75]
 v_exp_f32 v30, v30
 v_mfma_f32_16x16x32_bf16 v[76:79], a[172:175], v[40:43], v[76:79]
 v_exp_f32 v31, v31
 v_mfma_f32_16x16x32_bf16 v[76:79], a[204:207], v[44:47], v[76:79]
 ds_read_b64_tr_b16 a[188:189], v8 offset:224
 ds_read_b64_tr_b16 a[190:191], v8 offset:736
 v_mfma_f32_16x16x32_bf16 v[24:27], a[96:99], a[32:35], 0
 v_cvt_pk_bf16_f32 v50, v28, v29
 v_cvt_pk_bf16_f32 v51, v30, v31
 v_mfma_f32_16x16x32_bf16 v[24:27], a[100:103], a[36:39], v[24:27]
 v_mfma_f32_16x16x32_bf16 v[24:27], a[104:107], a[40:43], v[24:27]
 ds_read_b64_tr_b16 a[220:221], v8 offset:17120
 ds_read_b64_tr_b16 a[222:223], v8 offset:17632
 v_mfma_f32_16x16x32_bf16 v[24:27], a[108:111], a[44:47], v[24:27]
 v_exp_f32 v32, v32
 v_smfmac_f32_16x16x64_bf16 a[224:227], a[236:239], v[40:47], v2
 v_exp_f32 v33, v33
 v_mfma_f32_16x16x32_bf16 v[28:31], a[124:127], a[44:47], 0
 v_mfma_f32_16x16x32_bf16 v[28:31], a[120:123], a[40:43], v[28:31]
 s_mov_b32 s59, 1024
 v_exp_f32 v34, v34
 v_mfma_f32_16x16x32_bf16 v[28:31], a[116:119], a[36:39], v[28:31]
 s_add_u32 m0, s45, 1088
 v_exp_f32 v35, v35
 v_mfma_f32_16x16x32_bf16 v[28:31], a[112:115], a[32:35], v[28:31]
 s_waitcnt lgkmcnt(8)
 buffer_load_dwordx4 v1, s[28:31], s59 offen nt lds
 v_mfma_f32_16x16x32_bf16 v[80:83], a[176:179], v[40:43], v[80:83]
 v_mfma_f32_16x16x32_bf16 v[80:83], a[208:211], v[44:47], v[80:83]
 v_exp_f32 v36, v36
 v_mfma_f32_16x16x32_bf16 v[84:87], a[180:183], v[40:43], v[84:87]
 v_cvt_pk_bf16_f32 v52, v32, v33
 v_cvt_pk_bf16_f32 v53, v34, v35
 v_mfma_f32_16x16x32_bf16 v[84:87], a[212:215], v[44:47], v[84:87]
 s_waitcnt lgkmcnt(0)
 s_barrier
 v_mfma_f32_16x16x32_bf16 v[88:91], a[184:187], v[40:43], v[88:91]
 v_exp_f32 v37, v37
 v_mfma_f32_16x16x32_bf16 v[88:91], a[216:219], v[44:47], v[88:91]
 v_mfma_f32_16x16x32_bf16 v[92:95], a[188:191], v[40:43], v[92:95]
 v_exp_f32 v38, v38
 v_mfma_f32_16x16x32_bf16 v[92:95], a[220:223], v[44:47], v[92:95]
 v_exp_f32 v39, v39
 v_mfma_f32_16x16x32_bf16 v[32:35], a[128:131], a[32:35], 0
 v_mfma_f32_16x16x32_bf16 v[32:35], a[132:135], a[36:39], v[32:35]
 v_cvt_pk_bf16_f32 v54, v36, v37
 v_cvt_pk_bf16_f32 v55, v38, v39
 v_mfma_f32_16x16x32_bf16 v[32:35], a[136:139], a[40:43], v[32:35]
 v_exp_f32 v24, v24
 v_mfma_f32_16x16x32_bf16 v[32:35], a[140:143], a[44:47], v[32:35]
 v_mfma_f32_16x16x32_bf16 v[36:39], a[156:159], a[44:47], 0
 v_exp_f32 v25, v25
 v_mfma_f32_16x16x32_bf16 v[36:39], a[152:155], a[40:43], v[36:39]
 v_exp_f32 v26, v26
 v_mfma_f32_16x16x32_bf16 v[36:39], a[148:151], a[36:39], v[36:39]
 s_add_u32 m0, s39, 0
 v_mfma_f32_16x16x32_bf16 v[36:39], a[144:147], a[32:35], v[36:39]
 buffer_load_dwordx4 v1, s[20:23], s33 offen nt lds
 v_mfma_f32_16x16x32_bf16 v[96:99], a[160:163], v[48:51], v[96:99]
 v_exp_f32 v27, v27
 v_mfma_f32_16x16x32_bf16 v[96:99], a[192:195], v[52:55], v[96:99]
 v_exp_f32 v28, v28
 v_mfma_f32_16x16x32_bf16 v[100:103], a[164:167], v[48:51], v[100:103]
 v_cvt_pk_bf16_f32 v40, v24, v25
 v_cvt_pk_bf16_f32 v41, v26, v27
 v_mfma_f32_16x16x32_bf16 v[100:103], a[196:199], v[52:55], v[100:103]
 v_mfma_f32_16x16x32_bf16 v[104:107], a[168:171], v[48:51], v[104:107]
 v_exp_f32 v29, v29
 v_mfma_f32_16x16x32_bf16 v[104:107], a[200:203], v[52:55], v[104:107]
 v_exp_f32 v30, v30
 v_mfma_f32_16x16x32_bf16 v[108:111], a[172:175], v[48:51], v[108:111]
 v_mfma_f32_16x16x32_bf16 v[108:111], a[204:207], v[52:55], v[108:111]
 v_exp_f32 v31, v31
 v_mfma_f32_16x16x32_bf16 v[24:27], a[96:99], a[48:51], 0
 v_cvt_pk_bf16_f32 v42, v28, v29
 v_cvt_pk_bf16_f32 v43, v30, v31
 v_mfma_f32_16x16x32_bf16 v[24:27], a[100:103], a[52:55], v[24:27]
 v_exp_f32 v32, v32
 v_mfma_f32_16x16x32_bf16 v[24:27], a[104:107], a[56:59], v[24:27]
 v_exp_f32 v33, v33
 v_mfma_f32_16x16x32_bf16 v[24:27], a[108:111], a[60:63], v[24:27]
 v_exp_f32 v34, v34
 v_smfmac_f32_16x16x64_bf16 a[224:227], a[240:243], v[48:55], v2
 v_mfma_f32_16x16x32_bf16 v[28:31], a[124:127], a[60:63], 0
 v_exp_f32 v35, v35
 v_mfma_f32_16x16x32_bf16 v[28:31], a[120:123], a[56:59], v[28:31]
 v_exp_f32 v36, v36
 v_mfma_f32_16x16x32_bf16 v[28:31], a[116:119], a[52:55], v[28:31]
 s_add_u32 m0, s39, 32
 v_mfma_f32_16x16x32_bf16 v[28:31], a[112:115], a[48:51], v[28:31]
 buffer_load_dwordx4 v1, s[20:23], s33 offen offset:1024 nt lds
 v_mfma_f32_16x16x32_bf16 v[112:115], a[176:179], v[48:51], v[112:115]
 v_cvt_pk_bf16_f32 v44, v32, v33
 v_cvt_pk_bf16_f32 v45, v34, v35
 v_mfma_f32_16x16x32_bf16 v[112:115], a[208:211], v[52:55], v[112:115]
 v_exp_f32 v37, v37
 v_mfma_f32_16x16x32_bf16 v[116:119], a[180:183], v[48:51], v[116:119]
 v_mfma_f32_16x16x32_bf16 v[116:119], a[212:215], v[52:55], v[116:119]
 v_exp_f32 v38, v38
 v_mfma_f32_16x16x32_bf16 v[120:123], a[184:187], v[48:51], v[120:123]
 v_exp_f32 v39, v39
 v_mfma_f32_16x16x32_bf16 v[120:123], a[216:219], v[52:55], v[120:123]
 v_mfma_f32_16x16x32_bf16 v[124:127], a[188:191], v[48:51], v[124:127]
 v_cvt_pk_bf16_f32 v46, v36, v37
 v_cvt_pk_bf16_f32 v47, v38, v39
 v_mfma_f32_16x16x32_bf16 v[124:127], a[220:223], v[52:55], v[124:127]
 v_mfma_f32_16x16x32_bf16 v[32:35], a[128:131], a[48:51], 0
 v_exp_f32 v24, v24
 v_mfma_f32_16x16x32_bf16 v[32:35], a[132:135], a[52:55], v[32:35]
 v_mfma_f32_16x16x32_bf16 v[32:35], a[136:139], a[56:59], v[32:35]
 v_exp_f32 v25, v25
 v_mfma_f32_16x16x32_bf16 v[32:35], a[140:143], a[60:63], v[32:35]
 v_exp_f32 v26, v26
 v_mfma_f32_16x16x32_bf16 v[36:39], a[156:159], a[60:63], 0
 v_mfma_f32_16x16x32_bf16 v[36:39], a[152:155], a[56:59], v[36:39]
 v_exp_f32 v27, v27
 v_mfma_f32_16x16x32_bf16 v[36:39], a[148:151], a[52:55], v[36:39]
 v_exp_f32 v28, v28
 v_mfma_f32_16x16x32_bf16 v[36:39], a[144:147], a[48:51], v[36:39]
 v_mfma_f32_16x16x32_bf16 v[128:131], a[160:163], v[40:43], v[128:131]
 s_add_u32 m0, s39, 64
 v_cvt_pk_bf16_f32 v48, v24, v25
 v_cvt_pk_bf16_f32 v49, v26, v27
 v_mfma_f32_16x16x32_bf16 v[128:131], a[192:195], v[44:47], v[128:131]
 buffer_load_dwordx4 v1, s[20:23], s33 offen offset:2048 nt lds
 v_mfma_f32_16x16x32_bf16 v[132:135], a[164:167], v[40:43], v[132:135]
 v_exp_f32 v29, v29
 v_mfma_f32_16x16x32_bf16 v[132:135], a[196:199], v[44:47], v[132:135]
 v_exp_f32 v30, v30
 v_mfma_f32_16x16x32_bf16 v[136:139], a[168:171], v[40:43], v[136:139]
 v_mfma_f32_16x16x32_bf16 v[136:139], a[200:203], v[44:47], v[136:139]
 v_exp_f32 v31, v31
 v_mfma_f32_16x16x32_bf16 v[140:143], a[172:175], v[40:43], v[140:143]
 v_mfma_f32_16x16x32_bf16 v[140:143], a[204:207], v[44:47], v[140:143]
 v_cvt_pk_bf16_f32 v50, v28, v29
 v_cvt_pk_bf16_f32 v51, v30, v31
 v_mfma_f32_16x16x32_bf16 v[24:27], a[96:99], a[64:67], 0
 v_mfma_f32_16x16x32_bf16 v[24:27], a[100:103], a[68:71], v[24:27]
 v_exp_f32 v32, v32
 v_mfma_f32_16x16x32_bf16 v[24:27], a[104:107], a[72:75], v[24:27]
 v_exp_f32 v33, v33
 v_mfma_f32_16x16x32_bf16 v[24:27], a[108:111], a[76:79], v[24:27]
 v_exp_f32 v34, v34
 v_smfmac_f32_16x16x64_bf16 a[228:231], a[236:239], v[40:47], v2
 v_mfma_f32_16x16x32_bf16 v[28:31], a[124:127], a[76:79], 0
 v_exp_f32 v35, v35
 v_mfma_f32_16x16x32_bf16 v[28:31], a[120:123], a[72:75], v[28:31]
 v_mfma_f32_16x16x32_bf16 v[28:31], a[116:119], a[68:71], v[28:31]
 v_exp_f32 v36, v36
 v_mfma_f32_16x16x32_bf16 v[28:31], a[112:115], a[64:67], v[28:31]
 v_mfma_f32_16x16x32_bf16 v[144:147], a[176:179], v[40:43], v[144:147]
 s_add_u32 m0, s39, 96
 v_cvt_pk_bf16_f32 v52, v32, v33
 v_cvt_pk_bf16_f32 v53, v34, v35
 v_mfma_f32_16x16x32_bf16 v[144:147], a[208:211], v[44:47], v[144:147]
 buffer_load_dwordx4 v1, s[20:23], s33 offen offset:3072 nt lds
 v_mfma_f32_16x16x32_bf16 v[148:151], a[180:183], v[40:43], v[148:151]
 s_add_u32 s33, s33, 8192
 v_exp_f32 v37, v37
 v_mfma_f32_16x16x32_bf16 v[148:151], a[212:215], v[44:47], v[148:151]
 v_exp_f32 v38, v38
 v_mfma_f32_16x16x32_bf16 v[152:155], a[184:187], v[40:43], v[152:155]
 v_mfma_f32_16x16x32_bf16 v[152:155], a[216:219], v[44:47], v[152:155]
 s_mov_b32 s59, 2048
 v_exp_f32 v39, v39
 v_mfma_f32_16x16x32_bf16 v[156:159], a[188:191], v[40:43], v[156:159]
 s_add_u32 m0, s45, 2176
 v_cvt_pk_bf16_f32 v54, v36, v37
 v_cvt_pk_bf16_f32 v55, v38, v39
 v_mfma_f32_16x16x32_bf16 v[156:159], a[220:223], v[44:47], v[156:159]
 buffer_load_dwordx4 v1, s[28:31], s59 offen nt lds
 v_mfma_f32_16x16x32_bf16 v[32:35], a[128:131], a[64:67], 0
 v_mfma_f32_16x16x32_bf16 v[32:35], a[132:135], a[68:71], v[32:35]
 v_exp_f32 v24, v24
 v_mfma_f32_16x16x32_bf16 v[32:35], a[136:139], a[72:75], v[32:35]
 v_exp_f32 v25, v25
 v_mfma_f32_16x16x32_bf16 v[32:35], a[140:143], a[76:79], v[32:35]
 v_exp_f32 v26, v26
 v_mfma_f32_16x16x32_bf16 v[36:39], a[156:159], a[76:79], 0
 v_mfma_f32_16x16x32_bf16 v[36:39], a[152:155], a[72:75], v[36:39]
 v_exp_f32 v27, v27
 v_mfma_f32_16x16x32_bf16 v[36:39], a[148:151], a[68:71], v[36:39]
 v_exp_f32 v28, v28
 v_mfma_f32_16x16x32_bf16 v[36:39], a[144:147], a[64:67], v[36:39]
 v_mfma_f32_16x16x32_bf16 v[160:163], a[160:163], v[48:51], v[160:163]
 v_cvt_pk_bf16_f32 v40, v24, v25
 v_cvt_pk_bf16_f32 v41, v26, v27
 v_mfma_f32_16x16x32_bf16 v[160:163], a[192:195], v[52:55], v[160:163]
 v_mfma_f32_16x16x32_bf16 v[164:167], a[164:167], v[48:51], v[164:167]
 s_add_u32 m0, s39, 16896
 v_exp_f32 v29, v29
 v_mfma_f32_16x16x32_bf16 v[164:167], a[196:199], v[52:55], v[164:167]
 buffer_load_dwordx4 v1, s[20:23], s33 offen nt lds
 v_mfma_f32_16x16x32_bf16 v[168:171], a[168:171], v[48:51], v[168:171]
 v_exp_f32 v30, v30
 v_mfma_f32_16x16x32_bf16 v[168:171], a[200:203], v[52:55], v[168:171]
 v_exp_f32 v31, v31
 v_mfma_f32_16x16x32_bf16 v[172:175], a[172:175], v[48:51], v[172:175]
 v_mfma_f32_16x16x32_bf16 v[172:175], a[204:207], v[52:55], v[172:175]
 v_cvt_pk_bf16_f32 v42, v28, v29
 v_cvt_pk_bf16_f32 v43, v30, v31
 v_mfma_f32_16x16x32_bf16 v[24:27], a[96:99], a[80:83], 0
 v_mfma_f32_16x16x32_bf16 v[24:27], a[100:103], a[84:87], v[24:27]
 v_exp_f32 v32, v32
 v_mfma_f32_16x16x32_bf16 v[24:27], a[104:107], a[88:91], v[24:27]
 v_mfma_f32_16x16x32_bf16 v[24:27], a[108:111], a[92:95], v[24:27]
 v_exp_f32 v33, v33
 v_smfmac_f32_16x16x64_bf16 a[228:231], a[240:243], v[48:55], v2
 v_mfma_f32_16x16x32_bf16 v[28:31], a[124:127], a[92:95], 0
 v_exp_f32 v34, v34
 v_mfma_f32_16x16x32_bf16 v[28:31], a[120:123], a[88:91], v[28:31]
 v_exp_f32 v35, v35
 v_mfma_f32_16x16x32_bf16 v[28:31], a[116:119], a[84:87], v[28:31]
 v_exp_f32 v36, v36
 v_mfma_f32_16x16x32_bf16 v[28:31], a[112:115], a[80:83], v[28:31]
 v_mfma_f32_16x16x32_bf16 v[176:179], a[176:179], v[48:51], v[176:179]
 v_cvt_pk_bf16_f32 v44, v32, v33
 v_cvt_pk_bf16_f32 v45, v34, v35
 v_mfma_f32_16x16x32_bf16 v[176:179], a[208:211], v[52:55], v[176:179]
 v_mfma_f32_16x16x32_bf16 v[180:183], a[180:183], v[48:51], v[180:183]
 s_add_u32 m0, s39, 16928
 v_exp_f32 v37, v37
 v_mfma_f32_16x16x32_bf16 v[180:183], a[212:215], v[52:55], v[180:183]
 buffer_load_dwordx4 v1, s[20:23], s33 offen offset:1024 nt lds
 v_mfma_f32_16x16x32_bf16 v[184:187], a[184:187], v[48:51], v[184:187]
 v_exp_f32 v38, v38
 v_mfma_f32_16x16x32_bf16 v[184:187], a[216:219], v[52:55], v[184:187]
 v_exp_f32 v39, v39
 v_mfma_f32_16x16x32_bf16 v[188:191], a[188:191], v[48:51], v[188:191]
 v_cvt_pk_bf16_f32 v46, v36, v37
 v_cvt_pk_bf16_f32 v47, v38, v39
 v_mfma_f32_16x16x32_bf16 v[188:191], a[220:223], v[52:55], v[188:191]
 s_waitcnt vmcnt(13)
 s_barrier
 v_mfma_f32_16x16x32_bf16 v[32:35], a[128:131], a[80:83], 0
 v_exp_f32 v24, v24
 v_mfma_f32_16x16x32_bf16 v[32:35], a[132:135], a[84:87], v[32:35]
 ds_read_b128 a[96:99], v7 offset:33792
 ds_read_b128 a[100:103], v7 offset:33856
 v_mfma_f32_16x16x32_bf16 v[32:35], a[136:139], a[88:91], v[32:35]
L_pg1_2:
 s_cbranch_execz L_pg1_6
 v_exp_f32 v25, v25
 v_mfma_f32_16x16x32_bf16 v[32:35], a[140:143], a[92:95], v[32:35]
 ds_read_b128 a[104:107], v7 offset:33920
 ds_read_b128 a[108:111], v7 offset:33984
 v_mfma_f32_16x16x32_bf16 v[36:39], a[156:159], a[92:95], 0
 v_exp_f32 v26, v26
 v_mfma_f32_16x16x32_bf16 v[36:39], a[152:155], a[88:91], v[36:39]
 v_exp_f32 v27, v27
 v_mfma_f32_16x16x32_bf16 v[36:39], a[148:151], a[84:87], v[36:39]
 ds_read_b128 a[124:127], v7 offset:34496
 ds_read_b128 a[120:123], v7 offset:34432
 v_mfma_f32_16x16x32_bf16 v[36:39], a[144:147], a[80:83], v[36:39]
 v_exp_f32 v28, v28
 v_mfma_f32_16x16x32_bf16 v[192:195], a[160:163], v[40:43], v[192:195]
 ds_read_b128 a[116:119], v7 offset:34368
 ds_read_b128 a[112:115], v7 offset:34304
 v_mfma_f32_16x16x32_bf16 v[192:195], a[192:195], v[44:47], v[192:195]
 v_cvt_pk_bf16_f32 v48, v24, v25
 v_cvt_pk_bf16_f32 v49, v26, v27
 v_mfma_f32_16x16x32_bf16 v[196:199], a[164:167], v[40:43], v[196:199]
 s_add_u32 m0, s39, 16960
 v_exp_f32 v29, v29
 v_mfma_f32_16x16x32_bf16 v[196:199], a[196:199], v[44:47], v[196:199]
 buffer_load_dwordx4 v1, s[20:23], s33 offen offset:2048 nt lds
 v_mfma_f32_16x16x32_bf16 v[200:203], a[168:171], v[40:43], v[200:203]
 v_exp_f32 v30, v30
 v_mfma_f32_16x16x32_bf16 v[200:203], a[200:203], v[44:47], v[200:203]
 v_mfma_f32_16x16x32_bf16 v[204:207], a[172:175], v[40:43], v[204:207]
 v_exp_f32 v31, v31
 v_mfma_f32_16x16x32_bf16 v[204:207], a[204:207], v[44:47], v[204:207]
 s_waitcnt lgkmcnt(4)
 s_waitcnt vmcnt(10)
 s_barrier
 v_mfma_f32_16x16x32_bf16 v[24:27], a[96:99], a[0:3], 0
 v_cvt_pk_bf16_f32 v50, v28, v29
 v_cvt_pk_bf16_f32 v51, v30, v31
 v_mfma_f32_16x16x32_bf16 v[24:27], a[100:103], a[4:7], v[24:27]
 ds_read_b128 a[128:131], v7 offset:50688
 ds_read_b128 a[132:135], v7 offset:50752
 v_mfma_f32_16x16x32_bf16 v[24:27], a[104:107], a[8:11], v[24:27]
 v_exp_f32 v32, v32
 v_mfma_f32_16x16x32_bf16 v[24:27], a[108:111], a[12:15], v[24:27]
 s_waitcnt lgkmcnt(2)
 v_exp_f32 v33, v33
 v_smfmac_f32_16x16x64_bf16 a[232:235], a[236:239], v[40:47], v2
 ds_read_b128 a[136:139], v7 offset:50816
 ds_read_b128 a[140:143], v7 offset:50880
 v_mfma_f32_16x16x32_bf16 v[28:31], a[124:127], a[12:15], 0
 v_exp_f32 v34, v34
 v_mfma_f32_16x16x32_bf16 v[28:31], a[120:123], a[8:11], v[28:31]
 ds_read_b128 a[156:159], v7 offset:51392
 ds_read_b128 a[152:155], v7 offset:51328
 v_mfma_f32_16x16x32_bf16 v[28:31], a[116:119], a[4:7], v[28:31]
 v_exp_f32 v35, v35
 v_mfma_f32_16x16x32_bf16 v[28:31], a[112:115], a[0:3], v[28:31]
 v_exp_f32 v36, v36
 v_mfma_f32_16x16x32_bf16 v[208:211], a[176:179], v[40:43], v[208:211]
 ds_read_b128 a[148:151], v7 offset:51264
 ds_read_b128 a[144:147], v7 offset:51200
 v_mfma_f32_16x16x32_bf16 v[208:211], a[208:211], v[44:47], v[208:211]
 v_cvt_pk_bf16_f32 v52, v32, v33
 v_cvt_pk_bf16_f32 v53, v34, v35
 v_mfma_f32_16x16x32_bf16 v[212:215], a[180:183], v[40:43], v[212:215]
 s_add_u32 m0, s39, 16992
 v_exp_f32 v37, v37
 v_mfma_f32_16x16x32_bf16 v[212:215], a[212:215], v[44:47], v[212:215]
 buffer_load_dwordx4 v1, s[20:23], s33 offen offset:3072 nt lds
 v_mfma_f32_16x16x32_bf16 v[216:219], a[184:187], v[40:43], v[216:219]
 s_add_u32 s33, s33, 8192
 v_exp_f32 v38, v38
 v_mfma_f32_16x16x32_bf16 v[216:219], a[216:219], v[44:47], v[216:219]
 s_mov_b32 s59, 3072
 v_exp_f32 v39, v39
 v_mfma_f32_16x16x32_bf16 v[220:223], a[188:191], v[40:43], v[220:223]
 s_add_u32 m0, s45, 3264
 v_cvt_pk_bf16_f32 v54, v36, v37
 v_cvt_pk_bf16_f32 v55, v38, v39
 v_mfma_f32_16x16x32_bf16 v[220:223], a[220:223], v[44:47], v[220:223]
 s_waitcnt lgkmcnt(4)
 buffer_load_dwordx4 v1, s[28:31], s59 offen nt lds
 v_mfma_f32_16x16x32_bf16 v[32:35], a[128:131], a[0:3], 0
 v_exp_f32 v24, v24
 v_mfma_f32_16x16x32_bf16 v[32:35], a[132:135], a[4:7], v[32:35]
 v_mfma_f32_16x16x32_bf16 v[32:35], a[136:139], a[8:11], v[32:35]
 v_exp_f32 v25, v25
 v_mfma_f32_16x16x32_bf16 v[32:35], a[140:143], a[12:15], v[32:35]
 s_waitcnt lgkmcnt(0)
 v_exp_f32 v26, v26
 v_mfma_f32_16x16x32_bf16 v[36:39], a[156:159], a[12:15], 0
 v_mfma_f32_16x16x32_bf16 v[36:39], a[152:155], a[8:11], v[36:39]
 v_exp_f32 v27, v27
 v_mfma_f32_16x16x32_bf16 v[36:39], a[148:151], a[4:7], v[36:39]
 v_exp_f32 v28, v28
 v_mfma_f32_16x16x32_bf16 v[36:39], a[144:147], a[0:3], v[36:39]
 v_cvt_pk_bf16_f32 v40, v24, v25
 v_cvt_pk_bf16_f32 v41, v26, v27
 v_mfma_f32_16x16x32_bf16 v[224:227], a[160:163], v[48:51], v[224:227]
 v_exp_f32 v29, v29
 v_mfma_f32_16x16x32_bf16 v[224:227], a[192:195], v[52:55], v[224:227]
 v_exp_f32 v30, v30
 v_mfma_f32_16x16x32_bf16 v[228:231], a[164:167], v[48:51], v[228:231]
 ds_read_b64_tr_b16 a[160:161], v8 offset:33792
 ds_read_b64_tr_b16 a[162:163], v8 offset:34304
 v_mfma_f32_16x16x32_bf16 v[228:231], a[196:199], v[52:55], v[228:231]
 v_exp_f32 v31, v31
 v_mfma_f32_16x16x32_bf16 v[232:235], a[168:171], v[48:51], v[232:235]
 ds_read_b64_tr_b16 a[192:193], v8 offset:50688
 ds_read_b64_tr_b16 a[194:195], v8 offset:51200
 v_mfma_f32_16x16x32_bf16 v[232:235], a[200:203], v[52:55], v[232:235]
 v_cvt_pk_bf16_f32 v42, v28, v29
 v_cvt_pk_bf16_f32 v43, v30, v31
 v_mfma_f32_16x16x32_bf16 v[236:239], a[172:175], v[48:51], v[236:239]
 v_exp_f32 v32, v32
 v_mfma_f32_16x16x32_bf16 v[236:239], a[204:207], v[52:55], v[236:239]
 ds_read_b64_tr_b16 a[164:165], v8 offset:33824
 ds_read_b64_tr_b16 a[166:167], v8 offset:34336
 v_mfma_f32_16x16x32_bf16 v[24:27], a[96:99], a[16:19], 0
 v_exp_f32 v33, v33
 v_mfma_f32_16x16x32_bf16 v[24:27], a[100:103], a[20:23], v[24:27]
 ds_read_b64_tr_b16 a[196:197], v8 offset:50720
 ds_read_b64_tr_b16 a[198:199], v8 offset:51232
 v_mfma_f32_16x16x32_bf16 v[24:27], a[104:107], a[24:27], v[24:27]
 v_exp_f32 v34, v34
 v_mfma_f32_16x16x32_bf16 v[24:27], a[108:111], a[28:31], v[24:27]
 ds_read_b64_tr_b16 a[168:169], v8 offset:33856
 ds_read_b64_tr_b16 a[170:171], v8 offset:34368
 v_smfmac_f32_16x16x64_bf16 a[232:235], a[240:243], v[48:55], v2
 v_mfma_f32_16x16x32_bf16 v[28:31], a[124:127], a[28:31], 0
 ds_read_b64_tr_b16 a[200:201], v8 offset:50752
 ds_read_b64_tr_b16 a[202:203], v8 offset:51264
 v_mfma_f32_16x16x32_bf16 v[28:31], a[120:123], a[24:27], v[28:31]
 v_exp_f32 v35, v35
 v_mfma_f32_16x16x32_bf16 v[28:31], a[116:119], a[20:23], v[28:31]
 v_exp_f32 v36, v36
 v_mfma_f32_16x16x32_bf16 v[28:31], a[112:115], a[16:19], v[28:31]
 ds_read_b64_tr_b16 a[172:173], v8 offset:33888
 ds_read_b64_tr_b16 a[174:175], v8 offset:34400
 v_mfma_f32_16x16x32_bf16 v[240:243], a[176:179], v[48:51], v[240:243]
 v_cvt_pk_bf16_f32 v44, v32, v33
 v_cvt_pk_bf16_f32 v45, v34, v35
 v_mfma_f32_16x16x32_bf16 v[240:243], a[208:211], v[52:55], v[240:243]
 ds_read_b64_tr_b16 a[204:205], v8 offset:50784
 ds_read_b64_tr_b16 a[206:207], v8 offset:51296
 v_mfma_f32_16x16x32_bf16 v[244:247], a[180:183], v[48:51], v[244:247]
 v_exp_f32 v37, v37
 v_mfma_f32_16x16x32_bf16 v[244:247], a[212:215], v[52:55], v[244:247]
 v_exp_f32 v38, v38
 v_mfma_f32_16x16x32_bf16 v[248:251], a[184:187], v[48:51], v[248:251]
 v_exp_f32 v39, v39
 v_mfma_f32_16x16x32_bf16 v[248:251], a[216:219], v[52:55], v[248:251]
 s_mov_b32 s59, 4096
 ds_read_b64_tr_b16 a[176:177], v8 offset:33920
 ds_read_b64_tr_b16 a[178:179], v8 offset:34432
 v_mfma_f32_16x16x32_bf16 v[252:255], a[188:191], v[48:51], v[252:255]
 s_add_u32 m0, s45, 17408
 v_cvt_pk_bf16_f32 v46, v36, v37
 v_cvt_pk_bf16_f32 v47, v38, v39
 v_mfma_f32_16x16x32_bf16 v[252:255], a[220:223], v[52:55], v[252:255]
 buffer_load_dwordx4 v1, s[28:31], s59 offen nt lds
 v_mfma_f32_16x16x32_bf16 v[32:35], a[128:131], a[16:19], 0
 ds_read_b64_tr_b16 a[208:209], v8 offset:50816
 ds_read_b64_tr_b16 a[210:211], v8 offset:51328
 v_mfma_f32_16x16x32_bf16 v[32:35], a[132:135], a[20:23], v[32:35]
 v_exp_f32 v24, v24
 v_mfma_f32_16x16x32_bf16 v[32:35], a[136:139], a[24:27], v[32:35]
 v_exp_f32 v25, v25
 v_mfma_f32_16x16x32_bf16 v[32:35], a[140:143], a[28:31], v[32:35]
 ds_read_b64_tr_b16 a[180:181], v8 offset:33952
 ds_read_b64_tr_b16 a[182:183], v8 offset:34464
 v_mfma_f32_16x16x32_bf16 v[36:39], a[156:159], a[28:31], 0
 v_exp_f32 v26, v26
 v_mfma_f32_16x16x32_bf16 v[36:39], a[152:155], a[24:27], v[36:39]
 v_exp_f32 v27, v27
 v_mfma_f32_16x16x32_bf16 v[36:39], a[148:151], a[20:23], v[36:39]
 ds_read_b64_tr_b16 a[212:213], v8 offset:50848
 ds_read_b64_tr_b16 a[214:215], v8 offset:51360
 v_mfma_f32_16x16x32_bf16 v[36:39], a[144:147], a[16:19], v[36:39]
 s_waitcnt lgkmcnt(15)
 v_exp_f32 v28, v28
 v_mfma_f32_16x16x32_bf16 v[64:67], a[160:163], v[40:43], v[64:67]
 v_cvt_pk_bf16_f32 v48, v24, v25
 v_cvt_pk_bf16_f32 v49, v26, v27
 v_mfma_f32_16x16x32_bf16 v[64:67], a[192:195], v[44:47], v[64:67]
 ds_read_b64_tr_b16 a[184:185], v8 offset:33984
 ds_read_b64_tr_b16 a[186:187], v8 offset:34496
 v_mfma_f32_16x16x32_bf16 v[68:71], a[164:167], v[40:43], v[68:71]
 v_exp_f32 v29, v29
 v_mfma_f32_16x16x32_bf16 v[68:71], a[196:199], v[44:47], v[68:71]
 s_waitcnt lgkmcnt(10)
 v_exp_f32 v30, v30
 v_mfma_f32_16x16x32_bf16 v[72:75], a[168:171], v[40:43], v[72:75]
 ds_read_b64_tr_b16 a[216:217], v8 offset:50880
 ds_read_b64_tr_b16 a[218:219], v8 offset:51392
 v_mfma_f32_16x16x32_bf16 v[72:75], a[200:203], v[44:47], v[72:75]
 v_exp_f32 v31, v31
 v_mfma_f32_16x16x32_bf16 v[76:79], a[172:175], v[40:43], v[76:79]
 v_mfma_f32_16x16x32_bf16 v[76:79], a[204:207], v[44:47], v[76:79]
 ds_read_b64_tr_b16 a[188:189], v8 offset:34016
 ds_read_b64_tr_b16 a[190:191], v8 offset:34528
 v_mfma_f32_16x16x32_bf16 v[24:27], a[96:99], a[32:35], 0
 v_cvt_pk_bf16_f32 v50, v28, v29
 v_cvt_pk_bf16_f32 v51, v30, v31
 v_mfma_f32_16x16x32_bf16 v[24:27], a[100:103], a[36:39], v[24:27]
 v_exp_f32 v32, v32
 v_mfma_f32_16x16x32_bf16 v[24:27], a[104:107], a[40:43], v[24:27]
 ds_read_b64_tr_b16 a[220:221], v8 offset:50912
 ds_read_b64_tr_b16 a[222:223], v8 offset:51424
 v_mfma_f32_16x16x32_bf16 v[24:27], a[108:111], a[44:47], v[24:27]
 v_exp_f32 v33, v33
 v_smfmac_f32_16x16x64_bf16 a[224:227], a[236:239], v[40:47], v2
 v_mfma_f32_16x16x32_bf16 v[28:31], a[124:127], a[44:47], 0
 v_exp_f32 v34, v34
 v_mfma_f32_16x16x32_bf16 v[28:31], a[120:123], a[40:43], v[28:31]
 v_exp_f32 v35, v35
 v_mfma_f32_16x16x32_bf16 v[28:31], a[116:119], a[36:39], v[28:31]
 v_exp_f32 v36, v36
 v_mfma_f32_16x16x32_bf16 v[28:31], a[112:115], a[32:35], v[28:31]
 s_waitcnt lgkmcnt(8)
 v_mfma_f32_16x16x32_bf16 v[80:83], a[176:179], v[40:43], v[80:83]
 v_cvt_pk_bf16_f32 v52, v32, v33
 v_cvt_pk_bf16_f32 v53, v34, v35
 v_mfma_f32_16x16x32_bf16 v[80:83], a[208:211], v[44:47], v[80:83]
 v_mfma_f32_16x16x32_bf16 v[84:87], a[180:183], v[40:43], v[84:87]
 v_exp_f32 v37, v37
 v_mfma_f32_16x16x32_bf16 v[84:87], a[212:215], v[44:47], v[84:87]
 s_waitcnt lgkmcnt(0)
 s_barrier
 v_mfma_f32_16x16x32_bf16 v[88:91], a[184:187], v[40:43], v[88:91]
 v_exp_f32 v38, v38
 v_mfma_f32_16x16x32_bf16 v[88:91], a[216:219], v[44:47], v[88:91]
 s_mov_b32 s59, 5120
 v_exp_f32 v39, v39
 v_mfma_f32_16x16x32_bf16 v[92:95], a[188:191], v[40:43], v[92:95]
 s_add_u32 m0, s45, 18496
 v_cvt_pk_bf16_f32 v54, v36, v37
 v_cvt_pk_bf16_f32 v55, v38, v39
 v_mfma_f32_16x16x32_bf16 v[92:95], a[220:223], v[44:47], v[92:95]
 buffer_load_dwordx4 v1, s[28:31], s59 offen nt lds
 v_mfma_f32_16x16x32_bf16 v[32:35], a[128:131], a[32:35], 0
 v_mfma_f32_16x16x32_bf16 v[32:35], a[132:135], a[36:39], v[32:35]
 v_exp_f32 v24, v24
 v_mfma_f32_16x16x32_bf16 v[32:35], a[136:139], a[40:43], v[32:35]
 v_exp_f32 v25, v25
 v_mfma_f32_16x16x32_bf16 v[32:35], a[140:143], a[44:47], v[32:35]
 v_mfma_f32_16x16x32_bf16 v[36:39], a[156:159], a[44:47], 0
 v_exp_f32 v26, v26
 v_mfma_f32_16x16x32_bf16 v[36:39], a[152:155], a[40:43], v[36:39]
 v_exp_f32 v27, v27
 v_mfma_f32_16x16x32_bf16 v[36:39], a[148:151], a[36:39], v[36:39]
 s_add_u32 m0, s39, 33792
 v_exp_f32 v28, v28
 v_mfma_f32_16x16x32_bf16 v[36:39], a[144:147], a[32:35], v[36:39]
 buffer_load_dwordx4 v1, s[20:23], s33 offen nt lds
 v_mfma_f32_16x16x32_bf16 v[96:99], a[160:163], v[48:51], v[96:99]
 v_mfma_f32_16x16x32_bf16 v[96:99], a[192:195], v[52:55], v[96:99]
 v_cvt_pk_bf16_f32 v40, v24, v25
 v_cvt_pk_bf16_f32 v41, v26, v27
 v_mfma_f32_16x16x32_bf16 v[100:103], a[164:167], v[48:51], v[100:103]
 v_mfma_f32_16x16x32_bf16 v[100:103], a[196:199], v[52:55], v[100:103]
 v_exp_f32 v29, v29
 v_mfma_f32_16x16x32_bf16 v[104:107], a[168:171], v[48:51], v[104:107]
 v_exp_f32 v30, v30
 v_mfma_f32_16x16x32_bf16 v[104:107], a[200:203], v[52:55], v[104:107]
 v_mfma_f32_16x16x32_bf16 v[108:111], a[172:175], v[48:51], v[108:111]
 v_exp_f32 v31, v31
 v_mfma_f32_16x16x32_bf16 v[108:111], a[204:207], v[52:55], v[108:111]
 v_mfma_f32_16x16x32_bf16 v[24:27], a[96:99], a[48:51], 0
 v_cvt_pk_bf16_f32 v42, v28, v29
 v_cvt_pk_bf16_f32 v43, v30, v31
 v_mfma_f32_16x16x32_bf16 v[24:27], a[100:103], a[52:55], v[24:27]
 v_exp_f32 v32, v32
 v_mfma_f32_16x16x32_bf16 v[24:27], a[104:107], a[56:59], v[24:27]
 v_exp_f32 v33, v33
 v_mfma_f32_16x16x32_bf16 v[24:27], a[108:111], a[60:63], v[24:27]
 v_exp_f32 v34, v34
 v_smfmac_f32_16x16x64_bf16 a[224:227], a[240:243], v[48:55], v2
 v_mfma_f32_16x16x32_bf16 v[28:31], a[124:127], a[60:63], 0
 v_exp_f32 v35, v35
 v_mfma_f32_16x16x32_bf16 v[28:31], a[120:123], a[56:59], v[28:31]
 v_exp_f32 v36, v36
 v_mfma_f32_16x16x32_bf16 v[28:31], a[116:119], a[52:55], v[28:31]
 s_add_u32 m0, s39, 33824
 v_mfma_f32_16x16x32_bf16 v[28:31], a[112:115], a[48:51], v[28:31]
 buffer_load_dwordx4 v1, s[20:23], s33 offen offset:1024 nt lds
 v_mfma_f32_16x16x32_bf16 v[112:115], a[176:179], v[48:51], v[112:115]
 v_cvt_pk_bf16_f32 v44, v32, v33
 v_cvt_pk_bf16_f32 v45, v34, v35
 v_mfma_f32_16x16x32_bf16 v[112:115], a[208:211], v[52:55], v[112:115]
 v_exp_f32 v37, v37
 v_mfma_f32_16x16x32_bf16 v[116:119], a[180:183], v[48:51], v[116:119]
 v_mfma_f32_16x16x32_bf16 v[116:119], a[212:215], v[52:55], v[116:119]
 v_exp_f32 v38, v38
 v_mfma_f32_16x16x32_bf16 v[120:123], a[184:187], v[48:51], v[120:123]
 v_exp_f32 v39, v39
 v_mfma_f32_16x16x32_bf16 v[120:123], a[216:219], v[52:55], v[120:123]
 v_mfma_f32_16x16x32_bf16 v[124:127], a[188:191], v[48:51], v[124:127]
 v_cvt_pk_bf16_f32 v46, v36, v37
 v_cvt_pk_bf16_f32 v47, v38, v39
 v_mfma_f32_16x16x32_bf16 v[124:127], a[220:223], v[52:55], v[124:127]
 v_mfma_f32_16x16x32_bf16 v[32:35], a[128:131], a[48:51], 0
 v_exp_f32 v24, v24
 v_mfma_f32_16x16x32_bf16 v[32:35], a[132:135], a[52:55], v[32:35]
 v_mfma_f32_16x16x32_bf16 v[32:35], a[136:139], a[56:59], v[32:35]
 v_exp_f32 v25, v25
 v_mfma_f32_16x16x32_bf16 v[32:35], a[140:143], a[60:63], v[32:35]
 v_exp_f32 v26, v26
 v_mfma_f32_16x16x32_bf16 v[36:39], a[156:159], a[60:63], 0
 v_mfma_f32_16x16x32_bf16 v[36:39], a[152:155], a[56:59], v[36:39]
 v_exp_f32 v27, v27
 v_mfma_f32_16x16x32_bf16 v[36:39], a[148:151], a[52:55], v[36:39]
 v_exp_f32 v28, v28
 v_mfma_f32_16x16x32_bf16 v[36:39], a[144:147], a[48:51], v[36:39]
 v_mfma_f32_16x16x32_bf16 v[128:131], a[160:163], v[40:43], v[128:131]
 s_add_u32 m0, s39, 33856
 v_cvt_pk_bf16_f32 v48, v24, v25
 v_cvt_pk_bf16_f32 v49, v26, v27
 v_mfma_f32_16x16x32_bf16 v[128:131], a[192:195], v[44:47], v[128:131]
 buffer_load_dwordx4 v1, s[20:23], s33 offen offset:2048 nt lds
 v_mfma_f32_16x16x32_bf16 v[132:135], a[164:167], v[40:43], v[132:135]
 v_exp_f32 v29, v29
 v_mfma_f32_16x16x32_bf16 v[132:135], a[196:199], v[44:47], v[132:135]
 v_exp_f32 v30, v30
 v_mfma_f32_16x16x32_bf16 v[136:139], a[168:171], v[40:43], v[136:139]
 v_mfma_f32_16x16x32_bf16 v[136:139], a[200:203], v[44:47], v[136:139]
 v_exp_f32 v31, v31
 v_mfma_f32_16x16x32_bf16 v[140:143], a[172:175], v[40:43], v[140:143]
 v_mfma_f32_16x16x32_bf16 v[140:143], a[204:207], v[44:47], v[140:143]
 v_cvt_pk_bf16_f32 v50, v28, v29
 v_cvt_pk_bf16_f32 v51, v30, v31
 v_mfma_f32_16x16x32_bf16 v[24:27], a[96:99], a[64:67], 0
 v_mfma_f32_16x16x32_bf16 v[24:27], a[100:103], a[68:71], v[24:27]
 v_exp_f32 v32, v32
 v_mfma_f32_16x16x32_bf16 v[24:27], a[104:107], a[72:75], v[24:27]
 v_exp_f32 v33, v33
 v_mfma_f32_16x16x32_bf16 v[24:27], a[108:111], a[76:79], v[24:27]
 v_exp_f32 v34, v34
 v_smfmac_f32_16x16x64_bf16 a[228:231], a[236:239], v[40:47], v2
 v_mfma_f32_16x16x32_bf16 v[28:31], a[124:127], a[76:79], 0
 v_exp_f32 v35, v35
 v_mfma_f32_16x16x32_bf16 v[28:31], a[120:123], a[72:75], v[28:31]
 v_mfma_f32_16x16x32_bf16 v[28:31], a[116:119], a[68:71], v[28:31]
 v_exp_f32 v36, v36
 v_mfma_f32_16x16x32_bf16 v[28:31], a[112:115], a[64:67], v[28:31]
 v_mfma_f32_16x16x32_bf16 v[144:147], a[176:179], v[40:43], v[144:147]
 s_add_u32 m0, s39, 33888
 v_cvt_pk_bf16_f32 v52, v32, v33
 v_cvt_pk_bf16_f32 v53, v34, v35
 v_mfma_f32_16x16x32_bf16 v[144:147], a[208:211], v[44:47], v[144:147]
 buffer_load_dwordx4 v1, s[20:23], s33 offen offset:3072 nt lds
 v_mfma_f32_16x16x32_bf16 v[148:151], a[180:183], v[40:43], v[148:151]
 s_add_u32 s33, s33, 8192
 v_exp_f32 v37, v37
 v_mfma_f32_16x16x32_bf16 v[148:151], a[212:215], v[44:47], v[148:151]
 v_exp_f32 v38, v38
 v_mfma_f32_16x16x32_bf16 v[152:155], a[184:187], v[40:43], v[152:155]
 v_mfma_f32_16x16x32_bf16 v[152:155], a[216:219], v[44:47], v[152:155]
 s_mov_b32 s59, 6144
 v_exp_f32 v39, v39
 v_mfma_f32_16x16x32_bf16 v[156:159], a[188:191], v[40:43], v[156:159]
 s_add_u32 m0, s45, 19584
 v_cvt_pk_bf16_f32 v54, v36, v37
 v_cvt_pk_bf16_f32 v55, v38, v39
 v_mfma_f32_16x16x32_bf16 v[156:159], a[220:223], v[44:47], v[156:159]
 buffer_load_dwordx4 v1, s[28:31], s59 offen nt lds
 v_mfma_f32_16x16x32_bf16 v[32:35], a[128:131], a[64:67], 0
 v_mfma_f32_16x16x32_bf16 v[32:35], a[132:135], a[68:71], v[32:35]
 v_exp_f32 v24, v24
 v_mfma_f32_16x16x32_bf16 v[32:35], a[136:139], a[72:75], v[32:35]
 v_exp_f32 v25, v25
 v_mfma_f32_16x16x32_bf16 v[32:35], a[140:143], a[76:79], v[32:35]
 v_exp_f32 v26, v26
 v_mfma_f32_16x16x32_bf16 v[36:39], a[156:159], a[76:79], 0
 v_mfma_f32_16x16x32_bf16 v[36:39], a[152:155], a[72:75], v[36:39]
 v_exp_f32 v27, v27
 v_mfma_f32_16x16x32_bf16 v[36:39], a[148:151], a[68:71], v[36:39]
 v_exp_f32 v28, v28
 v_mfma_f32_16x16x32_bf16 v[36:39], a[144:147], a[64:67], v[36:39]
 v_mfma_f32_16x16x32_bf16 v[160:163], a[160:163], v[48:51], v[160:163]
 v_cvt_pk_bf16_f32 v40, v24, v25
 v_cvt_pk_bf16_f32 v41, v26, v27
 v_mfma_f32_16x16x32_bf16 v[160:163], a[192:195], v[52:55], v[160:163]
 v_mfma_f32_16x16x32_bf16 v[164:167], a[164:167], v[48:51], v[164:167]
 s_add_u32 m0, s39, 50688
 v_exp_f32 v29, v29
 v_mfma_f32_16x16x32_bf16 v[164:167], a[196:199], v[52:55], v[164:167]
 buffer_load_dwordx4 v1, s[20:23], s33 offen nt lds
 v_mfma_f32_16x16x32_bf16 v[168:171], a[168:171], v[48:51], v[168:171]
 v_exp_f32 v30, v30
 v_mfma_f32_16x16x32_bf16 v[168:171], a[200:203], v[52:55], v[168:171]
 v_exp_f32 v31, v31
 v_mfma_f32_16x16x32_bf16 v[172:175], a[172:175], v[48:51], v[172:175]
 v_mfma_f32_16x16x32_bf16 v[172:175], a[204:207], v[52:55], v[172:175]
 v_cvt_pk_bf16_f32 v42, v28, v29
 v_cvt_pk_bf16_f32 v43, v30, v31
 v_mfma_f32_16x16x32_bf16 v[24:27], a[96:99], a[80:83], 0
 v_mfma_f32_16x16x32_bf16 v[24:27], a[100:103], a[84:87], v[24:27]
 v_exp_f32 v32, v32
 v_mfma_f32_16x16x32_bf16 v[24:27], a[104:107], a[88:91], v[24:27]
 v_mfma_f32_16x16x32_bf16 v[24:27], a[108:111], a[92:95], v[24:27]
 v_exp_f32 v33, v33
 v_smfmac_f32_16x16x64_bf16 a[228:231], a[240:243], v[48:55], v2
 v_mfma_f32_16x16x32_bf16 v[28:31], a[124:127], a[92:95], 0
 v_exp_f32 v34, v34
 v_mfma_f32_16x16x32_bf16 v[28:31], a[120:123], a[88:91], v[28:31]
 v_exp_f32 v35, v35
 v_mfma_f32_16x16x32_bf16 v[28:31], a[116:119], a[84:87], v[28:31]
 v_exp_f32 v36, v36
 v_mfma_f32_16x16x32_bf16 v[28:31], a[112:115], a[80:83], v[28:31]
 s_waitcnt vmcnt(9)
 s_barrier
 v_mfma_f32_16x16x32_bf16 v[176:179], a[176:179], v[48:51], v[176:179]
 v_cvt_pk_bf16_f32 v44, v32, v33
 v_cvt_pk_bf16_f32 v45, v34, v35
 v_mfma_f32_16x16x32_bf16 v[176:179], a[208:211], v[52:55], v[176:179]
 v_exp_f32 v37, v37
 v_mfma_f32_16x16x32_bf16 v[180:183], a[180:183], v[48:51], v[180:183]
 s_add_u32 m0, s39, 50720
 ds_read_b128 a[96:99], v7 offset:0
 ds_read_b128 a[100:103], v7 offset:64
 v_mfma_f32_16x16x32_bf16 v[180:183], a[212:215], v[52:55], v[180:183]
 buffer_load_dwordx4 v1, s[20:23], s33 offen offset:1024 nt lds
 v_mfma_f32_16x16x32_bf16 v[184:187], a[184:187], v[48:51], v[184:187]
 v_exp_f32 v38, v38
 v_mfma_f32_16x16x32_bf16 v[184:187], a[216:219], v[52:55], v[184:187]
 v_exp_f32 v39, v39
 v_mfma_f32_16x16x32_bf16 v[188:191], a[188:191], v[48:51], v[188:191]
 ds_read_b128 a[104:107], v7 offset:128
 ds_read_b128 a[108:111], v7 offset:192
 v_mfma_f32_16x16x32_bf16 v[188:191], a[220:223], v[52:55], v[188:191]
 v_cvt_pk_bf16_f32 v46, v36, v37
 v_cvt_pk_bf16_f32 v47, v38, v39
 v_mfma_f32_16x16x32_bf16 v[32:35], a[128:131], a[80:83], 0
 v_mfma_f32_16x16x32_bf16 v[32:35], a[132:135], a[84:87], v[32:35]
 v_exp_f32 v24, v24
 v_mfma_f32_16x16x32_bf16 v[32:35], a[136:139], a[88:91], v[32:35]
 ds_read_b128 a[124:127], v7 offset:704
 ds_read_b128 a[120:123], v7 offset:640
 v_mfma_f32_16x16x32_bf16 v[32:35], a[140:143], a[92:95], v[32:35]
 v_exp_f32 v25, v25
 v_mfma_f32_16x16x32_bf16 v[36:39], a[156:159], a[92:95], 0
 v_exp_f32 v26, v26
 v_mfma_f32_16x16x32_bf16 v[36:39], a[152:155], a[88:91], v[36:39]
 v_exp_f32 v27, v27
 v_mfma_f32_16x16x32_bf16 v[36:39], a[148:151], a[84:87], v[36:39]
 ds_read_b128 a[116:119], v7 offset:576
 ds_read_b128 a[112:115], v7 offset:512
 v_mfma_f32_16x16x32_bf16 v[36:39], a[144:147], a[80:83], v[36:39]
 v_exp_f32 v28, v28
 v_mfma_f32_16x16x32_bf16 v[192:195], a[160:163], v[40:43], v[192:195]
 v_mfma_f32_16x16x32_bf16 v[192:195], a[192:195], v[44:47], v[192:195]
 v_cvt_pk_bf16_f32 v48, v24, v25
 v_cvt_pk_bf16_f32 v49, v26, v27
 v_mfma_f32_16x16x32_bf16 v[196:199], a[164:167], v[40:43], v[196:199]
 v_exp_f32 v29, v29
 v_mfma_f32_16x16x32_bf16 v[196:199], a[196:199], v[44:47], v[196:199]
 ds_read_b128 a[128:131], v7 offset:16896
 ds_read_b128 a[132:135], v7 offset:16960
 v_mfma_f32_16x16x32_bf16 v[200:203], a[168:171], v[40:43], v[200:203]
 s_add_u32 m0, s39, 50752
 v_exp_f32 v30, v30
 v_mfma_f32_16x16x32_bf16 v[200:203], a[200:203], v[44:47], v[200:203]
 buffer_load_dwordx4 v1, s[20:23], s33 offen offset:2048 nt lds
 v_mfma_f32_16x16x32_bf16 v[204:207], a[172:175], v[40:43], v[204:207]
 v_exp_f32 v31, v31
 v_mfma_f32_16x16x32_bf16 v[204:207], a[204:207], v[44:47], v[204:207]
 s_waitcnt lgkmcnt(6)
 ds_read_b128 a[136:139], v7 offset:17024
 ds_read_b128 a[140:143], v7 offset:17088
 v_mfma_f32_16x16x32_bf16 v[24:27], a[96:99], a[0:3], 0
 v_cvt_pk_bf16_f32 v50, v28, v29
 v_cvt_pk_bf16_f32 v51, v30, v31
 v_mfma_f32_16x16x32_bf16 v[24:27], a[100:103], a[4:7], v[24:27]
 v_exp_f32 v32, v32
 v_mfma_f32_16x16x32_bf16 v[24:27], a[104:107], a[8:11], v[24:27]
 v_exp_f32 v33, v33
 v_mfma_f32_16x16x32_bf16 v[24:27], a[108:111], a[12:15], v[24:27]
 s_waitcnt lgkmcnt(4)
 ds_read_b128 a[156:159], v7 offset:17600
 ds_read_b128 a[152:155], v7 offset:17536
 v_smfmac_f32_16x16x64_bf16 a[232:235], a[236:239], v[40:47], v2
 v_mfma_f32_16x16x32_bf16 v[28:31], a[124:127], a[12:15], 0
 v_exp_f32 v34, v34
 v_mfma_f32_16x16x32_bf16 v[28:31], a[120:123], a[8:11], v[28:31]
 v_exp_f32 v35, v35
 v_mfma_f32_16x16x32_bf16 v[28:31], a[116:119], a[4:7], v[28:31]
 ds_read_b128 a[148:151], v7 offset:17472
 ds_read_b128 a[144:147], v7 offset:17408
 v_mfma_f32_16x16x32_bf16 v[28:31], a[112:115], a[0:3], v[28:31]
 v_exp_f32 v36, v36
 v_mfma_f32_16x16x32_bf16 v[208:211], a[176:179], v[40:43], v[208:211]
 v_cvt_pk_bf16_f32 v52, v32, v33
 v_cvt_pk_bf16_f32 v53, v34, v35
 v_mfma_f32_16x16x32_bf16 v[208:211], a[208:211], v[44:47], v[208:211]
 v_exp_f32 v37, v37
 v_mfma_f32_16x16x32_bf16 v[212:215], a[180:183], v[40:43], v[212:215]
 s_add_u32 m0, s39, 50784
 v_exp_f32 v38, v38
 v_mfma_f32_16x16x32_bf16 v[212:215], a[212:215], v[44:47], v[212:215]
 buffer_load_dwordx4 v1, s[20:23], s33 offen offset:3072 nt lds
 v_mfma_f32_16x16x32_bf16 v[216:219], a[184:187], v[40:43], v[216:219]
 s_add_u32 s33, s33, 8192
 v_exp_f32 v39, v39
 v_mfma_f32_16x16x32_bf16 v[216:219], a[216:219], v[44:47], v[216:219]
 s_mov_b32 s59, 7168
 v_mfma_f32_16x16x32_bf16 v[220:223], a[188:191], v[40:43], v[220:223]
 s_add_u32 m0, s45, 20672
 v_cvt_pk_bf16_f32 v54, v36, v37
 v_cvt_pk_bf16_f32 v55, v38, v39
 v_mfma_f32_16x16x32_bf16 v[220:223], a[220:223], v[44:47], v[220:223]
 s_waitcnt lgkmcnt(4)
 buffer_load_dwordx4 v1, s[28:31], s59 offen nt lds
 v_mfma_f32_16x16x32_bf16 v[32:35], a[128:131], a[0:3], 0
 v_exp_f32 v24, v24
 v_mfma_f32_16x16x32_bf16 v[32:35], a[132:135], a[4:7], v[32:35]
 v_mfma_f32_16x16x32_bf16 v[32:35], a[136:139], a[8:11], v[32:35]
 v_exp_f32 v25, v25
 v_mfma_f32_16x16x32_bf16 v[32:35], a[140:143], a[12:15], v[32:35]
 s_waitcnt lgkmcnt(0)
 v_exp_f32 v26, v26
 v_mfma_f32_16x16x32_bf16 v[36:39], a[156:159], a[12:15], 0
 v_mfma_f32_16x16x32_bf16 v[36:39], a[152:155], a[8:11], v[36:39]
 v_exp_f32 v27, v27
 v_mfma_f32_16x16x32_bf16 v[36:39], a[148:151], a[4:7], v[36:39]
 v_exp_f32 v28, v28
 v_mfma_f32_16x16x32_bf16 v[36:39], a[144:147], a[0:3], v[36:39]
 v_cvt_pk_bf16_f32 v40, v24, v25
 v_cvt_pk_bf16_f32 v41, v26, v27
 v_mfma_f32_16x16x32_bf16 v[224:227], a[160:163], v[48:51], v[224:227]
 v_exp_f32 v29, v29
 v_mfma_f32_16x16x32_bf16 v[224:227], a[192:195], v[52:55], v[224:227]
 v_exp_f32 v30, v30
 v_mfma_f32_16x16x32_bf16 v[228:231], a[164:167], v[48:51], v[228:231]
 ds_read_b64_tr_b16 a[160:161], v8 offset:0
 ds_read_b64_tr_b16 a[162:163], v8 offset:512
 v_mfma_f32_16x16x32_bf16 v[228:231], a[196:199], v[52:55], v[228:231]
 v_exp_f32 v31, v31
 v_mfma_f32_16x16x32_bf16 v[232:235], a[168:171], v[48:51], v[232:235]
 ds_read_b64_tr_b16 a[192:193], v8 offset:16896
 ds_read_b64_tr_b16 a[194:195], v8 offset:17408
 v_mfma_f32_16x16x32_bf16 v[232:235], a[200:203], v[52:55], v[232:235]
 v_cvt_pk_bf16_f32 v42, v28, v29
 v_cvt_pk_bf16_f32 v43, v30, v31
 v_mfma_f32_16x16x32_bf16 v[236:239], a[172:175], v[48:51], v[236:239]
 v_exp_f32 v32, v32
 v_mfma_f32_16x16x32_bf16 v[236:239], a[204:207], v[52:55], v[236:239]
 ds_read_b64_tr_b16 a[164:165], v8 offset:32
 ds_read_b64_tr_b16 a[166:167], v8 offset:544
 v_mfma_f32_16x16x32_bf16 v[24:27], a[96:99], a[16:19], 0
 v_exp_f32 v33, v33
 v_mfma_f32_16x16x32_bf16 v[24:27], a[100:103], a[20:23], v[24:27]
 ds_read_b64_tr_b16 a[196:197], v8 offset:16928
 ds_read_b64_tr_b16 a[198:199], v8 offset:17440
 v_mfma_f32_16x16x32_bf16 v[24:27], a[104:107], a[24:27], v[24:27]
 v_exp_f32 v34, v34
 v_mfma_f32_16x16x32_bf16 v[24:27], a[108:111], a[28:31], v[24:27]
 ds_read_b64_tr_b16 a[168:169], v8 offset:64
 ds_read_b64_tr_b16 a[170:171], v8 offset:576
 v_smfmac_f32_16x16x64_bf16 a[232:235], a[240:243], v[48:55], v2
 v_mfma_f32_16x16x32_bf16 v[28:31], a[124:127], a[28:31], 0
 ds_read_b64_tr_b16 a[200:201], v8 offset:16960
 ds_read_b64_tr_b16 a[202:203], v8 offset:17472
 v_mfma_f32_16x16x32_bf16 v[28:31], a[120:123], a[24:27], v[28:31]
 v_exp_f32 v35, v35
 v_mfma_f32_16x16x32_bf16 v[28:31], a[116:119], a[20:23], v[28:31]
 v_exp_f32 v36, v36
 v_mfma_f32_16x16x32_bf16 v[28:31], a[112:115], a[16:19], v[28:31]
 ds_read_b64_tr_b16 a[172:173], v8 offset:96
 ds_read_b64_tr_b16 a[174:175], v8 offset:608
 v_mfma_f32_16x16x32_bf16 v[240:243], a[176:179], v[48:51], v[240:243]
 v_cvt_pk_bf16_f32 v44, v32, v33
 v_cvt_pk_bf16_f32 v45, v34, v35
 v_mfma_f32_16x16x32_bf16 v[240:243], a[208:211], v[52:55], v[240:243]
 ds_read_b64_tr_b16 a[204:205], v8 offset:16992
 ds_read_b64_tr_b16 a[206:207], v8 offset:17504
 v_mfma_f32_16x16x32_bf16 v[244:247], a[180:183], v[48:51], v[244:247]
 v_exp_f32 v37, v37
 v_mfma_f32_16x16x32_bf16 v[244:247], a[212:215], v[52:55], v[244:247]
 v_exp_f32 v38, v38
 v_mfma_f32_16x16x32_bf16 v[248:251], a[184:187], v[48:51], v[248:251]
 v_exp_f32 v39, v39
 v_mfma_f32_16x16x32_bf16 v[248:251], a[216:219], v[52:55], v[248:251]
 s_mov_b32 s59, 8192
 ds_read_b64_tr_b16 a[176:177], v8 offset:128
 ds_read_b64_tr_b16 a[178:179], v8 offset:640
 v_mfma_f32_16x16x32_bf16 v[252:255], a[188:191], v[48:51], v[252:255]
 s_add_u32 m0, s45, 4352
 v_cvt_pk_bf16_f32 v46, v36, v37
 v_cvt_pk_bf16_f32 v47, v38, v39
 v_mfma_f32_16x16x32_bf16 v[252:255], a[220:223], v[52:55], v[252:255]
L_pg1_3:
 s_cbranch_execz L_pg1_7
 buffer_load_dwordx4 v1, s[28:31], s59 offen nt lds
 v_mfma_f32_16x16x32_bf16 v[32:35], a[128:131], a[16:19], 0
 ds_read_b64_tr_b16 a[208:209], v8 offset:17024
 ds_read_b64_tr_b16 a[210:211], v8 offset:17536
 v_mfma_f32_16x16x32_bf16 v[32:35], a[132:135], a[20:23], v[32:35]
 v_exp_f32 v24, v24
 v_mfma_f32_16x16x32_bf16 v[32:35], a[136:139], a[24:27], v[32:35]
 v_exp_f32 v25, v25
 v_mfma_f32_16x16x32_bf16 v[32:35], a[140:143], a[28:31], v[32:35]
 ds_read_b64_tr_b16 a[180:181], v8 offset:160
 ds_read_b64_tr_b16 a[182:183], v8 offset:672
 v_mfma_f32_16x16x32_bf16 v[36:39], a[156:159], a[28:31], 0
 v_exp_f32 v26, v26
 v_mfma_f32_16x16x32_bf16 v[36:39], a[152:155], a[24:27], v[36:39]
 v_exp_f32 v27, v27
 v_mfma_f32_16x16x32_bf16 v[36:39], a[148:151], a[20:23], v[36:39]
 ds_read_b64_tr_b16 a[212:213], v8 offset:17056
 ds_read_b64_tr_b16 a[214:215], v8 offset:17568
 v_mfma_f32_16x16x32_bf16 v[36:39], a[144:147], a[16:19], v[36:39]
 s_waitcnt lgkmcnt(15)
 v_exp_f32 v28, v28
 v_mfma_f32_16x16x32_bf16 v[64:67], a[160:163], v[40:43], v[64:67]
 v_cvt_pk_bf16_f32 v48, v24, v25
 v_cvt_pk_bf16_f32 v49, v26, v27
 v_mfma_f32_16x16x32_bf16 v[64:67], a[192:195], v[44:47], v[64:67]
 ds_read_b64_tr_b16 a[184:185], v8 offset:192
 ds_read_b64_tr_b16 a[186:187], v8 offset:704
 v_mfma_f32_16x16x32_bf16 v[68:71], a[164:167], v[40:43], v[68:71]
 v_exp_f32 v29, v29
 v_mfma_f32_16x16x32_bf16 v[68:71], a[196:199], v[44:47], v[68:71]
 s_waitcnt lgkmcnt(10)
 v_exp_f32 v30, v30
 v_mfma_f32_16x16x32_bf16 v[72:75], a[168:171], v[40:43], v[72:75]
 ds_read_b64_tr_b16 a[216:217], v8 offset:17088
 ds_read_b64_tr_b16 a[218:219], v8 offset:17600
 v_mfma_f32_16x16x32_bf16 v[72:75], a[200:203], v[44:47], v[72:75]
 v_exp_f32 v31, v31
 v_mfma_f32_16x16x32_bf16 v[76:79], a[172:175], v[40:43], v[76:79]
 v_mfma_f32_16x16x32_bf16 v[76:79], a[204:207], v[44:47], v[76:79]
 ds_read_b64_tr_b16 a[188:189], v8 offset:224
 ds_read_b64_tr_b16 a[190:191], v8 offset:736
 v_mfma_f32_16x16x32_bf16 v[24:27], a[96:99], a[32:35], 0
 v_cvt_pk_bf16_f32 v50, v28, v29
 v_cvt_pk_bf16_f32 v51, v30, v31
 v_mfma_f32_16x16x32_bf16 v[24:27], a[100:103], a[36:39], v[24:27]
 v_exp_f32 v32, v32
 v_mfma_f32_16x16x32_bf16 v[24:27], a[104:107], a[40:43], v[24:27]
 ds_read_b64_tr_b16 a[220:221], v8 offset:17120
 ds_read_b64_tr_b16 a[222:223], v8 offset:17632
 v_mfma_f32_16x16x32_bf16 v[24:27], a[108:111], a[44:47], v[24:27]
 v_exp_f32 v33, v33
 v_smfmac_f32_16x16x64_bf16 a[224:227], a[236:239], v[40:47], v2
 v_mfma_f32_16x16x32_bf16 v[28:31], a[124:127], a[44:47], 0
 v_exp_f32 v34, v34
 v_mfma_f32_16x16x32_bf16 v[28:31], a[120:123], a[40:43], v[28:31]
 v_exp_f32 v35, v35
 v_mfma_f32_16x16x32_bf16 v[28:31], a[116:119], a[36:39], v[28:31]
 v_exp_f32 v36, v36
 v_mfma_f32_16x16x32_bf16 v[28:31], a[112:115], a[32:35], v[28:31]
 s_waitcnt lgkmcnt(8)
 v_mfma_f32_16x16x32_bf16 v[80:83], a[176:179], v[40:43], v[80:83]
 v_cvt_pk_bf16_f32 v52, v32, v33
 v_cvt_pk_bf16_f32 v53, v34, v35
 v_mfma_f32_16x16x32_bf16 v[80:83], a[208:211], v[44:47], v[80:83]
 v_mfma_f32_16x16x32_bf16 v[84:87], a[180:183], v[40:43], v[84:87]
 v_exp_f32 v37, v37
 v_mfma_f32_16x16x32_bf16 v[84:87], a[212:215], v[44:47], v[84:87]
 s_waitcnt lgkmcnt(0)
 s_barrier
 v_mfma_f32_16x16x32_bf16 v[88:91], a[184:187], v[40:43], v[88:91]
 v_exp_f32 v38, v38
 v_mfma_f32_16x16x32_bf16 v[88:91], a[216:219], v[44:47], v[88:91]
 s_mov_b32 s59, 9216
 v_exp_f32 v39, v39
 v_mfma_f32_16x16x32_bf16 v[92:95], a[188:191], v[40:43], v[92:95]
 s_add_u32 m0, s45, 5440
 v_cvt_pk_bf16_f32 v54, v36, v37
 v_cvt_pk_bf16_f32 v55, v38, v39
 v_mfma_f32_16x16x32_bf16 v[92:95], a[220:223], v[44:47], v[92:95]
 buffer_load_dwordx4 v1, s[28:31], s59 offen nt lds
 v_mfma_f32_16x16x32_bf16 v[32:35], a[128:131], a[32:35], 0
 v_mfma_f32_16x16x32_bf16 v[32:35], a[132:135], a[36:39], v[32:35]
 v_exp_f32 v24, v24
 v_mfma_f32_16x16x32_bf16 v[32:35], a[136:139], a[40:43], v[32:35]
 v_exp_f32 v25, v25
 v_mfma_f32_16x16x32_bf16 v[32:35], a[140:143], a[44:47], v[32:35]
 v_mfma_f32_16x16x32_bf16 v[36:39], a[156:159], a[44:47], 0
 v_exp_f32 v26, v26
 v_mfma_f32_16x16x32_bf16 v[36:39], a[152:155], a[40:43], v[36:39]
 v_exp_f32 v27, v27
 v_mfma_f32_16x16x32_bf16 v[36:39], a[148:151], a[36:39], v[36:39]
 s_add_u32 m0, s39, 0
 v_exp_f32 v28, v28
 v_mfma_f32_16x16x32_bf16 v[36:39], a[144:147], a[32:35], v[36:39]
 buffer_load_dwordx4 v1, s[20:23], s33 offen nt lds
 v_mfma_f32_16x16x32_bf16 v[96:99], a[160:163], v[48:51], v[96:99]
 v_mfma_f32_16x16x32_bf16 v[96:99], a[192:195], v[52:55], v[96:99]
 v_cvt_pk_bf16_f32 v40, v24, v25
 v_cvt_pk_bf16_f32 v41, v26, v27
 v_mfma_f32_16x16x32_bf16 v[100:103], a[164:167], v[48:51], v[100:103]
 v_mfma_f32_16x16x32_bf16 v[100:103], a[196:199], v[52:55], v[100:103]
 v_exp_f32 v29, v29
 v_mfma_f32_16x16x32_bf16 v[104:107], a[168:171], v[48:51], v[104:107]
 v_exp_f32 v30, v30
 v_mfma_f32_16x16x32_bf16 v[104:107], a[200:203], v[52:55], v[104:107]
 v_mfma_f32_16x16x32_bf16 v[108:111], a[172:175], v[48:51], v[108:111]
 v_exp_f32 v31, v31
 v_mfma_f32_16x16x32_bf16 v[108:111], a[204:207], v[52:55], v[108:111]
 v_mfma_f32_16x16x32_bf16 v[24:27], a[96:99], a[48:51], 0
 v_cvt_pk_bf16_f32 v42, v28, v29
 v_cvt_pk_bf16_f32 v43, v30, v31
 v_mfma_f32_16x16x32_bf16 v[24:27], a[100:103], a[52:55], v[24:27]
 v_exp_f32 v32, v32
 v_mfma_f32_16x16x32_bf16 v[24:27], a[104:107], a[56:59], v[24:27]
 v_exp_f32 v33, v33
 v_mfma_f32_16x16x32_bf16 v[24:27], a[108:111], a[60:63], v[24:27]
 v_exp_f32 v34, v34
 v_smfmac_f32_16x16x64_bf16 a[224:227], a[240:243], v[48:55], v2
 v_mfma_f32_16x16x32_bf16 v[28:31], a[124:127], a[60:63], 0
 v_exp_f32 v35, v35
 v_mfma_f32_16x16x32_bf16 v[28:31], a[120:123], a[56:59], v[28:31]
 v_exp_f32 v36, v36
 v_mfma_f32_16x16x32_bf16 v[28:31], a[116:119], a[52:55], v[28:31]
 s_add_u32 m0, s39, 32
 v_mfma_f32_16x16x32_bf16 v[28:31], a[112:115], a[48:51], v[28:31]
 buffer_load_dwordx4 v1, s[20:23], s33 offen offset:1024 nt lds
 v_mfma_f32_16x16x32_bf16 v[112:115], a[176:179], v[48:51], v[112:115]
 v_cvt_pk_bf16_f32 v44, v32, v33
 v_cvt_pk_bf16_f32 v45, v34, v35
 v_mfma_f32_16x16x32_bf16 v[112:115], a[208:211], v[52:55], v[112:115]
 v_exp_f32 v37, v37
 v_mfma_f32_16x16x32_bf16 v[116:119], a[180:183], v[48:51], v[116:119]
 v_mfma_f32_16x16x32_bf16 v[116:119], a[212:215], v[52:55], v[116:119]
 v_exp_f32 v38, v38
 v_mfma_f32_16x16x32_bf16 v[120:123], a[184:187], v[48:51], v[120:123]
 v_exp_f32 v39, v39
 v_mfma_f32_16x16x32_bf16 v[120:123], a[216:219], v[52:55], v[120:123]
 v_mfma_f32_16x16x32_bf16 v[124:127], a[188:191], v[48:51], v[124:127]
 v_cvt_pk_bf16_f32 v46, v36, v37
 v_cvt_pk_bf16_f32 v47, v38, v39
 v_mfma_f32_16x16x32_bf16 v[124:127], a[220:223], v[52:55], v[124:127]
 v_mfma_f32_16x16x32_bf16 v[32:35], a[128:131], a[48:51], 0
 v_exp_f32 v24, v24
 v_mfma_f32_16x16x32_bf16 v[32:35], a[132:135], a[52:55], v[32:35]
 v_mfma_f32_16x16x32_bf16 v[32:35], a[136:139], a[56:59], v[32:35]
 v_exp_f32 v25, v25
 v_mfma_f32_16x16x32_bf16 v[32:35], a[140:143], a[60:63], v[32:35]
 v_exp_f32 v26, v26
 v_mfma_f32_16x16x32_bf16 v[36:39], a[156:159], a[60:63], 0
 v_mfma_f32_16x16x32_bf16 v[36:39], a[152:155], a[56:59], v[36:39]
 v_exp_f32 v27, v27
 v_mfma_f32_16x16x32_bf16 v[36:39], a[148:151], a[52:55], v[36:39]
 v_exp_f32 v28, v28
 v_mfma_f32_16x16x32_bf16 v[36:39], a[144:147], a[48:51], v[36:39]
 v_mfma_f32_16x16x32_bf16 v[128:131], a[160:163], v[40:43], v[128:131]
 s_add_u32 m0, s39, 64
 v_cvt_pk_bf16_f32 v48, v24, v25
 v_cvt_pk_bf16_f32 v49, v26, v27
 v_mfma_f32_16x16x32_bf16 v[128:131], a[192:195], v[44:47], v[128:131]
 buffer_load_dwordx4 v1, s[20:23], s33 offen offset:2048 nt lds
 v_mfma_f32_16x16x32_bf16 v[132:135], a[164:167], v[40:43], v[132:135]
 v_exp_f32 v29, v29
 v_mfma_f32_16x16x32_bf16 v[132:135], a[196:199], v[44:47], v[132:135]
 v_exp_f32 v30, v30
 v_mfma_f32_16x16x32_bf16 v[136:139], a[168:171], v[40:43], v[136:139]
 v_mfma_f32_16x16x32_bf16 v[136:139], a[200:203], v[44:47], v[136:139]
 v_exp_f32 v31, v31
 v_mfma_f32_16x16x32_bf16 v[140:143], a[172:175], v[40:43], v[140:143]
 v_mfma_f32_16x16x32_bf16 v[140:143], a[204:207], v[44:47], v[140:143]
 v_cvt_pk_bf16_f32 v50, v28, v29
 v_cvt_pk_bf16_f32 v51, v30, v31
 v_mfma_f32_16x16x32_bf16 v[24:27], a[96:99], a[64:67], 0
 v_mfma_f32_16x16x32_bf16 v[24:27], a[100:103], a[68:71], v[24:27]
 v_exp_f32 v32, v32
 v_mfma_f32_16x16x32_bf16 v[24:27], a[104:107], a[72:75], v[24:27]
 v_exp_f32 v33, v33
 v_mfma_f32_16x16x32_bf16 v[24:27], a[108:111], a[76:79], v[24:27]
 v_exp_f32 v34, v34
 v_smfmac_f32_16x16x64_bf16 a[228:231], a[236:239], v[40:47], v2
 v_mfma_f32_16x16x32_bf16 v[28:31], a[124:127], a[76:79], 0
 v_exp_f32 v35, v35
 v_mfma_f32_16x16x32_bf16 v[28:31], a[120:123], a[72:75], v[28:31]
 v_mfma_f32_16x16x32_bf16 v[28:31], a[116:119], a[68:71], v[28:31]
 v_exp_f32 v36, v36
 v_mfma_f32_16x16x32_bf16 v[28:31], a[112:115], a[64:67], v[28:31]
 v_mfma_f32_16x16x32_bf16 v[144:147], a[176:179], v[40:43], v[144:147]
 s_add_u32 m0, s39, 96
 v_cvt_pk_bf16_f32 v52, v32, v33
 v_cvt_pk_bf16_f32 v53, v34, v35
 v_mfma_f32_16x16x32_bf16 v[144:147], a[208:211], v[44:47], v[144:147]
 buffer_load_dwordx4 v1, s[20:23], s33 offen offset:3072 nt lds
 v_mfma_f32_16x16x32_bf16 v[148:151], a[180:183], v[40:43], v[148:151]
 s_add_u32 s33, s33, 8192
 v_exp_f32 v37, v37
 v_mfma_f32_16x16x32_bf16 v[148:151], a[212:215], v[44:47], v[148:151]
 v_exp_f32 v38, v38
 v_mfma_f32_16x16x32_bf16 v[152:155], a[184:187], v[40:43], v[152:155]
 v_mfma_f32_16x16x32_bf16 v[152:155], a[216:219], v[44:47], v[152:155]
 s_mov_b32 s59, 10240
 v_exp_f32 v39, v39
 v_mfma_f32_16x16x32_bf16 v[156:159], a[188:191], v[40:43], v[156:159]
 s_add_u32 m0, s45, 6528
 v_cvt_pk_bf16_f32 v54, v36, v37
 v_cvt_pk_bf16_f32 v55, v38, v39
 v_mfma_f32_16x16x32_bf16 v[156:159], a[220:223], v[44:47], v[156:159]
 buffer_load_dwordx4 v1, s[28:31], s59 offen nt lds
 v_mfma_f32_16x16x32_bf16 v[32:35], a[128:131], a[64:67], 0
 v_mfma_f32_16x16x32_bf16 v[32:35], a[132:135], a[68:71], v[32:35]
 v_exp_f32 v24, v24
 v_mfma_f32_16x16x32_bf16 v[32:35], a[136:139], a[72:75], v[32:35]
 v_exp_f32 v25, v25
 v_mfma_f32_16x16x32_bf16 v[32:35], a[140:143], a[76:79], v[32:35]
 v_exp_f32 v26, v26
 v_mfma_f32_16x16x32_bf16 v[36:39], a[156:159], a[76:79], 0
 v_mfma_f32_16x16x32_bf16 v[36:39], a[152:155], a[72:75], v[36:39]
 v_exp_f32 v27, v27
 v_mfma_f32_16x16x32_bf16 v[36:39], a[148:151], a[68:71], v[36:39]
 v_exp_f32 v28, v28
 v_mfma_f32_16x16x32_bf16 v[36:39], a[144:147], a[64:67], v[36:39]
 v_mfma_f32_16x16x32_bf16 v[160:163], a[160:163], v[48:51], v[160:163]
 v_cvt_pk_bf16_f32 v40, v24, v25
 v_cvt_pk_bf16_f32 v41, v26, v27
 v_mfma_f32_16x16x32_bf16 v[160:163], a[192:195], v[52:55], v[160:163]
 v_mfma_f32_16x16x32_bf16 v[164:167], a[164:167], v[48:51], v[164:167]
 s_add_u32 m0, s39, 16896
 v_exp_f32 v29, v29
 v_mfma_f32_16x16x32_bf16 v[164:167], a[196:199], v[52:55], v[164:167]
 buffer_load_dwordx4 v1, s[20:23], s33 offen nt lds
 v_mfma_f32_16x16x32_bf16 v[168:171], a[168:171], v[48:51], v[168:171]
 v_exp_f32 v30, v30
 v_mfma_f32_16x16x32_bf16 v[168:171], a[200:203], v[52:55], v[168:171]
 v_exp_f32 v31, v31
 v_mfma_f32_16x16x32_bf16 v[172:175], a[172:175], v[48:51], v[172:175]
 v_mfma_f32_16x16x32_bf16 v[172:175], a[204:207], v[52:55], v[172:175]
 v_cvt_pk_bf16_f32 v42, v28, v29
 v_cvt_pk_bf16_f32 v43, v30, v31
 v_mfma_f32_16x16x32_bf16 v[24:27], a[96:99], a[80:83], 0
 v_mfma_f32_16x16x32_bf16 v[24:27], a[100:103], a[84:87], v[24:27]
 v_exp_f32 v32, v32
 v_mfma_f32_16x16x32_bf16 v[24:27], a[104:107], a[88:91], v[24:27]
 v_mfma_f32_16x16x32_bf16 v[24:27], a[108:111], a[92:95], v[24:27]
 v_exp_f32 v33, v33
 v_smfmac_f32_16x16x64_bf16 a[228:231], a[240:243], v[48:55], v2
 v_mfma_f32_16x16x32_bf16 v[28:31], a[124:127], a[92:95], 0
 v_exp_f32 v34, v34
 v_mfma_f32_16x16x32_bf16 v[28:31], a[120:123], a[88:91], v[28:31]
 v_exp_f32 v35, v35
 v_mfma_f32_16x16x32_bf16 v[28:31], a[116:119], a[84:87], v[28:31]
 v_exp_f32 v36, v36
 v_mfma_f32_16x16x32_bf16 v[28:31], a[112:115], a[80:83], v[28:31]
 s_waitcnt vmcnt(9)
 s_barrier
 v_mfma_f32_16x16x32_bf16 v[176:179], a[176:179], v[48:51], v[176:179]
 v_cvt_pk_bf16_f32 v44, v32, v33
 v_cvt_pk_bf16_f32 v45, v34, v35
 v_mfma_f32_16x16x32_bf16 v[176:179], a[208:211], v[52:55], v[176:179]
 v_exp_f32 v37, v37
 v_mfma_f32_16x16x32_bf16 v[180:183], a[180:183], v[48:51], v[180:183]
 s_add_u32 m0, s39, 16928
 ds_read_b128 a[96:99], v7 offset:33792
 ds_read_b128 a[100:103], v7 offset:33856
 v_mfma_f32_16x16x32_bf16 v[180:183], a[212:215], v[52:55], v[180:183]
 buffer_load_dwordx4 v1, s[20:23], s33 offen offset:1024 nt lds
 v_mfma_f32_16x16x32_bf16 v[184:187], a[184:187], v[48:51], v[184:187]
 v_exp_f32 v38, v38
 v_mfma_f32_16x16x32_bf16 v[184:187], a[216:219], v[52:55], v[184:187]
 v_exp_f32 v39, v39
 v_mfma_f32_16x16x32_bf16 v[188:191], a[188:191], v[48:51], v[188:191]
 ds_read_b128 a[104:107], v7 offset:33920
 ds_read_b128 a[108:111], v7 offset:33984
 v_mfma_f32_16x16x32_bf16 v[188:191], a[220:223], v[52:55], v[188:191]
 v_cvt_pk_bf16_f32 v46, v36, v37
 v_cvt_pk_bf16_f32 v47, v38, v39
 v_mfma_f32_16x16x32_bf16 v[32:35], a[128:131], a[80:83], 0
 v_mfma_f32_16x16x32_bf16 v[32:35], a[132:135], a[84:87], v[32:35]
 v_exp_f32 v24, v24
 v_mfma_f32_16x16x32_bf16 v[32:35], a[136:139], a[88:91], v[32:35]
 ds_read_b128 a[124:127], v7 offset:34496
 ds_read_b128 a[120:123], v7 offset:34432
 v_mfma_f32_16x16x32_bf16 v[32:35], a[140:143], a[92:95], v[32:35]
 v_exp_f32 v25, v25
 v_mfma_f32_16x16x32_bf16 v[36:39], a[156:159], a[92:95], 0
 v_exp_f32 v26, v26
 v_mfma_f32_16x16x32_bf16 v[36:39], a[152:155], a[88:91], v[36:39]
 v_exp_f32 v27, v27
 v_mfma_f32_16x16x32_bf16 v[36:39], a[148:151], a[84:87], v[36:39]
 ds_read_b128 a[116:119], v7 offset:34368
 ds_read_b128 a[112:115], v7 offset:34304
 v_mfma_f32_16x16x32_bf16 v[36:39], a[144:147], a[80:83], v[36:39]
 v_exp_f32 v28, v28
 v_mfma_f32_16x16x32_bf16 v[192:195], a[160:163], v[40:43], v[192:195]
 v_mfma_f32_16x16x32_bf16 v[192:195], a[192:195], v[44:47], v[192:195]
 v_cvt_pk_bf16_f32 v48, v24, v25
 v_cvt_pk_bf16_f32 v49, v26, v27
 v_mfma_f32_16x16x32_bf16 v[196:199], a[164:167], v[40:43], v[196:199]
 v_exp_f32 v29, v29
 v_mfma_f32_16x16x32_bf16 v[196:199], a[196:199], v[44:47], v[196:199]
 ds_read_b128 a[128:131], v7 offset:50688
 ds_read_b128 a[132:135], v7 offset:50752
 v_mfma_f32_16x16x32_bf16 v[200:203], a[168:171], v[40:43], v[200:203]
 s_add_u32 m0, s39, 16960
 v_exp_f32 v30, v30
 v_mfma_f32_16x16x32_bf16 v[200:203], a[200:203], v[44:47], v[200:203]
 buffer_load_dwordx4 v1, s[20:23], s33 offen offset:2048 nt lds
 v_mfma_f32_16x16x32_bf16 v[204:207], a[172:175], v[40:43], v[204:207]
 v_exp_f32 v31, v31
 v_mfma_f32_16x16x32_bf16 v[204:207], a[204:207], v[44:47], v[204:207]
 s_waitcnt lgkmcnt(6)
 ds_read_b128 a[136:139], v7 offset:50816
 ds_read_b128 a[140:143], v7 offset:50880
 v_mfma_f32_16x16x32_bf16 v[24:27], a[96:99], a[0:3], 0
 v_cvt_pk_bf16_f32 v50, v28, v29
 v_cvt_pk_bf16_f32 v51, v30, v31
 v_mfma_f32_16x16x32_bf16 v[24:27], a[100:103], a[4:7], v[24:27]
 v_exp_f32 v32, v32
 v_mfma_f32_16x16x32_bf16 v[24:27], a[104:107], a[8:11], v[24:27]
 v_exp_f32 v33, v33
 v_mfma_f32_16x16x32_bf16 v[24:27], a[108:111], a[12:15], v[24:27]
 s_waitcnt lgkmcnt(4)
 ds_read_b128 a[156:159], v7 offset:51392
 ds_read_b128 a[152:155], v7 offset:51328
 v_smfmac_f32_16x16x64_bf16 a[232:235], a[236:239], v[40:47], v2
 v_mfma_f32_16x16x32_bf16 v[28:31], a[124:127], a[12:15], 0
 v_exp_f32 v34, v34
 v_mfma_f32_16x16x32_bf16 v[28:31], a[120:123], a[8:11], v[28:31]
 v_exp_f32 v35, v35
 v_mfma_f32_16x16x32_bf16 v[28:31], a[116:119], a[4:7], v[28:31]
 ds_read_b128 a[148:151], v7 offset:51264
 ds_read_b128 a[144:147], v7 offset:51200
 v_mfma_f32_16x16x32_bf16 v[28:31], a[112:115], a[0:3], v[28:31]
 v_exp_f32 v36, v36
 v_mfma_f32_16x16x32_bf16 v[208:211], a[176:179], v[40:43], v[208:211]
 v_cvt_pk_bf16_f32 v52, v32, v33
 v_cvt_pk_bf16_f32 v53, v34, v35
 v_mfma_f32_16x16x32_bf16 v[208:211], a[208:211], v[44:47], v[208:211]
 v_exp_f32 v37, v37
 v_mfma_f32_16x16x32_bf16 v[212:215], a[180:183], v[40:43], v[212:215]
 s_add_u32 m0, s39, 16992
 v_exp_f32 v38, v38
 v_mfma_f32_16x16x32_bf16 v[212:215], a[212:215], v[44:47], v[212:215]
 buffer_load_dwordx4 v1, s[20:23], s33 offen offset:3072 nt lds
 v_mfma_f32_16x16x32_bf16 v[216:219], a[184:187], v[40:43], v[216:219]
 s_add_u32 s33, s33, 8192
 v_exp_f32 v39, v39
 v_mfma_f32_16x16x32_bf16 v[216:219], a[216:219], v[44:47], v[216:219]
 s_mov_b32 s59, 11264
 v_mfma_f32_16x16x32_bf16 v[220:223], a[188:191], v[40:43], v[220:223]
 s_add_u32 m0, s45, 7616
 v_cvt_pk_bf16_f32 v54, v36, v37
 v_cvt_pk_bf16_f32 v55, v38, v39
 v_mfma_f32_16x16x32_bf16 v[220:223], a[220:223], v[44:47], v[220:223]
 s_waitcnt lgkmcnt(4)
 buffer_load_dwordx4 v1, s[28:31], s59 offen nt lds
 v_mfma_f32_16x16x32_bf16 v[32:35], a[128:131], a[0:3], 0
 v_exp_f32 v24, v24
 v_mfma_f32_16x16x32_bf16 v[32:35], a[132:135], a[4:7], v[32:35]
 v_mfma_f32_16x16x32_bf16 v[32:35], a[136:139], a[8:11], v[32:35]
 v_exp_f32 v25, v25
 v_mfma_f32_16x16x32_bf16 v[32:35], a[140:143], a[12:15], v[32:35]
 s_waitcnt lgkmcnt(0)
 v_exp_f32 v26, v26
 v_mfma_f32_16x16x32_bf16 v[36:39], a[156:159], a[12:15], 0
 v_mfma_f32_16x16x32_bf16 v[36:39], a[152:155], a[8:11], v[36:39]
 v_exp_f32 v27, v27
 v_mfma_f32_16x16x32_bf16 v[36:39], a[148:151], a[4:7], v[36:39]
 v_exp_f32 v28, v28
 v_mfma_f32_16x16x32_bf16 v[36:39], a[144:147], a[0:3], v[36:39]
 v_cvt_pk_bf16_f32 v40, v24, v25
 v_cvt_pk_bf16_f32 v41, v26, v27
 v_mfma_f32_16x16x32_bf16 v[224:227], a[160:163], v[48:51], v[224:227]
 v_exp_f32 v29, v29
 v_mfma_f32_16x16x32_bf16 v[224:227], a[192:195], v[52:55], v[224:227]
 v_exp_f32 v30, v30
 v_mfma_f32_16x16x32_bf16 v[228:231], a[164:167], v[48:51], v[228:231]
 ds_read_b64_tr_b16 a[160:161], v8 offset:33792
 ds_read_b64_tr_b16 a[162:163], v8 offset:34304
 v_mfma_f32_16x16x32_bf16 v[228:231], a[196:199], v[52:55], v[228:231]
 v_exp_f32 v31, v31
 v_mfma_f32_16x16x32_bf16 v[232:235], a[168:171], v[48:51], v[232:235]
 ds_read_b64_tr_b16 a[192:193], v8 offset:50688
 ds_read_b64_tr_b16 a[194:195], v8 offset:51200
 v_mfma_f32_16x16x32_bf16 v[232:235], a[200:203], v[52:55], v[232:235]
 v_cvt_pk_bf16_f32 v42, v28, v29
 v_cvt_pk_bf16_f32 v43, v30, v31
 v_mfma_f32_16x16x32_bf16 v[236:239], a[172:175], v[48:51], v[236:239]
 v_exp_f32 v32, v32
 v_mfma_f32_16x16x32_bf16 v[236:239], a[204:207], v[52:55], v[236:239]
 ds_read_b64_tr_b16 a[164:165], v8 offset:33824
 ds_read_b64_tr_b16 a[166:167], v8 offset:34336
 v_mfma_f32_16x16x32_bf16 v[24:27], a[96:99], a[16:19], 0
 v_exp_f32 v33, v33
 v_mfma_f32_16x16x32_bf16 v[24:27], a[100:103], a[20:23], v[24:27]
 ds_read_b64_tr_b16 a[196:197], v8 offset:50720
 ds_read_b64_tr_b16 a[198:199], v8 offset:51232
 v_mfma_f32_16x16x32_bf16 v[24:27], a[104:107], a[24:27], v[24:27]
 v_exp_f32 v34, v34
 v_mfma_f32_16x16x32_bf16 v[24:27], a[108:111], a[28:31], v[24:27]
 ds_read_b64_tr_b16 a[168:169], v8 offset:33856
 ds_read_b64_tr_b16 a[170:171], v8 offset:34368
 v_smfmac_f32_16x16x64_bf16 a[232:235], a[240:243], v[48:55], v2
 v_mfma_f32_16x16x32_bf16 v[28:31], a[124:127], a[28:31], 0
 ds_read_b64_tr_b16 a[200:201], v8 offset:50752
 ds_read_b64_tr_b16 a[202:203], v8 offset:51264
 v_mfma_f32_16x16x32_bf16 v[28:31], a[120:123], a[24:27], v[28:31]
 v_exp_f32 v35, v35
 v_mfma_f32_16x16x32_bf16 v[28:31], a[116:119], a[20:23], v[28:31]
 v_exp_f32 v36, v36
 v_mfma_f32_16x16x32_bf16 v[28:31], a[112:115], a[16:19], v[28:31]
 ds_read_b64_tr_b16 a[172:173], v8 offset:33888
 ds_read_b64_tr_b16 a[174:175], v8 offset:34400
 v_mfma_f32_16x16x32_bf16 v[240:243], a[176:179], v[48:51], v[240:243]
 v_cvt_pk_bf16_f32 v44, v32, v33
 v_cvt_pk_bf16_f32 v45, v34, v35
 v_mfma_f32_16x16x32_bf16 v[240:243], a[208:211], v[52:55], v[240:243]
 ds_read_b64_tr_b16 a[204:205], v8 offset:50784
 ds_read_b64_tr_b16 a[206:207], v8 offset:51296
 v_mfma_f32_16x16x32_bf16 v[244:247], a[180:183], v[48:51], v[244:247]
 v_exp_f32 v37, v37
 v_mfma_f32_16x16x32_bf16 v[244:247], a[212:215], v[52:55], v[244:247]
 v_exp_f32 v38, v38
 v_mfma_f32_16x16x32_bf16 v[248:251], a[184:187], v[48:51], v[248:251]
 v_exp_f32 v39, v39
 v_mfma_f32_16x16x32_bf16 v[248:251], a[216:219], v[52:55], v[248:251]
 s_mov_b32 s59, 12288
 ds_read_b64_tr_b16 a[176:177], v8 offset:33920
 ds_read_b64_tr_b16 a[178:179], v8 offset:34432
 v_mfma_f32_16x16x32_bf16 v[252:255], a[188:191], v[48:51], v[252:255]
 s_add_u32 m0, s45, 8704
 v_cvt_pk_bf16_f32 v46, v36, v37
 v_cvt_pk_bf16_f32 v47, v38, v39
 v_mfma_f32_16x16x32_bf16 v[252:255], a[220:223], v[52:55], v[252:255]
 buffer_load_dwordx4 v1, s[28:31], s59 offen nt lds
 v_mfma_f32_16x16x32_bf16 v[32:35], a[128:131], a[16:19], 0
 ds_read_b64_tr_b16 a[208:209], v8 offset:50816
 ds_read_b64_tr_b16 a[210:211], v8 offset:51328
 v_mfma_f32_16x16x32_bf16 v[32:35], a[132:135], a[20:23], v[32:35]
 v_exp_f32 v24, v24
 v_mfma_f32_16x16x32_bf16 v[32:35], a[136:139], a[24:27], v[32:35]
 v_exp_f32 v25, v25
 v_mfma_f32_16x16x32_bf16 v[32:35], a[140:143], a[28:31], v[32:35]
 ds_read_b64_tr_b16 a[180:181], v8 offset:33952
 ds_read_b64_tr_b16 a[182:183], v8 offset:34464
 v_mfma_f32_16x16x32_bf16 v[36:39], a[156:159], a[28:31], 0
 v_exp_f32 v26, v26
 v_mfma_f32_16x16x32_bf16 v[36:39], a[152:155], a[24:27], v[36:39]
 v_exp_f32 v27, v27
 v_mfma_f32_16x16x32_bf16 v[36:39], a[148:151], a[20:23], v[36:39]
 ds_read_b64_tr_b16 a[212:213], v8 offset:50848
 ds_read_b64_tr_b16 a[214:215], v8 offset:51360
 v_mfma_f32_16x16x32_bf16 v[36:39], a[144:147], a[16:19], v[36:39]
 s_waitcnt lgkmcnt(15)
 v_exp_f32 v28, v28
 v_mfma_f32_16x16x32_bf16 v[64:67], a[160:163], v[40:43], v[64:67]
 v_cvt_pk_bf16_f32 v48, v24, v25
 v_cvt_pk_bf16_f32 v49, v26, v27
 v_mfma_f32_16x16x32_bf16 v[64:67], a[192:195], v[44:47], v[64:67]
 ds_read_b64_tr_b16 a[184:185], v8 offset:33984
 ds_read_b64_tr_b16 a[186:187], v8 offset:34496
 v_mfma_f32_16x16x32_bf16 v[68:71], a[164:167], v[40:43], v[68:71]
 v_exp_f32 v29, v29
 v_mfma_f32_16x16x32_bf16 v[68:71], a[196:199], v[44:47], v[68:71]
 s_waitcnt lgkmcnt(10)
 v_exp_f32 v30, v30
 v_mfma_f32_16x16x32_bf16 v[72:75], a[168:171], v[40:43], v[72:75]
 ds_read_b64_tr_b16 a[216:217], v8 offset:50880
 ds_read_b64_tr_b16 a[218:219], v8 offset:51392
 v_mfma_f32_16x16x32_bf16 v[72:75], a[200:203], v[44:47], v[72:75]
 v_exp_f32 v31, v31
 v_mfma_f32_16x16x32_bf16 v[76:79], a[172:175], v[40:43], v[76:79]
 v_mfma_f32_16x16x32_bf16 v[76:79], a[204:207], v[44:47], v[76:79]
 ds_read_b64_tr_b16 a[188:189], v8 offset:34016
 ds_read_b64_tr_b16 a[190:191], v8 offset:34528
 v_mfma_f32_16x16x32_bf16 v[24:27], a[96:99], a[32:35], 0
 v_cvt_pk_bf16_f32 v50, v28, v29
 v_cvt_pk_bf16_f32 v51, v30, v31
 v_mfma_f32_16x16x32_bf16 v[24:27], a[100:103], a[36:39], v[24:27]
 v_exp_f32 v32, v32
 v_mfma_f32_16x16x32_bf16 v[24:27], a[104:107], a[40:43], v[24:27]
 ds_read_b64_tr_b16 a[220:221], v8 offset:50912
 ds_read_b64_tr_b16 a[222:223], v8 offset:51424
 v_mfma_f32_16x16x32_bf16 v[24:27], a[108:111], a[44:47], v[24:27]
 v_exp_f32 v33, v33
 v_smfmac_f32_16x16x64_bf16 a[224:227], a[236:239], v[40:47], v2
 v_mfma_f32_16x16x32_bf16 v[28:31], a[124:127], a[44:47], 0
 v_exp_f32 v34, v34
 v_mfma_f32_16x16x32_bf16 v[28:31], a[120:123], a[40:43], v[28:31]
 v_exp_f32 v35, v35
 v_mfma_f32_16x16x32_bf16 v[28:31], a[116:119], a[36:39], v[28:31]
 v_exp_f32 v36, v36
 v_mfma_f32_16x16x32_bf16 v[28:31], a[112:115], a[32:35], v[28:31]
 s_waitcnt lgkmcnt(8)
 v_mfma_f32_16x16x32_bf16 v[80:83], a[176:179], v[40:43], v[80:83]
 v_cvt_pk_bf16_f32 v52, v32, v33
 v_cvt_pk_bf16_f32 v53, v34, v35
 v_mfma_f32_16x16x32_bf16 v[80:83], a[208:211], v[44:47], v[80:83]
 v_mfma_f32_16x16x32_bf16 v[84:87], a[180:183], v[40:43], v[84:87]
 v_exp_f32 v37, v37
 v_mfma_f32_16x16x32_bf16 v[84:87], a[212:215], v[44:47], v[84:87]
 s_waitcnt lgkmcnt(0)
 s_barrier
 v_mfma_f32_16x16x32_bf16 v[88:91], a[184:187], v[40:43], v[88:91]
 v_exp_f32 v38, v38
 v_mfma_f32_16x16x32_bf16 v[88:91], a[216:219], v[44:47], v[88:91]
 s_mov_b32 s59, 13312
 v_exp_f32 v39, v39
 v_mfma_f32_16x16x32_bf16 v[92:95], a[188:191], v[40:43], v[92:95]
 s_add_u32 m0, s45, 9792
 v_cvt_pk_bf16_f32 v54, v36, v37
 v_cvt_pk_bf16_f32 v55, v38, v39
 v_mfma_f32_16x16x32_bf16 v[92:95], a[220:223], v[44:47], v[92:95]
 buffer_load_dwordx4 v1, s[28:31], s59 offen nt lds
 v_mfma_f32_16x16x32_bf16 v[32:35], a[128:131], a[32:35], 0
 v_mfma_f32_16x16x32_bf16 v[32:35], a[132:135], a[36:39], v[32:35]
 v_exp_f32 v24, v24
 v_mfma_f32_16x16x32_bf16 v[32:35], a[136:139], a[40:43], v[32:35]
 v_exp_f32 v25, v25
 v_mfma_f32_16x16x32_bf16 v[32:35], a[140:143], a[44:47], v[32:35]
 v_mfma_f32_16x16x32_bf16 v[36:39], a[156:159], a[44:47], 0
 v_exp_f32 v26, v26
 v_mfma_f32_16x16x32_bf16 v[36:39], a[152:155], a[40:43], v[36:39]
 v_exp_f32 v27, v27
 v_mfma_f32_16x16x32_bf16 v[36:39], a[148:151], a[36:39], v[36:39]
 s_add_u32 m0, s39, 33792
 v_exp_f32 v28, v28
 v_mfma_f32_16x16x32_bf16 v[36:39], a[144:147], a[32:35], v[36:39]
 buffer_load_dwordx4 v1, s[20:23], s33 offen nt lds
 v_mfma_f32_16x16x32_bf16 v[96:99], a[160:163], v[48:51], v[96:99]
 v_mfma_f32_16x16x32_bf16 v[96:99], a[192:195], v[52:55], v[96:99]
 v_cvt_pk_bf16_f32 v40, v24, v25
 v_cvt_pk_bf16_f32 v41, v26, v27
 v_mfma_f32_16x16x32_bf16 v[100:103], a[164:167], v[48:51], v[100:103]
 v_mfma_f32_16x16x32_bf16 v[100:103], a[196:199], v[52:55], v[100:103]
 v_exp_f32 v29, v29
 v_mfma_f32_16x16x32_bf16 v[104:107], a[168:171], v[48:51], v[104:107]
 v_exp_f32 v30, v30
 v_mfma_f32_16x16x32_bf16 v[104:107], a[200:203], v[52:55], v[104:107]
 v_mfma_f32_16x16x32_bf16 v[108:111], a[172:175], v[48:51], v[108:111]
 v_exp_f32 v31, v31
 v_mfma_f32_16x16x32_bf16 v[108:111], a[204:207], v[52:55], v[108:111]
 v_mfma_f32_16x16x32_bf16 v[24:27], a[96:99], a[48:51], 0
 v_cvt_pk_bf16_f32 v42, v28, v29
 v_cvt_pk_bf16_f32 v43, v30, v31
 v_mfma_f32_16x16x32_bf16 v[24:27], a[100:103], a[52:55], v[24:27]
 v_exp_f32 v32, v32
 v_mfma_f32_16x16x32_bf16 v[24:27], a[104:107], a[56:59], v[24:27]
 v_exp_f32 v33, v33
 v_mfma_f32_16x16x32_bf16 v[24:27], a[108:111], a[60:63], v[24:27]
 v_exp_f32 v34, v34
 v_smfmac_f32_16x16x64_bf16 a[224:227], a[240:243], v[48:55], v2
 v_mfma_f32_16x16x32_bf16 v[28:31], a[124:127], a[60:63], 0
 v_exp_f32 v35, v35
 v_mfma_f32_16x16x32_bf16 v[28:31], a[120:123], a[56:59], v[28:31]
 v_exp_f32 v36, v36
 v_mfma_f32_16x16x32_bf16 v[28:31], a[116:119], a[52:55], v[28:31]
 s_add_u32 m0, s39, 33824
 v_mfma_f32_16x16x32_bf16 v[28:31], a[112:115], a[48:51], v[28:31]
 buffer_load_dwordx4 v1, s[20:23], s33 offen offset:1024 nt lds
 v_mfma_f32_16x16x32_bf16 v[112:115], a[176:179], v[48:51], v[112:115]
 v_cvt_pk_bf16_f32 v44, v32, v33
 v_cvt_pk_bf16_f32 v45, v34, v35
 v_mfma_f32_16x16x32_bf16 v[112:115], a[208:211], v[52:55], v[112:115]
 v_exp_f32 v37, v37
 v_mfma_f32_16x16x32_bf16 v[116:119], a[180:183], v[48:51], v[116:119]
 v_mfma_f32_16x16x32_bf16 v[116:119], a[212:215], v[52:55], v[116:119]
 v_exp_f32 v38, v38
 v_mfma_f32_16x16x32_bf16 v[120:123], a[184:187], v[48:51], v[120:123]
 v_exp_f32 v39, v39
 v_mfma_f32_16x16x32_bf16 v[120:123], a[216:219], v[52:55], v[120:123]
 v_mfma_f32_16x16x32_bf16 v[124:127], a[188:191], v[48:51], v[124:127]
 v_cvt_pk_bf16_f32 v46, v36, v37
 v_cvt_pk_bf16_f32 v47, v38, v39
 v_mfma_f32_16x16x32_bf16 v[124:127], a[220:223], v[52:55], v[124:127]
 v_mfma_f32_16x16x32_bf16 v[32:35], a[128:131], a[48:51], 0
 v_exp_f32 v24, v24
 v_mfma_f32_16x16x32_bf16 v[32:35], a[132:135], a[52:55], v[32:35]
 v_mfma_f32_16x16x32_bf16 v[32:35], a[136:139], a[56:59], v[32:35]
 v_exp_f32 v25, v25
 v_mfma_f32_16x16x32_bf16 v[32:35], a[140:143], a[60:63], v[32:35]
 v_exp_f32 v26, v26
 v_mfma_f32_16x16x32_bf16 v[36:39], a[156:159], a[60:63], 0
 v_mfma_f32_16x16x32_bf16 v[36:39], a[152:155], a[56:59], v[36:39]
 v_exp_f32 v27, v27
 v_mfma_f32_16x16x32_bf16 v[36:39], a[148:151], a[52:55], v[36:39]
 v_exp_f32 v28, v28
 v_mfma_f32_16x16x32_bf16 v[36:39], a[144:147], a[48:51], v[36:39]
L_pg1_4:
 s_cbranch_execz L_pg1_8
 v_mfma_f32_16x16x32_bf16 v[128:131], a[160:163], v[40:43], v[128:131]
 s_add_u32 m0, s39, 33856
 v_cvt_pk_bf16_f32 v48, v24, v25
 v_cvt_pk_bf16_f32 v49, v26, v27
 v_mfma_f32_16x16x32_bf16 v[128:131], a[192:195], v[44:47], v[128:131]
 buffer_load_dwordx4 v1, s[20:23], s33 offen offset:2048 nt lds
 v_mfma_f32_16x16x32_bf16 v[132:135], a[164:167], v[40:43], v[132:135]
 v_exp_f32 v29, v29
 v_mfma_f32_16x16x32_bf16 v[132:135], a[196:199], v[44:47], v[132:135]
 v_exp_f32 v30, v30
 v_mfma_f32_16x16x32_bf16 v[136:139], a[168:171], v[40:43], v[136:139]
 v_mfma_f32_16x16x32_bf16 v[136:139], a[200:203], v[44:47], v[136:139]
 v_exp_f32 v31, v31
 v_mfma_f32_16x16x32_bf16 v[140:143], a[172:175], v[40:43], v[140:143]
 v_mfma_f32_16x16x32_bf16 v[140:143], a[204:207], v[44:47], v[140:143]
 v_cvt_pk_bf16_f32 v50, v28, v29
 v_cvt_pk_bf16_f32 v51, v30, v31
 v_mfma_f32_16x16x32_bf16 v[24:27], a[96:99], a[64:67], 0
 v_mfma_f32_16x16x32_bf16 v[24:27], a[100:103], a[68:71], v[24:27]
 v_exp_f32 v32, v32
 v_mfma_f32_16x16x32_bf16 v[24:27], a[104:107], a[72:75], v[24:27]
 v_exp_f32 v33, v33
 v_mfma_f32_16x16x32_bf16 v[24:27], a[108:111], a[76:79], v[24:27]
 v_exp_f32 v34, v34
 v_smfmac_f32_16x16x64_bf16 a[228:231], a[236:239], v[40:47], v2
 v_mfma_f32_16x16x32_bf16 v[28:31], a[124:127], a[76:79], 0
 v_exp_f32 v35, v35
 v_mfma_f32_16x16x32_bf16 v[28:31], a[120:123], a[72:75], v[28:31]
 v_mfma_f32_16x16x32_bf16 v[28:31], a[116:119], a[68:71], v[28:31]
 v_exp_f32 v36, v36
 v_mfma_f32_16x16x32_bf16 v[28:31], a[112:115], a[64:67], v[28:31]
 v_mfma_f32_16x16x32_bf16 v[144:147], a[176:179], v[40:43], v[144:147]
 s_add_u32 m0, s39, 33888
 v_cvt_pk_bf16_f32 v52, v32, v33
 v_cvt_pk_bf16_f32 v53, v34, v35
 v_mfma_f32_16x16x32_bf16 v[144:147], a[208:211], v[44:47], v[144:147]
 buffer_load_dwordx4 v1, s[20:23], s33 offen offset:3072 nt lds
 v_mfma_f32_16x16x32_bf16 v[148:151], a[180:183], v[40:43], v[148:151]
 s_add_u32 s33, s33, 8192
 v_exp_f32 v37, v37
 v_mfma_f32_16x16x32_bf16 v[148:151], a[212:215], v[44:47], v[148:151]
 v_exp_f32 v38, v38
 v_mfma_f32_16x16x32_bf16 v[152:155], a[184:187], v[40:43], v[152:155]
 v_mfma_f32_16x16x32_bf16 v[152:155], a[216:219], v[44:47], v[152:155]
 s_mov_b32 s59, 14336
 v_exp_f32 v39, v39
 v_mfma_f32_16x16x32_bf16 v[156:159], a[188:191], v[40:43], v[156:159]
 s_add_u32 m0, s45, 10880
 v_cvt_pk_bf16_f32 v54, v36, v37
 v_cvt_pk_bf16_f32 v55, v38, v39
 v_mfma_f32_16x16x32_bf16 v[156:159], a[220:223], v[44:47], v[156:159]
 buffer_load_dwordx4 v1, s[28:31], s59 offen nt lds
 v_mfma_f32_16x16x32_bf16 v[32:35], a[128:131], a[64:67], 0
 v_mfma_f32_16x16x32_bf16 v[32:35], a[132:135], a[68:71], v[32:35]
 v_exp_f32 v24, v24
 v_mfma_f32_16x16x32_bf16 v[32:35], a[136:139], a[72:75], v[32:35]
 v_exp_f32 v25, v25
 v_mfma_f32_16x16x32_bf16 v[32:35], a[140:143], a[76:79], v[32:35]
 v_exp_f32 v26, v26
 v_mfma_f32_16x16x32_bf16 v[36:39], a[156:159], a[76:79], 0
 v_mfma_f32_16x16x32_bf16 v[36:39], a[152:155], a[72:75], v[36:39]
 v_exp_f32 v27, v27
 v_mfma_f32_16x16x32_bf16 v[36:39], a[148:151], a[68:71], v[36:39]
 v_exp_f32 v28, v28
 v_mfma_f32_16x16x32_bf16 v[36:39], a[144:147], a[64:67], v[36:39]
 v_mfma_f32_16x16x32_bf16 v[160:163], a[160:163], v[48:51], v[160:163]
 v_cvt_pk_bf16_f32 v40, v24, v25
 v_cvt_pk_bf16_f32 v41, v26, v27
 v_mfma_f32_16x16x32_bf16 v[160:163], a[192:195], v[52:55], v[160:163]
 v_mfma_f32_16x16x32_bf16 v[164:167], a[164:167], v[48:51], v[164:167]
 s_add_u32 m0, s39, 50688
 v_exp_f32 v29, v29
 v_mfma_f32_16x16x32_bf16 v[164:167], a[196:199], v[52:55], v[164:167]
 buffer_load_dwordx4 v1, s[20:23], s33 offen nt lds
 v_mfma_f32_16x16x32_bf16 v[168:171], a[168:171], v[48:51], v[168:171]
 v_exp_f32 v30, v30
 v_mfma_f32_16x16x32_bf16 v[168:171], a[200:203], v[52:55], v[168:171]
 v_exp_f32 v31, v31
 v_mfma_f32_16x16x32_bf16 v[172:175], a[172:175], v[48:51], v[172:175]
 v_mfma_f32_16x16x32_bf16 v[172:175], a[204:207], v[52:55], v[172:175]
 v_cvt_pk_bf16_f32 v42, v28, v29
 v_cvt_pk_bf16_f32 v43, v30, v31
 v_mfma_f32_16x16x32_bf16 v[24:27], a[96:99], a[80:83], 0
 v_mfma_f32_16x16x32_bf16 v[24:27], a[100:103], a[84:87], v[24:27]
 v_exp_f32 v32, v32
 v_mfma_f32_16x16x32_bf16 v[24:27], a[104:107], a[88:91], v[24:27]
 v_mfma_f32_16x16x32_bf16 v[24:27], a[108:111], a[92:95], v[24:27]
 v_exp_f32 v33, v33
 v_smfmac_f32_16x16x64_bf16 a[228:231], a[240:243], v[48:55], v2
 v_mfma_f32_16x16x32_bf16 v[28:31], a[124:127], a[92:95], 0
 v_exp_f32 v34, v34
 v_mfma_f32_16x16x32_bf16 v[28:31], a[120:123], a[88:91], v[28:31]
 v_exp_f32 v35, v35
 v_mfma_f32_16x16x32_bf16 v[28:31], a[116:119], a[84:87], v[28:31]
 v_exp_f32 v36, v36
 v_mfma_f32_16x16x32_bf16 v[28:31], a[112:115], a[80:83], v[28:31]
 s_waitcnt vmcnt(9)
 s_barrier
 v_mfma_f32_16x16x32_bf16 v[176:179], a[176:179], v[48:51], v[176:179]
 v_cvt_pk_bf16_f32 v44, v32, v33
 v_cvt_pk_bf16_f32 v45, v34, v35
 v_mfma_f32_16x16x32_bf16 v[176:179], a[208:211], v[52:55], v[176:179]
 v_exp_f32 v37, v37
 v_mfma_f32_16x16x32_bf16 v[180:183], a[180:183], v[48:51], v[180:183]
 s_add_u32 m0, s39, 50720
 ds_read_b128 a[96:99], v7 offset:0
 ds_read_b128 a[100:103], v7 offset:64
 v_mfma_f32_16x16x32_bf16 v[180:183], a[212:215], v[52:55], v[180:183]
 buffer_load_dwordx4 v1, s[20:23], s33 offen offset:1024 nt lds
 v_mfma_f32_16x16x32_bf16 v[184:187], a[184:187], v[48:51], v[184:187]
 v_exp_f32 v38, v38
 v_mfma_f32_16x16x32_bf16 v[184:187], a[216:219], v[52:55], v[184:187]
 v_exp_f32 v39, v39
 v_mfma_f32_16x16x32_bf16 v[188:191], a[188:191], v[48:51], v[188:191]
 ds_read_b128 a[104:107], v7 offset:128
 ds_read_b128 a[108:111], v7 offset:192
 v_mfma_f32_16x16x32_bf16 v[188:191], a[220:223], v[52:55], v[188:191]
 v_cvt_pk_bf16_f32 v46, v36, v37
 v_cvt_pk_bf16_f32 v47, v38, v39
 v_mfma_f32_16x16x32_bf16 v[32:35], a[128:131], a[80:83], 0
 v_mfma_f32_16x16x32_bf16 v[32:35], a[132:135], a[84:87], v[32:35]
 v_exp_f32 v24, v24
 v_mfma_f32_16x16x32_bf16 v[32:35], a[136:139], a[88:91], v[32:35]
 ds_read_b128 a[124:127], v7 offset:704
 ds_read_b128 a[120:123], v7 offset:640
 v_mfma_f32_16x16x32_bf16 v[32:35], a[140:143], a[92:95], v[32:35]
 v_exp_f32 v25, v25
 v_mfma_f32_16x16x32_bf16 v[36:39], a[156:159], a[92:95], 0
 v_exp_f32 v26, v26
 v_mfma_f32_16x16x32_bf16 v[36:39], a[152:155], a[88:91], v[36:39]
 v_exp_f32 v27, v27
 v_mfma_f32_16x16x32_bf16 v[36:39], a[148:151], a[84:87], v[36:39]
 ds_read_b128 a[116:119], v7 offset:576
 ds_read_b128 a[112:115], v7 offset:512
 v_mfma_f32_16x16x32_bf16 v[36:39], a[144:147], a[80:83], v[36:39]
 v_exp_f32 v28, v28
 v_mfma_f32_16x16x32_bf16 v[192:195], a[160:163], v[40:43], v[192:195]
 v_mfma_f32_16x16x32_bf16 v[192:195], a[192:195], v[44:47], v[192:195]
 v_cvt_pk_bf16_f32 v48, v24, v25
 v_cvt_pk_bf16_f32 v49, v26, v27
 v_mfma_f32_16x16x32_bf16 v[196:199], a[164:167], v[40:43], v[196:199]
 v_exp_f32 v29, v29
 v_mfma_f32_16x16x32_bf16 v[196:199], a[196:199], v[44:47], v[196:199]
 ds_read_b128 a[128:131], v7 offset:16896
 ds_read_b128 a[132:135], v7 offset:16960
 v_mfma_f32_16x16x32_bf16 v[200:203], a[168:171], v[40:43], v[200:203]
 s_add_u32 m0, s39, 50752
 v_exp_f32 v30, v30
 v_mfma_f32_16x16x32_bf16 v[200:203], a[200:203], v[44:47], v[200:203]
 buffer_load_dwordx4 v1, s[20:23], s33 offen offset:2048 nt lds
 v_mfma_f32_16x16x32_bf16 v[204:207], a[172:175], v[40:43], v[204:207]
 v_exp_f32 v31, v31
 v_mfma_f32_16x16x32_bf16 v[204:207], a[204:207], v[44:47], v[204:207]
 s_waitcnt lgkmcnt(6)
 ds_read_b128 a[136:139], v7 offset:17024
 ds_read_b128 a[140:143], v7 offset:17088
 v_mfma_f32_16x16x32_bf16 v[24:27], a[96:99], a[0:3], 0
 v_cvt_pk_bf16_f32 v50, v28, v29
 v_cvt_pk_bf16_f32 v51, v30, v31
 v_mfma_f32_16x16x32_bf16 v[24:27], a[100:103], a[4:7], v[24:27]
 v_exp_f32 v32, v32
 v_mfma_f32_16x16x32_bf16 v[24:27], a[104:107], a[8:11], v[24:27]
 v_exp_f32 v33, v33
 v_mfma_f32_16x16x32_bf16 v[24:27], a[108:111], a[12:15], v[24:27]
 s_waitcnt lgkmcnt(4)
 ds_read_b128 a[156:159], v7 offset:17600
 ds_read_b128 a[152:155], v7 offset:17536
 v_smfmac_f32_16x16x64_bf16 a[232:235], a[236:239], v[40:47], v2
 v_mfma_f32_16x16x32_bf16 v[28:31], a[124:127], a[12:15], 0
 v_exp_f32 v34, v34
 v_mfma_f32_16x16x32_bf16 v[28:31], a[120:123], a[8:11], v[28:31]
 v_exp_f32 v35, v35
 v_mfma_f32_16x16x32_bf16 v[28:31], a[116:119], a[4:7], v[28:31]
 ds_read_b128 a[148:151], v7 offset:17472
 ds_read_b128 a[144:147], v7 offset:17408
 v_mfma_f32_16x16x32_bf16 v[28:31], a[112:115], a[0:3], v[28:31]
 v_exp_f32 v36, v36
 v_mfma_f32_16x16x32_bf16 v[208:211], a[176:179], v[40:43], v[208:211]
 v_cvt_pk_bf16_f32 v52, v32, v33
 v_cvt_pk_bf16_f32 v53, v34, v35
 v_mfma_f32_16x16x32_bf16 v[208:211], a[208:211], v[44:47], v[208:211]
 v_exp_f32 v37, v37
 v_mfma_f32_16x16x32_bf16 v[212:215], a[180:183], v[40:43], v[212:215]
 s_add_u32 m0, s39, 50784
 v_exp_f32 v38, v38
 v_mfma_f32_16x16x32_bf16 v[212:215], a[212:215], v[44:47], v[212:215]
 buffer_load_dwordx4 v1, s[20:23], s33 offen offset:3072 nt lds
 v_mfma_f32_16x16x32_bf16 v[216:219], a[184:187], v[40:43], v[216:219]
 s_add_u32 s33, s33, 8192
 v_exp_f32 v39, v39
 v_mfma_f32_16x16x32_bf16 v[216:219], a[216:219], v[44:47], v[216:219]
 s_mov_b32 s59, 15360
 v_mfma_f32_16x16x32_bf16 v[220:223], a[188:191], v[40:43], v[220:223]
 s_add_u32 m0, s45, 11968
 v_cvt_pk_bf16_f32 v54, v36, v37
 v_cvt_pk_bf16_f32 v55, v38, v39
 v_mfma_f32_16x16x32_bf16 v[220:223], a[220:223], v[44:47], v[220:223]
 s_waitcnt lgkmcnt(4)
 buffer_load_dwordx4 v1, s[28:31], s59 offen nt lds
 v_mfma_f32_16x16x32_bf16 v[32:35], a[128:131], a[0:3], 0
 v_exp_f32 v24, v24
 v_mfma_f32_16x16x32_bf16 v[32:35], a[132:135], a[4:7], v[32:35]
 v_mfma_f32_16x16x32_bf16 v[32:35], a[136:139], a[8:11], v[32:35]
 v_exp_f32 v25, v25
 v_mfma_f32_16x16x32_bf16 v[32:35], a[140:143], a[12:15], v[32:35]
 s_waitcnt lgkmcnt(0)
 v_exp_f32 v26, v26
 v_mfma_f32_16x16x32_bf16 v[36:39], a[156:159], a[12:15], 0
 v_mfma_f32_16x16x32_bf16 v[36:39], a[152:155], a[8:11], v[36:39]
 v_exp_f32 v27, v27
 v_mfma_f32_16x16x32_bf16 v[36:39], a[148:151], a[4:7], v[36:39]
 v_exp_f32 v28, v28
 v_mfma_f32_16x16x32_bf16 v[36:39], a[144:147], a[0:3], v[36:39]
 v_cvt_pk_bf16_f32 v40, v24, v25
 v_cvt_pk_bf16_f32 v41, v26, v27
 v_mfma_f32_16x16x32_bf16 v[224:227], a[160:163], v[48:51], v[224:227]
 v_exp_f32 v29, v29
 v_mfma_f32_16x16x32_bf16 v[224:227], a[192:195], v[52:55], v[224:227]
 v_exp_f32 v30, v30
 v_mfma_f32_16x16x32_bf16 v[228:231], a[164:167], v[48:51], v[228:231]
 ds_read_b64_tr_b16 a[160:161], v8 offset:0
 ds_read_b64_tr_b16 a[162:163], v8 offset:512
 v_mfma_f32_16x16x32_bf16 v[228:231], a[196:199], v[52:55], v[228:231]
 v_exp_f32 v31, v31
 v_mfma_f32_16x16x32_bf16 v[232:235], a[168:171], v[48:51], v[232:235]
 ds_read_b64_tr_b16 a[192:193], v8 offset:16896
 ds_read_b64_tr_b16 a[194:195], v8 offset:17408
 v_mfma_f32_16x16x32_bf16 v[232:235], a[200:203], v[52:55], v[232:235]
 v_cvt_pk_bf16_f32 v42, v28, v29
 v_cvt_pk_bf16_f32 v43, v30, v31
 v_mfma_f32_16x16x32_bf16 v[236:239], a[172:175], v[48:51], v[236:239]
 v_exp_f32 v32, v32
 v_mfma_f32_16x16x32_bf16 v[236:239], a[204:207], v[52:55], v[236:239]
 ds_read_b64_tr_b16 a[164:165], v8 offset:32
 ds_read_b64_tr_b16 a[166:167], v8 offset:544
 v_mfma_f32_16x16x32_bf16 v[24:27], a[96:99], a[16:19], 0
 v_exp_f32 v33, v33
 v_mfma_f32_16x16x32_bf16 v[24:27], a[100:103], a[20:23], v[24:27]
 ds_read_b64_tr_b16 a[196:197], v8 offset:16928
 ds_read_b64_tr_b16 a[198:199], v8 offset:17440
 v_mfma_f32_16x16x32_bf16 v[24:27], a[104:107], a[24:27], v[24:27]
 v_exp_f32 v34, v34
 v_mfma_f32_16x16x32_bf16 v[24:27], a[108:111], a[28:31], v[24:27]
 ds_read_b64_tr_b16 a[168:169], v8 offset:64
 ds_read_b64_tr_b16 a[170:171], v8 offset:576
 v_smfmac_f32_16x16x64_bf16 a[232:235], a[240:243], v[48:55], v2
 v_mfma_f32_16x16x32_bf16 v[28:31], a[124:127], a[28:31], 0
 ds_read_b64_tr_b16 a[200:201], v8 offset:16960
 ds_read_b64_tr_b16 a[202:203], v8 offset:17472
 v_mfma_f32_16x16x32_bf16 v[28:31], a[120:123], a[24:27], v[28:31]
 v_exp_f32 v35, v35
 v_mfma_f32_16x16x32_bf16 v[28:31], a[116:119], a[20:23], v[28:31]
 v_exp_f32 v36, v36
 v_mfma_f32_16x16x32_bf16 v[28:31], a[112:115], a[16:19], v[28:31]
 ds_read_b64_tr_b16 a[172:173], v8 offset:96
 ds_read_b64_tr_b16 a[174:175], v8 offset:608
 v_mfma_f32_16x16x32_bf16 v[240:243], a[176:179], v[48:51], v[240:243]
 v_cvt_pk_bf16_f32 v44, v32, v33
 v_cvt_pk_bf16_f32 v45, v34, v35
 v_mfma_f32_16x16x32_bf16 v[240:243], a[208:211], v[52:55], v[240:243]
 ds_read_b64_tr_b16 a[204:205], v8 offset:16992
 ds_read_b64_tr_b16 a[206:207], v8 offset:17504
 v_mfma_f32_16x16x32_bf16 v[244:247], a[180:183], v[48:51], v[244:247]
 v_exp_f32 v37, v37
 v_mfma_f32_16x16x32_bf16 v[244:247], a[212:215], v[52:55], v[244:247]
 v_exp_f32 v38, v38
 v_mfma_f32_16x16x32_bf16 v[248:251], a[184:187], v[48:51], v[248:251]
 v_exp_f32 v39, v39
 v_mfma_f32_16x16x32_bf16 v[248:251], a[216:219], v[52:55], v[248:251]
 s_mov_b32 s59, 16384
 ds_read_b64_tr_b16 a[176:177], v8 offset:128
 ds_read_b64_tr_b16 a[178:179], v8 offset:640
 v_mfma_f32_16x16x32_bf16 v[252:255], a[188:191], v[48:51], v[252:255]
 s_add_u32 m0, s45, 13056
 v_cvt_pk_bf16_f32 v46, v36, v37
 v_cvt_pk_bf16_f32 v47, v38, v39
 v_mfma_f32_16x16x32_bf16 v[252:255], a[220:223], v[52:55], v[252:255]
 buffer_load_dwordx4 v1, s[28:31], s59 offen nt lds
 v_mfma_f32_16x16x32_bf16 v[32:35], a[128:131], a[16:19], 0
 ds_read_b64_tr_b16 a[208:209], v8 offset:17024
 ds_read_b64_tr_b16 a[210:211], v8 offset:17536
 v_mfma_f32_16x16x32_bf16 v[32:35], a[132:135], a[20:23], v[32:35]
 v_exp_f32 v24, v24
 v_mfma_f32_16x16x32_bf16 v[32:35], a[136:139], a[24:27], v[32:35]
 v_exp_f32 v25, v25
 v_mfma_f32_16x16x32_bf16 v[32:35], a[140:143], a[28:31], v[32:35]
 ds_read_b64_tr_b16 a[180:181], v8 offset:160
 ds_read_b64_tr_b16 a[182:183], v8 offset:672
 v_mfma_f32_16x16x32_bf16 v[36:39], a[156:159], a[28:31], 0
 v_exp_f32 v26, v26
 v_mfma_f32_16x16x32_bf16 v[36:39], a[152:155], a[24:27], v[36:39]
 v_exp_f32 v27, v27
 v_mfma_f32_16x16x32_bf16 v[36:39], a[148:151], a[20:23], v[36:39]
 ds_read_b64_tr_b16 a[212:213], v8 offset:17056
 ds_read_b64_tr_b16 a[214:215], v8 offset:17568
 v_mfma_f32_16x16x32_bf16 v[36:39], a[144:147], a[16:19], v[36:39]
 s_waitcnt lgkmcnt(15)
 v_exp_f32 v28, v28
 v_mfma_f32_16x16x32_bf16 v[64:67], a[160:163], v[40:43], v[64:67]
 v_cvt_pk_bf16_f32 v48, v24, v25
 v_cvt_pk_bf16_f32 v49, v26, v27
 v_mfma_f32_16x16x32_bf16 v[64:67], a[192:195], v[44:47], v[64:67]
 ds_read_b64_tr_b16 a[184:185], v8 offset:192
 ds_read_b64_tr_b16 a[186:187], v8 offset:704
 v_mfma_f32_16x16x32_bf16 v[68:71], a[164:167], v[40:43], v[68:71]
 v_exp_f32 v29, v29
 v_mfma_f32_16x16x32_bf16 v[68:71], a[196:199], v[44:47], v[68:71]
 s_waitcnt lgkmcnt(10)
 v_exp_f32 v30, v30
 v_mfma_f32_16x16x32_bf16 v[72:75], a[168:171], v[40:43], v[72:75]
 ds_read_b64_tr_b16 a[216:217], v8 offset:17088
 ds_read_b64_tr_b16 a[218:219], v8 offset:17600
 v_mfma_f32_16x16x32_bf16 v[72:75], a[200:203], v[44:47], v[72:75]
 v_exp_f32 v31, v31
 v_mfma_f32_16x16x32_bf16 v[76:79], a[172:175], v[40:43], v[76:79]
 v_mfma_f32_16x16x32_bf16 v[76:79], a[204:207], v[44:47], v[76:79]
 ds_read_b64_tr_b16 a[188:189], v8 offset:224
 ds_read_b64_tr_b16 a[190:191], v8 offset:736
 v_mfma_f32_16x16x32_bf16 v[24:27], a[96:99], a[32:35], 0
 v_cvt_pk_bf16_f32 v50, v28, v29
 v_cvt_pk_bf16_f32 v51, v30, v31
 v_mfma_f32_16x16x32_bf16 v[24:27], a[100:103], a[36:39], v[24:27]
 v_exp_f32 v32, v32
 v_mfma_f32_16x16x32_bf16 v[24:27], a[104:107], a[40:43], v[24:27]
 ds_read_b64_tr_b16 a[220:221], v8 offset:17120
 ds_read_b64_tr_b16 a[222:223], v8 offset:17632
 v_mfma_f32_16x16x32_bf16 v[24:27], a[108:111], a[44:47], v[24:27]
 v_exp_f32 v33, v33
 v_smfmac_f32_16x16x64_bf16 a[224:227], a[236:239], v[40:47], v2
 v_mfma_f32_16x16x32_bf16 v[28:31], a[124:127], a[44:47], 0
 v_exp_f32 v34, v34
 v_mfma_f32_16x16x32_bf16 v[28:31], a[120:123], a[40:43], v[28:31]
 v_exp_f32 v35, v35
 v_mfma_f32_16x16x32_bf16 v[28:31], a[116:119], a[36:39], v[28:31]
 v_exp_f32 v36, v36
 v_mfma_f32_16x16x32_bf16 v[28:31], a[112:115], a[32:35], v[28:31]
 s_waitcnt lgkmcnt(8)
 v_mfma_f32_16x16x32_bf16 v[80:83], a[176:179], v[40:43], v[80:83]
 v_cvt_pk_bf16_f32 v52, v32, v33
 v_cvt_pk_bf16_f32 v53, v34, v35
 v_mfma_f32_16x16x32_bf16 v[80:83], a[208:211], v[44:47], v[80:83]
 v_mfma_f32_16x16x32_bf16 v[84:87], a[180:183], v[40:43], v[84:87]
 v_exp_f32 v37, v37
 v_mfma_f32_16x16x32_bf16 v[84:87], a[212:215], v[44:47], v[84:87]
 s_waitcnt lgkmcnt(0)
 s_barrier
 v_mfma_f32_16x16x32_bf16 v[88:91], a[184:187], v[40:43], v[88:91]
 v_exp_f32 v38, v38
 v_mfma_f32_16x16x32_bf16 v[88:91], a[216:219], v[44:47], v[88:91]
 s_mov_b32 s59, 17408
 v_exp_f32 v39, v39
 v_mfma_f32_16x16x32_bf16 v[92:95], a[188:191], v[40:43], v[92:95]
 s_add_u32 m0, s45, 14144
 v_cvt_pk_bf16_f32 v54, v36, v37
 v_cvt_pk_bf16_f32 v55, v38, v39
 v_mfma_f32_16x16x32_bf16 v[92:95], a[220:223], v[44:47], v[92:95]
 buffer_load_dwordx4 v1, s[28:31], s59 offen nt lds
 v_mfma_f32_16x16x32_bf16 v[32:35], a[128:131], a[32:35], 0
 v_mfma_f32_16x16x32_bf16 v[32:35], a[132:135], a[36:39], v[32:35]
 v_exp_f32 v24, v24
 v_mfma_f32_16x16x32_bf16 v[32:35], a[136:139], a[40:43], v[32:35]
 v_exp_f32 v25, v25
 v_mfma_f32_16x16x32_bf16 v[32:35], a[140:143], a[44:47], v[32:35]
 v_mfma_f32_16x16x32_bf16 v[36:39], a[156:159], a[44:47], 0
 v_exp_f32 v26, v26
 v_mfma_f32_16x16x32_bf16 v[36:39], a[152:155], a[40:43], v[36:39]
 s_mov_b32 s33, s46
 v_exp_f32 v27, v27
 v_mfma_f32_16x16x32_bf16 v[36:39], a[148:151], a[36:39], v[36:39]
 s_add_u32 m0, s39, 0
 v_exp_f32 v28, v28
 v_mfma_f32_16x16x32_bf16 v[36:39], a[144:147], a[32:35], v[36:39]
 buffer_load_dwordx4 v1, s[20:23], s33 offen nt lds
 v_mfma_f32_16x16x32_bf16 v[96:99], a[160:163], v[48:51], v[96:99]
 v_mfma_f32_16x16x32_bf16 v[96:99], a[192:195], v[52:55], v[96:99]
 v_cvt_pk_bf16_f32 v40, v24, v25
 v_cvt_pk_bf16_f32 v41, v26, v27
 v_mfma_f32_16x16x32_bf16 v[100:103], a[164:167], v[48:51], v[100:103]
 v_mfma_f32_16x16x32_bf16 v[100:103], a[196:199], v[52:55], v[100:103]
 v_exp_f32 v29, v29
 v_mfma_f32_16x16x32_bf16 v[104:107], a[168:171], v[48:51], v[104:107]
 v_exp_f32 v30, v30
 v_mfma_f32_16x16x32_bf16 v[104:107], a[200:203], v[52:55], v[104:107]
 v_mfma_f32_16x16x32_bf16 v[108:111], a[172:175], v[48:51], v[108:111]
 v_exp_f32 v31, v31
 v_mfma_f32_16x16x32_bf16 v[108:111], a[204:207], v[52:55], v[108:111]
 v_mfma_f32_16x16x32_bf16 v[24:27], a[96:99], a[48:51], 0
 v_cvt_pk_bf16_f32 v42, v28, v29
 v_cvt_pk_bf16_f32 v43, v30, v31
 v_mfma_f32_16x16x32_bf16 v[24:27], a[100:103], a[52:55], v[24:27]
 v_exp_f32 v32, v32
 v_mfma_f32_16x16x32_bf16 v[24:27], a[104:107], a[56:59], v[24:27]
 v_exp_f32 v33, v33
 v_mfma_f32_16x16x32_bf16 v[24:27], a[108:111], a[60:63], v[24:27]
 v_exp_f32 v34, v34
 v_smfmac_f32_16x16x64_bf16 a[224:227], a[240:243], v[48:55], v2
 v_mfma_f32_16x16x32_bf16 v[28:31], a[124:127], a[60:63], 0
 v_exp_f32 v35, v35
 v_mfma_f32_16x16x32_bf16 v[28:31], a[120:123], a[56:59], v[28:31]
 v_exp_f32 v36, v36
 v_mfma_f32_16x16x32_bf16 v[28:31], a[116:119], a[52:55], v[28:31]
 s_add_u32 m0, s39, 32
 v_mfma_f32_16x16x32_bf16 v[28:31], a[112:115], a[48:51], v[28:31]
 buffer_load_dwordx4 v1, s[20:23], s33 offen offset:1024 nt lds
 v_mfma_f32_16x16x32_bf16 v[112:115], a[176:179], v[48:51], v[112:115]
 v_cvt_pk_bf16_f32 v44, v32, v33
 v_cvt_pk_bf16_f32 v45, v34, v35
 v_mfma_f32_16x16x32_bf16 v[112:115], a[208:211], v[52:55], v[112:115]
 v_exp_f32 v37, v37
 v_mfma_f32_16x16x32_bf16 v[116:119], a[180:183], v[48:51], v[116:119]
 v_mfma_f32_16x16x32_bf16 v[116:119], a[212:215], v[52:55], v[116:119]
 v_exp_f32 v38, v38
 v_mfma_f32_16x16x32_bf16 v[120:123], a[184:187], v[48:51], v[120:123]
 v_exp_f32 v39, v39
 v_mfma_f32_16x16x32_bf16 v[120:123], a[216:219], v[52:55], v[120:123]
 v_mfma_f32_16x16x32_bf16 v[124:127], a[188:191], v[48:51], v[124:127]
 v_cvt_pk_bf16_f32 v46, v36, v37
 v_cvt_pk_bf16_f32 v47, v38, v39
 v_mfma_f32_16x16x32_bf16 v[124:127], a[220:223], v[52:55], v[124:127]
 v_mfma_f32_16x16x32_bf16 v[32:35], a[128:131], a[48:51], 0
 v_exp_f32 v24, v24
 v_mfma_f32_16x16x32_bf16 v[32:35], a[132:135], a[52:55], v[32:35]
 v_mfma_f32_16x16x32_bf16 v[32:35], a[136:139], a[56:59], v[32:35]
 v_exp_f32 v25, v25
 v_mfma_f32_16x16x32_bf16 v[32:35], a[140:143], a[60:63], v[32:35]
 v_exp_f32 v26, v26
 v_mfma_f32_16x16x32_bf16 v[36:39], a[156:159], a[60:63], 0
 v_mfma_f32_16x16x32_bf16 v[36:39], a[152:155], a[56:59], v[36:39]
 s_mov_b32 s59, 18432
 v_exp_f32 v27, v27
 v_mfma_f32_16x16x32_bf16 v[36:39], a[148:151], a[52:55], v[36:39]
 s_add_u32 m0, s45, 15232
 v_exp_f32 v28, v28
 v_mfma_f32_16x16x32_bf16 v[36:39], a[144:147], a[48:51], v[36:39]
 buffer_load_dwordx4 v1, s[28:31], s59 offen nt lds
 v_mfma_f32_16x16x32_bf16 v[128:131], a[160:163], v[40:43], v[128:131]
 s_add_u32 m0, s39, 64
 v_cvt_pk_bf16_f32 v48, v24, v25
 v_cvt_pk_bf16_f32 v49, v26, v27
 v_mfma_f32_16x16x32_bf16 v[128:131], a[192:195], v[44:47], v[128:131]
 buffer_load_dwordx4 v1, s[20:23], s33 offen offset:2048 nt lds
 v_mfma_f32_16x16x32_bf16 v[132:135], a[164:167], v[40:43], v[132:135]
 v_exp_f32 v29, v29
 v_mfma_f32_16x16x32_bf16 v[132:135], a[196:199], v[44:47], v[132:135]
 v_exp_f32 v30, v30
 v_mfma_f32_16x16x32_bf16 v[136:139], a[168:171], v[40:43], v[136:139]
 v_mfma_f32_16x16x32_bf16 v[136:139], a[200:203], v[44:47], v[136:139]
 v_exp_f32 v31, v31
 v_mfma_f32_16x16x32_bf16 v[140:143], a[172:175], v[40:43], v[140:143]
 v_mfma_f32_16x16x32_bf16 v[140:143], a[204:207], v[44:47], v[140:143]
 v_cvt_pk_bf16_f32 v50, v28, v29
 v_cvt_pk_bf16_f32 v51, v30, v31
 v_mfma_f32_16x16x32_bf16 v[24:27], a[96:99], a[64:67], 0
 v_mfma_f32_16x16x32_bf16 v[24:27], a[100:103], a[68:71], v[24:27]
 v_exp_f32 v32, v32
 v_mfma_f32_16x16x32_bf16 v[24:27], a[104:107], a[72:75], v[24:27]
 v_exp_f32 v33, v33
 v_mfma_f32_16x16x32_bf16 v[24:27], a[108:111], a[76:79], v[24:27]
 v_exp_f32 v34, v34
 v_smfmac_f32_16x16x64_bf16 a[228:231], a[236:239], v[40:47], v2
 v_mfma_f32_16x16x32_bf16 v[28:31], a[124:127], a[76:79], 0
 v_exp_f32 v35, v35
 v_mfma_f32_16x16x32_bf16 v[28:31], a[120:123], a[72:75], v[28:31]
 v_mfma_f32_16x16x32_bf16 v[28:31], a[116:119], a[68:71], v[28:31]
 v_exp_f32 v36, v36
 v_mfma_f32_16x16x32_bf16 v[28:31], a[112:115], a[64:67], v[28:31]
 v_mfma_f32_16x16x32_bf16 v[144:147], a[176:179], v[40:43], v[144:147]
 s_add_u32 m0, s39, 96
 v_cvt_pk_bf16_f32 v52, v32, v33
 v_cvt_pk_bf16_f32 v53, v34, v35
 v_mfma_f32_16x16x32_bf16 v[144:147], a[208:211], v[44:47], v[144:147]
 buffer_load_dwordx4 v1, s[20:23], s33 offen offset:3072 nt lds
 v_mfma_f32_16x16x32_bf16 v[148:151], a[180:183], v[40:43], v[148:151]
 s_add_u32 s33, s33, 8192
 v_exp_f32 v37, v37
 v_mfma_f32_16x16x32_bf16 v[148:151], a[212:215], v[44:47], v[148:151]
 v_exp_f32 v38, v38
 v_mfma_f32_16x16x32_bf16 v[152:155], a[184:187], v[40:43], v[152:155]
 v_mfma_f32_16x16x32_bf16 v[152:155], a[216:219], v[44:47], v[152:155]
 v_exp_f32 v39, v39
 v_mfma_f32_16x16x32_bf16 v[156:159], a[188:191], v[40:43], v[156:159]
 v_mfma_f32_16x16x32_bf16 v[156:159], a[220:223], v[44:47], v[156:159]
 v_cvt_pk_bf16_f32 v54, v36, v37
 v_cvt_pk_bf16_f32 v55, v38, v39
 v_mfma_f32_16x16x32_bf16 v[32:35], a[128:131], a[64:67], 0
 v_mfma_f32_16x16x32_bf16 v[32:35], a[132:135], a[68:71], v[32:35]
 v_exp_f32 v24, v24
 v_mfma_f32_16x16x32_bf16 v[32:35], a[136:139], a[72:75], v[32:35]
 v_exp_f32 v25, v25
 v_mfma_f32_16x16x32_bf16 v[32:35], a[140:143], a[76:79], v[32:35]
 v_exp_f32 v26, v26
 v_mfma_f32_16x16x32_bf16 v[36:39], a[156:159], a[76:79], 0
 v_mfma_f32_16x16x32_bf16 v[36:39], a[152:155], a[72:75], v[36:39]
 v_exp_f32 v27, v27
 v_mfma_f32_16x16x32_bf16 v[36:39], a[148:151], a[68:71], v[36:39]
 v_exp_f32 v28, v28
 v_mfma_f32_16x16x32_bf16 v[36:39], a[144:147], a[64:67], v[36:39]
 v_mfma_f32_16x16x32_bf16 v[160:163], a[160:163], v[48:51], v[160:163]
 v_cvt_pk_bf16_f32 v40, v24, v25
 v_cvt_pk_bf16_f32 v41, v26, v27
 v_mfma_f32_16x16x32_bf16 v[160:163], a[192:195], v[52:55], v[160:163]
 v_mfma_f32_16x16x32_bf16 v[164:167], a[164:167], v[48:51], v[164:167]
 s_add_u32 m0, s39, 16896
 v_exp_f32 v29, v29
 v_mfma_f32_16x16x32_bf16 v[164:167], a[196:199], v[52:55], v[164:167]
 buffer_load_dwordx4 v1, s[20:23], s33 offen nt lds
 v_mfma_f32_16x16x32_bf16 v[168:171], a[168:171], v[48:51], v[168:171]
 v_exp_f32 v30, v30
 v_mfma_f32_16x16x32_bf16 v[168:171], a[200:203], v[52:55], v[168:171]
 v_exp_f32 v31, v31
 v_mfma_f32_16x16x32_bf16 v[172:175], a[172:175], v[48:51], v[172:175]
 v_mfma_f32_16x16x32_bf16 v[172:175], a[204:207], v[52:55], v[172:175]
 v_cvt_pk_bf16_f32 v42, v28, v29
 v_cvt_pk_bf16_f32 v43, v30, v31
 v_mfma_f32_16x16x32_bf16 v[24:27], a[96:99], a[80:83], 0
 v_mfma_f32_16x16x32_bf16 v[24:27], a[100:103], a[84:87], v[24:27]
 v_exp_f32 v32, v32
 v_mfma_f32_16x16x32_bf16 v[24:27], a[104:107], a[88:91], v[24:27]
 v_mfma_f32_16x16x32_bf16 v[24:27], a[108:111], a[92:95], v[24:27]
 v_exp_f32 v33, v33
 v_smfmac_f32_16x16x64_bf16 a[228:231], a[240:243], v[48:55], v2
 v_mfma_f32_16x16x32_bf16 v[28:31], a[124:127], a[92:95], 0
 v_exp_f32 v34, v34
 v_mfma_f32_16x16x32_bf16 v[28:31], a[120:123], a[88:91], v[28:31]
 v_exp_f32 v35, v35
 v_mfma_f32_16x16x32_bf16 v[28:31], a[116:119], a[84:87], v[28:31]
 v_exp_f32 v36, v36
 v_mfma_f32_16x16x32_bf16 v[28:31], a[112:115], a[80:83], v[28:31]
 s_mov_b32 s59, 19456
 s_waitcnt vmcnt(9)
 s_barrier
 v_mfma_f32_16x16x32_bf16 v[176:179], a[176:179], v[48:51], v[176:179]
 s_add_u32 m0, s45, 16320
 v_cvt_pk_bf16_f32 v44, v32, v33
 v_cvt_pk_bf16_f32 v45, v34, v35
 v_mfma_f32_16x16x32_bf16 v[176:179], a[208:211], v[52:55], v[176:179]
 buffer_load_dwordx4 v1, s[28:31], s59 offen nt lds
 v_mfma_f32_16x16x32_bf16 v[180:183], a[180:183], v[48:51], v[180:183]
 s_add_u32 m0, s39, 16928
 ds_read_b128 a[96:99], v7 offset:33792
 ds_read_b128 a[100:103], v7 offset:33856
 v_mfma_f32_16x16x32_bf16 v[180:183], a[212:215], v[52:55], v[180:183]
 buffer_load_dwordx4 v1, s[20:23], s33 offen offset:1024 nt lds
 v_mfma_f32_16x16x32_bf16 v[184:187], a[184:187], v[48:51], v[184:187]
 v_exp_f32 v37, v37
 v_mfma_f32_16x16x32_bf16 v[184:187], a[216:219], v[52:55], v[184:187]
 v_exp_f32 v38, v38
 v_mfma_f32_16x16x32_bf16 v[188:191], a[188:191], v[48:51], v[188:191]
 ds_read_b128 a[104:107], v7 offset:33920
 ds_read_b128 a[108:111], v7 offset:33984
 v_mfma_f32_16x16x32_bf16 v[188:191], a[220:223], v[52:55], v[188:191]
 v_exp_f32 v39, v39
 v_mfma_f32_16x16x32_bf16 v[32:35], a[128:131], a[80:83], 0
 v_cvt_pk_bf16_f32 v46, v36, v37
 v_cvt_pk_bf16_f32 v47, v38, v39
 v_mfma_f32_16x16x32_bf16 v[32:35], a[132:135], a[84:87], v[32:35]
 v_exp_f32 v24, v24
 v_mfma_f32_16x16x32_bf16 v[32:35], a[136:139], a[88:91], v[32:35]
 ds_read_b128 a[124:127], v7 offset:34496
 ds_read_b128 a[120:123], v7 offset:34432
 v_mfma_f32_16x16x32_bf16 v[32:35], a[140:143], a[92:95], v[32:35]
 v_exp_f32 v25, v25
 v_mfma_f32_16x16x32_bf16 v[36:39], a[156:159], a[92:95], 0
 v_exp_f32 v26, v26
 v_mfma_f32_16x16x32_bf16 v[36:39], a[152:155], a[88:91], v[36:39]
 v_exp_f32 v27, v27
 v_mfma_f32_16x16x32_bf16 v[36:39], a[148:151], a[84:87], v[36:39]
 ds_read_b128 a[116:119], v7 offset:34368
 ds_read_b128 a[112:115], v7 offset:34304
 v_mfma_f32_16x16x32_bf16 v[36:39], a[144:147], a[80:83], v[36:39]
 v_exp_f32 v28, v28
 v_mfma_f32_16x16x32_bf16 v[192:195], a[160:163], v[40:43], v[192:195]
 v_mfma_f32_16x16x32_bf16 v[192:195], a[192:195], v[44:47], v[192:195]
 v_cvt_pk_bf16_f32 v48, v24, v25
 v_cvt_pk_bf16_f32 v49, v26, v27
 v_mfma_f32_16x16x32_bf16 v[196:199], a[164:167], v[40:43], v[196:199]
 v_exp_f32 v29, v29
 v_mfma_f32_16x16x32_bf16 v[196:199], a[196:199], v[44:47], v[196:199]
 ds_read_b128 a[128:131], v7 offset:50688
 ds_read_b128 a[132:135], v7 offset:50752
 v_mfma_f32_16x16x32_bf16 v[200:203], a[168:171], v[40:43], v[200:203]
 s_add_u32 m0, s39, 16960
 v_exp_f32 v30, v30
 v_mfma_f32_16x16x32_bf16 v[200:203], a[200:203], v[44:47], v[200:203]
L_pg1_5:
 s_cbranch_execz L_pg1_9
 buffer_load_dwordx4 v1, s[20:23], s33 offen offset:2048 nt lds
 v_mfma_f32_16x16x32_bf16 v[204:207], a[172:175], v[40:43], v[204:207]
 v_exp_f32 v31, v31
 v_mfma_f32_16x16x32_bf16 v[204:207], a[204:207], v[44:47], v[204:207]
 s_waitcnt lgkmcnt(6)
 ds_read_b128 a[136:139], v7 offset:50816
 ds_read_b128 a[140:143], v7 offset:50880
 v_mfma_f32_16x16x32_bf16 v[24:27], a[96:99], a[0:3], 0
 v_cvt_pk_bf16_f32 v50, v28, v29
 v_cvt_pk_bf16_f32 v51, v30, v31
 v_mfma_f32_16x16x32_bf16 v[24:27], a[100:103], a[4:7], v[24:27]
 v_exp_f32 v32, v32
 v_mfma_f32_16x16x32_bf16 v[24:27], a[104:107], a[8:11], v[24:27]
 v_exp_f32 v33, v33
 v_mfma_f32_16x16x32_bf16 v[24:27], a[108:111], a[12:15], v[24:27]
 s_waitcnt lgkmcnt(4)
 ds_read_b128 a[156:159], v7 offset:51392
 ds_read_b128 a[152:155], v7 offset:51328
 v_smfmac_f32_16x16x64_bf16 a[232:235], a[236:239], v[40:47], v2
 v_mfma_f32_16x16x32_bf16 v[28:31], a[124:127], a[12:15], 0
 v_exp_f32 v34, v34
 v_mfma_f32_16x16x32_bf16 v[28:31], a[120:123], a[8:11], v[28:31]
 v_exp_f32 v35, v35
 v_mfma_f32_16x16x32_bf16 v[28:31], a[116:119], a[4:7], v[28:31]
 ds_read_b128 a[148:151], v7 offset:51264
 ds_read_b128 a[144:147], v7 offset:51200
 v_mfma_f32_16x16x32_bf16 v[28:31], a[112:115], a[0:3], v[28:31]
 v_exp_f32 v36, v36
 v_mfma_f32_16x16x32_bf16 v[208:211], a[176:179], v[40:43], v[208:211]
 v_cvt_pk_bf16_f32 v52, v32, v33
 v_cvt_pk_bf16_f32 v53, v34, v35
 v_mfma_f32_16x16x32_bf16 v[208:211], a[208:211], v[44:47], v[208:211]
 v_exp_f32 v37, v37
 v_mfma_f32_16x16x32_bf16 v[212:215], a[180:183], v[40:43], v[212:215]
 s_add_u32 m0, s39, 16992
 v_exp_f32 v38, v38
 v_mfma_f32_16x16x32_bf16 v[212:215], a[212:215], v[44:47], v[212:215]
 buffer_load_dwordx4 v1, s[20:23], s33 offen offset:3072 nt lds
 v_mfma_f32_16x16x32_bf16 v[216:219], a[184:187], v[40:43], v[216:219]
 s_add_u32 s33, s33, 8192
 v_exp_f32 v39, v39
 v_mfma_f32_16x16x32_bf16 v[216:219], a[216:219], v[44:47], v[216:219]
 v_mfma_f32_16x16x32_bf16 v[220:223], a[188:191], v[40:43], v[220:223]
 v_cvt_pk_bf16_f32 v54, v36, v37
 v_cvt_pk_bf16_f32 v55, v38, v39
 v_mfma_f32_16x16x32_bf16 v[220:223], a[220:223], v[44:47], v[220:223]
 s_waitcnt lgkmcnt(4)
 v_mfma_f32_16x16x32_bf16 v[32:35], a[128:131], a[0:3], 0
 v_exp_f32 v24, v24
 v_mfma_f32_16x16x32_bf16 v[32:35], a[132:135], a[4:7], v[32:35]
 v_mfma_f32_16x16x32_bf16 v[32:35], a[136:139], a[8:11], v[32:35]
 v_exp_f32 v25, v25
 v_mfma_f32_16x16x32_bf16 v[32:35], a[140:143], a[12:15], v[32:35]
 s_waitcnt lgkmcnt(0)
 v_exp_f32 v26, v26
 v_mfma_f32_16x16x32_bf16 v[36:39], a[156:159], a[12:15], 0
 v_exp_f32 v27, v27
 v_mfma_f32_16x16x32_bf16 v[36:39], a[152:155], a[8:11], v[36:39]
 v_exp_f32 v28, v28
 v_mfma_f32_16x16x32_bf16 v[36:39], a[148:151], a[4:7], v[36:39]
 v_cvt_pk_bf16_f32 v40, v24, v25
 v_cvt_pk_bf16_f32 v41, v26, v27
 v_mfma_f32_16x16x32_bf16 v[36:39], a[144:147], a[0:3], v[36:39]
 v_exp_f32 v29, v29
 v_mfma_f32_16x16x32_bf16 v[224:227], a[160:163], v[48:51], v[224:227]
 v_exp_f32 v30, v30
 v_mfma_f32_16x16x32_bf16 v[224:227], a[192:195], v[52:55], v[224:227]
 v_exp_f32 v31, v31
 v_mfma_f32_16x16x32_bf16 v[228:231], a[164:167], v[48:51], v[228:231]
 ds_read_b64_tr_b16 a[160:161], v8 offset:33792
 ds_read_b64_tr_b16 a[162:163], v8 offset:34304
 v_mfma_f32_16x16x32_bf16 v[228:231], a[196:199], v[52:55], v[228:231]
 v_cvt_pk_bf16_f32 v42, v28, v29
 v_cvt_pk_bf16_f32 v43, v30, v31
 v_mfma_f32_16x16x32_bf16 v[232:235], a[168:171], v[48:51], v[232:235]
 ds_read_b64_tr_b16 a[192:193], v8 offset:50688
 ds_read_b64_tr_b16 a[194:195], v8 offset:51200
 v_mfma_f32_16x16x32_bf16 v[232:235], a[200:203], v[52:55], v[232:235]
 v_exp_f32 v32, v32
 v_mfma_f32_16x16x32_bf16 v[236:239], a[172:175], v[48:51], v[236:239]
 v_exp_f32 v33, v33
 v_mfma_f32_16x16x32_bf16 v[236:239], a[204:207], v[52:55], v[236:239]
 ds_read_b64_tr_b16 a[164:165], v8 offset:33824
 ds_read_b64_tr_b16 a[166:167], v8 offset:34336
 v_mfma_f32_16x16x32_bf16 v[24:27], a[96:99], a[16:19], 0
 v_exp_f32 v34, v34
 v_mfma_f32_16x16x32_bf16 v[24:27], a[100:103], a[20:23], v[24:27]
 ds_read_b64_tr_b16 a[196:197], v8 offset:50720
 ds_read_b64_tr_b16 a[198:199], v8 offset:51232
 v_mfma_f32_16x16x32_bf16 v[24:27], a[104:107], a[24:27], v[24:27]
 s_waitcnt vmcnt(48)
 ds_read_b128 a[0:3], v4 offset:0
 ds_read_b128 a[4:7], v4 offset:64
 v_mfma_f32_16x16x32_bf16 v[24:27], a[108:111], a[28:31], v[24:27]
 ds_read_b64_tr_b16 a[168:169], v8 offset:33856
 ds_read_b64_tr_b16 a[170:171], v8 offset:34368
 v_smfmac_f32_16x16x64_bf16 a[232:235], a[240:243], v[48:55], v2
 v_mfma_f32_16x16x32_bf16 v[28:31], a[124:127], a[28:31], 0
 ds_read_b64_tr_b16 a[200:201], v8 offset:50752
 ds_read_b64_tr_b16 a[202:203], v8 offset:51264
 v_mfma_f32_16x16x32_bf16 v[28:31], a[120:123], a[24:27], v[28:31]
 ds_read_b128 a[8:11], v4 offset:128
 ds_read_b128 a[12:15], v4 offset:192
 v_mfma_f32_16x16x32_bf16 v[28:31], a[116:119], a[20:23], v[28:31]
 v_exp_f32 v35, v35
 v_mfma_f32_16x16x32_bf16 v[28:31], a[112:115], a[16:19], v[28:31]
 ds_read_b64_tr_b16 a[172:173], v8 offset:33888
 ds_read_b64_tr_b16 a[174:175], v8 offset:34400
 v_mfma_f32_16x16x32_bf16 v[240:243], a[176:179], v[48:51], v[240:243]
 v_exp_f32 v36, v36
 v_mfma_f32_16x16x32_bf16 v[240:243], a[208:211], v[52:55], v[240:243]
 ds_read_b64_tr_b16 a[204:205], v8 offset:50784
 ds_read_b64_tr_b16 a[206:207], v8 offset:51296
 v_mfma_f32_16x16x32_bf16 v[244:247], a[180:183], v[48:51], v[244:247]
 v_cvt_pk_bf16_f32 v44, v32, v33
 v_cvt_pk_bf16_f32 v45, v34, v35
 v_mfma_f32_16x16x32_bf16 v[244:247], a[212:215], v[52:55], v[244:247]
 v_exp_f32 v37, v37
 v_mfma_f32_16x16x32_bf16 v[248:251], a[184:187], v[48:51], v[248:251]
 v_exp_f32 v38, v38
 v_mfma_f32_16x16x32_bf16 v[248:251], a[216:219], v[52:55], v[248:251]
 ds_read_b64_tr_b16 a[176:177], v8 offset:33920
 ds_read_b64_tr_b16 a[178:179], v8 offset:34432
 v_mfma_f32_16x16x32_bf16 v[252:255], a[188:191], v[48:51], v[252:255]
 v_exp_f32 v39, v39
 v_mfma_f32_16x16x32_bf16 v[252:255], a[220:223], v[52:55], v[252:255]
 v_cvt_pk_bf16_f32 v46, v36, v37
 v_cvt_pk_bf16_f32 v47, v38, v39
 v_mfma_f32_16x16x32_bf16 v[32:35], a[128:131], a[16:19], 0
 s_waitcnt lgkmcnt(6)
 ds_read_b64_tr_b16 a[208:209], v8 offset:50816
 ds_read_b64_tr_b16 a[210:211], v8 offset:51328
 v_mfma_f32_16x16x32_bf16 v[32:35], a[132:135], a[20:23], v[32:35]
 v_exp_f32 v24, v24
 v_mfma_f32_16x16x32_bf16 v[32:35], a[136:139], a[24:27], v[32:35]
 v_exp_f32 v25, v25
 v_mfma_f32_16x16x32_bf16 v[32:35], a[140:143], a[28:31], v[32:35]
 ds_read_b64_tr_b16 a[180:181], v8 offset:33952
 ds_read_b64_tr_b16 a[182:183], v8 offset:34464
 v_mfma_f32_16x16x32_bf16 v[36:39], a[156:159], a[28:31], 0
 v_exp_f32 v26, v26
 v_mfma_f32_16x16x32_bf16 v[36:39], a[152:155], a[24:27], v[36:39]
 s_mov_b32 s59, 20480
 v_exp_f32 v27, v27
 v_mfma_f32_16x16x32_bf16 v[36:39], a[148:151], a[20:23], v[36:39]
 s_add_u32 m0, s45, 0
 ds_read_b64_tr_b16 a[212:213], v8 offset:50848
 ds_read_b64_tr_b16 a[214:215], v8 offset:51360
 v_mfma_f32_16x16x32_bf16 v[36:39], a[144:147], a[16:19], v[36:39]
 s_waitcnt lgkmcnt(15)
 buffer_load_dwordx4 v1, s[28:31], s59 offen nt lds
 v_mfma_f32_16x16x32_bf16 v[64:67], a[160:163], v[40:43], v[64:67]
 v_exp_f32 v28, v28
 v_mfma_f32_16x16x32_bf16 v[64:67], a[192:195], v[44:47], v[64:67]
 ds_read_b64_tr_b16 a[184:185], v8 offset:33984
 ds_read_b64_tr_b16 a[186:187], v8 offset:34496
 v_mfma_f32_16x16x32_bf16 v[68:71], a[164:167], v[40:43], v[68:71]
 v_cvt_pk_bf16_f32 v48, v24, v25
 v_cvt_pk_bf16_f32 v49, v26, v27
 v_mfma_f32_16x16x32_bf16 v[68:71], a[196:199], v[44:47], v[68:71]
 s_waitcnt lgkmcnt(10)
 v_exp_f32 v29, v29
 v_mfma_f32_16x16x32_bf16 v[72:75], a[168:171], v[40:43], v[72:75]
 ds_read_b64_tr_b16 a[216:217], v8 offset:50880
 ds_read_b64_tr_b16 a[218:219], v8 offset:51392
 v_mfma_f32_16x16x32_bf16 v[72:75], a[200:203], v[44:47], v[72:75]
 v_exp_f32 v30, v30
 v_mfma_f32_16x16x32_bf16 v[76:79], a[172:175], v[40:43], v[76:79]
 v_exp_f32 v31, v31
 v_mfma_f32_16x16x32_bf16 v[76:79], a[204:207], v[44:47], v[76:79]
 ds_read_b64_tr_b16 a[188:189], v8 offset:34016
 ds_read_b64_tr_b16 a[190:191], v8 offset:34528
 v_mfma_f32_16x16x32_bf16 v[24:27], a[96:99], a[32:35], 0
 v_cvt_pk_bf16_f32 v50, v28, v29
 v_cvt_pk_bf16_f32 v51, v30, v31
 v_mfma_f32_16x16x32_bf16 v[24:27], a[100:103], a[36:39], v[24:27]
 v_exp_f32 v32, v32
 v_mfma_f32_16x16x32_bf16 v[24:27], a[104:107], a[40:43], v[24:27]
 ds_read_b64_tr_b16 a[220:221], v8 offset:50912
 ds_read_b64_tr_b16 a[222:223], v8 offset:51424
 v_mfma_f32_16x16x32_bf16 v[24:27], a[108:111], a[44:47], v[24:27]
 s_waitcnt vmcnt(37)
 v_exp_f32 v33, v33
 v_smfmac_f32_16x16x64_bf16 a[224:227], a[236:239], v[40:47], v2
 v_mfma_f32_16x16x32_bf16 v[28:31], a[124:127], a[44:47], 0
 v_exp_f32 v34, v34
 v_mfma_f32_16x16x32_bf16 v[28:31], a[120:123], a[40:43], v[28:31]
 v_exp_f32 v35, v35
 v_mfma_f32_16x16x32_bf16 v[28:31], a[116:119], a[36:39], v[28:31]
 v_exp_f32 v36, v36
 v_mfma_f32_16x16x32_bf16 v[28:31], a[112:115], a[32:35], v[28:31]
 s_waitcnt lgkmcnt(8)
 v_mfma_f32_16x16x32_bf16 v[80:83], a[176:179], v[40:43], v[80:83]
 s_add_u32 m0, s45, 64
 v_cvt_pk_bf16_f32 v52, v32, v33
 v_cvt_pk_bf16_f32 v53, v34, v35
 v_mfma_f32_16x16x32_bf16 v[80:83], a[208:211], v[44:47], v[80:83]
 buffer_load_dwordx4 v1, s[28:31], s59 offen offset:1024 nt lds
 v_mfma_f32_16x16x32_bf16 v[84:87], a[180:183], v[40:43], v[84:87]
 ds_read_b128 a[16:19], v4 offset:17408
 ds_read_b128 a[20:23], v4 offset:17472
 v_mfma_f32_16x16x32_bf16 v[84:87], a[212:215], v[44:47], v[84:87]
 s_waitcnt lgkmcnt(2)
 s_barrier
 v_mfma_f32_16x16x32_bf16 v[88:91], a[184:187], v[40:43], v[88:91]
 v_exp_f32 v37, v37
 v_mfma_f32_16x16x32_bf16 v[88:91], a[216:219], v[44:47], v[88:91]
 v_exp_f32 v38, v38
 v_mfma_f32_16x16x32_bf16 v[92:95], a[188:191], v[40:43], v[92:95]
 v_exp_f32 v39, v39
 v_mfma_f32_16x16x32_bf16 v[92:95], a[220:223], v[44:47], v[92:95]
 v_cvt_pk_bf16_f32 v54, v36, v37
 v_cvt_pk_bf16_f32 v55, v38, v39
 v_mfma_f32_16x16x32_bf16 v[32:35], a[128:131], a[32:35], 0
 v_mfma_f32_16x16x32_bf16 v[32:35], a[132:135], a[36:39], v[32:35]
 v_exp_f32 v24, v24
 v_mfma_f32_16x16x32_bf16 v[32:35], a[136:139], a[40:43], v[32:35]
 v_exp_f32 v25, v25
 v_mfma_f32_16x16x32_bf16 v[32:35], a[140:143], a[44:47], v[32:35]
 v_exp_f32 v26, v26
 v_mfma_f32_16x16x32_bf16 v[36:39], a[156:159], a[44:47], 0
 ds_read_b128 a[24:27], v4 offset:17536
 ds_read_b128 a[28:31], v4 offset:17600
 v_mfma_f32_16x16x32_bf16 v[36:39], a[152:155], a[40:43], v[36:39]
 v_exp_f32 v27, v27
 v_mfma_f32_16x16x32_bf16 v[36:39], a[148:151], a[36:39], v[36:39]
 s_add_u32 m0, s39, 33792
 v_exp_f32 v28, v28
 v_mfma_f32_16x16x32_bf16 v[36:39], a[144:147], a[32:35], v[36:39]
 buffer_load_dwordx4 v1, s[20:23], s33 offen nt lds
 v_mfma_f32_16x16x32_bf16 v[96:99], a[160:163], v[48:51], v[96:99]
 v_cvt_pk_bf16_f32 v40, v24, v25
 v_cvt_pk_bf16_f32 v41, v26, v27
 v_mfma_f32_16x16x32_bf16 v[96:99], a[192:195], v[52:55], v[96:99]
 v_accvgpr_read_b32 v11, a224
 v_accvgpr_read_b32 v10, a225
 v_add_f32 v11, v11, v10
 v_rcp_f32 v10, v11
 v_cmp_nle_f32 vcc, s60, v11
 v_accvgpr_write_b32 a224, 0
 v_accvgpr_write_b32 a225, 0
 v_pk_mul_f32 v[64:65], v[64:65], v[10:11] op_sel_hi:[1,0]
 v_pk_mul_f32 v[66:67], v[66:67], v[10:11] op_sel_hi:[1,0]
 v_pk_mul_f32 v[68:69], v[68:69], v[10:11] op_sel_hi:[1,0]
 v_pk_mul_f32 v[70:71], v[70:71], v[10:11] op_sel_hi:[1,0]
 v_pk_mul_f32 v[72:73], v[72:73], v[10:11] op_sel_hi:[1,0]
 v_pk_mul_f32 v[74:75], v[74:75], v[10:11] op_sel_hi:[1,0]
 v_pk_mul_f32 v[76:77], v[76:77], v[10:11] op_sel_hi:[1,0]
 v_pk_mul_f32 v[78:79], v[78:79], v[10:11] op_sel_hi:[1,0]
 v_pk_mul_f32 v[80:81], v[80:81], v[10:11] op_sel_hi:[1,0]
 v_pk_mul_f32 v[82:83], v[82:83], v[10:11] op_sel_hi:[1,0]
 v_pk_mul_f32 v[84:85], v[84:85], v[10:11] op_sel_hi:[1,0]
 v_pk_mul_f32 v[86:87], v[86:87], v[10:11] op_sel_hi:[1,0]
 v_pk_mul_f32 v[88:89], v[88:89], v[10:11] op_sel_hi:[1,0]
 v_pk_mul_f32 v[90:91], v[90:91], v[10:11] op_sel_hi:[1,0]
 v_pk_mul_f32 v[92:93], v[92:93], v[10:11] op_sel_hi:[1,0]
 v_pk_mul_f32 v[94:95], v[94:95], v[10:11] op_sel_hi:[1,0]
 v_mfma_f32_16x16x32_bf16 v[100:103], a[164:167], v[48:51], v[100:103]
 s_or_b64 s[50:51], s[50:51], vcc
 v_cmp_nge_f32 vcc, s61, v11
 v_add_u32 v12, 17408, v5
 v_mfma_f32_16x16x32_bf16 v[100:103], a[196:199], v[52:55], v[100:103]
 v_exp_f32 v29, v29
 v_mfma_f32_16x16x32_bf16 v[104:107], a[168:171], v[48:51], v[104:107]
 v_exp_f32 v30, v30
 v_mfma_f32_16x16x32_bf16 v[104:107], a[200:203], v[52:55], v[104:107]
 v_cvt_pk_bf16_f32 v64, v64, v65
 v_cvt_pk_bf16_f32 v65, v66, v67
 v_mfma_f32_16x16x32_bf16 v[108:111], a[172:175], v[48:51], v[108:111]
 v_exp_f32 v31, v31
 v_mfma_f32_16x16x32_bf16 v[108:111], a[204:207], v[52:55], v[108:111]
 v_cvt_pk_bf16_f32 v68, v68, v69
 v_cvt_pk_bf16_f32 v69, v70, v71
 v_mfma_f32_16x16x32_bf16 v[24:27], a[96:99], a[48:51], 0
 v_cvt_pk_bf16_f32 v42, v28, v29
 v_cvt_pk_bf16_f32 v43, v30, v31
 v_mfma_f32_16x16x32_bf16 v[24:27], a[100:103], a[52:55], v[24:27]
 v_exp_f32 v32, v32
 v_mfma_f32_16x16x32_bf16 v[24:27], a[104:107], a[56:59], v[24:27]
 v_exp_f32 v33, v33
 v_mfma_f32_16x16x32_bf16 v[24:27], a[108:111], a[60:63], v[24:27]
 v_exp_f32 v34, v34
 v_smfmac_f32_16x16x64_bf16 a[224:227], a[240:243], v[48:55], v2
 s_or_b64 s[50:51], s[50:51], vcc
 ds_write2_b64 v12, v[64:65], v[68:69] offset0:0 offset1:4
 v_mfma_f32_16x16x32_bf16 v[28:31], a[124:127], a[60:63], 0
 v_exp_f32 v35, v35
 v_mfma_f32_16x16x32_bf16 v[28:31], a[120:123], a[56:59], v[28:31]
 v_exp_f32 v36, v36
 v_mfma_f32_16x16x32_bf16 v[28:31], a[116:119], a[52:55], v[28:31]
 s_add_u32 m0, s39, 33824
 v_cvt_pk_bf16_f32 v44, v32, v33
 v_cvt_pk_bf16_f32 v45, v34, v35
 v_mfma_f32_16x16x32_bf16 v[28:31], a[112:115], a[48:51], v[28:31]
 buffer_load_dwordx4 v1, s[20:23], s33 offen offset:1024 nt lds
 v_mfma_f32_16x16x32_bf16 v[112:115], a[176:179], v[48:51], v[112:115]
 s_add_u32 m0, s45, 128
 v_exp_f32 v37, v37
 v_mfma_f32_16x16x32_bf16 v[112:115], a[208:211], v[52:55], v[112:115]
 buffer_load_dwordx4 v1, s[28:31], s59 offen offset:2048 nt lds
 v_mfma_f32_16x16x32_bf16 v[116:119], a[180:183], v[48:51], v[116:119]
 s_waitcnt vmcnt(29)
 ds_read_b128 a[32:35], v4 offset:4352
 ds_read_b128 a[36:39], v4 offset:4416
 v_mfma_f32_16x16x32_bf16 v[116:119], a[212:215], v[52:55], v[116:119]
 v_exp_f32 v38, v38
 v_cvt_pk_bf16_f32 v72, v72, v73
 v_mfma_f32_16x16x32_bf16 v[120:123], a[184:187], v[48:51], v[120:123]
 v_exp_f32 v39, v39
 v_mfma_f32_16x16x32_bf16 v[120:123], a[216:219], v[52:55], v[120:123]
 v_cvt_pk_bf16_f32 v73, v74, v75
 v_cvt_pk_bf16_f32 v76, v76, v77
 v_cvt_pk_bf16_f32 v77, v78, v79
 v_mfma_f32_16x16x32_bf16 v[124:127], a[188:191], v[48:51], v[124:127]
 v_cvt_pk_bf16_f32 v46, v36, v37
 v_cvt_pk_bf16_f32 v47, v38, v39
 v_mfma_f32_16x16x32_bf16 v[124:127], a[220:223], v[52:55], v[124:127]
 ds_write2_b64 v12, v[72:73], v[76:77] offset0:8 offset1:12
 v_mfma_f32_16x16x32_bf16 v[32:35], a[128:131], a[48:51], 0
 v_exp_f32 v24, v24
 v_mfma_f32_16x16x32_bf16 v[32:35], a[132:135], a[52:55], v[32:35]
 v_cvt_pk_bf16_f32 v80, v80, v81
 v_cvt_pk_bf16_f32 v81, v82, v83
 v_mfma_f32_16x16x32_bf16 v[32:35], a[136:139], a[56:59], v[32:35]
 v_exp_f32 v25, v25
 v_mfma_f32_16x16x32_bf16 v[32:35], a[140:143], a[60:63], v[32:35]
 v_exp_f32 v26, v26
 v_mfma_f32_16x16x32_bf16 v[36:39], a[156:159], a[60:63], 0
 v_cvt_pk_bf16_f32 v84, v84, v85
 v_cvt_pk_bf16_f32 v85, v86, v87
 v_mfma_f32_16x16x32_bf16 v[36:39], a[152:155], a[56:59], v[36:39]
 v_exp_f32 v27, v27
 v_mfma_f32_16x16x32_bf16 v[36:39], a[148:151], a[52:55], v[36:39]
 v_exp_f32 v28, v28
 v_mfma_f32_16x16x32_bf16 v[36:39], a[144:147], a[48:51], v[36:39]
 ds_write2_b64 v12, v[80:81], v[84:85] offset0:16 offset1:20
 v_mfma_f32_16x16x32_bf16 v[128:131], a[160:163], v[40:43], v[128:131]
 s_add_u32 m0, s39, 33856
 v_cvt_pk_bf16_f32 v48, v24, v25
 v_cvt_pk_bf16_f32 v49, v26, v27
 v_mfma_f32_16x16x32_bf16 v[128:131], a[192:195], v[44:47], v[128:131]
 buffer_load_dwordx4 v1, s[20:23], s33 offen offset:2048 nt lds
 v_mfma_f32_16x16x32_bf16 v[132:135], a[164:167], v[40:43], v[132:135]
 v_exp_f32 v29, v29
 v_mfma_f32_16x16x32_bf16 v[132:135], a[196:199], v[44:47], v[132:135]
 v_exp_f32 v30, v30
 v_cvt_pk_bf16_f32 v88, v88, v89
 v_mfma_f32_16x16x32_bf16 v[136:139], a[168:171], v[40:43], v[136:139]
 ds_read_b128 a[40:43], v4 offset:4480
 ds_read_b128 a[44:47], v4 offset:4544
 v_mfma_f32_16x16x32_bf16 v[136:139], a[200:203], v[44:47], v[136:139]
 v_exp_f32 v31, v31
 v_cvt_pk_bf16_f32 v89, v90, v91
 v_mfma_f32_16x16x32_bf16 v[140:143], a[172:175], v[40:43], v[140:143]
 v_cvt_pk_bf16_f32 v92, v92, v93
 v_cvt_pk_bf16_f32 v93, v94, v95
 v_mfma_f32_16x16x32_bf16 v[140:143], a[204:207], v[44:47], v[140:143]
 v_cvt_pk_bf16_f32 v50, v28, v29
 v_cvt_pk_bf16_f32 v51, v30, v31
 v_mfma_f32_16x16x32_bf16 v[24:27], a[96:99], a[64:67], 0
 ds_write2_b64 v12, v[88:89], v[92:93] offset0:24 offset1:28
 v_mfma_f32_16x16x32_bf16 v[24:27], a[100:103], a[68:71], v[24:27]
 v_exp_f32 v32, v32
 v_mfma_f32_16x16x32_bf16 v[24:27], a[104:107], a[72:75], v[24:27]
 v_exp_f32 v33, v33
 v_mfma_f32_16x16x32_bf16 v[24:27], a[108:111], a[76:79], v[24:27]
 s_add_u32 m0, s45, 192
 v_accvgpr_read_b32 v11, a226
 v_accvgpr_read_b32 v10, a227
 v_add_f32 v11, v11, v10
 v_rcp_f32 v10, v11
 v_cmp_nle_f32 vcc, s60, v11
 v_accvgpr_write_b32 a226, 0
 v_accvgpr_write_b32 a227, 0
 v_pk_mul_f32 v[96:97], v[96:97], v[10:11] op_sel_hi:[1,0]
 v_pk_mul_f32 v[98:99], v[98:99], v[10:11] op_sel_hi:[1,0]
 v_pk_mul_f32 v[100:101], v[100:101], v[10:11] op_sel_hi:[1,0]
 v_pk_mul_f32 v[102:103], v[102:103], v[10:11] op_sel_hi:[1,0]
 v_pk_mul_f32 v[104:105], v[104:105], v[10:11] op_sel_hi:[1,0]
 v_pk_mul_f32 v[106:107], v[106:107], v[10:11] op_sel_hi:[1,0]
 v_pk_mul_f32 v[108:109], v[108:109], v[10:11] op_sel_hi:[1,0]
 v_pk_mul_f32 v[110:111], v[110:111], v[10:11] op_sel_hi:[1,0]
 v_pk_mul_f32 v[112:113], v[112:113], v[10:11] op_sel_hi:[1,0]
 v_pk_mul_f32 v[114:115], v[114:115], v[10:11] op_sel_hi:[1,0]
 v_pk_mul_f32 v[116:117], v[116:117], v[10:11] op_sel_hi:[1,0]
 v_pk_mul_f32 v[118:119], v[118:119], v[10:11] op_sel_hi:[1,0]
 v_pk_mul_f32 v[120:121], v[120:121], v[10:11] op_sel_hi:[1,0]
 v_pk_mul_f32 v[122:123], v[122:123], v[10:11] op_sel_hi:[1,0]
 v_pk_mul_f32 v[124:125], v[124:125], v[10:11] op_sel_hi:[1,0]
 v_pk_mul_f32 v[126:127], v[126:127], v[10:11] op_sel_hi:[1,0]
 v_smfmac_f32_16x16x64_bf16 a[228:231], a[236:239], v[40:47], v2
 buffer_load_dwordx4 v1, s[28:31], s59 offen offset:3072 nt lds
 v_mfma_f32_16x16x32_bf16 v[28:31], a[124:127], a[76:79], 0
 s_or_b64 s[50:51], s[50:51], vcc
 v_exp_f32 v34, v34
 v_mfma_f32_16x16x32_bf16 v[28:31], a[120:123], a[72:75], v[28:31]
 v_exp_f32 v35, v35
 v_mfma_f32_16x16x32_bf16 v[28:31], a[116:119], a[68:71], v[28:31]
 v_exp_f32 v36, v36
 v_mfma_f32_16x16x32_bf16 v[28:31], a[112:115], a[64:67], v[28:31]
 v_cmp_nge_f32 vcc, s61, v11
 v_add_u32 v12, 4352, v5
 v_cvt_pk_bf16_f32 v96, v96, v97
 v_mfma_f32_16x16x32_bf16 v[144:147], a[176:179], v[40:43], v[144:147]
 s_add_u32 m0, s39, 33888
 v_cvt_pk_bf16_f32 v52, v32, v33
 v_cvt_pk_bf16_f32 v53, v34, v35
 v_mfma_f32_16x16x32_bf16 v[144:147], a[208:211], v[44:47], v[144:147]
 buffer_load_dwordx4 v1, s[20:23], s33 offen offset:3072 nt lds
 v_mfma_f32_16x16x32_bf16 v[148:151], a[180:183], v[40:43], v[148:151]
 s_add_u32 s33, s33, 8192
 v_exp_f32 v37, v37
 v_mfma_f32_16x16x32_bf16 v[148:151], a[212:215], v[44:47], v[148:151]
 v_exp_f32 v38, v38
 v_cvt_pk_bf16_f32 v97, v98, v99
 v_mfma_f32_16x16x32_bf16 v[152:155], a[184:187], v[40:43], v[152:155]
 v_exp_f32 v39, v39
 v_mfma_f32_16x16x32_bf16 v[152:155], a[216:219], v[44:47], v[152:155]
 s_waitcnt vmcnt(20)
 ds_read_b128 a[48:51], v4 offset:8704
 ds_read_b128 a[52:55], v4 offset:8768
 v_mfma_f32_16x16x32_bf16 v[156:159], a[188:191], v[40:43], v[156:159]
 v_cvt_pk_bf16_f32 v100, v100, v101
 v_cvt_pk_bf16_f32 v101, v102, v103
 v_mfma_f32_16x16x32_bf16 v[156:159], a[220:223], v[44:47], v[156:159]
 s_or_b64 s[50:51], s[50:51], vcc
 ds_write2_b64 v12, v[96:97], v[100:101] offset0:0 offset1:4
 v_cvt_pk_bf16_f32 v54, v36, v37
 v_cvt_pk_bf16_f32 v55, v38, v39
 v_mfma_f32_16x16x32_bf16 v[32:35], a[128:131], a[64:67], 0
 v_cvt_pk_bf16_f32 v104, v104, v105
 v_cvt_pk_bf16_f32 v105, v106, v107
 v_mfma_f32_16x16x32_bf16 v[32:35], a[132:135], a[68:71], v[32:35]
 v_exp_f32 v24, v24
 v_mfma_f32_16x16x32_bf16 v[32:35], a[136:139], a[72:75], v[32:35]
 v_exp_f32 v25, v25
 v_mfma_f32_16x16x32_bf16 v[32:35], a[140:143], a[76:79], v[32:35]
 v_exp_f32 v26, v26
 v_mfma_f32_16x16x32_bf16 v[36:39], a[156:159], a[76:79], 0
 v_cvt_pk_bf16_f32 v108, v108, v109
 v_cvt_pk_bf16_f32 v109, v110, v111
 v_mfma_f32_16x16x32_bf16 v[36:39], a[152:155], a[72:75], v[36:39]
 v_exp_f32 v27, v27
 v_mfma_f32_16x16x32_bf16 v[36:39], a[148:151], a[68:71], v[36:39]
 v_exp_f32 v28, v28
 v_mfma_f32_16x16x32_bf16 v[36:39], a[144:147], a[64:67], v[36:39]
 ds_write2_b64 v12, v[104:105], v[108:109] offset0:8 offset1:12
 v_mfma_f32_16x16x32_bf16 v[160:163], a[160:163], v[48:51], v[160:163]
 v_cvt_pk_bf16_f32 v40, v24, v25
 v_cvt_pk_bf16_f32 v41, v26, v27
 v_mfma_f32_16x16x32_bf16 v[160:163], a[192:195], v[52:55], v[160:163]
 v_cvt_pk_bf16_f32 v112, v112, v113
 v_cvt_pk_bf16_f32 v113, v114, v115
 v_mfma_f32_16x16x32_bf16 v[164:167], a[164:167], v[48:51], v[164:167]
 s_add_u32 m0, s39, 50688
 v_exp_f32 v29, v29
 v_mfma_f32_16x16x32_bf16 v[164:167], a[196:199], v[52:55], v[164:167]
 buffer_load_dwordx4 v1, s[20:23], s33 offen nt lds
 v_mfma_f32_16x16x32_bf16 v[168:171], a[168:171], v[48:51], v[168:171]
 v_exp_f32 v30, v30
 v_mfma_f32_16x16x32_bf16 v[168:171], a[200:203], v[52:55], v[168:171]
 v_exp_f32 v31, v31
 v_mfma_f32_16x16x32_bf16 v[172:175], a[172:175], v[48:51], v[172:175]
 v_cvt_pk_bf16_f32 v116, v116, v117
 v_cvt_pk_bf16_f32 v117, v118, v119
 v_mfma_f32_16x16x32_bf16 v[172:175], a[204:207], v[52:55], v[172:175]
 ds_write2_b64 v12, v[112:113], v[116:117] offset0:16 offset1:20
 v_cvt_pk_bf16_f32 v42, v28, v29
 v_cvt_pk_bf16_f32 v43, v30, v31
 v_mfma_f32_16x16x32_bf16 v[24:27], a[96:99], a[80:83], 0
 v_cvt_pk_bf16_f32 v120, v120, v121
 v_cvt_pk_bf16_f32 v121, v122, v123
 v_mfma_f32_16x16x32_bf16 v[24:27], a[100:103], a[84:87], v[24:27]
 v_exp_f32 v32, v32
 v_mfma_f32_16x16x32_bf16 v[24:27], a[104:107], a[88:91], v[24:27]
 v_exp_f32 v33, v33
 v_mfma_f32_16x16x32_bf16 v[24:27], a[108:111], a[92:95], v[24:27]
 v_exp_f32 v34, v34
 v_cvt_pk_bf16_f32 v124, v124, v125
 v_cvt_pk_bf16_f32 v125, v126, v127
 v_smfmac_f32_16x16x64_bf16 a[228:231], a[240:243], v[48:55], v2
 ds_write2_b64 v12, v[120:121], v[124:125] offset0:24 offset1:28
 v_mfma_f32_16x16x32_bf16 v[28:31], a[124:127], a[92:95], 0
 ds_read_b128 a[56:59], v4 offset:8832
 ds_read_b128 a[60:63], v4 offset:8896
 v_mfma_f32_16x16x32_bf16 v[28:31], a[120:123], a[88:91], v[28:31]
 v_exp_f32 v35, v35
 v_mfma_f32_16x16x32_bf16 v[28:31], a[116:119], a[84:87], v[28:31]
 v_exp_f32 v36, v36
 v_mfma_f32_16x16x32_bf16 v[28:31], a[112:115], a[80:83], v[28:31]
 s_waitcnt vmcnt(9)
 s_barrier
 v_mfma_f32_16x16x32_bf16 v[176:179], a[176:179], v[48:51], v[176:179]
 v_cvt_pk_bf16_f32 v44, v32, v33
 v_cvt_pk_bf16_f32 v45, v34, v35
 v_mfma_f32_16x16x32_bf16 v[176:179], a[208:211], v[52:55], v[176:179]
 v_exp_f32 v37, v37
 v_mfma_f32_16x16x32_bf16 v[180:183], a[180:183], v[48:51], v[180:183]
 s_add_u32 m0, s39, 50720
 ds_read_b128 a[96:99], v7 offset:0
 ds_read_b128 a[100:103], v7 offset:64
 v_mfma_f32_16x16x32_bf16 v[180:183], a[212:215], v[52:55], v[180:183]
 buffer_load_dwordx4 v1, s[20:23], s33 offen offset:1024 nt lds
 v_mfma_f32_16x16x32_bf16 v[184:187], a[184:187], v[48:51], v[184:187]
 v_exp_f32 v38, v38
 v_mfma_f32_16x16x32_bf16 v[184:187], a[216:219], v[52:55], v[184:187]
 v_accvgpr_read_b32 v11, a228
 v_accvgpr_read_b32 v10, a229
 v_add_f32 v11, v11, v10
 v_rcp_f32 v10, v11
 v_cmp_nle_f32 vcc, s60, v11
 v_accvgpr_write_b32 a228, 0
 v_accvgpr_write_b32 a229, 0
 v_pk_mul_f32 v[128:129], v[128:129], v[10:11] op_sel_hi:[1,0]
 v_pk_mul_f32 v[130:131], v[130:131], v[10:11] op_sel_hi:[1,0]
 v_pk_mul_f32 v[132:133], v[132:133], v[10:11] op_sel_hi:[1,0]
 v_pk_mul_f32 v[134:135], v[134:135], v[10:11] op_sel_hi:[1,0]
 v_pk_mul_f32 v[136:137], v[136:137], v[10:11] op_sel_hi:[1,0]
 v_pk_mul_f32 v[138:139], v[138:139], v[10:11] op_sel_hi:[1,0]
 v_pk_mul_f32 v[140:141], v[140:141], v[10:11] op_sel_hi:[1,0]
 v_pk_mul_f32 v[142:143], v[142:143], v[10:11] op_sel_hi:[1,0]
 v_pk_mul_f32 v[144:145], v[144:145], v[10:11] op_sel_hi:[1,0]
 v_pk_mul_f32 v[146:147], v[146:147], v[10:11] op_sel_hi:[1,0]
 v_pk_mul_f32 v[148:149], v[148:149], v[10:11] op_sel_hi:[1,0]
 v_pk_mul_f32 v[150:151], v[150:151], v[10:11] op_sel_hi:[1,0]
 v_pk_mul_f32 v[152:153], v[152:153], v[10:11] op_sel_hi:[1,0]
 v_pk_mul_f32 v[154:155], v[154:155], v[10:11] op_sel_hi:[1,0]
 v_pk_mul_f32 v[156:157], v[156:157], v[10:11] op_sel_hi:[1,0]
 v_pk_mul_f32 v[158:159], v[158:159], v[10:11] op_sel_hi:[1,0]
 v_mfma_f32_16x16x32_bf16 v[188:191], a[188:191], v[48:51], v[188:191]
 ds_read_b128 a[104:107], v7 offset:128
 ds_read_b128 a[108:111], v7 offset:192
 v_mfma_f32_16x16x32_bf16 v[188:191], a[220:223], v[52:55], v[188:191]
 s_or_b64 s[50:51], s[50:51], vcc
 v_exp_f32 v39, v39
 v_cmp_nge_f32 vcc, s61, v11
 v_mfma_f32_16x16x32_bf16 v[32:35], a[128:131], a[80:83], 0
 v_cvt_pk_bf16_f32 v46, v36, v37
 v_cvt_pk_bf16_f32 v47, v38, v39
 v_mfma_f32_16x16x32_bf16 v[32:35], a[132:135], a[84:87], v[32:35]
 v_exp_f32 v24, v24
 v_mfma_f32_16x16x32_bf16 v[32:35], a[136:139], a[88:91], v[32:35]
 ds_read_b128 a[124:127], v7 offset:704
 ds_read_b128 a[120:123], v7 offset:640
 v_mfma_f32_16x16x32_bf16 v[32:35], a[140:143], a[92:95], v[32:35]
 s_waitcnt vmcnt(13)
 ds_read_b128 a[64:67], v4 offset:13056
 ds_read_b128 a[68:71], v4 offset:13120
 v_add_u32 v12, 8704, v5
 v_mfma_f32_16x16x32_bf16 v[36:39], a[156:159], a[92:95], 0
 v_exp_f32 v25, v25
 v_mfma_f32_16x16x32_bf16 v[36:39], a[152:155], a[88:91], v[36:39]
 v_exp_f32 v26, v26
 v_mfma_f32_16x16x32_bf16 v[36:39], a[148:151], a[84:87], v[36:39]
 ds_read_b128 a[116:119], v7 offset:576
 ds_read_b128 a[112:115], v7 offset:512
 v_mfma_f32_16x16x32_bf16 v[36:39], a[144:147], a[80:83], v[36:39]
 v_exp_f32 v27, v27
 v_cvt_pk_bf16_f32 v128, v128, v129
 v_cvt_pk_bf16_f32 v129, v130, v131
 v_mfma_f32_16x16x32_bf16 v[192:195], a[160:163], v[40:43], v[192:195]
 v_exp_f32 v28, v28
 v_mfma_f32_16x16x32_bf16 v[192:195], a[192:195], v[44:47], v[192:195]
 v_cvt_pk_bf16_f32 v48, v24, v25
 v_cvt_pk_bf16_f32 v49, v26, v27
 v_cvt_pk_bf16_f32 v132, v132, v133
 v_cvt_pk_bf16_f32 v133, v134, v135
 v_mfma_f32_16x16x32_bf16 v[196:199], a[164:167], v[40:43], v[196:199]
 s_or_b64 s[50:51], s[50:51], vcc
 v_exp_f32 v29, v29
 v_mfma_f32_16x16x32_bf16 v[196:199], a[196:199], v[44:47], v[196:199]
 ds_read_b128 a[128:131], v7 offset:16896
 ds_read_b128 a[132:135], v7 offset:16960
 ds_write2_b64 v12, v[128:129], v[132:133] offset0:0 offset1:4
 v_mfma_f32_16x16x32_bf16 v[200:203], a[168:171], v[40:43], v[200:203]
 s_add_u32 m0, s39, 50752
 v_exp_f32 v30, v30
 v_mfma_f32_16x16x32_bf16 v[200:203], a[200:203], v[44:47], v[200:203]
L_pg1_6:
 s_cbranch_execz L_pg1_10
 buffer_load_dwordx4 v1, s[20:23], s33 offen offset:2048 nt lds
 v_mfma_f32_16x16x32_bf16 v[204:207], a[172:175], v[40:43], v[204:207]
 v_exp_f32 v31, v31
 v_mfma_f32_16x16x32_bf16 v[204:207], a[204:207], v[44:47], v[204:207]
 s_waitcnt lgkmcnt(9)
 ds_read_b128 a[136:139], v7 offset:17024
 ds_read_b128 a[140:143], v7 offset:17088
 v_cvt_pk_bf16_f32 v136, v136, v137
 v_cvt_pk_bf16_f32 v137, v138, v139
 v_mfma_f32_16x16x32_bf16 v[24:27], a[96:99], a[0:3], 0
 v_cvt_pk_bf16_f32 v50, v28, v29
 v_cvt_pk_bf16_f32 v51, v30, v31
 v_mfma_f32_16x16x32_bf16 v[24:27], a[100:103], a[4:7], v[24:27]
 v_exp_f32 v32, v32
 v_mfma_f32_16x16x32_bf16 v[24:27], a[104:107], a[8:11], v[24:27]
 v_exp_f32 v33, v33
 v_mfma_f32_16x16x32_bf16 v[24:27], a[108:111], a[12:15], v[24:27]
 s_waitcnt lgkmcnt(5)
 ds_read_b128 a[156:159], v7 offset:17600
 ds_read_b128 a[152:155], v7 offset:17536
 v_cvt_pk_bf16_f32 v140, v140, v141
 v_cvt_pk_bf16_f32 v141, v142, v143
 v_smfmac_f32_16x16x64_bf16 a[232:235], a[236:239], v[40:47], v2
 ds_write2_b64 v12, v[136:137], v[140:141] offset0:8 offset1:12
 v_exp_f32 v34, v34
 v_mfma_f32_16x16x32_bf16 v[28:31], a[124:127], a[12:15], 0
 v_exp_f32 v35, v35
 v_mfma_f32_16x16x32_bf16 v[28:31], a[120:123], a[8:11], v[28:31]
 v_exp_f32 v36, v36
 v_mfma_f32_16x16x32_bf16 v[28:31], a[116:119], a[4:7], v[28:31]
 ds_read_b128 a[148:151], v7 offset:17472
 ds_read_b128 a[144:147], v7 offset:17408
 v_mfma_f32_16x16x32_bf16 v[28:31], a[112:115], a[0:3], v[28:31]
 v_cvt_pk_bf16_f32 v52, v32, v33
 v_cvt_pk_bf16_f32 v53, v34, v35
 v_cvt_pk_bf16_f32 v144, v144, v145
 v_mfma_f32_16x16x32_bf16 v[208:211], a[176:179], v[40:43], v[208:211]
 v_exp_f32 v37, v37
 v_mfma_f32_16x16x32_bf16 v[208:211], a[208:211], v[44:47], v[208:211]
 v_exp_f32 v38, v38
 v_cvt_pk_bf16_f32 v145, v146, v147
 v_mfma_f32_16x16x32_bf16 v[212:215], a[180:183], v[40:43], v[212:215]
 s_add_u32 m0, s39, 50784
 v_exp_f32 v39, v39
 v_mfma_f32_16x16x32_bf16 v[212:215], a[212:215], v[44:47], v[212:215]
 buffer_load_dwordx4 v1, s[20:23], s33 offen offset:3072 nt lds
 v_mfma_f32_16x16x32_bf16 v[216:219], a[184:187], v[40:43], v[216:219]
 s_add_u32 s33, s33, 8192
 v_cvt_pk_bf16_f32 v54, v36, v37
 v_cvt_pk_bf16_f32 v55, v38, v39
 v_mfma_f32_16x16x32_bf16 v[216:219], a[216:219], v[44:47], v[216:219]
 v_mul_f32 v24, s32, v24
 v_mul_f32 v25, s32, v25
 v_exp_f32 v24, v24
 v_mfma_f32_16x16x32_bf16 v[220:223], a[188:191], v[40:43], v[220:223]
 v_exp_f32 v25, v25
 v_mfma_f32_16x16x32_bf16 v[220:223], a[220:223], v[44:47], v[220:223]
 s_waitcnt lgkmcnt(5)
 v_mul_f32 v26, s32, v26
 v_mul_f32 v27, s32, v27
 v_cvt_pk_bf16_f32 v148, v148, v149
 v_cvt_pk_bf16_f32 v149, v150, v151
 v_mfma_f32_16x16x32_bf16 v[32:35], a[128:131], a[0:3], 0
 v_exp_f32 v26, v26
 v_mfma_f32_16x16x32_bf16 v[32:35], a[132:135], a[4:7], v[32:35]
 v_exp_f32 v27, v27
 v_mfma_f32_16x16x32_bf16 v[32:35], a[136:139], a[8:11], v[32:35]
 v_mul_f32 v28, s32, v28
 v_mul_f32 v29, s32, v29
 v_mfma_f32_16x16x32_bf16 v[32:35], a[140:143], a[12:15], v[32:35]
 s_waitcnt lgkmcnt(0)
 ds_read_b128 a[72:75], v4 offset:13184
 ds_read_b128 a[76:79], v4 offset:13248
 ds_write2_b64 v12, v[144:145], v[148:149] offset0:16 offset1:20
 v_mfma_f32_16x16x32_bf16 v[36:39], a[156:159], a[12:15], 0
 v_cvt_pk_bf16_f32 v40, v24, v25
 v_cvt_pk_bf16_f32 v41, v26, v27
 v_mfma_f32_16x16x32_bf16 v[36:39], a[152:155], a[8:11], v[36:39]
 v_exp_f32 v28, v28
 v_mfma_f32_16x16x32_bf16 v[36:39], a[148:151], a[4:7], v[36:39]
 v_exp_f32 v29, v29
 v_mfma_f32_16x16x32_bf16 v[36:39], a[144:147], a[0:3], v[36:39]
 v_mul_f32 v30, s32, v30
 v_mul_f32 v31, s32, v31
 v_cvt_pk_bf16_f32 v152, v152, v153
 v_cvt_pk_bf16_f32 v153, v154, v155
 v_mfma_f32_16x16x32_bf16 v[224:227], a[160:163], v[48:51], v[224:227]
 v_exp_f32 v30, v30
 v_mfma_f32_16x16x32_bf16 v[224:227], a[192:195], v[52:55], v[224:227]
 v_exp_f32 v31, v31
 v_cvt_pk_bf16_f32 v156, v156, v157
 v_cvt_pk_bf16_f32 v157, v158, v159
 v_mfma_f32_16x16x32_bf16 v[228:231], a[164:167], v[48:51], v[228:231]
 ds_read_b64_tr_b16 a[160:161], v8 offset:0
 ds_read_b64_tr_b16 a[162:163], v8 offset:512
 v_mfma_f32_16x16x32_bf16 v[228:231], a[196:199], v[52:55], v[228:231]
 ds_write2_b64 v12, v[152:153], v[156:157] offset0:24 offset1:28
 v_cvt_pk_bf16_f32 v42, v28, v29
 v_cvt_pk_bf16_f32 v43, v30, v31
 v_mfma_f32_16x16x32_bf16 v[232:235], a[168:171], v[48:51], v[232:235]
 ds_read_b64_tr_b16 a[192:193], v8 offset:16896
 ds_read_b64_tr_b16 a[194:195], v8 offset:17408
 v_mfma_f32_16x16x32_bf16 v[232:235], a[200:203], v[52:55], v[232:235]
 v_mul_f32 v32, s32, v32
 v_mul_f32 v33, s32, v33
 v_exp_f32 v32, v32
 v_mfma_f32_16x16x32_bf16 v[236:239], a[172:175], v[48:51], v[236:239]
 s_waitcnt lgkmcnt(15)
 v_exp_f32 v33, v33
 v_mfma_f32_16x16x32_bf16 v[236:239], a[204:207], v[52:55], v[236:239]
 ds_read_b64_tr_b16 a[164:165], v8 offset:32
 ds_read_b64_tr_b16 a[166:167], v8 offset:544
 v_mul_f32 v34, s32, v34
 v_mul_f32 v35, s32, v35
 v_mfma_f32_16x16x32_bf16 v[24:27], a[96:99], a[16:19], 0
 v_accvgpr_read_b32 v11, a230
 v_accvgpr_read_b32 v10, a231
 v_add_f32 v11, v11, v10
 v_rcp_f32 v10, v11
 v_cmp_nle_f32 vcc, s60, v11
 v_accvgpr_write_b32 a230, 0
 v_accvgpr_write_b32 a231, 0
 v_pk_mul_f32 v[160:161], v[160:161], v[10:11] op_sel_hi:[1,0]
 v_pk_mul_f32 v[162:163], v[162:163], v[10:11] op_sel_hi:[1,0]
 v_pk_mul_f32 v[164:165], v[164:165], v[10:11] op_sel_hi:[1,0]
 v_pk_mul_f32 v[166:167], v[166:167], v[10:11] op_sel_hi:[1,0]
 v_pk_mul_f32 v[168:169], v[168:169], v[10:11] op_sel_hi:[1,0]
 v_pk_mul_f32 v[170:171], v[170:171], v[10:11] op_sel_hi:[1,0]
 v_pk_mul_f32 v[172:173], v[172:173], v[10:11] op_sel_hi:[1,0]
 v_pk_mul_f32 v[174:175], v[174:175], v[10:11] op_sel_hi:[1,0]
 v_pk_mul_f32 v[176:177], v[176:177], v[10:11] op_sel_hi:[1,0]
 v_pk_mul_f32 v[178:179], v[178:179], v[10:11] op_sel_hi:[1,0]
 v_pk_mul_f32 v[180:181], v[180:181], v[10:11] op_sel_hi:[1,0]
 v_pk_mul_f32 v[182:183], v[182:183], v[10:11] op_sel_hi:[1,0]
 v_pk_mul_f32 v[184:185], v[184:185], v[10:11] op_sel_hi:[1,0]
 v_pk_mul_f32 v[186:187], v[186:187], v[10:11] op_sel_hi:[1,0]
 v_pk_mul_f32 v[188:189], v[188:189], v[10:11] op_sel_hi:[1,0]
 v_pk_mul_f32 v[190:191], v[190:191], v[10:11] op_sel_hi:[1,0]
 v_mfma_f32_16x16x32_bf16 v[24:27], a[100:103], a[20:23], v[24:27]
 ds_read_b64_tr_b16 a[196:197], v8 offset:16928
 ds_read_b64_tr_b16 a[198:199], v8 offset:17440
 v_mfma_f32_16x16x32_bf16 v[24:27], a[104:107], a[24:27], v[24:27]
 s_or_b64 s[50:51], s[50:51], vcc
 v_exp_f32 v34, v34
 v_mfma_f32_16x16x32_bf16 v[24:27], a[108:111], a[28:31], v[24:27]
 ds_read_b64_tr_b16 a[168:169], v8 offset:64
 ds_read_b64_tr_b16 a[170:171], v8 offset:576
 v_exp_f32 v35, v35
 v_cmp_nge_f32 vcc, s61, v11
 v_add_u32 v12, 13056, v5
 v_cvt_pk_bf16_f32 v160, v160, v161
 v_cvt_pk_bf16_f32 v161, v162, v163
 v_cvt_pk_bf16_f32 v164, v164, v165
 v_cvt_pk_bf16_f32 v165, v166, v167
 v_smfmac_f32_16x16x64_bf16 a[232:235], a[240:243], v[48:55], v2
 s_or_b64 s[50:51], s[50:51], vcc
 ds_write2_b64 v12, v[160:161], v[164:165] offset0:0 offset1:4
 v_mul_f32 v36, s32, v36
 v_mul_f32 v37, s32, v37
 v_cvt_pk_bf16_f32 v44, v32, v33
 v_mfma_f32_16x16x32_bf16 v[28:31], a[124:127], a[28:31], 0
 ds_read_b64_tr_b16 a[200:201], v8 offset:16960
 ds_read_b64_tr_b16 a[202:203], v8 offset:17472
 v_mfma_f32_16x16x32_bf16 v[28:31], a[120:123], a[24:27], v[28:31]
 ds_read_b128 v[56:59], v6 offset:19584
 v_cvt_pk_bf16_f32 v45, v34, v35
 v_mfma_f32_16x16x32_bf16 v[28:31], a[116:119], a[20:23], v[28:31]
 v_exp_f32 v36, v36
 v_mfma_f32_16x16x32_bf16 v[28:31], a[112:115], a[16:19], v[28:31]
 ds_read_b64_tr_b16 a[172:173], v8 offset:96
 ds_read_b64_tr_b16 a[174:175], v8 offset:608
 v_exp_f32 v37, v37
 v_mfma_f32_16x16x32_bf16 v[240:243], a[176:179], v[48:51], v[240:243]
 v_mul_f32 v38, s32, v38
 v_mul_f32 v39, s32, v39
 v_mfma_f32_16x16x32_bf16 v[240:243], a[208:211], v[52:55], v[240:243]
 ds_read_b64_tr_b16 a[204:205], v8 offset:16992
 ds_read_b64_tr_b16 a[206:207], v8 offset:17504
 v_mfma_f32_16x16x32_bf16 v[244:247], a[180:183], v[48:51], v[244:247]
 v_exp_f32 v38, v38
 v_mfma_f32_16x16x32_bf16 v[244:247], a[212:215], v[52:55], v[244:247]
 v_exp_f32 v39, v39
 v_mfma_f32_16x16x32_bf16 v[248:251], a[184:187], v[48:51], v[248:251]
 v_cvt_pk_bf16_f32 v46, v36, v37
 v_cvt_pk_bf16_f32 v47, v38, v39
 v_mfma_f32_16x16x32_bf16 v[248:251], a[216:219], v[52:55], v[248:251]
 ds_read_b64_tr_b16 a[176:177], v8 offset:128
 ds_read_b64_tr_b16 a[178:179], v8 offset:640
 v_mfma_f32_16x16x32_bf16 v[252:255], a[188:191], v[48:51], v[252:255]
 s_mov_b32 s38, 2048
 v_mul_f32 v24, s32, v24
 v_mul_f32 v25, s32, v25
 v_mfma_f32_16x16x32_bf16 v[252:255], a[220:223], v[52:55], v[252:255]
 s_waitcnt lgkmcnt(6)
 buffer_store_dwordx4 v[56:59], v1, s[24:27], s38 offen sc1 nt
 v_mfma_f32_16x16x32_bf16 v[32:35], a[128:131], a[16:19], 0
 ds_read_b64_tr_b16 a[208:209], v8 offset:17024
 ds_read_b64_tr_b16 a[210:211], v8 offset:17536
 v_mfma_f32_16x16x32_bf16 v[32:35], a[132:135], a[20:23], v[32:35]
 v_exp_f32 v24, v24
 v_mfma_f32_16x16x32_bf16 v[32:35], a[136:139], a[24:27], v[32:35]
 v_exp_f32 v25, v25
 v_mfma_f32_16x16x32_bf16 v[32:35], a[140:143], a[28:31], v[32:35]
 ds_read_b64_tr_b16 a[180:181], v8 offset:160
 ds_read_b64_tr_b16 a[182:183], v8 offset:672
 v_mfma_f32_16x16x32_bf16 v[36:39], a[156:159], a[28:31], 0
 v_mul_f32 v26, s32, v26
 v_mul_f32 v27, s32, v27
 v_mfma_f32_16x16x32_bf16 v[36:39], a[152:155], a[24:27], v[36:39]
 v_exp_f32 v26, v26
 v_mfma_f32_16x16x32_bf16 v[36:39], a[148:151], a[20:23], v[36:39]
 ds_read_b64_tr_b16 a[212:213], v8 offset:17056
 ds_read_b64_tr_b16 a[214:215], v8 offset:17568
 v_mfma_f32_16x16x32_bf16 v[36:39], a[144:147], a[16:19], v[36:39]
 s_waitcnt lgkmcnt(15)
 v_exp_f32 v27, v27
 v_mul_f32 v28, s32, v28
 v_mfma_f32_16x16x32_bf16 v[64:67], a[160:163], v[40:43], 0
 v_mul_f32 v29, s32, v29
 v_cvt_pk_bf16_f32 v48, v24, v25
 v_mfma_f32_16x16x32_bf16 v[64:67], a[192:195], v[44:47], v[64:67]
 ds_read_b64_tr_b16 a[184:185], v8 offset:192
 ds_read_b64_tr_b16 a[186:187], v8 offset:704
 v_cvt_pk_bf16_f32 v49, v26, v27
 v_mfma_f32_16x16x32_bf16 v[68:71], a[164:167], v[40:43], 0
 v_exp_f32 v28, v28
 v_mfma_f32_16x16x32_bf16 v[68:71], a[196:199], v[44:47], v[68:71]
 s_waitcnt lgkmcnt(10)
 v_exp_f32 v29, v29
 v_cvt_pk_bf16_f32 v168, v168, v169
 v_mfma_f32_16x16x32_bf16 v[72:75], a[168:171], v[40:43], 0
 ds_read_b64_tr_b16 a[216:217], v8 offset:17088
 ds_read_b64_tr_b16 a[218:219], v8 offset:17600
 v_mfma_f32_16x16x32_bf16 v[72:75], a[200:203], v[44:47], v[72:75]
 v_mul_f32 v30, s32, v30
 v_mul_f32 v31, s32, v31
 v_cvt_pk_bf16_f32 v169, v170, v171
 v_mfma_f32_16x16x32_bf16 v[76:79], a[172:175], v[40:43], 0
 s_waitcnt lgkmcnt(15)
 v_exp_f32 v30, v30
 v_mfma_f32_16x16x32_bf16 v[76:79], a[204:207], v[44:47], v[76:79]
 ds_read_b64_tr_b16 a[188:189], v8 offset:224
 ds_read_b64_tr_b16 a[190:191], v8 offset:736
 v_cvt_pk_bf16_f32 v172, v172, v173
 v_mfma_f32_16x16x32_bf16 v[24:27], a[96:99], a[32:35], 0
 v_exp_f32 v31, v31
 v_mfma_f32_16x16x32_bf16 v[24:27], a[100:103], a[36:39], v[24:27]
 v_cvt_pk_bf16_f32 v50, v28, v29
 v_cvt_pk_bf16_f32 v51, v30, v31
 v_mfma_f32_16x16x32_bf16 v[24:27], a[104:107], a[40:43], v[24:27]
 ds_read_b64_tr_b16 a[220:221], v8 offset:17120
 ds_read_b64_tr_b16 a[222:223], v8 offset:17632
 v_mfma_f32_16x16x32_bf16 v[24:27], a[108:111], a[44:47], v[24:27]
 v_mul_f32 v32, s32, v32
 v_mul_f32 v33, s32, v33
 v_cvt_pk_bf16_f32 v173, v174, v175
 v_smfmac_f32_16x16x64_bf16 a[224:227], a[236:239], v[40:47], v2
 ds_write2_b64 v12, v[168:169], v[172:173] offset0:8 offset1:12
 v_mfma_f32_16x16x32_bf16 v[28:31], a[124:127], a[44:47], 0
 v_exp_f32 v32, v32
 v_mfma_f32_16x16x32_bf16 v[28:31], a[120:123], a[40:43], v[28:31]
 v_exp_f32 v33, v33
 v_mfma_f32_16x16x32_bf16 v[28:31], a[116:119], a[36:39], v[28:31]
 v_mul_f32 v34, s32, v34
 v_mul_f32 v35, s32, v35
 v_mfma_f32_16x16x32_bf16 v[28:31], a[112:115], a[32:35], v[28:31]
 s_waitcnt lgkmcnt(9)
 v_exp_f32 v34, v34
 v_cvt_pk_bf16_f32 v176, v176, v177
 v_mfma_f32_16x16x32_bf16 v[80:83], a[176:179], v[40:43], 0
 v_exp_f32 v35, v35
 v_mfma_f32_16x16x32_bf16 v[80:83], a[208:211], v[44:47], v[80:83]
 v_mul_f32 v36, s32, v36
 v_mul_f32 v37, s32, v37
 v_cvt_pk_bf16_f32 v177, v178, v179
 v_mfma_f32_16x16x32_bf16 v[84:87], a[180:183], v[40:43], 0
 v_cvt_pk_bf16_f32 v52, v32, v33
 v_cvt_pk_bf16_f32 v53, v34, v35
 v_mfma_f32_16x16x32_bf16 v[84:87], a[212:215], v[44:47], v[84:87]
 s_waitcnt lgkmcnt(1)
 s_barrier
 v_mfma_f32_16x16x32_bf16 v[88:91], a[184:187], v[40:43], 0
 v_exp_f32 v36, v36
 v_mfma_f32_16x16x32_bf16 v[88:91], a[216:219], v[44:47], v[88:91]
 v_exp_f32 v37, v37
 v_cvt_pk_bf16_f32 v180, v180, v181
 v_mfma_f32_16x16x32_bf16 v[92:95], a[188:191], v[40:43], 0
 v_mul_f32 v38, s32, v38
 v_mul_f32 v39, s32, v39
 v_mfma_f32_16x16x32_bf16 v[92:95], a[220:223], v[44:47], v[92:95]
 v_exp_f32 v38, v38
 v_cvt_pk_bf16_f32 v181, v182, v183
 v_mfma_f32_16x16x32_bf16 v[32:35], a[128:131], a[32:35], 0
 v_exp_f32 v39, v39
 v_mfma_f32_16x16x32_bf16 v[32:35], a[132:135], a[36:39], v[32:35]
 v_cvt_pk_bf16_f32 v54, v36, v37
 v_cvt_pk_bf16_f32 v55, v38, v39
 v_mfma_f32_16x16x32_bf16 v[32:35], a[136:139], a[40:43], v[32:35]
 v_mul_f32 v24, s32, v24
 v_mul_f32 v25, s32, v25
 v_mfma_f32_16x16x32_bf16 v[32:35], a[140:143], a[44:47], v[32:35]
 ds_write2_b64 v12, v[176:177], v[180:181] offset0:16 offset1:20
 v_exp_f32 v24, v24
 v_mfma_f32_16x16x32_bf16 v[36:39], a[156:159], a[44:47], 0
 v_exp_f32 v25, v25
 v_mfma_f32_16x16x32_bf16 v[36:39], a[152:155], a[40:43], v[36:39]
 v_mul_f32 v26, s32, v26
 v_mul_f32 v27, s32, v27
 v_mfma_f32_16x16x32_bf16 v[36:39], a[148:151], a[36:39], v[36:39]
 s_add_u32 m0, s39, 0
 v_exp_f32 v26, v26
 v_mfma_f32_16x16x32_bf16 v[36:39], a[144:147], a[32:35], v[36:39]
 buffer_load_dwordx4 v1, s[20:23], s33 offen nt lds
 v_mfma_f32_16x16x32_bf16 v[96:99], a[160:163], v[48:51], 0
 v_exp_f32 v27, v27
 v_mfma_f32_16x16x32_bf16 v[96:99], a[192:195], v[52:55], v[96:99]
 v_mul_f32 v28, s32, v28
 v_mul_f32 v29, s32, v29
 v_cvt_pk_bf16_f32 v184, v184, v185
 v_mfma_f32_16x16x32_bf16 v[100:103], a[164:167], v[48:51], 0
 v_cvt_pk_bf16_f32 v40, v24, v25
 v_cvt_pk_bf16_f32 v41, v26, v27
 v_mfma_f32_16x16x32_bf16 v[100:103], a[196:199], v[52:55], v[100:103]
 v_exp_f32 v28, v28
 v_cvt_pk_bf16_f32 v185, v186, v187
 v_mfma_f32_16x16x32_bf16 v[104:107], a[168:171], v[48:51], 0
 v_exp_f32 v29, v29
 v_mfma_f32_16x16x32_bf16 v[104:107], a[200:203], v[52:55], v[104:107]
 v_mul_f32 v30, s32, v30
 v_mul_f32 v31, s32, v31
 v_cvt_pk_bf16_f32 v188, v188, v189
 v_cvt_pk_bf16_f32 v189, v190, v191
 v_mfma_f32_16x16x32_bf16 v[108:111], a[172:175], v[48:51], 0
 s_waitcnt lgkmcnt(15)
 v_exp_f32 v30, v30
 v_mfma_f32_16x16x32_bf16 v[108:111], a[204:207], v[52:55], v[108:111]
 ds_write2_b64 v12, v[184:185], v[188:189] offset0:24 offset1:28
 v_exp_f32 v31, v31
 v_mfma_f32_16x16x32_bf16 v[24:27], a[96:99], a[48:51], 0
 v_cvt_pk_bf16_f32 v42, v28, v29
 v_cvt_pk_bf16_f32 v43, v30, v31
 v_mfma_f32_16x16x32_bf16 v[24:27], a[100:103], a[52:55], v[24:27]
 s_waitcnt vmcnt(7)
 v_mul_f32 v32, s32, v32
 v_mul_f32 v33, s32, v33
 v_mfma_f32_16x16x32_bf16 v[24:27], a[104:107], a[56:59], v[24:27]
 v_exp_f32 v32, v32
 v_mfma_f32_16x16x32_bf16 v[24:27], a[108:111], a[60:63], v[24:27]
 v_exp_f32 v33, v33
 v_mul_f32 v34, s32, v34
 v_smfmac_f32_16x16x64_bf16 a[224:227], a[240:243], v[48:55], v2
 ds_read_b128 a[80:83], v4 offset:0
 ds_read_b128 a[84:87], v4 offset:64
 v_mul_f32 v35, s32, v35
 v_mfma_f32_16x16x32_bf16 v[28:31], a[124:127], a[60:63], 0
 v_exp_f32 v34, v34
 v_mfma_f32_16x16x32_bf16 v[28:31], a[120:123], a[56:59], v[28:31]
 v_exp_f32 v35, v35
 v_mfma_f32_16x16x32_bf16 v[28:31], a[116:119], a[52:55], v[28:31]
 s_add_u32 m0, s39, 32
 v_mul_f32 v36, s32, v36
 v_mul_f32 v37, s32, v37
 v_mfma_f32_16x16x32_bf16 v[28:31], a[112:115], a[48:51], v[28:31]
 buffer_load_dwordx4 v1, s[20:23], s33 offen offset:1024 nt lds
 v_mfma_f32_16x16x32_bf16 v[112:115], a[176:179], v[48:51], 0
 ds_read_b128 a[88:91], v4 offset:128
 ds_read_b128 a[92:95], v4 offset:192
 v_mfma_f32_16x16x32_bf16 v[112:115], a[208:211], v[52:55], v[112:115]
 v_accvgpr_read_b32 v11, a232
 v_accvgpr_read_b32 v10, a233
 v_add_f32 v11, v11, v10
 v_rcp_f32 v10, v11
 v_cmp_nle_f32 vcc, s60, v11
 v_accvgpr_write_b32 a232, 0
 v_accvgpr_write_b32 a233, 0
 v_pk_mul_f32 v[192:193], v[192:193], v[10:11] op_sel_hi:[1,0]
 v_pk_mul_f32 v[194:195], v[194:195], v[10:11] op_sel_hi:[1,0]
 v_pk_mul_f32 v[196:197], v[196:197], v[10:11] op_sel_hi:[1,0]
 v_pk_mul_f32 v[198:199], v[198:199], v[10:11] op_sel_hi:[1,0]
 v_pk_mul_f32 v[200:201], v[200:201], v[10:11] op_sel_hi:[1,0]
 v_pk_mul_f32 v[202:203], v[202:203], v[10:11] op_sel_hi:[1,0]
 v_pk_mul_f32 v[204:205], v[204:205], v[10:11] op_sel_hi:[1,0]
 v_pk_mul_f32 v[206:207], v[206:207], v[10:11] op_sel_hi:[1,0]
 v_pk_mul_f32 v[208:209], v[208:209], v[10:11] op_sel_hi:[1,0]
 v_pk_mul_f32 v[210:211], v[210:211], v[10:11] op_sel_hi:[1,0]
 v_pk_mul_f32 v[212:213], v[212:213], v[10:11] op_sel_hi:[1,0]
 v_pk_mul_f32 v[214:215], v[214:215], v[10:11] op_sel_hi:[1,0]
 v_pk_mul_f32 v[216:217], v[216:217], v[10:11] op_sel_hi:[1,0]
 v_pk_mul_f32 v[218:219], v[218:219], v[10:11] op_sel_hi:[1,0]
 v_pk_mul_f32 v[220:221], v[220:221], v[10:11] op_sel_hi:[1,0]
 v_pk_mul_f32 v[222:223], v[222:223], v[10:11] op_sel_hi:[1,0]
 v_mfma_f32_16x16x32_bf16 v[116:119], a[180:183], v[48:51], 0
 v_cvt_pk_bf16_f32 v44, v32, v33
 v_cvt_pk_bf16_f32 v45, v34, v35
 v_mfma_f32_16x16x32_bf16 v[116:119], a[212:215], v[52:55], v[116:119]
 s_or_b64 s[50:51], s[50:51], vcc
 v_exp_f32 v36, v36
 v_cmp_nge_f32 vcc, s61, v11
 v_mfma_f32_16x16x32_bf16 v[120:123], a[184:187], v[48:51], 0
 v_exp_f32 v37, v37
 v_mfma_f32_16x16x32_bf16 v[120:123], a[216:219], v[52:55], v[120:123]
 v_mul_f32 v38, s32, v38
 v_mul_f32 v39, s32, v39
 v_add_u32 v12, 0, v5
 v_mfma_f32_16x16x32_bf16 v[124:127], a[188:191], v[48:51], 0
 v_exp_f32 v38, v38
 v_mfma_f32_16x16x32_bf16 v[124:127], a[220:223], v[52:55], v[124:127]
 v_exp_f32 v39, v39
 v_cvt_pk_bf16_f32 v192, v192, v193
 v_cvt_pk_bf16_f32 v193, v194, v195
 v_mfma_f32_16x16x32_bf16 v[32:35], a[128:131], a[48:51], 0
 v_cvt_pk_bf16_f32 v46, v36, v37
 v_cvt_pk_bf16_f32 v47, v38, v39
 v_mfma_f32_16x16x32_bf16 v[32:35], a[132:135], a[52:55], v[32:35]
 v_mul_f32 v24, s32, v24
 v_mul_f32 v25, s32, v25
 v_mfma_f32_16x16x32_bf16 v[32:35], a[136:139], a[56:59], v[32:35]
 v_exp_f32 v24, v24
 v_mfma_f32_16x16x32_bf16 v[32:35], a[140:143], a[60:63], v[32:35]
 v_exp_f32 v25, v25
 v_cvt_pk_bf16_f32 v196, v196, v197
 v_cvt_pk_bf16_f32 v197, v198, v199
 v_mfma_f32_16x16x32_bf16 v[36:39], a[156:159], a[60:63], 0
 v_mul_f32 v26, s32, v26
 v_mul_f32 v27, s32, v27
 v_mfma_f32_16x16x32_bf16 v[36:39], a[152:155], a[56:59], v[36:39]
 v_exp_f32 v26, v26
 v_mfma_f32_16x16x32_bf16 v[36:39], a[148:151], a[52:55], v[36:39]
 v_exp_f32 v27, v27
 v_mfma_f32_16x16x32_bf16 v[36:39], a[144:147], a[48:51], v[36:39]
 s_or_b64 s[50:51], s[50:51], vcc
 ds_write2_b64 v12, v[192:193], v[196:197] offset0:0 offset1:4
 v_mul_f32 v28, s32, v28
 v_mul_f32 v29, s32, v29
 v_mfma_f32_16x16x32_bf16 v[128:131], a[160:163], v[40:43], 0
 s_add_u32 m0, s39, 64
 v_cvt_pk_bf16_f32 v48, v24, v25
 v_cvt_pk_bf16_f32 v49, v26, v27
 v_mfma_f32_16x16x32_bf16 v[128:131], a[192:195], v[44:47], v[128:131]
 buffer_load_dwordx4 v1, s[20:23], s33 offen offset:2048 nt lds
 v_cvt_pk_bf16_f32 v200, v200, v201
 v_mfma_f32_16x16x32_bf16 v[132:135], a[164:167], v[40:43], 0
 v_exp_f32 v28, v28
 v_mfma_f32_16x16x32_bf16 v[132:135], a[196:199], v[44:47], v[132:135]
 v_exp_f32 v29, v29
 v_cvt_pk_bf16_f32 v201, v202, v203
 v_cvt_pk_bf16_f32 v204, v204, v205
 v_cvt_pk_bf16_f32 v205, v206, v207
 v_mfma_f32_16x16x32_bf16 v[136:139], a[168:171], v[40:43], 0
 v_mul_f32 v30, s32, v30
 v_mul_f32 v31, s32, v31
 v_mfma_f32_16x16x32_bf16 v[136:139], a[200:203], v[44:47], v[136:139]
 ds_write2_b64 v12, v[200:201], v[204:205] offset0:8 offset1:12
 v_exp_f32 v30, v30
 v_mfma_f32_16x16x32_bf16 v[140:143], a[172:175], v[40:43], 0
 s_waitcnt lgkmcnt(15)
 v_exp_f32 v31, v31
 v_mfma_f32_16x16x32_bf16 v[140:143], a[204:207], v[44:47], v[140:143]
 v_cvt_pk_bf16_f32 v50, v28, v29
 v_cvt_pk_bf16_f32 v51, v30, v31
 v_cvt_pk_bf16_f32 v208, v208, v209
 v_cvt_pk_bf16_f32 v209, v210, v211
 v_mfma_f32_16x16x32_bf16 v[24:27], a[96:99], a[64:67], 0
 v_mul_f32 v32, s32, v32
 v_mul_f32 v33, s32, v33
 v_mfma_f32_16x16x32_bf16 v[24:27], a[100:103], a[68:71], v[24:27]
 v_exp_f32 v32, v32
 v_mfma_f32_16x16x32_bf16 v[24:27], a[104:107], a[72:75], v[24:27]
 v_exp_f32 v33, v33
 v_mfma_f32_16x16x32_bf16 v[24:27], a[108:111], a[76:79], v[24:27]
 v_mul_f32 v34, s32, v34
 v_mul_f32 v35, s32, v35
 v_cvt_pk_bf16_f32 v212, v212, v213
 v_cvt_pk_bf16_f32 v213, v214, v215
 v_smfmac_f32_16x16x64_bf16 a[228:231], a[236:239], v[40:47], v2
 ds_write2_b64 v12, v[208:209], v[212:213] offset0:16 offset1:20
 v_exp_f32 v34, v34
 v_mfma_f32_16x16x32_bf16 v[28:31], a[124:127], a[76:79], 0
 v_exp_f32 v35, v35
 v_mfma_f32_16x16x32_bf16 v[28:31], a[120:123], a[72:75], v[28:31]
 v_mul_f32 v36, s32, v36
 v_mul_f32 v37, s32, v37
 v_mfma_f32_16x16x32_bf16 v[28:31], a[116:119], a[68:71], v[28:31]
 v_cvt_pk_bf16_f32 v52, v32, v33
 v_cvt_pk_bf16_f32 v53, v34, v35
 v_mfma_f32_16x16x32_bf16 v[28:31], a[112:115], a[64:67], v[28:31]
 v_exp_f32 v36, v36
 v_cvt_pk_bf16_f32 v216, v216, v217
 v_cvt_pk_bf16_f32 v217, v218, v219
 v_mfma_f32_16x16x32_bf16 v[144:147], a[176:179], v[40:43], 0
 s_add_u32 m0, s39, 96
 v_exp_f32 v37, v37
 v_mfma_f32_16x16x32_bf16 v[144:147], a[208:211], v[44:47], v[144:147]
 buffer_load_dwordx4 v1, s[20:23], s33 offen offset:3072 nt lds
 v_mfma_f32_16x16x32_bf16 v[148:151], a[180:183], v[40:43], 0
 s_add_u32 s33, s33, 8192
 ds_read_b128 v[60:63], v6 offset:20672
 v_mul_f32 v38, s32, v38
 v_mfma_f32_16x16x32_bf16 v[148:151], a[212:215], v[44:47], v[148:151]
 v_mul_f32 v39, s32, v39
 v_exp_f32 v38, v38
 v_mfma_f32_16x16x32_bf16 v[152:155], a[184:187], v[40:43], 0
 v_exp_f32 v39, v39
 v_mfma_f32_16x16x32_bf16 v[152:155], a[216:219], v[44:47], v[152:155]
 v_cvt_pk_bf16_f32 v54, v36, v37
 v_cvt_pk_bf16_f32 v55, v38, v39
 v_cvt_pk_bf16_f32 v220, v220, v221
 v_cvt_pk_bf16_f32 v221, v222, v223
 v_mfma_f32_16x16x32_bf16 v[156:159], a[188:191], v[40:43], 0
 v_mul_f32 v24, s32, v24
 v_mul_f32 v25, s32, v25
 v_mfma_f32_16x16x32_bf16 v[156:159], a[220:223], v[44:47], v[156:159]
 ds_write2_b64 v12, v[216:217], v[220:221] offset0:24 offset1:28
 v_exp_f32 v24, v24
 v_mfma_f32_16x16x32_bf16 v[32:35], a[128:131], a[64:67], 0
 v_exp_f32 v25, v25
 v_mfma_f32_16x16x32_bf16 v[32:35], a[132:135], a[68:71], v[32:35]
 v_mul_f32 v26, s32, v26
 v_mul_f32 v27, s32, v27
 v_mfma_f32_16x16x32_bf16 v[32:35], a[136:139], a[72:75], v[32:35]
 s_mov_b32 s38, 3072
 v_exp_f32 v26, v26
 v_mfma_f32_16x16x32_bf16 v[32:35], a[140:143], a[76:79], v[32:35]
 s_waitcnt lgkmcnt(1)
 buffer_store_dwordx4 v[60:63], v1, s[24:27], s38 offen sc1 nt
 v_mfma_f32_16x16x32_bf16 v[36:39], a[156:159], a[76:79], 0
 v_exp_f32 v27, v27
 v_mfma_f32_16x16x32_bf16 v[36:39], a[152:155], a[72:75], v[36:39]
 v_mul_f32 v28, s32, v28
 v_mul_f32 v29, s32, v29
 v_mfma_f32_16x16x32_bf16 v[36:39], a[148:151], a[68:71], v[36:39]
 v_cvt_pk_bf16_f32 v40, v24, v25
 v_cvt_pk_bf16_f32 v41, v26, v27
 v_mfma_f32_16x16x32_bf16 v[36:39], a[144:147], a[64:67], v[36:39]
 v_accvgpr_read_b32 v11, a234
 v_accvgpr_read_b32 v10, a235
 v_add_f32 v11, v11, v10
 v_rcp_f32 v10, v11
 v_cmp_nle_f32 vcc, s60, v11
 v_accvgpr_write_b32 a234, 0
 v_accvgpr_write_b32 a235, 0
 v_pk_mul_f32 v[224:225], v[224:225], v[10:11] op_sel_hi:[1,0]
 v_pk_mul_f32 v[226:227], v[226:227], v[10:11] op_sel_hi:[1,0]
 v_pk_mul_f32 v[228:229], v[228:229], v[10:11] op_sel_hi:[1,0]
 v_pk_mul_f32 v[230:231], v[230:231], v[10:11] op_sel_hi:[1,0]
 v_pk_mul_f32 v[232:233], v[232:233], v[10:11] op_sel_hi:[1,0]
 v_pk_mul_f32 v[234:235], v[234:235], v[10:11] op_sel_hi:[1,0]
 v_pk_mul_f32 v[236:237], v[236:237], v[10:11] op_sel_hi:[1,0]
 v_pk_mul_f32 v[238:239], v[238:239], v[10:11] op_sel_hi:[1,0]
 v_pk_mul_f32 v[240:241], v[240:241], v[10:11] op_sel_hi:[1,0]
 v_pk_mul_f32 v[242:243], v[242:243], v[10:11] op_sel_hi:[1,0]
 v_pk_mul_f32 v[244:245], v[244:245], v[10:11] op_sel_hi:[1,0]
 v_pk_mul_f32 v[246:247], v[246:247], v[10:11] op_sel_hi:[1,0]
 v_pk_mul_f32 v[248:249], v[248:249], v[10:11] op_sel_hi:[1,0]
 v_pk_mul_f32 v[250:251], v[250:251], v[10:11] op_sel_hi:[1,0]
 v_pk_mul_f32 v[252:253], v[252:253], v[10:11] op_sel_hi:[1,0]
 v_pk_mul_f32 v[254:255], v[254:255], v[10:11] op_sel_hi:[1,0]
 v_mfma_f32_16x16x32_bf16 v[160:163], a[160:163], v[48:51], 0
 v_exp_f32 v28, v28
 v_mfma_f32_16x16x32_bf16 v[160:163], a[192:195], v[52:55], v[160:163]
 s_or_b64 s[50:51], s[50:51], vcc
 v_exp_f32 v29, v29
 v_cmp_nge_f32 vcc, s61, v11
 v_mfma_f32_16x16x32_bf16 v[164:167], a[164:167], v[48:51], 0
 s_add_u32 m0, s39, 16896
 v_mul_f32 v30, s32, v30
 v_mul_f32 v31, s32, v31
 v_mfma_f32_16x16x32_bf16 v[164:167], a[196:199], v[52:55], v[164:167]
 buffer_load_dwordx4 v1, s[20:23], s33 offen nt lds
 v_mfma_f32_16x16x32_bf16 v[168:171], a[168:171], v[48:51], 0
 v_exp_f32 v30, v30
 v_mfma_f32_16x16x32_bf16 v[168:171], a[200:203], v[52:55], v[168:171]
 v_exp_f32 v31, v31
 v_add_u32 v12, 19584, v5
 v_mfma_f32_16x16x32_bf16 v[172:175], a[172:175], v[48:51], 0
 s_waitcnt lgkmcnt(5)
 v_cvt_pk_bf16_f32 v42, v28, v29
 v_cvt_pk_bf16_f32 v43, v30, v31
 v_mfma_f32_16x16x32_bf16 v[172:175], a[204:207], v[52:55], v[172:175]
 v_mul_f32 v32, s32, v32
 v_mul_f32 v33, s32, v33
 v_cvt_pk_bf16_f32 v224, v224, v225
 v_cvt_pk_bf16_f32 v225, v226, v227
 v_mfma_f32_16x16x32_bf16 v[24:27], a[96:99], a[80:83], 0
 v_exp_f32 v32, v32
 v_mfma_f32_16x16x32_bf16 v[24:27], a[100:103], a[84:87], v[24:27]
 v_exp_f32 v33, v33
 v_mfma_f32_16x16x32_bf16 v[24:27], a[104:107], a[88:91], v[24:27]
 v_mul_f32 v34, s32, v34
 v_mul_f32 v35, s32, v35
 v_mfma_f32_16x16x32_bf16 v[24:27], a[108:111], a[92:95], v[24:27]
 v_exp_f32 v34, v34
 v_cvt_pk_bf16_f32 v228, v228, v229
 v_cvt_pk_bf16_f32 v229, v230, v231
 v_smfmac_f32_16x16x64_bf16 a[228:231], a[240:243], v[48:55], v2
 s_or_b64 s[50:51], s[50:51], vcc
 ds_write2_b64 v12, v[224:225], v[228:229] offset0:0 offset1:4
 v_exp_f32 v35, v35
 v_mfma_f32_16x16x32_bf16 v[28:31], a[124:127], a[92:95], 0
 v_mul_f32 v36, s32, v36
 v_mul_f32 v37, s32, v37
 v_mfma_f32_16x16x32_bf16 v[28:31], a[120:123], a[88:91], v[28:31]
 v_cvt_pk_bf16_f32 v44, v32, v33
 v_cvt_pk_bf16_f32 v45, v34, v35
 v_mfma_f32_16x16x32_bf16 v[28:31], a[116:119], a[84:87], v[28:31]
 v_exp_f32 v36, v36
 v_mfma_f32_16x16x32_bf16 v[28:31], a[112:115], a[80:83], v[28:31]
 s_waitcnt vmcnt(7)
 s_barrier
 v_mfma_f32_16x16x32_bf16 v[176:179], a[176:179], v[48:51], 0
 v_exp_f32 v37, v37
 v_mfma_f32_16x16x32_bf16 v[176:179], a[208:211], v[52:55], v[176:179]
L_pg1_7:
 s_cbranch_execz L_pg1_11
 v_mul_f32 v38, s32, v38
 v_mul_f32 v39, s32, v39
 v_cvt_pk_bf16_f32 v232, v232, v233
 v_mfma_f32_16x16x32_bf16 v[180:183], a[180:183], v[48:51], 0
 s_add_u32 m0, s39, 16928
 ds_read_b128 a[96:99], v7 offset:33792
 ds_read_b128 a[100:103], v7 offset:33856
 v_mfma_f32_16x16x32_bf16 v[180:183], a[212:215], v[52:55], v[180:183]
 buffer_load_dwordx4 v1, s[20:23], s33 offen offset:1024 nt lds
 v_mfma_f32_16x16x32_bf16 v[184:187], a[184:187], v[48:51], 0
 v_exp_f32 v38, v38
 v_mfma_f32_16x16x32_bf16 v[184:187], a[216:219], v[52:55], v[184:187]
 v_exp_f32 v39, v39
 v_cvt_pk_bf16_f32 v233, v234, v235
 v_mfma_f32_16x16x32_bf16 v[188:191], a[188:191], v[48:51], 0
 ds_read_b128 a[104:107], v7 offset:33920
 ds_read_b128 a[108:111], v7 offset:33984
 v_mfma_f32_16x16x32_bf16 v[188:191], a[220:223], v[52:55], v[188:191]
 v_cvt_pk_bf16_f32 v46, v36, v37
 v_cvt_pk_bf16_f32 v47, v38, v39
 v_cvt_pk_bf16_f32 v236, v236, v237
 v_cvt_pk_bf16_f32 v237, v238, v239
 v_mfma_f32_16x16x32_bf16 v[32:35], a[128:131], a[80:83], 0
 v_mul_f32 v24, s32, v24
 v_mul_f32 v25, s32, v25
 v_mfma_f32_16x16x32_bf16 v[32:35], a[132:135], a[84:87], v[32:35]
 v_exp_f32 v24, v24
 v_mfma_f32_16x16x32_bf16 v[32:35], a[136:139], a[88:91], v[32:35]
 ds_read_b128 a[124:127], v7 offset:34496
 ds_read_b128 a[120:123], v7 offset:34432
 v_mfma_f32_16x16x32_bf16 v[32:35], a[140:143], a[92:95], v[32:35]
 ds_write2_b64 v12, v[232:233], v[236:237] offset0:8 offset1:12
 v_exp_f32 v25, v25
 v_mfma_f32_16x16x32_bf16 v[36:39], a[156:159], a[92:95], 0
 v_mul_f32 v26, s32, v26
 v_mul_f32 v27, s32, v27
 v_mfma_f32_16x16x32_bf16 v[36:39], a[152:155], a[88:91], v[36:39]
 v_exp_f32 v26, v26
 v_mfma_f32_16x16x32_bf16 v[36:39], a[148:151], a[84:87], v[36:39]
 ds_read_b128 a[116:119], v7 offset:34368
 ds_read_b128 a[112:115], v7 offset:34304
 v_mfma_f32_16x16x32_bf16 v[36:39], a[144:147], a[80:83], v[36:39]
 v_exp_f32 v27, v27
 v_mul_f32 v28, s32, v28
 v_mfma_f32_16x16x32_bf16 v[192:195], a[160:163], v[40:43], 0
 v_mul_f32 v29, s32, v29
 v_cvt_pk_bf16_f32 v48, v24, v25
 v_mfma_f32_16x16x32_bf16 v[192:195], a[192:195], v[44:47], v[192:195]
 v_cvt_pk_bf16_f32 v49, v26, v27
 v_exp_f32 v28, v28
 v_mfma_f32_16x16x32_bf16 v[196:199], a[164:167], v[40:43], 0
 v_exp_f32 v29, v29
 v_mfma_f32_16x16x32_bf16 v[196:199], a[196:199], v[44:47], v[196:199]
 ds_read_b128 a[128:131], v7 offset:50688
 ds_read_b128 a[132:135], v7 offset:50752
 v_cvt_pk_bf16_f32 v240, v240, v241
 v_cvt_pk_bf16_f32 v241, v242, v243
 v_mfma_f32_16x16x32_bf16 v[200:203], a[168:171], v[40:43], 0
 s_add_u32 m0, s39, 16960
 v_mul_f32 v30, s32, v30
 v_mul_f32 v31, s32, v31
 v_mfma_f32_16x16x32_bf16 v[200:203], a[200:203], v[44:47], v[200:203]
 buffer_load_dwordx4 v1, s[20:23], s33 offen offset:2048 nt lds
 v_mfma_f32_16x16x32_bf16 v[204:207], a[172:175], v[40:43], 0
 v_exp_f32 v30, v30
 v_mfma_f32_16x16x32_bf16 v[204:207], a[204:207], v[44:47], v[204:207]
 s_waitcnt lgkmcnt(7)
 ds_read_b128 a[136:139], v7 offset:50816
 ds_read_b128 a[140:143], v7 offset:50880
 v_cvt_pk_bf16_f32 v244, v244, v245
 v_cvt_pk_bf16_f32 v245, v246, v247
 v_mfma_f32_16x16x32_bf16 v[24:27], a[96:99], a[0:3], 0
 v_exp_f32 v31, v31
 v_mfma_f32_16x16x32_bf16 v[24:27], a[100:103], a[4:7], v[24:27]
 v_cvt_pk_bf16_f32 v50, v28, v29
 v_cvt_pk_bf16_f32 v51, v30, v31
 v_mfma_f32_16x16x32_bf16 v[24:27], a[104:107], a[8:11], v[24:27]
 v_mul_f32 v32, s32, v32
 v_mul_f32 v33, s32, v33
 v_mfma_f32_16x16x32_bf16 v[24:27], a[108:111], a[12:15], v[24:27]
 s_waitcnt lgkmcnt(4)
 ds_read_b128 a[156:159], v7 offset:51392
 ds_read_b128 a[152:155], v7 offset:51328
 v_exp_f32 v32, v32
 v_smfmac_f32_16x16x64_bf16 a[232:235], a[236:239], v[40:47], v2
 ds_write2_b64 v12, v[240:241], v[244:245] offset0:16 offset1:20
 v_exp_f32 v33, v33
 v_mfma_f32_16x16x32_bf16 v[28:31], a[124:127], a[12:15], 0
 v_mul_f32 v34, s32, v34
 v_mul_f32 v35, s32, v35
 v_mfma_f32_16x16x32_bf16 v[28:31], a[120:123], a[8:11], v[28:31]
 v_exp_f32 v34, v34
 v_mfma_f32_16x16x32_bf16 v[28:31], a[116:119], a[4:7], v[28:31]
 ds_read_b128 a[148:151], v7 offset:51264
 ds_read_b128 a[144:147], v7 offset:51200
 v_mfma_f32_16x16x32_bf16 v[28:31], a[112:115], a[0:3], v[28:31]
 v_exp_f32 v35, v35
 v_mul_f32 v36, s32, v36
 v_mfma_f32_16x16x32_bf16 v[208:211], a[176:179], v[40:43], 0
 v_mul_f32 v37, s32, v37
 v_cvt_pk_bf16_f32 v52, v32, v33
 v_mfma_f32_16x16x32_bf16 v[208:211], a[208:211], v[44:47], v[208:211]
 v_cvt_pk_bf16_f32 v53, v34, v35
 v_exp_f32 v36, v36
 v_cvt_pk_bf16_f32 v248, v248, v249
 v_mfma_f32_16x16x32_bf16 v[212:215], a[180:183], v[40:43], 0
 s_add_u32 m0, s39, 16992
 v_exp_f32 v37, v37
 v_mfma_f32_16x16x32_bf16 v[212:215], a[212:215], v[44:47], v[212:215]
 buffer_load_dwordx4 v1, s[20:23], s33 offen offset:3072 nt lds
 v_mfma_f32_16x16x32_bf16 v[216:219], a[184:187], v[40:43], 0
 s_add_u32 s33, s33, 8192
 v_mul_f32 v38, s32, v38
 v_mul_f32 v39, s32, v39
 v_mfma_f32_16x16x32_bf16 v[216:219], a[216:219], v[44:47], v[216:219]
 v_exp_f32 v38, v38
 v_cvt_pk_bf16_f32 v249, v250, v251
 v_cvt_pk_bf16_f32 v252, v252, v253
 v_mfma_f32_16x16x32_bf16 v[220:223], a[188:191], v[40:43], 0
 v_exp_f32 v39, v39
 v_mfma_f32_16x16x32_bf16 v[220:223], a[220:223], v[44:47], v[220:223]
 s_waitcnt lgkmcnt(5)
 ds_read_b128 v[56:59], v6 offset:17408
 v_cvt_pk_bf16_f32 v54, v36, v37
 v_cvt_pk_bf16_f32 v55, v38, v39
 v_cvt_pk_bf16_f32 v253, v254, v255
 v_mfma_f32_16x16x32_bf16 v[32:35], a[128:131], a[0:3], 0
 v_mul_f32 v24, s32, v24
 v_mul_f32 v25, s32, v25
 v_mfma_f32_16x16x32_bf16 v[32:35], a[132:135], a[4:7], v[32:35]
 v_exp_f32 v24, v24
 v_mfma_f32_16x16x32_bf16 v[32:35], a[136:139], a[8:11], v[32:35]
 v_exp_f32 v25, v25
 v_mfma_f32_16x16x32_bf16 v[32:35], a[140:143], a[12:15], v[32:35]
 s_waitcnt lgkmcnt(1)
 ds_write2_b64 v12, v[248:249], v[252:253] offset0:24 offset1:28
 v_mul_f32 v26, s32, v26
 v_mul_f32 v27, s32, v27
 v_mfma_f32_16x16x32_bf16 v[36:39], a[156:159], a[12:15], 0
 v_exp_f32 v26, v26
 v_mfma_f32_16x16x32_bf16 v[36:39], a[152:155], a[8:11], v[36:39]
 v_exp_f32 v27, v27
 v_mfma_f32_16x16x32_bf16 v[36:39], a[148:151], a[4:7], v[36:39]
 v_mul_f32 v28, s32, v28
 v_mul_f32 v29, s32, v29
 v_mfma_f32_16x16x32_bf16 v[36:39], a[144:147], a[0:3], v[36:39]
 v_cvt_pk_bf16_f32 v40, v24, v25
 v_cvt_pk_bf16_f32 v41, v26, v27
 v_mfma_f32_16x16x32_bf16 v[224:227], a[160:163], v[48:51], 0
 s_mov_b32 s38, 0
 v_exp_f32 v28, v28
 v_mfma_f32_16x16x32_bf16 v[224:227], a[192:195], v[52:55], v[224:227]
 s_waitcnt lgkmcnt(1)
 buffer_store_dwordx4 v[56:59], v1, s[24:27], s38 offen sc1 nt
 v_mfma_f32_16x16x32_bf16 v[228:231], a[164:167], v[48:51], 0
 ds_read_b64_tr_b16 a[160:161], v8 offset:33792
 ds_read_b64_tr_b16 a[162:163], v8 offset:34304
 v_mfma_f32_16x16x32_bf16 v[228:231], a[196:199], v[52:55], v[228:231]
 v_exp_f32 v29, v29
 v_mul_f32 v30, s32, v30
 v_mfma_f32_16x16x32_bf16 v[232:235], a[168:171], v[48:51], 0
 ds_read_b64_tr_b16 a[192:193], v8 offset:50688
 ds_read_b64_tr_b16 a[194:195], v8 offset:51200
 v_mfma_f32_16x16x32_bf16 v[232:235], a[200:203], v[52:55], v[232:235]
 v_mul_f32 v31, s32, v31
 v_exp_f32 v30, v30
 v_mfma_f32_16x16x32_bf16 v[236:239], a[172:175], v[48:51], 0
 v_exp_f32 v31, v31
 v_mfma_f32_16x16x32_bf16 v[236:239], a[204:207], v[52:55], v[236:239]
 ds_read_b64_tr_b16 a[164:165], v8 offset:33824
 ds_read_b64_tr_b16 a[166:167], v8 offset:34336
 v_cvt_pk_bf16_f32 v42, v28, v29
 v_cvt_pk_bf16_f32 v43, v30, v31
 v_mfma_f32_16x16x32_bf16 v[24:27], a[96:99], a[16:19], 0
 v_mul_f32 v32, s32, v32
 v_mul_f32 v33, s32, v33
 v_mfma_f32_16x16x32_bf16 v[24:27], a[100:103], a[20:23], v[24:27]
 ds_read_b64_tr_b16 a[196:197], v8 offset:50720
 ds_read_b64_tr_b16 a[198:199], v8 offset:51232
 v_mfma_f32_16x16x32_bf16 v[24:27], a[104:107], a[24:27], v[24:27]
 v_exp_f32 v32, v32
 v_mfma_f32_16x16x32_bf16 v[24:27], a[108:111], a[28:31], v[24:27]
 ds_read_b64_tr_b16 a[168:169], v8 offset:33856
 ds_read_b64_tr_b16 a[170:171], v8 offset:34368
 v_exp_f32 v33, v33
 v_smfmac_f32_16x16x64_bf16 a[232:235], a[240:243], v[48:55], v2
 v_mul_f32 v34, s32, v34
 v_mul_f32 v35, s32, v35
 v_mfma_f32_16x16x32_bf16 v[28:31], a[124:127], a[28:31], 0
 ds_read_b64_tr_b16 a[200:201], v8 offset:50752
 ds_read_b64_tr_b16 a[202:203], v8 offset:51264
 v_mfma_f32_16x16x32_bf16 v[28:31], a[120:123], a[24:27], v[28:31]
 v_exp_f32 v34, v34
 v_mfma_f32_16x16x32_bf16 v[28:31], a[116:119], a[20:23], v[28:31]
 v_exp_f32 v35, v35
 v_mfma_f32_16x16x32_bf16 v[28:31], a[112:115], a[16:19], v[28:31]
 ds_read_b64_tr_b16 a[172:173], v8 offset:33888
 ds_read_b64_tr_b16 a[174:175], v8 offset:34400
 v_mul_f32 v36, s32, v36
 v_mfma_f32_16x16x32_bf16 v[240:243], a[176:179], v[48:51], 0
 v_mul_f32 v37, s32, v37
 v_cvt_pk_bf16_f32 v44, v32, v33
 v_mfma_f32_16x16x32_bf16 v[240:243], a[208:211], v[52:55], v[240:243]
 s_cmp_lg_u64 s[50:51], 0
 s_cselect_b32 s59, 1, 0
 s_or_b32 s52, s52, s59
 s_mov_b64 s[50:51], 0
 ds_read_b64_tr_b16 a[204:205], v8 offset:50784
 ds_read_b64_tr_b16 a[206:207], v8 offset:51296
 v_cvt_pk_bf16_f32 v45, v34, v35
 v_mfma_f32_16x16x32_bf16 v[244:247], a[180:183], v[48:51], 0
 v_exp_f32 v36, v36
 v_mfma_f32_16x16x32_bf16 v[244:247], a[212:215], v[52:55], v[244:247]
 v_exp_f32 v37, v37
 v_mfma_f32_16x16x32_bf16 v[248:251], a[184:187], v[48:51], 0
 v_mul_f32 v38, s32, v38
 v_mul_f32 v39, s32, v39
 v_mfma_f32_16x16x32_bf16 v[248:251], a[216:219], v[52:55], v[248:251]
 ds_read_b64_tr_b16 a[176:177], v8 offset:33920
 ds_read_b64_tr_b16 a[178:179], v8 offset:34432
 v_mfma_f32_16x16x32_bf16 v[252:255], a[188:191], v[48:51], 0
 v_exp_f32 v38, v38
 v_mfma_f32_16x16x32_bf16 v[252:255], a[220:223], v[52:55], v[252:255]
 v_exp_f32 v39, v39
 v_cvt_pk_bf16_f32 v46, v36, v37
 v_cvt_pk_bf16_f32 v47, v38, v39
 v_mfma_f32_16x16x32_bf16 v[32:35], a[128:131], a[16:19], 0
 ds_read_b64_tr_b16 a[208:209], v8 offset:50816
 ds_read_b64_tr_b16 a[210:211], v8 offset:51328
 v_mfma_f32_16x16x32_bf16 v[32:35], a[132:135], a[20:23], v[32:35]
 v_mul_f32 v24, s32, v24
 v_mul_f32 v25, s32, v25
 v_mfma_f32_16x16x32_bf16 v[32:35], a[136:139], a[24:27], v[32:35]
 v_exp_f32 v24, v24
 v_mfma_f32_16x16x32_bf16 v[32:35], a[140:143], a[28:31], v[32:35]
 ds_read_b64_tr_b16 a[180:181], v8 offset:33952
 ds_read_b64_tr_b16 a[182:183], v8 offset:34464
 v_exp_f32 v25, v25
 v_mfma_f32_16x16x32_bf16 v[36:39], a[156:159], a[28:31], 0
 v_mul_f32 v26, s32, v26
 v_mul_f32 v27, s32, v27
 v_mfma_f32_16x16x32_bf16 v[36:39], a[152:155], a[24:27], v[36:39]
 v_exp_f32 v26, v26
 v_mfma_f32_16x16x32_bf16 v[36:39], a[148:151], a[20:23], v[36:39]
 ds_read_b64_tr_b16 a[212:213], v8 offset:50848
 ds_read_b64_tr_b16 a[214:215], v8 offset:51360
 v_mfma_f32_16x16x32_bf16 v[36:39], a[144:147], a[16:19], v[36:39]
 s_waitcnt lgkmcnt(15)
 v_exp_f32 v27, v27
 v_mul_f32 v28, s32, v28
 v_mfma_f32_16x16x32_bf16 v[64:67], a[160:163], v[40:43], v[64:67]
 v_mul_f32 v29, s32, v29
 v_cvt_pk_bf16_f32 v48, v24, v25
 v_mfma_f32_16x16x32_bf16 v[64:67], a[192:195], v[44:47], v[64:67]
 ds_read_b64_tr_b16 a[184:185], v8 offset:33984
 ds_read_b64_tr_b16 a[186:187], v8 offset:34496
 v_cvt_pk_bf16_f32 v49, v26, v27
 v_mfma_f32_16x16x32_bf16 v[68:71], a[164:167], v[40:43], v[68:71]
 v_exp_f32 v28, v28
 v_mfma_f32_16x16x32_bf16 v[68:71], a[196:199], v[44:47], v[68:71]
 s_waitcnt lgkmcnt(10)
 v_exp_f32 v29, v29
 v_mfma_f32_16x16x32_bf16 v[72:75], a[168:171], v[40:43], v[72:75]
 ds_read_b64_tr_b16 a[216:217], v8 offset:50880
 ds_read_b64_tr_b16 a[218:219], v8 offset:51392
 v_mfma_f32_16x16x32_bf16 v[72:75], a[200:203], v[44:47], v[72:75]
 v_mul_f32 v30, s32, v30
 v_mul_f32 v31, s32, v31
 v_mfma_f32_16x16x32_bf16 v[76:79], a[172:175], v[40:43], v[76:79]
 v_exp_f32 v30, v30
 v_mfma_f32_16x16x32_bf16 v[76:79], a[204:207], v[44:47], v[76:79]
 ds_read_b64_tr_b16 a[188:189], v8 offset:34016
 ds_read_b64_tr_b16 a[190:191], v8 offset:34528
 v_mfma_f32_16x16x32_bf16 v[24:27], a[96:99], a[32:35], 0
 ds_read_b128 v[60:63], v6 offset:18496
 v_exp_f32 v31, v31
 v_mfma_f32_16x16x32_bf16 v[24:27], a[100:103], a[36:39], v[24:27]
 v_cvt_pk_bf16_f32 v50, v28, v29
 v_cvt_pk_bf16_f32 v51, v30, v31
 v_mfma_f32_16x16x32_bf16 v[24:27], a[104:107], a[40:43], v[24:27]
 ds_read_b64_tr_b16 a[220:221], v8 offset:50912
 ds_read_b64_tr_b16 a[222:223], v8 offset:51424
 v_mfma_f32_16x16x32_bf16 v[24:27], a[108:111], a[44:47], v[24:27]
 v_mul_f32 v32, s32, v32
 v_mul_f32 v33, s32, v33
 v_smfmac_f32_16x16x64_bf16 a[224:227], a[236:239], v[40:47], v2
 v_exp_f32 v32, v32
 v_mfma_f32_16x16x32_bf16 v[28:31], a[124:127], a[44:47], 0
 v_exp_f32 v33, v33
 v_mfma_f32_16x16x32_bf16 v[28:31], a[120:123], a[40:43], v[28:31]
 v_mul_f32 v34, s32, v34
 v_mul_f32 v35, s32, v35
 v_mfma_f32_16x16x32_bf16 v[28:31], a[116:119], a[36:39], v[28:31]
 v_exp_f32 v34, v34
 v_mfma_f32_16x16x32_bf16 v[28:31], a[112:115], a[32:35], v[28:31]
 s_waitcnt lgkmcnt(9)
 v_exp_f32 v35, v35
 v_mfma_f32_16x16x32_bf16 v[80:83], a[176:179], v[40:43], v[80:83]
 s_mov_b32 s38, 1024
 v_mul_f32 v36, s32, v36
 v_mul_f32 v37, s32, v37
 v_mfma_f32_16x16x32_bf16 v[80:83], a[208:211], v[44:47], v[80:83]
 s_waitcnt lgkmcnt(2)
 buffer_store_dwordx4 v[60:63], v1, s[24:27], s38 offen sc1 nt
 v_mfma_f32_16x16x32_bf16 v[84:87], a[180:183], v[40:43], v[84:87]
 v_cvt_pk_bf16_f32 v52, v32, v33
 v_cvt_pk_bf16_f32 v53, v34, v35
 v_mfma_f32_16x16x32_bf16 v[84:87], a[212:215], v[44:47], v[84:87]
 s_waitcnt lgkmcnt(0)
 s_barrier
 v_mfma_f32_16x16x32_bf16 v[88:91], a[184:187], v[40:43], v[88:91]
 v_exp_f32 v36, v36
 v_mfma_f32_16x16x32_bf16 v[88:91], a[216:219], v[44:47], v[88:91]
 v_exp_f32 v37, v37
 v_mfma_f32_16x16x32_bf16 v[92:95], a[188:191], v[40:43], v[92:95]
 v_mul_f32 v38, s32, v38
 v_mul_f32 v39, s32, v39
 v_mfma_f32_16x16x32_bf16 v[92:95], a[220:223], v[44:47], v[92:95]
 v_exp_f32 v38, v38
 v_mfma_f32_16x16x32_bf16 v[32:35], a[128:131], a[32:35], 0
 v_exp_f32 v39, v39
 v_mfma_f32_16x16x32_bf16 v[32:35], a[132:135], a[36:39], v[32:35]
 v_cvt_pk_bf16_f32 v54, v36, v37
 v_cvt_pk_bf16_f32 v55, v38, v39
 v_mfma_f32_16x16x32_bf16 v[32:35], a[136:139], a[40:43], v[32:35]
 v_mul_f32 v24, s32, v24
 v_mul_f32 v25, s32, v25
 v_mfma_f32_16x16x32_bf16 v[32:35], a[140:143], a[44:47], v[32:35]
 v_exp_f32 v24, v24
 v_mfma_f32_16x16x32_bf16 v[36:39], a[156:159], a[44:47], 0
 v_exp_f32 v25, v25
 v_mfma_f32_16x16x32_bf16 v[36:39], a[152:155], a[40:43], v[36:39]
 v_mul_f32 v26, s32, v26
 v_mul_f32 v27, s32, v27
 v_mfma_f32_16x16x32_bf16 v[36:39], a[148:151], a[36:39], v[36:39]
 s_add_u32 m0, s39, 33792
 v_exp_f32 v26, v26
 v_mfma_f32_16x16x32_bf16 v[36:39], a[144:147], a[32:35], v[36:39]
 buffer_load_dwordx4 v1, s[20:23], s33 offen nt lds
 v_mfma_f32_16x16x32_bf16 v[96:99], a[160:163], v[48:51], v[96:99]
 v_exp_f32 v27, v27
 v_mfma_f32_16x16x32_bf16 v[96:99], a[192:195], v[52:55], v[96:99]
 v_mul_f32 v28, s32, v28
 v_mul_f32 v29, s32, v29
 v_mfma_f32_16x16x32_bf16 v[100:103], a[164:167], v[48:51], v[100:103]
 v_cvt_pk_bf16_f32 v40, v24, v25
 v_cvt_pk_bf16_f32 v41, v26, v27
 v_mfma_f32_16x16x32_bf16 v[100:103], a[196:199], v[52:55], v[100:103]
 v_exp_f32 v28, v28
 v_mfma_f32_16x16x32_bf16 v[104:107], a[168:171], v[48:51], v[104:107]
 v_exp_f32 v29, v29
 v_mfma_f32_16x16x32_bf16 v[104:107], a[200:203], v[52:55], v[104:107]
 v_mul_f32 v30, s32, v30
 v_mul_f32 v31, s32, v31
 v_mfma_f32_16x16x32_bf16 v[108:111], a[172:175], v[48:51], v[108:111]
 v_exp_f32 v30, v30
 v_mfma_f32_16x16x32_bf16 v[108:111], a[204:207], v[52:55], v[108:111]
 v_exp_f32 v31, v31
 v_mfma_f32_16x16x32_bf16 v[24:27], a[96:99], a[48:51], 0
 v_cvt_pk_bf16_f32 v42, v28, v29
 v_cvt_pk_bf16_f32 v43, v30, v31
 v_mfma_f32_16x16x32_bf16 v[24:27], a[100:103], a[52:55], v[24:27]
 v_mul_f32 v32, s32, v32
 v_mul_f32 v33, s32, v33
 v_mfma_f32_16x16x32_bf16 v[24:27], a[104:107], a[56:59], v[24:27]
 v_exp_f32 v32, v32
 v_mfma_f32_16x16x32_bf16 v[24:27], a[108:111], a[60:63], v[24:27]
 v_exp_f32 v33, v33
 v_smfmac_f32_16x16x64_bf16 a[224:227], a[240:243], v[48:55], v2
 v_mfma_f32_16x16x32_bf16 v[28:31], a[124:127], a[60:63], 0
 v_mul_f32 v34, s32, v34
 v_mul_f32 v35, s32, v35
 v_mfma_f32_16x16x32_bf16 v[28:31], a[120:123], a[56:59], v[28:31]
 v_exp_f32 v34, v34
 v_mfma_f32_16x16x32_bf16 v[28:31], a[116:119], a[52:55], v[28:31]
 s_add_u32 m0, s39, 33824
 v_exp_f32 v35, v35
 v_mfma_f32_16x16x32_bf16 v[28:31], a[112:115], a[48:51], v[28:31]
 buffer_load_dwordx4 v1, s[20:23], s33 offen offset:1024 nt lds
 v_mfma_f32_16x16x32_bf16 v[112:115], a[176:179], v[48:51], v[112:115]
 v_mul_f32 v36, s32, v36
 v_mul_f32 v37, s32, v37
 v_mfma_f32_16x16x32_bf16 v[112:115], a[208:211], v[52:55], v[112:115]
 v_cvt_pk_bf16_f32 v44, v32, v33
 v_cvt_pk_bf16_f32 v45, v34, v35
 v_mfma_f32_16x16x32_bf16 v[116:119], a[180:183], v[48:51], v[116:119]
 v_exp_f32 v36, v36
 v_mfma_f32_16x16x32_bf16 v[116:119], a[212:215], v[52:55], v[116:119]
 v_exp_f32 v37, v37
 v_mfma_f32_16x16x32_bf16 v[120:123], a[184:187], v[48:51], v[120:123]
 v_mul_f32 v38, s32, v38
 v_mul_f32 v39, s32, v39
 v_mfma_f32_16x16x32_bf16 v[120:123], a[216:219], v[52:55], v[120:123]
 v_exp_f32 v38, v38
 v_mfma_f32_16x16x32_bf16 v[124:127], a[188:191], v[48:51], v[124:127]
 v_exp_f32 v39, v39
 v_mfma_f32_16x16x32_bf16 v[124:127], a[220:223], v[52:55], v[124:127]
 v_cvt_pk_bf16_f32 v46, v36, v37
 v_cvt_pk_bf16_f32 v47, v38, v39
 v_mfma_f32_16x16x32_bf16 v[32:35], a[128:131], a[48:51], 0
 v_mul_f32 v24, s32, v24
 v_mul_f32 v25, s32, v25
 v_mfma_f32_16x16x32_bf16 v[32:35], a[132:135], a[52:55], v[32:35]
 v_exp_f32 v24, v24
 v_mfma_f32_16x16x32_bf16 v[32:35], a[136:139], a[56:59], v[32:35]
 v_exp_f32 v25, v25
 v_mfma_f32_16x16x32_bf16 v[32:35], a[140:143], a[60:63], v[32:35]
 v_mul_f32 v26, s32, v26
 v_mul_f32 v27, s32, v27
 v_mfma_f32_16x16x32_bf16 v[36:39], a[156:159], a[60:63], 0
 v_exp_f32 v26, v26
 v_mfma_f32_16x16x32_bf16 v[36:39], a[152:155], a[56:59], v[36:39]
 v_exp_f32 v27, v27
 v_mfma_f32_16x16x32_bf16 v[36:39], a[148:151], a[52:55], v[36:39]
 v_mul_f32 v28, s32, v28
 v_mul_f32 v29, s32, v29
 v_mfma_f32_16x16x32_bf16 v[36:39], a[144:147], a[48:51], v[36:39]
 v_cvt_pk_bf16_f32 v48, v24, v25
 v_cvt_pk_bf16_f32 v49, v26, v27
 v_mfma_f32_16x16x32_bf16 v[128:131], a[160:163], v[40:43], v[128:131]
 s_add_u32 m0, s39, 33856
 v_exp_f32 v28, v28
 v_mfma_f32_16x16x32_bf16 v[128:131], a[192:195], v[44:47], v[128:131]
 buffer_load_dwordx4 v1, s[20:23], s33 offen offset:2048 nt lds
 v_mfma_f32_16x16x32_bf16 v[132:135], a[164:167], v[40:43], v[132:135]
 v_exp_f32 v29, v29
 v_mfma_f32_16x16x32_bf16 v[132:135], a[196:199], v[44:47], v[132:135]
 v_mul_f32 v30, s32, v30
 v_mul_f32 v31, s32, v31
 v_mfma_f32_16x16x32_bf16 v[136:139], a[168:171], v[40:43], v[136:139]
 v_exp_f32 v30, v30
 v_mfma_f32_16x16x32_bf16 v[136:139], a[200:203], v[44:47], v[136:139]
 v_exp_f32 v31, v31
 v_mfma_f32_16x16x32_bf16 v[140:143], a[172:175], v[40:43], v[140:143]
 v_cvt_pk_bf16_f32 v50, v28, v29
 v_cvt_pk_bf16_f32 v51, v30, v31
 v_mfma_f32_16x16x32_bf16 v[140:143], a[204:207], v[44:47], v[140:143]
 v_mul_f32 v32, s32, v32
 v_mul_f32 v33, s32, v33
 v_mfma_f32_16x16x32_bf16 v[24:27], a[96:99], a[64:67], 0
 v_exp_f32 v32, v32
 v_mfma_f32_16x16x32_bf16 v[24:27], a[100:103], a[68:71], v[24:27]
 v_exp_f32 v33, v33
 v_mfma_f32_16x16x32_bf16 v[24:27], a[104:107], a[72:75], v[24:27]
 v_mul_f32 v34, s32, v34
 v_mul_f32 v35, s32, v35
 v_mfma_f32_16x16x32_bf16 v[24:27], a[108:111], a[76:79], v[24:27]
 v_exp_f32 v34, v34
 v_smfmac_f32_16x16x64_bf16 a[228:231], a[236:239], v[40:47], v2
 v_mfma_f32_16x16x32_bf16 v[28:31], a[124:127], a[76:79], 0
 v_exp_f32 v35, v35
 v_mfma_f32_16x16x32_bf16 v[28:31], a[120:123], a[72:75], v[28:31]
 v_mul_f32 v36, s32, v36
 v_mul_f32 v37, s32, v37
 v_mfma_f32_16x16x32_bf16 v[28:31], a[116:119], a[68:71], v[28:31]
 v_cvt_pk_bf16_f32 v52, v32, v33
 v_cvt_pk_bf16_f32 v53, v34, v35
 v_mfma_f32_16x16x32_bf16 v[28:31], a[112:115], a[64:67], v[28:31]
 v_exp_f32 v36, v36
 v_mfma_f32_16x16x32_bf16 v[144:147], a[176:179], v[40:43], v[144:147]
 s_add_u32 m0, s39, 33888
 v_exp_f32 v37, v37
 v_mfma_f32_16x16x32_bf16 v[144:147], a[208:211], v[44:47], v[144:147]
 buffer_load_dwordx4 v1, s[20:23], s33 offen offset:3072 nt lds
 v_mfma_f32_16x16x32_bf16 v[148:151], a[180:183], v[40:43], v[148:151]
 s_add_u32 s33, s33, 8192
 v_mul_f32 v38, s32, v38
 v_mul_f32 v39, s32, v39
 v_mfma_f32_16x16x32_bf16 v[148:151], a[212:215], v[44:47], v[148:151]
 v_exp_f32 v38, v38
 v_mfma_f32_16x16x32_bf16 v[152:155], a[184:187], v[40:43], v[152:155]
 v_exp_f32 v39, v39
 v_mfma_f32_16x16x32_bf16 v[152:155], a[216:219], v[44:47], v[152:155]
 v_cvt_pk_bf16_f32 v54, v36, v37
 v_cvt_pk_bf16_f32 v55, v38, v39
 v_mfma_f32_16x16x32_bf16 v[156:159], a[188:191], v[40:43], v[156:159]
 v_mul_f32 v24, s32, v24
 v_mul_f32 v25, s32, v25
 v_mfma_f32_16x16x32_bf16 v[156:159], a[220:223], v[44:47], v[156:159]
 v_exp_f32 v24, v24
 v_mfma_f32_16x16x32_bf16 v[32:35], a[128:131], a[64:67], 0
 v_exp_f32 v25, v25
 v_mfma_f32_16x16x32_bf16 v[32:35], a[132:135], a[68:71], v[32:35]
 v_mul_f32 v26, s32, v26
 v_mul_f32 v27, s32, v27
 v_mfma_f32_16x16x32_bf16 v[32:35], a[136:139], a[72:75], v[32:35]
 v_exp_f32 v26, v26
 v_mfma_f32_16x16x32_bf16 v[32:35], a[140:143], a[76:79], v[32:35]
 v_exp_f32 v27, v27
 v_mfma_f32_16x16x32_bf16 v[36:39], a[156:159], a[76:79], 0
 v_mul_f32 v28, s32, v28
 v_mul_f32 v29, s32, v29
 v_mfma_f32_16x16x32_bf16 v[36:39], a[152:155], a[72:75], v[36:39]
 v_cvt_pk_bf16_f32 v40, v24, v25
 v_cvt_pk_bf16_f32 v41, v26, v27
 v_mfma_f32_16x16x32_bf16 v[36:39], a[148:151], a[68:71], v[36:39]
 v_exp_f32 v28, v28
 v_mfma_f32_16x16x32_bf16 v[36:39], a[144:147], a[64:67], v[36:39]
 v_exp_f32 v29, v29
 v_mfma_f32_16x16x32_bf16 v[160:163], a[160:163], v[48:51], v[160:163]
 v_mul_f32 v30, s32, v30
 v_mul_f32 v31, s32, v31
 v_mfma_f32_16x16x32_bf16 v[160:163], a[192:195], v[52:55], v[160:163]
 v_exp_f32 v30, v30
 v_mfma_f32_16x16x32_bf16 v[164:167], a[164:167], v[48:51], v[164:167]
 s_add_u32 m0, s39, 50688
 v_exp_f32 v31, v31
 v_mfma_f32_16x16x32_bf16 v[164:167], a[196:199], v[52:55], v[164:167]
 buffer_load_dwordx4 v1, s[20:23], s33 offen nt lds
 v_mfma_f32_16x16x32_bf16 v[168:171], a[168:171], v[48:51], v[168:171]
 v_cvt_pk_bf16_f32 v42, v28, v29
 v_cvt_pk_bf16_f32 v43, v30, v31
 v_mfma_f32_16x16x32_bf16 v[168:171], a[200:203], v[52:55], v[168:171]
 v_mul_f32 v32, s32, v32
 v_mul_f32 v33, s32, v33
 v_mfma_f32_16x16x32_bf16 v[172:175], a[172:175], v[48:51], v[172:175]
 v_exp_f32 v32, v32
 v_mfma_f32_16x16x32_bf16 v[172:175], a[204:207], v[52:55], v[172:175]
 v_exp_f32 v33, v33
 v_mfma_f32_16x16x32_bf16 v[24:27], a[96:99], a[80:83], 0
 v_mul_f32 v34, s32, v34
 v_mul_f32 v35, s32, v35
 v_mfma_f32_16x16x32_bf16 v[24:27], a[100:103], a[84:87], v[24:27]
 v_exp_f32 v34, v34
 v_mfma_f32_16x16x32_bf16 v[24:27], a[104:107], a[88:91], v[24:27]
 v_exp_f32 v35, v35
 v_mfma_f32_16x16x32_bf16 v[24:27], a[108:111], a[92:95], v[24:27]
 v_mul_f32 v36, s32, v36
 v_mul_f32 v37, s32, v37
 v_smfmac_f32_16x16x64_bf16 a[228:231], a[240:243], v[48:55], v2
 v_mfma_f32_16x16x32_bf16 v[28:31], a[124:127], a[92:95], 0
 v_cvt_pk_bf16_f32 v44, v32, v33
 v_cvt_pk_bf16_f32 v45, v34, v35
 v_mfma_f32_16x16x32_bf16 v[28:31], a[120:123], a[88:91], v[28:31]
 v_exp_f32 v36, v36
 v_mfma_f32_16x16x32_bf16 v[28:31], a[116:119], a[84:87], v[28:31]
 v_exp_f32 v37, v37
 v_mfma_f32_16x16x32_bf16 v[28:31], a[112:115], a[80:83], v[28:31]
 s_waitcnt vmcnt(7)
 s_barrier
 v_mfma_f32_16x16x32_bf16 v[176:179], a[176:179], v[48:51], v[176:179]
 v_mul_f32 v38, s32, v38
 v_mul_f32 v39, s32, v39
 v_mfma_f32_16x16x32_bf16 v[176:179], a[208:211], v[52:55], v[176:179]
 v_exp_f32 v38, v38
 v_mfma_f32_16x16x32_bf16 v[180:183], a[180:183], v[48:51], v[180:183]
 s_add_u32 m0, s39, 50720
 ds_read_b128 a[96:99], v7 offset:0
 ds_read_b128 a[100:103], v7 offset:64
 v_mfma_f32_16x16x32_bf16 v[180:183], a[212:215], v[52:55], v[180:183]
 buffer_load_dwordx4 v1, s[20:23], s33 offen offset:1024 nt lds
 v_mfma_f32_16x16x32_bf16 v[184:187], a[184:187], v[48:51], v[184:187]
 v_exp_f32 v39, v39
 v_mfma_f32_16x16x32_bf16 v[184:187], a[216:219], v[52:55], v[184:187]
 v_cvt_pk_bf16_f32 v46, v36, v37
 v_cvt_pk_bf16_f32 v47, v38, v39
 v_mfma_f32_16x16x32_bf16 v[188:191], a[188:191], v[48:51], v[188:191]
 ds_read_b128 a[104:107], v7 offset:128
 ds_read_b128 a[108:111], v7 offset:192
 v_mfma_f32_16x16x32_bf16 v[188:191], a[220:223], v[52:55], v[188:191]
 v_mul_f32 v24, s32, v24
 v_mul_f32 v25, s32, v25
 v_mfma_f32_16x16x32_bf16 v[32:35], a[128:131], a[80:83], 0
 v_exp_f32 v24, v24
 v_mfma_f32_16x16x32_bf16 v[32:35], a[132:135], a[84:87], v[32:35]
 v_exp_f32 v25, v25
 v_mfma_f32_16x16x32_bf16 v[32:35], a[136:139], a[88:91], v[32:35]
 ds_read_b128 a[124:127], v7 offset:704
 ds_read_b128 a[120:123], v7 offset:640
 v_mfma_f32_16x16x32_bf16 v[32:35], a[140:143], a[92:95], v[32:35]
 v_mul_f32 v26, s32, v26
 v_mul_f32 v27, s32, v27
 v_mfma_f32_16x16x32_bf16 v[36:39], a[156:159], a[92:95], 0
 v_exp_f32 v26, v26
 v_mfma_f32_16x16x32_bf16 v[36:39], a[152:155], a[88:91], v[36:39]
 v_exp_f32 v27, v27
 v_mfma_f32_16x16x32_bf16 v[36:39], a[148:151], a[84:87], v[36:39]
 ds_read_b128 a[116:119], v7 offset:576
 ds_read_b128 a[112:115], v7 offset:512
 v_mfma_f32_16x16x32_bf16 v[36:39], a[144:147], a[80:83], v[36:39]
 v_mul_f32 v28, s32, v28
 v_mul_f32 v29, s32, v29
 v_mfma_f32_16x16x32_bf16 v[192:195], a[160:163], v[40:43], v[192:195]
 v_cvt_pk_bf16_f32 v48, v24, v25
 v_cvt_pk_bf16_f32 v49, v26, v27
 v_mfma_f32_16x16x32_bf16 v[192:195], a[192:195], v[44:47], v[192:195]
 v_exp_f32 v28, v28
 v_mfma_f32_16x16x32_bf16 v[196:199], a[164:167], v[40:43], v[196:199]
 v_exp_f32 v29, v29
 v_mfma_f32_16x16x32_bf16 v[196:199], a[196:199], v[44:47], v[196:199]
 ds_read_b128 a[128:131], v7 offset:16896
 ds_read_b128 a[132:135], v7 offset:16960
 v_mfma_f32_16x16x32_bf16 v[200:203], a[168:171], v[40:43], v[200:203]
 s_add_u32 m0, s39, 50752
 v_mul_f32 v30, s32, v30
 v_mul_f32 v31, s32, v31
 v_mfma_f32_16x16x32_bf16 v[200:203], a[200:203], v[44:47], v[200:203]
 buffer_load_dwordx4 v1, s[20:23], s33 offen offset:2048 nt lds
 v_mfma_f32_16x16x32_bf16 v[204:207], a[172:175], v[40:43], v[204:207]
 v_exp_f32 v30, v30
 v_mfma_f32_16x16x32_bf16 v[204:207], a[204:207], v[44:47], v[204:207]
 s_waitcnt lgkmcnt(6)
 ds_read_b128 a[136:139], v7 offset:17024
 ds_read_b128 a[140:143], v7 offset:17088
 v_mfma_f32_16x16x32_bf16 v[24:27], a[96:99], a[0:3], 0
 v_exp_f32 v31, v31
 v_mfma_f32_16x16x32_bf16 v[24:27], a[100:103], a[4:7], v[24:27]
 v_cvt_pk_bf16_f32 v50, v28, v29
 v_cvt_pk_bf16_f32 v51, v30, v31
 v_mfma_f32_16x16x32_bf16 v[24:27], a[104:107], a[8:11], v[24:27]
 v_mul_f32 v32, s32, v32
 v_mul_f32 v33, s32, v33
 v_mfma_f32_16x16x32_bf16 v[24:27], a[108:111], a[12:15], v[24:27]
 s_waitcnt lgkmcnt(4)
 ds_read_b128 a[156:159], v7 offset:17600
 ds_read_b128 a[152:155], v7 offset:17536
 v_exp_f32 v32, v32
 v_smfmac_f32_16x16x64_bf16 a[232:235], a[236:239], v[40:47], v2
 v_exp_f32 v33, v33
 v_mfma_f32_16x16x32_bf16 v[28:31], a[124:127], a[12:15], 0
 v_mul_f32 v34, s32, v34
 v_mul_f32 v35, s32, v35
 v_mfma_f32_16x16x32_bf16 v[28:31], a[120:123], a[8:11], v[28:31]
 v_exp_f32 v34, v34
 v_mfma_f32_16x16x32_bf16 v[28:31], a[116:119], a[4:7], v[28:31]
 ds_read_b128 a[148:151], v7 offset:17472
 ds_read_b128 a[144:147], v7 offset:17408
 v_mfma_f32_16x16x32_bf16 v[28:31], a[112:115], a[0:3], v[28:31]
 v_exp_f32 v35, v35
 v_mul_f32 v36, s32, v36
 v_mfma_f32_16x16x32_bf16 v[208:211], a[176:179], v[40:43], v[208:211]
 v_mul_f32 v37, s32, v37
 v_cvt_pk_bf16_f32 v52, v32, v33
 v_mfma_f32_16x16x32_bf16 v[208:211], a[208:211], v[44:47], v[208:211]
L_pg1_8:
 s_cbranch_execz L_pg1_12
 v_cvt_pk_bf16_f32 v53, v34, v35
 v_exp_f32 v36, v36
 v_mfma_f32_16x16x32_bf16 v[212:215], a[180:183], v[40:43], v[212:215]
 s_add_u32 m0, s39, 50784
 v_exp_f32 v37, v37
 v_mfma_f32_16x16x32_bf16 v[212:215], a[212:215], v[44:47], v[212:215]
 buffer_load_dwordx4 v1, s[20:23], s33 offen offset:3072 nt lds
 v_mfma_f32_16x16x32_bf16 v[216:219], a[184:187], v[40:43], v[216:219]
 s_add_u32 s33, s33, 8192
 v_mul_f32 v38, s32, v38
 v_mul_f32 v39, s32, v39
 v_mfma_f32_16x16x32_bf16 v[216:219], a[216:219], v[44:47], v[216:219]
 v_exp_f32 v38, v38
 v_mfma_f32_16x16x32_bf16 v[220:223], a[188:191], v[40:43], v[220:223]
 v_exp_f32 v39, v39
 v_mfma_f32_16x16x32_bf16 v[220:223], a[220:223], v[44:47], v[220:223]
 s_waitcnt lgkmcnt(4)
 ds_read_b128 v[56:59], v6 offset:4352
 v_cvt_pk_bf16_f32 v54, v36, v37
 v_cvt_pk_bf16_f32 v55, v38, v39
 v_mfma_f32_16x16x32_bf16 v[32:35], a[128:131], a[0:3], 0
 v_mul_f32 v24, s32, v24
 v_mul_f32 v25, s32, v25
 v_mfma_f32_16x16x32_bf16 v[32:35], a[132:135], a[4:7], v[32:35]
 v_exp_f32 v24, v24
 v_mfma_f32_16x16x32_bf16 v[32:35], a[136:139], a[8:11], v[32:35]
 v_exp_f32 v25, v25
 v_mfma_f32_16x16x32_bf16 v[32:35], a[140:143], a[12:15], v[32:35]
 s_waitcnt lgkmcnt(1)
 v_mul_f32 v26, s32, v26
 v_mul_f32 v27, s32, v27
 v_mfma_f32_16x16x32_bf16 v[36:39], a[156:159], a[12:15], 0
 v_exp_f32 v26, v26
 v_mfma_f32_16x16x32_bf16 v[36:39], a[152:155], a[8:11], v[36:39]
 v_exp_f32 v27, v27
 v_mfma_f32_16x16x32_bf16 v[36:39], a[148:151], a[4:7], v[36:39]
 v_mul_f32 v28, s32, v28
 v_mul_f32 v29, s32, v29
 v_mfma_f32_16x16x32_bf16 v[36:39], a[144:147], a[0:3], v[36:39]
 v_cvt_pk_bf16_f32 v40, v24, v25
 v_cvt_pk_bf16_f32 v41, v26, v27
 v_mfma_f32_16x16x32_bf16 v[224:227], a[160:163], v[48:51], v[224:227]
 s_mov_b32 s38, 4096
 v_exp_f32 v28, v28
 v_mfma_f32_16x16x32_bf16 v[224:227], a[192:195], v[52:55], v[224:227]
 s_waitcnt lgkmcnt(0)
 buffer_store_dwordx4 v[56:59], v1, s[24:27], s38 offen sc1 nt
 v_mfma_f32_16x16x32_bf16 v[228:231], a[164:167], v[48:51], v[228:231]
 ds_read_b64_tr_b16 a[160:161], v8 offset:0
 ds_read_b64_tr_b16 a[162:163], v8 offset:512
 v_mfma_f32_16x16x32_bf16 v[228:231], a[196:199], v[52:55], v[228:231]
 v_exp_f32 v29, v29
 v_mul_f32 v30, s32, v30
 v_mfma_f32_16x16x32_bf16 v[232:235], a[168:171], v[48:51], v[232:235]
 ds_read_b64_tr_b16 a[192:193], v8 offset:16896
 ds_read_b64_tr_b16 a[194:195], v8 offset:17408
 v_mfma_f32_16x16x32_bf16 v[232:235], a[200:203], v[52:55], v[232:235]
 v_mul_f32 v31, s32, v31
 v_exp_f32 v30, v30
 v_mfma_f32_16x16x32_bf16 v[236:239], a[172:175], v[48:51], v[236:239]
 v_exp_f32 v31, v31
 v_mfma_f32_16x16x32_bf16 v[236:239], a[204:207], v[52:55], v[236:239]
 ds_read_b64_tr_b16 a[164:165], v8 offset:32
 ds_read_b64_tr_b16 a[166:167], v8 offset:544
 v_cvt_pk_bf16_f32 v42, v28, v29
 v_cvt_pk_bf16_f32 v43, v30, v31
 v_mfma_f32_16x16x32_bf16 v[24:27], a[96:99], a[16:19], 0
 v_mul_f32 v32, s32, v32
 v_mul_f32 v33, s32, v33
 v_mfma_f32_16x16x32_bf16 v[24:27], a[100:103], a[20:23], v[24:27]
 ds_read_b64_tr_b16 a[196:197], v8 offset:16928
 ds_read_b64_tr_b16 a[198:199], v8 offset:17440
 v_mfma_f32_16x16x32_bf16 v[24:27], a[104:107], a[24:27], v[24:27]
 v_exp_f32 v32, v32
 v_mfma_f32_16x16x32_bf16 v[24:27], a[108:111], a[28:31], v[24:27]
 ds_read_b64_tr_b16 a[168:169], v8 offset:64
 ds_read_b64_tr_b16 a[170:171], v8 offset:576
 v_exp_f32 v33, v33
 v_smfmac_f32_16x16x64_bf16 a[232:235], a[240:243], v[48:55], v2
 v_mul_f32 v34, s32, v34
 v_mul_f32 v35, s32, v35
 v_mfma_f32_16x16x32_bf16 v[28:31], a[124:127], a[28:31], 0
 ds_read_b64_tr_b16 a[200:201], v8 offset:16960
 ds_read_b64_tr_b16 a[202:203], v8 offset:17472
 v_mfma_f32_16x16x32_bf16 v[28:31], a[120:123], a[24:27], v[28:31]
 v_exp_f32 v34, v34
 v_mfma_f32_16x16x32_bf16 v[28:31], a[116:119], a[20:23], v[28:31]
 v_exp_f32 v35, v35
 v_mfma_f32_16x16x32_bf16 v[28:31], a[112:115], a[16:19], v[28:31]
 ds_read_b64_tr_b16 a[172:173], v8 offset:96
 ds_read_b64_tr_b16 a[174:175], v8 offset:608
 v_mul_f32 v36, s32, v36
 v_mfma_f32_16x16x32_bf16 v[240:243], a[176:179], v[48:51], v[240:243]
 v_mul_f32 v37, s32, v37
 v_cvt_pk_bf16_f32 v44, v32, v33
 v_mfma_f32_16x16x32_bf16 v[240:243], a[208:211], v[52:55], v[240:243]
 ds_read_b64_tr_b16 a[204:205], v8 offset:16992
 ds_read_b64_tr_b16 a[206:207], v8 offset:17504
 v_cvt_pk_bf16_f32 v45, v34, v35
 v_mfma_f32_16x16x32_bf16 v[244:247], a[180:183], v[48:51], v[244:247]
 v_exp_f32 v36, v36
 v_mfma_f32_16x16x32_bf16 v[244:247], a[212:215], v[52:55], v[244:247]
 v_exp_f32 v37, v37
 v_mfma_f32_16x16x32_bf16 v[248:251], a[184:187], v[48:51], v[248:251]
 v_mul_f32 v38, s32, v38
 v_mul_f32 v39, s32, v39
 v_mfma_f32_16x16x32_bf16 v[248:251], a[216:219], v[52:55], v[248:251]
 ds_read_b64_tr_b16 a[176:177], v8 offset:128
 ds_read_b64_tr_b16 a[178:179], v8 offset:640
 v_mfma_f32_16x16x32_bf16 v[252:255], a[188:191], v[48:51], v[252:255]
 v_exp_f32 v38, v38
 v_mfma_f32_16x16x32_bf16 v[252:255], a[220:223], v[52:55], v[252:255]
 v_exp_f32 v39, v39
 v_cvt_pk_bf16_f32 v46, v36, v37
 v_cvt_pk_bf16_f32 v47, v38, v39
 v_mfma_f32_16x16x32_bf16 v[32:35], a[128:131], a[16:19], 0
 ds_read_b64_tr_b16 a[208:209], v8 offset:17024
 ds_read_b64_tr_b16 a[210:211], v8 offset:17536
 v_mfma_f32_16x16x32_bf16 v[32:35], a[132:135], a[20:23], v[32:35]
 v_mul_f32 v24, s32, v24
 v_mul_f32 v25, s32, v25
 v_mfma_f32_16x16x32_bf16 v[32:35], a[136:139], a[24:27], v[32:35]
 v_exp_f32 v24, v24
 v_mfma_f32_16x16x32_bf16 v[32:35], a[140:143], a[28:31], v[32:35]
 ds_read_b64_tr_b16 a[180:181], v8 offset:160
 ds_read_b64_tr_b16 a[182:183], v8 offset:672
 v_exp_f32 v25, v25
 v_mfma_f32_16x16x32_bf16 v[36:39], a[156:159], a[28:31], 0
 v_mul_f32 v26, s32, v26
 v_mul_f32 v27, s32, v27
 v_mfma_f32_16x16x32_bf16 v[36:39], a[152:155], a[24:27], v[36:39]
 v_exp_f32 v26, v26
 v_mfma_f32_16x16x32_bf16 v[36:39], a[148:151], a[20:23], v[36:39]
 ds_read_b64_tr_b16 a[212:213], v8 offset:17056
 ds_read_b64_tr_b16 a[214:215], v8 offset:17568
 v_mfma_f32_16x16x32_bf16 v[36:39], a[144:147], a[16:19], v[36:39]
 s_waitcnt lgkmcnt(15)
 v_exp_f32 v27, v27
 v_mul_f32 v28, s32, v28
 v_mfma_f32_16x16x32_bf16 v[64:67], a[160:163], v[40:43], v[64:67]
 v_mul_f32 v29, s32, v29
 v_cvt_pk_bf16_f32 v48, v24, v25
 v_mfma_f32_16x16x32_bf16 v[64:67], a[192:195], v[44:47], v[64:67]
 ds_read_b64_tr_b16 a[184:185], v8 offset:192
 ds_read_b64_tr_b16 a[186:187], v8 offset:704
 v_cvt_pk_bf16_f32 v49, v26, v27
 v_mfma_f32_16x16x32_bf16 v[68:71], a[164:167], v[40:43], v[68:71]
 v_exp_f32 v28, v28
 v_mfma_f32_16x16x32_bf16 v[68:71], a[196:199], v[44:47], v[68:71]
 s_waitcnt lgkmcnt(10)
 v_exp_f32 v29, v29
 v_mfma_f32_16x16x32_bf16 v[72:75], a[168:171], v[40:43], v[72:75]
 ds_read_b64_tr_b16 a[216:217], v8 offset:17088
 ds_read_b64_tr_b16 a[218:219], v8 offset:17600
 v_mfma_f32_16x16x32_bf16 v[72:75], a[200:203], v[44:47], v[72:75]
 v_mul_f32 v30, s32, v30
 v_mul_f32 v31, s32, v31
 v_mfma_f32_16x16x32_bf16 v[76:79], a[172:175], v[40:43], v[76:79]
 v_exp_f32 v30, v30
 v_mfma_f32_16x16x32_bf16 v[76:79], a[204:207], v[44:47], v[76:79]
 ds_read_b64_tr_b16 a[188:189], v8 offset:224
 ds_read_b64_tr_b16 a[190:191], v8 offset:736
 v_mfma_f32_16x16x32_bf16 v[24:27], a[96:99], a[32:35], 0
 ds_read_b128 v[60:63], v6 offset:5440
 v_exp_f32 v31, v31
 v_mfma_f32_16x16x32_bf16 v[24:27], a[100:103], a[36:39], v[24:27]
 v_cvt_pk_bf16_f32 v50, v28, v29
 v_cvt_pk_bf16_f32 v51, v30, v31
 v_mfma_f32_16x16x32_bf16 v[24:27], a[104:107], a[40:43], v[24:27]
 ds_read_b64_tr_b16 a[220:221], v8 offset:17120
 ds_read_b64_tr_b16 a[222:223], v8 offset:17632
 v_mfma_f32_16x16x32_bf16 v[24:27], a[108:111], a[44:47], v[24:27]
 v_mul_f32 v32, s32, v32
 v_mul_f32 v33, s32, v33
 v_smfmac_f32_16x16x64_bf16 a[224:227], a[236:239], v[40:47], v2
 v_exp_f32 v32, v32
 v_mfma_f32_16x16x32_bf16 v[28:31], a[124:127], a[44:47], 0
 v_exp_f32 v33, v33
 v_mfma_f32_16x16x32_bf16 v[28:31], a[120:123], a[40:43], v[28:31]
 v_mul_f32 v34, s32, v34
 v_mul_f32 v35, s32, v35
 v_mfma_f32_16x16x32_bf16 v[28:31], a[116:119], a[36:39], v[28:31]
 v_exp_f32 v34, v34
 v_mfma_f32_16x16x32_bf16 v[28:31], a[112:115], a[32:35], v[28:31]
 s_waitcnt lgkmcnt(9)
 v_exp_f32 v35, v35
 v_mfma_f32_16x16x32_bf16 v[80:83], a[176:179], v[40:43], v[80:83]
 s_mov_b32 s38, 5120
 v_mul_f32 v36, s32, v36
 v_mul_f32 v37, s32, v37
 v_mfma_f32_16x16x32_bf16 v[80:83], a[208:211], v[44:47], v[80:83]
 s_waitcnt lgkmcnt(2)
 buffer_store_dwordx4 v[60:63], v1, s[24:27], s38 offen sc1 nt
 v_mfma_f32_16x16x32_bf16 v[84:87], a[180:183], v[40:43], v[84:87]
 v_cvt_pk_bf16_f32 v52, v32, v33
 v_cvt_pk_bf16_f32 v53, v34, v35
 v_mfma_f32_16x16x32_bf16 v[84:87], a[212:215], v[44:47], v[84:87]
 s_waitcnt lgkmcnt(0)
 s_barrier
 v_mfma_f32_16x16x32_bf16 v[88:91], a[184:187], v[40:43], v[88:91]
 v_exp_f32 v36, v36
 v_mfma_f32_16x16x32_bf16 v[88:91], a[216:219], v[44:47], v[88:91]
 v_exp_f32 v37, v37
 v_mfma_f32_16x16x32_bf16 v[92:95], a[188:191], v[40:43], v[92:95]
 v_mul_f32 v38, s32, v38
 v_mul_f32 v39, s32, v39
 v_mfma_f32_16x16x32_bf16 v[92:95], a[220:223], v[44:47], v[92:95]
 v_exp_f32 v38, v38
 v_mfma_f32_16x16x32_bf16 v[32:35], a[128:131], a[32:35], 0
 v_exp_f32 v39, v39
 v_mfma_f32_16x16x32_bf16 v[32:35], a[132:135], a[36:39], v[32:35]
 v_cvt_pk_bf16_f32 v54, v36, v37
 v_cvt_pk_bf16_f32 v55, v38, v39
 v_mfma_f32_16x16x32_bf16 v[32:35], a[136:139], a[40:43], v[32:35]
 v_mul_f32 v24, s32, v24
 v_mul_f32 v25, s32, v25
 v_mfma_f32_16x16x32_bf16 v[32:35], a[140:143], a[44:47], v[32:35]
 v_exp_f32 v24, v24
 v_mfma_f32_16x16x32_bf16 v[36:39], a[156:159], a[44:47], 0
 v_exp_f32 v25, v25
 v_mfma_f32_16x16x32_bf16 v[36:39], a[152:155], a[40:43], v[36:39]
 v_mul_f32 v26, s32, v26
 v_mul_f32 v27, s32, v27
 v_mfma_f32_16x16x32_bf16 v[36:39], a[148:151], a[36:39], v[36:39]
 s_add_u32 m0, s39, 0
 v_exp_f32 v26, v26
 v_mfma_f32_16x16x32_bf16 v[36:39], a[144:147], a[32:35], v[36:39]
 buffer_load_dwordx4 v1, s[20:23], s33 offen nt lds
 v_mfma_f32_16x16x32_bf16 v[96:99], a[160:163], v[48:51], v[96:99]
 v_exp_f32 v27, v27
 v_mfma_f32_16x16x32_bf16 v[96:99], a[192:195], v[52:55], v[96:99]
 v_mul_f32 v28, s32, v28
 v_mul_f32 v29, s32, v29
 v_mfma_f32_16x16x32_bf16 v[100:103], a[164:167], v[48:51], v[100:103]
 v_cvt_pk_bf16_f32 v40, v24, v25
 v_cvt_pk_bf16_f32 v41, v26, v27
 v_mfma_f32_16x16x32_bf16 v[100:103], a[196:199], v[52:55], v[100:103]
 v_exp_f32 v28, v28
 v_mfma_f32_16x16x32_bf16 v[104:107], a[168:171], v[48:51], v[104:107]
 v_exp_f32 v29, v29
 v_mfma_f32_16x16x32_bf16 v[104:107], a[200:203], v[52:55], v[104:107]
 v_mul_f32 v30, s32, v30
 v_mul_f32 v31, s32, v31
 v_mfma_f32_16x16x32_bf16 v[108:111], a[172:175], v[48:51], v[108:111]
 v_exp_f32 v30, v30
 v_mfma_f32_16x16x32_bf16 v[108:111], a[204:207], v[52:55], v[108:111]
 v_exp_f32 v31, v31
 v_mfma_f32_16x16x32_bf16 v[24:27], a[96:99], a[48:51], 0
 v_cvt_pk_bf16_f32 v42, v28, v29
 v_cvt_pk_bf16_f32 v43, v30, v31
 v_mfma_f32_16x16x32_bf16 v[24:27], a[100:103], a[52:55], v[24:27]
 v_mul_f32 v32, s32, v32
 v_mul_f32 v33, s32, v33
 v_mfma_f32_16x16x32_bf16 v[24:27], a[104:107], a[56:59], v[24:27]
 v_exp_f32 v32, v32
 v_mfma_f32_16x16x32_bf16 v[24:27], a[108:111], a[60:63], v[24:27]
 v_exp_f32 v33, v33
 v_smfmac_f32_16x16x64_bf16 a[224:227], a[240:243], v[48:55], v2
 v_mfma_f32_16x16x32_bf16 v[28:31], a[124:127], a[60:63], 0
 v_mul_f32 v34, s32, v34
 v_mul_f32 v35, s32, v35
 v_mfma_f32_16x16x32_bf16 v[28:31], a[120:123], a[56:59], v[28:31]
 v_exp_f32 v34, v34
 v_mfma_f32_16x16x32_bf16 v[28:31], a[116:119], a[52:55], v[28:31]
 s_add_u32 m0, s39, 32
 v_exp_f32 v35, v35
 v_mfma_f32_16x16x32_bf16 v[28:31], a[112:115], a[48:51], v[28:31]
 buffer_load_dwordx4 v1, s[20:23], s33 offen offset:1024 nt lds
 v_mfma_f32_16x16x32_bf16 v[112:115], a[176:179], v[48:51], v[112:115]
 v_mul_f32 v36, s32, v36
 v_mul_f32 v37, s32, v37
 v_mfma_f32_16x16x32_bf16 v[112:115], a[208:211], v[52:55], v[112:115]
 v_cvt_pk_bf16_f32 v44, v32, v33
 v_cvt_pk_bf16_f32 v45, v34, v35
 v_mfma_f32_16x16x32_bf16 v[116:119], a[180:183], v[48:51], v[116:119]
 v_exp_f32 v36, v36
 v_mfma_f32_16x16x32_bf16 v[116:119], a[212:215], v[52:55], v[116:119]
 v_exp_f32 v37, v37
 v_mfma_f32_16x16x32_bf16 v[120:123], a[184:187], v[48:51], v[120:123]
 v_mul_f32 v38, s32, v38
 v_mul_f32 v39, s32, v39
 v_mfma_f32_16x16x32_bf16 v[120:123], a[216:219], v[52:55], v[120:123]
 v_exp_f32 v38, v38
 v_mfma_f32_16x16x32_bf16 v[124:127], a[188:191], v[48:51], v[124:127]
 v_exp_f32 v39, v39
 v_mfma_f32_16x16x32_bf16 v[124:127], a[220:223], v[52:55], v[124:127]
 v_cvt_pk_bf16_f32 v46, v36, v37
 v_cvt_pk_bf16_f32 v47, v38, v39
 v_mfma_f32_16x16x32_bf16 v[32:35], a[128:131], a[48:51], 0
 v_mul_f32 v24, s32, v24
 v_mul_f32 v25, s32, v25
 v_mfma_f32_16x16x32_bf16 v[32:35], a[132:135], a[52:55], v[32:35]
 v_exp_f32 v24, v24
 v_mfma_f32_16x16x32_bf16 v[32:35], a[136:139], a[56:59], v[32:35]
 v_exp_f32 v25, v25
 v_mfma_f32_16x16x32_bf16 v[32:35], a[140:143], a[60:63], v[32:35]
 v_mul_f32 v26, s32, v26
 v_mul_f32 v27, s32, v27
 v_mfma_f32_16x16x32_bf16 v[36:39], a[156:159], a[60:63], 0
 v_exp_f32 v26, v26
 v_mfma_f32_16x16x32_bf16 v[36:39], a[152:155], a[56:59], v[36:39]
 v_exp_f32 v27, v27
 v_mfma_f32_16x16x32_bf16 v[36:39], a[148:151], a[52:55], v[36:39]
 v_mul_f32 v28, s32, v28
 v_mul_f32 v29, s32, v29
 v_mfma_f32_16x16x32_bf16 v[36:39], a[144:147], a[48:51], v[36:39]
 v_cvt_pk_bf16_f32 v48, v24, v25
 v_cvt_pk_bf16_f32 v49, v26, v27
 v_mfma_f32_16x16x32_bf16 v[128:131], a[160:163], v[40:43], v[128:131]
 s_add_u32 m0, s39, 64
 v_exp_f32 v28, v28
 v_mfma_f32_16x16x32_bf16 v[128:131], a[192:195], v[44:47], v[128:131]
 buffer_load_dwordx4 v1, s[20:23], s33 offen offset:2048 nt lds
 v_mfma_f32_16x16x32_bf16 v[132:135], a[164:167], v[40:43], v[132:135]
 v_exp_f32 v29, v29
 v_mfma_f32_16x16x32_bf16 v[132:135], a[196:199], v[44:47], v[132:135]
 v_mul_f32 v30, s32, v30
 v_mul_f32 v31, s32, v31
 v_mfma_f32_16x16x32_bf16 v[136:139], a[168:171], v[40:43], v[136:139]
 v_exp_f32 v30, v30
 v_mfma_f32_16x16x32_bf16 v[136:139], a[200:203], v[44:47], v[136:139]
 v_exp_f32 v31, v31
 v_mfma_f32_16x16x32_bf16 v[140:143], a[172:175], v[40:43], v[140:143]
 v_cvt_pk_bf16_f32 v50, v28, v29
 v_cvt_pk_bf16_f32 v51, v30, v31
 v_mfma_f32_16x16x32_bf16 v[140:143], a[204:207], v[44:47], v[140:143]
 v_mul_f32 v32, s32, v32
 v_mul_f32 v33, s32, v33
 v_mfma_f32_16x16x32_bf16 v[24:27], a[96:99], a[64:67], 0
 v_exp_f32 v32, v32
 v_mfma_f32_16x16x32_bf16 v[24:27], a[100:103], a[68:71], v[24:27]
 v_exp_f32 v33, v33
 v_mfma_f32_16x16x32_bf16 v[24:27], a[104:107], a[72:75], v[24:27]
 v_mul_f32 v34, s32, v34
 v_mul_f32 v35, s32, v35
 v_mfma_f32_16x16x32_bf16 v[24:27], a[108:111], a[76:79], v[24:27]
 v_exp_f32 v34, v34
 v_smfmac_f32_16x16x64_bf16 a[228:231], a[236:239], v[40:47], v2
 v_mfma_f32_16x16x32_bf16 v[28:31], a[124:127], a[76:79], 0
 v_exp_f32 v35, v35
 v_mfma_f32_16x16x32_bf16 v[28:31], a[120:123], a[72:75], v[28:31]
 v_mul_f32 v36, s32, v36
 v_mul_f32 v37, s32, v37
 v_mfma_f32_16x16x32_bf16 v[28:31], a[116:119], a[68:71], v[28:31]
 v_cvt_pk_bf16_f32 v52, v32, v33
 v_cvt_pk_bf16_f32 v53, v34, v35
 v_mfma_f32_16x16x32_bf16 v[28:31], a[112:115], a[64:67], v[28:31]
 v_exp_f32 v36, v36
 v_mfma_f32_16x16x32_bf16 v[144:147], a[176:179], v[40:43], v[144:147]
 s_add_u32 m0, s39, 96
 v_exp_f32 v37, v37
 v_mfma_f32_16x16x32_bf16 v[144:147], a[208:211], v[44:47], v[144:147]
 buffer_load_dwordx4 v1, s[20:23], s33 offen offset:3072 nt lds
 v_mfma_f32_16x16x32_bf16 v[148:151], a[180:183], v[40:43], v[148:151]
 s_add_u32 s33, s33, 8192
 v_mul_f32 v38, s32, v38
 v_mul_f32 v39, s32, v39
 v_mfma_f32_16x16x32_bf16 v[148:151], a[212:215], v[44:47], v[148:151]
 v_exp_f32 v38, v38
 v_mfma_f32_16x16x32_bf16 v[152:155], a[184:187], v[40:43], v[152:155]
 v_exp_f32 v39, v39
 v_mfma_f32_16x16x32_bf16 v[152:155], a[216:219], v[44:47], v[152:155]
 v_cvt_pk_bf16_f32 v54, v36, v37
 v_cvt_pk_bf16_f32 v55, v38, v39
 v_mfma_f32_16x16x32_bf16 v[156:159], a[188:191], v[40:43], v[156:159]
 v_mul_f32 v24, s32, v24
 v_mul_f32 v25, s32, v25
 v_mfma_f32_16x16x32_bf16 v[156:159], a[220:223], v[44:47], v[156:159]
 v_exp_f32 v24, v24
 v_mfma_f32_16x16x32_bf16 v[32:35], a[128:131], a[64:67], 0
 v_exp_f32 v25, v25
 v_mfma_f32_16x16x32_bf16 v[32:35], a[132:135], a[68:71], v[32:35]
 v_mul_f32 v26, s32, v26
 v_mul_f32 v27, s32, v27
 v_mfma_f32_16x16x32_bf16 v[32:35], a[136:139], a[72:75], v[32:35]
 v_exp_f32 v26, v26
 v_mfma_f32_16x16x32_bf16 v[32:35], a[140:143], a[76:79], v[32:35]
 v_exp_f32 v27, v27
 v_mfma_f32_16x16x32_bf16 v[36:39], a[156:159], a[76:79], 0
 v_mul_f32 v28, s32, v28
 v_mul_f32 v29, s32, v29
 v_mfma_f32_16x16x32_bf16 v[36:39], a[152:155], a[72:75], v[36:39]
 v_cvt_pk_bf16_f32 v40, v24, v25
 v_cvt_pk_bf16_f32 v41, v26, v27
 v_mfma_f32_16x16x32_bf16 v[36:39], a[148:151], a[68:71], v[36:39]
 v_exp_f32 v28, v28
 v_mfma_f32_16x16x32_bf16 v[36:39], a[144:147], a[64:67], v[36:39]
 v_exp_f32 v29, v29
 v_mfma_f32_16x16x32_bf16 v[160:163], a[160:163], v[48:51], v[160:163]
 v_mul_f32 v30, s32, v30
 v_mul_f32 v31, s32, v31
 v_mfma_f32_16x16x32_bf16 v[160:163], a[192:195], v[52:55], v[160:163]
 v_exp_f32 v30, v30
 v_mfma_f32_16x16x32_bf16 v[164:167], a[164:167], v[48:51], v[164:167]
 s_add_u32 m0, s39, 16896
 v_exp_f32 v31, v31
 v_mfma_f32_16x16x32_bf16 v[164:167], a[196:199], v[52:55], v[164:167]
 buffer_load_dwordx4 v1, s[20:23], s33 offen nt lds
 v_mfma_f32_16x16x32_bf16 v[168:171], a[168:171], v[48:51], v[168:171]
 v_cvt_pk_bf16_f32 v42, v28, v29
 v_cvt_pk_bf16_f32 v43, v30, v31
 v_mfma_f32_16x16x32_bf16 v[168:171], a[200:203], v[52:55], v[168:171]
 v_mul_f32 v32, s32, v32
 v_mul_f32 v33, s32, v33
 v_mfma_f32_16x16x32_bf16 v[172:175], a[172:175], v[48:51], v[172:175]
 v_exp_f32 v32, v32
 v_mfma_f32_16x16x32_bf16 v[172:175], a[204:207], v[52:55], v[172:175]
 v_exp_f32 v33, v33
 v_mfma_f32_16x16x32_bf16 v[24:27], a[96:99], a[80:83], 0
 v_mul_f32 v34, s32, v34
 v_mul_f32 v35, s32, v35
 v_mfma_f32_16x16x32_bf16 v[24:27], a[100:103], a[84:87], v[24:27]
 v_exp_f32 v34, v34
 v_mfma_f32_16x16x32_bf16 v[24:27], a[104:107], a[88:91], v[24:27]
 v_exp_f32 v35, v35
 v_mfma_f32_16x16x32_bf16 v[24:27], a[108:111], a[92:95], v[24:27]
 v_mul_f32 v36, s32, v36
 v_mul_f32 v37, s32, v37
 v_smfmac_f32_16x16x64_bf16 a[228:231], a[240:243], v[48:55], v2
 v_mfma_f32_16x16x32_bf16 v[28:31], a[124:127], a[92:95], 0
 v_cvt_pk_bf16_f32 v44, v32, v33
 v_cvt_pk_bf16_f32 v45, v34, v35
 v_mfma_f32_16x16x32_bf16 v[28:31], a[120:123], a[88:91], v[28:31]
 v_exp_f32 v36, v36
 v_mfma_f32_16x16x32_bf16 v[28:31], a[116:119], a[84:87], v[28:31]
 v_exp_f32 v37, v37
 v_mfma_f32_16x16x32_bf16 v[28:31], a[112:115], a[80:83], v[28:31]
 s_waitcnt vmcnt(7)
 s_barrier
 v_mfma_f32_16x16x32_bf16 v[176:179], a[176:179], v[48:51], v[176:179]
 v_mul_f32 v38, s32, v38
 v_mul_f32 v39, s32, v39
 v_mfma_f32_16x16x32_bf16 v[176:179], a[208:211], v[52:55], v[176:179]
 v_exp_f32 v38, v38
 v_mfma_f32_16x16x32_bf16 v[180:183], a[180:183], v[48:51], v[180:183]
 s_add_u32 m0, s39, 16928
 ds_read_b128 a[96:99], v7 offset:33792
 ds_read_b128 a[100:103], v7 offset:33856
 v_mfma_f32_16x16x32_bf16 v[180:183], a[212:215], v[52:55], v[180:183]
 buffer_load_dwordx4 v1, s[20:23], s33 offen offset:1024 nt lds
 v_mfma_f32_16x16x32_bf16 v[184:187], a[184:187], v[48:51], v[184:187]
 v_exp_f32 v39, v39
 v_mfma_f32_16x16x32_bf16 v[184:187], a[216:219], v[52:55], v[184:187]
 v_cvt_pk_bf16_f32 v46, v36, v37
 v_cvt_pk_bf16_f32 v47, v38, v39
 v_mfma_f32_16x16x32_bf16 v[188:191], a[188:191], v[48:51], v[188:191]
 ds_read_b128 a[104:107], v7 offset:33920
 ds_read_b128 a[108:111], v7 offset:33984
 v_mfma_f32_16x16x32_bf16 v[188:191], a[220:223], v[52:55], v[188:191]
 v_mul_f32 v24, s32, v24
 v_mul_f32 v25, s32, v25
 v_mfma_f32_16x16x32_bf16 v[32:35], a[128:131], a[80:83], 0
 v_exp_f32 v24, v24
 v_mfma_f32_16x16x32_bf16 v[32:35], a[132:135], a[84:87], v[32:35]
 v_exp_f32 v25, v25
 v_mfma_f32_16x16x32_bf16 v[32:35], a[136:139], a[88:91], v[32:35]
 ds_read_b128 a[124:127], v7 offset:34496
 ds_read_b128 a[120:123], v7 offset:34432
 v_mfma_f32_16x16x32_bf16 v[32:35], a[140:143], a[92:95], v[32:35]
 v_mul_f32 v26, s32, v26
 v_mul_f32 v27, s32, v27
 v_mfma_f32_16x16x32_bf16 v[36:39], a[156:159], a[92:95], 0
 v_exp_f32 v26, v26
 v_mfma_f32_16x16x32_bf16 v[36:39], a[152:155], a[88:91], v[36:39]
 v_exp_f32 v27, v27
 v_mfma_f32_16x16x32_bf16 v[36:39], a[148:151], a[84:87], v[36:39]
 ds_read_b128 a[116:119], v7 offset:34368
 ds_read_b128 a[112:115], v7 offset:34304
 v_mfma_f32_16x16x32_bf16 v[36:39], a[144:147], a[80:83], v[36:39]
 v_mul_f32 v28, s32, v28
 v_mul_f32 v29, s32, v29
 v_mfma_f32_16x16x32_bf16 v[192:195], a[160:163], v[40:43], v[192:195]
 v_cvt_pk_bf16_f32 v48, v24, v25
 v_cvt_pk_bf16_f32 v49, v26, v27
 v_mfma_f32_16x16x32_bf16 v[192:195], a[192:195], v[44:47], v[192:195]
 v_exp_f32 v28, v28
 v_mfma_f32_16x16x32_bf16 v[196:199], a[164:167], v[40:43], v[196:199]
 v_exp_f32 v29, v29
 v_mfma_f32_16x16x32_bf16 v[196:199], a[196:199], v[44:47], v[196:199]
 ds_read_b128 a[128:131], v7 offset:50688
 ds_read_b128 a[132:135], v7 offset:50752
 v_mfma_f32_16x16x32_bf16 v[200:203], a[168:171], v[40:43], v[200:203]
 s_add_u32 m0, s39, 16960
 v_mul_f32 v30, s32, v30
 v_mul_f32 v31, s32, v31
 v_mfma_f32_16x16x32_bf16 v[200:203], a[200:203], v[44:47], v[200:203]
 buffer_load_dwordx4 v1, s[20:23], s33 offen offset:2048 nt lds
 v_mfma_f32_16x16x32_bf16 v[204:207], a[172:175], v[40:43], v[204:207]
 v_exp_f32 v30, v30
 v_mfma_f32_16x16x32_bf16 v[204:207], a[204:207], v[44:47], v[204:207]
 s_waitcnt lgkmcnt(6)
 ds_read_b128 a[136:139], v7 offset:50816
 ds_read_b128 a[140:143], v7 offset:50880
 v_mfma_f32_16x16x32_bf16 v[24:27], a[96:99], a[0:3], 0
 v_exp_f32 v31, v31
 v_mfma_f32_16x16x32_bf16 v[24:27], a[100:103], a[4:7], v[24:27]
 v_cvt_pk_bf16_f32 v50, v28, v29
 v_cvt_pk_bf16_f32 v51, v30, v31
 v_mfma_f32_16x16x32_bf16 v[24:27], a[104:107], a[8:11], v[24:27]
 v_mul_f32 v32, s32, v32
 v_mul_f32 v33, s32, v33
 v_mfma_f32_16x16x32_bf16 v[24:27], a[108:111], a[12:15], v[24:27]
 s_waitcnt lgkmcnt(4)
 ds_read_b128 a[156:159], v7 offset:51392
 ds_read_b128 a[152:155], v7 offset:51328
 v_exp_f32 v32, v32
 v_smfmac_f32_16x16x64_bf16 a[232:235], a[236:239], v[40:47], v2
 v_exp_f32 v33, v33
 v_mfma_f32_16x16x32_bf16 v[28:31], a[124:127], a[12:15], 0
 v_mul_f32 v34, s32, v34
 v_mul_f32 v35, s32, v35
 v_mfma_f32_16x16x32_bf16 v[28:31], a[120:123], a[8:11], v[28:31]
 v_exp_f32 v34, v34
 v_mfma_f32_16x16x32_bf16 v[28:31], a[116:119], a[4:7], v[28:31]
 ds_read_b128 a[148:151], v7 offset:51264
 ds_read_b128 a[144:147], v7 offset:51200
 v_mfma_f32_16x16x32_bf16 v[28:31], a[112:115], a[0:3], v[28:31]
 v_exp_f32 v35, v35
 v_mul_f32 v36, s32, v36
 v_mfma_f32_16x16x32_bf16 v[208:211], a[176:179], v[40:43], v[208:211]
 v_mul_f32 v37, s32, v37
 v_cvt_pk_bf16_f32 v52, v32, v33
 v_mfma_f32_16x16x32_bf16 v[208:211], a[208:211], v[44:47], v[208:211]
 v_cvt_pk_bf16_f32 v53, v34, v35
 v_exp_f32 v36, v36
 v_mfma_f32_16x16x32_bf16 v[212:215], a[180:183], v[40:43], v[212:215]
 s_add_u32 m0, s39, 16992
 v_exp_f32 v37, v37
 v_mfma_f32_16x16x32_bf16 v[212:215], a[212:215], v[44:47], v[212:215]
 buffer_load_dwordx4 v1, s[20:23], s33 offen offset:3072 nt lds
 v_mfma_f32_16x16x32_bf16 v[216:219], a[184:187], v[40:43], v[216:219]
 s_add_u32 s33, s33, 8192
 v_mul_f32 v38, s32, v38
 v_mul_f32 v39, s32, v39
 v_mfma_f32_16x16x32_bf16 v[216:219], a[216:219], v[44:47], v[216:219]
 v_exp_f32 v38, v38
 v_mfma_f32_16x16x32_bf16 v[220:223], a[188:191], v[40:43], v[220:223]
 v_exp_f32 v39, v39
 v_mfma_f32_16x16x32_bf16 v[220:223], a[220:223], v[44:47], v[220:223]
 s_waitcnt lgkmcnt(4)
 ds_read_b128 v[56:59], v6 offset:6528
 v_cvt_pk_bf16_f32 v54, v36, v37
 v_cvt_pk_bf16_f32 v55, v38, v39
 v_mfma_f32_16x16x32_bf16 v[32:35], a[128:131], a[0:3], 0
 v_mul_f32 v24, s32, v24
 v_mul_f32 v25, s32, v25
 v_mfma_f32_16x16x32_bf16 v[32:35], a[132:135], a[4:7], v[32:35]
 v_exp_f32 v24, v24
 v_mfma_f32_16x16x32_bf16 v[32:35], a[136:139], a[8:11], v[32:35]
 v_exp_f32 v25, v25
 v_mfma_f32_16x16x32_bf16 v[32:35], a[140:143], a[12:15], v[32:35]
 s_waitcnt lgkmcnt(1)
 v_mul_f32 v26, s32, v26
 v_mul_f32 v27, s32, v27
 v_mfma_f32_16x16x32_bf16 v[36:39], a[156:159], a[12:15], 0
 v_exp_f32 v26, v26
 v_mfma_f32_16x16x32_bf16 v[36:39], a[152:155], a[8:11], v[36:39]
 v_exp_f32 v27, v27
 v_mfma_f32_16x16x32_bf16 v[36:39], a[148:151], a[4:7], v[36:39]
 v_mul_f32 v28, s32, v28
 v_mul_f32 v29, s32, v29
 v_mfma_f32_16x16x32_bf16 v[36:39], a[144:147], a[0:3], v[36:39]
 v_cvt_pk_bf16_f32 v40, v24, v25
 v_cvt_pk_bf16_f32 v41, v26, v27
 v_mfma_f32_16x16x32_bf16 v[224:227], a[160:163], v[48:51], v[224:227]
 s_mov_b32 s38, 6144
 v_exp_f32 v28, v28
 v_mfma_f32_16x16x32_bf16 v[224:227], a[192:195], v[52:55], v[224:227]
 s_waitcnt lgkmcnt(0)
 buffer_store_dwordx4 v[56:59], v1, s[24:27], s38 offen sc1 nt
 v_mfma_f32_16x16x32_bf16 v[228:231], a[164:167], v[48:51], v[228:231]
 ds_read_b64_tr_b16 a[160:161], v8 offset:33792
 ds_read_b64_tr_b16 a[162:163], v8 offset:34304
 v_mfma_f32_16x16x32_bf16 v[228:231], a[196:199], v[52:55], v[228:231]
 v_exp_f32 v29, v29
 v_mul_f32 v30, s32, v30
 v_mfma_f32_16x16x32_bf16 v[232:235], a[168:171], v[48:51], v[232:235]
 ds_read_b64_tr_b16 a[192:193], v8 offset:50688
 ds_read_b64_tr_b16 a[194:195], v8 offset:51200
 v_mfma_f32_16x16x32_bf16 v[232:235], a[200:203], v[52:55], v[232:235]
 v_mul_f32 v31, s32, v31
 v_exp_f32 v30, v30
 v_mfma_f32_16x16x32_bf16 v[236:239], a[172:175], v[48:51], v[236:239]
 v_exp_f32 v31, v31
 v_mfma_f32_16x16x32_bf16 v[236:239], a[204:207], v[52:55], v[236:239]
 ds_read_b64_tr_b16 a[164:165], v8 offset:33824
 ds_read_b64_tr_b16 a[166:167], v8 offset:34336
 v_cvt_pk_bf16_f32 v42, v28, v29
 v_cvt_pk_bf16_f32 v43, v30, v31
 v_mfma_f32_16x16x32_bf16 v[24:27], a[96:99], a[16:19], 0
 v_mul_f32 v32, s32, v32
 v_mul_f32 v33, s32, v33
 v_mfma_f32_16x16x32_bf16 v[24:27], a[100:103], a[20:23], v[24:27]
 ds_read_b64_tr_b16 a[196:197], v8 offset:50720
 ds_read_b64_tr_b16 a[198:199], v8 offset:51232
 v_mfma_f32_16x16x32_bf16 v[24:27], a[104:107], a[24:27], v[24:27]
 v_exp_f32 v32, v32
 v_mfma_f32_16x16x32_bf16 v[24:27], a[108:111], a[28:31], v[24:27]
 ds_read_b64_tr_b16 a[168:169], v8 offset:33856
 ds_read_b64_tr_b16 a[170:171], v8 offset:34368
 v_exp_f32 v33, v33
 v_smfmac_f32_16x16x64_bf16 a[232:235], a[240:243], v[48:55], v2
 v_mul_f32 v34, s32, v34
 v_mul_f32 v35, s32, v35
 v_mfma_f32_16x16x32_bf16 v[28:31], a[124:127], a[28:31], 0
 ds_read_b64_tr_b16 a[200:201], v8 offset:50752
 ds_read_b64_tr_b16 a[202:203], v8 offset:51264
 v_mfma_f32_16x16x32_bf16 v[28:31], a[120:123], a[24:27], v[28:31]
 v_exp_f32 v34, v34
 v_mfma_f32_16x16x32_bf16 v[28:31], a[116:119], a[20:23], v[28:31]
 v_exp_f32 v35, v35
 v_mfma_f32_16x16x32_bf16 v[28:31], a[112:115], a[16:19], v[28:31]
 ds_read_b64_tr_b16 a[172:173], v8 offset:33888
 ds_read_b64_tr_b16 a[174:175], v8 offset:34400
 v_mul_f32 v36, s32, v36
 v_mfma_f32_16x16x32_bf16 v[240:243], a[176:179], v[48:51], v[240:243]
 v_mul_f32 v37, s32, v37
 v_cvt_pk_bf16_f32 v44, v32, v33
 v_mfma_f32_16x16x32_bf16 v[240:243], a[208:211], v[52:55], v[240:243]
 ds_read_b64_tr_b16 a[204:205], v8 offset:50784
 ds_read_b64_tr_b16 a[206:207], v8 offset:51296
 v_cvt_pk_bf16_f32 v45, v34, v35
 v_mfma_f32_16x16x32_bf16 v[244:247], a[180:183], v[48:51], v[244:247]
 v_exp_f32 v36, v36
 v_mfma_f32_16x16x32_bf16 v[244:247], a[212:215], v[52:55], v[244:247]
 v_exp_f32 v37, v37
 v_mfma_f32_16x16x32_bf16 v[248:251], a[184:187], v[48:51], v[248:251]
 v_mul_f32 v38, s32, v38
 v_mul_f32 v39, s32, v39
 v_mfma_f32_16x16x32_bf16 v[248:251], a[216:219], v[52:55], v[248:251]
 ds_read_b64_tr_b16 a[176:177], v8 offset:33920
 ds_read_b64_tr_b16 a[178:179], v8 offset:34432
 v_mfma_f32_16x16x32_bf16 v[252:255], a[188:191], v[48:51], v[252:255]
 v_exp_f32 v38, v38
 v_mfma_f32_16x16x32_bf16 v[252:255], a[220:223], v[52:55], v[252:255]
L_pg1_9:
 s_cbranch_execz L_pg1_13
 v_exp_f32 v39, v39
 v_cvt_pk_bf16_f32 v46, v36, v37
 v_cvt_pk_bf16_f32 v47, v38, v39
 v_mfma_f32_16x16x32_bf16 v[32:35], a[128:131], a[16:19], 0
 ds_read_b64_tr_b16 a[208:209], v8 offset:50816
 ds_read_b64_tr_b16 a[210:211], v8 offset:51328
 v_mfma_f32_16x16x32_bf16 v[32:35], a[132:135], a[20:23], v[32:35]
 v_mul_f32 v24, s32, v24
 v_mul_f32 v25, s32, v25
 v_mfma_f32_16x16x32_bf16 v[32:35], a[136:139], a[24:27], v[32:35]
 v_exp_f32 v24, v24
 v_mfma_f32_16x16x32_bf16 v[32:35], a[140:143], a[28:31], v[32:35]
 ds_read_b64_tr_b16 a[180:181], v8 offset:33952
 ds_read_b64_tr_b16 a[182:183], v8 offset:34464
 v_exp_f32 v25, v25
 v_mfma_f32_16x16x32_bf16 v[36:39], a[156:159], a[28:31], 0
 v_mul_f32 v26, s32, v26
 v_mul_f32 v27, s32, v27
 v_mfma_f32_16x16x32_bf16 v[36:39], a[152:155], a[24:27], v[36:39]
 v_exp_f32 v26, v26
 v_mfma_f32_16x16x32_bf16 v[36:39], a[148:151], a[20:23], v[36:39]
 ds_read_b64_tr_b16 a[212:213], v8 offset:50848
 ds_read_b64_tr_b16 a[214:215], v8 offset:51360
 v_mfma_f32_16x16x32_bf16 v[36:39], a[144:147], a[16:19], v[36:39]
 s_waitcnt lgkmcnt(15)
 v_exp_f32 v27, v27
 v_mul_f32 v28, s32, v28
 v_mfma_f32_16x16x32_bf16 v[64:67], a[160:163], v[40:43], v[64:67]
 v_mul_f32 v29, s32, v29
 v_cvt_pk_bf16_f32 v48, v24, v25
 v_mfma_f32_16x16x32_bf16 v[64:67], a[192:195], v[44:47], v[64:67]
 ds_read_b64_tr_b16 a[184:185], v8 offset:33984
 ds_read_b64_tr_b16 a[186:187], v8 offset:34496
 v_cvt_pk_bf16_f32 v49, v26, v27
 v_mfma_f32_16x16x32_bf16 v[68:71], a[164:167], v[40:43], v[68:71]
 v_exp_f32 v28, v28
 v_mfma_f32_16x16x32_bf16 v[68:71], a[196:199], v[44:47], v[68:71]
 s_waitcnt lgkmcnt(10)
 v_exp_f32 v29, v29
 v_mfma_f32_16x16x32_bf16 v[72:75], a[168:171], v[40:43], v[72:75]
 ds_read_b64_tr_b16 a[216:217], v8 offset:50880
 ds_read_b64_tr_b16 a[218:219], v8 offset:51392
 v_mfma_f32_16x16x32_bf16 v[72:75], a[200:203], v[44:47], v[72:75]
 v_mul_f32 v30, s32, v30
 v_mul_f32 v31, s32, v31
 v_mfma_f32_16x16x32_bf16 v[76:79], a[172:175], v[40:43], v[76:79]
 v_exp_f32 v30, v30
 v_mfma_f32_16x16x32_bf16 v[76:79], a[204:207], v[44:47], v[76:79]
 ds_read_b64_tr_b16 a[188:189], v8 offset:34016
 ds_read_b64_tr_b16 a[190:191], v8 offset:34528
 v_mfma_f32_16x16x32_bf16 v[24:27], a[96:99], a[32:35], 0
 ds_read_b128 v[60:63], v6 offset:7616
 v_exp_f32 v31, v31
 v_mfma_f32_16x16x32_bf16 v[24:27], a[100:103], a[36:39], v[24:27]
 v_cvt_pk_bf16_f32 v50, v28, v29
 v_cvt_pk_bf16_f32 v51, v30, v31
 v_mfma_f32_16x16x32_bf16 v[24:27], a[104:107], a[40:43], v[24:27]
 ds_read_b64_tr_b16 a[220:221], v8 offset:50912
 ds_read_b64_tr_b16 a[222:223], v8 offset:51424
 v_mfma_f32_16x16x32_bf16 v[24:27], a[108:111], a[44:47], v[24:27]
 v_mul_f32 v32, s32, v32
 v_mul_f32 v33, s32, v33
 v_smfmac_f32_16x16x64_bf16 a[224:227], a[236:239], v[40:47], v2
 v_exp_f32 v32, v32
 v_mfma_f32_16x16x32_bf16 v[28:31], a[124:127], a[44:47], 0
 v_exp_f32 v33, v33
 v_mfma_f32_16x16x32_bf16 v[28:31], a[120:123], a[40:43], v[28:31]
 v_mul_f32 v34, s32, v34
 v_mul_f32 v35, s32, v35
 v_mfma_f32_16x16x32_bf16 v[28:31], a[116:119], a[36:39], v[28:31]
 v_exp_f32 v34, v34
 v_mfma_f32_16x16x32_bf16 v[28:31], a[112:115], a[32:35], v[28:31]
 s_waitcnt lgkmcnt(9)
 v_exp_f32 v35, v35
 v_mfma_f32_16x16x32_bf16 v[80:83], a[176:179], v[40:43], v[80:83]
 s_mov_b32 s38, 7168
 v_mul_f32 v36, s32, v36
 v_mul_f32 v37, s32, v37
 v_mfma_f32_16x16x32_bf16 v[80:83], a[208:211], v[44:47], v[80:83]
 s_waitcnt lgkmcnt(2)
 buffer_store_dwordx4 v[60:63], v1, s[24:27], s38 offen sc1 nt
 v_mfma_f32_16x16x32_bf16 v[84:87], a[180:183], v[40:43], v[84:87]
 v_cvt_pk_bf16_f32 v52, v32, v33
 v_cvt_pk_bf16_f32 v53, v34, v35
 v_mfma_f32_16x16x32_bf16 v[84:87], a[212:215], v[44:47], v[84:87]
 s_waitcnt lgkmcnt(0)
 s_barrier
 v_mfma_f32_16x16x32_bf16 v[88:91], a[184:187], v[40:43], v[88:91]
 v_exp_f32 v36, v36
 v_mfma_f32_16x16x32_bf16 v[88:91], a[216:219], v[44:47], v[88:91]
 v_exp_f32 v37, v37
 v_mfma_f32_16x16x32_bf16 v[92:95], a[188:191], v[40:43], v[92:95]
 v_mul_f32 v38, s32, v38
 v_mul_f32 v39, s32, v39
 v_mfma_f32_16x16x32_bf16 v[92:95], a[220:223], v[44:47], v[92:95]
 v_exp_f32 v38, v38
 v_mfma_f32_16x16x32_bf16 v[32:35], a[128:131], a[32:35], 0
 v_exp_f32 v39, v39
 v_mfma_f32_16x16x32_bf16 v[32:35], a[132:135], a[36:39], v[32:35]
 v_cvt_pk_bf16_f32 v54, v36, v37
 v_cvt_pk_bf16_f32 v55, v38, v39
 v_mfma_f32_16x16x32_bf16 v[32:35], a[136:139], a[40:43], v[32:35]
 v_mul_f32 v24, s32, v24
 v_mul_f32 v25, s32, v25
 v_mfma_f32_16x16x32_bf16 v[32:35], a[140:143], a[44:47], v[32:35]
 v_exp_f32 v24, v24
 v_mfma_f32_16x16x32_bf16 v[36:39], a[156:159], a[44:47], 0
 v_exp_f32 v25, v25
 v_mfma_f32_16x16x32_bf16 v[36:39], a[152:155], a[40:43], v[36:39]
 v_mul_f32 v26, s32, v26
 v_mul_f32 v27, s32, v27
 v_mfma_f32_16x16x32_bf16 v[36:39], a[148:151], a[36:39], v[36:39]
 s_add_u32 m0, s39, 33792
 v_exp_f32 v26, v26
 v_mfma_f32_16x16x32_bf16 v[36:39], a[144:147], a[32:35], v[36:39]
 buffer_load_dwordx4 v1, s[20:23], s33 offen nt lds
 v_mfma_f32_16x16x32_bf16 v[96:99], a[160:163], v[48:51], v[96:99]
 v_exp_f32 v27, v27
 v_mfma_f32_16x16x32_bf16 v[96:99], a[192:195], v[52:55], v[96:99]
 v_mul_f32 v28, s32, v28
 v_mul_f32 v29, s32, v29
 v_mfma_f32_16x16x32_bf16 v[100:103], a[164:167], v[48:51], v[100:103]
 v_cvt_pk_bf16_f32 v40, v24, v25
 v_cvt_pk_bf16_f32 v41, v26, v27
 v_mfma_f32_16x16x32_bf16 v[100:103], a[196:199], v[52:55], v[100:103]
 v_exp_f32 v28, v28
 v_mfma_f32_16x16x32_bf16 v[104:107], a[168:171], v[48:51], v[104:107]
 v_exp_f32 v29, v29
 v_mfma_f32_16x16x32_bf16 v[104:107], a[200:203], v[52:55], v[104:107]
 v_mul_f32 v30, s32, v30
 v_mul_f32 v31, s32, v31
 v_mfma_f32_16x16x32_bf16 v[108:111], a[172:175], v[48:51], v[108:111]
 v_exp_f32 v30, v30
 v_mfma_f32_16x16x32_bf16 v[108:111], a[204:207], v[52:55], v[108:111]
 v_exp_f32 v31, v31
 v_mfma_f32_16x16x32_bf16 v[24:27], a[96:99], a[48:51], 0
 v_cvt_pk_bf16_f32 v42, v28, v29
 v_cvt_pk_bf16_f32 v43, v30, v31
 v_mfma_f32_16x16x32_bf16 v[24:27], a[100:103], a[52:55], v[24:27]
 v_mul_f32 v32, s32, v32
 v_mul_f32 v33, s32, v33
 v_mfma_f32_16x16x32_bf16 v[24:27], a[104:107], a[56:59], v[24:27]
 v_exp_f32 v32, v32
 v_mfma_f32_16x16x32_bf16 v[24:27], a[108:111], a[60:63], v[24:27]
 v_exp_f32 v33, v33
 v_smfmac_f32_16x16x64_bf16 a[224:227], a[240:243], v[48:55], v2
 v_mfma_f32_16x16x32_bf16 v[28:31], a[124:127], a[60:63], 0
 v_mul_f32 v34, s32, v34
 v_mul_f32 v35, s32, v35
 v_mfma_f32_16x16x32_bf16 v[28:31], a[120:123], a[56:59], v[28:31]
 v_exp_f32 v34, v34
 v_mfma_f32_16x16x32_bf16 v[28:31], a[116:119], a[52:55], v[28:31]
 s_add_u32 m0, s39, 33824
 v_exp_f32 v35, v35
 v_mfma_f32_16x16x32_bf16 v[28:31], a[112:115], a[48:51], v[28:31]
 buffer_load_dwordx4 v1, s[20:23], s33 offen offset:1024 nt lds
 v_mfma_f32_16x16x32_bf16 v[112:115], a[176:179], v[48:51], v[112:115]
 v_mul_f32 v36, s32, v36
 v_mul_f32 v37, s32, v37
 v_mfma_f32_16x16x32_bf16 v[112:115], a[208:211], v[52:55], v[112:115]
 v_cvt_pk_bf16_f32 v44, v32, v33
 v_cvt_pk_bf16_f32 v45, v34, v35
 v_mfma_f32_16x16x32_bf16 v[116:119], a[180:183], v[48:51], v[116:119]
 v_exp_f32 v36, v36
 v_mfma_f32_16x16x32_bf16 v[116:119], a[212:215], v[52:55], v[116:119]
 v_exp_f32 v37, v37
 v_mfma_f32_16x16x32_bf16 v[120:123], a[184:187], v[48:51], v[120:123]
 v_mul_f32 v38, s32, v38
 v_mul_f32 v39, s32, v39
 v_mfma_f32_16x16x32_bf16 v[120:123], a[216:219], v[52:55], v[120:123]
 v_exp_f32 v38, v38
 v_mfma_f32_16x16x32_bf16 v[124:127], a[188:191], v[48:51], v[124:127]
 v_exp_f32 v39, v39
 v_mfma_f32_16x16x32_bf16 v[124:127], a[220:223], v[52:55], v[124:127]
 v_cvt_pk_bf16_f32 v46, v36, v37
 v_cvt_pk_bf16_f32 v47, v38, v39
 v_mfma_f32_16x16x32_bf16 v[32:35], a[128:131], a[48:51], 0
 v_mul_f32 v24, s32, v24
 v_mul_f32 v25, s32, v25
 v_mfma_f32_16x16x32_bf16 v[32:35], a[132:135], a[52:55], v[32:35]
 v_exp_f32 v24, v24
 v_mfma_f32_16x16x32_bf16 v[32:35], a[136:139], a[56:59], v[32:35]
 v_exp_f32 v25, v25
 v_mfma_f32_16x16x32_bf16 v[32:35], a[140:143], a[60:63], v[32:35]
 v_mul_f32 v26, s32, v26
 v_mul_f32 v27, s32, v27
 v_mfma_f32_16x16x32_bf16 v[36:39], a[156:159], a[60:63], 0
 v_exp_f32 v26, v26
 v_mfma_f32_16x16x32_bf16 v[36:39], a[152:155], a[56:59], v[36:39]
 v_exp_f32 v27, v27
 v_mfma_f32_16x16x32_bf16 v[36:39], a[148:151], a[52:55], v[36:39]
 v_mul_f32 v28, s32, v28
 v_mul_f32 v29, s32, v29
 v_mfma_f32_16x16x32_bf16 v[36:39], a[144:147], a[48:51], v[36:39]
 v_cvt_pk_bf16_f32 v48, v24, v25
 v_cvt_pk_bf16_f32 v49, v26, v27
 v_mfma_f32_16x16x32_bf16 v[128:131], a[160:163], v[40:43], v[128:131]
 s_add_u32 m0, s39, 33856
 v_exp_f32 v28, v28
 v_mfma_f32_16x16x32_bf16 v[128:131], a[192:195], v[44:47], v[128:131]
 buffer_load_dwordx4 v1, s[20:23], s33 offen offset:2048 nt lds
 v_mfma_f32_16x16x32_bf16 v[132:135], a[164:167], v[40:43], v[132:135]
 v_exp_f32 v29, v29
 v_mfma_f32_16x16x32_bf16 v[132:135], a[196:199], v[44:47], v[132:135]
 v_mul_f32 v30, s32, v30
 v_mul_f32 v31, s32, v31
 v_mfma_f32_16x16x32_bf16 v[136:139], a[168:171], v[40:43], v[136:139]
 v_exp_f32 v30, v30
 v_mfma_f32_16x16x32_bf16 v[136:139], a[200:203], v[44:47], v[136:139]
 v_exp_f32 v31, v31
 v_mfma_f32_16x16x32_bf16 v[140:143], a[172:175], v[40:43], v[140:143]
 v_cvt_pk_bf16_f32 v50, v28, v29
 v_cvt_pk_bf16_f32 v51, v30, v31
 v_mfma_f32_16x16x32_bf16 v[140:143], a[204:207], v[44:47], v[140:143]
 v_mul_f32 v32, s32, v32
 v_mul_f32 v33, s32, v33
 v_mfma_f32_16x16x32_bf16 v[24:27], a[96:99], a[64:67], 0
 v_exp_f32 v32, v32
 v_mfma_f32_16x16x32_bf16 v[24:27], a[100:103], a[68:71], v[24:27]
 v_exp_f32 v33, v33
 v_mfma_f32_16x16x32_bf16 v[24:27], a[104:107], a[72:75], v[24:27]
 v_mul_f32 v34, s32, v34
 v_mul_f32 v35, s32, v35
 v_mfma_f32_16x16x32_bf16 v[24:27], a[108:111], a[76:79], v[24:27]
 v_exp_f32 v34, v34
 v_smfmac_f32_16x16x64_bf16 a[228:231], a[236:239], v[40:47], v2
 v_mfma_f32_16x16x32_bf16 v[28:31], a[124:127], a[76:79], 0
 v_exp_f32 v35, v35
 v_mfma_f32_16x16x32_bf16 v[28:31], a[120:123], a[72:75], v[28:31]
 v_mul_f32 v36, s32, v36
 v_mul_f32 v37, s32, v37
 v_mfma_f32_16x16x32_bf16 v[28:31], a[116:119], a[68:71], v[28:31]
 v_cvt_pk_bf16_f32 v52, v32, v33
 v_cvt_pk_bf16_f32 v53, v34, v35
 v_mfma_f32_16x16x32_bf16 v[28:31], a[112:115], a[64:67], v[28:31]
 v_exp_f32 v36, v36
 v_mfma_f32_16x16x32_bf16 v[144:147], a[176:179], v[40:43], v[144:147]
 s_add_u32 m0, s39, 33888
 v_exp_f32 v37, v37
 v_mfma_f32_16x16x32_bf16 v[144:147], a[208:211], v[44:47], v[144:147]
 buffer_load_dwordx4 v1, s[20:23], s33 offen offset:3072 nt lds
 v_mfma_f32_16x16x32_bf16 v[148:151], a[180:183], v[40:43], v[148:151]
 s_add_u32 s33, s33, 8192
 v_mul_f32 v38, s32, v38
 v_mul_f32 v39, s32, v39
 v_mfma_f32_16x16x32_bf16 v[148:151], a[212:215], v[44:47], v[148:151]
 v_exp_f32 v38, v38
 v_mfma_f32_16x16x32_bf16 v[152:155], a[184:187], v[40:43], v[152:155]
 v_exp_f32 v39, v39
 v_mfma_f32_16x16x32_bf16 v[152:155], a[216:219], v[44:47], v[152:155]
 v_cvt_pk_bf16_f32 v54, v36, v37
 v_cvt_pk_bf16_f32 v55, v38, v39
 v_mfma_f32_16x16x32_bf16 v[156:159], a[188:191], v[40:43], v[156:159]
 v_mul_f32 v24, s32, v24
 v_mul_f32 v25, s32, v25
 v_mfma_f32_16x16x32_bf16 v[156:159], a[220:223], v[44:47], v[156:159]
 v_exp_f32 v24, v24
 v_mfma_f32_16x16x32_bf16 v[32:35], a[128:131], a[64:67], 0
 v_exp_f32 v25, v25
 v_mfma_f32_16x16x32_bf16 v[32:35], a[132:135], a[68:71], v[32:35]
 v_mul_f32 v26, s32, v26
 v_mul_f32 v27, s32, v27
 v_mfma_f32_16x16x32_bf16 v[32:35], a[136:139], a[72:75], v[32:35]
 v_exp_f32 v26, v26
 v_mfma_f32_16x16x32_bf16 v[32:35], a[140:143], a[76:79], v[32:35]
 v_exp_f32 v27, v27
 v_mfma_f32_16x16x32_bf16 v[36:39], a[156:159], a[76:79], 0
 v_mul_f32 v28, s32, v28
 v_mul_f32 v29, s32, v29
 v_mfma_f32_16x16x32_bf16 v[36:39], a[152:155], a[72:75], v[36:39]
 v_cvt_pk_bf16_f32 v40, v24, v25
 v_cvt_pk_bf16_f32 v41, v26, v27
 v_mfma_f32_16x16x32_bf16 v[36:39], a[148:151], a[68:71], v[36:39]
 v_exp_f32 v28, v28
 v_mfma_f32_16x16x32_bf16 v[36:39], a[144:147], a[64:67], v[36:39]
 v_exp_f32 v29, v29
 v_mfma_f32_16x16x32_bf16 v[160:163], a[160:163], v[48:51], v[160:163]
 v_mul_f32 v30, s32, v30
 v_mul_f32 v31, s32, v31
 v_mfma_f32_16x16x32_bf16 v[160:163], a[192:195], v[52:55], v[160:163]
 v_exp_f32 v30, v30
 v_mfma_f32_16x16x32_bf16 v[164:167], a[164:167], v[48:51], v[164:167]
 s_add_u32 m0, s39, 50688
 v_exp_f32 v31, v31
 v_mfma_f32_16x16x32_bf16 v[164:167], a[196:199], v[52:55], v[164:167]
 buffer_load_dwordx4 v1, s[20:23], s33 offen nt lds
 v_mfma_f32_16x16x32_bf16 v[168:171], a[168:171], v[48:51], v[168:171]
 v_cvt_pk_bf16_f32 v42, v28, v29
 v_cvt_pk_bf16_f32 v43, v30, v31
 v_mfma_f32_16x16x32_bf16 v[168:171], a[200:203], v[52:55], v[168:171]
 v_mul_f32 v32, s32, v32
 v_mul_f32 v33, s32, v33
 v_mfma_f32_16x16x32_bf16 v[172:175], a[172:175], v[48:51], v[172:175]
 v_exp_f32 v32, v32
 v_mfma_f32_16x16x32_bf16 v[172:175], a[204:207], v[52:55], v[172:175]
 v_exp_f32 v33, v33
 v_mfma_f32_16x16x32_bf16 v[24:27], a[96:99], a[80:83], 0
 v_mul_f32 v34, s32, v34
 v_mul_f32 v35, s32, v35
 v_mfma_f32_16x16x32_bf16 v[24:27], a[100:103], a[84:87], v[24:27]
 v_exp_f32 v34, v34
 v_mfma_f32_16x16x32_bf16 v[24:27], a[104:107], a[88:91], v[24:27]
 v_exp_f32 v35, v35
 v_mfma_f32_16x16x32_bf16 v[24:27], a[108:111], a[92:95], v[24:27]
 v_mul_f32 v36, s32, v36
 v_mul_f32 v37, s32, v37
 v_smfmac_f32_16x16x64_bf16 a[228:231], a[240:243], v[48:55], v2
 v_mfma_f32_16x16x32_bf16 v[28:31], a[124:127], a[92:95], 0
 v_cvt_pk_bf16_f32 v44, v32, v33
 v_cvt_pk_bf16_f32 v45, v34, v35
 v_mfma_f32_16x16x32_bf16 v[28:31], a[120:123], a[88:91], v[28:31]
 v_exp_f32 v36, v36
 v_mfma_f32_16x16x32_bf16 v[28:31], a[116:119], a[84:87], v[28:31]
 v_exp_f32 v37, v37
 v_mfma_f32_16x16x32_bf16 v[28:31], a[112:115], a[80:83], v[28:31]
 s_waitcnt vmcnt(7)
 s_barrier
 v_mfma_f32_16x16x32_bf16 v[176:179], a[176:179], v[48:51], v[176:179]
 v_mul_f32 v38, s32, v38
 v_mul_f32 v39, s32, v39
 v_mfma_f32_16x16x32_bf16 v[176:179], a[208:211], v[52:55], v[176:179]
 v_exp_f32 v38, v38
 v_mfma_f32_16x16x32_bf16 v[180:183], a[180:183], v[48:51], v[180:183]
 s_add_u32 m0, s39, 50720
 ds_read_b128 a[96:99], v7 offset:0
 ds_read_b128 a[100:103], v7 offset:64
 v_mfma_f32_16x16x32_bf16 v[180:183], a[212:215], v[52:55], v[180:183]
 buffer_load_dwordx4 v1, s[20:23], s33 offen offset:1024 nt lds
 v_mfma_f32_16x16x32_bf16 v[184:187], a[184:187], v[48:51], v[184:187]
 v_exp_f32 v39, v39
 v_mfma_f32_16x16x32_bf16 v[184:187], a[216:219], v[52:55], v[184:187]
 v_cvt_pk_bf16_f32 v46, v36, v37
 v_cvt_pk_bf16_f32 v47, v38, v39
 v_mfma_f32_16x16x32_bf16 v[188:191], a[188:191], v[48:51], v[188:191]
 ds_read_b128 a[104:107], v7 offset:128
 ds_read_b128 a[108:111], v7 offset:192
 v_mfma_f32_16x16x32_bf16 v[188:191], a[220:223], v[52:55], v[188:191]
 v_mul_f32 v24, s32, v24
 v_mul_f32 v25, s32, v25
 v_mfma_f32_16x16x32_bf16 v[32:35], a[128:131], a[80:83], 0
 v_exp_f32 v24, v24
 v_mfma_f32_16x16x32_bf16 v[32:35], a[132:135], a[84:87], v[32:35]
 v_exp_f32 v25, v25
 v_mfma_f32_16x16x32_bf16 v[32:35], a[136:139], a[88:91], v[32:35]
 ds_read_b128 a[124:127], v7 offset:704
 ds_read_b128 a[120:123], v7 offset:640
 v_mfma_f32_16x16x32_bf16 v[32:35], a[140:143], a[92:95], v[32:35]
 v_mul_f32 v26, s32, v26
 v_mul_f32 v27, s32, v27
 v_mfma_f32_16x16x32_bf16 v[36:39], a[156:159], a[92:95], 0
 v_exp_f32 v26, v26
 v_mfma_f32_16x16x32_bf16 v[36:39], a[152:155], a[88:91], v[36:39]
 v_exp_f32 v27, v27
 v_mfma_f32_16x16x32_bf16 v[36:39], a[148:151], a[84:87], v[36:39]
 ds_read_b128 a[116:119], v7 offset:576
 ds_read_b128 a[112:115], v7 offset:512
 v_mfma_f32_16x16x32_bf16 v[36:39], a[144:147], a[80:83], v[36:39]
 v_mul_f32 v28, s32, v28
 v_mul_f32 v29, s32, v29
 v_mfma_f32_16x16x32_bf16 v[192:195], a[160:163], v[40:43], v[192:195]
 v_cvt_pk_bf16_f32 v48, v24, v25
 v_cvt_pk_bf16_f32 v49, v26, v27
 v_mfma_f32_16x16x32_bf16 v[192:195], a[192:195], v[44:47], v[192:195]
 v_exp_f32 v28, v28
 v_mfma_f32_16x16x32_bf16 v[196:199], a[164:167], v[40:43], v[196:199]
 v_exp_f32 v29, v29
 v_mfma_f32_16x16x32_bf16 v[196:199], a[196:199], v[44:47], v[196:199]
 ds_read_b128 a[128:131], v7 offset:16896
 ds_read_b128 a[132:135], v7 offset:16960
 v_mfma_f32_16x16x32_bf16 v[200:203], a[168:171], v[40:43], v[200:203]
 s_add_u32 m0, s39, 50752
 v_mul_f32 v30, s32, v30
 v_mul_f32 v31, s32, v31
 v_mfma_f32_16x16x32_bf16 v[200:203], a[200:203], v[44:47], v[200:203]
 buffer_load_dwordx4 v1, s[20:23], s33 offen offset:2048 nt lds
 v_mfma_f32_16x16x32_bf16 v[204:207], a[172:175], v[40:43], v[204:207]
 v_exp_f32 v30, v30
 v_mfma_f32_16x16x32_bf16 v[204:207], a[204:207], v[44:47], v[204:207]
 s_waitcnt lgkmcnt(6)
 ds_read_b128 a[136:139], v7 offset:17024
 ds_read_b128 a[140:143], v7 offset:17088
 v_mfma_f32_16x16x32_bf16 v[24:27], a[96:99], a[0:3], 0
 v_exp_f32 v31, v31
 v_mfma_f32_16x16x32_bf16 v[24:27], a[100:103], a[4:7], v[24:27]
 v_cvt_pk_bf16_f32 v50, v28, v29
 v_cvt_pk_bf16_f32 v51, v30, v31
 v_mfma_f32_16x16x32_bf16 v[24:27], a[104:107], a[8:11], v[24:27]
 v_mul_f32 v32, s32, v32
 v_mul_f32 v33, s32, v33
 v_mfma_f32_16x16x32_bf16 v[24:27], a[108:111], a[12:15], v[24:27]
 s_waitcnt lgkmcnt(4)
 ds_read_b128 a[156:159], v7 offset:17600
 ds_read_b128 a[152:155], v7 offset:17536
 v_exp_f32 v32, v32
 v_smfmac_f32_16x16x64_bf16 a[232:235], a[236:239], v[40:47], v2
 v_exp_f32 v33, v33
 v_mfma_f32_16x16x32_bf16 v[28:31], a[124:127], a[12:15], 0
 v_mul_f32 v34, s32, v34
 v_mul_f32 v35, s32, v35
 v_mfma_f32_16x16x32_bf16 v[28:31], a[120:123], a[8:11], v[28:31]
 v_exp_f32 v34, v34
 v_mfma_f32_16x16x32_bf16 v[28:31], a[116:119], a[4:7], v[28:31]
 ds_read_b128 a[148:151], v7 offset:17472
 ds_read_b128 a[144:147], v7 offset:17408
 v_mfma_f32_16x16x32_bf16 v[28:31], a[112:115], a[0:3], v[28:31]
 v_exp_f32 v35, v35
 v_mul_f32 v36, s32, v36
 v_mfma_f32_16x16x32_bf16 v[208:211], a[176:179], v[40:43], v[208:211]
 v_mul_f32 v37, s32, v37
 v_cvt_pk_bf16_f32 v52, v32, v33
 v_mfma_f32_16x16x32_bf16 v[208:211], a[208:211], v[44:47], v[208:211]
 v_cvt_pk_bf16_f32 v53, v34, v35
 v_exp_f32 v36, v36
 v_mfma_f32_16x16x32_bf16 v[212:215], a[180:183], v[40:43], v[212:215]
 s_add_u32 m0, s39, 50784
 v_exp_f32 v37, v37
 v_mfma_f32_16x16x32_bf16 v[212:215], a[212:215], v[44:47], v[212:215]
 buffer_load_dwordx4 v1, s[20:23], s33 offen offset:3072 nt lds
 v_mfma_f32_16x16x32_bf16 v[216:219], a[184:187], v[40:43], v[216:219]
 s_add_u32 s33, s33, 8192
 v_mul_f32 v38, s32, v38
 v_mul_f32 v39, s32, v39
 v_mfma_f32_16x16x32_bf16 v[216:219], a[216:219], v[44:47], v[216:219]
 v_exp_f32 v38, v38
 v_mfma_f32_16x16x32_bf16 v[220:223], a[188:191], v[40:43], v[220:223]
 v_exp_f32 v39, v39
 v_mfma_f32_16x16x32_bf16 v[220:223], a[220:223], v[44:47], v[220:223]
 s_waitcnt lgkmcnt(4)
 ds_read_b128 v[56:59], v6 offset:8704
 v_cvt_pk_bf16_f32 v54, v36, v37
 v_cvt_pk_bf16_f32 v55, v38, v39
 v_mfma_f32_16x16x32_bf16 v[32:35], a[128:131], a[0:3], 0
 v_mul_f32 v24, s32, v24
 v_mul_f32 v25, s32, v25
 v_mfma_f32_16x16x32_bf16 v[32:35], a[132:135], a[4:7], v[32:35]
 v_exp_f32 v24, v24
 v_mfma_f32_16x16x32_bf16 v[32:35], a[136:139], a[8:11], v[32:35]
 v_exp_f32 v25, v25
 v_mfma_f32_16x16x32_bf16 v[32:35], a[140:143], a[12:15], v[32:35]
 s_waitcnt lgkmcnt(1)
 v_mul_f32 v26, s32, v26
 v_mul_f32 v27, s32, v27
 v_mfma_f32_16x16x32_bf16 v[36:39], a[156:159], a[12:15], 0
 v_exp_f32 v26, v26
 v_mfma_f32_16x16x32_bf16 v[36:39], a[152:155], a[8:11], v[36:39]
 v_exp_f32 v27, v27
 v_mfma_f32_16x16x32_bf16 v[36:39], a[148:151], a[4:7], v[36:39]
 v_mul_f32 v28, s32, v28
 v_mul_f32 v29, s32, v29
 v_mfma_f32_16x16x32_bf16 v[36:39], a[144:147], a[0:3], v[36:39]
 v_cvt_pk_bf16_f32 v40, v24, v25
 v_cvt_pk_bf16_f32 v41, v26, v27
 v_mfma_f32_16x16x32_bf16 v[224:227], a[160:163], v[48:51], v[224:227]
 s_mov_b32 s38, 8192
 v_exp_f32 v28, v28
 v_mfma_f32_16x16x32_bf16 v[224:227], a[192:195], v[52:55], v[224:227]
 s_waitcnt lgkmcnt(0)
 buffer_store_dwordx4 v[56:59], v1, s[24:27], s38 offen sc1 nt
 v_mfma_f32_16x16x32_bf16 v[228:231], a[164:167], v[48:51], v[228:231]
 ds_read_b64_tr_b16 a[160:161], v8 offset:0
 ds_read_b64_tr_b16 a[162:163], v8 offset:512
 v_mfma_f32_16x16x32_bf16 v[228:231], a[196:199], v[52:55], v[228:231]
 v_exp_f32 v29, v29
 v_mul_f32 v30, s32, v30
 v_mfma_f32_16x16x32_bf16 v[232:235], a[168:171], v[48:51], v[232:235]
 ds_read_b64_tr_b16 a[192:193], v8 offset:16896
 ds_read_b64_tr_b16 a[194:195], v8 offset:17408
 v_mfma_f32_16x16x32_bf16 v[232:235], a[200:203], v[52:55], v[232:235]
 v_mul_f32 v31, s32, v31
 v_exp_f32 v30, v30
 v_mfma_f32_16x16x32_bf16 v[236:239], a[172:175], v[48:51], v[236:239]
 v_exp_f32 v31, v31
 v_mfma_f32_16x16x32_bf16 v[236:239], a[204:207], v[52:55], v[236:239]
 ds_read_b64_tr_b16 a[164:165], v8 offset:32
 ds_read_b64_tr_b16 a[166:167], v8 offset:544
 v_cvt_pk_bf16_f32 v42, v28, v29
 v_cvt_pk_bf16_f32 v43, v30, v31
 v_mfma_f32_16x16x32_bf16 v[24:27], a[96:99], a[16:19], 0
 v_mul_f32 v32, s32, v32
 v_mul_f32 v33, s32, v33
 v_mfma_f32_16x16x32_bf16 v[24:27], a[100:103], a[20:23], v[24:27]
 ds_read_b64_tr_b16 a[196:197], v8 offset:16928
 ds_read_b64_tr_b16 a[198:199], v8 offset:17440
 v_mfma_f32_16x16x32_bf16 v[24:27], a[104:107], a[24:27], v[24:27]
 v_exp_f32 v32, v32
 v_mfma_f32_16x16x32_bf16 v[24:27], a[108:111], a[28:31], v[24:27]
 ds_read_b64_tr_b16 a[168:169], v8 offset:64
 ds_read_b64_tr_b16 a[170:171], v8 offset:576
 v_exp_f32 v33, v33
 v_smfmac_f32_16x16x64_bf16 a[232:235], a[240:243], v[48:55], v2
 v_mul_f32 v34, s32, v34
 v_mul_f32 v35, s32, v35
 v_mfma_f32_16x16x32_bf16 v[28:31], a[124:127], a[28:31], 0
 ds_read_b64_tr_b16 a[200:201], v8 offset:16960
 ds_read_b64_tr_b16 a[202:203], v8 offset:17472
 v_mfma_f32_16x16x32_bf16 v[28:31], a[120:123], a[24:27], v[28:31]
 v_exp_f32 v34, v34
 v_mfma_f32_16x16x32_bf16 v[28:31], a[116:119], a[20:23], v[28:31]
 v_exp_f32 v35, v35
 v_mfma_f32_16x16x32_bf16 v[28:31], a[112:115], a[16:19], v[28:31]
 ds_read_b64_tr_b16 a[172:173], v8 offset:96
 ds_read_b64_tr_b16 a[174:175], v8 offset:608
 v_mul_f32 v36, s32, v36
 v_mfma_f32_16x16x32_bf16 v[240:243], a[176:179], v[48:51], v[240:243]
 v_mul_f32 v37, s32, v37
 v_cvt_pk_bf16_f32 v44, v32, v33
 v_mfma_f32_16x16x32_bf16 v[240:243], a[208:211], v[52:55], v[240:243]
 ds_read_b64_tr_b16 a[204:205], v8 offset:16992
 ds_read_b64_tr_b16 a[206:207], v8 offset:17504
 v_cvt_pk_bf16_f32 v45, v34, v35
 v_mfma_f32_16x16x32_bf16 v[244:247], a[180:183], v[48:51], v[244:247]
 v_exp_f32 v36, v36
 v_mfma_f32_16x16x32_bf16 v[244:247], a[212:215], v[52:55], v[244:247]
 v_exp_f32 v37, v37
 v_mfma_f32_16x16x32_bf16 v[248:251], a[184:187], v[48:51], v[248:251]
 v_mul_f32 v38, s32, v38
 v_mul_f32 v39, s32, v39
 v_mfma_f32_16x16x32_bf16 v[248:251], a[216:219], v[52:55], v[248:251]
 ds_read_b64_tr_b16 a[176:177], v8 offset:128
 ds_read_b64_tr_b16 a[178:179], v8 offset:640
 v_mfma_f32_16x16x32_bf16 v[252:255], a[188:191], v[48:51], v[252:255]
 v_exp_f32 v38, v38
 v_mfma_f32_16x16x32_bf16 v[252:255], a[220:223], v[52:55], v[252:255]
 v_exp_f32 v39, v39
 v_cvt_pk_bf16_f32 v46, v36, v37
 v_cvt_pk_bf16_f32 v47, v38, v39
 v_mfma_f32_16x16x32_bf16 v[32:35], a[128:131], a[16:19], 0
 ds_read_b64_tr_b16 a[208:209], v8 offset:17024
 ds_read_b64_tr_b16 a[210:211], v8 offset:17536
 v_mfma_f32_16x16x32_bf16 v[32:35], a[132:135], a[20:23], v[32:35]
 v_mul_f32 v24, s32, v24
 v_mul_f32 v25, s32, v25
 v_mfma_f32_16x16x32_bf16 v[32:35], a[136:139], a[24:27], v[32:35]
 v_exp_f32 v24, v24
 v_mfma_f32_16x16x32_bf16 v[32:35], a[140:143], a[28:31], v[32:35]
 ds_read_b64_tr_b16 a[180:181], v8 offset:160
 ds_read_b64_tr_b16 a[182:183], v8 offset:672
 v_exp_f32 v25, v25
 v_mfma_f32_16x16x32_bf16 v[36:39], a[156:159], a[28:31], 0
 v_mul_f32 v26, s32, v26
 v_mul_f32 v27, s32, v27
 v_mfma_f32_16x16x32_bf16 v[36:39], a[152:155], a[24:27], v[36:39]
 v_exp_f32 v26, v26
 v_mfma_f32_16x16x32_bf16 v[36:39], a[148:151], a[20:23], v[36:39]
 ds_read_b64_tr_b16 a[212:213], v8 offset:17056
 ds_read_b64_tr_b16 a[214:215], v8 offset:17568
 v_mfma_f32_16x16x32_bf16 v[36:39], a[144:147], a[16:19], v[36:39]
 s_waitcnt lgkmcnt(15)
 v_exp_f32 v27, v27
 v_mul_f32 v28, s32, v28
 v_mfma_f32_16x16x32_bf16 v[64:67], a[160:163], v[40:43], v[64:67]
 v_mul_f32 v29, s32, v29
 v_cvt_pk_bf16_f32 v48, v24, v25
 v_mfma_f32_16x16x32_bf16 v[64:67], a[192:195], v[44:47], v[64:67]
 ds_read_b64_tr_b16 a[184:185], v8 offset:192
 ds_read_b64_tr_b16 a[186:187], v8 offset:704
 v_cvt_pk_bf16_f32 v49, v26, v27
 v_mfma_f32_16x16x32_bf16 v[68:71], a[164:167], v[40:43], v[68:71]
 v_exp_f32 v28, v28
 v_mfma_f32_16x16x32_bf16 v[68:71], a[196:199], v[44:47], v[68:71]
 s_waitcnt lgkmcnt(10)
 v_exp_f32 v29, v29
 v_mfma_f32_16x16x32_bf16 v[72:75], a[168:171], v[40:43], v[72:75]
 ds_read_b64_tr_b16 a[216:217], v8 offset:17088
 ds_read_b64_tr_b16 a[218:219], v8 offset:17600
 v_mfma_f32_16x16x32_bf16 v[72:75], a[200:203], v[44:47], v[72:75]
 v_mul_f32 v30, s32, v30
 v_mul_f32 v31, s32, v31
 v_mfma_f32_16x16x32_bf16 v[76:79], a[172:175], v[40:43], v[76:79]
 v_exp_f32 v30, v30
 v_mfma_f32_16x16x32_bf16 v[76:79], a[204:207], v[44:47], v[76:79]
 ds_read_b64_tr_b16 a[188:189], v8 offset:224
 ds_read_b64_tr_b16 a[190:191], v8 offset:736
 v_mfma_f32_16x16x32_bf16 v[24:27], a[96:99], a[32:35], 0
 ds_read_b128 v[60:63], v6 offset:9792
 v_exp_f32 v31, v31
 v_mfma_f32_16x16x32_bf16 v[24:27], a[100:103], a[36:39], v[24:27]
 v_cvt_pk_bf16_f32 v50, v28, v29
 v_cvt_pk_bf16_f32 v51, v30, v31
 v_mfma_f32_16x16x32_bf16 v[24:27], a[104:107], a[40:43], v[24:27]
 ds_read_b64_tr_b16 a[220:221], v8 offset:17120
 ds_read_b64_tr_b16 a[222:223], v8 offset:17632
 v_mfma_f32_16x16x32_bf16 v[24:27], a[108:111], a[44:47], v[24:27]
 v_mul_f32 v32, s32, v32
 v_mul_f32 v33, s32, v33
 v_smfmac_f32_16x16x64_bf16 a[224:227], a[236:239], v[40:47], v2
 v_exp_f32 v32, v32
 v_mfma_f32_16x16x32_bf16 v[28:31], a[124:127], a[44:47], 0
 v_exp_f32 v33, v33
 v_mfma_f32_16x16x32_bf16 v[28:31], a[120:123], a[40:43], v[28:31]
 v_mul_f32 v34, s32, v34
 v_mul_f32 v35, s32, v35
 v_mfma_f32_16x16x32_bf16 v[28:31], a[116:119], a[36:39], v[28:31]
 v_exp_f32 v34, v34
 v_mfma_f32_16x16x32_bf16 v[28:31], a[112:115], a[32:35], v[28:31]
 s_waitcnt lgkmcnt(9)
 v_exp_f32 v35, v35
 v_mfma_f32_16x16x32_bf16 v[80:83], a[176:179], v[40:43], v[80:83]
 s_mov_b32 s38, 9216
 v_mul_f32 v36, s32, v36
 v_mul_f32 v37, s32, v37
 v_mfma_f32_16x16x32_bf16 v[80:83], a[208:211], v[44:47], v[80:83]
 s_waitcnt lgkmcnt(2)
 buffer_store_dwordx4 v[60:63], v1, s[24:27], s38 offen sc1 nt
 v_mfma_f32_16x16x32_bf16 v[84:87], a[180:183], v[40:43], v[84:87]
 v_cvt_pk_bf16_f32 v52, v32, v33
 v_cvt_pk_bf16_f32 v53, v34, v35
 v_mfma_f32_16x16x32_bf16 v[84:87], a[212:215], v[44:47], v[84:87]
 s_waitcnt lgkmcnt(0)
 s_barrier
 v_mfma_f32_16x16x32_bf16 v[88:91], a[184:187], v[40:43], v[88:91]
 v_exp_f32 v36, v36
 v_mfma_f32_16x16x32_bf16 v[88:91], a[216:219], v[44:47], v[88:91]
 v_exp_f32 v37, v37
 v_mfma_f32_16x16x32_bf16 v[92:95], a[188:191], v[40:43], v[92:95]
 v_mul_f32 v38, s32, v38
 v_mul_f32 v39, s32, v39
 v_mfma_f32_16x16x32_bf16 v[92:95], a[220:223], v[44:47], v[92:95]
 v_exp_f32 v38, v38
 v_mfma_f32_16x16x32_bf16 v[32:35], a[128:131], a[32:35], 0
 v_exp_f32 v39, v39
 v_mfma_f32_16x16x32_bf16 v[32:35], a[132:135], a[36:39], v[32:35]
 v_cvt_pk_bf16_f32 v54, v36, v37
 v_cvt_pk_bf16_f32 v55, v38, v39
 v_mfma_f32_16x16x32_bf16 v[32:35], a[136:139], a[40:43], v[32:35]
 v_mul_f32 v24, s32, v24
 v_mul_f32 v25, s32, v25
 v_mfma_f32_16x16x32_bf16 v[32:35], a[140:143], a[44:47], v[32:35]
 v_exp_f32 v24, v24
 v_mfma_f32_16x16x32_bf16 v[36:39], a[156:159], a[44:47], 0
 v_exp_f32 v25, v25
 v_mfma_f32_16x16x32_bf16 v[36:39], a[152:155], a[40:43], v[36:39]
 v_mul_f32 v26, s32, v26
 v_mul_f32 v27, s32, v27
 v_mfma_f32_16x16x32_bf16 v[36:39], a[148:151], a[36:39], v[36:39]
 s_add_u32 m0, s39, 0
 v_exp_f32 v26, v26
 v_mfma_f32_16x16x32_bf16 v[36:39], a[144:147], a[32:35], v[36:39]
L_pg1_10:
 s_cbranch_execz L_main1
 buffer_load_dwordx4 v1, s[20:23], s33 offen nt lds
 v_mfma_f32_16x16x32_bf16 v[96:99], a[160:163], v[48:51], v[96:99]
 v_exp_f32 v27, v27
 v_mfma_f32_16x16x32_bf16 v[96:99], a[192:195], v[52:55], v[96:99]
 v_mul_f32 v28, s32, v28
 v_mul_f32 v29, s32, v29
 v_mfma_f32_16x16x32_bf16 v[100:103], a[164:167], v[48:51], v[100:103]
 v_cvt_pk_bf16_f32 v40, v24, v25
 v_cvt_pk_bf16_f32 v41, v26, v27
 v_mfma_f32_16x16x32_bf16 v[100:103], a[196:199], v[52:55], v[100:103]
 v_exp_f32 v28, v28
 v_mfma_f32_16x16x32_bf16 v[104:107], a[168:171], v[48:51], v[104:107]
 v_exp_f32 v29, v29
 v_mfma_f32_16x16x32_bf16 v[104:107], a[200:203], v[52:55], v[104:107]
 v_mul_f32 v30, s32, v30
 v_mul_f32 v31, s32, v31
 v_mfma_f32_16x16x32_bf16 v[108:111], a[172:175], v[48:51], v[108:111]
 v_exp_f32 v30, v30
 v_mfma_f32_16x16x32_bf16 v[108:111], a[204:207], v[52:55], v[108:111]
 v_exp_f32 v31, v31
 v_mfma_f32_16x16x32_bf16 v[24:27], a[96:99], a[48:51], 0
 v_cvt_pk_bf16_f32 v42, v28, v29
 v_cvt_pk_bf16_f32 v43, v30, v31
 v_mfma_f32_16x16x32_bf16 v[24:27], a[100:103], a[52:55], v[24:27]
 v_mul_f32 v32, s32, v32
 v_mul_f32 v33, s32, v33
 v_mfma_f32_16x16x32_bf16 v[24:27], a[104:107], a[56:59], v[24:27]
 v_exp_f32 v32, v32
 v_mfma_f32_16x16x32_bf16 v[24:27], a[108:111], a[60:63], v[24:27]
 v_exp_f32 v33, v33
 v_smfmac_f32_16x16x64_bf16 a[224:227], a[240:243], v[48:55], v2
 v_mfma_f32_16x16x32_bf16 v[28:31], a[124:127], a[60:63], 0
 v_mul_f32 v34, s32, v34
 v_mul_f32 v35, s32, v35
 v_mfma_f32_16x16x32_bf16 v[28:31], a[120:123], a[56:59], v[28:31]
 v_exp_f32 v34, v34
 v_mfma_f32_16x16x32_bf16 v[28:31], a[116:119], a[52:55], v[28:31]
 s_add_u32 m0, s39, 32
 v_exp_f32 v35, v35
 v_mfma_f32_16x16x32_bf16 v[28:31], a[112:115], a[48:51], v[28:31]
 buffer_load_dwordx4 v1, s[20:23], s33 offen offset:1024 nt lds
 v_mfma_f32_16x16x32_bf16 v[112:115], a[176:179], v[48:51], v[112:115]
 v_mul_f32 v36, s32, v36
 v_mul_f32 v37, s32, v37
 v_mfma_f32_16x16x32_bf16 v[112:115], a[208:211], v[52:55], v[112:115]
 v_cvt_pk_bf16_f32 v44, v32, v33
 v_cvt_pk_bf16_f32 v45, v34, v35
 v_mfma_f32_16x16x32_bf16 v[116:119], a[180:183], v[48:51], v[116:119]
 v_exp_f32 v36, v36
 v_mfma_f32_16x16x32_bf16 v[116:119], a[212:215], v[52:55], v[116:119]
 v_exp_f32 v37, v37
 v_mfma_f32_16x16x32_bf16 v[120:123], a[184:187], v[48:51], v[120:123]
 v_mul_f32 v38, s32, v38
 v_mul_f32 v39, s32, v39
 v_mfma_f32_16x16x32_bf16 v[120:123], a[216:219], v[52:55], v[120:123]
 v_exp_f32 v38, v38
 v_mfma_f32_16x16x32_bf16 v[124:127], a[188:191], v[48:51], v[124:127]
 v_exp_f32 v39, v39
 v_mfma_f32_16x16x32_bf16 v[124:127], a[220:223], v[52:55], v[124:127]
 v_cvt_pk_bf16_f32 v46, v36, v37
 v_cvt_pk_bf16_f32 v47, v38, v39
 v_mfma_f32_16x16x32_bf16 v[32:35], a[128:131], a[48:51], 0
 v_mul_f32 v24, s32, v24
 v_mul_f32 v25, s32, v25
 v_mfma_f32_16x16x32_bf16 v[32:35], a[132:135], a[52:55], v[32:35]
 v_exp_f32 v24, v24
 v_mfma_f32_16x16x32_bf16 v[32:35], a[136:139], a[56:59], v[32:35]
 v_exp_f32 v25, v25
 v_mfma_f32_16x16x32_bf16 v[32:35], a[140:143], a[60:63], v[32:35]
 v_mul_f32 v26, s32, v26
 v_mul_f32 v27, s32, v27
 v_mfma_f32_16x16x32_bf16 v[36:39], a[156:159], a[60:63], 0
 v_exp_f32 v26, v26
 v_mfma_f32_16x16x32_bf16 v[36:39], a[152:155], a[56:59], v[36:39]
 v_exp_f32 v27, v27
 v_mfma_f32_16x16x32_bf16 v[36:39], a[148:151], a[52:55], v[36:39]
 v_mul_f32 v28, s32, v28
 v_mul_f32 v29, s32, v29
 v_mfma_f32_16x16x32_bf16 v[36:39], a[144:147], a[48:51], v[36:39]
 v_cvt_pk_bf16_f32 v48, v24, v25
 v_cvt_pk_bf16_f32 v49, v26, v27
 v_mfma_f32_16x16x32_bf16 v[128:131], a[160:163], v[40:43], v[128:131]
 s_add_u32 m0, s39, 64
 v_exp_f32 v28, v28
 v_mfma_f32_16x16x32_bf16 v[128:131], a[192:195], v[44:47], v[128:131]
 buffer_load_dwordx4 v1, s[20:23], s33 offen offset:2048 nt lds
 v_mfma_f32_16x16x32_bf16 v[132:135], a[164:167], v[40:43], v[132:135]
 v_exp_f32 v29, v29
 v_mfma_f32_16x16x32_bf16 v[132:135], a[196:199], v[44:47], v[132:135]
 v_mul_f32 v30, s32, v30
 v_mul_f32 v31, s32, v31
 v_mfma_f32_16x16x32_bf16 v[136:139], a[168:171], v[40:43], v[136:139]
 v_exp_f32 v30, v30
 v_mfma_f32_16x16x32_bf16 v[136:139], a[200:203], v[44:47], v[136:139]
 v_exp_f32 v31, v31
 v_mfma_f32_16x16x32_bf16 v[140:143], a[172:175], v[40:43], v[140:143]
 v_cvt_pk_bf16_f32 v50, v28, v29
 v_cvt_pk_bf16_f32 v51, v30, v31
 v_mfma_f32_16x16x32_bf16 v[140:143], a[204:207], v[44:47], v[140:143]
 v_mul_f32 v32, s32, v32
 v_mul_f32 v33, s32, v33
 v_mfma_f32_16x16x32_bf16 v[24:27], a[96:99], a[64:67], 0
 v_exp_f32 v32, v32
 v_mfma_f32_16x16x32_bf16 v[24:27], a[100:103], a[68:71], v[24:27]
 v_exp_f32 v33, v33
 v_mfma_f32_16x16x32_bf16 v[24:27], a[104:107], a[72:75], v[24:27]
 v_mul_f32 v34, s32, v34
 v_mul_f32 v35, s32, v35
 v_mfma_f32_16x16x32_bf16 v[24:27], a[108:111], a[76:79], v[24:27]
 v_exp_f32 v34, v34
 v_smfmac_f32_16x16x64_bf16 a[228:231], a[236:239], v[40:47], v2
 v_mfma_f32_16x16x32_bf16 v[28:31], a[124:127], a[76:79], 0
 v_exp_f32 v35, v35
 v_mfma_f32_16x16x32_bf16 v[28:31], a[120:123], a[72:75], v[28:31]
 v_mul_f32 v36, s32, v36
 v_mul_f32 v37, s32, v37
 v_mfma_f32_16x16x32_bf16 v[28:31], a[116:119], a[68:71], v[28:31]
 v_cvt_pk_bf16_f32 v52, v32, v33
 v_cvt_pk_bf16_f32 v53, v34, v35
 v_mfma_f32_16x16x32_bf16 v[28:31], a[112:115], a[64:67], v[28:31]
 v_exp_f32 v36, v36
 v_mfma_f32_16x16x32_bf16 v[144:147], a[176:179], v[40:43], v[144:147]
 s_add_u32 m0, s39, 96
 v_exp_f32 v37, v37
 v_mfma_f32_16x16x32_bf16 v[144:147], a[208:211], v[44:47], v[144:147]
 buffer_load_dwordx4 v1, s[20:23], s33 offen offset:3072 nt lds
 v_mfma_f32_16x16x32_bf16 v[148:151], a[180:183], v[40:43], v[148:151]
 s_add_u32 s33, s33, 8192
 v_mul_f32 v38, s32, v38
 v_mul_f32 v39, s32, v39
 v_mfma_f32_16x16x32_bf16 v[148:151], a[212:215], v[44:47], v[148:151]
 v_exp_f32 v38, v38
 v_mfma_f32_16x16x32_bf16 v[152:155], a[184:187], v[40:43], v[152:155]
 v_exp_f32 v39, v39
 v_mfma_f32_16x16x32_bf16 v[152:155], a[216:219], v[44:47], v[152:155]
 v_cvt_pk_bf16_f32 v54, v36, v37
 v_cvt_pk_bf16_f32 v55, v38, v39
 v_mfma_f32_16x16x32_bf16 v[156:159], a[188:191], v[40:43], v[156:159]
 v_mul_f32 v24, s32, v24
 v_mul_f32 v25, s32, v25
 v_mfma_f32_16x16x32_bf16 v[156:159], a[220:223], v[44:47], v[156:159]
 v_exp_f32 v24, v24
 v_mfma_f32_16x16x32_bf16 v[32:35], a[128:131], a[64:67], 0
 v_exp_f32 v25, v25
 v_mfma_f32_16x16x32_bf16 v[32:35], a[132:135], a[68:71], v[32:35]
 v_mul_f32 v26, s32, v26
 v_mul_f32 v27, s32, v27
 v_mfma_f32_16x16x32_bf16 v[32:35], a[136:139], a[72:75], v[32:35]
 v_exp_f32 v26, v26
 v_mfma_f32_16x16x32_bf16 v[32:35], a[140:143], a[76:79], v[32:35]
 v_exp_f32 v27, v27
 v_mfma_f32_16x16x32_bf16 v[36:39], a[156:159], a[76:79], 0
 v_mul_f32 v28, s32, v28
 v_mul_f32 v29, s32, v29
 v_mfma_f32_16x16x32_bf16 v[36:39], a[152:155], a[72:75], v[36:39]
 v_cvt_pk_bf16_f32 v40, v24, v25
 v_cvt_pk_bf16_f32 v41, v26, v27
 v_mfma_f32_16x16x32_bf16 v[36:39], a[148:151], a[68:71], v[36:39]
 v_exp_f32 v28, v28
 v_mfma_f32_16x16x32_bf16 v[36:39], a[144:147], a[64:67], v[36:39]
 v_exp_f32 v29, v29
 v_mfma_f32_16x16x32_bf16 v[160:163], a[160:163], v[48:51], v[160:163]
 v_mul_f32 v30, s32, v30
 v_mul_f32 v31, s32, v31
 v_mfma_f32_16x16x32_bf16 v[160:163], a[192:195], v[52:55], v[160:163]
 v_exp_f32 v30, v30
 v_mfma_f32_16x16x32_bf16 v[164:167], a[164:167], v[48:51], v[164:167]
 s_add_u32 m0, s39, 16896
 v_exp_f32 v31, v31
 v_mfma_f32_16x16x32_bf16 v[164:167], a[196:199], v[52:55], v[164:167]
 buffer_load_dwordx4 v1, s[20:23], s33 offen nt lds
 v_mfma_f32_16x16x32_bf16 v[168:171], a[168:171], v[48:51], v[168:171]
 v_cvt_pk_bf16_f32 v42, v28, v29
 v_cvt_pk_bf16_f32 v43, v30, v31
 v_mfma_f32_16x16x32_bf16 v[168:171], a[200:203], v[52:55], v[168:171]
 v_mul_f32 v32, s32, v32
 v_mul_f32 v33, s32, v33
 v_mfma_f32_16x16x32_bf16 v[172:175], a[172:175], v[48:51], v[172:175]
 v_exp_f32 v32, v32
 v_mfma_f32_16x16x32_bf16 v[172:175], a[204:207], v[52:55], v[172:175]
 v_exp_f32 v33, v33
 v_mfma_f32_16x16x32_bf16 v[24:27], a[96:99], a[80:83], 0
 v_mul_f32 v34, s32, v34
 v_mul_f32 v35, s32, v35
 v_mfma_f32_16x16x32_bf16 v[24:27], a[100:103], a[84:87], v[24:27]
 v_exp_f32 v34, v34
 v_mfma_f32_16x16x32_bf16 v[24:27], a[104:107], a[88:91], v[24:27]
 v_exp_f32 v35, v35
 v_mfma_f32_16x16x32_bf16 v[24:27], a[108:111], a[92:95], v[24:27]
 v_mul_f32 v36, s32, v36
 v_mul_f32 v37, s32, v37
 v_smfmac_f32_16x16x64_bf16 a[228:231], a[240:243], v[48:55], v2
 v_mfma_f32_16x16x32_bf16 v[28:31], a[124:127], a[92:95], 0
 v_cvt_pk_bf16_f32 v44, v32, v33
 v_cvt_pk_bf16_f32 v45, v34, v35
 v_mfma_f32_16x16x32_bf16 v[28:31], a[120:123], a[88:91], v[28:31]
 v_exp_f32 v36, v36
 v_mfma_f32_16x16x32_bf16 v[28:31], a[116:119], a[84:87], v[28:31]
 v_exp_f32 v37, v37
 v_mfma_f32_16x16x32_bf16 v[28:31], a[112:115], a[80:83], v[28:31]
 s_waitcnt vmcnt(7)
 s_barrier
 v_mfma_f32_16x16x32_bf16 v[176:179], a[176:179], v[48:51], v[176:179]
 v_mul_f32 v38, s32, v38
 v_mul_f32 v39, s32, v39
 v_mfma_f32_16x16x32_bf16 v[176:179], a[208:211], v[52:55], v[176:179]
 v_exp_f32 v38, v38
 v_mfma_f32_16x16x32_bf16 v[180:183], a[180:183], v[48:51], v[180:183]
 s_add_u32 m0, s39, 16928
 ds_read_b128 a[96:99], v7 offset:33792
 ds_read_b128 a[100:103], v7 offset:33856
 v_mfma_f32_16x16x32_bf16 v[180:183], a[212:215], v[52:55], v[180:183]
 buffer_load_dwordx4 v1, s[20:23], s33 offen offset:1024 nt lds
 v_mfma_f32_16x16x32_bf16 v[184:187], a[184:187], v[48:51], v[184:187]
 v_exp_f32 v39, v39
 v_mfma_f32_16x16x32_bf16 v[184:187], a[216:219], v[52:55], v[184:187]
 v_cvt_pk_bf16_f32 v46, v36, v37
 v_cvt_pk_bf16_f32 v47, v38, v39
 v_mfma_f32_16x16x32_bf16 v[188:191], a[188:191], v[48:51], v[188:191]
 ds_read_b128 a[104:107], v7 offset:33920
 ds_read_b128 a[108:111], v7 offset:33984
 v_mfma_f32_16x16x32_bf16 v[188:191], a[220:223], v[52:55], v[188:191]
 v_mul_f32 v24, s32, v24
 v_mul_f32 v25, s32, v25
 v_mfma_f32_16x16x32_bf16 v[32:35], a[128:131], a[80:83], 0
 v_exp_f32 v24, v24
 v_mfma_f32_16x16x32_bf16 v[32:35], a[132:135], a[84:87], v[32:35]
 v_exp_f32 v25, v25
 v_mfma_f32_16x16x32_bf16 v[32:35], a[136:139], a[88:91], v[32:35]
 ds_read_b128 a[124:127], v7 offset:34496
 ds_read_b128 a[120:123], v7 offset:34432
 v_mfma_f32_16x16x32_bf16 v[32:35], a[140:143], a[92:95], v[32:35]
 v_mul_f32 v26, s32, v26
 v_mul_f32 v27, s32, v27
 v_mfma_f32_16x16x32_bf16 v[36:39], a[156:159], a[92:95], 0
 v_exp_f32 v26, v26
 v_mfma_f32_16x16x32_bf16 v[36:39], a[152:155], a[88:91], v[36:39]
 v_exp_f32 v27, v27
 v_mfma_f32_16x16x32_bf16 v[36:39], a[148:151], a[84:87], v[36:39]
 ds_read_b128 a[116:119], v7 offset:34368
 ds_read_b128 a[112:115], v7 offset:34304
 v_mfma_f32_16x16x32_bf16 v[36:39], a[144:147], a[80:83], v[36:39]
 v_mul_f32 v28, s32, v28
 v_mul_f32 v29, s32, v29
 v_mfma_f32_16x16x32_bf16 v[192:195], a[160:163], v[40:43], v[192:195]
 v_cvt_pk_bf16_f32 v48, v24, v25
 v_cvt_pk_bf16_f32 v49, v26, v27
 v_mfma_f32_16x16x32_bf16 v[192:195], a[192:195], v[44:47], v[192:195]
 v_exp_f32 v28, v28
 v_mfma_f32_16x16x32_bf16 v[196:199], a[164:167], v[40:43], v[196:199]
 v_exp_f32 v29, v29
 v_mfma_f32_16x16x32_bf16 v[196:199], a[196:199], v[44:47], v[196:199]
 ds_read_b128 a[128:131], v7 offset:50688
 ds_read_b128 a[132:135], v7 offset:50752
 v_mfma_f32_16x16x32_bf16 v[200:203], a[168:171], v[40:43], v[200:203]
 s_add_u32 m0, s39, 16960
 v_mul_f32 v30, s32, v30
 v_mul_f32 v31, s32, v31
 v_mfma_f32_16x16x32_bf16 v[200:203], a[200:203], v[44:47], v[200:203]
 buffer_load_dwordx4 v1, s[20:23], s33 offen offset:2048 nt lds
 v_mfma_f32_16x16x32_bf16 v[204:207], a[172:175], v[40:43], v[204:207]
 v_exp_f32 v30, v30
 v_mfma_f32_16x16x32_bf16 v[204:207], a[204:207], v[44:47], v[204:207]
 s_waitcnt lgkmcnt(6)
 ds_read_b128 a[136:139], v7 offset:50816
 ds_read_b128 a[140:143], v7 offset:50880
 v_mfma_f32_16x16x32_bf16 v[24:27], a[96:99], a[0:3], 0
 v_exp_f32 v31, v31
 v_mfma_f32_16x16x32_bf16 v[24:27], a[100:103], a[4:7], v[24:27]
 v_cvt_pk_bf16_f32 v50, v28, v29
 v_cvt_pk_bf16_f32 v51, v30, v31
 v_mfma_f32_16x16x32_bf16 v[24:27], a[104:107], a[8:11], v[24:27]
 v_mul_f32 v32, s32, v32
 v_mul_f32 v33, s32, v33
 v_mfma_f32_16x16x32_bf16 v[24:27], a[108:111], a[12:15], v[24:27]
 s_waitcnt lgkmcnt(4)
 ds_read_b128 a[156:159], v7 offset:51392
 ds_read_b128 a[152:155], v7 offset:51328
 v_exp_f32 v32, v32
 v_smfmac_f32_16x16x64_bf16 a[232:235], a[236:239], v[40:47], v2
 v_exp_f32 v33, v33
 v_mfma_f32_16x16x32_bf16 v[28:31], a[124:127], a[12:15], 0
 v_mul_f32 v34, s32, v34
 v_mul_f32 v35, s32, v35
 v_mfma_f32_16x16x32_bf16 v[28:31], a[120:123], a[8:11], v[28:31]
 v_exp_f32 v34, v34
 v_mfma_f32_16x16x32_bf16 v[28:31], a[116:119], a[4:7], v[28:31]
 ds_read_b128 a[148:151], v7 offset:51264
 ds_read_b128 a[144:147], v7 offset:51200
 v_mfma_f32_16x16x32_bf16 v[28:31], a[112:115], a[0:3], v[28:31]
 v_exp_f32 v35, v35
 v_mul_f32 v36, s32, v36
 v_mfma_f32_16x16x32_bf16 v[208:211], a[176:179], v[40:43], v[208:211]
 v_mul_f32 v37, s32, v37
 v_cvt_pk_bf16_f32 v52, v32, v33
 v_mfma_f32_16x16x32_bf16 v[208:211], a[208:211], v[44:47], v[208:211]
 v_cvt_pk_bf16_f32 v53, v34, v35
 v_exp_f32 v36, v36
 v_mfma_f32_16x16x32_bf16 v[212:215], a[180:183], v[40:43], v[212:215]
 s_add_u32 m0, s39, 16992
 v_exp_f32 v37, v37
 v_mfma_f32_16x16x32_bf16 v[212:215], a[212:215], v[44:47], v[212:215]
 buffer_load_dwordx4 v1, s[20:23], s33 offen offset:3072 nt lds
 v_mfma_f32_16x16x32_bf16 v[216:219], a[184:187], v[40:43], v[216:219]
 s_add_u32 s33, s33, 8192
 v_mul_f32 v38, s32, v38
 v_mul_f32 v39, s32, v39
 v_mfma_f32_16x16x32_bf16 v[216:219], a[216:219], v[44:47], v[216:219]
 v_exp_f32 v38, v38
 v_mfma_f32_16x16x32_bf16 v[220:223], a[188:191], v[40:43], v[220:223]
 v_exp_f32 v39, v39
 v_mfma_f32_16x16x32_bf16 v[220:223], a[220:223], v[44:47], v[220:223]
 s_waitcnt lgkmcnt(4)
 ds_read_b128 v[56:59], v6 offset:10880
 v_cvt_pk_bf16_f32 v54, v36, v37
 v_cvt_pk_bf16_f32 v55, v38, v39
 v_mfma_f32_16x16x32_bf16 v[32:35], a[128:131], a[0:3], 0
 v_mul_f32 v24, s32, v24
 v_mul_f32 v25, s32, v25
 v_mfma_f32_16x16x32_bf16 v[32:35], a[132:135], a[4:7], v[32:35]
 v_exp_f32 v24, v24
 v_mfma_f32_16x16x32_bf16 v[32:35], a[136:139], a[8:11], v[32:35]
 v_exp_f32 v25, v25
 v_mfma_f32_16x16x32_bf16 v[32:35], a[140:143], a[12:15], v[32:35]
 s_waitcnt lgkmcnt(1)
 v_mul_f32 v26, s32, v26
 v_mul_f32 v27, s32, v27
 v_mfma_f32_16x16x32_bf16 v[36:39], a[156:159], a[12:15], 0
 v_exp_f32 v26, v26
 v_mfma_f32_16x16x32_bf16 v[36:39], a[152:155], a[8:11], v[36:39]
 v_exp_f32 v27, v27
 v_mfma_f32_16x16x32_bf16 v[36:39], a[148:151], a[4:7], v[36:39]
 v_mul_f32 v28, s32, v28
 v_mul_f32 v29, s32, v29
 v_mfma_f32_16x16x32_bf16 v[36:39], a[144:147], a[0:3], v[36:39]
 v_cvt_pk_bf16_f32 v40, v24, v25
 v_cvt_pk_bf16_f32 v41, v26, v27
 v_mfma_f32_16x16x32_bf16 v[224:227], a[160:163], v[48:51], v[224:227]
 s_mov_b32 s38, 10240
 v_exp_f32 v28, v28
 v_mfma_f32_16x16x32_bf16 v[224:227], a[192:195], v[52:55], v[224:227]
 s_waitcnt lgkmcnt(0)
 buffer_store_dwordx4 v[56:59], v1, s[24:27], s38 offen sc1 nt
 v_mfma_f32_16x16x32_bf16 v[228:231], a[164:167], v[48:51], v[228:231]
 ds_read_b64_tr_b16 a[160:161], v8 offset:33792
 ds_read_b64_tr_b16 a[162:163], v8 offset:34304
 v_mfma_f32_16x16x32_bf16 v[228:231], a[196:199], v[52:55], v[228:231]
 v_exp_f32 v29, v29
 v_mul_f32 v30, s32, v30
 v_mfma_f32_16x16x32_bf16 v[232:235], a[168:171], v[48:51], v[232:235]
 ds_read_b64_tr_b16 a[192:193], v8 offset:50688
 ds_read_b64_tr_b16 a[194:195], v8 offset:51200
 v_mfma_f32_16x16x32_bf16 v[232:235], a[200:203], v[52:55], v[232:235]
 v_mul_f32 v31, s32, v31
 v_exp_f32 v30, v30
 v_mfma_f32_16x16x32_bf16 v[236:239], a[172:175], v[48:51], v[236:239]
 v_exp_f32 v31, v31
 v_mfma_f32_16x16x32_bf16 v[236:239], a[204:207], v[52:55], v[236:239]
 ds_read_b64_tr_b16 a[164:165], v8 offset:33824
 ds_read_b64_tr_b16 a[166:167], v8 offset:34336
 v_cvt_pk_bf16_f32 v42, v28, v29
 v_cvt_pk_bf16_f32 v43, v30, v31
 v_mfma_f32_16x16x32_bf16 v[24:27], a[96:99], a[16:19], 0
 v_mul_f32 v32, s32, v32
 v_mul_f32 v33, s32, v33
 v_mfma_f32_16x16x32_bf16 v[24:27], a[100:103], a[20:23], v[24:27]
 ds_read_b64_tr_b16 a[196:197], v8 offset:50720
 ds_read_b64_tr_b16 a[198:199], v8 offset:51232
 v_mfma_f32_16x16x32_bf16 v[24:27], a[104:107], a[24:27], v[24:27]
 v_exp_f32 v32, v32
 v_mfma_f32_16x16x32_bf16 v[24:27], a[108:111], a[28:31], v[24:27]
 ds_read_b64_tr_b16 a[168:169], v8 offset:33856
 ds_read_b64_tr_b16 a[170:171], v8 offset:34368
 v_exp_f32 v33, v33
 v_smfmac_f32_16x16x64_bf16 a[232:235], a[240:243], v[48:55], v2
 v_mul_f32 v34, s32, v34
 v_mul_f32 v35, s32, v35
 v_mfma_f32_16x16x32_bf16 v[28:31], a[124:127], a[28:31], 0
 ds_read_b64_tr_b16 a[200:201], v8 offset:50752
 ds_read_b64_tr_b16 a[202:203], v8 offset:51264
 v_mfma_f32_16x16x32_bf16 v[28:31], a[120:123], a[24:27], v[28:31]
 v_exp_f32 v34, v34
 v_mfma_f32_16x16x32_bf16 v[28:31], a[116:119], a[20:23], v[28:31]
 v_exp_f32 v35, v35
 v_mfma_f32_16x16x32_bf16 v[28:31], a[112:115], a[16:19], v[28:31]
 ds_read_b64_tr_b16 a[172:173], v8 offset:33888
 ds_read_b64_tr_b16 a[174:175], v8 offset:34400
 v_mul_f32 v36, s32, v36
 v_mfma_f32_16x16x32_bf16 v[240:243], a[176:179], v[48:51], v[240:243]
 v_mul_f32 v37, s32, v37
 v_cvt_pk_bf16_f32 v44, v32, v33
 v_mfma_f32_16x16x32_bf16 v[240:243], a[208:211], v[52:55], v[240:243]
 ds_read_b64_tr_b16 a[204:205], v8 offset:50784
 ds_read_b64_tr_b16 a[206:207], v8 offset:51296
 v_cvt_pk_bf16_f32 v45, v34, v35
 v_mfma_f32_16x16x32_bf16 v[244:247], a[180:183], v[48:51], v[244:247]
 v_exp_f32 v36, v36
 v_mfma_f32_16x16x32_bf16 v[244:247], a[212:215], v[52:55], v[244:247]
 v_exp_f32 v37, v37
 v_mfma_f32_16x16x32_bf16 v[248:251], a[184:187], v[48:51], v[248:251]
 v_mul_f32 v38, s32, v38
 v_mul_f32 v39, s32, v39
 v_mfma_f32_16x16x32_bf16 v[248:251], a[216:219], v[52:55], v[248:251]
 ds_read_b64_tr_b16 a[176:177], v8 offset:33920
 ds_read_b64_tr_b16 a[178:179], v8 offset:34432
 v_mfma_f32_16x16x32_bf16 v[252:255], a[188:191], v[48:51], v[252:255]
 v_exp_f32 v38, v38
 v_mfma_f32_16x16x32_bf16 v[252:255], a[220:223], v[52:55], v[252:255]
 v_exp_f32 v39, v39
 v_cvt_pk_bf16_f32 v46, v36, v37
 v_cvt_pk_bf16_f32 v47, v38, v39
 v_mfma_f32_16x16x32_bf16 v[32:35], a[128:131], a[16:19], 0
 ds_read_b64_tr_b16 a[208:209], v8 offset:50816
 ds_read_b64_tr_b16 a[210:211], v8 offset:51328
 v_mfma_f32_16x16x32_bf16 v[32:35], a[132:135], a[20:23], v[32:35]
 v_mul_f32 v24, s32, v24
 v_mul_f32 v25, s32, v25
 v_mfma_f32_16x16x32_bf16 v[32:35], a[136:139], a[24:27], v[32:35]
 v_exp_f32 v24, v24
 v_mfma_f32_16x16x32_bf16 v[32:35], a[140:143], a[28:31], v[32:35]
 ds_read_b64_tr_b16 a[180:181], v8 offset:33952
 ds_read_b64_tr_b16 a[182:183], v8 offset:34464
 v_exp_f32 v25, v25
 v_mfma_f32_16x16x32_bf16 v[36:39], a[156:159], a[28:31], 0
 v_mul_f32 v26, s32, v26
 v_mul_f32 v27, s32, v27
 v_mfma_f32_16x16x32_bf16 v[36:39], a[152:155], a[24:27], v[36:39]
 v_exp_f32 v26, v26
 v_mfma_f32_16x16x32_bf16 v[36:39], a[148:151], a[20:23], v[36:39]
 ds_read_b64_tr_b16 a[212:213], v8 offset:50848
 ds_read_b64_tr_b16 a[214:215], v8 offset:51360
 v_mfma_f32_16x16x32_bf16 v[36:39], a[144:147], a[16:19], v[36:39]
 s_waitcnt lgkmcnt(15)
 v_exp_f32 v27, v27
 v_mul_f32 v28, s32, v28
 v_mfma_f32_16x16x32_bf16 v[64:67], a[160:163], v[40:43], v[64:67]
 v_mul_f32 v29, s32, v29
 v_cvt_pk_bf16_f32 v48, v24, v25
 v_mfma_f32_16x16x32_bf16 v[64:67], a[192:195], v[44:47], v[64:67]
 ds_read_b64_tr_b16 a[184:185], v8 offset:33984
 ds_read_b64_tr_b16 a[186:187], v8 offset:34496
 v_cvt_pk_bf16_f32 v49, v26, v27
 v_mfma_f32_16x16x32_bf16 v[68:71], a[164:167], v[40:43], v[68:71]
 v_exp_f32 v28, v28
 v_mfma_f32_16x16x32_bf16 v[68:71], a[196:199], v[44:47], v[68:71]
 s_waitcnt lgkmcnt(10)
 v_exp_f32 v29, v29
 v_mfma_f32_16x16x32_bf16 v[72:75], a[168:171], v[40:43], v[72:75]
 ds_read_b64_tr_b16 a[216:217], v8 offset:50880
 ds_read_b64_tr_b16 a[218:219], v8 offset:51392
 v_mfma_f32_16x16x32_bf16 v[72:75], a[200:203], v[44:47], v[72:75]
 v_mul_f32 v30, s32, v30
 v_mul_f32 v31, s32, v31
 v_mfma_f32_16x16x32_bf16 v[76:79], a[172:175], v[40:43], v[76:79]
 v_exp_f32 v30, v30
 v_mfma_f32_16x16x32_bf16 v[76:79], a[204:207], v[44:47], v[76:79]
 ds_read_b64_tr_b16 a[188:189], v8 offset:34016
 ds_read_b64_tr_b16 a[190:191], v8 offset:34528
 v_mfma_f32_16x16x32_bf16 v[24:27], a[96:99], a[32:35], 0
 ds_read_b128 v[60:63], v6 offset:11968
 v_exp_f32 v31, v31
 v_mfma_f32_16x16x32_bf16 v[24:27], a[100:103], a[36:39], v[24:27]
 v_cvt_pk_bf16_f32 v50, v28, v29
 v_cvt_pk_bf16_f32 v51, v30, v31
 v_mfma_f32_16x16x32_bf16 v[24:27], a[104:107], a[40:43], v[24:27]
 ds_read_b64_tr_b16 a[220:221], v8 offset:50912
 ds_read_b64_tr_b16 a[222:223], v8 offset:51424
 v_mfma_f32_16x16x32_bf16 v[24:27], a[108:111], a[44:47], v[24:27]
 v_mul_f32 v32, s32, v32
 v_mul_f32 v33, s32, v33
 v_smfmac_f32_16x16x64_bf16 a[224:227], a[236:239], v[40:47], v2
 v_exp_f32 v32, v32
 v_mfma_f32_16x16x32_bf16 v[28:31], a[124:127], a[44:47], 0
 v_exp_f32 v33, v33
 v_mfma_f32_16x16x32_bf16 v[28:31], a[120:123], a[40:43], v[28:31]
 v_mul_f32 v34, s32, v34
 v_mul_f32 v35, s32, v35
 v_mfma_f32_16x16x32_bf16 v[28:31], a[116:119], a[36:39], v[28:31]
 v_exp_f32 v34, v34
 v_mfma_f32_16x16x32_bf16 v[28:31], a[112:115], a[32:35], v[28:31]
 s_waitcnt lgkmcnt(9)
 v_exp_f32 v35, v35
 v_mfma_f32_16x16x32_bf16 v[80:83], a[176:179], v[40:43], v[80:83]
 s_mov_b32 s38, 11264
 v_mul_f32 v36, s32, v36
 v_mul_f32 v37, s32, v37
 v_mfma_f32_16x16x32_bf16 v[80:83], a[208:211], v[44:47], v[80:83]
 s_waitcnt lgkmcnt(2)
 buffer_store_dwordx4 v[60:63], v1, s[24:27], s38 offen sc1 nt
 v_mfma_f32_16x16x32_bf16 v[84:87], a[180:183], v[40:43], v[84:87]
 v_cvt_pk_bf16_f32 v52, v32, v33
 v_cvt_pk_bf16_f32 v53, v34, v35
 v_mfma_f32_16x16x32_bf16 v[84:87], a[212:215], v[44:47], v[84:87]
 s_waitcnt lgkmcnt(0)
 s_barrier
 v_mfma_f32_16x16x32_bf16 v[88:91], a[184:187], v[40:43], v[88:91]
 v_exp_f32 v36, v36
 v_mfma_f32_16x16x32_bf16 v[88:91], a[216:219], v[44:47], v[88:91]
 v_exp_f32 v37, v37
 v_mfma_f32_16x16x32_bf16 v[92:95], a[188:191], v[40:43], v[92:95]
 v_mul_f32 v38, s32, v38
 v_mul_f32 v39, s32, v39
 v_mfma_f32_16x16x32_bf16 v[92:95], a[220:223], v[44:47], v[92:95]
 v_exp_f32 v38, v38
 v_mfma_f32_16x16x32_bf16 v[32:35], a[128:131], a[32:35], 0
 v_exp_f32 v39, v39
 v_mfma_f32_16x16x32_bf16 v[32:35], a[132:135], a[36:39], v[32:35]
 v_cvt_pk_bf16_f32 v54, v36, v37
 v_cvt_pk_bf16_f32 v55, v38, v39
 v_mfma_f32_16x16x32_bf16 v[32:35], a[136:139], a[40:43], v[32:35]
 v_mul_f32 v24, s32, v24
 v_mul_f32 v25, s32, v25
 v_mfma_f32_16x16x32_bf16 v[32:35], a[140:143], a[44:47], v[32:35]
 v_exp_f32 v24, v24
 v_mfma_f32_16x16x32_bf16 v[36:39], a[156:159], a[44:47], 0
 v_exp_f32 v25, v25
 v_mfma_f32_16x16x32_bf16 v[36:39], a[152:155], a[40:43], v[36:39]
 v_mul_f32 v26, s32, v26
 v_mul_f32 v27, s32, v27
 v_mfma_f32_16x16x32_bf16 v[36:39], a[148:151], a[36:39], v[36:39]
 s_add_u32 m0, s39, 33792
 v_exp_f32 v26, v26
 v_mfma_f32_16x16x32_bf16 v[36:39], a[144:147], a[32:35], v[36:39]
 buffer_load_dwordx4 v1, s[20:23], s33 offen nt lds
 v_mfma_f32_16x16x32_bf16 v[96:99], a[160:163], v[48:51], v[96:99]
 v_exp_f32 v27, v27
 v_mfma_f32_16x16x32_bf16 v[96:99], a[192:195], v[52:55], v[96:99]
 v_mul_f32 v28, s32, v28
 v_mul_f32 v29, s32, v29
 v_mfma_f32_16x16x32_bf16 v[100:103], a[164:167], v[48:51], v[100:103]
 v_cvt_pk_bf16_f32 v40, v24, v25
 v_cvt_pk_bf16_f32 v41, v26, v27
 v_mfma_f32_16x16x32_bf16 v[100:103], a[196:199], v[52:55], v[100:103]
 v_exp_f32 v28, v28
 v_mfma_f32_16x16x32_bf16 v[104:107], a[168:171], v[48:51], v[104:107]
 v_exp_f32 v29, v29
 v_mfma_f32_16x16x32_bf16 v[104:107], a[200:203], v[52:55], v[104:107]
 v_mul_f32 v30, s32, v30
 v_mul_f32 v31, s32, v31
 v_mfma_f32_16x16x32_bf16 v[108:111], a[172:175], v[48:51], v[108:111]
 v_exp_f32 v30, v30
 v_mfma_f32_16x16x32_bf16 v[108:111], a[204:207], v[52:55], v[108:111]
 v_exp_f32 v31, v31
 v_mfma_f32_16x16x32_bf16 v[24:27], a[96:99], a[48:51], 0
 v_cvt_pk_bf16_f32 v42, v28, v29
 v_cvt_pk_bf16_f32 v43, v30, v31
 v_mfma_f32_16x16x32_bf16 v[24:27], a[100:103], a[52:55], v[24:27]
 v_mul_f32 v32, s32, v32
 v_mul_f32 v33, s32, v33
 v_mfma_f32_16x16x32_bf16 v[24:27], a[104:107], a[56:59], v[24:27]
 v_exp_f32 v32, v32
 v_mfma_f32_16x16x32_bf16 v[24:27], a[108:111], a[60:63], v[24:27]
 v_exp_f32 v33, v33
 v_smfmac_f32_16x16x64_bf16 a[224:227], a[240:243], v[48:55], v2
 v_mfma_f32_16x16x32_bf16 v[28:31], a[124:127], a[60:63], 0
 v_mul_f32 v34, s32, v34
 v_mul_f32 v35, s32, v35
 v_mfma_f32_16x16x32_bf16 v[28:31], a[120:123], a[56:59], v[28:31]
 v_exp_f32 v34, v34
 v_mfma_f32_16x16x32_bf16 v[28:31], a[116:119], a[52:55], v[28:31]
 s_add_u32 m0, s39, 33824
 v_exp_f32 v35, v35
 v_mfma_f32_16x16x32_bf16 v[28:31], a[112:115], a[48:51], v[28:31]
 buffer_load_dwordx4 v1, s[20:23], s33 offen offset:1024 nt lds
 v_mfma_f32_16x16x32_bf16 v[112:115], a[176:179], v[48:51], v[112:115]
 v_mul_f32 v36, s32, v36
 v_mul_f32 v37, s32, v37
 v_mfma_f32_16x16x32_bf16 v[112:115], a[208:211], v[52:55], v[112:115]
 v_cvt_pk_bf16_f32 v44, v32, v33
 v_cvt_pk_bf16_f32 v45, v34, v35
 v_mfma_f32_16x16x32_bf16 v[116:119], a[180:183], v[48:51], v[116:119]
 v_exp_f32 v36, v36
 v_mfma_f32_16x16x32_bf16 v[116:119], a[212:215], v[52:55], v[116:119]
 v_exp_f32 v37, v37
 v_mfma_f32_16x16x32_bf16 v[120:123], a[184:187], v[48:51], v[120:123]
 v_mul_f32 v38, s32, v38
 v_mul_f32 v39, s32, v39
 v_mfma_f32_16x16x32_bf16 v[120:123], a[216:219], v[52:55], v[120:123]
 v_exp_f32 v38, v38
 v_mfma_f32_16x16x32_bf16 v[124:127], a[188:191], v[48:51], v[124:127]
 v_exp_f32 v39, v39
 v_mfma_f32_16x16x32_bf16 v[124:127], a[220:223], v[52:55], v[124:127]
 v_cvt_pk_bf16_f32 v46, v36, v37
 v_cvt_pk_bf16_f32 v47, v38, v39
 v_mfma_f32_16x16x32_bf16 v[32:35], a[128:131], a[48:51], 0
 v_mul_f32 v24, s32, v24
 v_mul_f32 v25, s32, v25
 v_mfma_f32_16x16x32_bf16 v[32:35], a[132:135], a[52:55], v[32:35]
 v_exp_f32 v24, v24
 v_mfma_f32_16x16x32_bf16 v[32:35], a[136:139], a[56:59], v[32:35]
 v_exp_f32 v25, v25
 v_mfma_f32_16x16x32_bf16 v[32:35], a[140:143], a[60:63], v[32:35]
 v_mul_f32 v26, s32, v26
 v_mul_f32 v27, s32, v27
 v_mfma_f32_16x16x32_bf16 v[36:39], a[156:159], a[60:63], 0
 v_exp_f32 v26, v26
 v_mfma_f32_16x16x32_bf16 v[36:39], a[152:155], a[56:59], v[36:39]
 v_exp_f32 v27, v27
 v_mfma_f32_16x16x32_bf16 v[36:39], a[148:151], a[52:55], v[36:39]
 v_mul_f32 v28, s32, v28
 v_mul_f32 v29, s32, v29
 v_mfma_f32_16x16x32_bf16 v[36:39], a[144:147], a[48:51], v[36:39]
 v_cvt_pk_bf16_f32 v48, v24, v25
 v_cvt_pk_bf16_f32 v49, v26, v27
 v_mfma_f32_16x16x32_bf16 v[128:131], a[160:163], v[40:43], v[128:131]
 s_add_u32 m0, s39, 33856
 v_exp_f32 v28, v28
 v_mfma_f32_16x16x32_bf16 v[128:131], a[192:195], v[44:47], v[128:131]
 buffer_load_dwordx4 v1, s[20:23], s33 offen offset:2048 nt lds
 v_mfma_f32_16x16x32_bf16 v[132:135], a[164:167], v[40:43], v[132:135]
 v_exp_f32 v29, v29
 v_mfma_f32_16x16x32_bf16 v[132:135], a[196:199], v[44:47], v[132:135]
 v_mul_f32 v30, s32, v30
 v_mul_f32 v31, s32, v31
 v_mfma_f32_16x16x32_bf16 v[136:139], a[168:171], v[40:43], v[136:139]
 v_exp_f32 v30, v30
 v_mfma_f32_16x16x32_bf16 v[136:139], a[200:203], v[44:47], v[136:139]
 v_exp_f32 v31, v31
 v_mfma_f32_16x16x32_bf16 v[140:143], a[172:175], v[40:43], v[140:143]
 v_cvt_pk_bf16_f32 v50, v28, v29
 v_cvt_pk_bf16_f32 v51, v30, v31
 v_mfma_f32_16x16x32_bf16 v[140:143], a[204:207], v[44:47], v[140:143]
 v_mul_f32 v32, s32, v32
 v_mul_f32 v33, s32, v33
 v_mfma_f32_16x16x32_bf16 v[24:27], a[96:99], a[64:67], 0
 v_exp_f32 v32, v32
 v_mfma_f32_16x16x32_bf16 v[24:27], a[100:103], a[68:71], v[24:27]
 v_exp_f32 v33, v33
 v_mfma_f32_16x16x32_bf16 v[24:27], a[104:107], a[72:75], v[24:27]
 v_mul_f32 v34, s32, v34
 v_mul_f32 v35, s32, v35
 v_mfma_f32_16x16x32_bf16 v[24:27], a[108:111], a[76:79], v[24:27]
 v_exp_f32 v34, v34
 v_smfmac_f32_16x16x64_bf16 a[228:231], a[236:239], v[40:47], v2
 v_mfma_f32_16x16x32_bf16 v[28:31], a[124:127], a[76:79], 0
 v_exp_f32 v35, v35
 v_mfma_f32_16x16x32_bf16 v[28:31], a[120:123], a[72:75], v[28:31]
 v_mul_f32 v36, s32, v36
 v_mul_f32 v37, s32, v37
 v_mfma_f32_16x16x32_bf16 v[28:31], a[116:119], a[68:71], v[28:31]
L_pg1_11:
 s_cbranch_execz L_main1
 v_cvt_pk_bf16_f32 v52, v32, v33
 v_cvt_pk_bf16_f32 v53, v34, v35
 v_mfma_f32_16x16x32_bf16 v[28:31], a[112:115], a[64:67], v[28:31]
 v_exp_f32 v36, v36
 v_mfma_f32_16x16x32_bf16 v[144:147], a[176:179], v[40:43], v[144:147]
 s_add_u32 m0, s39, 33888
 v_exp_f32 v37, v37
 v_mfma_f32_16x16x32_bf16 v[144:147], a[208:211], v[44:47], v[144:147]
 buffer_load_dwordx4 v1, s[20:23], s33 offen offset:3072 nt lds
 v_mfma_f32_16x16x32_bf16 v[148:151], a[180:183], v[40:43], v[148:151]
 s_add_u32 s33, s33, 8192
 v_mul_f32 v38, s32, v38
 v_mul_f32 v39, s32, v39
 v_mfma_f32_16x16x32_bf16 v[148:151], a[212:215], v[44:47], v[148:151]
 v_exp_f32 v38, v38
 v_mfma_f32_16x16x32_bf16 v[152:155], a[184:187], v[40:43], v[152:155]
 v_exp_f32 v39, v39
 v_mfma_f32_16x16x32_bf16 v[152:155], a[216:219], v[44:47], v[152:155]
 v_cvt_pk_bf16_f32 v54, v36, v37
 v_cvt_pk_bf16_f32 v55, v38, v39
 v_mfma_f32_16x16x32_bf16 v[156:159], a[188:191], v[40:43], v[156:159]
 v_mul_f32 v24, s32, v24
 v_mul_f32 v25, s32, v25
 v_mfma_f32_16x16x32_bf16 v[156:159], a[220:223], v[44:47], v[156:159]
 v_exp_f32 v24, v24
 v_mfma_f32_16x16x32_bf16 v[32:35], a[128:131], a[64:67], 0
 v_exp_f32 v25, v25
 v_mfma_f32_16x16x32_bf16 v[32:35], a[132:135], a[68:71], v[32:35]
 v_mul_f32 v26, s32, v26
 v_mul_f32 v27, s32, v27
 v_mfma_f32_16x16x32_bf16 v[32:35], a[136:139], a[72:75], v[32:35]
 v_exp_f32 v26, v26
 v_mfma_f32_16x16x32_bf16 v[32:35], a[140:143], a[76:79], v[32:35]
 v_exp_f32 v27, v27
 v_mfma_f32_16x16x32_bf16 v[36:39], a[156:159], a[76:79], 0
 v_mul_f32 v28, s32, v28
 v_mul_f32 v29, s32, v29
 v_mfma_f32_16x16x32_bf16 v[36:39], a[152:155], a[72:75], v[36:39]
 v_cvt_pk_bf16_f32 v40, v24, v25
 v_cvt_pk_bf16_f32 v41, v26, v27
 v_mfma_f32_16x16x32_bf16 v[36:39], a[148:151], a[68:71], v[36:39]
 v_exp_f32 v28, v28
 v_mfma_f32_16x16x32_bf16 v[36:39], a[144:147], a[64:67], v[36:39]
 v_exp_f32 v29, v29
 v_mfma_f32_16x16x32_bf16 v[160:163], a[160:163], v[48:51], v[160:163]
 v_mul_f32 v30, s32, v30
 v_mul_f32 v31, s32, v31
 v_mfma_f32_16x16x32_bf16 v[160:163], a[192:195], v[52:55], v[160:163]
 v_exp_f32 v30, v30
 v_mfma_f32_16x16x32_bf16 v[164:167], a[164:167], v[48:51], v[164:167]
 s_add_u32 m0, s39, 50688
 v_exp_f32 v31, v31
 v_mfma_f32_16x16x32_bf16 v[164:167], a[196:199], v[52:55], v[164:167]
 buffer_load_dwordx4 v1, s[20:23], s33 offen nt lds
 v_mfma_f32_16x16x32_bf16 v[168:171], a[168:171], v[48:51], v[168:171]
 v_cvt_pk_bf16_f32 v42, v28, v29
 v_cvt_pk_bf16_f32 v43, v30, v31
 v_mfma_f32_16x16x32_bf16 v[168:171], a[200:203], v[52:55], v[168:171]
 v_mul_f32 v32, s32, v32
 v_mul_f32 v33, s32, v33
 v_mfma_f32_16x16x32_bf16 v[172:175], a[172:175], v[48:51], v[172:175]
 v_exp_f32 v32, v32
 v_mfma_f32_16x16x32_bf16 v[172:175], a[204:207], v[52:55], v[172:175]
 v_exp_f32 v33, v33
 v_mfma_f32_16x16x32_bf16 v[24:27], a[96:99], a[80:83], 0
 v_mul_f32 v34, s32, v34
 v_mul_f32 v35, s32, v35
 v_mfma_f32_16x16x32_bf16 v[24:27], a[100:103], a[84:87], v[24:27]
 v_exp_f32 v34, v34
 v_mfma_f32_16x16x32_bf16 v[24:27], a[104:107], a[88:91], v[24:27]
 v_exp_f32 v35, v35
 v_mfma_f32_16x16x32_bf16 v[24:27], a[108:111], a[92:95], v[24:27]
 v_mul_f32 v36, s32, v36
 v_mul_f32 v37, s32, v37
 v_smfmac_f32_16x16x64_bf16 a[228:231], a[240:243], v[48:55], v2
 v_mfma_f32_16x16x32_bf16 v[28:31], a[124:127], a[92:95], 0
 v_cvt_pk_bf16_f32 v44, v32, v33
 v_cvt_pk_bf16_f32 v45, v34, v35
 v_mfma_f32_16x16x32_bf16 v[28:31], a[120:123], a[88:91], v[28:31]
 v_exp_f32 v36, v36
 v_mfma_f32_16x16x32_bf16 v[28:31], a[116:119], a[84:87], v[28:31]
 v_exp_f32 v37, v37
 v_mfma_f32_16x16x32_bf16 v[28:31], a[112:115], a[80:83], v[28:31]
 s_waitcnt vmcnt(7)
 s_barrier
 v_mfma_f32_16x16x32_bf16 v[176:179], a[176:179], v[48:51], v[176:179]
 v_mul_f32 v38, s32, v38
 v_mul_f32 v39, s32, v39
 v_mfma_f32_16x16x32_bf16 v[176:179], a[208:211], v[52:55], v[176:179]
 v_exp_f32 v38, v38
 v_mfma_f32_16x16x32_bf16 v[180:183], a[180:183], v[48:51], v[180:183]
 s_add_u32 m0, s39, 50720
 ds_read_b128 a[96:99], v7 offset:0
 ds_read_b128 a[100:103], v7 offset:64
 v_mfma_f32_16x16x32_bf16 v[180:183], a[212:215], v[52:55], v[180:183]
 buffer_load_dwordx4 v1, s[20:23], s33 offen offset:1024 nt lds
 v_mfma_f32_16x16x32_bf16 v[184:187], a[184:187], v[48:51], v[184:187]
 v_exp_f32 v39, v39
 v_mfma_f32_16x16x32_bf16 v[184:187], a[216:219], v[52:55], v[184:187]
 v_cvt_pk_bf16_f32 v46, v36, v37
 v_cvt_pk_bf16_f32 v47, v38, v39
 v_mfma_f32_16x16x32_bf16 v[188:191], a[188:191], v[48:51], v[188:191]
 ds_read_b128 a[104:107], v7 offset:128
 ds_read_b128 a[108:111], v7 offset:192
 v_mfma_f32_16x16x32_bf16 v[188:191], a[220:223], v[52:55], v[188:191]
 v_mul_f32 v24, s32, v24
 v_mul_f32 v25, s32, v25
 v_mfma_f32_16x16x32_bf16 v[32:35], a[128:131], a[80:83], 0
 v_exp_f32 v24, v24
 v_mfma_f32_16x16x32_bf16 v[32:35], a[132:135], a[84:87], v[32:35]
 v_exp_f32 v25, v25
 v_mfma_f32_16x16x32_bf16 v[32:35], a[136:139], a[88:91], v[32:35]
 ds_read_b128 a[124:127], v7 offset:704
 ds_read_b128 a[120:123], v7 offset:640
 v_mfma_f32_16x16x32_bf16 v[32:35], a[140:143], a[92:95], v[32:35]
 v_mul_f32 v26, s32, v26
 v_mul_f32 v27, s32, v27
 v_mfma_f32_16x16x32_bf16 v[36:39], a[156:159], a[92:95], 0
 v_exp_f32 v26, v26
 v_mfma_f32_16x16x32_bf16 v[36:39], a[152:155], a[88:91], v[36:39]
 v_exp_f32 v27, v27
 v_mfma_f32_16x16x32_bf16 v[36:39], a[148:151], a[84:87], v[36:39]
 ds_read_b128 a[116:119], v7 offset:576
 ds_read_b128 a[112:115], v7 offset:512
 v_mfma_f32_16x16x32_bf16 v[36:39], a[144:147], a[80:83], v[36:39]
 v_mul_f32 v28, s32, v28
 v_mul_f32 v29, s32, v29
 v_mfma_f32_16x16x32_bf16 v[192:195], a[160:163], v[40:43], v[192:195]
 v_cvt_pk_bf16_f32 v48, v24, v25
 v_cvt_pk_bf16_f32 v49, v26, v27
 v_mfma_f32_16x16x32_bf16 v[192:195], a[192:195], v[44:47], v[192:195]
 v_exp_f32 v28, v28
 v_mfma_f32_16x16x32_bf16 v[196:199], a[164:167], v[40:43], v[196:199]
 v_exp_f32 v29, v29
 v_mfma_f32_16x16x32_bf16 v[196:199], a[196:199], v[44:47], v[196:199]
 ds_read_b128 a[128:131], v7 offset:16896
 ds_read_b128 a[132:135], v7 offset:16960
 v_mfma_f32_16x16x32_bf16 v[200:203], a[168:171], v[40:43], v[200:203]
 s_add_u32 m0, s39, 50752
 v_mul_f32 v30, s32, v30
 v_mul_f32 v31, s32, v31
 v_mfma_f32_16x16x32_bf16 v[200:203], a[200:203], v[44:47], v[200:203]
 buffer_load_dwordx4 v1, s[20:23], s33 offen offset:2048 nt lds
 v_mfma_f32_16x16x32_bf16 v[204:207], a[172:175], v[40:43], v[204:207]
 v_exp_f32 v30, v30
 v_mfma_f32_16x16x32_bf16 v[204:207], a[204:207], v[44:47], v[204:207]
 s_waitcnt lgkmcnt(6)
 ds_read_b128 a[136:139], v7 offset:17024
 ds_read_b128 a[140:143], v7 offset:17088
 v_mfma_f32_16x16x32_bf16 v[24:27], a[96:99], a[0:3], 0
 v_exp_f32 v31, v31
 v_mfma_f32_16x16x32_bf16 v[24:27], a[100:103], a[4:7], v[24:27]
 v_cvt_pk_bf16_f32 v50, v28, v29
 v_cvt_pk_bf16_f32 v51, v30, v31
 v_mfma_f32_16x16x32_bf16 v[24:27], a[104:107], a[8:11], v[24:27]
 v_mul_f32 v32, s32, v32
 v_mul_f32 v33, s32, v33
 v_mfma_f32_16x16x32_bf16 v[24:27], a[108:111], a[12:15], v[24:27]
 s_waitcnt lgkmcnt(4)
 ds_read_b128 a[156:159], v7 offset:17600
 ds_read_b128 a[152:155], v7 offset:17536
 v_exp_f32 v32, v32
 v_smfmac_f32_16x16x64_bf16 a[232:235], a[236:239], v[40:47], v2
 v_exp_f32 v33, v33
 v_mfma_f32_16x16x32_bf16 v[28:31], a[124:127], a[12:15], 0
 v_mul_f32 v34, s32, v34
 v_mul_f32 v35, s32, v35
 v_mfma_f32_16x16x32_bf16 v[28:31], a[120:123], a[8:11], v[28:31]
 v_exp_f32 v34, v34
 v_mfma_f32_16x16x32_bf16 v[28:31], a[116:119], a[4:7], v[28:31]
 ds_read_b128 a[148:151], v7 offset:17472
 ds_read_b128 a[144:147], v7 offset:17408
 v_mfma_f32_16x16x32_bf16 v[28:31], a[112:115], a[0:3], v[28:31]
 v_exp_f32 v35, v35
 v_mul_f32 v36, s32, v36
 v_mfma_f32_16x16x32_bf16 v[208:211], a[176:179], v[40:43], v[208:211]
 v_mul_f32 v37, s32, v37
 v_cvt_pk_bf16_f32 v52, v32, v33
 v_mfma_f32_16x16x32_bf16 v[208:211], a[208:211], v[44:47], v[208:211]
 ds_read_b128 v[56:59], v6 offset:13056
 v_cvt_pk_bf16_f32 v53, v34, v35
 v_mfma_f32_16x16x32_bf16 v[212:215], a[180:183], v[40:43], v[212:215]
 s_add_u32 m0, s39, 50784
 v_exp_f32 v36, v36
 v_mfma_f32_16x16x32_bf16 v[212:215], a[212:215], v[44:47], v[212:215]
 buffer_load_dwordx4 v1, s[20:23], s33 offen offset:3072 nt lds
 v_mfma_f32_16x16x32_bf16 v[216:219], a[184:187], v[40:43], v[216:219]
 s_add_u32 s33, s33, 8192
 v_exp_f32 v37, v37
 v_mfma_f32_16x16x32_bf16 v[216:219], a[216:219], v[44:47], v[216:219]
 v_mul_f32 v38, s32, v38
 v_mul_f32 v39, s32, v39
 v_mfma_f32_16x16x32_bf16 v[220:223], a[188:191], v[40:43], v[220:223]
 v_exp_f32 v38, v38
 v_mfma_f32_16x16x32_bf16 v[220:223], a[220:223], v[44:47], v[220:223]
 s_waitcnt lgkmcnt(5)
 v_exp_f32 v39, v39
 v_mfma_f32_16x16x32_bf16 v[32:35], a[128:131], a[0:3], 0
 v_cvt_pk_bf16_f32 v54, v36, v37
 v_cvt_pk_bf16_f32 v55, v38, v39
 v_mfma_f32_16x16x32_bf16 v[32:35], a[132:135], a[4:7], v[32:35]
 v_mul_f32 v24, s32, v24
 v_mul_f32 v25, s32, v25
 v_mfma_f32_16x16x32_bf16 v[32:35], a[136:139], a[8:11], v[32:35]
 s_mov_b32 s38, 12288
 v_exp_f32 v24, v24
 v_mfma_f32_16x16x32_bf16 v[32:35], a[140:143], a[12:15], v[32:35]
 s_waitcnt lgkmcnt(0)
 s_waitcnt lgkmcnt(1)
 buffer_store_dwordx4 v[56:59], v1, s[24:27], s38 offen sc1 nt
 v_mfma_f32_16x16x32_bf16 v[36:39], a[156:159], a[12:15], 0
 v_exp_f32 v25, v25
 v_mfma_f32_16x16x32_bf16 v[36:39], a[152:155], a[8:11], v[36:39]
 v_mul_f32 v26, s32, v26
 v_mul_f32 v27, s32, v27
 v_mfma_f32_16x16x32_bf16 v[36:39], a[148:151], a[4:7], v[36:39]
 v_exp_f32 v26, v26
 v_mfma_f32_16x16x32_bf16 v[36:39], a[144:147], a[0:3], v[36:39]
 v_exp_f32 v27, v27
 v_mul_f32 v28, s32, v28
 v_mfma_f32_16x16x32_bf16 v[224:227], a[160:163], v[48:51], v[224:227]
 v_mul_f32 v29, s32, v29
 v_cvt_pk_bf16_f32 v40, v24, v25
 v_mfma_f32_16x16x32_bf16 v[224:227], a[192:195], v[52:55], v[224:227]
 v_cvt_pk_bf16_f32 v41, v26, v27
 v_exp_f32 v28, v28
 v_mfma_f32_16x16x32_bf16 v[228:231], a[164:167], v[48:51], v[228:231]
 ds_read_b64_tr_b16 a[160:161], v8 offset:0
 ds_read_b64_tr_b16 a[162:163], v8 offset:512
 v_mfma_f32_16x16x32_bf16 v[228:231], a[196:199], v[52:55], v[228:231]
 v_exp_f32 v29, v29
 v_mul_f32 v30, s32, v30
 v_mfma_f32_16x16x32_bf16 v[232:235], a[168:171], v[48:51], v[232:235]
 ds_read_b64_tr_b16 a[192:193], v8 offset:16896
 ds_read_b64_tr_b16 a[194:195], v8 offset:17408
 v_mfma_f32_16x16x32_bf16 v[232:235], a[200:203], v[52:55], v[232:235]
 v_mul_f32 v31, s32, v31
 v_exp_f32 v30, v30
 v_mfma_f32_16x16x32_bf16 v[236:239], a[172:175], v[48:51], v[236:239]
 v_exp_f32 v31, v31
 v_mfma_f32_16x16x32_bf16 v[236:239], a[204:207], v[52:55], v[236:239]
 ds_read_b64_tr_b16 a[164:165], v8 offset:32
 ds_read_b64_tr_b16 a[166:167], v8 offset:544
 v_mfma_f32_16x16x32_bf16 v[24:27], a[96:99], a[16:19], 0
 v_cvt_pk_bf16_f32 v42, v28, v29
 v_cvt_pk_bf16_f32 v43, v30, v31
 v_mfma_f32_16x16x32_bf16 v[24:27], a[100:103], a[20:23], v[24:27]
 ds_read_b64_tr_b16 a[196:197], v8 offset:16928
 ds_read_b64_tr_b16 a[198:199], v8 offset:17440
 v_mfma_f32_16x16x32_bf16 v[24:27], a[104:107], a[24:27], v[24:27]
 v_mul_f32 v32, s32, v32
 v_mul_f32 v33, s32, v33
 v_mfma_f32_16x16x32_bf16 v[24:27], a[108:111], a[28:31], v[24:27]
 ds_read_b64_tr_b16 a[168:169], v8 offset:64
 ds_read_b64_tr_b16 a[170:171], v8 offset:576
 v_exp_f32 v32, v32
 v_smfmac_f32_16x16x64_bf16 a[232:235], a[240:243], v[48:55], v2
 v_exp_f32 v33, v33
 v_mul_f32 v34, s32, v34
 v_mfma_f32_16x16x32_bf16 v[28:31], a[124:127], a[28:31], 0
 ds_read_b64_tr_b16 a[200:201], v8 offset:16960
 ds_read_b64_tr_b16 a[202:203], v8 offset:17472
 v_mfma_f32_16x16x32_bf16 v[28:31], a[120:123], a[24:27], v[28:31]
 ds_read_b128 v[60:63], v6 offset:14144
 v_mul_f32 v35, s32, v35
 v_mfma_f32_16x16x32_bf16 v[28:31], a[116:119], a[20:23], v[28:31]
 v_exp_f32 v34, v34
 v_mfma_f32_16x16x32_bf16 v[28:31], a[112:115], a[16:19], v[28:31]
 ds_read_b64_tr_b16 a[172:173], v8 offset:96
 ds_read_b64_tr_b16 a[174:175], v8 offset:608
 v_exp_f32 v35, v35
 v_mfma_f32_16x16x32_bf16 v[240:243], a[176:179], v[48:51], v[240:243]
 v_mul_f32 v36, s32, v36
 v_mul_f32 v37, s32, v37
 v_mfma_f32_16x16x32_bf16 v[240:243], a[208:211], v[52:55], v[240:243]
 ds_read_b64_tr_b16 a[204:205], v8 offset:16992
 ds_read_b64_tr_b16 a[206:207], v8 offset:17504
 v_cvt_pk_bf16_f32 v44, v32, v33
 v_cvt_pk_bf16_f32 v45, v34, v35
 v_mfma_f32_16x16x32_bf16 v[244:247], a[180:183], v[48:51], v[244:247]
 v_exp_f32 v36, v36
 v_mfma_f32_16x16x32_bf16 v[244:247], a[212:215], v[52:55], v[244:247]
 v_exp_f32 v37, v37
 v_mfma_f32_16x16x32_bf16 v[248:251], a[184:187], v[48:51], v[248:251]
 v_mul_f32 v38, s32, v38
 v_mul_f32 v39, s32, v39
 v_mfma_f32_16x16x32_bf16 v[248:251], a[216:219], v[52:55], v[248:251]
 ds_read_b64_tr_b16 a[176:177], v8 offset:128
 ds_read_b64_tr_b16 a[178:179], v8 offset:640
 v_exp_f32 v38, v38
 v_mfma_f32_16x16x32_bf16 v[252:255], a[188:191], v[48:51], v[252:255]
 s_mov_b32 s38, 13312
 v_exp_f32 v39, v39
 v_mfma_f32_16x16x32_bf16 v[252:255], a[220:223], v[52:55], v[252:255]
 s_waitcnt lgkmcnt(6)
 buffer_store_dwordx4 v[60:63], v1, s[24:27], s38 offen sc1 nt
 v_mfma_f32_16x16x32_bf16 v[32:35], a[128:131], a[16:19], 0
 ds_read_b64_tr_b16 a[208:209], v8 offset:17024
 ds_read_b64_tr_b16 a[210:211], v8 offset:17536
 v_mfma_f32_16x16x32_bf16 v[32:35], a[132:135], a[20:23], v[32:35]
 v_cvt_pk_bf16_f32 v46, v36, v37
 v_cvt_pk_bf16_f32 v47, v38, v39
 v_mfma_f32_16x16x32_bf16 v[32:35], a[136:139], a[24:27], v[32:35]
 v_mul_f32 v24, s32, v24
 v_mul_f32 v25, s32, v25
 v_mfma_f32_16x16x32_bf16 v[32:35], a[140:143], a[28:31], v[32:35]
 ds_read_b64_tr_b16 a[180:181], v8 offset:160
 ds_read_b64_tr_b16 a[182:183], v8 offset:672
 v_exp_f32 v24, v24
 v_mfma_f32_16x16x32_bf16 v[36:39], a[156:159], a[28:31], 0
 v_exp_f32 v25, v25
 v_mfma_f32_16x16x32_bf16 v[36:39], a[152:155], a[24:27], v[36:39]
 v_mul_f32 v26, s32, v26
 v_mul_f32 v27, s32, v27
 v_mfma_f32_16x16x32_bf16 v[36:39], a[148:151], a[20:23], v[36:39]
 ds_read_b64_tr_b16 a[212:213], v8 offset:17056
 ds_read_b64_tr_b16 a[214:215], v8 offset:17568
 v_mfma_f32_16x16x32_bf16 v[36:39], a[144:147], a[16:19], v[36:39]
 s_waitcnt lgkmcnt(15)
 v_exp_f32 v26, v26
 v_mfma_f32_16x16x32_bf16 v[64:67], a[160:163], v[40:43], v[64:67]
 v_exp_f32 v27, v27
 v_mfma_f32_16x16x32_bf16 v[64:67], a[192:195], v[44:47], v[64:67]
 ds_read_b64_tr_b16 a[184:185], v8 offset:192
 ds_read_b64_tr_b16 a[186:187], v8 offset:704
 v_mul_f32 v28, s32, v28
 v_mfma_f32_16x16x32_bf16 v[68:71], a[164:167], v[40:43], v[68:71]
 v_mul_f32 v29, s32, v29
 v_cvt_pk_bf16_f32 v48, v24, v25
 v_mfma_f32_16x16x32_bf16 v[68:71], a[196:199], v[44:47], v[68:71]
 s_waitcnt lgkmcnt(10)
 v_cvt_pk_bf16_f32 v49, v26, v27
 v_exp_f32 v28, v28
 v_mfma_f32_16x16x32_bf16 v[72:75], a[168:171], v[40:43], v[72:75]
 ds_read_b64_tr_b16 a[216:217], v8 offset:17088
 ds_read_b64_tr_b16 a[218:219], v8 offset:17600
 v_mfma_f32_16x16x32_bf16 v[72:75], a[200:203], v[44:47], v[72:75]
 v_exp_f32 v29, v29
 v_mul_f32 v30, s32, v30
 v_mul_f32 v31, s32, v31
 v_mfma_f32_16x16x32_bf16 v[76:79], a[172:175], v[40:43], v[76:79]
 v_exp_f32 v30, v30
 v_mfma_f32_16x16x32_bf16 v[76:79], a[204:207], v[44:47], v[76:79]
 ds_read_b64_tr_b16 a[188:189], v8 offset:224
 ds_read_b64_tr_b16 a[190:191], v8 offset:736
 v_mfma_f32_16x16x32_bf16 v[24:27], a[96:99], a[32:35], 0
 v_exp_f32 v31, v31
 v_mfma_f32_16x16x32_bf16 v[24:27], a[100:103], a[36:39], v[24:27]
 v_cvt_pk_bf16_f32 v50, v28, v29
 v_cvt_pk_bf16_f32 v51, v30, v31
 v_mfma_f32_16x16x32_bf16 v[24:27], a[104:107], a[40:43], v[24:27]
 ds_read_b64_tr_b16 a[220:221], v8 offset:17120
 ds_read_b64_tr_b16 a[222:223], v8 offset:17632
 v_mfma_f32_16x16x32_bf16 v[24:27], a[108:111], a[44:47], v[24:27]
 v_mul_f32 v32, s32, v32
 v_mul_f32 v33, s32, v33
 v_smfmac_f32_16x16x64_bf16 a[224:227], a[236:239], v[40:47], v2
 v_mfma_f32_16x16x32_bf16 v[28:31], a[124:127], a[44:47], 0
 v_exp_f32 v32, v32
 v_mfma_f32_16x16x32_bf16 v[28:31], a[120:123], a[40:43], v[28:31]
 v_exp_f32 v33, v33
 v_mfma_f32_16x16x32_bf16 v[28:31], a[116:119], a[36:39], v[28:31]
 v_mul_f32 v34, s32, v34
 v_mul_f32 v35, s32, v35
 v_mfma_f32_16x16x32_bf16 v[28:31], a[112:115], a[32:35], v[28:31]
 s_waitcnt lgkmcnt(8)
 v_exp_f32 v34, v34
 v_mfma_f32_16x16x32_bf16 v[80:83], a[176:179], v[40:43], v[80:83]
 v_exp_f32 v35, v35
 v_mfma_f32_16x16x32_bf16 v[80:83], a[208:211], v[44:47], v[80:83]
 ds_read_b128 v[56:59], v6 offset:15232
 v_mfma_f32_16x16x32_bf16 v[84:87], a[180:183], v[40:43], v[84:87]
 v_mul_f32 v36, s32, v36
 v_mul_f32 v37, s32, v37
 v_mfma_f32_16x16x32_bf16 v[84:87], a[212:215], v[44:47], v[84:87]
 s_waitcnt lgkmcnt(1)
 v_cvt_pk_bf16_f32 v52, v32, v33
 v_cvt_pk_bf16_f32 v53, v34, v35
 v_mfma_f32_16x16x32_bf16 v[88:91], a[184:187], v[40:43], v[88:91]
 v_exp_f32 v36, v36
 v_mfma_f32_16x16x32_bf16 v[88:91], a[216:219], v[44:47], v[88:91]
 v_exp_f32 v37, v37
 v_mfma_f32_16x16x32_bf16 v[92:95], a[188:191], v[40:43], v[92:95]
 v_mul_f32 v38, s32, v38
 v_mul_f32 v39, s32, v39
 v_mfma_f32_16x16x32_bf16 v[92:95], a[220:223], v[44:47], v[92:95]
 v_exp_f32 v38, v38
 v_mfma_f32_16x16x32_bf16 v[32:35], a[128:131], a[32:35], 0
 v_exp_f32 v39, v39
 v_mfma_f32_16x16x32_bf16 v[32:35], a[132:135], a[36:39], v[32:35]
 v_cvt_pk_bf16_f32 v54, v36, v37
 v_cvt_pk_bf16_f32 v55, v38, v39
 v_mfma_f32_16x16x32_bf16 v[32:35], a[136:139], a[40:43], v[32:35]
 s_mov_b32 s38, 14336
 v_mul_f32 v24, s32, v24
 v_mul_f32 v25, s32, v25
 v_mfma_f32_16x16x32_bf16 v[32:35], a[140:143], a[44:47], v[32:35]
 s_waitcnt lgkmcnt(0)
 buffer_store_dwordx4 v[56:59], v1, s[24:27], s38 offen sc1 nt
 v_mfma_f32_16x16x32_bf16 v[36:39], a[156:159], a[44:47], 0
 v_exp_f32 v24, v24
 v_mfma_f32_16x16x32_bf16 v[36:39], a[152:155], a[40:43], v[36:39]
 v_exp_f32 v25, v25
 v_mfma_f32_16x16x32_bf16 v[36:39], a[148:151], a[36:39], v[36:39]
 v_mul_f32 v26, s32, v26
 v_mul_f32 v27, s32, v27
 v_mfma_f32_16x16x32_bf16 v[36:39], a[144:147], a[32:35], v[36:39]
 v_exp_f32 v26, v26
 v_mfma_f32_16x16x32_bf16 v[96:99], a[160:163], v[48:51], v[96:99]
 v_exp_f32 v27, v27
 v_mfma_f32_16x16x32_bf16 v[96:99], a[192:195], v[52:55], v[96:99]
 v_mul_f32 v28, s32, v28
 v_mul_f32 v29, s32, v29
 v_mfma_f32_16x16x32_bf16 v[100:103], a[164:167], v[48:51], v[100:103]
 v_cvt_pk_bf16_f32 v40, v24, v25
 v_cvt_pk_bf16_f32 v41, v26, v27
 v_mfma_f32_16x16x32_bf16 v[100:103], a[196:199], v[52:55], v[100:103]
 v_exp_f32 v28, v28
 v_mfma_f32_16x16x32_bf16 v[104:107], a[168:171], v[48:51], v[104:107]
 v_exp_f32 v29, v29
 v_mfma_f32_16x16x32_bf16 v[104:107], a[200:203], v[52:55], v[104:107]
 v_mul_f32 v30, s32, v30
 v_mul_f32 v31, s32, v31
 v_mfma_f32_16x16x32_bf16 v[108:111], a[172:175], v[48:51], v[108:111]
 v_exp_f32 v30, v30
 v_mfma_f32_16x16x32_bf16 v[108:111], a[204:207], v[52:55], v[108:111]
 v_exp_f32 v31, v31
 v_mfma_f32_16x16x32_bf16 v[24:27], a[96:99], a[48:51], 0
 v_cvt_pk_bf16_f32 v42, v28, v29
 v_cvt_pk_bf16_f32 v43, v30, v31
 v_mfma_f32_16x16x32_bf16 v[24:27], a[100:103], a[52:55], v[24:27]
 v_mul_f32 v32, s32, v32
 v_mul_f32 v33, s32, v33
 v_mfma_f32_16x16x32_bf16 v[24:27], a[104:107], a[56:59], v[24:27]
 ds_read_b128 v[60:63], v6 offset:16320
 v_mfma_f32_16x16x32_bf16 v[24:27], a[108:111], a[60:63], v[24:27]
 v_exp_f32 v32, v32
 v_smfmac_f32_16x16x64_bf16 a[224:227], a[240:243], v[48:55], v2
 v_mfma_f32_16x16x32_bf16 v[28:31], a[124:127], a[60:63], 0
 v_exp_f32 v33, v33
 v_mfma_f32_16x16x32_bf16 v[28:31], a[120:123], a[56:59], v[28:31]
 v_mul_f32 v34, s32, v34
 v_mul_f32 v35, s32, v35
 v_mfma_f32_16x16x32_bf16 v[28:31], a[116:119], a[52:55], v[28:31]
 v_exp_f32 v34, v34
 v_mfma_f32_16x16x32_bf16 v[28:31], a[112:115], a[48:51], v[28:31]
 v_exp_f32 v35, v35
 v_mfma_f32_16x16x32_bf16 v[112:115], a[176:179], v[48:51], v[112:115]
 v_mul_f32 v36, s32, v36
 v_mul_f32 v37, s32, v37
 v_mfma_f32_16x16x32_bf16 v[112:115], a[208:211], v[52:55], v[112:115]
 v_cvt_pk_bf16_f32 v44, v32, v33
 v_cvt_pk_bf16_f32 v45, v34, v35
 v_mfma_f32_16x16x32_bf16 v[116:119], a[180:183], v[48:51], v[116:119]
 s_mov_b32 s38, 15360
 v_exp_f32 v36, v36
 v_mfma_f32_16x16x32_bf16 v[116:119], a[212:215], v[52:55], v[116:119]
 s_waitcnt lgkmcnt(0)
 buffer_store_dwordx4 v[60:63], v1, s[24:27], s38 offen sc1 nt
 v_mfma_f32_16x16x32_bf16 v[120:123], a[184:187], v[48:51], v[120:123]
 v_exp_f32 v37, v37
 v_mfma_f32_16x16x32_bf16 v[120:123], a[216:219], v[52:55], v[120:123]
 v_mul_f32 v38, s32, v38
 v_mul_f32 v39, s32, v39
 v_mfma_f32_16x16x32_bf16 v[124:127], a[188:191], v[48:51], v[124:127]
 v_exp_f32 v38, v38
 v_mfma_f32_16x16x32_bf16 v[124:127], a[220:223], v[52:55], v[124:127]
 v_exp_f32 v39, v39
 v_mfma_f32_16x16x32_bf16 v[32:35], a[128:131], a[48:51], 0
 v_cvt_pk_bf16_f32 v46, v36, v37
 v_cvt_pk_bf16_f32 v47, v38, v39
 v_mfma_f32_16x16x32_bf16 v[32:35], a[132:135], a[52:55], v[32:35]
 v_mul_f32 v24, s32, v24
 v_mul_f32 v25, s32, v25
 v_mfma_f32_16x16x32_bf16 v[32:35], a[136:139], a[56:59], v[32:35]
 v_exp_f32 v24, v24
 v_mfma_f32_16x16x32_bf16 v[32:35], a[140:143], a[60:63], v[32:35]
 v_exp_f32 v25, v25
 v_mfma_f32_16x16x32_bf16 v[36:39], a[156:159], a[60:63], 0
 v_mul_f32 v26, s32, v26
 v_mul_f32 v27, s32, v27
 v_mfma_f32_16x16x32_bf16 v[36:39], a[152:155], a[56:59], v[36:39]
 ds_read_b128 v[56:59], v6 offset:0
 v_mfma_f32_16x16x32_bf16 v[36:39], a[148:151], a[52:55], v[36:39]
 v_exp_f32 v26, v26
 v_mfma_f32_16x16x32_bf16 v[36:39], a[144:147], a[48:51], v[36:39]
 v_exp_f32 v27, v27
 v_mfma_f32_16x16x32_bf16 v[128:131], a[160:163], v[40:43], v[128:131]
 v_mul_f32 v28, s32, v28
 v_mul_f32 v29, s32, v29
 v_mfma_f32_16x16x32_bf16 v[128:131], a[192:195], v[44:47], v[128:131]
 v_cvt_pk_bf16_f32 v48, v24, v25
 v_cvt_pk_bf16_f32 v49, v26, v27
 v_mfma_f32_16x16x32_bf16 v[132:135], a[164:167], v[40:43], v[132:135]
 v_exp_f32 v28, v28
 v_mfma_f32_16x16x32_bf16 v[132:135], a[196:199], v[44:47], v[132:135]
 v_exp_f32 v29, v29
 v_mfma_f32_16x16x32_bf16 v[136:139], a[168:171], v[40:43], v[136:139]
 v_mul_f32 v30, s32, v30
 v_mul_f32 v31, s32, v31
 v_mfma_f32_16x16x32_bf16 v[136:139], a[200:203], v[44:47], v[136:139]
 v_exp_f32 v30, v30
 v_mfma_f32_16x16x32_bf16 v[140:143], a[172:175], v[40:43], v[140:143]
 s_mov_b32 s38, 16384
 v_exp_f32 v31, v31
 v_mfma_f32_16x16x32_bf16 v[140:143], a[204:207], v[44:47], v[140:143]
 s_waitcnt lgkmcnt(0)
 buffer_store_dwordx4 v[56:59], v1, s[24:27], s38 offen sc1 nt
 v_mfma_f32_16x16x32_bf16 v[24:27], a[96:99], a[64:67], 0
 v_cvt_pk_bf16_f32 v50, v28, v29
 v_cvt_pk_bf16_f32 v51, v30, v31
 v_mfma_f32_16x16x32_bf16 v[24:27], a[100:103], a[68:71], v[24:27]
 v_mul_f32 v32, s32, v32
 v_mul_f32 v33, s32, v33
 v_mfma_f32_16x16x32_bf16 v[24:27], a[104:107], a[72:75], v[24:27]
 v_exp_f32 v32, v32
 v_mfma_f32_16x16x32_bf16 v[24:27], a[108:111], a[76:79], v[24:27]
 v_exp_f32 v33, v33
 v_smfmac_f32_16x16x64_bf16 a[228:231], a[236:239], v[40:47], v2
 v_mfma_f32_16x16x32_bf16 v[28:31], a[124:127], a[76:79], 0
 v_mul_f32 v34, s32, v34
 v_mul_f32 v35, s32, v35
 v_mfma_f32_16x16x32_bf16 v[28:31], a[120:123], a[72:75], v[28:31]
 v_exp_f32 v34, v34
 v_mfma_f32_16x16x32_bf16 v[28:31], a[116:119], a[68:71], v[28:31]
 v_exp_f32 v35, v35
 v_mfma_f32_16x16x32_bf16 v[28:31], a[112:115], a[64:67], v[28:31]
 v_mul_f32 v36, s32, v36
 v_mul_f32 v37, s32, v37
 v_mfma_f32_16x16x32_bf16 v[144:147], a[176:179], v[40:43], v[144:147]
 v_cvt_pk_bf16_f32 v52, v32, v33
 v_cvt_pk_bf16_f32 v53, v34, v35
 v_mfma_f32_16x16x32_bf16 v[144:147], a[208:211], v[44:47], v[144:147]
 ds_read_b128 v[60:63], v6 offset:1088
 v_exp_f32 v36, v36
 v_mfma_f32_16x16x32_bf16 v[148:151], a[180:183], v[40:43], v[148:151]
 v_exp_f32 v37, v37
 v_mfma_f32_16x16x32_bf16 v[148:151], a[212:215], v[44:47], v[148:151]
 v_mul_f32 v38, s32, v38
 v_mul_f32 v39, s32, v39
 v_mfma_f32_16x16x32_bf16 v[152:155], a[184:187], v[40:43], v[152:155]
 v_exp_f32 v38, v38
 v_mfma_f32_16x16x32_bf16 v[152:155], a[216:219], v[44:47], v[152:155]
 v_exp_f32 v39, v39
 v_mfma_f32_16x16x32_bf16 v[156:159], a[188:191], v[40:43], v[156:159]
 v_cvt_pk_bf16_f32 v54, v36, v37
 v_cvt_pk_bf16_f32 v55, v38, v39
 v_mfma_f32_16x16x32_bf16 v[156:159], a[220:223], v[44:47], v[156:159]
 v_mul_f32 v24, s32, v24
 v_mul_f32 v25, s32, v25
 v_mfma_f32_16x16x32_bf16 v[32:35], a[128:131], a[64:67], 0
 v_exp_f32 v24, v24
 v_mfma_f32_16x16x32_bf16 v[32:35], a[132:135], a[68:71], v[32:35]
 v_exp_f32 v25, v25
 v_mfma_f32_16x16x32_bf16 v[32:35], a[136:139], a[72:75], v[32:35]
 s_mov_b32 s38, 17408
 v_mul_f32 v26, s32, v26
 v_mul_f32 v27, s32, v27
 v_mfma_f32_16x16x32_bf16 v[32:35], a[140:143], a[76:79], v[32:35]
 s_waitcnt lgkmcnt(0)
 buffer_store_dwordx4 v[60:63], v1, s[24:27], s38 offen sc1 nt
 v_mfma_f32_16x16x32_bf16 v[36:39], a[156:159], a[76:79], 0
 v_exp_f32 v26, v26
 v_mfma_f32_16x16x32_bf16 v[36:39], a[152:155], a[72:75], v[36:39]
 v_exp_f32 v27, v27
 v_mfma_f32_16x16x32_bf16 v[36:39], a[148:151], a[68:71], v[36:39]
 v_mul_f32 v28, s32, v28
 v_mul_f32 v29, s32, v29
 v_mfma_f32_16x16x32_bf16 v[36:39], a[144:147], a[64:67], v[36:39]
 v_cvt_pk_bf16_f32 v40, v24, v25
 v_cvt_pk_bf16_f32 v41, v26, v27
 v_mfma_f32_16x16x32_bf16 v[160:163], a[160:163], v[48:51], v[160:163]
 v_exp_f32 v28, v28
 v_mfma_f32_16x16x32_bf16 v[160:163], a[192:195], v[52:55], v[160:163]
 v_exp_f32 v29, v29
 v_mfma_f32_16x16x32_bf16 v[164:167], a[164:167], v[48:51], v[164:167]
 ds_read_b128 v[56:59], v6 offset:2176
 v_mul_f32 v30, s32, v30
 v_mfma_f32_16x16x32_bf16 v[164:167], a[196:199], v[52:55], v[164:167]
 v_mul_f32 v31, s32, v31
 v_exp_f32 v30, v30
 v_mfma_f32_16x16x32_bf16 v[168:171], a[168:171], v[48:51], v[168:171]
 v_exp_f32 v31, v31
 v_mfma_f32_16x16x32_bf16 v[168:171], a[200:203], v[52:55], v[168:171]
 v_cvt_pk_bf16_f32 v42, v28, v29
 v_cvt_pk_bf16_f32 v43, v30, v31
 v_mfma_f32_16x16x32_bf16 v[172:175], a[172:175], v[48:51], v[172:175]
 v_mul_f32 v32, s32, v32
 v_mul_f32 v33, s32, v33
 v_mfma_f32_16x16x32_bf16 v[172:175], a[204:207], v[52:55], v[172:175]
 v_exp_f32 v32, v32
 v_mfma_f32_16x16x32_bf16 v[24:27], a[96:99], a[80:83], 0
 v_exp_f32 v33, v33
 v_mfma_f32_16x16x32_bf16 v[24:27], a[100:103], a[84:87], v[24:27]
 v_mul_f32 v34, s32, v34
 v_mul_f32 v35, s32, v35
 v_mfma_f32_16x16x32_bf16 v[24:27], a[104:107], a[88:91], v[24:27]
 v_exp_f32 v34, v34
 v_mfma_f32_16x16x32_bf16 v[24:27], a[108:111], a[92:95], v[24:27]
 s_mov_b32 s38, 18432
 v_exp_f32 v35, v35
 v_smfmac_f32_16x16x64_bf16 a[228:231], a[240:243], v[48:55], v2
 s_waitcnt lgkmcnt(0)
 buffer_store_dwordx4 v[56:59], v1, s[24:27], s38 offen sc1 nt
 v_mfma_f32_16x16x32_bf16 v[28:31], a[124:127], a[92:95], 0
 v_mul_f32 v36, s32, v36
 v_mul_f32 v37, s32, v37
 v_mfma_f32_16x16x32_bf16 v[28:31], a[120:123], a[88:91], v[28:31]
 v_cvt_pk_bf16_f32 v44, v32, v33
 v_cvt_pk_bf16_f32 v45, v34, v35
 v_mfma_f32_16x16x32_bf16 v[28:31], a[116:119], a[84:87], v[28:31]
 v_exp_f32 v36, v36
 v_mfma_f32_16x16x32_bf16 v[28:31], a[112:115], a[80:83], v[28:31]
 s_waitcnt vmcnt(7)
 s_barrier
 v_mfma_f32_16x16x32_bf16 v[176:179], a[176:179], v[48:51], v[176:179]
 v_exp_f32 v37, v37
 v_mfma_f32_16x16x32_bf16 v[176:179], a[208:211], v[52:55], v[176:179]
 v_mul_f32 v38, s32, v38
 v_mul_f32 v39, s32, v39
 v_mfma_f32_16x16x32_bf16 v[180:183], a[180:183], v[48:51], v[180:183]
 ds_read_b128 a[96:99], v7 offset:33792
 ds_read_b128 a[100:103], v7 offset:33856
 v_mfma_f32_16x16x32_bf16 v[180:183], a[212:215], v[52:55], v[180:183]
 v_exp_f32 v38, v38
 v_mfma_f32_16x16x32_bf16 v[184:187], a[184:187], v[48:51], v[184:187]
 v_exp_f32 v39, v39
 v_mfma_f32_16x16x32_bf16 v[184:187], a[216:219], v[52:55], v[184:187]
 ds_read_b128 v[60:63], v6 offset:3264
 v_cvt_pk_bf16_f32 v46, v36, v37
 v_mfma_f32_16x16x32_bf16 v[188:191], a[188:191], v[48:51], v[188:191]
 ds_read_b128 a[104:107], v7 offset:33920
 ds_read_b128 a[108:111], v7 offset:33984
 v_mfma_f32_16x16x32_bf16 v[188:191], a[220:223], v[52:55], v[188:191]
 v_cvt_pk_bf16_f32 v47, v38, v39
 v_mul_f32 v24, s32, v24
 v_mul_f32 v25, s32, v25
 v_mfma_f32_16x16x32_bf16 v[32:35], a[128:131], a[80:83], 0
L_pg1_12:
 s_cbranch_execz L_main1
 v_exp_f32 v24, v24
 v_mfma_f32_16x16x32_bf16 v[32:35], a[132:135], a[84:87], v[32:35]
 v_exp_f32 v25, v25
 v_mfma_f32_16x16x32_bf16 v[32:35], a[136:139], a[88:91], v[32:35]
 ds_read_b128 a[124:127], v7 offset:34496
 ds_read_b128 a[120:123], v7 offset:34432
 v_mfma_f32_16x16x32_bf16 v[32:35], a[140:143], a[92:95], v[32:35]
 v_mul_f32 v26, s32, v26
 v_mul_f32 v27, s32, v27
 v_mfma_f32_16x16x32_bf16 v[36:39], a[156:159], a[92:95], 0
 v_exp_f32 v26, v26
 v_mfma_f32_16x16x32_bf16 v[36:39], a[152:155], a[88:91], v[36:39]
 v_exp_f32 v27, v27
 v_mfma_f32_16x16x32_bf16 v[36:39], a[148:151], a[84:87], v[36:39]
 s_mov_b32 s38, 19456
 ds_read_b128 a[116:119], v7 offset:34368
 ds_read_b128 a[112:115], v7 offset:34304
 v_mfma_f32_16x16x32_bf16 v[36:39], a[144:147], a[80:83], v[36:39]
 s_waitcnt lgkmcnt(6)
 buffer_store_dwordx4 v[60:63], v1, s[24:27], s38 offen sc1 nt
 v_mfma_f32_16x16x32_bf16 v[192:195], a[160:163], v[40:43], v[192:195]
 v_mul_f32 v28, s32, v28
 v_mul_f32 v29, s32, v29
 v_mfma_f32_16x16x32_bf16 v[192:195], a[192:195], v[44:47], v[192:195]
 v_cvt_pk_bf16_f32 v48, v24, v25
 v_cvt_pk_bf16_f32 v49, v26, v27
 v_mfma_f32_16x16x32_bf16 v[196:199], a[164:167], v[40:43], v[196:199]
 v_exp_f32 v28, v28
 v_mfma_f32_16x16x32_bf16 v[196:199], a[196:199], v[44:47], v[196:199]
 ds_read_b128 a[128:131], v7 offset:50688
 ds_read_b128 a[132:135], v7 offset:50752
 v_mfma_f32_16x16x32_bf16 v[200:203], a[168:171], v[40:43], v[200:203]
 v_exp_f32 v29, v29
 v_mfma_f32_16x16x32_bf16 v[200:203], a[200:203], v[44:47], v[200:203]
 v_mul_f32 v30, s32, v30
 v_mul_f32 v31, s32, v31
 v_mfma_f32_16x16x32_bf16 v[204:207], a[172:175], v[40:43], v[204:207]
 v_exp_f32 v30, v30
 v_mfma_f32_16x16x32_bf16 v[204:207], a[204:207], v[44:47], v[204:207]
 s_waitcnt lgkmcnt(6)
 ds_read_b128 a[136:139], v7 offset:50816
 ds_read_b128 a[140:143], v7 offset:50880
 v_mfma_f32_16x16x32_bf16 v[24:27], a[96:99], a[0:3], 0
 v_exp_f32 v31, v31
 v_mfma_f32_16x16x32_bf16 v[24:27], a[100:103], a[4:7], v[24:27]
 v_cvt_pk_bf16_f32 v50, v28, v29
 v_cvt_pk_bf16_f32 v51, v30, v31
 v_mfma_f32_16x16x32_bf16 v[24:27], a[104:107], a[8:11], v[24:27]
 ds_read_b128 v[56:59], v6 offset:19584
 v_mul_f32 v32, s32, v32
 v_mfma_f32_16x16x32_bf16 v[24:27], a[108:111], a[12:15], v[24:27]
 s_waitcnt lgkmcnt(5)
 ds_read_b128 a[156:159], v7 offset:51392
 ds_read_b128 a[152:155], v7 offset:51328
 v_mul_f32 v33, s32, v33
 v_smfmac_f32_16x16x64_bf16 a[232:235], a[236:239], v[40:47], v2
 v_exp_f32 v32, v32
 v_mfma_f32_16x16x32_bf16 v[28:31], a[124:127], a[12:15], 0
 v_exp_f32 v33, v33
 v_mfma_f32_16x16x32_bf16 v[28:31], a[120:123], a[8:11], v[28:31]
 v_mul_f32 v34, s32, v34
 v_mul_f32 v35, s32, v35
 v_mfma_f32_16x16x32_bf16 v[28:31], a[116:119], a[4:7], v[28:31]
 ds_read_b128 a[148:151], v7 offset:51264
 ds_read_b128 a[144:147], v7 offset:51200
 v_mfma_f32_16x16x32_bf16 v[28:31], a[112:115], a[0:3], v[28:31]
 v_exp_f32 v34, v34
 v_mfma_f32_16x16x32_bf16 v[208:211], a[176:179], v[40:43], v[208:211]
 v_exp_f32 v35, v35
 v_mfma_f32_16x16x32_bf16 v[208:211], a[208:211], v[44:47], v[208:211]
 v_mul_f32 v36, s32, v36
 v_mul_f32 v37, s32, v37
 v_mfma_f32_16x16x32_bf16 v[212:215], a[180:183], v[40:43], v[212:215]
 s_mov_b32 s38, 20480
 v_cvt_pk_bf16_f32 v52, v32, v33
 v_cvt_pk_bf16_f32 v53, v34, v35
 v_mfma_f32_16x16x32_bf16 v[212:215], a[212:215], v[44:47], v[212:215]
 s_waitcnt lgkmcnt(4)
 buffer_store_dwordx4 v[56:59], v1, s[24:27], s38 offen sc1 nt
 v_mfma_f32_16x16x32_bf16 v[216:219], a[184:187], v[40:43], v[216:219]
 v_exp_f32 v36, v36
 v_mfma_f32_16x16x32_bf16 v[216:219], a[216:219], v[44:47], v[216:219]
 v_exp_f32 v37, v37
 v_mfma_f32_16x16x32_bf16 v[220:223], a[188:191], v[40:43], v[220:223]
 v_mul_f32 v38, s32, v38
 v_mul_f32 v39, s32, v39
 v_mfma_f32_16x16x32_bf16 v[220:223], a[220:223], v[44:47], v[220:223]
 s_waitcnt lgkmcnt(5)
 v_exp_f32 v38, v38
 v_mfma_f32_16x16x32_bf16 v[32:35], a[128:131], a[0:3], 0
 v_exp_f32 v39, v39
 v_mfma_f32_16x16x32_bf16 v[32:35], a[132:135], a[4:7], v[32:35]
 v_cvt_pk_bf16_f32 v54, v36, v37
 v_cvt_pk_bf16_f32 v55, v38, v39
 v_mfma_f32_16x16x32_bf16 v[32:35], a[136:139], a[8:11], v[32:35]
 v_mul_f32 v24, s32, v24
 v_mul_f32 v25, s32, v25
 v_mfma_f32_16x16x32_bf16 v[32:35], a[140:143], a[12:15], v[32:35]
 s_waitcnt lgkmcnt(0)
 ds_read_b128 v[60:63], v6 offset:20672
 v_exp_f32 v24, v24
 v_mfma_f32_16x16x32_bf16 v[36:39], a[156:159], a[12:15], 0
 v_exp_f32 v25, v25
 v_mfma_f32_16x16x32_bf16 v[36:39], a[152:155], a[8:11], v[36:39]
 v_mul_f32 v26, s32, v26
 v_mul_f32 v27, s32, v27
 v_mfma_f32_16x16x32_bf16 v[36:39], a[148:151], a[4:7], v[36:39]
 v_exp_f32 v26, v26
 v_mfma_f32_16x16x32_bf16 v[36:39], a[144:147], a[0:3], v[36:39]
 v_exp_f32 v27, v27
 v_mul_f32 v28, s32, v28
 v_mfma_f32_16x16x32_bf16 v[224:227], a[160:163], v[48:51], v[224:227]
 v_mul_f32 v29, s32, v29
 v_cvt_pk_bf16_f32 v40, v24, v25
 v_mfma_f32_16x16x32_bf16 v[224:227], a[192:195], v[52:55], v[224:227]
 v_cvt_pk_bf16_f32 v41, v26, v27
 v_exp_f32 v28, v28
 v_mfma_f32_16x16x32_bf16 v[228:231], a[164:167], v[48:51], v[228:231]
 ds_read_b64_tr_b16 a[160:161], v8 offset:33792
 ds_read_b64_tr_b16 a[162:163], v8 offset:34304
 v_mfma_f32_16x16x32_bf16 v[228:231], a[196:199], v[52:55], v[228:231]
 v_exp_f32 v29, v29
 v_mul_f32 v30, s32, v30
 v_mul_f32 v31, s32, v31
 v_mfma_f32_16x16x32_bf16 v[232:235], a[168:171], v[48:51], v[232:235]
 s_mov_b32 s38, 21504
 ds_read_b64_tr_b16 a[192:193], v8 offset:50688
 ds_read_b64_tr_b16 a[194:195], v8 offset:51200
 v_mfma_f32_16x16x32_bf16 v[232:235], a[200:203], v[52:55], v[232:235]
 s_waitcnt lgkmcnt(4)
 buffer_store_dwordx4 v[60:63], v1, s[24:27], s38 offen sc1 nt
 v_mfma_f32_16x16x32_bf16 v[236:239], a[172:175], v[48:51], v[236:239]
 v_exp_f32 v30, v30
 v_mfma_f32_16x16x32_bf16 v[236:239], a[204:207], v[52:55], v[236:239]
 ds_read_b64_tr_b16 a[164:165], v8 offset:33824
 ds_read_b64_tr_b16 a[166:167], v8 offset:34336
 v_exp_f32 v31, v31
 v_mfma_f32_16x16x32_bf16 v[24:27], a[96:99], a[16:19], 0
 v_cvt_pk_bf16_f32 v42, v28, v29
 v_cvt_pk_bf16_f32 v43, v30, v31
 v_mfma_f32_16x16x32_bf16 v[24:27], a[100:103], a[20:23], v[24:27]
 ds_read_b64_tr_b16 a[196:197], v8 offset:50720
 ds_read_b64_tr_b16 a[198:199], v8 offset:51232
 v_mfma_f32_16x16x32_bf16 v[24:27], a[104:107], a[24:27], v[24:27]
 v_mul_f32 v32, s32, v32
 v_mul_f32 v33, s32, v33
 v_mfma_f32_16x16x32_bf16 v[24:27], a[108:111], a[28:31], v[24:27]
 ds_read_b64_tr_b16 a[168:169], v8 offset:33856
 ds_read_b64_tr_b16 a[170:171], v8 offset:34368
 v_exp_f32 v32, v32
 v_smfmac_f32_16x16x64_bf16 a[232:235], a[240:243], v[48:55], v2
 v_exp_f32 v33, v33
 v_mul_f32 v34, s32, v34
 v_mfma_f32_16x16x32_bf16 v[28:31], a[124:127], a[28:31], 0
 ds_read_b64_tr_b16 a[200:201], v8 offset:50752
 ds_read_b64_tr_b16 a[202:203], v8 offset:51264
 v_mfma_f32_16x16x32_bf16 v[28:31], a[120:123], a[24:27], v[28:31]
 ds_read_b128 v[56:59], v6 offset:21760
 v_mul_f32 v35, s32, v35
 v_mfma_f32_16x16x32_bf16 v[28:31], a[116:119], a[20:23], v[28:31]
 v_exp_f32 v34, v34
 v_mfma_f32_16x16x32_bf16 v[28:31], a[112:115], a[16:19], v[28:31]
 ds_read_b64_tr_b16 a[172:173], v8 offset:33888
 ds_read_b64_tr_b16 a[174:175], v8 offset:34400
 v_exp_f32 v35, v35
 v_mfma_f32_16x16x32_bf16 v[240:243], a[176:179], v[48:51], v[240:243]
 v_mul_f32 v36, s32, v36
 v_mul_f32 v37, s32, v37
 v_mfma_f32_16x16x32_bf16 v[240:243], a[208:211], v[52:55], v[240:243]
 ds_read_b64_tr_b16 a[204:205], v8 offset:50784
 ds_read_b64_tr_b16 a[206:207], v8 offset:51296
 v_cvt_pk_bf16_f32 v44, v32, v33
 v_cvt_pk_bf16_f32 v45, v34, v35
 v_mfma_f32_16x16x32_bf16 v[244:247], a[180:183], v[48:51], v[244:247]
 v_exp_f32 v36, v36
 v_mfma_f32_16x16x32_bf16 v[244:247], a[212:215], v[52:55], v[244:247]
 v_exp_f32 v37, v37
 v_mfma_f32_16x16x32_bf16 v[248:251], a[184:187], v[48:51], v[248:251]
 v_mul_f32 v38, s32, v38
 v_mul_f32 v39, s32, v39
 v_mfma_f32_16x16x32_bf16 v[248:251], a[216:219], v[52:55], v[248:251]
 ds_read_b64_tr_b16 a[176:177], v8 offset:33920
 ds_read_b64_tr_b16 a[178:179], v8 offset:34432
 v_exp_f32 v38, v38
 v_mfma_f32_16x16x32_bf16 v[252:255], a[188:191], v[48:51], v[252:255]
 s_mov_b32 s38, 22528
 v_exp_f32 v39, v39
 v_mfma_f32_16x16x32_bf16 v[252:255], a[220:223], v[52:55], v[252:255]
 s_waitcnt lgkmcnt(6)
 buffer_store_dwordx4 v[56:59], v1, s[24:27], s38 offen sc1 nt
 v_mfma_f32_16x16x32_bf16 v[32:35], a[128:131], a[16:19], 0
 ds_read_b64_tr_b16 a[208:209], v8 offset:50816
 ds_read_b64_tr_b16 a[210:211], v8 offset:51328
 v_mfma_f32_16x16x32_bf16 v[32:35], a[132:135], a[20:23], v[32:35]
 v_cvt_pk_bf16_f32 v46, v36, v37
 v_cvt_pk_bf16_f32 v47, v38, v39
 v_mfma_f32_16x16x32_bf16 v[32:35], a[136:139], a[24:27], v[32:35]
 v_mul_f32 v24, s32, v24
 v_mul_f32 v25, s32, v25
 v_mfma_f32_16x16x32_bf16 v[32:35], a[140:143], a[28:31], v[32:35]
 ds_read_b64_tr_b16 a[180:181], v8 offset:33952
 ds_read_b64_tr_b16 a[182:183], v8 offset:34464
 v_exp_f32 v24, v24
 v_mfma_f32_16x16x32_bf16 v[36:39], a[156:159], a[28:31], 0
 v_exp_f32 v25, v25
 v_mfma_f32_16x16x32_bf16 v[36:39], a[152:155], a[24:27], v[36:39]
 v_mul_f32 v26, s32, v26
 v_mul_f32 v27, s32, v27
 v_mfma_f32_16x16x32_bf16 v[36:39], a[148:151], a[20:23], v[36:39]
 ds_read_b64_tr_b16 a[212:213], v8 offset:50848
 ds_read_b64_tr_b16 a[214:215], v8 offset:51360
 v_mfma_f32_16x16x32_bf16 v[36:39], a[144:147], a[16:19], v[36:39]
 s_waitcnt lgkmcnt(15)
 v_exp_f32 v26, v26
 v_exp_f32 v27, v27
 v_mfma_f32_16x16x32_bf16 v[64:67], a[160:163], v[40:43], v[64:67]
 v_mul_f32 v28, s32, v28
 v_mul_f32 v29, s32, v29
 v_mfma_f32_16x16x32_bf16 v[64:67], a[192:195], v[44:47], v[64:67]
 ds_read_b64_tr_b16 a[184:185], v8 offset:33984
 ds_read_b64_tr_b16 a[186:187], v8 offset:34496
 v_cvt_pk_bf16_f32 v48, v24, v25
 v_mfma_f32_16x16x32_bf16 v[68:71], a[164:167], v[40:43], v[68:71]
 ds_read_b128 v[60:63], v6 offset:22848
 v_cvt_pk_bf16_f32 v49, v26, v27
 v_mfma_f32_16x16x32_bf16 v[68:71], a[196:199], v[44:47], v[68:71]
 s_waitcnt lgkmcnt(11)
 v_exp_f32 v28, v28
 v_exp_f32 v29, v29
 v_mfma_f32_16x16x32_bf16 v[72:75], a[168:171], v[40:43], v[72:75]
 ds_read_b64_tr_b16 a[216:217], v8 offset:50880
 ds_read_b64_tr_b16 a[218:219], v8 offset:51392
 v_mfma_f32_16x16x32_bf16 v[72:75], a[200:203], v[44:47], v[72:75]
 v_mul_f32 v30, s32, v30
 v_mul_f32 v31, s32, v31
 v_mfma_f32_16x16x32_bf16 v[76:79], a[172:175], v[40:43], v[76:79]
 v_exp_f32 v30, v30
 v_mfma_f32_16x16x32_bf16 v[76:79], a[204:207], v[44:47], v[76:79]
 ds_read_b64_tr_b16 a[188:189], v8 offset:34016
 ds_read_b64_tr_b16 a[190:191], v8 offset:34528
 v_mfma_f32_16x16x32_bf16 v[24:27], a[96:99], a[32:35], 0
 v_exp_f32 v31, v31
 v_mfma_f32_16x16x32_bf16 v[24:27], a[100:103], a[36:39], v[24:27]
 v_cvt_pk_bf16_f32 v50, v28, v29
 v_cvt_pk_bf16_f32 v51, v30, v31
 v_mfma_f32_16x16x32_bf16 v[24:27], a[104:107], a[40:43], v[24:27]
 s_mov_b32 s38, 23552
 ds_read_b64_tr_b16 a[220:221], v8 offset:50912
 ds_read_b64_tr_b16 a[222:223], v8 offset:51424
 v_mfma_f32_16x16x32_bf16 v[24:27], a[108:111], a[44:47], v[24:27]
 s_waitcnt lgkmcnt(6)
 buffer_store_dwordx4 v[60:63], v1, s[24:27], s38 offen sc1 nt
 v_smfmac_f32_16x16x64_bf16 a[224:227], a[236:239], v[40:47], v2
 v_mul_f32 v32, s32, v32
 v_mul_f32 v33, s32, v33
 v_mfma_f32_16x16x32_bf16 v[28:31], a[124:127], a[44:47], 0
 v_exp_f32 v32, v32
 v_mfma_f32_16x16x32_bf16 v[28:31], a[120:123], a[40:43], v[28:31]
 v_exp_f32 v33, v33
 v_mfma_f32_16x16x32_bf16 v[28:31], a[116:119], a[36:39], v[28:31]
 v_mul_f32 v34, s32, v34
 v_mul_f32 v35, s32, v35
 v_mfma_f32_16x16x32_bf16 v[28:31], a[112:115], a[32:35], v[28:31]
 s_waitcnt lgkmcnt(9)
 v_exp_f32 v34, v34
 v_mfma_f32_16x16x32_bf16 v[80:83], a[176:179], v[40:43], v[80:83]
 v_exp_f32 v35, v35
 v_mfma_f32_16x16x32_bf16 v[80:83], a[208:211], v[44:47], v[80:83]
 v_mul_f32 v36, s32, v36
 v_mul_f32 v37, s32, v37
 v_mfma_f32_16x16x32_bf16 v[84:87], a[180:183], v[40:43], v[84:87]
 v_cvt_pk_bf16_f32 v52, v32, v33
 v_cvt_pk_bf16_f32 v53, v34, v35
 v_mfma_f32_16x16x32_bf16 v[84:87], a[212:215], v[44:47], v[84:87]
 s_waitcnt lgkmcnt(0)
 v_exp_f32 v36, v36
 v_mfma_f32_16x16x32_bf16 v[88:91], a[184:187], v[40:43], v[88:91]
 v_exp_f32 v37, v37
 v_mfma_f32_16x16x32_bf16 v[88:91], a[216:219], v[44:47], v[88:91]
 v_mul_f32 v38, s32, v38
 v_mul_f32 v39, s32, v39
 v_mfma_f32_16x16x32_bf16 v[92:95], a[188:191], v[40:43], v[92:95]
 s_mul_i32 s38, s57, 98304
 v_exp_f32 v38, v38
 v_mfma_f32_16x16x32_bf16 v[92:95], a[220:223], v[44:47], v[92:95]
 s_mul_i32 s59, s3, 24576
 v_exp_f32 v39, v39
 v_mfma_f32_16x16x32_bf16 v[32:35], a[128:131], a[32:35], 0
 s_add_u32 s38, s38, s59
 v_cvt_pk_bf16_f32 v54, v36, v37
 v_cvt_pk_bf16_f32 v55, v38, v39
 v_mfma_f32_16x16x32_bf16 v[32:35], a[132:135], a[36:39], v[32:35]
 s_add_u32 s24, s10, s38
 s_addc_u32 s25, s11, 0
 v_mfma_f32_16x16x32_bf16 v[32:35], a[136:139], a[40:43], v[32:35]
 v_mul_f32 v24, s32, v24
 v_mul_f32 v25, s32, v25
 v_mfma_f32_16x16x32_bf16 v[32:35], a[140:143], a[44:47], v[32:35]
 v_accvgpr_read_b32 v11, a224
 v_accvgpr_read_b32 v10, a225
 v_add_f32 v11, v11, v10
 v_rcp_f32 v10, v11
 v_cmp_nle_f32 vcc, s60, v11
 v_pk_mul_f32 v[64:65], v[64:65], v[10:11] op_sel_hi:[1,0]
 v_pk_mul_f32 v[66:67], v[66:67], v[10:11] op_sel_hi:[1,0]
 v_pk_mul_f32 v[68:69], v[68:69], v[10:11] op_sel_hi:[1,0]
 v_pk_mul_f32 v[70:71], v[70:71], v[10:11] op_sel_hi:[1,0]
 v_pk_mul_f32 v[72:73], v[72:73], v[10:11] op_sel_hi:[1,0]
 v_pk_mul_f32 v[74:75], v[74:75], v[10:11] op_sel_hi:[1,0]
 v_pk_mul_f32 v[76:77], v[76:77], v[10:11] op_sel_hi:[1,0]
 v_pk_mul_f32 v[78:79], v[78:79], v[10:11] op_sel_hi:[1,0]
 v_pk_mul_f32 v[80:81], v[80:81], v[10:11] op_sel_hi:[1,0]
 v_pk_mul_f32 v[82:83], v[82:83], v[10:11] op_sel_hi:[1,0]
 v_pk_mul_f32 v[84:85], v[84:85], v[10:11] op_sel_hi:[1,0]
 v_pk_mul_f32 v[86:87], v[86:87], v[10:11] op_sel_hi:[1,0]
 v_pk_mul_f32 v[88:89], v[88:89], v[10:11] op_sel_hi:[1,0]
 v_pk_mul_f32 v[90:91], v[90:91], v[10:11] op_sel_hi:[1,0]
 v_pk_mul_f32 v[92:93], v[92:93], v[10:11] op_sel_hi:[1,0]
 v_pk_mul_f32 v[94:95], v[94:95], v[10:11] op_sel_hi:[1,0]
 v_mfma_f32_16x16x32_bf16 v[36:39], a[156:159], a[44:47], 0
 s_or_b64 s[50:51], s[50:51], vcc
 v_exp_f32 v24, v24
 v_mfma_f32_16x16x32_bf16 v[36:39], a[152:155], a[40:43], v[36:39]
 v_exp_f32 v25, v25
 v_mfma_f32_16x16x32_bf16 v[36:39], a[148:151], a[36:39], v[36:39]
 v_mul_f32 v26, s32, v26
 v_mul_f32 v27, s32, v27
 v_mfma_f32_16x16x32_bf16 v[36:39], a[144:147], a[32:35], v[36:39]
 v_exp_f32 v26, v26
 v_cmp_nge_f32 vcc, s61, v11
 v_add_u32 v12, 4352, v5
 v_cvt_pk_bf16_f32 v64, v64, v65
 v_cvt_pk_bf16_f32 v65, v66, v67
 v_cvt_pk_bf16_f32 v68, v68, v69
 v_cvt_pk_bf16_f32 v69, v70, v71
 v_mfma_f32_16x16x32_bf16 v[96:99], a[160:163], v[48:51], v[96:99]
 v_exp_f32 v27, v27
 v_mfma_f32_16x16x32_bf16 v[96:99], a[192:195], v[52:55], v[96:99]
 s_or_b64 s[50:51], s[50:51], vcc
 ds_write2_b64 v12, v[64:65], v[68:69] offset0:0 offset1:4
 v_mul_f32 v28, s32, v28
 v_mul_f32 v29, s32, v29
 v_cvt_pk_bf16_f32 v72, v72, v73
 v_cvt_pk_bf16_f32 v73, v74, v75
 v_cvt_pk_bf16_f32 v76, v76, v77
 v_cvt_pk_bf16_f32 v77, v78, v79
 v_mfma_f32_16x16x32_bf16 v[100:103], a[164:167], v[48:51], v[100:103]
 v_cvt_pk_bf16_f32 v40, v24, v25
 v_cvt_pk_bf16_f32 v41, v26, v27
 v_mfma_f32_16x16x32_bf16 v[100:103], a[196:199], v[52:55], v[100:103]
 ds_write2_b64 v12, v[72:73], v[76:77] offset0:8 offset1:12
 v_exp_f32 v28, v28
 v_cvt_pk_bf16_f32 v80, v80, v81
 v_cvt_pk_bf16_f32 v81, v82, v83
 v_cvt_pk_bf16_f32 v84, v84, v85
 v_cvt_pk_bf16_f32 v85, v86, v87
 v_mfma_f32_16x16x32_bf16 v[104:107], a[168:171], v[48:51], v[104:107]
 v_exp_f32 v29, v29
 v_mfma_f32_16x16x32_bf16 v[104:107], a[200:203], v[52:55], v[104:107]
 ds_write2_b64 v12, v[80:81], v[84:85] offset0:16 offset1:20
 v_mul_f32 v30, s32, v30
 v_mul_f32 v31, s32, v31
 v_cvt_pk_bf16_f32 v88, v88, v89
 v_cvt_pk_bf16_f32 v89, v90, v91
 v_cvt_pk_bf16_f32 v92, v92, v93
 v_cvt_pk_bf16_f32 v93, v94, v95
 v_mfma_f32_16x16x32_bf16 v[108:111], a[172:175], v[48:51], v[108:111]
 v_exp_f32 v30, v30
 v_mfma_f32_16x16x32_bf16 v[108:111], a[204:207], v[52:55], v[108:111]
 ds_write2_b64 v12, v[88:89], v[92:93] offset0:24 offset1:28
 ds_read_b128 v[64:67], v6 offset:4352
 ds_read_b128 v[68:71], v6 offset:5440
 ds_read_b128 v[72:75], v6 offset:6528
 ds_read_b128 v[76:79], v6 offset:7616
 v_exp_f32 v31, v31
 v_mfma_f32_16x16x32_bf16 v[24:27], a[96:99], a[48:51], 0
 v_cvt_pk_bf16_f32 v42, v28, v29
 v_cvt_pk_bf16_f32 v43, v30, v31
 v_mfma_f32_16x16x32_bf16 v[24:27], a[100:103], a[52:55], v[24:27]
 v_mul_f32 v32, s32, v32
 v_mul_f32 v33, s32, v33
 v_mfma_f32_16x16x32_bf16 v[24:27], a[104:107], a[56:59], v[24:27]
 v_exp_f32 v32, v32
 v_mfma_f32_16x16x32_bf16 v[24:27], a[108:111], a[60:63], v[24:27]
 v_exp_f32 v33, v33
 v_smfmac_f32_16x16x64_bf16 a[224:227], a[240:243], v[48:55], v2
 v_mfma_f32_16x16x32_bf16 v[28:31], a[124:127], a[60:63], 0
 v_mul_f32 v34, s32, v34
 v_mul_f32 v35, s32, v35
 v_mfma_f32_16x16x32_bf16 v[28:31], a[120:123], a[56:59], v[28:31]
 v_exp_f32 v34, v34
 v_mfma_f32_16x16x32_bf16 v[28:31], a[116:119], a[52:55], v[28:31]
 s_mov_b32 s59, 0
 v_exp_f32 v35, v35
 v_mfma_f32_16x16x32_bf16 v[28:31], a[112:115], a[48:51], v[28:31]
 s_waitcnt lgkmcnt(3)
 v_mul_f32 v36, s32, v36
 v_mul_f32 v37, s32, v37
 v_mfma_f32_16x16x32_bf16 v[112:115], a[176:179], v[48:51], v[112:115]
 v_cvt_pk_bf16_f32 v44, v32, v33
 v_cvt_pk_bf16_f32 v45, v34, v35
 v_mfma_f32_16x16x32_bf16 v[112:115], a[208:211], v[52:55], v[112:115]
 buffer_store_dwordx4 v[64:67], v1, s[24:27], s59 offen sc1 nt
 v_exp_f32 v36, v36
 v_mfma_f32_16x16x32_bf16 v[116:119], a[180:183], v[48:51], v[116:119]
 v_exp_f32 v37, v37
 v_mfma_f32_16x16x32_bf16 v[116:119], a[212:215], v[52:55], v[116:119]
 s_waitcnt lgkmcnt(2)
 buffer_store_dwordx4 v[68:71], v1, s[24:27], s59 offen offset:1024 sc1 nt
 v_mul_f32 v38, s32, v38
 v_mul_f32 v39, s32, v39
 v_mfma_f32_16x16x32_bf16 v[120:123], a[184:187], v[48:51], v[120:123]
 v_exp_f32 v38, v38
 v_mfma_f32_16x16x32_bf16 v[120:123], a[216:219], v[52:55], v[120:123]
 s_waitcnt lgkmcnt(1)
 v_exp_f32 v39, v39
 v_mfma_f32_16x16x32_bf16 v[124:127], a[188:191], v[48:51], v[124:127]
 buffer_store_dwordx4 v[72:75], v1, s[24:27], s59 offen offset:2048 sc1 nt
 v_mfma_f32_16x16x32_bf16 v[124:127], a[220:223], v[52:55], v[124:127]
 s_waitcnt lgkmcnt(0)
 buffer_store_dwordx4 v[76:79], v1, s[24:27], s59 offen offset:3072 sc1 nt
 v_cvt_pk_bf16_f32 v46, v36, v37
 v_cvt_pk_bf16_f32 v47, v38, v39
 v_mfma_f32_16x16x32_bf16 v[32:35], a[128:131], a[48:51], 0
 v_mul_f32 v24, s32, v24
 v_mul_f32 v25, s32, v25
 v_mfma_f32_16x16x32_bf16 v[32:35], a[132:135], a[52:55], v[32:35]
 v_exp_f32 v24, v24
 v_mfma_f32_16x16x32_bf16 v[32:35], a[136:139], a[56:59], v[32:35]
 v_exp_f32 v25, v25
 v_mfma_f32_16x16x32_bf16 v[32:35], a[140:143], a[60:63], v[32:35]
 v_accvgpr_read_b32 v11, a226
 v_accvgpr_read_b32 v10, a227
 v_add_f32 v11, v11, v10
 v_rcp_f32 v10, v11
 v_cmp_nle_f32 vcc, s60, v11
 v_pk_mul_f32 v[96:97], v[96:97], v[10:11] op_sel_hi:[1,0]
 v_pk_mul_f32 v[98:99], v[98:99], v[10:11] op_sel_hi:[1,0]
 v_pk_mul_f32 v[100:101], v[100:101], v[10:11] op_sel_hi:[1,0]
 v_pk_mul_f32 v[102:103], v[102:103], v[10:11] op_sel_hi:[1,0]
 v_pk_mul_f32 v[104:105], v[104:105], v[10:11] op_sel_hi:[1,0]
 v_pk_mul_f32 v[106:107], v[106:107], v[10:11] op_sel_hi:[1,0]
 v_pk_mul_f32 v[108:109], v[108:109], v[10:11] op_sel_hi:[1,0]
 v_pk_mul_f32 v[110:111], v[110:111], v[10:11] op_sel_hi:[1,0]
 v_pk_mul_f32 v[112:113], v[112:113], v[10:11] op_sel_hi:[1,0]
 v_pk_mul_f32 v[114:115], v[114:115], v[10:11] op_sel_hi:[1,0]
 v_pk_mul_f32 v[116:117], v[116:117], v[10:11] op_sel_hi:[1,0]
 v_pk_mul_f32 v[118:119], v[118:119], v[10:11] op_sel_hi:[1,0]
 v_pk_mul_f32 v[120:121], v[120:121], v[10:11] op_sel_hi:[1,0]
 v_pk_mul_f32 v[122:123], v[122:123], v[10:11] op_sel_hi:[1,0]
 v_pk_mul_f32 v[124:125], v[124:125], v[10:11] op_sel_hi:[1,0]
 v_pk_mul_f32 v[126:127], v[126:127], v[10:11] op_sel_hi:[1,0]
 v_mfma_f32_16x16x32_bf16 v[36:39], a[156:159], a[60:63], 0
 s_or_b64 s[50:51], s[50:51], vcc
 v_mul_f32 v26, s32, v26
 v_mul_f32 v27, s32, v27
 v_mfma_f32_16x16x32_bf16 v[36:39], a[152:155], a[56:59], v[36:39]
 v_exp_f32 v26, v26
 v_mfma_f32_16x16x32_bf16 v[36:39], a[148:151], a[52:55], v[36:39]
 v_exp_f32 v27, v27
 v_mfma_f32_16x16x32_bf16 v[36:39], a[144:147], a[48:51], v[36:39]
 v_mul_f32 v28, s32, v28
 v_mul_f32 v29, s32, v29
 v_cmp_nge_f32 vcc, s61, v11
 v_add_u32 v12, 8704, v5
 v_cvt_pk_bf16_f32 v96, v96, v97
 v_cvt_pk_bf16_f32 v97, v98, v99
 v_cvt_pk_bf16_f32 v100, v100, v101
 v_cvt_pk_bf16_f32 v101, v102, v103
 v_mfma_f32_16x16x32_bf16 v[128:131], a[160:163], v[40:43], v[128:131]
 v_cvt_pk_bf16_f32 v48, v24, v25
 v_cvt_pk_bf16_f32 v49, v26, v27
 v_mfma_f32_16x16x32_bf16 v[128:131], a[192:195], v[44:47], v[128:131]
 s_or_b64 s[50:51], s[50:51], vcc
 ds_write2_b64 v12, v[96:97], v[100:101] offset0:0 offset1:4
 v_exp_f32 v28, v28
 v_cvt_pk_bf16_f32 v104, v104, v105
 v_cvt_pk_bf16_f32 v105, v106, v107
 v_cvt_pk_bf16_f32 v108, v108, v109
 v_cvt_pk_bf16_f32 v109, v110, v111
 v_mfma_f32_16x16x32_bf16 v[132:135], a[164:167], v[40:43], v[132:135]
 v_exp_f32 v29, v29
 v_mfma_f32_16x16x32_bf16 v[132:135], a[196:199], v[44:47], v[132:135]
 ds_write2_b64 v12, v[104:105], v[108:109] offset0:8 offset1:12
 v_cvt_pk_bf16_f32 v112, v112, v113
 v_cvt_pk_bf16_f32 v113, v114, v115
 v_cvt_pk_bf16_f32 v116, v116, v117
 v_cvt_pk_bf16_f32 v117, v118, v119
 v_mfma_f32_16x16x32_bf16 v[136:139], a[168:171], v[40:43], v[136:139]
 v_mul_f32 v30, s32, v30
 v_mul_f32 v31, s32, v31
 v_mfma_f32_16x16x32_bf16 v[136:139], a[200:203], v[44:47], v[136:139]
 ds_write2_b64 v12, v[112:113], v[116:117] offset0:16 offset1:20
 v_exp_f32 v30, v30
 v_cvt_pk_bf16_f32 v120, v120, v121
 v_cvt_pk_bf16_f32 v121, v122, v123
 v_cvt_pk_bf16_f32 v124, v124, v125
 v_cvt_pk_bf16_f32 v125, v126, v127
 v_mfma_f32_16x16x32_bf16 v[140:143], a[172:175], v[40:43], v[140:143]
 v_exp_f32 v31, v31
 v_mfma_f32_16x16x32_bf16 v[140:143], a[204:207], v[44:47], v[140:143]
 ds_write2_b64 v12, v[120:121], v[124:125] offset0:24 offset1:28
 ds_read_b128 v[96:99], v6 offset:8704
 ds_read_b128 v[100:103], v6 offset:9792
 ds_read_b128 v[104:107], v6 offset:10880
 ds_read_b128 v[108:111], v6 offset:11968
 v_cvt_pk_bf16_f32 v50, v28, v29
 v_cvt_pk_bf16_f32 v51, v30, v31
 v_mfma_f32_16x16x32_bf16 v[24:27], a[96:99], a[64:67], 0
 v_mul_f32 v32, s32, v32
 v_mul_f32 v33, s32, v33
 v_mfma_f32_16x16x32_bf16 v[24:27], a[100:103], a[68:71], v[24:27]
 v_exp_f32 v32, v32
 v_mfma_f32_16x16x32_bf16 v[24:27], a[104:107], a[72:75], v[24:27]
 v_exp_f32 v33, v33
 v_mfma_f32_16x16x32_bf16 v[24:27], a[108:111], a[76:79], v[24:27]
 v_mul_f32 v34, s32, v34
 v_mul_f32 v35, s32, v35
 v_smfmac_f32_16x16x64_bf16 a[228:231], a[236:239], v[40:47], v2
 v_mfma_f32_16x16x32_bf16 v[28:31], a[124:127], a[76:79], 0
 v_exp_f32 v34, v34
 v_mfma_f32_16x16x32_bf16 v[28:31], a[120:123], a[72:75], v[28:31]
 v_exp_f32 v35, v35
 v_mfma_f32_16x16x32_bf16 v[28:31], a[116:119], a[68:71], v[28:31]
 s_mov_b32 s59, 4096
 v_mul_f32 v36, s32, v36
 v_mul_f32 v37, s32, v37
 v_mfma_f32_16x16x32_bf16 v[28:31], a[112:115], a[64:67], v[28:31]
 s_waitcnt lgkmcnt(3)
 buffer_store_dwordx4 v[96:99], v1, s[24:27], s59 offen sc1 nt
 v_mfma_f32_16x16x32_bf16 v[144:147], a[176:179], v[40:43], v[144:147]
 v_cvt_pk_bf16_f32 v52, v32, v33
 v_cvt_pk_bf16_f32 v53, v34, v35
 v_mfma_f32_16x16x32_bf16 v[144:147], a[208:211], v[44:47], v[144:147]
 v_exp_f32 v36, v36
 v_mfma_f32_16x16x32_bf16 v[148:151], a[180:183], v[40:43], v[148:151]
 v_exp_f32 v37, v37
 v_mfma_f32_16x16x32_bf16 v[148:151], a[212:215], v[44:47], v[148:151]
 s_waitcnt lgkmcnt(2)
 buffer_store_dwordx4 v[100:103], v1, s[24:27], s59 offen offset:1024 sc1 nt
 v_mul_f32 v38, s32, v38
 v_mul_f32 v39, s32, v39
 v_mfma_f32_16x16x32_bf16 v[152:155], a[184:187], v[40:43], v[152:155]
 v_exp_f32 v38, v38
 v_mfma_f32_16x16x32_bf16 v[152:155], a[216:219], v[44:47], v[152:155]
 s_waitcnt lgkmcnt(1)
 buffer_store_dwordx4 v[104:107], v1, s[24:27], s59 offen offset:2048 sc1 nt
 v_exp_f32 v39, v39
 v_mfma_f32_16x16x32_bf16 v[156:159], a[188:191], v[40:43], v[156:159]
 v_cvt_pk_bf16_f32 v54, v36, v37
 v_cvt_pk_bf16_f32 v55, v38, v39
 v_mfma_f32_16x16x32_bf16 v[156:159], a[220:223], v[44:47], v[156:159]
 s_waitcnt lgkmcnt(0)
 buffer_store_dwordx4 v[108:111], v1, s[24:27], s59 offen offset:3072 sc1 nt
 v_mfma_f32_16x16x32_bf16 v[32:35], a[128:131], a[64:67], 0
 v_mul_f32 v24, s32, v24
 v_mul_f32 v25, s32, v25
 v_mfma_f32_16x16x32_bf16 v[32:35], a[132:135], a[68:71], v[32:35]
 v_exp_f32 v24, v24
 v_mfma_f32_16x16x32_bf16 v[32:35], a[136:139], a[72:75], v[32:35]
 v_exp_f32 v25, v25
 v_mfma_f32_16x16x32_bf16 v[32:35], a[140:143], a[76:79], v[32:35]
 v_accvgpr_read_b32 v11, a228
 v_accvgpr_read_b32 v10, a229
 v_add_f32 v11, v11, v10
 v_rcp_f32 v10, v11
 v_cmp_nle_f32 vcc, s60, v11
 v_pk_mul_f32 v[128:129], v[128:129], v[10:11] op_sel_hi:[1,0]
 v_pk_mul_f32 v[130:131], v[130:131], v[10:11] op_sel_hi:[1,0]
 v_pk_mul_f32 v[132:133], v[132:133], v[10:11] op_sel_hi:[1,0]
 v_pk_mul_f32 v[134:135], v[134:135], v[10:11] op_sel_hi:[1,0]
 v_pk_mul_f32 v[136:137], v[136:137], v[10:11] op_sel_hi:[1,0]
 v_pk_mul_f32 v[138:139], v[138:139], v[10:11] op_sel_hi:[1,0]
 v_pk_mul_f32 v[140:141], v[140:141], v[10:11] op_sel_hi:[1,0]
 v_pk_mul_f32 v[142:143], v[142:143], v[10:11] op_sel_hi:[1,0]
 v_pk_mul_f32 v[144:145], v[144:145], v[10:11] op_sel_hi:[1,0]
 v_pk_mul_f32 v[146:147], v[146:147], v[10:11] op_sel_hi:[1,0]
 v_pk_mul_f32 v[148:149], v[148:149], v[10:11] op_sel_hi:[1,0]
 v_pk_mul_f32 v[150:151], v[150:151], v[10:11] op_sel_hi:[1,0]
 v_pk_mul_f32 v[152:153], v[152:153], v[10:11] op_sel_hi:[1,0]
 v_pk_mul_f32 v[154:155], v[154:155], v[10:11] op_sel_hi:[1,0]
 v_pk_mul_f32 v[156:157], v[156:157], v[10:11] op_sel_hi:[1,0]
 v_pk_mul_f32 v[158:159], v[158:159], v[10:11] op_sel_hi:[1,0]
 v_mfma_f32_16x16x32_bf16 v[36:39], a[156:159], a[76:79], 0
 s_or_b64 s[50:51], s[50:51], vcc
 v_mul_f32 v26, s32, v26
 v_mul_f32 v27, s32, v27
 v_mfma_f32_16x16x32_bf16 v[36:39], a[152:155], a[72:75], v[36:39]
 v_exp_f32 v26, v26
 v_mfma_f32_16x16x32_bf16 v[36:39], a[148:151], a[68:71], v[36:39]
 v_exp_f32 v27, v27
 v_mfma_f32_16x16x32_bf16 v[36:39], a[144:147], a[64:67], v[36:39]
 v_mul_f32 v28, s32, v28
 v_mul_f32 v29, s32, v29
 v_cmp_nge_f32 vcc, s61, v11
 v_add_u32 v12, 13056, v5
 v_cvt_pk_bf16_f32 v128, v128, v129
 v_cvt_pk_bf16_f32 v129, v130, v131
 v_cvt_pk_bf16_f32 v132, v132, v133
 v_cvt_pk_bf16_f32 v133, v134, v135
 v_mfma_f32_16x16x32_bf16 v[160:163], a[160:163], v[48:51], v[160:163]
 v_cvt_pk_bf16_f32 v40, v24, v25
 v_cvt_pk_bf16_f32 v41, v26, v27
 v_mfma_f32_16x16x32_bf16 v[160:163], a[192:195], v[52:55], v[160:163]
 s_or_b64 s[50:51], s[50:51], vcc
 ds_write2_b64 v12, v[128:129], v[132:133] offset0:0 offset1:4
 v_exp_f32 v28, v28
 v_cvt_pk_bf16_f32 v136, v136, v137
 v_cvt_pk_bf16_f32 v137, v138, v139
 v_cvt_pk_bf16_f32 v140, v140, v141
 v_cvt_pk_bf16_f32 v141, v142, v143
 v_mfma_f32_16x16x32_bf16 v[164:167], a[164:167], v[48:51], v[164:167]
 v_exp_f32 v29, v29
 v_mfma_f32_16x16x32_bf16 v[164:167], a[196:199], v[52:55], v[164:167]
 ds_write2_b64 v12, v[136:137], v[140:141] offset0:8 offset1:12
 v_mul_f32 v30, s32, v30
 v_mul_f32 v31, s32, v31
 v_cvt_pk_bf16_f32 v144, v144, v145
 v_cvt_pk_bf16_f32 v145, v146, v147
 v_cvt_pk_bf16_f32 v148, v148, v149
 v_cvt_pk_bf16_f32 v149, v150, v151
 v_mfma_f32_16x16x32_bf16 v[168:171], a[168:171], v[48:51], v[168:171]
L_pg1_13:
 s_cbranch_execz L_main1
 v_exp_f32 v30, v30
 v_mfma_f32_16x16x32_bf16 v[168:171], a[200:203], v[52:55], v[168:171]
 ds_write2_b64 v12, v[144:145], v[148:149] offset0:16 offset1:20
 v_exp_f32 v31, v31
 v_cvt_pk_bf16_f32 v152, v152, v153
 v_cvt_pk_bf16_f32 v153, v154, v155
 v_mfma_f32_16x16x32_bf16 v[172:175], a[172:175], v[48:51], v[172:175]
 v_cvt_pk_bf16_f32 v156, v156, v157
 v_cvt_pk_bf16_f32 v157, v158, v159
 v_mfma_f32_16x16x32_bf16 v[172:175], a[204:207], v[52:55], v[172:175]
 ds_write2_b64 v12, v[152:153], v[156:157] offset0:24 offset1:28
 ds_read_b128 v[128:131], v6 offset:13056
 ds_read_b128 v[132:135], v6 offset:14144
 ds_read_b128 v[136:139], v6 offset:15232
 ds_read_b128 v[140:143], v6 offset:16320
 v_cvt_pk_bf16_f32 v42, v28, v29
 v_cvt_pk_bf16_f32 v43, v30, v31
 v_mfma_f32_16x16x32_bf16 v[24:27], a[96:99], a[80:83], 0
 v_mul_f32 v32, s32, v32
 v_mul_f32 v33, s32, v33
 v_mfma_f32_16x16x32_bf16 v[24:27], a[100:103], a[84:87], v[24:27]
 v_exp_f32 v32, v32
 v_mfma_f32_16x16x32_bf16 v[24:27], a[104:107], a[88:91], v[24:27]
 v_exp_f32 v33, v33
 v_mfma_f32_16x16x32_bf16 v[24:27], a[108:111], a[92:95], v[24:27]
 v_mul_f32 v34, s32, v34
 v_mul_f32 v35, s32, v35
 v_smfmac_f32_16x16x64_bf16 a[228:231], a[240:243], v[48:55], v2
 v_mfma_f32_16x16x32_bf16 v[28:31], a[124:127], a[92:95], 0
 v_exp_f32 v34, v34
 v_mfma_f32_16x16x32_bf16 v[28:31], a[120:123], a[88:91], v[28:31]
 v_exp_f32 v35, v35
 v_mfma_f32_16x16x32_bf16 v[28:31], a[116:119], a[84:87], v[28:31]
 s_mov_b32 s59, 8192
 v_mul_f32 v36, s32, v36
 v_mul_f32 v37, s32, v37
 v_mfma_f32_16x16x32_bf16 v[28:31], a[112:115], a[80:83], v[28:31]
 s_waitcnt lgkmcnt(3)
 v_cvt_pk_bf16_f32 v44, v32, v33
 v_cvt_pk_bf16_f32 v45, v34, v35
 v_mfma_f32_16x16x32_bf16 v[176:179], a[176:179], v[48:51], v[176:179]
 v_exp_f32 v36, v36
 v_mfma_f32_16x16x32_bf16 v[176:179], a[208:211], v[52:55], v[176:179]
 v_exp_f32 v37, v37
 v_mfma_f32_16x16x32_bf16 v[180:183], a[180:183], v[48:51], v[180:183]
 buffer_store_dwordx4 v[128:131], v1, s[24:27], s59 offen sc1 nt
 v_mfma_f32_16x16x32_bf16 v[180:183], a[212:215], v[52:55], v[180:183]
 s_waitcnt lgkmcnt(2)
 buffer_store_dwordx4 v[132:135], v1, s[24:27], s59 offen offset:1024 sc1 nt
 v_mul_f32 v38, s32, v38
 v_mul_f32 v39, s32, v39
 v_mfma_f32_16x16x32_bf16 v[184:187], a[184:187], v[48:51], v[184:187]
 v_exp_f32 v38, v38
 v_mfma_f32_16x16x32_bf16 v[184:187], a[216:219], v[52:55], v[184:187]
 s_waitcnt lgkmcnt(1)
 buffer_store_dwordx4 v[136:139], v1, s[24:27], s59 offen offset:2048 sc1 nt
 v_exp_f32 v39, v39
 v_mfma_f32_16x16x32_bf16 v[188:191], a[188:191], v[48:51], v[188:191]
 v_cvt_pk_bf16_f32 v46, v36, v37
 v_cvt_pk_bf16_f32 v47, v38, v39
 v_mfma_f32_16x16x32_bf16 v[188:191], a[220:223], v[52:55], v[188:191]
 s_waitcnt lgkmcnt(0)
 buffer_store_dwordx4 v[140:143], v1, s[24:27], s59 offen offset:3072 sc1 nt
 v_mul_f32 v24, s32, v24
 v_mul_f32 v25, s32, v25
 v_mfma_f32_16x16x32_bf16 v[32:35], a[128:131], a[80:83], 0
 v_exp_f32 v24, v24
 v_mfma_f32_16x16x32_bf16 v[32:35], a[132:135], a[84:87], v[32:35]
 v_exp_f32 v25, v25
 v_mfma_f32_16x16x32_bf16 v[32:35], a[136:139], a[88:91], v[32:35]
 v_mul_f32 v26, s32, v26
 v_mul_f32 v27, s32, v27
 v_mfma_f32_16x16x32_bf16 v[32:35], a[140:143], a[92:95], v[32:35]
 v_accvgpr_read_b32 v11, a230
 v_accvgpr_read_b32 v10, a231
 v_add_f32 v11, v11, v10
 v_rcp_f32 v10, v11
 v_cmp_nle_f32 vcc, s60, v11
 v_pk_mul_f32 v[160:161], v[160:161], v[10:11] op_sel_hi:[1,0]
 v_pk_mul_f32 v[162:163], v[162:163], v[10:11] op_sel_hi:[1,0]
 v_pk_mul_f32 v[164:165], v[164:165], v[10:11] op_sel_hi:[1,0]
 v_pk_mul_f32 v[166:167], v[166:167], v[10:11] op_sel_hi:[1,0]
 v_pk_mul_f32 v[168:169], v[168:169], v[10:11] op_sel_hi:[1,0]
 v_pk_mul_f32 v[170:171], v[170:171], v[10:11] op_sel_hi:[1,0]
 v_pk_mul_f32 v[172:173], v[172:173], v[10:11] op_sel_hi:[1,0]
 v_pk_mul_f32 v[174:175], v[174:175], v[10:11] op_sel_hi:[1,0]
 v_pk_mul_f32 v[176:177], v[176:177], v[10:11] op_sel_hi:[1,0]
 v_pk_mul_f32 v[178:179], v[178:179], v[10:11] op_sel_hi:[1,0]
 v_pk_mul_f32 v[180:181], v[180:181], v[10:11] op_sel_hi:[1,0]
 v_pk_mul_f32 v[182:183], v[182:183], v[10:11] op_sel_hi:[1,0]
 v_pk_mul_f32 v[184:185], v[184:185], v[10:11] op_sel_hi:[1,0]
 v_pk_mul_f32 v[186:187], v[186:187], v[10:11] op_sel_hi:[1,0]
 v_pk_mul_f32 v[188:189], v[188:189], v[10:11] op_sel_hi:[1,0]
 v_pk_mul_f32 v[190:191], v[190:191], v[10:11] op_sel_hi:[1,0]
 v_mfma_f32_16x16x32_bf16 v[36:39], a[156:159], a[92:95], 0
 s_or_b64 s[50:51], s[50:51], vcc
 v_exp_f32 v26, v26
 v_mfma_f32_16x16x32_bf16 v[36:39], a[152:155], a[88:91], v[36:39]
 v_exp_f32 v27, v27
 v_mfma_f32_16x16x32_bf16 v[36:39], a[148:151], a[84:87], v[36:39]
 v_mul_f32 v28, s32, v28
 v_mul_f32 v29, s32, v29
 v_mfma_f32_16x16x32_bf16 v[36:39], a[144:147], a[80:83], v[36:39]
 v_cmp_nge_f32 vcc, s61, v11
 v_add_u32 v12, 4352, v5
 v_cvt_pk_bf16_f32 v160, v160, v161
 v_cvt_pk_bf16_f32 v161, v162, v163
 v_cvt_pk_bf16_f32 v164, v164, v165
 v_cvt_pk_bf16_f32 v165, v166, v167
 v_mfma_f32_16x16x32_bf16 v[192:195], a[160:163], v[40:43], v[192:195]
 v_cvt_pk_bf16_f32 v48, v24, v25
 v_cvt_pk_bf16_f32 v49, v26, v27
 v_mfma_f32_16x16x32_bf16 v[192:195], a[192:195], v[44:47], v[192:195]
 s_or_b64 s[50:51], s[50:51], vcc
 ds_write2_b64 v12, v[160:161], v[164:165] offset0:0 offset1:4
 v_exp_f32 v28, v28
 v_cvt_pk_bf16_f32 v168, v168, v169
 v_cvt_pk_bf16_f32 v169, v170, v171
 v_cvt_pk_bf16_f32 v172, v172, v173
 v_cvt_pk_bf16_f32 v173, v174, v175
 v_mfma_f32_16x16x32_bf16 v[196:199], a[164:167], v[40:43], v[196:199]
 v_exp_f32 v29, v29
 v_mfma_f32_16x16x32_bf16 v[196:199], a[196:199], v[44:47], v[196:199]
 ds_write2_b64 v12, v[168:169], v[172:173] offset0:8 offset1:12
 v_mul_f32 v30, s32, v30
 v_mul_f32 v31, s32, v31
 v_cvt_pk_bf16_f32 v176, v176, v177
 v_cvt_pk_bf16_f32 v177, v178, v179
 v_cvt_pk_bf16_f32 v180, v180, v181
 v_cvt_pk_bf16_f32 v181, v182, v183
 v_mfma_f32_16x16x32_bf16 v[200:203], a[168:171], v[40:43], v[200:203]
 v_exp_f32 v30, v30
 v_mfma_f32_16x16x32_bf16 v[200:203], a[200:203], v[44:47], v[200:203]
 ds_write2_b64 v12, v[176:177], v[180:181] offset0:16 offset1:20
 v_exp_f32 v31, v31
 v_mfma_f32_16x16x32_bf16 v[204:207], a[172:175], v[40:43], v[204:207]
 v_cvt_pk_bf16_f32 v50, v28, v29
 v_cvt_pk_bf16_f32 v51, v30, v31
 v_mfma_f32_16x16x32_bf16 v[204:207], a[204:207], v[44:47], v[204:207]
 v_mul_f32 v32, s32, v32
 v_mul_f32 v33, s32, v33
 v_cvt_pk_bf16_f32 v184, v184, v185
 v_cvt_pk_bf16_f32 v185, v186, v187
 v_cvt_pk_bf16_f32 v188, v188, v189
 v_cvt_pk_bf16_f32 v189, v190, v191
 v_smfmac_f32_16x16x64_bf16 a[232:235], a[236:239], v[40:47], v2
 ds_write2_b64 v12, v[184:185], v[188:189] offset0:24 offset1:28
 v_exp_f32 v32, v32
 v_mfma_f32_16x16x32_bf16 v[208:211], a[176:179], v[40:43], v[208:211]
 v_exp_f32 v33, v33
 v_mfma_f32_16x16x32_bf16 v[208:211], a[208:211], v[44:47], v[208:211]
 ds_read_b128 v[160:163], v6 offset:4352
 ds_read_b128 v[164:167], v6 offset:5440
 ds_read_b128 v[168:171], v6 offset:6528
 ds_read_b128 v[172:175], v6 offset:7616
 v_mul_f32 v34, s32, v34
 v_mul_f32 v35, s32, v35
 v_mfma_f32_16x16x32_bf16 v[212:215], a[180:183], v[40:43], v[212:215]
 v_exp_f32 v34, v34
 v_mfma_f32_16x16x32_bf16 v[212:215], a[212:215], v[44:47], v[212:215]
 v_exp_f32 v35, v35
 v_mul_f32 v36, s32, v36
 v_mfma_f32_16x16x32_bf16 v[216:219], a[184:187], v[40:43], v[216:219]
 v_mul_f32 v37, s32, v37
 v_cvt_pk_bf16_f32 v52, v32, v33
 v_mfma_f32_16x16x32_bf16 v[216:219], a[216:219], v[44:47], v[216:219]
 s_mov_b32 s59, 12288
 v_cvt_pk_bf16_f32 v53, v34, v35
 v_exp_f32 v36, v36
 v_mfma_f32_16x16x32_bf16 v[220:223], a[188:191], v[40:43], v[220:223]
 s_waitcnt lgkmcnt(3)
 buffer_store_dwordx4 v[160:163], v1, s[24:27], s59 offen sc1 nt
 v_exp_f32 v37, v37
 v_mfma_f32_16x16x32_bf16 v[220:223], a[220:223], v[44:47], v[220:223]
 v_mul_f32 v38, s32, v38
 v_mul_f32 v39, s32, v39
 v_exp_f32 v38, v38
 v_exp_f32 v39, v39
 v_cvt_pk_bf16_f32 v54, v36, v37
 v_cvt_pk_bf16_f32 v55, v38, v39
 s_nop 0
 v_mfma_f32_16x16x32_bf16 v[224:227], a[160:163], v[48:51], v[224:227]
 s_waitcnt lgkmcnt(2)
 buffer_store_dwordx4 v[164:167], v1, s[24:27], s59 offen offset:1024 sc1 nt
 v_mfma_f32_16x16x32_bf16 v[224:227], a[192:195], v[52:55], v[224:227]
 s_waitcnt lgkmcnt(1)
 buffer_store_dwordx4 v[168:171], v1, s[24:27], s59 offen offset:2048 sc1 nt
 v_mfma_f32_16x16x32_bf16 v[228:231], a[164:167], v[48:51], v[228:231]
 s_waitcnt lgkmcnt(0)
 buffer_store_dwordx4 v[172:175], v1, s[24:27], s59 offen offset:3072 sc1 nt
 v_mfma_f32_16x16x32_bf16 v[228:231], a[196:199], v[52:55], v[228:231]
 v_accvgpr_read_b32 v11, a232
 v_accvgpr_read_b32 v10, a233
 v_add_f32 v11, v11, v10
 v_rcp_f32 v10, v11
 v_cmp_nle_f32 vcc, s60, v11
 v_pk_mul_f32 v[192:193], v[192:193], v[10:11] op_sel_hi:[1,0]
 v_pk_mul_f32 v[194:195], v[194:195], v[10:11] op_sel_hi:[1,0]
 v_pk_mul_f32 v[196:197], v[196:197], v[10:11] op_sel_hi:[1,0]
 v_pk_mul_f32 v[198:199], v[198:199], v[10:11] op_sel_hi:[1,0]
 v_pk_mul_f32 v[200:201], v[200:201], v[10:11] op_sel_hi:[1,0]
 v_pk_mul_f32 v[202:203], v[202:203], v[10:11] op_sel_hi:[1,0]
 v_pk_mul_f32 v[204:205], v[204:205], v[10:11] op_sel_hi:[1,0]
 v_pk_mul_f32 v[206:207], v[206:207], v[10:11] op_sel_hi:[1,0]
 v_pk_mul_f32 v[208:209], v[208:209], v[10:11] op_sel_hi:[1,0]
 v_pk_mul_f32 v[210:211], v[210:211], v[10:11] op_sel_hi:[1,0]
 v_pk_mul_f32 v[212:213], v[212:213], v[10:11] op_sel_hi:[1,0]
 v_pk_mul_f32 v[214:215], v[214:215], v[10:11] op_sel_hi:[1,0]
 v_pk_mul_f32 v[216:217], v[216:217], v[10:11] op_sel_hi:[1,0]
 v_pk_mul_f32 v[218:219], v[218:219], v[10:11] op_sel_hi:[1,0]
 v_pk_mul_f32 v[220:221], v[220:221], v[10:11] op_sel_hi:[1,0]
 v_pk_mul_f32 v[222:223], v[222:223], v[10:11] op_sel_hi:[1,0]
 v_mfma_f32_16x16x32_bf16 v[232:235], a[168:171], v[48:51], v[232:235]
 s_or_b64 s[50:51], s[50:51], vcc
 v_cmp_nge_f32 vcc, s61, v11
 v_add_u32 v12, 8704, v5
 v_mfma_f32_16x16x32_bf16 v[232:235], a[200:203], v[52:55], v[232:235]
 v_cvt_pk_bf16_f32 v192, v192, v193
 v_cvt_pk_bf16_f32 v193, v194, v195
 v_mfma_f32_16x16x32_bf16 v[236:239], a[172:175], v[48:51], v[236:239]
 v_cvt_pk_bf16_f32 v196, v196, v197
 v_cvt_pk_bf16_f32 v197, v198, v199
 v_mfma_f32_16x16x32_bf16 v[236:239], a[204:207], v[52:55], v[236:239]
 s_or_b64 s[50:51], s[50:51], vcc
 ds_write2_b64 v12, v[192:193], v[196:197] offset0:0 offset1:4
 v_cvt_pk_bf16_f32 v200, v200, v201
 v_cvt_pk_bf16_f32 v201, v202, v203
 v_cvt_pk_bf16_f32 v204, v204, v205
 v_cvt_pk_bf16_f32 v205, v206, v207
 v_smfmac_f32_16x16x64_bf16 a[232:235], a[240:243], v[48:55], v2
 ds_write2_b64 v12, v[200:201], v[204:205] offset0:8 offset1:12
 v_mfma_f32_16x16x32_bf16 v[240:243], a[176:179], v[48:51], v[240:243]
 v_cvt_pk_bf16_f32 v208, v208, v209
 v_cvt_pk_bf16_f32 v209, v210, v211
 v_mfma_f32_16x16x32_bf16 v[240:243], a[208:211], v[52:55], v[240:243]
 v_cvt_pk_bf16_f32 v212, v212, v213
 v_cvt_pk_bf16_f32 v213, v214, v215
 v_mfma_f32_16x16x32_bf16 v[244:247], a[180:183], v[48:51], v[244:247]
 ds_write2_b64 v12, v[208:209], v[212:213] offset0:16 offset1:20
 v_mfma_f32_16x16x32_bf16 v[244:247], a[212:215], v[52:55], v[244:247]
 v_cvt_pk_bf16_f32 v216, v216, v217
 v_cvt_pk_bf16_f32 v217, v218, v219
 v_mfma_f32_16x16x32_bf16 v[248:251], a[184:187], v[48:51], v[248:251]
 v_cvt_pk_bf16_f32 v220, v220, v221
 v_cvt_pk_bf16_f32 v221, v222, v223
 v_mfma_f32_16x16x32_bf16 v[248:251], a[216:219], v[52:55], v[248:251]
 ds_write2_b64 v12, v[216:217], v[220:221] offset0:24 offset1:28
 v_mfma_f32_16x16x32_bf16 v[252:255], a[188:191], v[48:51], v[252:255]
 ds_read_b128 v[192:195], v6 offset:8704
 ds_read_b128 v[196:199], v6 offset:9792
 v_mfma_f32_16x16x32_bf16 v[252:255], a[220:223], v[52:55], v[252:255]
 ds_read_b128 v[200:203], v6 offset:10880
 ds_read_b128 v[204:207], v6 offset:11968
 s_nop 1
 v_accvgpr_read_b32 v11, a234
 v_accvgpr_read_b32 v10, a235
 v_add_f32 v11, v11, v10
 v_rcp_f32 v10, v11
 v_cmp_nle_f32 vcc, s60, v11
 v_pk_mul_f32 v[224:225], v[224:225], v[10:11] op_sel_hi:[1,0]
 v_pk_mul_f32 v[226:227], v[226:227], v[10:11] op_sel_hi:[1,0]
 v_pk_mul_f32 v[228:229], v[228:229], v[10:11] op_sel_hi:[1,0]
 v_pk_mul_f32 v[230:231], v[230:231], v[10:11] op_sel_hi:[1,0]
 v_pk_mul_f32 v[232:233], v[232:233], v[10:11] op_sel_hi:[1,0]
 v_pk_mul_f32 v[234:235], v[234:235], v[10:11] op_sel_hi:[1,0]
 v_pk_mul_f32 v[236:237], v[236:237], v[10:11] op_sel_hi:[1,0]
 v_pk_mul_f32 v[238:239], v[238:239], v[10:11] op_sel_hi:[1,0]
 v_pk_mul_f32 v[240:241], v[240:241], v[10:11] op_sel_hi:[1,0]
 v_pk_mul_f32 v[242:243], v[242:243], v[10:11] op_sel_hi:[1,0]
 v_pk_mul_f32 v[244:245], v[244:245], v[10:11] op_sel_hi:[1,0]
 v_pk_mul_f32 v[246:247], v[246:247], v[10:11] op_sel_hi:[1,0]
 v_pk_mul_f32 v[248:249], v[248:249], v[10:11] op_sel_hi:[1,0]
 v_pk_mul_f32 v[250:251], v[250:251], v[10:11] op_sel_hi:[1,0]
 v_pk_mul_f32 v[252:253], v[252:253], v[10:11] op_sel_hi:[1,0]
 v_pk_mul_f32 v[254:255], v[254:255], v[10:11] op_sel_hi:[1,0]
 s_mov_b32 s59, 16384
 s_waitcnt lgkmcnt(3)
 buffer_store_dwordx4 v[192:195], v1, s[24:27], s59 offen sc1 nt
 s_or_b64 s[50:51], s[50:51], vcc
 v_cmp_nge_f32 vcc, s61, v11
 v_add_u32 v12, 13056, v5
 v_cvt_pk_bf16_f32 v224, v224, v225
 v_cvt_pk_bf16_f32 v225, v226, v227
 v_cvt_pk_bf16_f32 v228, v228, v229
 v_cvt_pk_bf16_f32 v229, v230, v231
 s_or_b64 s[50:51], s[50:51], vcc
 ds_write2_b64 v12, v[224:225], v[228:229] offset0:0 offset1:4
 s_waitcnt lgkmcnt(3)
 buffer_store_dwordx4 v[196:199], v1, s[24:27], s59 offen offset:1024 sc1 nt
 v_cvt_pk_bf16_f32 v232, v232, v233
 v_cvt_pk_bf16_f32 v233, v234, v235
 v_cvt_pk_bf16_f32 v236, v236, v237
 v_cvt_pk_bf16_f32 v237, v238, v239
 ds_write2_b64 v12, v[232:233], v[236:237] offset0:8 offset1:12
 v_cvt_pk_bf16_f32 v240, v240, v241
 v_cvt_pk_bf16_f32 v241, v242, v243
 v_cvt_pk_bf16_f32 v244, v244, v245
 v_cvt_pk_bf16_f32 v245, v246, v247
 ds_write2_b64 v12, v[240:241], v[244:245] offset0:16 offset1:20
 v_cvt_pk_bf16_f32 v248, v248, v249
 v_cvt_pk_bf16_f32 v249, v250, v251
 v_cvt_pk_bf16_f32 v252, v252, v253
 v_cvt_pk_bf16_f32 v253, v254, v255
 ds_write2_b64 v12, v[248:249], v[252:253] offset0:24 offset1:28
 ds_read_b128 v[224:227], v6 offset:13056
 ds_read_b128 v[228:231], v6 offset:14144
 ds_read_b128 v[232:235], v6 offset:15232
 ds_read_b128 v[236:239], v6 offset:16320
 s_waitcnt lgkmcnt(9)
 buffer_store_dwordx4 v[200:203], v1, s[24:27], s59 offen offset:2048 sc1 nt
 s_waitcnt lgkmcnt(8)
 buffer_store_dwordx4 v[204:207], v1, s[24:27], s59 offen offset:3072 sc1 nt
 s_cmp_lg_u64 s[50:51], 0
 s_cselect_b32 s59, 2, 0
 s_or_b32 s52, s52, s59
 s_mov_b64 s[50:51], 0
 s_mov_b32 s59, 20480
 s_waitcnt lgkmcnt(3)
 buffer_store_dwordx4 v[224:227], v1, s[24:27], s59 offen sc1 nt
 s_waitcnt lgkmcnt(2)
 buffer_store_dwordx4 v[228:231], v1, s[24:27], s59 offen offset:1024 sc1 nt
 s_waitcnt lgkmcnt(1)
 buffer_store_dwordx4 v[232:235], v1, s[24:27], s59 offen offset:2048 sc1 nt
 s_waitcnt lgkmcnt(0)
 buffer_store_dwordx4 v[236:239], v1, s[24:27], s59 offen offset:3072 sc1 nt
 s_lshl_b32 s38, s3, 2
 s_add_u32 s38, s38, 163328
 v_mov_b32 v10, s38
 v_mov_b32 v11, s52
 ds_write_b32 v10, v11
 v_mov_b32 v10, 163328
 s_waitcnt lgkmcnt(0)
 s_barrier
 ds_read_b128 v[12:15], v10
 s_waitcnt lgkmcnt(0)
 v_or_b32 v12, v12, v13
 v_or3_b32 v12, v12, v14, v15
 s_nop 0
 v_readfirstlane_b32 s54, v12
 s_nop 3
 s_cmp_lg_u32 s54, 0
 s_cbranch_scc1 L_pend
 s_endpgm
L_end1:
L_last:
.section .rodata,"a"
.p2align 6
.amdhsa_kernel standalone__mha_softmax__near_ridge_kernel
  .amdhsa_next_free_vgpr 512
  .amdhsa_next_free_sgpr 102
  .amdhsa_accum_offset 256
  .amdhsa_group_segment_fixed_size 0
  .amdhsa_kernarg_size 48
  .amdhsa_user_sgpr_count 2
  .amdhsa_user_sgpr_kernarg_segment_ptr 1
  .amdhsa_system_sgpr_workgroup_id_x 1
  .amdhsa_float_denorm_mode_32 3
.end_amdhsa_kernel
```
